```python
import torch

def _softmax(x, axis=-1):
    return torch.softmax(x, dim=axis)

def _gelu(x):
    return torch.nn.functional.gelu(x, approximate='tanh')

def _silu(x):
    return torch.nn.functional.silu(x)

def _sigmoid(x):
    return torch.sigmoid(x)

def _layernorm(x, axis=-1, eps=1e-05):
    m = x.mean(dim=axis, keepdim=True)
    v = x.var(dim=axis, keepdim=True, unbiased=False)
    return (x - m) / torch.sqrt(v + eps)

def _scatter_add(tgt, idx, src, axis=0):
    return tgt.clone().index_add_(axis, idx, src)

def _segment_sum(src, seg, n):
    out = torch.zeros((n,) + src.shape[1:], dtype=src.dtype)
    return out.index_add_(0, seg, src)

def _pad(x, pw):
    flat = tuple((v for pair in reversed(pw) for v in pair))
    return torch.nn.functional.pad(x, flat)
kernel_name = 'adaLN_cond__memory_aug_recurrent_mem_tr__glu_gated_swiglu__prompt'

def setup_inputs():

    _w = lambda a: (lambda t: t.to(torch.bfloat16) if t.is_floating_point() else t)(torch.as_tensor(a))

    def _A_setup():
        B, S, Dm = (1, 2048, 1024)
        H, Dh = (32, 128)
        M, seg = (8, 32)
        seg = min(seg, S)
        S = S // seg * seg
        return {'x': _w((lambda *s: torch.randn(*s, dtype=torch.bfloat16) * 0.05)(B, S, Dm)), 'mem0': _w((lambda *s: torch.randn(*s, dtype=torch.bfloat16) * 0.8)(B, M, Dm)), 'Wq': _w((lambda *s: torch.randn(*s, dtype=torch.bfloat16) * 0.8)(Dm, H, Dh) * Dm ** (-0.5)), 'Wk': _w((lambda *s: torch.randn(*s, dtype=torch.bfloat16) * 0.8)(Dm, H, Dh) * Dm ** (-0.5)), 'Wv': _w((lambda *s: torch.randn(*s, dtype=torch.bfloat16) * 0.8)(Dm, H, Dh) * Dm ** (-0.5)), 'Wo': _w((lambda *s: torch.randn(*s, dtype=torch.bfloat16) * 0.8)(H, Dh, Dm) * (H * Dh) ** (-0.5)), 'seg_len': seg}
    _A_in = _A_setup()

    def _B_setup():
        B, S, D, F = (1, 2048, 1024, 3584)
        return {'x': _w((lambda *s: torch.randn(*s, dtype=torch.bfloat16) * 0.05)(B, S, D)), 'w1': _w((lambda *s: torch.randn(*s, dtype=torch.bfloat16) * 0.4)(D, F) * (2.0 / D) ** 0.5), 'w3': _w((lambda *s: torch.randn(*s, dtype=torch.bfloat16) * 0.4)(D, F) * (2.0 / D) ** 0.5), 'w2': _w((lambda *s: torch.randn(*s, dtype=torch.bfloat16) * 0.4)(F, D) * (2.0 / F) ** 0.5)}
    _B_in = _B_setup()
    return {'A_x': _A_in['x'], 'A_mem0': _A_in['mem0'], 'A_Wq': _A_in['Wq'], 'A_Wk': _A_in['Wk'], 'A_Wv': _A_in['Wv'], 'A_Wo': _A_in['Wo'], 'A_seg_len': _A_in['seg_len'], 'B_x': _B_in['x'], 'B_w1': _B_in['w1'], 'B_w3': _B_in['w3'], 'B_w2': _B_in['w2'], 'c': _w((lambda *s: torch.randn(*s, dtype=torch.bfloat16) * 0.1)(1, 1024) * 8.0), 'w_mod': _w((lambda *s: torch.randn(*s, dtype=torch.bfloat16) * 0.1)(1024, 6 * 1024) * 1024 ** (-0.5) * 8.0)}

def reference(A_x, A_mem0, A_Wq, A_Wk, A_Wv, A_Wo, A_seg_len, B_x, B_w1, B_w3, B_w2, c, w_mod):

    def _A_ref(x, mem0, Wq, Wk, Wv, Wo, seg_len):
        B, S, Dm = x.shape
        H, Dh = (Wq.shape[1], Wq.shape[2])
        M = mem0.shape[1]
        scale = Dh ** (-0.5)
        n_seg = S // seg_len
        L = M + seg_len
        idx = torch.arange(L)
        mask = (idx[:, None] < M) | (idx[:, None] >= idx[None, :])
        mem = mem0
        outs = []
        for s in range(n_seg):
            xs = x[:, s * seg_len:(s + 1) * seg_len, :].clone()
            h = torch.concatenate([mem, xs], axis=1)
            q = torch.einsum('btd,dhe->bhte', h, Wq)
            k = torch.einsum('btd,dhe->bhte', h, Wk)
            v = torch.einsum('btd,dhe->bhte', h, Wv)
            scores = torch.einsum('bhqe,bhke->bhqk', q, k) * scale
            scores = torch.where(mask[None, None], scores, -1000000000.0)
            p = _softmax(scores, axis=-1)
            o = torch.einsum('bhqk,bhke->bhqe', p, v)
            o = torch.einsum('bhte,hed->btd', o, Wo)
            mem = o[:, :M, :].clone()
            outs.append(o[:, M:, :])
        return torch.concatenate(outs, axis=1)

    def _B_ref(x, w1, w3, w2):
        gate = torch.einsum('bsd,df->bsf', x, w1)
        up = torch.einsum('bsd,df->bsf', x, w3)
        h = _silu(gate) * up
        out = torch.einsum('bsf,fd->bsd', h, w2)
        return out
    x = A_x
    mod = (_silu(c) @ w_mod).reshape(c.shape[0], 6, 1, -1)
    sa, ca, ga, sb, cb, gb = (mod[:, 0].clone(), mod[:, 1].clone(), mod[:, 2].clone(), mod[:, 3].clone(), mod[:, 4].clone(), mod[:, 5].clone())
    h = _layernorm(x, axis=-1) * (1 + ca) + sa
    x = x + ga * _A_ref(h, A_mem0, A_Wq, A_Wk, A_Wv, A_Wo, A_seg_len)
    h = _layernorm(x, axis=-1) * (1 + cb) + sb
    x = x + gb * _B_ref(h, B_w1, B_w3, B_w2)
    return x
```

```asm
; @launch kernel=mod_kernel grid=(193,1,1) block=(256,1,1) lds=1024
; @launch kernel=ln1_kernel grid=(128,1,1) block=(256,1,1) lds=1024
; @launch kernel=qkv_kernel grid=(384,1,1) block=(256,1,1) lds=131072
; @launch kernel=chain_kernel grid=(256,1,1) block=(256,1,1) lds=163840
; @launch kernel=wo_kernel grid=(128,1,1) block=(256,1,1) lds=131072
; @launch kernel=ln2_kernel grid=(128,1,1) block=(256,1,1) lds=1024
; @launch kernel=up_kernel grid=(224,1,1) block=(256,1,1) lds=131072
; @launch kernel=down_kernel grid=(128,1,1) block=(256,1,1) lds=131072
.amdgcn_target "amdgcn-amd-amdhsa--gfx950"
.text
.globl mod_kernel
.p2align 8
.type mod_kernel,@function
mod_kernel:
s_cmp_ge_u32 s2, 193
s_cbranch_scc1 Lend_1
s_load_dwordx2 s[16:17], s[0:1], 96
s_load_dwordx2 s[18:19], s[0:1], 88
s_load_dwordx2 s[30:31], s[0:1], 120
v_lshrrev_b32 v1, 6, v0
s_nop 0
v_readfirstlane_b32 s32, v1
v_and_b32 v1, 63, v0
s_waitcnt lgkmcnt(0)
s_mov_b32 s4, s30
s_and_b32 s5, s31, 0xffff
s_mov_b32 s6, 0x10000000
s_mov_b32 s7, 0x20000
s_cmp_eq_u32 s2, 192
s_cbranch_scc1 Lprb_2
s_mov_b32 s8, s16
s_and_b32 s9, s17, 0xffff
s_mov_b32 s10, 0xc00000
s_mov_b32 s11, 0x20000
s_mov_b32 s12, s18
s_and_b32 s13, s19, 0xffff
s_mov_b32 s14, 0x800
s_mov_b32 s15, 0x20000
v_lshrrev_b32 v2, 2, v0
v_and_b32 v3, 3, v0
v_mul_u32_u24 v4, 12288, v2
v_lshl_add_u32 v4, v3, 4, v4
v_lshlrev_b32 v5, 1, v2
s_lshl_b32 s40, s2, 6
buffer_load_ushort v80, v5, s[12:15], 0 offen offset:0
buffer_load_ushort v81, v5, s[12:15], 0 offen offset:128
buffer_load_ushort v82, v5, s[12:15], 0 offen offset:256
buffer_load_ushort v83, v5, s[12:15], 0 offen offset:384
buffer_load_ushort v84, v5, s[12:15], 0 offen offset:512
buffer_load_ushort v85, v5, s[12:15], 0 offen offset:640
buffer_load_ushort v86, v5, s[12:15], 0 offen offset:768
buffer_load_ushort v87, v5, s[12:15], 0 offen offset:896
buffer_load_ushort v88, v5, s[12:15], 0 offen offset:1024
buffer_load_ushort v89, v5, s[12:15], 0 offen offset:1152
buffer_load_ushort v90, v5, s[12:15], 0 offen offset:1280
buffer_load_ushort v91, v5, s[12:15], 0 offen offset:1408
buffer_load_ushort v92, v5, s[12:15], 0 offen offset:1536
buffer_load_ushort v93, v5, s[12:15], 0 offen offset:1664
buffer_load_ushort v94, v5, s[12:15], 0 offen offset:1792
buffer_load_ushort v95, v5, s[12:15], 0 offen offset:1920
buffer_load_dwordx4 v[16:19], v4, s[8:11], s40 offen
s_add_u32 s40, s40, 786432
buffer_load_dwordx4 v[20:23], v4, s[8:11], s40 offen
s_add_u32 s40, s40, 786432
buffer_load_dwordx4 v[24:27], v4, s[8:11], s40 offen
s_add_u32 s40, s40, 786432
buffer_load_dwordx4 v[28:31], v4, s[8:11], s40 offen
s_add_u32 s40, s40, 786432
buffer_load_dwordx4 v[32:35], v4, s[8:11], s40 offen
s_add_u32 s40, s40, 786432
buffer_load_dwordx4 v[36:39], v4, s[8:11], s40 offen
s_add_u32 s40, s40, 786432
buffer_load_dwordx4 v[40:43], v4, s[8:11], s40 offen
s_add_u32 s40, s40, 786432
buffer_load_dwordx4 v[44:47], v4, s[8:11], s40 offen
s_add_u32 s40, s40, 786432
buffer_load_dwordx4 v[48:51], v4, s[8:11], s40 offen
s_add_u32 s40, s40, 786432
buffer_load_dwordx4 v[52:55], v4, s[8:11], s40 offen
s_add_u32 s40, s40, 786432
buffer_load_dwordx4 v[56:59], v4, s[8:11], s40 offen
s_add_u32 s40, s40, 786432
buffer_load_dwordx4 v[60:63], v4, s[8:11], s40 offen
s_add_u32 s40, s40, 786432
buffer_load_dwordx4 v[64:67], v4, s[8:11], s40 offen
s_add_u32 s40, s40, 786432
buffer_load_dwordx4 v[68:71], v4, s[8:11], s40 offen
s_add_u32 s40, s40, 786432
buffer_load_dwordx4 v[72:75], v4, s[8:11], s40 offen
s_add_u32 s40, s40, 786432
buffer_load_dwordx4 v[76:79], v4, s[8:11], s40 offen
s_add_u32 s40, s40, 786432
v_mov_b32 v96, 0
v_mov_b32 v97, 0
v_mov_b32 v98, 0
v_mov_b32 v99, 0
v_mov_b32 v100, 0
v_mov_b32 v101, 0
v_mov_b32 v102, 0
v_mov_b32 v103, 0
s_waitcnt vmcnt(16)
v_lshlrev_b32 v80, 16, v80
v_mul_f32 v104, 0xbfb8aa3b, v80
v_exp_f32 v104, v104
s_nop 0
v_add_f32 v104, 1.0, v104
v_rcp_f32 v104, v104
s_nop 0
v_mul_f32 v104, v104, v80
v_cvt_pk_bf16_f32 v104, 0, v104
v_and_b32 v80, 0xffff0000, v104
v_lshlrev_b32 v81, 16, v81
v_mul_f32 v104, 0xbfb8aa3b, v81
v_exp_f32 v104, v104
s_nop 0
v_add_f32 v104, 1.0, v104
v_rcp_f32 v104, v104
s_nop 0
v_mul_f32 v104, v104, v81
v_cvt_pk_bf16_f32 v104, 0, v104
v_and_b32 v81, 0xffff0000, v104
v_lshlrev_b32 v82, 16, v82
v_mul_f32 v104, 0xbfb8aa3b, v82
v_exp_f32 v104, v104
s_nop 0
v_add_f32 v104, 1.0, v104
v_rcp_f32 v104, v104
s_nop 0
v_mul_f32 v104, v104, v82
v_cvt_pk_bf16_f32 v104, 0, v104
v_and_b32 v82, 0xffff0000, v104
v_lshlrev_b32 v83, 16, v83
v_mul_f32 v104, 0xbfb8aa3b, v83
v_exp_f32 v104, v104
s_nop 0
v_add_f32 v104, 1.0, v104
v_rcp_f32 v104, v104
s_nop 0
v_mul_f32 v104, v104, v83
v_cvt_pk_bf16_f32 v104, 0, v104
v_and_b32 v83, 0xffff0000, v104
v_lshlrev_b32 v84, 16, v84
v_mul_f32 v104, 0xbfb8aa3b, v84
v_exp_f32 v104, v104
s_nop 0
v_add_f32 v104, 1.0, v104
v_rcp_f32 v104, v104
s_nop 0
v_mul_f32 v104, v104, v84
v_cvt_pk_bf16_f32 v104, 0, v104
v_and_b32 v84, 0xffff0000, v104
v_lshlrev_b32 v85, 16, v85
v_mul_f32 v104, 0xbfb8aa3b, v85
v_exp_f32 v104, v104
s_nop 0
v_add_f32 v104, 1.0, v104
v_rcp_f32 v104, v104
s_nop 0
v_mul_f32 v104, v104, v85
v_cvt_pk_bf16_f32 v104, 0, v104
v_and_b32 v85, 0xffff0000, v104
v_lshlrev_b32 v86, 16, v86
v_mul_f32 v104, 0xbfb8aa3b, v86
v_exp_f32 v104, v104
s_nop 0
v_add_f32 v104, 1.0, v104
v_rcp_f32 v104, v104
s_nop 0
v_mul_f32 v104, v104, v86
v_cvt_pk_bf16_f32 v104, 0, v104
v_and_b32 v86, 0xffff0000, v104
v_lshlrev_b32 v87, 16, v87
v_mul_f32 v104, 0xbfb8aa3b, v87
v_exp_f32 v104, v104
s_nop 0
v_add_f32 v104, 1.0, v104
v_rcp_f32 v104, v104
s_nop 0
v_mul_f32 v104, v104, v87
v_cvt_pk_bf16_f32 v104, 0, v104
v_and_b32 v87, 0xffff0000, v104
v_lshlrev_b32 v88, 16, v88
v_mul_f32 v104, 0xbfb8aa3b, v88
v_exp_f32 v104, v104
s_nop 0
v_add_f32 v104, 1.0, v104
v_rcp_f32 v104, v104
s_nop 0
v_mul_f32 v104, v104, v88
v_cvt_pk_bf16_f32 v104, 0, v104
v_and_b32 v88, 0xffff0000, v104
v_lshlrev_b32 v89, 16, v89
v_mul_f32 v104, 0xbfb8aa3b, v89
v_exp_f32 v104, v104
s_nop 0
v_add_f32 v104, 1.0, v104
v_rcp_f32 v104, v104
s_nop 0
v_mul_f32 v104, v104, v89
v_cvt_pk_bf16_f32 v104, 0, v104
v_and_b32 v89, 0xffff0000, v104
v_lshlrev_b32 v90, 16, v90
v_mul_f32 v104, 0xbfb8aa3b, v90
v_exp_f32 v104, v104
s_nop 0
v_add_f32 v104, 1.0, v104
v_rcp_f32 v104, v104
s_nop 0
v_mul_f32 v104, v104, v90
v_cvt_pk_bf16_f32 v104, 0, v104
v_and_b32 v90, 0xffff0000, v104
v_lshlrev_b32 v91, 16, v91
v_mul_f32 v104, 0xbfb8aa3b, v91
v_exp_f32 v104, v104
s_nop 0
v_add_f32 v104, 1.0, v104
v_rcp_f32 v104, v104
s_nop 0
v_mul_f32 v104, v104, v91
v_cvt_pk_bf16_f32 v104, 0, v104
v_and_b32 v91, 0xffff0000, v104
v_lshlrev_b32 v92, 16, v92
v_mul_f32 v104, 0xbfb8aa3b, v92
v_exp_f32 v104, v104
s_nop 0
v_add_f32 v104, 1.0, v104
v_rcp_f32 v104, v104
s_nop 0
v_mul_f32 v104, v104, v92
v_cvt_pk_bf16_f32 v104, 0, v104
v_and_b32 v92, 0xffff0000, v104
v_lshlrev_b32 v93, 16, v93
v_mul_f32 v104, 0xbfb8aa3b, v93
v_exp_f32 v104, v104
s_nop 0
v_add_f32 v104, 1.0, v104
v_rcp_f32 v104, v104
s_nop 0
v_mul_f32 v104, v104, v93
v_cvt_pk_bf16_f32 v104, 0, v104
v_and_b32 v93, 0xffff0000, v104
v_lshlrev_b32 v94, 16, v94
v_mul_f32 v104, 0xbfb8aa3b, v94
v_exp_f32 v104, v104
s_nop 0
v_add_f32 v104, 1.0, v104
v_rcp_f32 v104, v104
s_nop 0
v_mul_f32 v104, v104, v94
v_cvt_pk_bf16_f32 v104, 0, v104
v_and_b32 v94, 0xffff0000, v104
v_lshlrev_b32 v95, 16, v95
v_mul_f32 v104, 0xbfb8aa3b, v95
v_exp_f32 v104, v104
s_nop 0
v_add_f32 v104, 1.0, v104
v_rcp_f32 v104, v104
s_nop 0
v_mul_f32 v104, v104, v95
v_cvt_pk_bf16_f32 v104, 0, v104
v_and_b32 v95, 0xffff0000, v104
s_waitcnt vmcnt(15)
v_lshlrev_b32 v104, 16, v16
v_and_b32 v105, 0xffff0000, v16
v_fmac_f32 v96, v104, v80
v_fmac_f32 v97, v105, v80
v_lshlrev_b32 v104, 16, v17
v_and_b32 v105, 0xffff0000, v17
v_fmac_f32 v98, v104, v80
v_fmac_f32 v99, v105, v80
v_lshlrev_b32 v104, 16, v18
v_and_b32 v105, 0xffff0000, v18
v_fmac_f32 v100, v104, v80
v_fmac_f32 v101, v105, v80
v_lshlrev_b32 v104, 16, v19
v_and_b32 v105, 0xffff0000, v19
v_fmac_f32 v102, v104, v80
v_fmac_f32 v103, v105, v80
s_waitcnt vmcnt(14)
v_lshlrev_b32 v104, 16, v20
v_and_b32 v105, 0xffff0000, v20
v_fmac_f32 v96, v104, v81
v_fmac_f32 v97, v105, v81
v_lshlrev_b32 v104, 16, v21
v_and_b32 v105, 0xffff0000, v21
v_fmac_f32 v98, v104, v81
v_fmac_f32 v99, v105, v81
v_lshlrev_b32 v104, 16, v22
v_and_b32 v105, 0xffff0000, v22
v_fmac_f32 v100, v104, v81
v_fmac_f32 v101, v105, v81
v_lshlrev_b32 v104, 16, v23
v_and_b32 v105, 0xffff0000, v23
v_fmac_f32 v102, v104, v81
v_fmac_f32 v103, v105, v81
s_waitcnt vmcnt(13)
v_lshlrev_b32 v104, 16, v24
v_and_b32 v105, 0xffff0000, v24
v_fmac_f32 v96, v104, v82
v_fmac_f32 v97, v105, v82
v_lshlrev_b32 v104, 16, v25
v_and_b32 v105, 0xffff0000, v25
v_fmac_f32 v98, v104, v82
v_fmac_f32 v99, v105, v82
v_lshlrev_b32 v104, 16, v26
v_and_b32 v105, 0xffff0000, v26
v_fmac_f32 v100, v104, v82
v_fmac_f32 v101, v105, v82
v_lshlrev_b32 v104, 16, v27
v_and_b32 v105, 0xffff0000, v27
v_fmac_f32 v102, v104, v82
v_fmac_f32 v103, v105, v82
s_waitcnt vmcnt(12)
v_lshlrev_b32 v104, 16, v28
v_and_b32 v105, 0xffff0000, v28
v_fmac_f32 v96, v104, v83
v_fmac_f32 v97, v105, v83
v_lshlrev_b32 v104, 16, v29
v_and_b32 v105, 0xffff0000, v29
v_fmac_f32 v98, v104, v83
v_fmac_f32 v99, v105, v83
v_lshlrev_b32 v104, 16, v30
v_and_b32 v105, 0xffff0000, v30
v_fmac_f32 v100, v104, v83
v_fmac_f32 v101, v105, v83
v_lshlrev_b32 v104, 16, v31
v_and_b32 v105, 0xffff0000, v31
v_fmac_f32 v102, v104, v83
v_fmac_f32 v103, v105, v83
s_waitcnt vmcnt(11)
v_lshlrev_b32 v104, 16, v32
v_and_b32 v105, 0xffff0000, v32
v_fmac_f32 v96, v104, v84
v_fmac_f32 v97, v105, v84
v_lshlrev_b32 v104, 16, v33
v_and_b32 v105, 0xffff0000, v33
v_fmac_f32 v98, v104, v84
v_fmac_f32 v99, v105, v84
v_lshlrev_b32 v104, 16, v34
v_and_b32 v105, 0xffff0000, v34
v_fmac_f32 v100, v104, v84
v_fmac_f32 v101, v105, v84
v_lshlrev_b32 v104, 16, v35
v_and_b32 v105, 0xffff0000, v35
v_fmac_f32 v102, v104, v84
v_fmac_f32 v103, v105, v84
s_waitcnt vmcnt(10)
v_lshlrev_b32 v104, 16, v36
v_and_b32 v105, 0xffff0000, v36
v_fmac_f32 v96, v104, v85
v_fmac_f32 v97, v105, v85
v_lshlrev_b32 v104, 16, v37
v_and_b32 v105, 0xffff0000, v37
v_fmac_f32 v98, v104, v85
v_fmac_f32 v99, v105, v85
v_lshlrev_b32 v104, 16, v38
v_and_b32 v105, 0xffff0000, v38
v_fmac_f32 v100, v104, v85
v_fmac_f32 v101, v105, v85
v_lshlrev_b32 v104, 16, v39
v_and_b32 v105, 0xffff0000, v39
v_fmac_f32 v102, v104, v85
v_fmac_f32 v103, v105, v85
s_waitcnt vmcnt(9)
v_lshlrev_b32 v104, 16, v40
v_and_b32 v105, 0xffff0000, v40
v_fmac_f32 v96, v104, v86
v_fmac_f32 v97, v105, v86
v_lshlrev_b32 v104, 16, v41
v_and_b32 v105, 0xffff0000, v41
v_fmac_f32 v98, v104, v86
v_fmac_f32 v99, v105, v86
v_lshlrev_b32 v104, 16, v42
v_and_b32 v105, 0xffff0000, v42
v_fmac_f32 v100, v104, v86
v_fmac_f32 v101, v105, v86
v_lshlrev_b32 v104, 16, v43
v_and_b32 v105, 0xffff0000, v43
v_fmac_f32 v102, v104, v86
v_fmac_f32 v103, v105, v86
s_waitcnt vmcnt(8)
v_lshlrev_b32 v104, 16, v44
v_and_b32 v105, 0xffff0000, v44
v_fmac_f32 v96, v104, v87
v_fmac_f32 v97, v105, v87
v_lshlrev_b32 v104, 16, v45
v_and_b32 v105, 0xffff0000, v45
v_fmac_f32 v98, v104, v87
v_fmac_f32 v99, v105, v87
v_lshlrev_b32 v104, 16, v46
v_and_b32 v105, 0xffff0000, v46
v_fmac_f32 v100, v104, v87
v_fmac_f32 v101, v105, v87
v_lshlrev_b32 v104, 16, v47
v_and_b32 v105, 0xffff0000, v47
v_fmac_f32 v102, v104, v87
v_fmac_f32 v103, v105, v87
s_waitcnt vmcnt(7)
v_lshlrev_b32 v104, 16, v48
v_and_b32 v105, 0xffff0000, v48
v_fmac_f32 v96, v104, v88
v_fmac_f32 v97, v105, v88
v_lshlrev_b32 v104, 16, v49
v_and_b32 v105, 0xffff0000, v49
v_fmac_f32 v98, v104, v88
v_fmac_f32 v99, v105, v88
v_lshlrev_b32 v104, 16, v50
v_and_b32 v105, 0xffff0000, v50
v_fmac_f32 v100, v104, v88
v_fmac_f32 v101, v105, v88
v_lshlrev_b32 v104, 16, v51
v_and_b32 v105, 0xffff0000, v51
v_fmac_f32 v102, v104, v88
v_fmac_f32 v103, v105, v88
s_waitcnt vmcnt(6)
v_lshlrev_b32 v104, 16, v52
v_and_b32 v105, 0xffff0000, v52
v_fmac_f32 v96, v104, v89
v_fmac_f32 v97, v105, v89
v_lshlrev_b32 v104, 16, v53
v_and_b32 v105, 0xffff0000, v53
v_fmac_f32 v98, v104, v89
v_fmac_f32 v99, v105, v89
v_lshlrev_b32 v104, 16, v54
v_and_b32 v105, 0xffff0000, v54
v_fmac_f32 v100, v104, v89
v_fmac_f32 v101, v105, v89
v_lshlrev_b32 v104, 16, v55
v_and_b32 v105, 0xffff0000, v55
v_fmac_f32 v102, v104, v89
v_fmac_f32 v103, v105, v89
s_waitcnt vmcnt(5)
v_lshlrev_b32 v104, 16, v56
v_and_b32 v105, 0xffff0000, v56
v_fmac_f32 v96, v104, v90
v_fmac_f32 v97, v105, v90
v_lshlrev_b32 v104, 16, v57
v_and_b32 v105, 0xffff0000, v57
v_fmac_f32 v98, v104, v90
v_fmac_f32 v99, v105, v90
v_lshlrev_b32 v104, 16, v58
v_and_b32 v105, 0xffff0000, v58
v_fmac_f32 v100, v104, v90
v_fmac_f32 v101, v105, v90
v_lshlrev_b32 v104, 16, v59
v_and_b32 v105, 0xffff0000, v59
v_fmac_f32 v102, v104, v90
v_fmac_f32 v103, v105, v90
s_waitcnt vmcnt(4)
v_lshlrev_b32 v104, 16, v60
v_and_b32 v105, 0xffff0000, v60
v_fmac_f32 v96, v104, v91
v_fmac_f32 v97, v105, v91
v_lshlrev_b32 v104, 16, v61
v_and_b32 v105, 0xffff0000, v61
v_fmac_f32 v98, v104, v91
v_fmac_f32 v99, v105, v91
v_lshlrev_b32 v104, 16, v62
v_and_b32 v105, 0xffff0000, v62
v_fmac_f32 v100, v104, v91
v_fmac_f32 v101, v105, v91
v_lshlrev_b32 v104, 16, v63
v_and_b32 v105, 0xffff0000, v63
v_fmac_f32 v102, v104, v91
v_fmac_f32 v103, v105, v91
s_waitcnt vmcnt(3)
v_lshlrev_b32 v104, 16, v64
v_and_b32 v105, 0xffff0000, v64
v_fmac_f32 v96, v104, v92
v_fmac_f32 v97, v105, v92
v_lshlrev_b32 v104, 16, v65
v_and_b32 v105, 0xffff0000, v65
v_fmac_f32 v98, v104, v92
v_fmac_f32 v99, v105, v92
v_lshlrev_b32 v104, 16, v66
v_and_b32 v105, 0xffff0000, v66
v_fmac_f32 v100, v104, v92
v_fmac_f32 v101, v105, v92
v_lshlrev_b32 v104, 16, v67
v_and_b32 v105, 0xffff0000, v67
v_fmac_f32 v102, v104, v92
v_fmac_f32 v103, v105, v92
s_waitcnt vmcnt(2)
v_lshlrev_b32 v104, 16, v68
v_and_b32 v105, 0xffff0000, v68
v_fmac_f32 v96, v104, v93
v_fmac_f32 v97, v105, v93
v_lshlrev_b32 v104, 16, v69
v_and_b32 v105, 0xffff0000, v69
v_fmac_f32 v98, v104, v93
v_fmac_f32 v99, v105, v93
v_lshlrev_b32 v104, 16, v70
v_and_b32 v105, 0xffff0000, v70
v_fmac_f32 v100, v104, v93
v_fmac_f32 v101, v105, v93
v_lshlrev_b32 v104, 16, v71
v_and_b32 v105, 0xffff0000, v71
v_fmac_f32 v102, v104, v93
v_fmac_f32 v103, v105, v93
s_waitcnt vmcnt(1)
v_lshlrev_b32 v104, 16, v72
v_and_b32 v105, 0xffff0000, v72
v_fmac_f32 v96, v104, v94
v_fmac_f32 v97, v105, v94
v_lshlrev_b32 v104, 16, v73
v_and_b32 v105, 0xffff0000, v73
v_fmac_f32 v98, v104, v94
v_fmac_f32 v99, v105, v94
v_lshlrev_b32 v104, 16, v74
v_and_b32 v105, 0xffff0000, v74
v_fmac_f32 v100, v104, v94
v_fmac_f32 v101, v105, v94
v_lshlrev_b32 v104, 16, v75
v_and_b32 v105, 0xffff0000, v75
v_fmac_f32 v102, v104, v94
v_fmac_f32 v103, v105, v94
s_waitcnt vmcnt(0)
v_lshlrev_b32 v104, 16, v76
v_and_b32 v105, 0xffff0000, v76
v_fmac_f32 v96, v104, v95
v_fmac_f32 v97, v105, v95
v_lshlrev_b32 v104, 16, v77
v_and_b32 v105, 0xffff0000, v77
v_fmac_f32 v98, v104, v95
v_fmac_f32 v99, v105, v95
v_lshlrev_b32 v104, 16, v78
v_and_b32 v105, 0xffff0000, v78
v_fmac_f32 v100, v104, v95
v_fmac_f32 v101, v105, v95
v_lshlrev_b32 v104, 16, v79
v_and_b32 v105, 0xffff0000, v79
v_fmac_f32 v102, v104, v95
v_fmac_f32 v103, v105, v95
s_nop 1
v_add_f32_dpp v96, v96, v96 row_ror:4 row_mask:0xf bank_mask:0xf
s_nop 1
v_add_f32_dpp v96, v96, v96 row_ror:8 row_mask:0xf bank_mask:0xf
v_mov_b32 v104, v96
s_nop 1
v_permlane16_swap_b32 v96, v104
s_nop 0
v_add_f32 v96, v96, v104
v_mov_b32 v104, v96
s_nop 1
v_permlane32_swap_b32 v96, v104
s_nop 0
v_add_f32 v96, v96, v104
s_nop 1
v_add_f32_dpp v97, v97, v97 row_ror:4 row_mask:0xf bank_mask:0xf
s_nop 1
v_add_f32_dpp v97, v97, v97 row_ror:8 row_mask:0xf bank_mask:0xf
v_mov_b32 v104, v97
s_nop 1
v_permlane16_swap_b32 v97, v104
s_nop 0
v_add_f32 v97, v97, v104
v_mov_b32 v104, v97
s_nop 1
v_permlane32_swap_b32 v97, v104
s_nop 0
v_add_f32 v97, v97, v104
s_nop 1
v_add_f32_dpp v98, v98, v98 row_ror:4 row_mask:0xf bank_mask:0xf
s_nop 1
v_add_f32_dpp v98, v98, v98 row_ror:8 row_mask:0xf bank_mask:0xf
v_mov_b32 v104, v98
s_nop 1
v_permlane16_swap_b32 v98, v104
s_nop 0
v_add_f32 v98, v98, v104
v_mov_b32 v104, v98
s_nop 1
v_permlane32_swap_b32 v98, v104
s_nop 0
v_add_f32 v98, v98, v104
s_nop 1
v_add_f32_dpp v99, v99, v99 row_ror:4 row_mask:0xf bank_mask:0xf
s_nop 1
v_add_f32_dpp v99, v99, v99 row_ror:8 row_mask:0xf bank_mask:0xf
v_mov_b32 v104, v99
s_nop 1
v_permlane16_swap_b32 v99, v104
s_nop 0
v_add_f32 v99, v99, v104
v_mov_b32 v104, v99
s_nop 1
v_permlane32_swap_b32 v99, v104
s_nop 0
v_add_f32 v99, v99, v104
s_nop 1
v_add_f32_dpp v100, v100, v100 row_ror:4 row_mask:0xf bank_mask:0xf
s_nop 1
v_add_f32_dpp v100, v100, v100 row_ror:8 row_mask:0xf bank_mask:0xf
v_mov_b32 v104, v100
s_nop 1
v_permlane16_swap_b32 v100, v104
s_nop 0
v_add_f32 v100, v100, v104
v_mov_b32 v104, v100
s_nop 1
v_permlane32_swap_b32 v100, v104
s_nop 0
v_add_f32 v100, v100, v104
s_nop 1
v_add_f32_dpp v101, v101, v101 row_ror:4 row_mask:0xf bank_mask:0xf
s_nop 1
v_add_f32_dpp v101, v101, v101 row_ror:8 row_mask:0xf bank_mask:0xf
v_mov_b32 v104, v101
s_nop 1
v_permlane16_swap_b32 v101, v104
s_nop 0
v_add_f32 v101, v101, v104
v_mov_b32 v104, v101
s_nop 1
v_permlane32_swap_b32 v101, v104
s_nop 0
v_add_f32 v101, v101, v104
s_nop 1
v_add_f32_dpp v102, v102, v102 row_ror:4 row_mask:0xf bank_mask:0xf
s_nop 1
v_add_f32_dpp v102, v102, v102 row_ror:8 row_mask:0xf bank_mask:0xf
v_mov_b32 v104, v102
s_nop 1
v_permlane16_swap_b32 v102, v104
s_nop 0
v_add_f32 v102, v102, v104
v_mov_b32 v104, v102
s_nop 1
v_permlane32_swap_b32 v102, v104
s_nop 0
v_add_f32 v102, v102, v104
s_nop 1
v_add_f32_dpp v103, v103, v103 row_ror:4 row_mask:0xf bank_mask:0xf
s_nop 1
v_add_f32_dpp v103, v103, v103 row_ror:8 row_mask:0xf bank_mask:0xf
v_mov_b32 v104, v103
s_nop 1
v_permlane16_swap_b32 v103, v104
s_nop 0
v_add_f32 v103, v103, v104
v_mov_b32 v104, v103
s_nop 1
v_permlane32_swap_b32 v103, v104
s_nop 0
v_add_f32 v103, v103, v104
s_lshl_b32 s40, s32, 7
v_lshl_add_u32 v4, v3, 5, s40
ds_write_b128 v4, v[96:99]
ds_write_b128 v4, v[100:103] offset:16
s_waitcnt lgkmcnt(0)
s_barrier
v_and_b32 v4, 31, v0
v_lshlrev_b32 v4, 2, v4
ds_read_b32 v96, v4 offset:0
ds_read_b32 v97, v4 offset:128
ds_read_b32 v98, v4 offset:256
ds_read_b32 v99, v4 offset:384
v_lshrrev_b32 v5, 5, v0
v_min_u32 v5, 1, v5
v_lshl_add_u32 v4, v5, 30, v4
s_lshl_b32 s40, s2, 7
s_add_u32 s40, s40, 3145728
s_waitcnt lgkmcnt(0)
v_add_f32 v96, v96, v97
v_add_f32 v98, v98, v99
v_add_f32 v96, v96, v98
v_cvt_pk_bf16_f32 v96, 0, v96
v_and_b32 v96, 0xffff0000, v96
buffer_store_dword v96, v4, s[4:7], s40 offen sc1
s_endpgm
Lprb_2:
s_getreg_b32 s51, hwreg(HW_REG_XCC_ID, 0, 4)
s_bfe_u32 s51, s51, 0x10002
v_lshlrev_b32 v2, 8, v1
v_mov_b32 v3, -1
s_lshl_b32 s52, s32, 22
s_add_u32 s52, s52, 134217728
buffer_store_dword v3, v2, s[4:7], s52 offen sc1
s_lshl_b32 s53, s32, 22
s_add_u32 s53, s53, 136314880
buffer_store_dword v3, v2, s[4:7], s53 offen sc1
s_waitcnt vmcnt(0)
s_mov_b64 exec, 1
s_mov_b32 s54, -1
s_mov_b32 s55, -1
v_mov_b32 v2, 0
s_memtime s[56:57]
s_waitcnt lgkmcnt(0)
buffer_load_dword v3, v2, s[4:7], s52 offen sc1
s_waitcnt vmcnt(0)
s_memtime s[58:59]
s_waitcnt lgkmcnt(0)
s_sub_u32 s56, s58, s56
s_min_u32 s54, s54, s56
v_mov_b32 v2, 8192
s_memtime s[56:57]
s_waitcnt lgkmcnt(0)
buffer_load_dword v3, v2, s[4:7], s52 offen sc1
s_waitcnt vmcnt(0)
s_memtime s[58:59]
s_waitcnt lgkmcnt(0)
s_sub_u32 s56, s58, s56
s_min_u32 s55, s55, s56
v_mov_b32 v2, 2304
s_memtime s[56:57]
s_waitcnt lgkmcnt(0)
buffer_load_dword v3, v2, s[4:7], s52 offen sc1
s_waitcnt vmcnt(0)
s_memtime s[58:59]
s_waitcnt lgkmcnt(0)
s_sub_u32 s56, s58, s56
s_min_u32 s54, s54, s56
v_mov_b32 v2, 10496
s_memtime s[56:57]
s_waitcnt lgkmcnt(0)
buffer_load_dword v3, v2, s[4:7], s52 offen sc1
s_waitcnt vmcnt(0)
s_memtime s[58:59]
s_waitcnt lgkmcnt(0)
s_sub_u32 s56, s58, s56
s_min_u32 s55, s55, s56
v_mov_b32 v2, 4608
s_memtime s[56:57]
s_waitcnt lgkmcnt(0)
buffer_load_dword v3, v2, s[4:7], s52 offen sc1
s_waitcnt vmcnt(0)
s_memtime s[58:59]
s_waitcnt lgkmcnt(0)
s_sub_u32 s56, s58, s56
s_min_u32 s54, s54, s56
v_mov_b32 v2, 12800
s_memtime s[56:57]
s_waitcnt lgkmcnt(0)
buffer_load_dword v3, v2, s[4:7], s52 offen sc1
s_waitcnt vmcnt(0)
s_memtime s[58:59]
s_waitcnt lgkmcnt(0)
s_sub_u32 s56, s58, s56
s_min_u32 s55, s55, s56
s_cmp_lt_u32 s55, s54
s_cselect_b32 s56, 1, 0
s_xor_b32 s56, s56, s51
v_mov_b32 v4, s56
s_mov_b32 s54, -1
s_mov_b32 s55, -1
v_mov_b32 v2, 0
s_memtime s[56:57]
s_waitcnt lgkmcnt(0)
buffer_load_dword v3, v2, s[4:7], s53 offen sc1
s_waitcnt vmcnt(0)
s_memtime s[58:59]
s_waitcnt lgkmcnt(0)
s_sub_u32 s56, s58, s56
s_min_u32 s54, s54, s56
v_mov_b32 v2, 8192
s_memtime s[56:57]
s_waitcnt lgkmcnt(0)
buffer_load_dword v3, v2, s[4:7], s53 offen sc1
s_waitcnt vmcnt(0)
s_memtime s[58:59]
s_waitcnt lgkmcnt(0)
s_sub_u32 s56, s58, s56
s_min_u32 s55, s55, s56
v_mov_b32 v2, 2304
s_memtime s[56:57]
s_waitcnt lgkmcnt(0)
buffer_load_dword v3, v2, s[4:7], s53 offen sc1
s_waitcnt vmcnt(0)
s_memtime s[58:59]
s_waitcnt lgkmcnt(0)
s_sub_u32 s56, s58, s56
s_min_u32 s54, s54, s56
v_mov_b32 v2, 10496
s_memtime s[56:57]
s_waitcnt lgkmcnt(0)
buffer_load_dword v3, v2, s[4:7], s53 offen sc1
s_waitcnt vmcnt(0)
s_memtime s[58:59]
s_waitcnt lgkmcnt(0)
s_sub_u32 s56, s58, s56
s_min_u32 s55, s55, s56
v_mov_b32 v2, 4608
s_memtime s[56:57]
s_waitcnt lgkmcnt(0)
buffer_load_dword v3, v2, s[4:7], s53 offen sc1
s_waitcnt vmcnt(0)
s_memtime s[58:59]
s_waitcnt lgkmcnt(0)
s_sub_u32 s56, s58, s56
s_min_u32 s54, s54, s56
v_mov_b32 v2, 12800
s_memtime s[56:57]
s_waitcnt lgkmcnt(0)
buffer_load_dword v3, v2, s[4:7], s53 offen sc1
s_waitcnt vmcnt(0)
s_memtime s[58:59]
s_waitcnt lgkmcnt(0)
s_sub_u32 s56, s58, s56
s_min_u32 s55, s55, s56
s_cmp_lt_u32 s55, s54
s_cselect_b32 s56, 1, 0
s_xor_b32 s56, s56, s51
v_mov_b32 v5, s56
v_lshlrev_b32 v2, 3, s32
s_mov_b32 s56, 1048576
buffer_store_dwordx2 v[4:5], v2, s[4:7], s56 offen
s_mov_b64 exec, -1
Lend_1:
s_endpgm
.globl ln1_kernel
.p2align 8
.type ln1_kernel,@function
ln1_kernel:
s_cmp_ge_u32 s2, 128
s_cbranch_scc1 Lend_3
s_load_dwordx2 s[16:17], s[0:1], 0
s_load_dwordx2 s[30:31], s[0:1], 120
v_lshrrev_b32 v1, 6, v0
s_nop 0
v_readfirstlane_b32 s32, v1
v_and_b32 v1, 63, v0
s_waitcnt lgkmcnt(0)
s_mov_b32 s4, s30
s_and_b32 s5, s31, 0xffff
s_mov_b32 s6, 0x10000000
s_mov_b32 s7, 0x20000
s_mov_b32 s8, s16
s_and_b32 s9, s17, 0xffff
s_mov_b32 s10, 0x400000
s_mov_b32 s11, 0x20000
s_lshr_b32 s40, s2, 2
s_lshl_b32 s40, s40, 2
s_add_u32 s40, s40, s32
s_lshl_b32 s40, s40, 15
s_and_b32 s41, s2, 3
s_lshl_b32 s41, s41, 10
s_add_u32 s40, s40, s41
v_lshlrev_b32 v2, 4, v1
v_lshrrev_b32 v3, 4, v1
v_and_b32 v4, 15, v1
v_lshlrev_b32 v4, 11, v4
v_and_b32 v5, 1, v3
v_lshl_add_u32 v4, v5, 5, v4
v_lshrrev_b32 v5, 1, v3
v_lshl_add_u32 v4, v5, 4, v4
s_lshl_b32 s41, s2, 15
s_lshl_b32 s42, s32, 9
s_add_u32 s41, s41, s42
buffer_load_dwordx4 v[16:19], v4, s[8:11], s41 offen offset:0
buffer_load_dwordx4 v[20:23], v4, s[8:11], s41 offen offset:64
buffer_load_dwordx4 v[24:27], v4, s[8:11], s41 offen offset:128
buffer_load_dwordx4 v[28:31], v4, s[8:11], s41 offen offset:192
buffer_load_dwordx4 v[32:35], v4, s[8:11], s41 offen offset:256
buffer_load_dwordx4 v[36:39], v4, s[8:11], s41 offen offset:320
buffer_load_dwordx4 v[40:43], v4, s[8:11], s41 offen offset:384
buffer_load_dwordx4 v[44:47], v4, s[8:11], s41 offen offset:448
v_lshlrev_b32 v3, 4, v3
s_lshl_b32 s42, s32, 10
s_add_u32 s43, s42, 3149824
s_add_u32 s42, s42, 3145728
buffer_load_dwordx4 v[176:179], v3, s[4:7], s43 offen offset:0 sc1
buffer_load_dwordx4 v[112:115], v3, s[4:7], s42 offen offset:0 sc1
buffer_load_dwordx4 v[180:183], v3, s[4:7], s43 offen offset:64 sc1
buffer_load_dwordx4 v[116:119], v3, s[4:7], s42 offen offset:64 sc1
buffer_load_dwordx4 v[184:187], v3, s[4:7], s43 offen offset:128 sc1
buffer_load_dwordx4 v[120:123], v3, s[4:7], s42 offen offset:128 sc1
buffer_load_dwordx4 v[188:191], v3, s[4:7], s43 offen offset:192 sc1
buffer_load_dwordx4 v[124:127], v3, s[4:7], s42 offen offset:192 sc1
buffer_load_dwordx4 v[192:195], v3, s[4:7], s43 offen offset:256 sc1
buffer_load_dwordx4 v[128:131], v3, s[4:7], s42 offen offset:256 sc1
buffer_load_dwordx4 v[196:199], v3, s[4:7], s43 offen offset:320 sc1
buffer_load_dwordx4 v[132:135], v3, s[4:7], s42 offen offset:320 sc1
buffer_load_dwordx4 v[200:203], v3, s[4:7], s43 offen offset:384 sc1
buffer_load_dwordx4 v[136:139], v3, s[4:7], s42 offen offset:384 sc1
buffer_load_dwordx4 v[204:207], v3, s[4:7], s43 offen offset:448 sc1
buffer_load_dwordx4 v[140:143], v3, s[4:7], s42 offen offset:448 sc1
buffer_load_dwordx4 v[208:211], v3, s[4:7], s43 offen offset:512 sc1
buffer_load_dwordx4 v[144:147], v3, s[4:7], s42 offen offset:512 sc1
buffer_load_dwordx4 v[212:215], v3, s[4:7], s43 offen offset:576 sc1
buffer_load_dwordx4 v[148:151], v3, s[4:7], s42 offen offset:576 sc1
buffer_load_dwordx4 v[216:219], v3, s[4:7], s43 offen offset:640 sc1
buffer_load_dwordx4 v[152:155], v3, s[4:7], s42 offen offset:640 sc1
buffer_load_dwordx4 v[220:223], v3, s[4:7], s43 offen offset:704 sc1
buffer_load_dwordx4 v[156:159], v3, s[4:7], s42 offen offset:704 sc1
buffer_load_dwordx4 v[224:227], v3, s[4:7], s43 offen offset:768 sc1
buffer_load_dwordx4 v[160:163], v3, s[4:7], s42 offen offset:768 sc1
buffer_load_dwordx4 v[228:231], v3, s[4:7], s43 offen offset:832 sc1
buffer_load_dwordx4 v[164:167], v3, s[4:7], s42 offen offset:832 sc1
buffer_load_dwordx4 v[232:235], v3, s[4:7], s43 offen offset:896 sc1
buffer_load_dwordx4 v[168:171], v3, s[4:7], s42 offen offset:896 sc1
buffer_load_dwordx4 v[236:239], v3, s[4:7], s43 offen offset:960 sc1
buffer_load_dwordx4 v[172:175], v3, s[4:7], s42 offen offset:960 sc1
s_waitcnt vmcnt(32)
v_permlane16_swap_b32 v16, v18
v_permlane16_swap_b32 v17, v19
s_add_u32 s41, s40, 20971520
buffer_store_dwordx4 v[16:19], v2, s[4:7], s41 offen sc1
v_permlane16_swap_b32 v20, v22
v_permlane16_swap_b32 v21, v23
s_add_u32 s41, s40, 20975616
buffer_store_dwordx4 v[20:23], v2, s[4:7], s41 offen sc1
v_permlane16_swap_b32 v24, v26
v_permlane16_swap_b32 v25, v27
s_add_u32 s41, s40, 20979712
buffer_store_dwordx4 v[24:27], v2, s[4:7], s41 offen sc1
v_permlane16_swap_b32 v28, v30
v_permlane16_swap_b32 v29, v31
s_add_u32 s41, s40, 20983808
buffer_store_dwordx4 v[28:31], v2, s[4:7], s41 offen sc1
v_permlane16_swap_b32 v32, v34
v_permlane16_swap_b32 v33, v35
s_add_u32 s41, s40, 20987904
buffer_store_dwordx4 v[32:35], v2, s[4:7], s41 offen sc1
v_permlane16_swap_b32 v36, v38
v_permlane16_swap_b32 v37, v39
s_add_u32 s41, s40, 20992000
buffer_store_dwordx4 v[36:39], v2, s[4:7], s41 offen sc1
v_permlane16_swap_b32 v40, v42
v_permlane16_swap_b32 v41, v43
s_add_u32 s41, s40, 20996096
buffer_store_dwordx4 v[40:43], v2, s[4:7], s41 offen sc1
v_permlane16_swap_b32 v44, v46
v_permlane16_swap_b32 v45, v47
s_add_u32 s41, s40, 21000192
buffer_store_dwordx4 v[44:47], v2, s[4:7], s41 offen sc1
v_lshlrev_b32 v48, 16, v16
v_and_b32 v49, 0xffff0000, v16
v_lshlrev_b32 v50, 16, v17
v_and_b32 v51, 0xffff0000, v17
v_lshlrev_b32 v52, 16, v18
v_and_b32 v53, 0xffff0000, v18
v_lshlrev_b32 v54, 16, v19
v_and_b32 v55, 0xffff0000, v19
v_lshlrev_b32 v56, 16, v20
v_and_b32 v57, 0xffff0000, v20
v_lshlrev_b32 v58, 16, v21
v_and_b32 v59, 0xffff0000, v21
v_lshlrev_b32 v60, 16, v22
v_and_b32 v61, 0xffff0000, v22
v_lshlrev_b32 v62, 16, v23
v_and_b32 v63, 0xffff0000, v23
v_lshlrev_b32 v64, 16, v24
v_and_b32 v65, 0xffff0000, v24
v_lshlrev_b32 v66, 16, v25
v_and_b32 v67, 0xffff0000, v25
v_lshlrev_b32 v68, 16, v26
v_and_b32 v69, 0xffff0000, v26
v_lshlrev_b32 v70, 16, v27
v_and_b32 v71, 0xffff0000, v27
v_lshlrev_b32 v72, 16, v28
v_and_b32 v73, 0xffff0000, v28
v_lshlrev_b32 v74, 16, v29
v_and_b32 v75, 0xffff0000, v29
v_lshlrev_b32 v76, 16, v30
v_and_b32 v77, 0xffff0000, v30
v_lshlrev_b32 v78, 16, v31
v_and_b32 v79, 0xffff0000, v31
v_lshlrev_b32 v80, 16, v32
v_and_b32 v81, 0xffff0000, v32
v_lshlrev_b32 v82, 16, v33
v_and_b32 v83, 0xffff0000, v33
v_lshlrev_b32 v84, 16, v34
v_and_b32 v85, 0xffff0000, v34
v_lshlrev_b32 v86, 16, v35
v_and_b32 v87, 0xffff0000, v35
v_lshlrev_b32 v88, 16, v36
v_and_b32 v89, 0xffff0000, v36
v_lshlrev_b32 v90, 16, v37
v_and_b32 v91, 0xffff0000, v37
v_lshlrev_b32 v92, 16, v38
v_and_b32 v93, 0xffff0000, v38
v_lshlrev_b32 v94, 16, v39
v_and_b32 v95, 0xffff0000, v39
v_lshlrev_b32 v96, 16, v40
v_and_b32 v97, 0xffff0000, v40
v_lshlrev_b32 v98, 16, v41
v_and_b32 v99, 0xffff0000, v41
v_lshlrev_b32 v100, 16, v42
v_and_b32 v101, 0xffff0000, v42
v_lshlrev_b32 v102, 16, v43
v_and_b32 v103, 0xffff0000, v43
v_lshlrev_b32 v104, 16, v44
v_and_b32 v105, 0xffff0000, v44
v_lshlrev_b32 v106, 16, v45
v_and_b32 v107, 0xffff0000, v45
v_lshlrev_b32 v108, 16, v46
v_and_b32 v109, 0xffff0000, v46
v_lshlrev_b32 v110, 16, v47
v_and_b32 v111, 0xffff0000, v47
v_and_b32 v8, 15, v1
v_lshlrev_b32 v8, 4, v8
s_lshl_b32 s41, s32, 2
v_add_u32 v9, s41, v8
v_pk_add_f32 v[4:5], v[48:49], v[50:51]
v_pk_add_f32 v[4:5], v[4:5], v[52:53]
v_pk_add_f32 v[4:5], v[4:5], v[54:55]
v_pk_add_f32 v[4:5], v[4:5], v[56:57]
v_pk_add_f32 v[4:5], v[4:5], v[58:59]
v_pk_add_f32 v[4:5], v[4:5], v[60:61]
v_pk_add_f32 v[4:5], v[4:5], v[62:63]
v_pk_add_f32 v[4:5], v[4:5], v[64:65]
v_pk_add_f32 v[4:5], v[4:5], v[66:67]
v_pk_add_f32 v[4:5], v[4:5], v[68:69]
v_pk_add_f32 v[4:5], v[4:5], v[70:71]
v_pk_add_f32 v[4:5], v[4:5], v[72:73]
v_pk_add_f32 v[4:5], v[4:5], v[74:75]
v_pk_add_f32 v[4:5], v[4:5], v[76:77]
v_pk_add_f32 v[4:5], v[4:5], v[78:79]
v_pk_add_f32 v[4:5], v[4:5], v[80:81]
v_pk_add_f32 v[4:5], v[4:5], v[82:83]
v_pk_add_f32 v[4:5], v[4:5], v[84:85]
v_pk_add_f32 v[4:5], v[4:5], v[86:87]
v_pk_add_f32 v[4:5], v[4:5], v[88:89]
v_pk_add_f32 v[4:5], v[4:5], v[90:91]
v_pk_add_f32 v[4:5], v[4:5], v[92:93]
v_pk_add_f32 v[4:5], v[4:5], v[94:95]
v_pk_add_f32 v[4:5], v[4:5], v[96:97]
v_pk_add_f32 v[4:5], v[4:5], v[98:99]
v_pk_add_f32 v[4:5], v[4:5], v[100:101]
v_pk_add_f32 v[4:5], v[4:5], v[102:103]
v_pk_add_f32 v[4:5], v[4:5], v[104:105]
v_pk_add_f32 v[4:5], v[4:5], v[106:107]
v_pk_add_f32 v[4:5], v[4:5], v[108:109]
v_pk_add_f32 v[4:5], v[4:5], v[110:111]
v_add_f32 v4, v4, v5
v_mov_b32 v5, v4
s_nop 1
v_permlane16_swap_b32 v4, v5
s_nop 0
v_add_f32 v4, v4, v5
v_mov_b32 v5, v4
s_nop 1
v_permlane32_swap_b32 v4, v5
s_nop 0
v_add_f32 v4, v4, v5
ds_write_b32 v9, v4 offset:0
s_waitcnt lgkmcnt(0)
s_barrier
ds_read_b128 v[4:7], v8 offset:0
s_waitcnt lgkmcnt(0)
v_pk_add_f32 v[4:5], v[4:5], v[6:7]
v_add_f32 v4, v4, v5
v_mul_f32 v4, 0x3a800000, v4
v_pk_add_f32 v[48:49], v[48:49], v[4:5] op_sel_hi:[1,0] neg_lo:[0,1] neg_hi:[0,1]
v_pk_add_f32 v[50:51], v[50:51], v[4:5] op_sel_hi:[1,0] neg_lo:[0,1] neg_hi:[0,1]
v_pk_add_f32 v[52:53], v[52:53], v[4:5] op_sel_hi:[1,0] neg_lo:[0,1] neg_hi:[0,1]
v_pk_add_f32 v[54:55], v[54:55], v[4:5] op_sel_hi:[1,0] neg_lo:[0,1] neg_hi:[0,1]
v_pk_add_f32 v[56:57], v[56:57], v[4:5] op_sel_hi:[1,0] neg_lo:[0,1] neg_hi:[0,1]
v_pk_add_f32 v[58:59], v[58:59], v[4:5] op_sel_hi:[1,0] neg_lo:[0,1] neg_hi:[0,1]
v_pk_add_f32 v[60:61], v[60:61], v[4:5] op_sel_hi:[1,0] neg_lo:[0,1] neg_hi:[0,1]
v_pk_add_f32 v[62:63], v[62:63], v[4:5] op_sel_hi:[1,0] neg_lo:[0,1] neg_hi:[0,1]
v_pk_add_f32 v[64:65], v[64:65], v[4:5] op_sel_hi:[1,0] neg_lo:[0,1] neg_hi:[0,1]
v_pk_add_f32 v[66:67], v[66:67], v[4:5] op_sel_hi:[1,0] neg_lo:[0,1] neg_hi:[0,1]
v_pk_add_f32 v[68:69], v[68:69], v[4:5] op_sel_hi:[1,0] neg_lo:[0,1] neg_hi:[0,1]
v_pk_add_f32 v[70:71], v[70:71], v[4:5] op_sel_hi:[1,0] neg_lo:[0,1] neg_hi:[0,1]
v_pk_add_f32 v[72:73], v[72:73], v[4:5] op_sel_hi:[1,0] neg_lo:[0,1] neg_hi:[0,1]
v_pk_add_f32 v[74:75], v[74:75], v[4:5] op_sel_hi:[1,0] neg_lo:[0,1] neg_hi:[0,1]
v_pk_add_f32 v[76:77], v[76:77], v[4:5] op_sel_hi:[1,0] neg_lo:[0,1] neg_hi:[0,1]
v_pk_add_f32 v[78:79], v[78:79], v[4:5] op_sel_hi:[1,0] neg_lo:[0,1] neg_hi:[0,1]
v_pk_add_f32 v[80:81], v[80:81], v[4:5] op_sel_hi:[1,0] neg_lo:[0,1] neg_hi:[0,1]
v_pk_add_f32 v[82:83], v[82:83], v[4:5] op_sel_hi:[1,0] neg_lo:[0,1] neg_hi:[0,1]
v_pk_add_f32 v[84:85], v[84:85], v[4:5] op_sel_hi:[1,0] neg_lo:[0,1] neg_hi:[0,1]
v_pk_add_f32 v[86:87], v[86:87], v[4:5] op_sel_hi:[1,0] neg_lo:[0,1] neg_hi:[0,1]
v_pk_add_f32 v[88:89], v[88:89], v[4:5] op_sel_hi:[1,0] neg_lo:[0,1] neg_hi:[0,1]
v_pk_add_f32 v[90:91], v[90:91], v[4:5] op_sel_hi:[1,0] neg_lo:[0,1] neg_hi:[0,1]
v_pk_add_f32 v[92:93], v[92:93], v[4:5] op_sel_hi:[1,0] neg_lo:[0,1] neg_hi:[0,1]
v_pk_add_f32 v[94:95], v[94:95], v[4:5] op_sel_hi:[1,0] neg_lo:[0,1] neg_hi:[0,1]
v_pk_add_f32 v[96:97], v[96:97], v[4:5] op_sel_hi:[1,0] neg_lo:[0,1] neg_hi:[0,1]
v_pk_add_f32 v[98:99], v[98:99], v[4:5] op_sel_hi:[1,0] neg_lo:[0,1] neg_hi:[0,1]
v_pk_add_f32 v[100:101], v[100:101], v[4:5] op_sel_hi:[1,0] neg_lo:[0,1] neg_hi:[0,1]
v_pk_add_f32 v[102:103], v[102:103], v[4:5] op_sel_hi:[1,0] neg_lo:[0,1] neg_hi:[0,1]
v_pk_add_f32 v[104:105], v[104:105], v[4:5] op_sel_hi:[1,0] neg_lo:[0,1] neg_hi:[0,1]
v_pk_add_f32 v[106:107], v[106:107], v[4:5] op_sel_hi:[1,0] neg_lo:[0,1] neg_hi:[0,1]
v_pk_add_f32 v[108:109], v[108:109], v[4:5] op_sel_hi:[1,0] neg_lo:[0,1] neg_hi:[0,1]
v_pk_add_f32 v[110:111], v[110:111], v[4:5] op_sel_hi:[1,0] neg_lo:[0,1] neg_hi:[0,1]
v_pk_mul_f32 v[4:5], v[48:49], v[48:49]
v_pk_fma_f32 v[4:5], v[50:51], v[50:51], v[4:5]
v_pk_fma_f32 v[4:5], v[52:53], v[52:53], v[4:5]
v_pk_fma_f32 v[4:5], v[54:55], v[54:55], v[4:5]
v_pk_fma_f32 v[4:5], v[56:57], v[56:57], v[4:5]
v_pk_fma_f32 v[4:5], v[58:59], v[58:59], v[4:5]
v_pk_fma_f32 v[4:5], v[60:61], v[60:61], v[4:5]
v_pk_fma_f32 v[4:5], v[62:63], v[62:63], v[4:5]
v_pk_fma_f32 v[4:5], v[64:65], v[64:65], v[4:5]
v_pk_fma_f32 v[4:5], v[66:67], v[66:67], v[4:5]
v_pk_fma_f32 v[4:5], v[68:69], v[68:69], v[4:5]
v_pk_fma_f32 v[4:5], v[70:71], v[70:71], v[4:5]
v_pk_fma_f32 v[4:5], v[72:73], v[72:73], v[4:5]
v_pk_fma_f32 v[4:5], v[74:75], v[74:75], v[4:5]
v_pk_fma_f32 v[4:5], v[76:77], v[76:77], v[4:5]
v_pk_fma_f32 v[4:5], v[78:79], v[78:79], v[4:5]
v_pk_fma_f32 v[4:5], v[80:81], v[80:81], v[4:5]
v_pk_fma_f32 v[4:5], v[82:83], v[82:83], v[4:5]
v_pk_fma_f32 v[4:5], v[84:85], v[84:85], v[4:5]
v_pk_fma_f32 v[4:5], v[86:87], v[86:87], v[4:5]
v_pk_fma_f32 v[4:5], v[88:89], v[88:89], v[4:5]
v_pk_fma_f32 v[4:5], v[90:91], v[90:91], v[4:5]
v_pk_fma_f32 v[4:5], v[92:93], v[92:93], v[4:5]
v_pk_fma_f32 v[4:5], v[94:95], v[94:95], v[4:5]
v_pk_fma_f32 v[4:5], v[96:97], v[96:97], v[4:5]
v_pk_fma_f32 v[4:5], v[98:99], v[98:99], v[4:5]
v_pk_fma_f32 v[4:5], v[100:101], v[100:101], v[4:5]
v_pk_fma_f32 v[4:5], v[102:103], v[102:103], v[4:5]
v_pk_fma_f32 v[4:5], v[104:105], v[104:105], v[4:5]
v_pk_fma_f32 v[4:5], v[106:107], v[106:107], v[4:5]
v_pk_fma_f32 v[4:5], v[108:109], v[108:109], v[4:5]
v_pk_fma_f32 v[4:5], v[110:111], v[110:111], v[4:5]
v_add_f32 v4, v4, v5
v_mov_b32 v5, v4
s_nop 1
v_permlane16_swap_b32 v4, v5
s_nop 0
v_add_f32 v4, v4, v5
v_mov_b32 v5, v4
s_nop 1
v_permlane32_swap_b32 v4, v5
s_nop 0
v_add_f32 v4, v4, v5
ds_write_b32 v9, v4 offset:256
s_waitcnt lgkmcnt(0)
s_barrier
ds_read_b128 v[4:7], v8 offset:256
s_waitcnt lgkmcnt(0)
v_pk_add_f32 v[4:5], v[4:5], v[6:7]
v_add_f32 v4, v4, v5
v_mul_f32 v4, 0x3a800000, v4
v_add_f32 v4, 0x3727c5ac, v4
v_rsq_f32 v4, v4
s_waitcnt vmcnt(8)
v_pk_mul_f32 v[48:49], v[48:49], v[4:5] op_sel_hi:[1,0]
v_pk_add_f32 v[112:113], v[112:113], v[48:49]
v_pk_fma_f32 v[48:49], v[48:49], v[176:177], v[112:113]
v_pk_mul_f32 v[50:51], v[50:51], v[4:5] op_sel_hi:[1,0]
v_pk_add_f32 v[114:115], v[114:115], v[50:51]
v_pk_fma_f32 v[50:51], v[50:51], v[178:179], v[114:115]
v_pk_mul_f32 v[52:53], v[52:53], v[4:5] op_sel_hi:[1,0]
v_pk_add_f32 v[116:117], v[116:117], v[52:53]
v_pk_fma_f32 v[52:53], v[52:53], v[180:181], v[116:117]
v_pk_mul_f32 v[54:55], v[54:55], v[4:5] op_sel_hi:[1,0]
v_pk_add_f32 v[118:119], v[118:119], v[54:55]
v_pk_fma_f32 v[54:55], v[54:55], v[182:183], v[118:119]
v_cvt_pk_bf16_f32 v176, v48, v49
v_cvt_pk_bf16_f32 v177, v50, v51
v_cvt_pk_bf16_f32 v178, v52, v53
v_cvt_pk_bf16_f32 v179, v54, v55
s_add_u32 s41, s40, 8388608
buffer_store_dwordx4 v[176:179], v2, s[4:7], s41 offen sc1
v_pk_mul_f32 v[56:57], v[56:57], v[4:5] op_sel_hi:[1,0]
v_pk_add_f32 v[120:121], v[120:121], v[56:57]
v_pk_fma_f32 v[56:57], v[56:57], v[184:185], v[120:121]
v_pk_mul_f32 v[58:59], v[58:59], v[4:5] op_sel_hi:[1,0]
v_pk_add_f32 v[122:123], v[122:123], v[58:59]
v_pk_fma_f32 v[58:59], v[58:59], v[186:187], v[122:123]
v_pk_mul_f32 v[60:61], v[60:61], v[4:5] op_sel_hi:[1,0]
v_pk_add_f32 v[124:125], v[124:125], v[60:61]
v_pk_fma_f32 v[60:61], v[60:61], v[188:189], v[124:125]
v_pk_mul_f32 v[62:63], v[62:63], v[4:5] op_sel_hi:[1,0]
v_pk_add_f32 v[126:127], v[126:127], v[62:63]
v_pk_fma_f32 v[62:63], v[62:63], v[190:191], v[126:127]
v_cvt_pk_bf16_f32 v180, v56, v57
v_cvt_pk_bf16_f32 v181, v58, v59
v_cvt_pk_bf16_f32 v182, v60, v61
v_cvt_pk_bf16_f32 v183, v62, v63
s_add_u32 s41, s40, 8392704
buffer_store_dwordx4 v[180:183], v2, s[4:7], s41 offen sc1
v_pk_mul_f32 v[64:65], v[64:65], v[4:5] op_sel_hi:[1,0]
v_pk_add_f32 v[128:129], v[128:129], v[64:65]
v_pk_fma_f32 v[64:65], v[64:65], v[192:193], v[128:129]
v_pk_mul_f32 v[66:67], v[66:67], v[4:5] op_sel_hi:[1,0]
v_pk_add_f32 v[130:131], v[130:131], v[66:67]
v_pk_fma_f32 v[66:67], v[66:67], v[194:195], v[130:131]
v_pk_mul_f32 v[68:69], v[68:69], v[4:5] op_sel_hi:[1,0]
v_pk_add_f32 v[132:133], v[132:133], v[68:69]
v_pk_fma_f32 v[68:69], v[68:69], v[196:197], v[132:133]
v_pk_mul_f32 v[70:71], v[70:71], v[4:5] op_sel_hi:[1,0]
v_pk_add_f32 v[134:135], v[134:135], v[70:71]
v_pk_fma_f32 v[70:71], v[70:71], v[198:199], v[134:135]
v_cvt_pk_bf16_f32 v184, v64, v65
v_cvt_pk_bf16_f32 v185, v66, v67
v_cvt_pk_bf16_f32 v186, v68, v69
v_cvt_pk_bf16_f32 v187, v70, v71
s_add_u32 s41, s40, 8396800
buffer_store_dwordx4 v[184:187], v2, s[4:7], s41 offen sc1
v_pk_mul_f32 v[72:73], v[72:73], v[4:5] op_sel_hi:[1,0]
v_pk_add_f32 v[136:137], v[136:137], v[72:73]
v_pk_fma_f32 v[72:73], v[72:73], v[200:201], v[136:137]
v_pk_mul_f32 v[74:75], v[74:75], v[4:5] op_sel_hi:[1,0]
v_pk_add_f32 v[138:139], v[138:139], v[74:75]
v_pk_fma_f32 v[74:75], v[74:75], v[202:203], v[138:139]
v_pk_mul_f32 v[76:77], v[76:77], v[4:5] op_sel_hi:[1,0]
v_pk_add_f32 v[140:141], v[140:141], v[76:77]
v_pk_fma_f32 v[76:77], v[76:77], v[204:205], v[140:141]
v_pk_mul_f32 v[78:79], v[78:79], v[4:5] op_sel_hi:[1,0]
v_pk_add_f32 v[142:143], v[142:143], v[78:79]
v_pk_fma_f32 v[78:79], v[78:79], v[206:207], v[142:143]
v_cvt_pk_bf16_f32 v188, v72, v73
v_cvt_pk_bf16_f32 v189, v74, v75
v_cvt_pk_bf16_f32 v190, v76, v77
v_cvt_pk_bf16_f32 v191, v78, v79
s_add_u32 s41, s40, 8400896
buffer_store_dwordx4 v[188:191], v2, s[4:7], s41 offen sc1
v_pk_mul_f32 v[80:81], v[80:81], v[4:5] op_sel_hi:[1,0]
v_pk_add_f32 v[144:145], v[144:145], v[80:81]
v_pk_fma_f32 v[80:81], v[80:81], v[208:209], v[144:145]
v_pk_mul_f32 v[82:83], v[82:83], v[4:5] op_sel_hi:[1,0]
v_pk_add_f32 v[146:147], v[146:147], v[82:83]
v_pk_fma_f32 v[82:83], v[82:83], v[210:211], v[146:147]
v_pk_mul_f32 v[84:85], v[84:85], v[4:5] op_sel_hi:[1,0]
v_pk_add_f32 v[148:149], v[148:149], v[84:85]
v_pk_fma_f32 v[84:85], v[84:85], v[212:213], v[148:149]
v_pk_mul_f32 v[86:87], v[86:87], v[4:5] op_sel_hi:[1,0]
v_pk_add_f32 v[150:151], v[150:151], v[86:87]
v_pk_fma_f32 v[86:87], v[86:87], v[214:215], v[150:151]
v_cvt_pk_bf16_f32 v192, v80, v81
v_cvt_pk_bf16_f32 v193, v82, v83
v_cvt_pk_bf16_f32 v194, v84, v85
v_cvt_pk_bf16_f32 v195, v86, v87
s_add_u32 s41, s40, 8404992
buffer_store_dwordx4 v[192:195], v2, s[4:7], s41 offen sc1
v_pk_mul_f32 v[88:89], v[88:89], v[4:5] op_sel_hi:[1,0]
v_pk_add_f32 v[152:153], v[152:153], v[88:89]
v_pk_fma_f32 v[88:89], v[88:89], v[216:217], v[152:153]
v_pk_mul_f32 v[90:91], v[90:91], v[4:5] op_sel_hi:[1,0]
v_pk_add_f32 v[154:155], v[154:155], v[90:91]
v_pk_fma_f32 v[90:91], v[90:91], v[218:219], v[154:155]
v_pk_mul_f32 v[92:93], v[92:93], v[4:5] op_sel_hi:[1,0]
v_pk_add_f32 v[156:157], v[156:157], v[92:93]
v_pk_fma_f32 v[92:93], v[92:93], v[220:221], v[156:157]
v_pk_mul_f32 v[94:95], v[94:95], v[4:5] op_sel_hi:[1,0]
v_pk_add_f32 v[158:159], v[158:159], v[94:95]
v_pk_fma_f32 v[94:95], v[94:95], v[222:223], v[158:159]
v_cvt_pk_bf16_f32 v196, v88, v89
v_cvt_pk_bf16_f32 v197, v90, v91
v_cvt_pk_bf16_f32 v198, v92, v93
v_cvt_pk_bf16_f32 v199, v94, v95
s_add_u32 s41, s40, 8409088
buffer_store_dwordx4 v[196:199], v2, s[4:7], s41 offen sc1
v_pk_mul_f32 v[96:97], v[96:97], v[4:5] op_sel_hi:[1,0]
v_pk_add_f32 v[160:161], v[160:161], v[96:97]
v_pk_fma_f32 v[96:97], v[96:97], v[224:225], v[160:161]
v_pk_mul_f32 v[98:99], v[98:99], v[4:5] op_sel_hi:[1,0]
v_pk_add_f32 v[162:163], v[162:163], v[98:99]
v_pk_fma_f32 v[98:99], v[98:99], v[226:227], v[162:163]
v_pk_mul_f32 v[100:101], v[100:101], v[4:5] op_sel_hi:[1,0]
v_pk_add_f32 v[164:165], v[164:165], v[100:101]
v_pk_fma_f32 v[100:101], v[100:101], v[228:229], v[164:165]
v_pk_mul_f32 v[102:103], v[102:103], v[4:5] op_sel_hi:[1,0]
v_pk_add_f32 v[166:167], v[166:167], v[102:103]
v_pk_fma_f32 v[102:103], v[102:103], v[230:231], v[166:167]
v_cvt_pk_bf16_f32 v200, v96, v97
v_cvt_pk_bf16_f32 v201, v98, v99
v_cvt_pk_bf16_f32 v202, v100, v101
v_cvt_pk_bf16_f32 v203, v102, v103
s_add_u32 s41, s40, 8413184
buffer_store_dwordx4 v[200:203], v2, s[4:7], s41 offen sc1
v_pk_mul_f32 v[104:105], v[104:105], v[4:5] op_sel_hi:[1,0]
v_pk_add_f32 v[168:169], v[168:169], v[104:105]
v_pk_fma_f32 v[104:105], v[104:105], v[232:233], v[168:169]
v_pk_mul_f32 v[106:107], v[106:107], v[4:5] op_sel_hi:[1,0]
v_pk_add_f32 v[170:171], v[170:171], v[106:107]
v_pk_fma_f32 v[106:107], v[106:107], v[234:235], v[170:171]
v_pk_mul_f32 v[108:109], v[108:109], v[4:5] op_sel_hi:[1,0]
v_pk_add_f32 v[172:173], v[172:173], v[108:109]
v_pk_fma_f32 v[108:109], v[108:109], v[236:237], v[172:173]
v_pk_mul_f32 v[110:111], v[110:111], v[4:5] op_sel_hi:[1,0]
v_pk_add_f32 v[174:175], v[174:175], v[110:111]
v_pk_fma_f32 v[110:111], v[110:111], v[238:239], v[174:175]
v_cvt_pk_bf16_f32 v204, v104, v105
v_cvt_pk_bf16_f32 v205, v106, v107
v_cvt_pk_bf16_f32 v206, v108, v109
v_cvt_pk_bf16_f32 v207, v110, v111
s_add_u32 s41, s40, 8417280
buffer_store_dwordx4 v[204:207], v2, s[4:7], s41 offen sc1
Lend_3:
s_endpgm
.globl qkv_kernel
.p2align 8
.type qkv_kernel,@function
qkv_kernel:
s_cmp_ge_u32 s2, 384
s_cbranch_scc1 Lend_4
s_load_dwordx2 s[18:19], s[0:1], 16
s_load_dwordx2 s[20:21], s[0:1], 24
s_load_dwordx2 s[22:23], s[0:1], 32
s_load_dwordx2 s[30:31], s[0:1], 120
v_lshrrev_b32 v1, 6, v0
s_nop 0
v_readfirstlane_b32 s32, v1
v_and_b32 v1, 63, v0
s_waitcnt lgkmcnt(0)
s_mov_b32 s4, s30
s_and_b32 s5, s31, 0xffff
s_mov_b32 s6, 0x10000000
s_mov_b32 s7, 0x20000
s_lshr_b32 s40, s2, 3
s_mul_i32 s41, s40, 43
s_lshr_b32 s41, s41, 8
s_mul_i32 s42, s41, 6
s_sub_u32 s42, s40, s42
s_and_b32 s43, s2, 7
s_mul_i32 s43, s43, 6
s_add_u32 s42, s42, s43
s_lshr_b32 s43, s42, 4
s_and_b32 s47, s42, 15
s_cmp_eq_u32 s43, 1
s_cselect_b64 s[44:45], s[20:21], s[18:19]
s_cmp_eq_u32 s43, 2
s_cselect_b64 s[44:45], s[22:23], s[44:45]
s_mov_b32 s8, s44
s_and_b32 s9, s45, 0xffff
s_mov_b32 s10, 0x800000
s_mov_b32 s11, 0x20000
v_lshlrev_b32 v2, 4, v1
v_lshrrev_b32 v20, 4, v1
v_and_b32 v21, 15, v1
s_mov_b32 s66, 8192
v_lshlrev_b32 v22, 2, v20
v_or_b32 v22, 0, v22
v_xor_b32 v22, v22, v21
v_lshlrev_b32 v22, 4, v22
v_mad_u32_u24 v22, v20, s66, v22
v_add_u32 v4, 0, v22
v_lshlrev_b32 v22, 2, v20
v_or_b32 v22, 2, v22
v_xor_b32 v22, v22, v21
v_lshlrev_b32 v22, 4, v22
v_mad_u32_u24 v22, v20, s66, v22
v_add_u32 v5, 31744, v22
v_lshlrev_b32 v22, 2, v20
v_or_b32 v22, 0, v22
v_xor_b32 v22, v22, v21
v_lshlrev_b32 v22, 4, v22
v_mad_u32_u24 v22, v20, s66, v22
v_add_u32 v6, 63488, v22
v_lshlrev_b32 v22, 2, v20
v_or_b32 v22, 2, v22
v_xor_b32 v22, v22, v21
v_lshlrev_b32 v22, 4, v22
v_mad_u32_u24 v22, v20, s66, v22
v_add_u32 v7, 95232, v22
s_mul_i32 s63, s32, 4096
s_add_u32 s63, s63, 65536
s_mul_i32 s64, s32, 4096
s_mov_b32 s65, 262144
s_lshr_b32 s66, s32, 1
s_mul_i32 s66, s66, 8192
s_add_u32 s66, s66, 65536
v_add_u32 v8, s66, v2
v_bfe_u32 v20, v1, 2, 2
v_lshrrev_b32 v21, 4, v1
v_lshl_add_u32 v22, v21, 2, v20
v_lshlrev_b32 v22, 8, v22
v_and_b32 v23, 3, v1
v_lshl_add_u32 v22, v23, 3, v22
v_and_b32 v21, 1, v21
v_lshl_add_u32 v20, v20, 1, v21
s_and_b32 s66, s32, 1
s_mul_i32 s66, s66, 8192
v_add_u32 v22, s66, v22
v_xor_b32 v21, 0, v20
v_lshl_add_u32 v10, v21, 5, v22
v_xor_b32 v21, 1, v20
v_lshl_add_u32 v11, v21, 5, v22
v_xor_b32 v21, 2, v20
v_lshl_add_u32 v12, v21, 5, v22
v_xor_b32 v21, 3, v20
v_lshl_add_u32 v13, v21, 5, v22
v_xor_b32 v21, 4, v20
v_lshl_add_u32 v14, v21, 5, v22
v_xor_b32 v21, 5, v20
v_lshl_add_u32 v15, v21, 5, v22
v_xor_b32 v21, 6, v20
v_lshl_add_u32 v16, v21, 5, v22
v_xor_b32 v21, 7, v20
v_lshl_add_u32 v17, v21, 5, v22
s_mul_i32 s60, s41, 524288
s_add_u32 s60, s60, 8388608
s_lshr_b32 s46, s32, 1
s_lshl_b32 s47, s47, 1
s_add_u32 s48, s47, s46
s_lshl_b32 s61, s48, 8
s_lshr_b32 s66, s32, 0
s_mul_i32 s66, s66, 131072
s_add_u32 s60, s60, s66
s_and_b32 s66, s32, 1
s_mul_i32 s66, s66, 131072
s_add_u32 s61, s61, s66
s_lshl_b32 s48, s41, 1
s_add_u32 s48, s48, s46
s_mul_i32 s48, s48, 128
s_and_b32 s46, s32, 1
s_add_u32 s48, s48, s46
s_add_u32 s48, s48, s47
s_mul_i32 s48, s48, 24576
s_lshl_b32 s46, s43, 13
s_add_u32 s48, s48, s46
s_add_u32 s48, s48, 33554432
s_add_u32 m0, s63, 0
s_nop 0
buffer_load_dwordx4 v2, s[4:7], s60 offen offset:0 sc1 lds
buffer_load_dwordx4 v2, s[4:7], s60 offen offset:1024 sc1 lds
buffer_load_dwordx4 v2, s[4:7], s60 offen offset:2048 sc1 lds
buffer_load_dwordx4 v2, s[4:7], s60 offen offset:3072 sc1 lds
s_add_u32 s60, s60, 4096
s_add_u32 m0, s64, 0
s_nop 0
buffer_load_dwordx4 v4, s[8:11], s61 offen offset:0 lds
buffer_load_dwordx4 v5, s[8:11], s61 offen offset:1024 lds
buffer_load_dwordx4 v6, s[8:11], s61 offen offset:2048 lds
buffer_load_dwordx4 v7, s[8:11], s61 offen offset:3072 lds
s_add_u32 s61, s61, s65
s_add_u32 m0, s63, 16384
s_nop 0
buffer_load_dwordx4 v2, s[4:7], s60 offen offset:0 sc1 lds
buffer_load_dwordx4 v2, s[4:7], s60 offen offset:1024 sc1 lds
buffer_load_dwordx4 v2, s[4:7], s60 offen offset:2048 sc1 lds
buffer_load_dwordx4 v2, s[4:7], s60 offen offset:3072 sc1 lds
s_add_u32 s60, s60, 4096
s_add_u32 m0, s64, 16384
s_nop 0
buffer_load_dwordx4 v4, s[8:11], s61 offen offset:0 lds
buffer_load_dwordx4 v5, s[8:11], s61 offen offset:1024 lds
buffer_load_dwordx4 v6, s[8:11], s61 offen offset:2048 lds
buffer_load_dwordx4 v7, s[8:11], s61 offen offset:3072 lds
s_add_u32 s61, s61, s65
s_add_u32 m0, s63, 32768
s_nop 0
buffer_load_dwordx4 v2, s[4:7], s60 offen offset:0 sc1 lds
buffer_load_dwordx4 v2, s[4:7], s60 offen offset:1024 sc1 lds
buffer_load_dwordx4 v2, s[4:7], s60 offen offset:2048 sc1 lds
buffer_load_dwordx4 v2, s[4:7], s60 offen offset:3072 sc1 lds
s_add_u32 s60, s60, 4096
s_add_u32 m0, s64, 32768
s_nop 0
buffer_load_dwordx4 v4, s[8:11], s61 offen offset:0 lds
buffer_load_dwordx4 v5, s[8:11], s61 offen offset:1024 lds
buffer_load_dwordx4 v6, s[8:11], s61 offen offset:2048 lds
buffer_load_dwordx4 v7, s[8:11], s61 offen offset:3072 lds
s_add_u32 s61, s61, s65
s_add_u32 m0, s63, 49152
s_nop 0
buffer_load_dwordx4 v2, s[4:7], s60 offen offset:0 sc1 lds
buffer_load_dwordx4 v2, s[4:7], s60 offen offset:1024 sc1 lds
buffer_load_dwordx4 v2, s[4:7], s60 offen offset:2048 sc1 lds
buffer_load_dwordx4 v2, s[4:7], s60 offen offset:3072 sc1 lds
s_add_u32 s60, s60, 4096
s_add_u32 m0, s64, 49152
s_nop 0
buffer_load_dwordx4 v4, s[8:11], s61 offen offset:0 lds
buffer_load_dwordx4 v5, s[8:11], s61 offen offset:1024 lds
buffer_load_dwordx4 v6, s[8:11], s61 offen offset:2048 lds
buffer_load_dwordx4 v7, s[8:11], s61 offen offset:3072 lds
s_add_u32 s61, s61, s65
s_cmp_eq_u32 s43, 2
s_cbranch_scc1 Lisv_5
s_waitcnt vmcnt(24)
s_barrier
ds_read_b128 a[0:3], v8 offset:0
ds_read_b64_tr_b16 a[32:33], v10 offset:0
ds_read_b64_tr_b16 a[34:35], v10 offset:4096
ds_read_b128 a[4:7], v8 offset:1024
ds_read_b64_tr_b16 a[36:37], v11 offset:0
ds_read_b64_tr_b16 a[38:39], v11 offset:4096
ds_read_b128 a[8:11], v8 offset:2048
ds_read_b64_tr_b16 a[40:41], v12 offset:0
ds_read_b64_tr_b16 a[42:43], v12 offset:4096
ds_read_b128 a[12:15], v8 offset:3072
ds_read_b64_tr_b16 a[44:45], v13 offset:0
ds_read_b64_tr_b16 a[46:47], v13 offset:4096
ds_read_b128 a[16:19], v8 offset:4096
ds_read_b64_tr_b16 a[48:49], v14 offset:0
ds_read_b64_tr_b16 a[50:51], v14 offset:4096
ds_read_b128 a[20:23], v8 offset:5120
ds_read_b64_tr_b16 a[52:53], v15 offset:0
ds_read_b64_tr_b16 a[54:55], v15 offset:4096
ds_read_b128 a[24:27], v8 offset:6144
ds_read_b64_tr_b16 a[56:57], v16 offset:0
ds_read_b64_tr_b16 a[58:59], v16 offset:4096
ds_read_b128 a[28:31], v8 offset:7168
ds_read_b64_tr_b16 a[60:61], v17 offset:0
ds_read_b64_tr_b16 a[62:63], v17 offset:4096
s_waitcnt vmcnt(16) lgkmcnt(0)
s_barrier
v_mfma_f32_16x16x32_bf16 v[64:67], a[32:35], a[0:3], 0
ds_read_b128 a[64:67], v8 offset:16384
v_mfma_f32_16x16x32_bf16 v[96:99], a[32:35], a[4:7], 0
v_mfma_f32_16x16x32_bf16 v[128:131], a[32:35], a[8:11], 0
ds_read_b64_tr_b16 a[96:97], v10 offset:16384
v_mfma_f32_16x16x32_bf16 v[160:163], a[32:35], a[12:15], 0
v_mfma_f32_16x16x32_bf16 v[192:195], a[32:35], a[16:19], 0
ds_read_b64_tr_b16 a[98:99], v10 offset:20480
s_add_u32 m0, s63, 0
s_nop 0
buffer_load_dwordx4 v2, s[4:7], s60 offen offset:0 sc1 lds
v_mfma_f32_16x16x32_bf16 v[224:227], a[32:35], a[20:23], 0
v_mfma_f32_16x16x32_bf16 a[128:131], a[32:35], a[24:27], 0
ds_read_b128 a[68:71], v8 offset:17408
v_mfma_f32_16x16x32_bf16 a[160:163], a[32:35], a[28:31], 0
v_mfma_f32_16x16x32_bf16 a[164:167], a[36:39], a[28:31], 0
ds_read_b64_tr_b16 a[100:101], v11 offset:16384
v_mfma_f32_16x16x32_bf16 a[132:135], a[36:39], a[24:27], 0
v_mfma_f32_16x16x32_bf16 v[228:231], a[36:39], a[20:23], 0
ds_read_b64_tr_b16 a[102:103], v11 offset:20480
v_mfma_f32_16x16x32_bf16 v[196:199], a[36:39], a[16:19], 0
v_mfma_f32_16x16x32_bf16 v[164:167], a[36:39], a[12:15], 0
ds_read_b128 a[72:75], v8 offset:18432
buffer_load_dwordx4 v2, s[4:7], s60 offen offset:1024 sc1 lds
v_mfma_f32_16x16x32_bf16 v[132:135], a[36:39], a[8:11], 0
v_mfma_f32_16x16x32_bf16 v[100:103], a[36:39], a[4:7], 0
ds_read_b64_tr_b16 a[104:105], v12 offset:16384
v_mfma_f32_16x16x32_bf16 v[68:71], a[36:39], a[0:3], 0
v_mfma_f32_16x16x32_bf16 v[72:75], a[40:43], a[0:3], 0
ds_read_b64_tr_b16 a[106:107], v12 offset:20480
v_mfma_f32_16x16x32_bf16 v[104:107], a[40:43], a[4:7], 0
v_mfma_f32_16x16x32_bf16 v[136:139], a[40:43], a[8:11], 0
ds_read_b128 a[76:79], v8 offset:19456
v_mfma_f32_16x16x32_bf16 v[168:171], a[40:43], a[12:15], 0
v_mfma_f32_16x16x32_bf16 v[200:203], a[40:43], a[16:19], 0
ds_read_b64_tr_b16 a[108:109], v13 offset:16384
buffer_load_dwordx4 v2, s[4:7], s60 offen offset:2048 sc1 lds
v_mfma_f32_16x16x32_bf16 v[232:235], a[40:43], a[20:23], 0
v_mfma_f32_16x16x32_bf16 a[136:139], a[40:43], a[24:27], 0
ds_read_b64_tr_b16 a[110:111], v13 offset:20480
v_mfma_f32_16x16x32_bf16 a[168:171], a[40:43], a[28:31], 0
v_mfma_f32_16x16x32_bf16 a[172:175], a[44:47], a[28:31], 0
ds_read_b128 a[80:83], v8 offset:20480
v_mfma_f32_16x16x32_bf16 a[140:143], a[44:47], a[24:27], 0
v_mfma_f32_16x16x32_bf16 v[236:239], a[44:47], a[20:23], 0
ds_read_b64_tr_b16 a[112:113], v14 offset:16384
v_mfma_f32_16x16x32_bf16 v[204:207], a[44:47], a[16:19], 0
v_mfma_f32_16x16x32_bf16 v[172:175], a[44:47], a[12:15], 0
ds_read_b64_tr_b16 a[114:115], v14 offset:20480
buffer_load_dwordx4 v2, s[4:7], s60 offen offset:3072 sc1 lds
s_add_u32 s60, s60, 4096
v_mfma_f32_16x16x32_bf16 v[140:143], a[44:47], a[8:11], 0
v_mfma_f32_16x16x32_bf16 v[108:111], a[44:47], a[4:7], 0
ds_read_b128 a[84:87], v8 offset:21504
v_mfma_f32_16x16x32_bf16 v[76:79], a[44:47], a[0:3], 0
v_mfma_f32_16x16x32_bf16 v[80:83], a[48:51], a[0:3], 0
ds_read_b64_tr_b16 a[116:117], v15 offset:16384
v_mfma_f32_16x16x32_bf16 v[112:115], a[48:51], a[4:7], 0
v_mfma_f32_16x16x32_bf16 v[144:147], a[48:51], a[8:11], 0
ds_read_b64_tr_b16 a[118:119], v15 offset:20480
v_mfma_f32_16x16x32_bf16 v[176:179], a[48:51], a[12:15], 0
v_mfma_f32_16x16x32_bf16 v[208:211], a[48:51], a[16:19], 0
ds_read_b128 a[88:91], v8 offset:22528
s_add_u32 m0, s64, 0
s_nop 0
buffer_load_dwordx4 v4, s[8:11], s61 offen offset:0 lds
v_mfma_f32_16x16x32_bf16 v[240:243], a[48:51], a[20:23], 0
v_mfma_f32_16x16x32_bf16 a[144:147], a[48:51], a[24:27], 0
ds_read_b64_tr_b16 a[120:121], v16 offset:16384
v_mfma_f32_16x16x32_bf16 a[176:179], a[48:51], a[28:31], 0
v_mfma_f32_16x16x32_bf16 a[180:183], a[52:55], a[28:31], 0
ds_read_b64_tr_b16 a[122:123], v16 offset:20480
v_mfma_f32_16x16x32_bf16 a[148:151], a[52:55], a[24:27], 0
v_mfma_f32_16x16x32_bf16 v[244:247], a[52:55], a[20:23], 0
ds_read_b128 a[92:95], v8 offset:23552
v_mfma_f32_16x16x32_bf16 v[212:215], a[52:55], a[16:19], 0
v_mfma_f32_16x16x32_bf16 v[180:183], a[52:55], a[12:15], 0
ds_read_b64_tr_b16 a[124:125], v17 offset:16384
buffer_load_dwordx4 v5, s[8:11], s61 offen offset:1024 lds
v_mfma_f32_16x16x32_bf16 v[148:151], a[52:55], a[8:11], 0
v_mfma_f32_16x16x32_bf16 v[116:119], a[52:55], a[4:7], 0
ds_read_b64_tr_b16 a[126:127], v17 offset:20480
v_mfma_f32_16x16x32_bf16 v[84:87], a[52:55], a[0:3], 0
v_mfma_f32_16x16x32_bf16 v[88:91], a[56:59], a[0:3], 0
v_mfma_f32_16x16x32_bf16 v[120:123], a[56:59], a[4:7], 0
v_mfma_f32_16x16x32_bf16 v[152:155], a[56:59], a[8:11], 0
v_mfma_f32_16x16x32_bf16 v[184:187], a[56:59], a[12:15], 0
v_mfma_f32_16x16x32_bf16 v[216:219], a[56:59], a[16:19], 0
buffer_load_dwordx4 v6, s[8:11], s61 offen offset:2048 lds
v_mfma_f32_16x16x32_bf16 v[248:251], a[56:59], a[20:23], 0
v_mfma_f32_16x16x32_bf16 a[152:155], a[56:59], a[24:27], 0
v_mfma_f32_16x16x32_bf16 a[184:187], a[56:59], a[28:31], 0
v_mfma_f32_16x16x32_bf16 a[188:191], a[60:63], a[28:31], 0
v_mfma_f32_16x16x32_bf16 a[156:159], a[60:63], a[24:27], 0
v_mfma_f32_16x16x32_bf16 v[252:255], a[60:63], a[20:23], 0
v_mfma_f32_16x16x32_bf16 v[220:223], a[60:63], a[16:19], 0
v_mfma_f32_16x16x32_bf16 v[188:191], a[60:63], a[12:15], 0
buffer_load_dwordx4 v7, s[8:11], s61 offen offset:3072 lds
s_add_u32 s61, s61, s65
v_mfma_f32_16x16x32_bf16 v[156:159], a[60:63], a[8:11], 0
v_mfma_f32_16x16x32_bf16 v[124:127], a[60:63], a[4:7], 0
v_mfma_f32_16x16x32_bf16 v[92:95], a[60:63], a[0:3], 0
s_waitcnt vmcnt(16) lgkmcnt(0)
s_barrier
v_mfma_f32_16x16x32_bf16 v[64:67], a[96:99], a[64:67], v[64:67]
ds_read_b128 a[0:3], v8 offset:32768
v_mfma_f32_16x16x32_bf16 v[96:99], a[96:99], a[68:71], v[96:99]
v_mfma_f32_16x16x32_bf16 v[128:131], a[96:99], a[72:75], v[128:131]
ds_read_b64_tr_b16 a[32:33], v10 offset:32768
v_mfma_f32_16x16x32_bf16 v[160:163], a[96:99], a[76:79], v[160:163]
v_mfma_f32_16x16x32_bf16 v[192:195], a[96:99], a[80:83], v[192:195]
ds_read_b64_tr_b16 a[34:35], v10 offset:36864
s_add_u32 m0, s63, 16384
s_nop 0
buffer_load_dwordx4 v2, s[4:7], s60 offen offset:0 sc1 lds
v_mfma_f32_16x16x32_bf16 v[224:227], a[96:99], a[84:87], v[224:227]
v_mfma_f32_16x16x32_bf16 a[128:131], a[96:99], a[88:91], a[128:131]
ds_read_b128 a[4:7], v8 offset:33792
v_mfma_f32_16x16x32_bf16 a[160:163], a[96:99], a[92:95], a[160:163]
v_mfma_f32_16x16x32_bf16 a[164:167], a[100:103], a[92:95], a[164:167]
ds_read_b64_tr_b16 a[36:37], v11 offset:32768
v_mfma_f32_16x16x32_bf16 a[132:135], a[100:103], a[88:91], a[132:135]
v_mfma_f32_16x16x32_bf16 v[228:231], a[100:103], a[84:87], v[228:231]
ds_read_b64_tr_b16 a[38:39], v11 offset:36864
v_mfma_f32_16x16x32_bf16 v[196:199], a[100:103], a[80:83], v[196:199]
v_mfma_f32_16x16x32_bf16 v[164:167], a[100:103], a[76:79], v[164:167]
ds_read_b128 a[8:11], v8 offset:34816
buffer_load_dwordx4 v2, s[4:7], s60 offen offset:1024 sc1 lds
v_mfma_f32_16x16x32_bf16 v[132:135], a[100:103], a[72:75], v[132:135]
v_mfma_f32_16x16x32_bf16 v[100:103], a[100:103], a[68:71], v[100:103]
ds_read_b64_tr_b16 a[40:41], v12 offset:32768
v_mfma_f32_16x16x32_bf16 v[68:71], a[100:103], a[64:67], v[68:71]
v_mfma_f32_16x16x32_bf16 v[72:75], a[104:107], a[64:67], v[72:75]
ds_read_b64_tr_b16 a[42:43], v12 offset:36864
v_mfma_f32_16x16x32_bf16 v[104:107], a[104:107], a[68:71], v[104:107]
v_mfma_f32_16x16x32_bf16 v[136:139], a[104:107], a[72:75], v[136:139]
ds_read_b128 a[12:15], v8 offset:35840
v_mfma_f32_16x16x32_bf16 v[168:171], a[104:107], a[76:79], v[168:171]
v_mfma_f32_16x16x32_bf16 v[200:203], a[104:107], a[80:83], v[200:203]
ds_read_b64_tr_b16 a[44:45], v13 offset:32768
buffer_load_dwordx4 v2, s[4:7], s60 offen offset:2048 sc1 lds
v_mfma_f32_16x16x32_bf16 v[232:235], a[104:107], a[84:87], v[232:235]
v_mfma_f32_16x16x32_bf16 a[136:139], a[104:107], a[88:91], a[136:139]
ds_read_b64_tr_b16 a[46:47], v13 offset:36864
v_mfma_f32_16x16x32_bf16 a[168:171], a[104:107], a[92:95], a[168:171]
v_mfma_f32_16x16x32_bf16 a[172:175], a[108:111], a[92:95], a[172:175]
ds_read_b128 a[16:19], v8 offset:36864
v_mfma_f32_16x16x32_bf16 a[140:143], a[108:111], a[88:91], a[140:143]
v_mfma_f32_16x16x32_bf16 v[236:239], a[108:111], a[84:87], v[236:239]
ds_read_b64_tr_b16 a[48:49], v14 offset:32768
v_mfma_f32_16x16x32_bf16 v[204:207], a[108:111], a[80:83], v[204:207]
v_mfma_f32_16x16x32_bf16 v[172:175], a[108:111], a[76:79], v[172:175]
ds_read_b64_tr_b16 a[50:51], v14 offset:36864
buffer_load_dwordx4 v2, s[4:7], s60 offen offset:3072 sc1 lds
s_add_u32 s60, s60, 4096
v_mfma_f32_16x16x32_bf16 v[140:143], a[108:111], a[72:75], v[140:143]
v_mfma_f32_16x16x32_bf16 v[108:111], a[108:111], a[68:71], v[108:111]
ds_read_b128 a[20:23], v8 offset:37888
v_mfma_f32_16x16x32_bf16 v[76:79], a[108:111], a[64:67], v[76:79]
v_mfma_f32_16x16x32_bf16 v[80:83], a[112:115], a[64:67], v[80:83]
ds_read_b64_tr_b16 a[52:53], v15 offset:32768
v_mfma_f32_16x16x32_bf16 v[112:115], a[112:115], a[68:71], v[112:115]
v_mfma_f32_16x16x32_bf16 v[144:147], a[112:115], a[72:75], v[144:147]
ds_read_b64_tr_b16 a[54:55], v15 offset:36864
v_mfma_f32_16x16x32_bf16 v[176:179], a[112:115], a[76:79], v[176:179]
v_mfma_f32_16x16x32_bf16 v[208:211], a[112:115], a[80:83], v[208:211]
ds_read_b128 a[24:27], v8 offset:38912
s_add_u32 m0, s64, 16384
s_nop 0
buffer_load_dwordx4 v4, s[8:11], s61 offen offset:0 lds
v_mfma_f32_16x16x32_bf16 v[240:243], a[112:115], a[84:87], v[240:243]
v_mfma_f32_16x16x32_bf16 a[144:147], a[112:115], a[88:91], a[144:147]
ds_read_b64_tr_b16 a[56:57], v16 offset:32768
v_mfma_f32_16x16x32_bf16 a[176:179], a[112:115], a[92:95], a[176:179]
v_mfma_f32_16x16x32_bf16 a[180:183], a[116:119], a[92:95], a[180:183]
ds_read_b64_tr_b16 a[58:59], v16 offset:36864
v_mfma_f32_16x16x32_bf16 a[148:151], a[116:119], a[88:91], a[148:151]
v_mfma_f32_16x16x32_bf16 v[244:247], a[116:119], a[84:87], v[244:247]
ds_read_b128 a[28:31], v8 offset:39936
v_mfma_f32_16x16x32_bf16 v[212:215], a[116:119], a[80:83], v[212:215]
v_mfma_f32_16x16x32_bf16 v[180:183], a[116:119], a[76:79], v[180:183]
ds_read_b64_tr_b16 a[60:61], v17 offset:32768
buffer_load_dwordx4 v5, s[8:11], s61 offen offset:1024 lds
v_mfma_f32_16x16x32_bf16 v[148:151], a[116:119], a[72:75], v[148:151]
v_mfma_f32_16x16x32_bf16 v[116:119], a[116:119], a[68:71], v[116:119]
ds_read_b64_tr_b16 a[62:63], v17 offset:36864
v_mfma_f32_16x16x32_bf16 v[84:87], a[116:119], a[64:67], v[84:87]
v_mfma_f32_16x16x32_bf16 v[88:91], a[120:123], a[64:67], v[88:91]
v_mfma_f32_16x16x32_bf16 v[120:123], a[120:123], a[68:71], v[120:123]
v_mfma_f32_16x16x32_bf16 v[152:155], a[120:123], a[72:75], v[152:155]
v_mfma_f32_16x16x32_bf16 v[184:187], a[120:123], a[76:79], v[184:187]
v_mfma_f32_16x16x32_bf16 v[216:219], a[120:123], a[80:83], v[216:219]
buffer_load_dwordx4 v6, s[8:11], s61 offen offset:2048 lds
v_mfma_f32_16x16x32_bf16 v[248:251], a[120:123], a[84:87], v[248:251]
v_mfma_f32_16x16x32_bf16 a[152:155], a[120:123], a[88:91], a[152:155]
v_mfma_f32_16x16x32_bf16 a[184:187], a[120:123], a[92:95], a[184:187]
v_mfma_f32_16x16x32_bf16 a[188:191], a[124:127], a[92:95], a[188:191]
v_mfma_f32_16x16x32_bf16 a[156:159], a[124:127], a[88:91], a[156:159]
v_mfma_f32_16x16x32_bf16 v[252:255], a[124:127], a[84:87], v[252:255]
v_mfma_f32_16x16x32_bf16 v[220:223], a[124:127], a[80:83], v[220:223]
v_mfma_f32_16x16x32_bf16 v[188:191], a[124:127], a[76:79], v[188:191]
buffer_load_dwordx4 v7, s[8:11], s61 offen offset:3072 lds
s_add_u32 s61, s61, s65
v_mfma_f32_16x16x32_bf16 v[156:159], a[124:127], a[72:75], v[156:159]
v_mfma_f32_16x16x32_bf16 v[124:127], a[124:127], a[68:71], v[124:127]
v_mfma_f32_16x16x32_bf16 v[92:95], a[124:127], a[64:67], v[92:95]
s_waitcnt vmcnt(16) lgkmcnt(0)
s_barrier
v_mfma_f32_16x16x32_bf16 v[64:67], a[32:35], a[0:3], v[64:67]
ds_read_b128 a[64:67], v8 offset:49152
v_mfma_f32_16x16x32_bf16 v[96:99], a[32:35], a[4:7], v[96:99]
v_mfma_f32_16x16x32_bf16 v[128:131], a[32:35], a[8:11], v[128:131]
ds_read_b64_tr_b16 a[96:97], v10 offset:49152
v_mfma_f32_16x16x32_bf16 v[160:163], a[32:35], a[12:15], v[160:163]
v_mfma_f32_16x16x32_bf16 v[192:195], a[32:35], a[16:19], v[192:195]
ds_read_b64_tr_b16 a[98:99], v10 offset:53248
s_add_u32 m0, s63, 32768
s_nop 0
buffer_load_dwordx4 v2, s[4:7], s60 offen offset:0 sc1 lds
v_mfma_f32_16x16x32_bf16 v[224:227], a[32:35], a[20:23], v[224:227]
v_mfma_f32_16x16x32_bf16 a[128:131], a[32:35], a[24:27], a[128:131]
ds_read_b128 a[68:71], v8 offset:50176
v_mfma_f32_16x16x32_bf16 a[160:163], a[32:35], a[28:31], a[160:163]
v_mfma_f32_16x16x32_bf16 a[164:167], a[36:39], a[28:31], a[164:167]
ds_read_b64_tr_b16 a[100:101], v11 offset:49152
v_mfma_f32_16x16x32_bf16 a[132:135], a[36:39], a[24:27], a[132:135]
v_mfma_f32_16x16x32_bf16 v[228:231], a[36:39], a[20:23], v[228:231]
ds_read_b64_tr_b16 a[102:103], v11 offset:53248
v_mfma_f32_16x16x32_bf16 v[196:199], a[36:39], a[16:19], v[196:199]
v_mfma_f32_16x16x32_bf16 v[164:167], a[36:39], a[12:15], v[164:167]
ds_read_b128 a[72:75], v8 offset:51200
buffer_load_dwordx4 v2, s[4:7], s60 offen offset:1024 sc1 lds
v_mfma_f32_16x16x32_bf16 v[132:135], a[36:39], a[8:11], v[132:135]
v_mfma_f32_16x16x32_bf16 v[100:103], a[36:39], a[4:7], v[100:103]
ds_read_b64_tr_b16 a[104:105], v12 offset:49152
v_mfma_f32_16x16x32_bf16 v[68:71], a[36:39], a[0:3], v[68:71]
v_mfma_f32_16x16x32_bf16 v[72:75], a[40:43], a[0:3], v[72:75]
ds_read_b64_tr_b16 a[106:107], v12 offset:53248
v_mfma_f32_16x16x32_bf16 v[104:107], a[40:43], a[4:7], v[104:107]
v_mfma_f32_16x16x32_bf16 v[136:139], a[40:43], a[8:11], v[136:139]
ds_read_b128 a[76:79], v8 offset:52224
v_mfma_f32_16x16x32_bf16 v[168:171], a[40:43], a[12:15], v[168:171]
v_mfma_f32_16x16x32_bf16 v[200:203], a[40:43], a[16:19], v[200:203]
ds_read_b64_tr_b16 a[108:109], v13 offset:49152
buffer_load_dwordx4 v2, s[4:7], s60 offen offset:2048 sc1 lds
v_mfma_f32_16x16x32_bf16 v[232:235], a[40:43], a[20:23], v[232:235]
v_mfma_f32_16x16x32_bf16 a[136:139], a[40:43], a[24:27], a[136:139]
ds_read_b64_tr_b16 a[110:111], v13 offset:53248
v_mfma_f32_16x16x32_bf16 a[168:171], a[40:43], a[28:31], a[168:171]
v_mfma_f32_16x16x32_bf16 a[172:175], a[44:47], a[28:31], a[172:175]
ds_read_b128 a[80:83], v8 offset:53248
v_mfma_f32_16x16x32_bf16 a[140:143], a[44:47], a[24:27], a[140:143]
v_mfma_f32_16x16x32_bf16 v[236:239], a[44:47], a[20:23], v[236:239]
ds_read_b64_tr_b16 a[112:113], v14 offset:49152
v_mfma_f32_16x16x32_bf16 v[204:207], a[44:47], a[16:19], v[204:207]
v_mfma_f32_16x16x32_bf16 v[172:175], a[44:47], a[12:15], v[172:175]
ds_read_b64_tr_b16 a[114:115], v14 offset:53248
buffer_load_dwordx4 v2, s[4:7], s60 offen offset:3072 sc1 lds
s_add_u32 s60, s60, 4096
v_mfma_f32_16x16x32_bf16 v[140:143], a[44:47], a[8:11], v[140:143]
v_mfma_f32_16x16x32_bf16 v[108:111], a[44:47], a[4:7], v[108:111]
ds_read_b128 a[84:87], v8 offset:54272
v_mfma_f32_16x16x32_bf16 v[76:79], a[44:47], a[0:3], v[76:79]
v_mfma_f32_16x16x32_bf16 v[80:83], a[48:51], a[0:3], v[80:83]
ds_read_b64_tr_b16 a[116:117], v15 offset:49152
v_mfma_f32_16x16x32_bf16 v[112:115], a[48:51], a[4:7], v[112:115]
v_mfma_f32_16x16x32_bf16 v[144:147], a[48:51], a[8:11], v[144:147]
ds_read_b64_tr_b16 a[118:119], v15 offset:53248
v_mfma_f32_16x16x32_bf16 v[176:179], a[48:51], a[12:15], v[176:179]
v_mfma_f32_16x16x32_bf16 v[208:211], a[48:51], a[16:19], v[208:211]
ds_read_b128 a[88:91], v8 offset:55296
s_add_u32 m0, s64, 32768
s_nop 0
buffer_load_dwordx4 v4, s[8:11], s61 offen offset:0 lds
v_mfma_f32_16x16x32_bf16 v[240:243], a[48:51], a[20:23], v[240:243]
v_mfma_f32_16x16x32_bf16 a[144:147], a[48:51], a[24:27], a[144:147]
ds_read_b64_tr_b16 a[120:121], v16 offset:49152
v_mfma_f32_16x16x32_bf16 a[176:179], a[48:51], a[28:31], a[176:179]
v_mfma_f32_16x16x32_bf16 a[180:183], a[52:55], a[28:31], a[180:183]
ds_read_b64_tr_b16 a[122:123], v16 offset:53248
v_mfma_f32_16x16x32_bf16 a[148:151], a[52:55], a[24:27], a[148:151]
v_mfma_f32_16x16x32_bf16 v[244:247], a[52:55], a[20:23], v[244:247]
ds_read_b128 a[92:95], v8 offset:56320
v_mfma_f32_16x16x32_bf16 v[212:215], a[52:55], a[16:19], v[212:215]
v_mfma_f32_16x16x32_bf16 v[180:183], a[52:55], a[12:15], v[180:183]
ds_read_b64_tr_b16 a[124:125], v17 offset:49152
buffer_load_dwordx4 v5, s[8:11], s61 offen offset:1024 lds
v_mfma_f32_16x16x32_bf16 v[148:151], a[52:55], a[8:11], v[148:151]
v_mfma_f32_16x16x32_bf16 v[116:119], a[52:55], a[4:7], v[116:119]
ds_read_b64_tr_b16 a[126:127], v17 offset:53248
v_mfma_f32_16x16x32_bf16 v[84:87], a[52:55], a[0:3], v[84:87]
v_mfma_f32_16x16x32_bf16 v[88:91], a[56:59], a[0:3], v[88:91]
v_mfma_f32_16x16x32_bf16 v[120:123], a[56:59], a[4:7], v[120:123]
v_mfma_f32_16x16x32_bf16 v[152:155], a[56:59], a[8:11], v[152:155]
v_mfma_f32_16x16x32_bf16 v[184:187], a[56:59], a[12:15], v[184:187]
v_mfma_f32_16x16x32_bf16 v[216:219], a[56:59], a[16:19], v[216:219]
buffer_load_dwordx4 v6, s[8:11], s61 offen offset:2048 lds
v_mfma_f32_16x16x32_bf16 v[248:251], a[56:59], a[20:23], v[248:251]
v_mfma_f32_16x16x32_bf16 a[152:155], a[56:59], a[24:27], a[152:155]
v_mfma_f32_16x16x32_bf16 a[184:187], a[56:59], a[28:31], a[184:187]
v_mfma_f32_16x16x32_bf16 a[188:191], a[60:63], a[28:31], a[188:191]
v_mfma_f32_16x16x32_bf16 a[156:159], a[60:63], a[24:27], a[156:159]
v_mfma_f32_16x16x32_bf16 v[252:255], a[60:63], a[20:23], v[252:255]
v_mfma_f32_16x16x32_bf16 v[220:223], a[60:63], a[16:19], v[220:223]
v_mfma_f32_16x16x32_bf16 v[188:191], a[60:63], a[12:15], v[188:191]
buffer_load_dwordx4 v7, s[8:11], s61 offen offset:3072 lds
s_add_u32 s61, s61, s65
v_mfma_f32_16x16x32_bf16 v[156:159], a[60:63], a[8:11], v[156:159]
v_mfma_f32_16x16x32_bf16 v[124:127], a[60:63], a[4:7], v[124:127]
v_mfma_f32_16x16x32_bf16 v[92:95], a[60:63], a[0:3], v[92:95]
s_waitcnt vmcnt(16) lgkmcnt(0)
s_barrier
v_mfma_f32_16x16x32_bf16 v[64:67], a[96:99], a[64:67], v[64:67]
ds_read_b128 a[0:3], v8 offset:0
v_mfma_f32_16x16x32_bf16 v[96:99], a[96:99], a[68:71], v[96:99]
v_mfma_f32_16x16x32_bf16 v[128:131], a[96:99], a[72:75], v[128:131]
ds_read_b64_tr_b16 a[32:33], v10 offset:0
v_mfma_f32_16x16x32_bf16 v[160:163], a[96:99], a[76:79], v[160:163]
v_mfma_f32_16x16x32_bf16 v[192:195], a[96:99], a[80:83], v[192:195]
ds_read_b64_tr_b16 a[34:35], v10 offset:4096
s_add_u32 m0, s63, 49152
s_nop 0
buffer_load_dwordx4 v2, s[4:7], s60 offen offset:0 sc1 lds
v_mfma_f32_16x16x32_bf16 v[224:227], a[96:99], a[84:87], v[224:227]
v_mfma_f32_16x16x32_bf16 a[128:131], a[96:99], a[88:91], a[128:131]
ds_read_b128 a[4:7], v8 offset:1024
v_mfma_f32_16x16x32_bf16 a[160:163], a[96:99], a[92:95], a[160:163]
v_mfma_f32_16x16x32_bf16 a[164:167], a[100:103], a[92:95], a[164:167]
ds_read_b64_tr_b16 a[36:37], v11 offset:0
v_mfma_f32_16x16x32_bf16 a[132:135], a[100:103], a[88:91], a[132:135]
v_mfma_f32_16x16x32_bf16 v[228:231], a[100:103], a[84:87], v[228:231]
ds_read_b64_tr_b16 a[38:39], v11 offset:4096
v_mfma_f32_16x16x32_bf16 v[196:199], a[100:103], a[80:83], v[196:199]
v_mfma_f32_16x16x32_bf16 v[164:167], a[100:103], a[76:79], v[164:167]
ds_read_b128 a[8:11], v8 offset:2048
buffer_load_dwordx4 v2, s[4:7], s60 offen offset:1024 sc1 lds
v_mfma_f32_16x16x32_bf16 v[132:135], a[100:103], a[72:75], v[132:135]
v_mfma_f32_16x16x32_bf16 v[100:103], a[100:103], a[68:71], v[100:103]
ds_read_b64_tr_b16 a[40:41], v12 offset:0
v_mfma_f32_16x16x32_bf16 v[68:71], a[100:103], a[64:67], v[68:71]
v_mfma_f32_16x16x32_bf16 v[72:75], a[104:107], a[64:67], v[72:75]
ds_read_b64_tr_b16 a[42:43], v12 offset:4096
v_mfma_f32_16x16x32_bf16 v[104:107], a[104:107], a[68:71], v[104:107]
v_mfma_f32_16x16x32_bf16 v[136:139], a[104:107], a[72:75], v[136:139]
ds_read_b128 a[12:15], v8 offset:3072
v_mfma_f32_16x16x32_bf16 v[168:171], a[104:107], a[76:79], v[168:171]
v_mfma_f32_16x16x32_bf16 v[200:203], a[104:107], a[80:83], v[200:203]
ds_read_b64_tr_b16 a[44:45], v13 offset:0
buffer_load_dwordx4 v2, s[4:7], s60 offen offset:2048 sc1 lds
v_mfma_f32_16x16x32_bf16 v[232:235], a[104:107], a[84:87], v[232:235]
v_mfma_f32_16x16x32_bf16 a[136:139], a[104:107], a[88:91], a[136:139]
ds_read_b64_tr_b16 a[46:47], v13 offset:4096
v_mfma_f32_16x16x32_bf16 a[168:171], a[104:107], a[92:95], a[168:171]
v_mfma_f32_16x16x32_bf16 a[172:175], a[108:111], a[92:95], a[172:175]
ds_read_b128 a[16:19], v8 offset:4096
v_mfma_f32_16x16x32_bf16 a[140:143], a[108:111], a[88:91], a[140:143]
v_mfma_f32_16x16x32_bf16 v[236:239], a[108:111], a[84:87], v[236:239]
ds_read_b64_tr_b16 a[48:49], v14 offset:0
v_mfma_f32_16x16x32_bf16 v[204:207], a[108:111], a[80:83], v[204:207]
v_mfma_f32_16x16x32_bf16 v[172:175], a[108:111], a[76:79], v[172:175]
ds_read_b64_tr_b16 a[50:51], v14 offset:4096
buffer_load_dwordx4 v2, s[4:7], s60 offen offset:3072 sc1 lds
s_add_u32 s60, s60, 4096
v_mfma_f32_16x16x32_bf16 v[140:143], a[108:111], a[72:75], v[140:143]
v_mfma_f32_16x16x32_bf16 v[108:111], a[108:111], a[68:71], v[108:111]
ds_read_b128 a[20:23], v8 offset:5120
v_mfma_f32_16x16x32_bf16 v[76:79], a[108:111], a[64:67], v[76:79]
v_mfma_f32_16x16x32_bf16 v[80:83], a[112:115], a[64:67], v[80:83]
ds_read_b64_tr_b16 a[52:53], v15 offset:0
v_mfma_f32_16x16x32_bf16 v[112:115], a[112:115], a[68:71], v[112:115]
v_mfma_f32_16x16x32_bf16 v[144:147], a[112:115], a[72:75], v[144:147]
ds_read_b64_tr_b16 a[54:55], v15 offset:4096
v_mfma_f32_16x16x32_bf16 v[176:179], a[112:115], a[76:79], v[176:179]
v_mfma_f32_16x16x32_bf16 v[208:211], a[112:115], a[80:83], v[208:211]
ds_read_b128 a[24:27], v8 offset:6144
s_add_u32 m0, s64, 49152
s_nop 0
buffer_load_dwordx4 v4, s[8:11], s61 offen offset:0 lds
v_mfma_f32_16x16x32_bf16 v[240:243], a[112:115], a[84:87], v[240:243]
v_mfma_f32_16x16x32_bf16 a[144:147], a[112:115], a[88:91], a[144:147]
ds_read_b64_tr_b16 a[56:57], v16 offset:0
v_mfma_f32_16x16x32_bf16 a[176:179], a[112:115], a[92:95], a[176:179]
v_mfma_f32_16x16x32_bf16 a[180:183], a[116:119], a[92:95], a[180:183]
ds_read_b64_tr_b16 a[58:59], v16 offset:4096
v_mfma_f32_16x16x32_bf16 a[148:151], a[116:119], a[88:91], a[148:151]
v_mfma_f32_16x16x32_bf16 v[244:247], a[116:119], a[84:87], v[244:247]
ds_read_b128 a[28:31], v8 offset:7168
v_mfma_f32_16x16x32_bf16 v[212:215], a[116:119], a[80:83], v[212:215]
v_mfma_f32_16x16x32_bf16 v[180:183], a[116:119], a[76:79], v[180:183]
ds_read_b64_tr_b16 a[60:61], v17 offset:0
buffer_load_dwordx4 v5, s[8:11], s61 offen offset:1024 lds
v_mfma_f32_16x16x32_bf16 v[148:151], a[116:119], a[72:75], v[148:151]
v_mfma_f32_16x16x32_bf16 v[116:119], a[116:119], a[68:71], v[116:119]
ds_read_b64_tr_b16 a[62:63], v17 offset:4096
v_mfma_f32_16x16x32_bf16 v[84:87], a[116:119], a[64:67], v[84:87]
v_mfma_f32_16x16x32_bf16 v[88:91], a[120:123], a[64:67], v[88:91]
v_mfma_f32_16x16x32_bf16 v[120:123], a[120:123], a[68:71], v[120:123]
v_mfma_f32_16x16x32_bf16 v[152:155], a[120:123], a[72:75], v[152:155]
v_mfma_f32_16x16x32_bf16 v[184:187], a[120:123], a[76:79], v[184:187]
v_mfma_f32_16x16x32_bf16 v[216:219], a[120:123], a[80:83], v[216:219]
buffer_load_dwordx4 v6, s[8:11], s61 offen offset:2048 lds
v_mfma_f32_16x16x32_bf16 v[248:251], a[120:123], a[84:87], v[248:251]
v_mfma_f32_16x16x32_bf16 a[152:155], a[120:123], a[88:91], a[152:155]
v_mfma_f32_16x16x32_bf16 a[184:187], a[120:123], a[92:95], a[184:187]
v_mfma_f32_16x16x32_bf16 a[188:191], a[124:127], a[92:95], a[188:191]
v_mfma_f32_16x16x32_bf16 a[156:159], a[124:127], a[88:91], a[156:159]
v_mfma_f32_16x16x32_bf16 v[252:255], a[124:127], a[84:87], v[252:255]
v_mfma_f32_16x16x32_bf16 v[220:223], a[124:127], a[80:83], v[220:223]
v_mfma_f32_16x16x32_bf16 v[188:191], a[124:127], a[76:79], v[188:191]
buffer_load_dwordx4 v7, s[8:11], s61 offen offset:3072 lds
s_add_u32 s61, s61, s65
v_mfma_f32_16x16x32_bf16 v[156:159], a[124:127], a[72:75], v[156:159]
v_mfma_f32_16x16x32_bf16 v[124:127], a[124:127], a[68:71], v[124:127]
v_mfma_f32_16x16x32_bf16 v[92:95], a[124:127], a[64:67], v[92:95]
s_mov_b32 s62, 6
Lgl_6:
s_waitcnt vmcnt(16) lgkmcnt(0)
s_barrier
v_mfma_f32_16x16x32_bf16 v[64:67], a[32:35], a[0:3], v[64:67]
ds_read_b128 a[64:67], v8 offset:16384
v_mfma_f32_16x16x32_bf16 v[96:99], a[32:35], a[4:7], v[96:99]
v_mfma_f32_16x16x32_bf16 v[128:131], a[32:35], a[8:11], v[128:131]
ds_read_b64_tr_b16 a[96:97], v10 offset:16384
v_mfma_f32_16x16x32_bf16 v[160:163], a[32:35], a[12:15], v[160:163]
v_mfma_f32_16x16x32_bf16 v[192:195], a[32:35], a[16:19], v[192:195]
ds_read_b64_tr_b16 a[98:99], v10 offset:20480
s_add_u32 m0, s63, 0
s_nop 0
buffer_load_dwordx4 v2, s[4:7], s60 offen offset:0 sc1 lds
v_mfma_f32_16x16x32_bf16 v[224:227], a[32:35], a[20:23], v[224:227]
v_mfma_f32_16x16x32_bf16 a[128:131], a[32:35], a[24:27], a[128:131]
ds_read_b128 a[68:71], v8 offset:17408
v_mfma_f32_16x16x32_bf16 a[160:163], a[32:35], a[28:31], a[160:163]
v_mfma_f32_16x16x32_bf16 a[164:167], a[36:39], a[28:31], a[164:167]
ds_read_b64_tr_b16 a[100:101], v11 offset:16384
v_mfma_f32_16x16x32_bf16 a[132:135], a[36:39], a[24:27], a[132:135]
v_mfma_f32_16x16x32_bf16 v[228:231], a[36:39], a[20:23], v[228:231]
ds_read_b64_tr_b16 a[102:103], v11 offset:20480
v_mfma_f32_16x16x32_bf16 v[196:199], a[36:39], a[16:19], v[196:199]
v_mfma_f32_16x16x32_bf16 v[164:167], a[36:39], a[12:15], v[164:167]
ds_read_b128 a[72:75], v8 offset:18432
buffer_load_dwordx4 v2, s[4:7], s60 offen offset:1024 sc1 lds
v_mfma_f32_16x16x32_bf16 v[132:135], a[36:39], a[8:11], v[132:135]
v_mfma_f32_16x16x32_bf16 v[100:103], a[36:39], a[4:7], v[100:103]
ds_read_b64_tr_b16 a[104:105], v12 offset:16384
v_mfma_f32_16x16x32_bf16 v[68:71], a[36:39], a[0:3], v[68:71]
v_mfma_f32_16x16x32_bf16 v[72:75], a[40:43], a[0:3], v[72:75]
ds_read_b64_tr_b16 a[106:107], v12 offset:20480
v_mfma_f32_16x16x32_bf16 v[104:107], a[40:43], a[4:7], v[104:107]
v_mfma_f32_16x16x32_bf16 v[136:139], a[40:43], a[8:11], v[136:139]
ds_read_b128 a[76:79], v8 offset:19456
v_mfma_f32_16x16x32_bf16 v[168:171], a[40:43], a[12:15], v[168:171]
v_mfma_f32_16x16x32_bf16 v[200:203], a[40:43], a[16:19], v[200:203]
ds_read_b64_tr_b16 a[108:109], v13 offset:16384
buffer_load_dwordx4 v2, s[4:7], s60 offen offset:2048 sc1 lds
v_mfma_f32_16x16x32_bf16 v[232:235], a[40:43], a[20:23], v[232:235]
v_mfma_f32_16x16x32_bf16 a[136:139], a[40:43], a[24:27], a[136:139]
ds_read_b64_tr_b16 a[110:111], v13 offset:20480
v_mfma_f32_16x16x32_bf16 a[168:171], a[40:43], a[28:31], a[168:171]
v_mfma_f32_16x16x32_bf16 a[172:175], a[44:47], a[28:31], a[172:175]
ds_read_b128 a[80:83], v8 offset:20480
v_mfma_f32_16x16x32_bf16 a[140:143], a[44:47], a[24:27], a[140:143]
v_mfma_f32_16x16x32_bf16 v[236:239], a[44:47], a[20:23], v[236:239]
ds_read_b64_tr_b16 a[112:113], v14 offset:16384
v_mfma_f32_16x16x32_bf16 v[204:207], a[44:47], a[16:19], v[204:207]
v_mfma_f32_16x16x32_bf16 v[172:175], a[44:47], a[12:15], v[172:175]
ds_read_b64_tr_b16 a[114:115], v14 offset:20480
buffer_load_dwordx4 v2, s[4:7], s60 offen offset:3072 sc1 lds
s_add_u32 s60, s60, 4096
v_mfma_f32_16x16x32_bf16 v[140:143], a[44:47], a[8:11], v[140:143]
v_mfma_f32_16x16x32_bf16 v[108:111], a[44:47], a[4:7], v[108:111]
ds_read_b128 a[84:87], v8 offset:21504
v_mfma_f32_16x16x32_bf16 v[76:79], a[44:47], a[0:3], v[76:79]
v_mfma_f32_16x16x32_bf16 v[80:83], a[48:51], a[0:3], v[80:83]
ds_read_b64_tr_b16 a[116:117], v15 offset:16384
v_mfma_f32_16x16x32_bf16 v[112:115], a[48:51], a[4:7], v[112:115]
v_mfma_f32_16x16x32_bf16 v[144:147], a[48:51], a[8:11], v[144:147]
ds_read_b64_tr_b16 a[118:119], v15 offset:20480
v_mfma_f32_16x16x32_bf16 v[176:179], a[48:51], a[12:15], v[176:179]
v_mfma_f32_16x16x32_bf16 v[208:211], a[48:51], a[16:19], v[208:211]
ds_read_b128 a[88:91], v8 offset:22528
s_add_u32 m0, s64, 0
s_nop 0
buffer_load_dwordx4 v4, s[8:11], s61 offen offset:0 lds
v_mfma_f32_16x16x32_bf16 v[240:243], a[48:51], a[20:23], v[240:243]
v_mfma_f32_16x16x32_bf16 a[144:147], a[48:51], a[24:27], a[144:147]
ds_read_b64_tr_b16 a[120:121], v16 offset:16384
v_mfma_f32_16x16x32_bf16 a[176:179], a[48:51], a[28:31], a[176:179]
v_mfma_f32_16x16x32_bf16 a[180:183], a[52:55], a[28:31], a[180:183]
ds_read_b64_tr_b16 a[122:123], v16 offset:20480
v_mfma_f32_16x16x32_bf16 a[148:151], a[52:55], a[24:27], a[148:151]
v_mfma_f32_16x16x32_bf16 v[244:247], a[52:55], a[20:23], v[244:247]
ds_read_b128 a[92:95], v8 offset:23552
v_mfma_f32_16x16x32_bf16 v[212:215], a[52:55], a[16:19], v[212:215]
v_mfma_f32_16x16x32_bf16 v[180:183], a[52:55], a[12:15], v[180:183]
ds_read_b64_tr_b16 a[124:125], v17 offset:16384
buffer_load_dwordx4 v5, s[8:11], s61 offen offset:1024 lds
v_mfma_f32_16x16x32_bf16 v[148:151], a[52:55], a[8:11], v[148:151]
v_mfma_f32_16x16x32_bf16 v[116:119], a[52:55], a[4:7], v[116:119]
ds_read_b64_tr_b16 a[126:127], v17 offset:20480
v_mfma_f32_16x16x32_bf16 v[84:87], a[52:55], a[0:3], v[84:87]
v_mfma_f32_16x16x32_bf16 v[88:91], a[56:59], a[0:3], v[88:91]
v_mfma_f32_16x16x32_bf16 v[120:123], a[56:59], a[4:7], v[120:123]
v_mfma_f32_16x16x32_bf16 v[152:155], a[56:59], a[8:11], v[152:155]
v_mfma_f32_16x16x32_bf16 v[184:187], a[56:59], a[12:15], v[184:187]
v_mfma_f32_16x16x32_bf16 v[216:219], a[56:59], a[16:19], v[216:219]
buffer_load_dwordx4 v6, s[8:11], s61 offen offset:2048 lds
v_mfma_f32_16x16x32_bf16 v[248:251], a[56:59], a[20:23], v[248:251]
v_mfma_f32_16x16x32_bf16 a[152:155], a[56:59], a[24:27], a[152:155]
v_mfma_f32_16x16x32_bf16 a[184:187], a[56:59], a[28:31], a[184:187]
v_mfma_f32_16x16x32_bf16 a[188:191], a[60:63], a[28:31], a[188:191]
v_mfma_f32_16x16x32_bf16 a[156:159], a[60:63], a[24:27], a[156:159]
v_mfma_f32_16x16x32_bf16 v[252:255], a[60:63], a[20:23], v[252:255]
v_mfma_f32_16x16x32_bf16 v[220:223], a[60:63], a[16:19], v[220:223]
v_mfma_f32_16x16x32_bf16 v[188:191], a[60:63], a[12:15], v[188:191]
buffer_load_dwordx4 v7, s[8:11], s61 offen offset:3072 lds
s_add_u32 s61, s61, s65
v_mfma_f32_16x16x32_bf16 v[156:159], a[60:63], a[8:11], v[156:159]
v_mfma_f32_16x16x32_bf16 v[124:127], a[60:63], a[4:7], v[124:127]
v_mfma_f32_16x16x32_bf16 v[92:95], a[60:63], a[0:3], v[92:95]
s_waitcnt vmcnt(16) lgkmcnt(0)
s_barrier
v_mfma_f32_16x16x32_bf16 v[64:67], a[96:99], a[64:67], v[64:67]
ds_read_b128 a[0:3], v8 offset:32768
v_mfma_f32_16x16x32_bf16 v[96:99], a[96:99], a[68:71], v[96:99]
v_mfma_f32_16x16x32_bf16 v[128:131], a[96:99], a[72:75], v[128:131]
ds_read_b64_tr_b16 a[32:33], v10 offset:32768
v_mfma_f32_16x16x32_bf16 v[160:163], a[96:99], a[76:79], v[160:163]
v_mfma_f32_16x16x32_bf16 v[192:195], a[96:99], a[80:83], v[192:195]
ds_read_b64_tr_b16 a[34:35], v10 offset:36864
s_add_u32 m0, s63, 16384
s_nop 0
buffer_load_dwordx4 v2, s[4:7], s60 offen offset:0 sc1 lds
v_mfma_f32_16x16x32_bf16 v[224:227], a[96:99], a[84:87], v[224:227]
v_mfma_f32_16x16x32_bf16 a[128:131], a[96:99], a[88:91], a[128:131]
ds_read_b128 a[4:7], v8 offset:33792
v_mfma_f32_16x16x32_bf16 a[160:163], a[96:99], a[92:95], a[160:163]
v_mfma_f32_16x16x32_bf16 a[164:167], a[100:103], a[92:95], a[164:167]
ds_read_b64_tr_b16 a[36:37], v11 offset:32768
v_mfma_f32_16x16x32_bf16 a[132:135], a[100:103], a[88:91], a[132:135]
v_mfma_f32_16x16x32_bf16 v[228:231], a[100:103], a[84:87], v[228:231]
ds_read_b64_tr_b16 a[38:39], v11 offset:36864
v_mfma_f32_16x16x32_bf16 v[196:199], a[100:103], a[80:83], v[196:199]
v_mfma_f32_16x16x32_bf16 v[164:167], a[100:103], a[76:79], v[164:167]
ds_read_b128 a[8:11], v8 offset:34816
buffer_load_dwordx4 v2, s[4:7], s60 offen offset:1024 sc1 lds
v_mfma_f32_16x16x32_bf16 v[132:135], a[100:103], a[72:75], v[132:135]
v_mfma_f32_16x16x32_bf16 v[100:103], a[100:103], a[68:71], v[100:103]
ds_read_b64_tr_b16 a[40:41], v12 offset:32768
v_mfma_f32_16x16x32_bf16 v[68:71], a[100:103], a[64:67], v[68:71]
v_mfma_f32_16x16x32_bf16 v[72:75], a[104:107], a[64:67], v[72:75]
ds_read_b64_tr_b16 a[42:43], v12 offset:36864
v_mfma_f32_16x16x32_bf16 v[104:107], a[104:107], a[68:71], v[104:107]
v_mfma_f32_16x16x32_bf16 v[136:139], a[104:107], a[72:75], v[136:139]
ds_read_b128 a[12:15], v8 offset:35840
v_mfma_f32_16x16x32_bf16 v[168:171], a[104:107], a[76:79], v[168:171]
v_mfma_f32_16x16x32_bf16 v[200:203], a[104:107], a[80:83], v[200:203]
ds_read_b64_tr_b16 a[44:45], v13 offset:32768
buffer_load_dwordx4 v2, s[4:7], s60 offen offset:2048 sc1 lds
v_mfma_f32_16x16x32_bf16 v[232:235], a[104:107], a[84:87], v[232:235]
v_mfma_f32_16x16x32_bf16 a[136:139], a[104:107], a[88:91], a[136:139]
ds_read_b64_tr_b16 a[46:47], v13 offset:36864
v_mfma_f32_16x16x32_bf16 a[168:171], a[104:107], a[92:95], a[168:171]
v_mfma_f32_16x16x32_bf16 a[172:175], a[108:111], a[92:95], a[172:175]
ds_read_b128 a[16:19], v8 offset:36864
v_mfma_f32_16x16x32_bf16 a[140:143], a[108:111], a[88:91], a[140:143]
v_mfma_f32_16x16x32_bf16 v[236:239], a[108:111], a[84:87], v[236:239]
ds_read_b64_tr_b16 a[48:49], v14 offset:32768
v_mfma_f32_16x16x32_bf16 v[204:207], a[108:111], a[80:83], v[204:207]
v_mfma_f32_16x16x32_bf16 v[172:175], a[108:111], a[76:79], v[172:175]
ds_read_b64_tr_b16 a[50:51], v14 offset:36864
buffer_load_dwordx4 v2, s[4:7], s60 offen offset:3072 sc1 lds
s_add_u32 s60, s60, 4096
v_mfma_f32_16x16x32_bf16 v[140:143], a[108:111], a[72:75], v[140:143]
v_mfma_f32_16x16x32_bf16 v[108:111], a[108:111], a[68:71], v[108:111]
ds_read_b128 a[20:23], v8 offset:37888
v_mfma_f32_16x16x32_bf16 v[76:79], a[108:111], a[64:67], v[76:79]
v_mfma_f32_16x16x32_bf16 v[80:83], a[112:115], a[64:67], v[80:83]
ds_read_b64_tr_b16 a[52:53], v15 offset:32768
v_mfma_f32_16x16x32_bf16 v[112:115], a[112:115], a[68:71], v[112:115]
v_mfma_f32_16x16x32_bf16 v[144:147], a[112:115], a[72:75], v[144:147]
ds_read_b64_tr_b16 a[54:55], v15 offset:36864
v_mfma_f32_16x16x32_bf16 v[176:179], a[112:115], a[76:79], v[176:179]
v_mfma_f32_16x16x32_bf16 v[208:211], a[112:115], a[80:83], v[208:211]
ds_read_b128 a[24:27], v8 offset:38912
s_add_u32 m0, s64, 16384
s_nop 0
buffer_load_dwordx4 v4, s[8:11], s61 offen offset:0 lds
v_mfma_f32_16x16x32_bf16 v[240:243], a[112:115], a[84:87], v[240:243]
v_mfma_f32_16x16x32_bf16 a[144:147], a[112:115], a[88:91], a[144:147]
ds_read_b64_tr_b16 a[56:57], v16 offset:32768
v_mfma_f32_16x16x32_bf16 a[176:179], a[112:115], a[92:95], a[176:179]
v_mfma_f32_16x16x32_bf16 a[180:183], a[116:119], a[92:95], a[180:183]
ds_read_b64_tr_b16 a[58:59], v16 offset:36864
v_mfma_f32_16x16x32_bf16 a[148:151], a[116:119], a[88:91], a[148:151]
v_mfma_f32_16x16x32_bf16 v[244:247], a[116:119], a[84:87], v[244:247]
ds_read_b128 a[28:31], v8 offset:39936
v_mfma_f32_16x16x32_bf16 v[212:215], a[116:119], a[80:83], v[212:215]
v_mfma_f32_16x16x32_bf16 v[180:183], a[116:119], a[76:79], v[180:183]
ds_read_b64_tr_b16 a[60:61], v17 offset:32768
buffer_load_dwordx4 v5, s[8:11], s61 offen offset:1024 lds
v_mfma_f32_16x16x32_bf16 v[148:151], a[116:119], a[72:75], v[148:151]
v_mfma_f32_16x16x32_bf16 v[116:119], a[116:119], a[68:71], v[116:119]
ds_read_b64_tr_b16 a[62:63], v17 offset:36864
v_mfma_f32_16x16x32_bf16 v[84:87], a[116:119], a[64:67], v[84:87]
v_mfma_f32_16x16x32_bf16 v[88:91], a[120:123], a[64:67], v[88:91]
v_mfma_f32_16x16x32_bf16 v[120:123], a[120:123], a[68:71], v[120:123]
v_mfma_f32_16x16x32_bf16 v[152:155], a[120:123], a[72:75], v[152:155]
v_mfma_f32_16x16x32_bf16 v[184:187], a[120:123], a[76:79], v[184:187]
v_mfma_f32_16x16x32_bf16 v[216:219], a[120:123], a[80:83], v[216:219]
buffer_load_dwordx4 v6, s[8:11], s61 offen offset:2048 lds
v_mfma_f32_16x16x32_bf16 v[248:251], a[120:123], a[84:87], v[248:251]
v_mfma_f32_16x16x32_bf16 a[152:155], a[120:123], a[88:91], a[152:155]
v_mfma_f32_16x16x32_bf16 a[184:187], a[120:123], a[92:95], a[184:187]
v_mfma_f32_16x16x32_bf16 a[188:191], a[124:127], a[92:95], a[188:191]
v_mfma_f32_16x16x32_bf16 a[156:159], a[124:127], a[88:91], a[156:159]
v_mfma_f32_16x16x32_bf16 v[252:255], a[124:127], a[84:87], v[252:255]
v_mfma_f32_16x16x32_bf16 v[220:223], a[124:127], a[80:83], v[220:223]
v_mfma_f32_16x16x32_bf16 v[188:191], a[124:127], a[76:79], v[188:191]
buffer_load_dwordx4 v7, s[8:11], s61 offen offset:3072 lds
s_add_u32 s61, s61, s65
v_mfma_f32_16x16x32_bf16 v[156:159], a[124:127], a[72:75], v[156:159]
v_mfma_f32_16x16x32_bf16 v[124:127], a[124:127], a[68:71], v[124:127]
v_mfma_f32_16x16x32_bf16 v[92:95], a[124:127], a[64:67], v[92:95]
s_waitcnt vmcnt(16) lgkmcnt(0)
s_barrier
v_mfma_f32_16x16x32_bf16 v[64:67], a[32:35], a[0:3], v[64:67]
ds_read_b128 a[64:67], v8 offset:49152
v_mfma_f32_16x16x32_bf16 v[96:99], a[32:35], a[4:7], v[96:99]
v_mfma_f32_16x16x32_bf16 v[128:131], a[32:35], a[8:11], v[128:131]
ds_read_b64_tr_b16 a[96:97], v10 offset:49152
v_mfma_f32_16x16x32_bf16 v[160:163], a[32:35], a[12:15], v[160:163]
v_mfma_f32_16x16x32_bf16 v[192:195], a[32:35], a[16:19], v[192:195]
ds_read_b64_tr_b16 a[98:99], v10 offset:53248
s_add_u32 m0, s63, 32768
s_nop 0
buffer_load_dwordx4 v2, s[4:7], s60 offen offset:0 sc1 lds
v_mfma_f32_16x16x32_bf16 v[224:227], a[32:35], a[20:23], v[224:227]
v_mfma_f32_16x16x32_bf16 a[128:131], a[32:35], a[24:27], a[128:131]
ds_read_b128 a[68:71], v8 offset:50176
v_mfma_f32_16x16x32_bf16 a[160:163], a[32:35], a[28:31], a[160:163]
v_mfma_f32_16x16x32_bf16 a[164:167], a[36:39], a[28:31], a[164:167]
ds_read_b64_tr_b16 a[100:101], v11 offset:49152
v_mfma_f32_16x16x32_bf16 a[132:135], a[36:39], a[24:27], a[132:135]
v_mfma_f32_16x16x32_bf16 v[228:231], a[36:39], a[20:23], v[228:231]
ds_read_b64_tr_b16 a[102:103], v11 offset:53248
v_mfma_f32_16x16x32_bf16 v[196:199], a[36:39], a[16:19], v[196:199]
v_mfma_f32_16x16x32_bf16 v[164:167], a[36:39], a[12:15], v[164:167]
ds_read_b128 a[72:75], v8 offset:51200
buffer_load_dwordx4 v2, s[4:7], s60 offen offset:1024 sc1 lds
v_mfma_f32_16x16x32_bf16 v[132:135], a[36:39], a[8:11], v[132:135]
v_mfma_f32_16x16x32_bf16 v[100:103], a[36:39], a[4:7], v[100:103]
ds_read_b64_tr_b16 a[104:105], v12 offset:49152
v_mfma_f32_16x16x32_bf16 v[68:71], a[36:39], a[0:3], v[68:71]
v_mfma_f32_16x16x32_bf16 v[72:75], a[40:43], a[0:3], v[72:75]
ds_read_b64_tr_b16 a[106:107], v12 offset:53248
v_mfma_f32_16x16x32_bf16 v[104:107], a[40:43], a[4:7], v[104:107]
v_mfma_f32_16x16x32_bf16 v[136:139], a[40:43], a[8:11], v[136:139]
ds_read_b128 a[76:79], v8 offset:52224
v_mfma_f32_16x16x32_bf16 v[168:171], a[40:43], a[12:15], v[168:171]
v_mfma_f32_16x16x32_bf16 v[200:203], a[40:43], a[16:19], v[200:203]
ds_read_b64_tr_b16 a[108:109], v13 offset:49152
buffer_load_dwordx4 v2, s[4:7], s60 offen offset:2048 sc1 lds
v_mfma_f32_16x16x32_bf16 v[232:235], a[40:43], a[20:23], v[232:235]
v_mfma_f32_16x16x32_bf16 a[136:139], a[40:43], a[24:27], a[136:139]
ds_read_b64_tr_b16 a[110:111], v13 offset:53248
v_mfma_f32_16x16x32_bf16 a[168:171], a[40:43], a[28:31], a[168:171]
v_mfma_f32_16x16x32_bf16 a[172:175], a[44:47], a[28:31], a[172:175]
ds_read_b128 a[80:83], v8 offset:53248
v_mfma_f32_16x16x32_bf16 a[140:143], a[44:47], a[24:27], a[140:143]
v_mfma_f32_16x16x32_bf16 v[236:239], a[44:47], a[20:23], v[236:239]
ds_read_b64_tr_b16 a[112:113], v14 offset:49152
v_mfma_f32_16x16x32_bf16 v[204:207], a[44:47], a[16:19], v[204:207]
v_mfma_f32_16x16x32_bf16 v[172:175], a[44:47], a[12:15], v[172:175]
ds_read_b64_tr_b16 a[114:115], v14 offset:53248
buffer_load_dwordx4 v2, s[4:7], s60 offen offset:3072 sc1 lds
s_add_u32 s60, s60, 4096
v_mfma_f32_16x16x32_bf16 v[140:143], a[44:47], a[8:11], v[140:143]
v_mfma_f32_16x16x32_bf16 v[108:111], a[44:47], a[4:7], v[108:111]
ds_read_b128 a[84:87], v8 offset:54272
v_mfma_f32_16x16x32_bf16 v[76:79], a[44:47], a[0:3], v[76:79]
v_mfma_f32_16x16x32_bf16 v[80:83], a[48:51], a[0:3], v[80:83]
ds_read_b64_tr_b16 a[116:117], v15 offset:49152
v_mfma_f32_16x16x32_bf16 v[112:115], a[48:51], a[4:7], v[112:115]
v_mfma_f32_16x16x32_bf16 v[144:147], a[48:51], a[8:11], v[144:147]
ds_read_b64_tr_b16 a[118:119], v15 offset:53248
v_mfma_f32_16x16x32_bf16 v[176:179], a[48:51], a[12:15], v[176:179]
v_mfma_f32_16x16x32_bf16 v[208:211], a[48:51], a[16:19], v[208:211]
ds_read_b128 a[88:91], v8 offset:55296
s_add_u32 m0, s64, 32768
s_nop 0
buffer_load_dwordx4 v4, s[8:11], s61 offen offset:0 lds
v_mfma_f32_16x16x32_bf16 v[240:243], a[48:51], a[20:23], v[240:243]
v_mfma_f32_16x16x32_bf16 a[144:147], a[48:51], a[24:27], a[144:147]
ds_read_b64_tr_b16 a[120:121], v16 offset:49152
v_mfma_f32_16x16x32_bf16 a[176:179], a[48:51], a[28:31], a[176:179]
v_mfma_f32_16x16x32_bf16 a[180:183], a[52:55], a[28:31], a[180:183]
ds_read_b64_tr_b16 a[122:123], v16 offset:53248
v_mfma_f32_16x16x32_bf16 a[148:151], a[52:55], a[24:27], a[148:151]
v_mfma_f32_16x16x32_bf16 v[244:247], a[52:55], a[20:23], v[244:247]
ds_read_b128 a[92:95], v8 offset:56320
v_mfma_f32_16x16x32_bf16 v[212:215], a[52:55], a[16:19], v[212:215]
v_mfma_f32_16x16x32_bf16 v[180:183], a[52:55], a[12:15], v[180:183]
ds_read_b64_tr_b16 a[124:125], v17 offset:49152
buffer_load_dwordx4 v5, s[8:11], s61 offen offset:1024 lds
v_mfma_f32_16x16x32_bf16 v[148:151], a[52:55], a[8:11], v[148:151]
v_mfma_f32_16x16x32_bf16 v[116:119], a[52:55], a[4:7], v[116:119]
ds_read_b64_tr_b16 a[126:127], v17 offset:53248
v_mfma_f32_16x16x32_bf16 v[84:87], a[52:55], a[0:3], v[84:87]
v_mfma_f32_16x16x32_bf16 v[88:91], a[56:59], a[0:3], v[88:91]
v_mfma_f32_16x16x32_bf16 v[120:123], a[56:59], a[4:7], v[120:123]
v_mfma_f32_16x16x32_bf16 v[152:155], a[56:59], a[8:11], v[152:155]
v_mfma_f32_16x16x32_bf16 v[184:187], a[56:59], a[12:15], v[184:187]
v_mfma_f32_16x16x32_bf16 v[216:219], a[56:59], a[16:19], v[216:219]
buffer_load_dwordx4 v6, s[8:11], s61 offen offset:2048 lds
v_mfma_f32_16x16x32_bf16 v[248:251], a[56:59], a[20:23], v[248:251]
v_mfma_f32_16x16x32_bf16 a[152:155], a[56:59], a[24:27], a[152:155]
v_mfma_f32_16x16x32_bf16 a[184:187], a[56:59], a[28:31], a[184:187]
v_mfma_f32_16x16x32_bf16 a[188:191], a[60:63], a[28:31], a[188:191]
v_mfma_f32_16x16x32_bf16 a[156:159], a[60:63], a[24:27], a[156:159]
v_mfma_f32_16x16x32_bf16 v[252:255], a[60:63], a[20:23], v[252:255]
v_mfma_f32_16x16x32_bf16 v[220:223], a[60:63], a[16:19], v[220:223]
v_mfma_f32_16x16x32_bf16 v[188:191], a[60:63], a[12:15], v[188:191]
buffer_load_dwordx4 v7, s[8:11], s61 offen offset:3072 lds
s_add_u32 s61, s61, s65
v_mfma_f32_16x16x32_bf16 v[156:159], a[60:63], a[8:11], v[156:159]
v_mfma_f32_16x16x32_bf16 v[124:127], a[60:63], a[4:7], v[124:127]
v_mfma_f32_16x16x32_bf16 v[92:95], a[60:63], a[0:3], v[92:95]
s_waitcnt vmcnt(16) lgkmcnt(0)
s_barrier
v_mfma_f32_16x16x32_bf16 v[64:67], a[96:99], a[64:67], v[64:67]
ds_read_b128 a[0:3], v8 offset:0
v_mfma_f32_16x16x32_bf16 v[96:99], a[96:99], a[68:71], v[96:99]
v_mfma_f32_16x16x32_bf16 v[128:131], a[96:99], a[72:75], v[128:131]
ds_read_b64_tr_b16 a[32:33], v10 offset:0
v_mfma_f32_16x16x32_bf16 v[160:163], a[96:99], a[76:79], v[160:163]
v_mfma_f32_16x16x32_bf16 v[192:195], a[96:99], a[80:83], v[192:195]
ds_read_b64_tr_b16 a[34:35], v10 offset:4096
s_add_u32 m0, s63, 49152
s_nop 0
buffer_load_dwordx4 v2, s[4:7], s60 offen offset:0 sc1 lds
v_mfma_f32_16x16x32_bf16 v[224:227], a[96:99], a[84:87], v[224:227]
v_mfma_f32_16x16x32_bf16 a[128:131], a[96:99], a[88:91], a[128:131]
ds_read_b128 a[4:7], v8 offset:1024
v_mfma_f32_16x16x32_bf16 a[160:163], a[96:99], a[92:95], a[160:163]
v_mfma_f32_16x16x32_bf16 a[164:167], a[100:103], a[92:95], a[164:167]
ds_read_b64_tr_b16 a[36:37], v11 offset:0
v_mfma_f32_16x16x32_bf16 a[132:135], a[100:103], a[88:91], a[132:135]
v_mfma_f32_16x16x32_bf16 v[228:231], a[100:103], a[84:87], v[228:231]
ds_read_b64_tr_b16 a[38:39], v11 offset:4096
v_mfma_f32_16x16x32_bf16 v[196:199], a[100:103], a[80:83], v[196:199]
v_mfma_f32_16x16x32_bf16 v[164:167], a[100:103], a[76:79], v[164:167]
ds_read_b128 a[8:11], v8 offset:2048
buffer_load_dwordx4 v2, s[4:7], s60 offen offset:1024 sc1 lds
v_mfma_f32_16x16x32_bf16 v[132:135], a[100:103], a[72:75], v[132:135]
v_mfma_f32_16x16x32_bf16 v[100:103], a[100:103], a[68:71], v[100:103]
ds_read_b64_tr_b16 a[40:41], v12 offset:0
v_mfma_f32_16x16x32_bf16 v[68:71], a[100:103], a[64:67], v[68:71]
v_mfma_f32_16x16x32_bf16 v[72:75], a[104:107], a[64:67], v[72:75]
ds_read_b64_tr_b16 a[42:43], v12 offset:4096
v_mfma_f32_16x16x32_bf16 v[104:107], a[104:107], a[68:71], v[104:107]
v_mfma_f32_16x16x32_bf16 v[136:139], a[104:107], a[72:75], v[136:139]
ds_read_b128 a[12:15], v8 offset:3072
v_mfma_f32_16x16x32_bf16 v[168:171], a[104:107], a[76:79], v[168:171]
v_mfma_f32_16x16x32_bf16 v[200:203], a[104:107], a[80:83], v[200:203]
ds_read_b64_tr_b16 a[44:45], v13 offset:0
buffer_load_dwordx4 v2, s[4:7], s60 offen offset:2048 sc1 lds
v_mfma_f32_16x16x32_bf16 v[232:235], a[104:107], a[84:87], v[232:235]
v_mfma_f32_16x16x32_bf16 a[136:139], a[104:107], a[88:91], a[136:139]
ds_read_b64_tr_b16 a[46:47], v13 offset:4096
v_mfma_f32_16x16x32_bf16 a[168:171], a[104:107], a[92:95], a[168:171]
v_mfma_f32_16x16x32_bf16 a[172:175], a[108:111], a[92:95], a[172:175]
ds_read_b128 a[16:19], v8 offset:4096
v_mfma_f32_16x16x32_bf16 a[140:143], a[108:111], a[88:91], a[140:143]
v_mfma_f32_16x16x32_bf16 v[236:239], a[108:111], a[84:87], v[236:239]
ds_read_b64_tr_b16 a[48:49], v14 offset:0
v_mfma_f32_16x16x32_bf16 v[204:207], a[108:111], a[80:83], v[204:207]
v_mfma_f32_16x16x32_bf16 v[172:175], a[108:111], a[76:79], v[172:175]
ds_read_b64_tr_b16 a[50:51], v14 offset:4096
buffer_load_dwordx4 v2, s[4:7], s60 offen offset:3072 sc1 lds
s_add_u32 s60, s60, 4096
v_mfma_f32_16x16x32_bf16 v[140:143], a[108:111], a[72:75], v[140:143]
v_mfma_f32_16x16x32_bf16 v[108:111], a[108:111], a[68:71], v[108:111]
ds_read_b128 a[20:23], v8 offset:5120
v_mfma_f32_16x16x32_bf16 v[76:79], a[108:111], a[64:67], v[76:79]
v_mfma_f32_16x16x32_bf16 v[80:83], a[112:115], a[64:67], v[80:83]
ds_read_b64_tr_b16 a[52:53], v15 offset:0
v_mfma_f32_16x16x32_bf16 v[112:115], a[112:115], a[68:71], v[112:115]
v_mfma_f32_16x16x32_bf16 v[144:147], a[112:115], a[72:75], v[144:147]
ds_read_b64_tr_b16 a[54:55], v15 offset:4096
v_mfma_f32_16x16x32_bf16 v[176:179], a[112:115], a[76:79], v[176:179]
v_mfma_f32_16x16x32_bf16 v[208:211], a[112:115], a[80:83], v[208:211]
ds_read_b128 a[24:27], v8 offset:6144
s_add_u32 m0, s64, 49152
s_nop 0
buffer_load_dwordx4 v4, s[8:11], s61 offen offset:0 lds
v_mfma_f32_16x16x32_bf16 v[240:243], a[112:115], a[84:87], v[240:243]
v_mfma_f32_16x16x32_bf16 a[144:147], a[112:115], a[88:91], a[144:147]
ds_read_b64_tr_b16 a[56:57], v16 offset:0
v_mfma_f32_16x16x32_bf16 a[176:179], a[112:115], a[92:95], a[176:179]
v_mfma_f32_16x16x32_bf16 a[180:183], a[116:119], a[92:95], a[180:183]
ds_read_b64_tr_b16 a[58:59], v16 offset:4096
v_mfma_f32_16x16x32_bf16 a[148:151], a[116:119], a[88:91], a[148:151]
v_mfma_f32_16x16x32_bf16 v[244:247], a[116:119], a[84:87], v[244:247]
ds_read_b128 a[28:31], v8 offset:7168
v_mfma_f32_16x16x32_bf16 v[212:215], a[116:119], a[80:83], v[212:215]
v_mfma_f32_16x16x32_bf16 v[180:183], a[116:119], a[76:79], v[180:183]
ds_read_b64_tr_b16 a[60:61], v17 offset:0
buffer_load_dwordx4 v5, s[8:11], s61 offen offset:1024 lds
v_mfma_f32_16x16x32_bf16 v[148:151], a[116:119], a[72:75], v[148:151]
v_mfma_f32_16x16x32_bf16 v[116:119], a[116:119], a[68:71], v[116:119]
ds_read_b64_tr_b16 a[62:63], v17 offset:4096
v_mfma_f32_16x16x32_bf16 v[84:87], a[116:119], a[64:67], v[84:87]
v_mfma_f32_16x16x32_bf16 v[88:91], a[120:123], a[64:67], v[88:91]
v_mfma_f32_16x16x32_bf16 v[120:123], a[120:123], a[68:71], v[120:123]
v_mfma_f32_16x16x32_bf16 v[152:155], a[120:123], a[72:75], v[152:155]
v_mfma_f32_16x16x32_bf16 v[184:187], a[120:123], a[76:79], v[184:187]
v_mfma_f32_16x16x32_bf16 v[216:219], a[120:123], a[80:83], v[216:219]
buffer_load_dwordx4 v6, s[8:11], s61 offen offset:2048 lds
v_mfma_f32_16x16x32_bf16 v[248:251], a[120:123], a[84:87], v[248:251]
v_mfma_f32_16x16x32_bf16 a[152:155], a[120:123], a[88:91], a[152:155]
v_mfma_f32_16x16x32_bf16 a[184:187], a[120:123], a[92:95], a[184:187]
v_mfma_f32_16x16x32_bf16 a[188:191], a[124:127], a[92:95], a[188:191]
v_mfma_f32_16x16x32_bf16 a[156:159], a[124:127], a[88:91], a[156:159]
v_mfma_f32_16x16x32_bf16 v[252:255], a[124:127], a[84:87], v[252:255]
v_mfma_f32_16x16x32_bf16 v[220:223], a[124:127], a[80:83], v[220:223]
v_mfma_f32_16x16x32_bf16 v[188:191], a[124:127], a[76:79], v[188:191]
buffer_load_dwordx4 v7, s[8:11], s61 offen offset:3072 lds
s_add_u32 s61, s61, s65
v_mfma_f32_16x16x32_bf16 v[156:159], a[124:127], a[72:75], v[156:159]
v_mfma_f32_16x16x32_bf16 v[124:127], a[124:127], a[68:71], v[124:127]
v_mfma_f32_16x16x32_bf16 v[92:95], a[124:127], a[64:67], v[92:95]
s_sub_u32 s62, s62, 1
s_cmp_lg_u32 s62, 0
s_cbranch_scc1 Lgl_6
s_waitcnt vmcnt(16) lgkmcnt(0)
s_barrier
v_mfma_f32_16x16x32_bf16 v[64:67], a[32:35], a[0:3], v[64:67]
ds_read_b128 a[64:67], v8 offset:16384
v_mfma_f32_16x16x32_bf16 v[96:99], a[32:35], a[4:7], v[96:99]
v_mfma_f32_16x16x32_bf16 v[128:131], a[32:35], a[8:11], v[128:131]
ds_read_b64_tr_b16 a[96:97], v10 offset:16384
v_mfma_f32_16x16x32_bf16 v[160:163], a[32:35], a[12:15], v[160:163]
v_mfma_f32_16x16x32_bf16 v[192:195], a[32:35], a[16:19], v[192:195]
ds_read_b64_tr_b16 a[98:99], v10 offset:20480
v_mfma_f32_16x16x32_bf16 v[224:227], a[32:35], a[20:23], v[224:227]
v_mfma_f32_16x16x32_bf16 a[128:131], a[32:35], a[24:27], a[128:131]
ds_read_b128 a[68:71], v8 offset:17408
v_mfma_f32_16x16x32_bf16 a[160:163], a[32:35], a[28:31], a[160:163]
v_mfma_f32_16x16x32_bf16 a[164:167], a[36:39], a[28:31], a[164:167]
ds_read_b64_tr_b16 a[100:101], v11 offset:16384
v_mfma_f32_16x16x32_bf16 a[132:135], a[36:39], a[24:27], a[132:135]
v_mfma_f32_16x16x32_bf16 v[228:231], a[36:39], a[20:23], v[228:231]
ds_read_b64_tr_b16 a[102:103], v11 offset:20480
v_mfma_f32_16x16x32_bf16 v[196:199], a[36:39], a[16:19], v[196:199]
v_mfma_f32_16x16x32_bf16 v[164:167], a[36:39], a[12:15], v[164:167]
ds_read_b128 a[72:75], v8 offset:18432
v_mfma_f32_16x16x32_bf16 v[132:135], a[36:39], a[8:11], v[132:135]
v_mfma_f32_16x16x32_bf16 v[100:103], a[36:39], a[4:7], v[100:103]
ds_read_b64_tr_b16 a[104:105], v12 offset:16384
v_mfma_f32_16x16x32_bf16 v[68:71], a[36:39], a[0:3], v[68:71]
v_mfma_f32_16x16x32_bf16 v[72:75], a[40:43], a[0:3], v[72:75]
ds_read_b64_tr_b16 a[106:107], v12 offset:20480
v_mfma_f32_16x16x32_bf16 v[104:107], a[40:43], a[4:7], v[104:107]
v_mfma_f32_16x16x32_bf16 v[136:139], a[40:43], a[8:11], v[136:139]
ds_read_b128 a[76:79], v8 offset:19456
v_mfma_f32_16x16x32_bf16 v[168:171], a[40:43], a[12:15], v[168:171]
v_mfma_f32_16x16x32_bf16 v[200:203], a[40:43], a[16:19], v[200:203]
ds_read_b64_tr_b16 a[108:109], v13 offset:16384
v_mfma_f32_16x16x32_bf16 v[232:235], a[40:43], a[20:23], v[232:235]
v_mfma_f32_16x16x32_bf16 a[136:139], a[40:43], a[24:27], a[136:139]
ds_read_b64_tr_b16 a[110:111], v13 offset:20480
v_mfma_f32_16x16x32_bf16 a[168:171], a[40:43], a[28:31], a[168:171]
v_mfma_f32_16x16x32_bf16 a[172:175], a[44:47], a[28:31], a[172:175]
ds_read_b128 a[80:83], v8 offset:20480
v_mfma_f32_16x16x32_bf16 a[140:143], a[44:47], a[24:27], a[140:143]
v_mfma_f32_16x16x32_bf16 v[236:239], a[44:47], a[20:23], v[236:239]
ds_read_b64_tr_b16 a[112:113], v14 offset:16384
v_mfma_f32_16x16x32_bf16 v[204:207], a[44:47], a[16:19], v[204:207]
v_mfma_f32_16x16x32_bf16 v[172:175], a[44:47], a[12:15], v[172:175]
ds_read_b64_tr_b16 a[114:115], v14 offset:20480
v_mfma_f32_16x16x32_bf16 v[140:143], a[44:47], a[8:11], v[140:143]
v_mfma_f32_16x16x32_bf16 v[108:111], a[44:47], a[4:7], v[108:111]
ds_read_b128 a[84:87], v8 offset:21504
v_mfma_f32_16x16x32_bf16 v[76:79], a[44:47], a[0:3], v[76:79]
v_mfma_f32_16x16x32_bf16 v[80:83], a[48:51], a[0:3], v[80:83]
ds_read_b64_tr_b16 a[116:117], v15 offset:16384
v_mfma_f32_16x16x32_bf16 v[112:115], a[48:51], a[4:7], v[112:115]
v_mfma_f32_16x16x32_bf16 v[144:147], a[48:51], a[8:11], v[144:147]
ds_read_b64_tr_b16 a[118:119], v15 offset:20480
v_mfma_f32_16x16x32_bf16 v[176:179], a[48:51], a[12:15], v[176:179]
v_mfma_f32_16x16x32_bf16 v[208:211], a[48:51], a[16:19], v[208:211]
ds_read_b128 a[88:91], v8 offset:22528
v_mfma_f32_16x16x32_bf16 v[240:243], a[48:51], a[20:23], v[240:243]
v_mfma_f32_16x16x32_bf16 a[144:147], a[48:51], a[24:27], a[144:147]
ds_read_b64_tr_b16 a[120:121], v16 offset:16384
v_mfma_f32_16x16x32_bf16 a[176:179], a[48:51], a[28:31], a[176:179]
v_mfma_f32_16x16x32_bf16 a[180:183], a[52:55], a[28:31], a[180:183]
ds_read_b64_tr_b16 a[122:123], v16 offset:20480
v_mfma_f32_16x16x32_bf16 a[148:151], a[52:55], a[24:27], a[148:151]
v_mfma_f32_16x16x32_bf16 v[244:247], a[52:55], a[20:23], v[244:247]
ds_read_b128 a[92:95], v8 offset:23552
v_mfma_f32_16x16x32_bf16 v[212:215], a[52:55], a[16:19], v[212:215]
v_mfma_f32_16x16x32_bf16 v[180:183], a[52:55], a[12:15], v[180:183]
ds_read_b64_tr_b16 a[124:125], v17 offset:16384
v_mfma_f32_16x16x32_bf16 v[148:151], a[52:55], a[8:11], v[148:151]
v_mfma_f32_16x16x32_bf16 v[116:119], a[52:55], a[4:7], v[116:119]
ds_read_b64_tr_b16 a[126:127], v17 offset:20480
v_mfma_f32_16x16x32_bf16 v[84:87], a[52:55], a[0:3], v[84:87]
v_mfma_f32_16x16x32_bf16 v[88:91], a[56:59], a[0:3], v[88:91]
v_mfma_f32_16x16x32_bf16 v[120:123], a[56:59], a[4:7], v[120:123]
v_mfma_f32_16x16x32_bf16 v[152:155], a[56:59], a[8:11], v[152:155]
v_mfma_f32_16x16x32_bf16 v[184:187], a[56:59], a[12:15], v[184:187]
v_mfma_f32_16x16x32_bf16 v[216:219], a[56:59], a[16:19], v[216:219]
v_mfma_f32_16x16x32_bf16 v[248:251], a[56:59], a[20:23], v[248:251]
v_mfma_f32_16x16x32_bf16 a[152:155], a[56:59], a[24:27], a[152:155]
v_mfma_f32_16x16x32_bf16 a[184:187], a[56:59], a[28:31], a[184:187]
v_mfma_f32_16x16x32_bf16 a[188:191], a[60:63], a[28:31], a[188:191]
v_mfma_f32_16x16x32_bf16 a[156:159], a[60:63], a[24:27], a[156:159]
v_mfma_f32_16x16x32_bf16 v[252:255], a[60:63], a[20:23], v[252:255]
v_mfma_f32_16x16x32_bf16 v[220:223], a[60:63], a[16:19], v[220:223]
v_mfma_f32_16x16x32_bf16 v[188:191], a[60:63], a[12:15], v[188:191]
v_mfma_f32_16x16x32_bf16 v[156:159], a[60:63], a[8:11], v[156:159]
v_mfma_f32_16x16x32_bf16 v[124:127], a[60:63], a[4:7], v[124:127]
v_mfma_f32_16x16x32_bf16 v[92:95], a[60:63], a[0:3], v[92:95]
s_waitcnt vmcnt(8) lgkmcnt(0)
s_barrier
v_mfma_f32_16x16x32_bf16 v[64:67], a[96:99], a[64:67], v[64:67]
ds_read_b128 a[0:3], v8 offset:32768
v_mfma_f32_16x16x32_bf16 v[96:99], a[96:99], a[68:71], v[96:99]
v_mfma_f32_16x16x32_bf16 v[128:131], a[96:99], a[72:75], v[128:131]
ds_read_b64_tr_b16 a[32:33], v10 offset:32768
v_mfma_f32_16x16x32_bf16 v[160:163], a[96:99], a[76:79], v[160:163]
v_mfma_f32_16x16x32_bf16 v[192:195], a[96:99], a[80:83], v[192:195]
ds_read_b64_tr_b16 a[34:35], v10 offset:36864
v_mfma_f32_16x16x32_bf16 v[224:227], a[96:99], a[84:87], v[224:227]
v_mfma_f32_16x16x32_bf16 a[128:131], a[96:99], a[88:91], a[128:131]
ds_read_b128 a[4:7], v8 offset:33792
v_mfma_f32_16x16x32_bf16 a[160:163], a[96:99], a[92:95], a[160:163]
v_mfma_f32_16x16x32_bf16 a[164:167], a[100:103], a[92:95], a[164:167]
ds_read_b64_tr_b16 a[36:37], v11 offset:32768
v_mfma_f32_16x16x32_bf16 a[132:135], a[100:103], a[88:91], a[132:135]
v_mfma_f32_16x16x32_bf16 v[228:231], a[100:103], a[84:87], v[228:231]
ds_read_b64_tr_b16 a[38:39], v11 offset:36864
v_mfma_f32_16x16x32_bf16 v[196:199], a[100:103], a[80:83], v[196:199]
v_mfma_f32_16x16x32_bf16 v[164:167], a[100:103], a[76:79], v[164:167]
ds_read_b128 a[8:11], v8 offset:34816
v_mfma_f32_16x16x32_bf16 v[132:135], a[100:103], a[72:75], v[132:135]
v_mfma_f32_16x16x32_bf16 v[100:103], a[100:103], a[68:71], v[100:103]
ds_read_b64_tr_b16 a[40:41], v12 offset:32768
v_mfma_f32_16x16x32_bf16 v[68:71], a[100:103], a[64:67], v[68:71]
v_mfma_f32_16x16x32_bf16 v[72:75], a[104:107], a[64:67], v[72:75]
ds_read_b64_tr_b16 a[42:43], v12 offset:36864
v_mfma_f32_16x16x32_bf16 v[104:107], a[104:107], a[68:71], v[104:107]
v_mfma_f32_16x16x32_bf16 v[136:139], a[104:107], a[72:75], v[136:139]
ds_read_b128 a[12:15], v8 offset:35840
v_mfma_f32_16x16x32_bf16 v[168:171], a[104:107], a[76:79], v[168:171]
v_mfma_f32_16x16x32_bf16 v[200:203], a[104:107], a[80:83], v[200:203]
ds_read_b64_tr_b16 a[44:45], v13 offset:32768
v_mfma_f32_16x16x32_bf16 v[232:235], a[104:107], a[84:87], v[232:235]
v_mfma_f32_16x16x32_bf16 a[136:139], a[104:107], a[88:91], a[136:139]
ds_read_b64_tr_b16 a[46:47], v13 offset:36864
v_mfma_f32_16x16x32_bf16 a[168:171], a[104:107], a[92:95], a[168:171]
v_mfma_f32_16x16x32_bf16 a[172:175], a[108:111], a[92:95], a[172:175]
ds_read_b128 a[16:19], v8 offset:36864
v_mfma_f32_16x16x32_bf16 a[140:143], a[108:111], a[88:91], a[140:143]
v_mfma_f32_16x16x32_bf16 v[236:239], a[108:111], a[84:87], v[236:239]
ds_read_b64_tr_b16 a[48:49], v14 offset:32768
v_mfma_f32_16x16x32_bf16 v[204:207], a[108:111], a[80:83], v[204:207]
v_mfma_f32_16x16x32_bf16 v[172:175], a[108:111], a[76:79], v[172:175]
ds_read_b64_tr_b16 a[50:51], v14 offset:36864
v_mfma_f32_16x16x32_bf16 v[140:143], a[108:111], a[72:75], v[140:143]
v_mfma_f32_16x16x32_bf16 v[108:111], a[108:111], a[68:71], v[108:111]
ds_read_b128 a[20:23], v8 offset:37888
v_mfma_f32_16x16x32_bf16 v[76:79], a[108:111], a[64:67], v[76:79]
v_mfma_f32_16x16x32_bf16 v[80:83], a[112:115], a[64:67], v[80:83]
ds_read_b64_tr_b16 a[52:53], v15 offset:32768
v_mfma_f32_16x16x32_bf16 v[112:115], a[112:115], a[68:71], v[112:115]
v_mfma_f32_16x16x32_bf16 v[144:147], a[112:115], a[72:75], v[144:147]
ds_read_b64_tr_b16 a[54:55], v15 offset:36864
v_mfma_f32_16x16x32_bf16 v[176:179], a[112:115], a[76:79], v[176:179]
v_mfma_f32_16x16x32_bf16 v[208:211], a[112:115], a[80:83], v[208:211]
ds_read_b128 a[24:27], v8 offset:38912
v_mfma_f32_16x16x32_bf16 v[240:243], a[112:115], a[84:87], v[240:243]
v_mfma_f32_16x16x32_bf16 a[144:147], a[112:115], a[88:91], a[144:147]
ds_read_b64_tr_b16 a[56:57], v16 offset:32768
v_mfma_f32_16x16x32_bf16 a[176:179], a[112:115], a[92:95], a[176:179]
v_mfma_f32_16x16x32_bf16 a[180:183], a[116:119], a[92:95], a[180:183]
ds_read_b64_tr_b16 a[58:59], v16 offset:36864
v_mfma_f32_16x16x32_bf16 a[148:151], a[116:119], a[88:91], a[148:151]
v_mfma_f32_16x16x32_bf16 v[244:247], a[116:119], a[84:87], v[244:247]
ds_read_b128 a[28:31], v8 offset:39936
v_mfma_f32_16x16x32_bf16 v[212:215], a[116:119], a[80:83], v[212:215]
v_mfma_f32_16x16x32_bf16 v[180:183], a[116:119], a[76:79], v[180:183]
ds_read_b64_tr_b16 a[60:61], v17 offset:32768
v_mfma_f32_16x16x32_bf16 v[148:151], a[116:119], a[72:75], v[148:151]
v_mfma_f32_16x16x32_bf16 v[116:119], a[116:119], a[68:71], v[116:119]
ds_read_b64_tr_b16 a[62:63], v17 offset:36864
v_mfma_f32_16x16x32_bf16 v[84:87], a[116:119], a[64:67], v[84:87]
v_mfma_f32_16x16x32_bf16 v[88:91], a[120:123], a[64:67], v[88:91]
v_mfma_f32_16x16x32_bf16 v[120:123], a[120:123], a[68:71], v[120:123]
v_mfma_f32_16x16x32_bf16 v[152:155], a[120:123], a[72:75], v[152:155]
v_mfma_f32_16x16x32_bf16 v[184:187], a[120:123], a[76:79], v[184:187]
v_mfma_f32_16x16x32_bf16 v[216:219], a[120:123], a[80:83], v[216:219]
v_mfma_f32_16x16x32_bf16 v[248:251], a[120:123], a[84:87], v[248:251]
v_mfma_f32_16x16x32_bf16 a[152:155], a[120:123], a[88:91], a[152:155]
v_mfma_f32_16x16x32_bf16 a[184:187], a[120:123], a[92:95], a[184:187]
v_mfma_f32_16x16x32_bf16 a[188:191], a[124:127], a[92:95], a[188:191]
v_mfma_f32_16x16x32_bf16 a[156:159], a[124:127], a[88:91], a[156:159]
v_mfma_f32_16x16x32_bf16 v[252:255], a[124:127], a[84:87], v[252:255]
v_mfma_f32_16x16x32_bf16 v[220:223], a[124:127], a[80:83], v[220:223]
v_mfma_f32_16x16x32_bf16 v[188:191], a[124:127], a[76:79], v[188:191]
v_mfma_f32_16x16x32_bf16 v[156:159], a[124:127], a[72:75], v[156:159]
v_mfma_f32_16x16x32_bf16 v[124:127], a[124:127], a[68:71], v[124:127]
v_mfma_f32_16x16x32_bf16 v[92:95], a[124:127], a[64:67], v[92:95]
s_waitcnt vmcnt(0) lgkmcnt(0)
s_barrier
v_mfma_f32_16x16x32_bf16 v[64:67], a[32:35], a[0:3], v[64:67]
ds_read_b128 a[64:67], v8 offset:49152
v_mfma_f32_16x16x32_bf16 v[96:99], a[32:35], a[4:7], v[96:99]
v_mfma_f32_16x16x32_bf16 v[128:131], a[32:35], a[8:11], v[128:131]
ds_read_b64_tr_b16 a[96:97], v10 offset:49152
v_mfma_f32_16x16x32_bf16 v[160:163], a[32:35], a[12:15], v[160:163]
v_mfma_f32_16x16x32_bf16 v[192:195], a[32:35], a[16:19], v[192:195]
ds_read_b64_tr_b16 a[98:99], v10 offset:53248
v_mfma_f32_16x16x32_bf16 v[224:227], a[32:35], a[20:23], v[224:227]
v_mfma_f32_16x16x32_bf16 a[128:131], a[32:35], a[24:27], a[128:131]
ds_read_b128 a[68:71], v8 offset:50176
v_mfma_f32_16x16x32_bf16 a[160:163], a[32:35], a[28:31], a[160:163]
v_mfma_f32_16x16x32_bf16 a[164:167], a[36:39], a[28:31], a[164:167]
ds_read_b64_tr_b16 a[100:101], v11 offset:49152
v_mfma_f32_16x16x32_bf16 a[132:135], a[36:39], a[24:27], a[132:135]
v_mfma_f32_16x16x32_bf16 v[228:231], a[36:39], a[20:23], v[228:231]
ds_read_b64_tr_b16 a[102:103], v11 offset:53248
v_mfma_f32_16x16x32_bf16 v[196:199], a[36:39], a[16:19], v[196:199]
v_mfma_f32_16x16x32_bf16 v[164:167], a[36:39], a[12:15], v[164:167]
ds_read_b128 a[72:75], v8 offset:51200
v_mfma_f32_16x16x32_bf16 v[132:135], a[36:39], a[8:11], v[132:135]
v_mfma_f32_16x16x32_bf16 v[100:103], a[36:39], a[4:7], v[100:103]
ds_read_b64_tr_b16 a[104:105], v12 offset:49152
v_mfma_f32_16x16x32_bf16 v[68:71], a[36:39], a[0:3], v[68:71]
v_mfma_f32_16x16x32_bf16 v[72:75], a[40:43], a[0:3], v[72:75]
ds_read_b64_tr_b16 a[106:107], v12 offset:53248
v_mfma_f32_16x16x32_bf16 v[104:107], a[40:43], a[4:7], v[104:107]
v_mfma_f32_16x16x32_bf16 v[136:139], a[40:43], a[8:11], v[136:139]
ds_read_b128 a[76:79], v8 offset:52224
v_mfma_f32_16x16x32_bf16 v[168:171], a[40:43], a[12:15], v[168:171]
v_mfma_f32_16x16x32_bf16 v[200:203], a[40:43], a[16:19], v[200:203]
ds_read_b64_tr_b16 a[108:109], v13 offset:49152
v_mfma_f32_16x16x32_bf16 v[232:235], a[40:43], a[20:23], v[232:235]
v_mfma_f32_16x16x32_bf16 a[136:139], a[40:43], a[24:27], a[136:139]
ds_read_b64_tr_b16 a[110:111], v13 offset:53248
v_mfma_f32_16x16x32_bf16 a[168:171], a[40:43], a[28:31], a[168:171]
v_mfma_f32_16x16x32_bf16 a[172:175], a[44:47], a[28:31], a[172:175]
ds_read_b128 a[80:83], v8 offset:53248
v_mfma_f32_16x16x32_bf16 a[140:143], a[44:47], a[24:27], a[140:143]
v_mfma_f32_16x16x32_bf16 v[236:239], a[44:47], a[20:23], v[236:239]
ds_read_b64_tr_b16 a[112:113], v14 offset:49152
v_mfma_f32_16x16x32_bf16 v[204:207], a[44:47], a[16:19], v[204:207]
v_mfma_f32_16x16x32_bf16 v[172:175], a[44:47], a[12:15], v[172:175]
ds_read_b64_tr_b16 a[114:115], v14 offset:53248
v_mfma_f32_16x16x32_bf16 v[140:143], a[44:47], a[8:11], v[140:143]
v_mfma_f32_16x16x32_bf16 v[108:111], a[44:47], a[4:7], v[108:111]
ds_read_b128 a[84:87], v8 offset:54272
v_mfma_f32_16x16x32_bf16 v[76:79], a[44:47], a[0:3], v[76:79]
v_mfma_f32_16x16x32_bf16 v[80:83], a[48:51], a[0:3], v[80:83]
ds_read_b64_tr_b16 a[116:117], v15 offset:49152
v_mfma_f32_16x16x32_bf16 v[112:115], a[48:51], a[4:7], v[112:115]
v_mfma_f32_16x16x32_bf16 v[144:147], a[48:51], a[8:11], v[144:147]
ds_read_b64_tr_b16 a[118:119], v15 offset:53248
v_mfma_f32_16x16x32_bf16 v[176:179], a[48:51], a[12:15], v[176:179]
v_mfma_f32_16x16x32_bf16 v[208:211], a[48:51], a[16:19], v[208:211]
ds_read_b128 a[88:91], v8 offset:55296
v_mfma_f32_16x16x32_bf16 v[240:243], a[48:51], a[20:23], v[240:243]
v_mfma_f32_16x16x32_bf16 a[144:147], a[48:51], a[24:27], a[144:147]
ds_read_b64_tr_b16 a[120:121], v16 offset:49152
v_mfma_f32_16x16x32_bf16 a[176:179], a[48:51], a[28:31], a[176:179]
v_mfma_f32_16x16x32_bf16 a[180:183], a[52:55], a[28:31], a[180:183]
ds_read_b64_tr_b16 a[122:123], v16 offset:53248
v_mfma_f32_16x16x32_bf16 a[148:151], a[52:55], a[24:27], a[148:151]
v_mfma_f32_16x16x32_bf16 v[244:247], a[52:55], a[20:23], v[244:247]
ds_read_b128 a[92:95], v8 offset:56320
v_mfma_f32_16x16x32_bf16 v[212:215], a[52:55], a[16:19], v[212:215]
v_mfma_f32_16x16x32_bf16 v[180:183], a[52:55], a[12:15], v[180:183]
ds_read_b64_tr_b16 a[124:125], v17 offset:49152
v_mfma_f32_16x16x32_bf16 v[148:151], a[52:55], a[8:11], v[148:151]
v_mfma_f32_16x16x32_bf16 v[116:119], a[52:55], a[4:7], v[116:119]
ds_read_b64_tr_b16 a[126:127], v17 offset:53248
v_mfma_f32_16x16x32_bf16 v[84:87], a[52:55], a[0:3], v[84:87]
v_mfma_f32_16x16x32_bf16 v[88:91], a[56:59], a[0:3], v[88:91]
v_mfma_f32_16x16x32_bf16 v[120:123], a[56:59], a[4:7], v[120:123]
v_mfma_f32_16x16x32_bf16 v[152:155], a[56:59], a[8:11], v[152:155]
v_mfma_f32_16x16x32_bf16 v[184:187], a[56:59], a[12:15], v[184:187]
v_mfma_f32_16x16x32_bf16 v[216:219], a[56:59], a[16:19], v[216:219]
v_mfma_f32_16x16x32_bf16 v[248:251], a[56:59], a[20:23], v[248:251]
v_mfma_f32_16x16x32_bf16 a[152:155], a[56:59], a[24:27], a[152:155]
v_mfma_f32_16x16x32_bf16 a[184:187], a[56:59], a[28:31], a[184:187]
v_mfma_f32_16x16x32_bf16 a[188:191], a[60:63], a[28:31], a[188:191]
v_mfma_f32_16x16x32_bf16 a[156:159], a[60:63], a[24:27], a[156:159]
v_mfma_f32_16x16x32_bf16 v[252:255], a[60:63], a[20:23], v[252:255]
v_mfma_f32_16x16x32_bf16 v[220:223], a[60:63], a[16:19], v[220:223]
v_mfma_f32_16x16x32_bf16 v[188:191], a[60:63], a[12:15], v[188:191]
v_mfma_f32_16x16x32_bf16 v[156:159], a[60:63], a[8:11], v[156:159]
v_mfma_f32_16x16x32_bf16 v[124:127], a[60:63], a[4:7], v[124:127]
v_mfma_f32_16x16x32_bf16 v[92:95], a[60:63], a[0:3], v[92:95]
s_waitcnt lgkmcnt(0)
v_mfma_f32_16x16x32_bf16 v[64:67], a[96:99], a[64:67], v[64:67]
v_mfma_f32_16x16x32_bf16 v[96:99], a[96:99], a[68:71], v[96:99]
v_mfma_f32_16x16x32_bf16 v[128:131], a[96:99], a[72:75], v[128:131]
v_mfma_f32_16x16x32_bf16 v[160:163], a[96:99], a[76:79], v[160:163]
v_mfma_f32_16x16x32_bf16 v[192:195], a[96:99], a[80:83], v[192:195]
v_mfma_f32_16x16x32_bf16 v[224:227], a[96:99], a[84:87], v[224:227]
v_mfma_f32_16x16x32_bf16 a[128:131], a[96:99], a[88:91], a[128:131]
v_mfma_f32_16x16x32_bf16 a[160:163], a[96:99], a[92:95], a[160:163]
v_mfma_f32_16x16x32_bf16 a[164:167], a[100:103], a[92:95], a[164:167]
v_mfma_f32_16x16x32_bf16 a[132:135], a[100:103], a[88:91], a[132:135]
v_mfma_f32_16x16x32_bf16 v[228:231], a[100:103], a[84:87], v[228:231]
v_mfma_f32_16x16x32_bf16 v[196:199], a[100:103], a[80:83], v[196:199]
v_mfma_f32_16x16x32_bf16 v[164:167], a[100:103], a[76:79], v[164:167]
v_mfma_f32_16x16x32_bf16 v[132:135], a[100:103], a[72:75], v[132:135]
v_mfma_f32_16x16x32_bf16 v[100:103], a[100:103], a[68:71], v[100:103]
v_mfma_f32_16x16x32_bf16 v[68:71], a[100:103], a[64:67], v[68:71]
v_mfma_f32_16x16x32_bf16 v[72:75], a[104:107], a[64:67], v[72:75]
v_mfma_f32_16x16x32_bf16 v[104:107], a[104:107], a[68:71], v[104:107]
v_mfma_f32_16x16x32_bf16 v[136:139], a[104:107], a[72:75], v[136:139]
v_mfma_f32_16x16x32_bf16 v[168:171], a[104:107], a[76:79], v[168:171]
v_mfma_f32_16x16x32_bf16 v[200:203], a[104:107], a[80:83], v[200:203]
v_mfma_f32_16x16x32_bf16 v[232:235], a[104:107], a[84:87], v[232:235]
v_mfma_f32_16x16x32_bf16 a[136:139], a[104:107], a[88:91], a[136:139]
v_mfma_f32_16x16x32_bf16 a[168:171], a[104:107], a[92:95], a[168:171]
v_mfma_f32_16x16x32_bf16 a[172:175], a[108:111], a[92:95], a[172:175]
v_mfma_f32_16x16x32_bf16 a[140:143], a[108:111], a[88:91], a[140:143]
v_mfma_f32_16x16x32_bf16 v[236:239], a[108:111], a[84:87], v[236:239]
v_mfma_f32_16x16x32_bf16 v[204:207], a[108:111], a[80:83], v[204:207]
v_mfma_f32_16x16x32_bf16 v[172:175], a[108:111], a[76:79], v[172:175]
v_mfma_f32_16x16x32_bf16 v[140:143], a[108:111], a[72:75], v[140:143]
v_mfma_f32_16x16x32_bf16 v[108:111], a[108:111], a[68:71], v[108:111]
v_mfma_f32_16x16x32_bf16 v[76:79], a[108:111], a[64:67], v[76:79]
v_mfma_f32_16x16x32_bf16 v[80:83], a[112:115], a[64:67], v[80:83]
v_mfma_f32_16x16x32_bf16 v[112:115], a[112:115], a[68:71], v[112:115]
v_mfma_f32_16x16x32_bf16 v[144:147], a[112:115], a[72:75], v[144:147]
v_mfma_f32_16x16x32_bf16 v[176:179], a[112:115], a[76:79], v[176:179]
v_mfma_f32_16x16x32_bf16 v[208:211], a[112:115], a[80:83], v[208:211]
v_mfma_f32_16x16x32_bf16 v[240:243], a[112:115], a[84:87], v[240:243]
v_mfma_f32_16x16x32_bf16 a[144:147], a[112:115], a[88:91], a[144:147]
v_mfma_f32_16x16x32_bf16 a[176:179], a[112:115], a[92:95], a[176:179]
v_mfma_f32_16x16x32_bf16 a[180:183], a[116:119], a[92:95], a[180:183]
v_mfma_f32_16x16x32_bf16 a[148:151], a[116:119], a[88:91], a[148:151]
v_mfma_f32_16x16x32_bf16 v[244:247], a[116:119], a[84:87], v[244:247]
v_mfma_f32_16x16x32_bf16 v[212:215], a[116:119], a[80:83], v[212:215]
v_mfma_f32_16x16x32_bf16 v[180:183], a[116:119], a[76:79], v[180:183]
v_mfma_f32_16x16x32_bf16 v[148:151], a[116:119], a[72:75], v[148:151]
v_mfma_f32_16x16x32_bf16 v[116:119], a[116:119], a[68:71], v[116:119]
v_mfma_f32_16x16x32_bf16 v[84:87], a[116:119], a[64:67], v[84:87]
v_mfma_f32_16x16x32_bf16 v[88:91], a[120:123], a[64:67], v[88:91]
v_mfma_f32_16x16x32_bf16 v[120:123], a[120:123], a[68:71], v[120:123]
v_mfma_f32_16x16x32_bf16 v[152:155], a[120:123], a[72:75], v[152:155]
v_mfma_f32_16x16x32_bf16 v[184:187], a[120:123], a[76:79], v[184:187]
v_mfma_f32_16x16x32_bf16 v[216:219], a[120:123], a[80:83], v[216:219]
v_mfma_f32_16x16x32_bf16 v[248:251], a[120:123], a[84:87], v[248:251]
v_mfma_f32_16x16x32_bf16 a[152:155], a[120:123], a[88:91], a[152:155]
v_mfma_f32_16x16x32_bf16 a[184:187], a[120:123], a[92:95], a[184:187]
v_mfma_f32_16x16x32_bf16 a[188:191], a[124:127], a[92:95], a[188:191]
v_mfma_f32_16x16x32_bf16 a[156:159], a[124:127], a[88:91], a[156:159]
v_mfma_f32_16x16x32_bf16 v[252:255], a[124:127], a[84:87], v[252:255]
v_mfma_f32_16x16x32_bf16 v[220:223], a[124:127], a[80:83], v[220:223]
v_mfma_f32_16x16x32_bf16 v[188:191], a[124:127], a[76:79], v[188:191]
v_mfma_f32_16x16x32_bf16 v[156:159], a[124:127], a[72:75], v[156:159]
v_mfma_f32_16x16x32_bf16 v[124:127], a[124:127], a[68:71], v[124:127]
v_mfma_f32_16x16x32_bf16 v[92:95], a[124:127], a[64:67], v[92:95]
v_lshlrev_b32 v24, 4, v1
v_add_u32 v25, 4096, v24
s_nop 7
s_add_u32 s66, s48, 0
v_cvt_pk_bf16_f32 v40, v64, v65
v_cvt_pk_bf16_f32 v41, v66, v67
v_cvt_pk_bf16_f32 v42, v68, v69
v_cvt_pk_bf16_f32 v43, v70, v71
buffer_store_dwordx4 v[40:43], v24, s[4:7], s66 offen offset:0 sc1
v_cvt_pk_bf16_f32 v44, v72, v73
v_cvt_pk_bf16_f32 v45, v74, v75
v_cvt_pk_bf16_f32 v46, v76, v77
v_cvt_pk_bf16_f32 v47, v78, v79
buffer_store_dwordx4 v[44:47], v24, s[4:7], s66 offen offset:1024 sc1
v_cvt_pk_bf16_f32 v48, v80, v81
v_cvt_pk_bf16_f32 v49, v82, v83
v_cvt_pk_bf16_f32 v50, v84, v85
v_cvt_pk_bf16_f32 v51, v86, v87
buffer_store_dwordx4 v[48:51], v24, s[4:7], s66 offen offset:2048 sc1
v_cvt_pk_bf16_f32 v52, v88, v89
v_cvt_pk_bf16_f32 v53, v90, v91
v_cvt_pk_bf16_f32 v54, v92, v93
v_cvt_pk_bf16_f32 v55, v94, v95
buffer_store_dwordx4 v[52:55], v24, s[4:7], s66 offen offset:3072 sc1
v_cvt_pk_bf16_f32 v56, v96, v97
v_cvt_pk_bf16_f32 v57, v98, v99
v_cvt_pk_bf16_f32 v58, v100, v101
v_cvt_pk_bf16_f32 v59, v102, v103
buffer_store_dwordx4 v[56:59], v25, s[4:7], s66 offen offset:0 sc1
v_cvt_pk_bf16_f32 v36, v104, v105
v_cvt_pk_bf16_f32 v37, v106, v107
v_cvt_pk_bf16_f32 v38, v108, v109
v_cvt_pk_bf16_f32 v39, v110, v111
buffer_store_dwordx4 v[36:39], v25, s[4:7], s66 offen offset:1024 sc1
v_cvt_pk_bf16_f32 v40, v112, v113
v_cvt_pk_bf16_f32 v41, v114, v115
v_cvt_pk_bf16_f32 v42, v116, v117
v_cvt_pk_bf16_f32 v43, v118, v119
buffer_store_dwordx4 v[40:43], v25, s[4:7], s66 offen offset:2048 sc1
v_cvt_pk_bf16_f32 v44, v120, v121
v_cvt_pk_bf16_f32 v45, v122, v123
v_cvt_pk_bf16_f32 v46, v124, v125
v_cvt_pk_bf16_f32 v47, v126, v127
buffer_store_dwordx4 v[44:47], v25, s[4:7], s66 offen offset:3072 sc1
s_add_u32 s66, s48, 786432
v_cvt_pk_bf16_f32 v48, v128, v129
v_cvt_pk_bf16_f32 v49, v130, v131
v_cvt_pk_bf16_f32 v50, v132, v133
v_cvt_pk_bf16_f32 v51, v134, v135
buffer_store_dwordx4 v[48:51], v24, s[4:7], s66 offen offset:0 sc1
v_cvt_pk_bf16_f32 v52, v136, v137
v_cvt_pk_bf16_f32 v53, v138, v139
v_cvt_pk_bf16_f32 v54, v140, v141
v_cvt_pk_bf16_f32 v55, v142, v143
buffer_store_dwordx4 v[52:55], v24, s[4:7], s66 offen offset:1024 sc1
v_cvt_pk_bf16_f32 v56, v144, v145
v_cvt_pk_bf16_f32 v57, v146, v147
v_cvt_pk_bf16_f32 v58, v148, v149
v_cvt_pk_bf16_f32 v59, v150, v151
buffer_store_dwordx4 v[56:59], v24, s[4:7], s66 offen offset:2048 sc1
v_cvt_pk_bf16_f32 v36, v152, v153
v_cvt_pk_bf16_f32 v37, v154, v155
v_cvt_pk_bf16_f32 v38, v156, v157
v_cvt_pk_bf16_f32 v39, v158, v159
buffer_store_dwordx4 v[36:39], v24, s[4:7], s66 offen offset:3072 sc1
v_cvt_pk_bf16_f32 v40, v160, v161
v_cvt_pk_bf16_f32 v41, v162, v163
v_cvt_pk_bf16_f32 v42, v164, v165
v_cvt_pk_bf16_f32 v43, v166, v167
buffer_store_dwordx4 v[40:43], v25, s[4:7], s66 offen offset:0 sc1
v_cvt_pk_bf16_f32 v44, v168, v169
v_cvt_pk_bf16_f32 v45, v170, v171
v_cvt_pk_bf16_f32 v46, v172, v173
v_cvt_pk_bf16_f32 v47, v174, v175
buffer_store_dwordx4 v[44:47], v25, s[4:7], s66 offen offset:1024 sc1
v_cvt_pk_bf16_f32 v48, v176, v177
v_cvt_pk_bf16_f32 v49, v178, v179
v_cvt_pk_bf16_f32 v50, v180, v181
v_cvt_pk_bf16_f32 v51, v182, v183
buffer_store_dwordx4 v[48:51], v25, s[4:7], s66 offen offset:2048 sc1
v_cvt_pk_bf16_f32 v52, v184, v185
v_cvt_pk_bf16_f32 v53, v186, v187
v_cvt_pk_bf16_f32 v54, v188, v189
v_cvt_pk_bf16_f32 v55, v190, v191
buffer_store_dwordx4 v[52:55], v25, s[4:7], s66 offen offset:3072 sc1
s_add_u32 s66, s48, 1572864
v_cvt_pk_bf16_f32 v56, v192, v193
v_cvt_pk_bf16_f32 v57, v194, v195
v_cvt_pk_bf16_f32 v58, v196, v197
v_cvt_pk_bf16_f32 v59, v198, v199
buffer_store_dwordx4 v[56:59], v24, s[4:7], s66 offen offset:0 sc1
v_cvt_pk_bf16_f32 v36, v200, v201
v_cvt_pk_bf16_f32 v37, v202, v203
v_cvt_pk_bf16_f32 v38, v204, v205
v_cvt_pk_bf16_f32 v39, v206, v207
buffer_store_dwordx4 v[36:39], v24, s[4:7], s66 offen offset:1024 sc1
v_cvt_pk_bf16_f32 v40, v208, v209
v_cvt_pk_bf16_f32 v41, v210, v211
v_cvt_pk_bf16_f32 v42, v212, v213
v_cvt_pk_bf16_f32 v43, v214, v215
buffer_store_dwordx4 v[40:43], v24, s[4:7], s66 offen offset:2048 sc1
v_cvt_pk_bf16_f32 v44, v216, v217
v_cvt_pk_bf16_f32 v45, v218, v219
v_cvt_pk_bf16_f32 v46, v220, v221
v_cvt_pk_bf16_f32 v47, v222, v223
buffer_store_dwordx4 v[44:47], v24, s[4:7], s66 offen offset:3072 sc1
v_cvt_pk_bf16_f32 v48, v224, v225
v_cvt_pk_bf16_f32 v49, v226, v227
v_cvt_pk_bf16_f32 v50, v228, v229
v_cvt_pk_bf16_f32 v51, v230, v231
buffer_store_dwordx4 v[48:51], v25, s[4:7], s66 offen offset:0 sc1
v_cvt_pk_bf16_f32 v52, v232, v233
v_cvt_pk_bf16_f32 v53, v234, v235
v_cvt_pk_bf16_f32 v54, v236, v237
v_cvt_pk_bf16_f32 v55, v238, v239
buffer_store_dwordx4 v[52:55], v25, s[4:7], s66 offen offset:1024 sc1
v_cvt_pk_bf16_f32 v56, v240, v241
v_cvt_pk_bf16_f32 v57, v242, v243
v_cvt_pk_bf16_f32 v58, v244, v245
v_cvt_pk_bf16_f32 v59, v246, v247
buffer_store_dwordx4 v[56:59], v25, s[4:7], s66 offen offset:2048 sc1
v_cvt_pk_bf16_f32 v36, v248, v249
v_cvt_pk_bf16_f32 v37, v250, v251
v_cvt_pk_bf16_f32 v38, v252, v253
v_cvt_pk_bf16_f32 v39, v254, v255
buffer_store_dwordx4 v[36:39], v25, s[4:7], s66 offen offset:3072 sc1
s_add_u32 s66, s48, 2359296
v_accvgpr_read_b32 v26, a128
v_accvgpr_read_b32 v27, a129
v_accvgpr_read_b32 v28, a130
v_accvgpr_read_b32 v29, a131
v_accvgpr_read_b32 v30, a132
v_accvgpr_read_b32 v31, a133
v_accvgpr_read_b32 v32, a134
v_accvgpr_read_b32 v33, a135
v_cvt_pk_bf16_f32 v40, v26, v27
v_cvt_pk_bf16_f32 v41, v28, v29
v_cvt_pk_bf16_f32 v42, v30, v31
v_cvt_pk_bf16_f32 v43, v32, v33
buffer_store_dwordx4 v[40:43], v24, s[4:7], s66 offen offset:0 sc1
v_accvgpr_read_b32 v26, a136
v_accvgpr_read_b32 v27, a137
v_accvgpr_read_b32 v28, a138
v_accvgpr_read_b32 v29, a139
v_accvgpr_read_b32 v30, a140
v_accvgpr_read_b32 v31, a141
v_accvgpr_read_b32 v32, a142
v_accvgpr_read_b32 v33, a143
v_cvt_pk_bf16_f32 v44, v26, v27
v_cvt_pk_bf16_f32 v45, v28, v29
v_cvt_pk_bf16_f32 v46, v30, v31
v_cvt_pk_bf16_f32 v47, v32, v33
buffer_store_dwordx4 v[44:47], v24, s[4:7], s66 offen offset:1024 sc1
v_accvgpr_read_b32 v26, a144
v_accvgpr_read_b32 v27, a145
v_accvgpr_read_b32 v28, a146
v_accvgpr_read_b32 v29, a147
v_accvgpr_read_b32 v30, a148
v_accvgpr_read_b32 v31, a149
v_accvgpr_read_b32 v32, a150
v_accvgpr_read_b32 v33, a151
v_cvt_pk_bf16_f32 v48, v26, v27
v_cvt_pk_bf16_f32 v49, v28, v29
v_cvt_pk_bf16_f32 v50, v30, v31
v_cvt_pk_bf16_f32 v51, v32, v33
buffer_store_dwordx4 v[48:51], v24, s[4:7], s66 offen offset:2048 sc1
v_accvgpr_read_b32 v26, a152
v_accvgpr_read_b32 v27, a153
v_accvgpr_read_b32 v28, a154
v_accvgpr_read_b32 v29, a155
v_accvgpr_read_b32 v30, a156
v_accvgpr_read_b32 v31, a157
v_accvgpr_read_b32 v32, a158
v_accvgpr_read_b32 v33, a159
v_cvt_pk_bf16_f32 v52, v26, v27
v_cvt_pk_bf16_f32 v53, v28, v29
v_cvt_pk_bf16_f32 v54, v30, v31
v_cvt_pk_bf16_f32 v55, v32, v33
buffer_store_dwordx4 v[52:55], v24, s[4:7], s66 offen offset:3072 sc1
v_accvgpr_read_b32 v26, a160
v_accvgpr_read_b32 v27, a161
v_accvgpr_read_b32 v28, a162
v_accvgpr_read_b32 v29, a163
v_accvgpr_read_b32 v30, a164
v_accvgpr_read_b32 v31, a165
v_accvgpr_read_b32 v32, a166
v_accvgpr_read_b32 v33, a167
v_cvt_pk_bf16_f32 v56, v26, v27
v_cvt_pk_bf16_f32 v57, v28, v29
v_cvt_pk_bf16_f32 v58, v30, v31
v_cvt_pk_bf16_f32 v59, v32, v33
buffer_store_dwordx4 v[56:59], v25, s[4:7], s66 offen offset:0 sc1
v_accvgpr_read_b32 v26, a168
v_accvgpr_read_b32 v27, a169
v_accvgpr_read_b32 v28, a170
v_accvgpr_read_b32 v29, a171
v_accvgpr_read_b32 v30, a172
v_accvgpr_read_b32 v31, a173
v_accvgpr_read_b32 v32, a174
v_accvgpr_read_b32 v33, a175
v_cvt_pk_bf16_f32 v36, v26, v27
v_cvt_pk_bf16_f32 v37, v28, v29
v_cvt_pk_bf16_f32 v38, v30, v31
v_cvt_pk_bf16_f32 v39, v32, v33
buffer_store_dwordx4 v[36:39], v25, s[4:7], s66 offen offset:1024 sc1
v_accvgpr_read_b32 v26, a176
v_accvgpr_read_b32 v27, a177
v_accvgpr_read_b32 v28, a178
v_accvgpr_read_b32 v29, a179
v_accvgpr_read_b32 v30, a180
v_accvgpr_read_b32 v31, a181
v_accvgpr_read_b32 v32, a182
v_accvgpr_read_b32 v33, a183
v_cvt_pk_bf16_f32 v40, v26, v27
v_cvt_pk_bf16_f32 v41, v28, v29
v_cvt_pk_bf16_f32 v42, v30, v31
v_cvt_pk_bf16_f32 v43, v32, v33
buffer_store_dwordx4 v[40:43], v25, s[4:7], s66 offen offset:2048 sc1
v_accvgpr_read_b32 v26, a184
v_accvgpr_read_b32 v27, a185
v_accvgpr_read_b32 v28, a186
v_accvgpr_read_b32 v29, a187
v_accvgpr_read_b32 v30, a188
v_accvgpr_read_b32 v31, a189
v_accvgpr_read_b32 v32, a190
v_accvgpr_read_b32 v33, a191
v_cvt_pk_bf16_f32 v44, v26, v27
v_cvt_pk_bf16_f32 v45, v28, v29
v_cvt_pk_bf16_f32 v46, v30, v31
v_cvt_pk_bf16_f32 v47, v32, v33
buffer_store_dwordx4 v[44:47], v25, s[4:7], s66 offen offset:3072 sc1
s_endpgm
Lisv_5:
s_waitcnt vmcnt(24)
s_barrier
ds_read_b128 a[0:3], v8 offset:0
ds_read_b64_tr_b16 a[32:33], v10 offset:0
ds_read_b64_tr_b16 a[34:35], v10 offset:4096
ds_read_b128 a[4:7], v8 offset:1024
ds_read_b64_tr_b16 a[36:37], v11 offset:0
ds_read_b64_tr_b16 a[38:39], v11 offset:4096
ds_read_b128 a[8:11], v8 offset:2048
ds_read_b64_tr_b16 a[40:41], v12 offset:0
ds_read_b64_tr_b16 a[42:43], v12 offset:4096
ds_read_b128 a[12:15], v8 offset:3072
ds_read_b64_tr_b16 a[44:45], v13 offset:0
ds_read_b64_tr_b16 a[46:47], v13 offset:4096
ds_read_b128 a[16:19], v8 offset:4096
ds_read_b64_tr_b16 a[48:49], v14 offset:0
ds_read_b64_tr_b16 a[50:51], v14 offset:4096
ds_read_b128 a[20:23], v8 offset:5120
ds_read_b64_tr_b16 a[52:53], v15 offset:0
ds_read_b64_tr_b16 a[54:55], v15 offset:4096
ds_read_b128 a[24:27], v8 offset:6144
ds_read_b64_tr_b16 a[56:57], v16 offset:0
ds_read_b64_tr_b16 a[58:59], v16 offset:4096
ds_read_b128 a[28:31], v8 offset:7168
ds_read_b64_tr_b16 a[60:61], v17 offset:0
ds_read_b64_tr_b16 a[62:63], v17 offset:4096
s_waitcnt vmcnt(16) lgkmcnt(0)
s_barrier
v_mfma_f32_16x16x32_bf16 v[64:67], a[0:3], a[32:35], 0
ds_read_b128 a[64:67], v8 offset:16384
v_mfma_f32_16x16x32_bf16 v[96:99], a[4:7], a[32:35], 0
v_mfma_f32_16x16x32_bf16 v[128:131], a[8:11], a[32:35], 0
ds_read_b64_tr_b16 a[96:97], v10 offset:16384
v_mfma_f32_16x16x32_bf16 v[160:163], a[12:15], a[32:35], 0
v_mfma_f32_16x16x32_bf16 v[192:195], a[16:19], a[32:35], 0
ds_read_b64_tr_b16 a[98:99], v10 offset:20480
s_add_u32 m0, s63, 0
s_nop 0
buffer_load_dwordx4 v2, s[4:7], s60 offen offset:0 sc1 lds
v_mfma_f32_16x16x32_bf16 v[224:227], a[20:23], a[32:35], 0
v_mfma_f32_16x16x32_bf16 a[128:131], a[24:27], a[32:35], 0
ds_read_b128 a[68:71], v8 offset:17408
v_mfma_f32_16x16x32_bf16 a[160:163], a[28:31], a[32:35], 0
v_mfma_f32_16x16x32_bf16 a[164:167], a[28:31], a[36:39], 0
ds_read_b64_tr_b16 a[100:101], v11 offset:16384
v_mfma_f32_16x16x32_bf16 a[132:135], a[24:27], a[36:39], 0
v_mfma_f32_16x16x32_bf16 v[228:231], a[20:23], a[36:39], 0
ds_read_b64_tr_b16 a[102:103], v11 offset:20480
v_mfma_f32_16x16x32_bf16 v[196:199], a[16:19], a[36:39], 0
v_mfma_f32_16x16x32_bf16 v[164:167], a[12:15], a[36:39], 0
ds_read_b128 a[72:75], v8 offset:18432
buffer_load_dwordx4 v2, s[4:7], s60 offen offset:1024 sc1 lds
v_mfma_f32_16x16x32_bf16 v[132:135], a[8:11], a[36:39], 0
v_mfma_f32_16x16x32_bf16 v[100:103], a[4:7], a[36:39], 0
ds_read_b64_tr_b16 a[104:105], v12 offset:16384
v_mfma_f32_16x16x32_bf16 v[68:71], a[0:3], a[36:39], 0
v_mfma_f32_16x16x32_bf16 v[72:75], a[0:3], a[40:43], 0
ds_read_b64_tr_b16 a[106:107], v12 offset:20480
v_mfma_f32_16x16x32_bf16 v[104:107], a[4:7], a[40:43], 0
v_mfma_f32_16x16x32_bf16 v[136:139], a[8:11], a[40:43], 0
ds_read_b128 a[76:79], v8 offset:19456
v_mfma_f32_16x16x32_bf16 v[168:171], a[12:15], a[40:43], 0
v_mfma_f32_16x16x32_bf16 v[200:203], a[16:19], a[40:43], 0
ds_read_b64_tr_b16 a[108:109], v13 offset:16384
buffer_load_dwordx4 v2, s[4:7], s60 offen offset:2048 sc1 lds
v_mfma_f32_16x16x32_bf16 v[232:235], a[20:23], a[40:43], 0
v_mfma_f32_16x16x32_bf16 a[136:139], a[24:27], a[40:43], 0
ds_read_b64_tr_b16 a[110:111], v13 offset:20480
v_mfma_f32_16x16x32_bf16 a[168:171], a[28:31], a[40:43], 0
v_mfma_f32_16x16x32_bf16 a[172:175], a[28:31], a[44:47], 0
ds_read_b128 a[80:83], v8 offset:20480
v_mfma_f32_16x16x32_bf16 a[140:143], a[24:27], a[44:47], 0
v_mfma_f32_16x16x32_bf16 v[236:239], a[20:23], a[44:47], 0
ds_read_b64_tr_b16 a[112:113], v14 offset:16384
v_mfma_f32_16x16x32_bf16 v[204:207], a[16:19], a[44:47], 0
v_mfma_f32_16x16x32_bf16 v[172:175], a[12:15], a[44:47], 0
ds_read_b64_tr_b16 a[114:115], v14 offset:20480
buffer_load_dwordx4 v2, s[4:7], s60 offen offset:3072 sc1 lds
s_add_u32 s60, s60, 4096
v_mfma_f32_16x16x32_bf16 v[140:143], a[8:11], a[44:47], 0
v_mfma_f32_16x16x32_bf16 v[108:111], a[4:7], a[44:47], 0
ds_read_b128 a[84:87], v8 offset:21504
v_mfma_f32_16x16x32_bf16 v[76:79], a[0:3], a[44:47], 0
v_mfma_f32_16x16x32_bf16 v[80:83], a[0:3], a[48:51], 0
ds_read_b64_tr_b16 a[116:117], v15 offset:16384
v_mfma_f32_16x16x32_bf16 v[112:115], a[4:7], a[48:51], 0
v_mfma_f32_16x16x32_bf16 v[144:147], a[8:11], a[48:51], 0
ds_read_b64_tr_b16 a[118:119], v15 offset:20480
v_mfma_f32_16x16x32_bf16 v[176:179], a[12:15], a[48:51], 0
v_mfma_f32_16x16x32_bf16 v[208:211], a[16:19], a[48:51], 0
ds_read_b128 a[88:91], v8 offset:22528
s_add_u32 m0, s64, 0
s_nop 0
buffer_load_dwordx4 v4, s[8:11], s61 offen offset:0 lds
v_mfma_f32_16x16x32_bf16 v[240:243], a[20:23], a[48:51], 0
v_mfma_f32_16x16x32_bf16 a[144:147], a[24:27], a[48:51], 0
ds_read_b64_tr_b16 a[120:121], v16 offset:16384
v_mfma_f32_16x16x32_bf16 a[176:179], a[28:31], a[48:51], 0
v_mfma_f32_16x16x32_bf16 a[180:183], a[28:31], a[52:55], 0
ds_read_b64_tr_b16 a[122:123], v16 offset:20480
v_mfma_f32_16x16x32_bf16 a[148:151], a[24:27], a[52:55], 0
v_mfma_f32_16x16x32_bf16 v[244:247], a[20:23], a[52:55], 0
ds_read_b128 a[92:95], v8 offset:23552
v_mfma_f32_16x16x32_bf16 v[212:215], a[16:19], a[52:55], 0
v_mfma_f32_16x16x32_bf16 v[180:183], a[12:15], a[52:55], 0
ds_read_b64_tr_b16 a[124:125], v17 offset:16384
buffer_load_dwordx4 v5, s[8:11], s61 offen offset:1024 lds
v_mfma_f32_16x16x32_bf16 v[148:151], a[8:11], a[52:55], 0
v_mfma_f32_16x16x32_bf16 v[116:119], a[4:7], a[52:55], 0
ds_read_b64_tr_b16 a[126:127], v17 offset:20480
v_mfma_f32_16x16x32_bf16 v[84:87], a[0:3], a[52:55], 0
v_mfma_f32_16x16x32_bf16 v[88:91], a[0:3], a[56:59], 0
v_mfma_f32_16x16x32_bf16 v[120:123], a[4:7], a[56:59], 0
v_mfma_f32_16x16x32_bf16 v[152:155], a[8:11], a[56:59], 0
v_mfma_f32_16x16x32_bf16 v[184:187], a[12:15], a[56:59], 0
v_mfma_f32_16x16x32_bf16 v[216:219], a[16:19], a[56:59], 0
buffer_load_dwordx4 v6, s[8:11], s61 offen offset:2048 lds
v_mfma_f32_16x16x32_bf16 v[248:251], a[20:23], a[56:59], 0
v_mfma_f32_16x16x32_bf16 a[152:155], a[24:27], a[56:59], 0
v_mfma_f32_16x16x32_bf16 a[184:187], a[28:31], a[56:59], 0
v_mfma_f32_16x16x32_bf16 a[188:191], a[28:31], a[60:63], 0
v_mfma_f32_16x16x32_bf16 a[156:159], a[24:27], a[60:63], 0
v_mfma_f32_16x16x32_bf16 v[252:255], a[20:23], a[60:63], 0
v_mfma_f32_16x16x32_bf16 v[220:223], a[16:19], a[60:63], 0
v_mfma_f32_16x16x32_bf16 v[188:191], a[12:15], a[60:63], 0
buffer_load_dwordx4 v7, s[8:11], s61 offen offset:3072 lds
s_add_u32 s61, s61, s65
v_mfma_f32_16x16x32_bf16 v[156:159], a[8:11], a[60:63], 0
v_mfma_f32_16x16x32_bf16 v[124:127], a[4:7], a[60:63], 0
v_mfma_f32_16x16x32_bf16 v[92:95], a[0:3], a[60:63], 0
s_waitcnt vmcnt(16) lgkmcnt(0)
s_barrier
v_mfma_f32_16x16x32_bf16 v[64:67], a[64:67], a[96:99], v[64:67]
ds_read_b128 a[0:3], v8 offset:32768
v_mfma_f32_16x16x32_bf16 v[96:99], a[68:71], a[96:99], v[96:99]
v_mfma_f32_16x16x32_bf16 v[128:131], a[72:75], a[96:99], v[128:131]
ds_read_b64_tr_b16 a[32:33], v10 offset:32768
v_mfma_f32_16x16x32_bf16 v[160:163], a[76:79], a[96:99], v[160:163]
v_mfma_f32_16x16x32_bf16 v[192:195], a[80:83], a[96:99], v[192:195]
ds_read_b64_tr_b16 a[34:35], v10 offset:36864
s_add_u32 m0, s63, 16384
s_nop 0
buffer_load_dwordx4 v2, s[4:7], s60 offen offset:0 sc1 lds
v_mfma_f32_16x16x32_bf16 v[224:227], a[84:87], a[96:99], v[224:227]
v_mfma_f32_16x16x32_bf16 a[128:131], a[88:91], a[96:99], a[128:131]
ds_read_b128 a[4:7], v8 offset:33792
v_mfma_f32_16x16x32_bf16 a[160:163], a[92:95], a[96:99], a[160:163]
v_mfma_f32_16x16x32_bf16 a[164:167], a[92:95], a[100:103], a[164:167]
ds_read_b64_tr_b16 a[36:37], v11 offset:32768
v_mfma_f32_16x16x32_bf16 a[132:135], a[88:91], a[100:103], a[132:135]
v_mfma_f32_16x16x32_bf16 v[228:231], a[84:87], a[100:103], v[228:231]
ds_read_b64_tr_b16 a[38:39], v11 offset:36864
v_mfma_f32_16x16x32_bf16 v[196:199], a[80:83], a[100:103], v[196:199]
v_mfma_f32_16x16x32_bf16 v[164:167], a[76:79], a[100:103], v[164:167]
ds_read_b128 a[8:11], v8 offset:34816
buffer_load_dwordx4 v2, s[4:7], s60 offen offset:1024 sc1 lds
v_mfma_f32_16x16x32_bf16 v[132:135], a[72:75], a[100:103], v[132:135]
v_mfma_f32_16x16x32_bf16 v[100:103], a[68:71], a[100:103], v[100:103]
ds_read_b64_tr_b16 a[40:41], v12 offset:32768
v_mfma_f32_16x16x32_bf16 v[68:71], a[64:67], a[100:103], v[68:71]
v_mfma_f32_16x16x32_bf16 v[72:75], a[64:67], a[104:107], v[72:75]
ds_read_b64_tr_b16 a[42:43], v12 offset:36864
v_mfma_f32_16x16x32_bf16 v[104:107], a[68:71], a[104:107], v[104:107]
v_mfma_f32_16x16x32_bf16 v[136:139], a[72:75], a[104:107], v[136:139]
ds_read_b128 a[12:15], v8 offset:35840
v_mfma_f32_16x16x32_bf16 v[168:171], a[76:79], a[104:107], v[168:171]
v_mfma_f32_16x16x32_bf16 v[200:203], a[80:83], a[104:107], v[200:203]
ds_read_b64_tr_b16 a[44:45], v13 offset:32768
buffer_load_dwordx4 v2, s[4:7], s60 offen offset:2048 sc1 lds
v_mfma_f32_16x16x32_bf16 v[232:235], a[84:87], a[104:107], v[232:235]
v_mfma_f32_16x16x32_bf16 a[136:139], a[88:91], a[104:107], a[136:139]
ds_read_b64_tr_b16 a[46:47], v13 offset:36864
v_mfma_f32_16x16x32_bf16 a[168:171], a[92:95], a[104:107], a[168:171]
v_mfma_f32_16x16x32_bf16 a[172:175], a[92:95], a[108:111], a[172:175]
ds_read_b128 a[16:19], v8 offset:36864
v_mfma_f32_16x16x32_bf16 a[140:143], a[88:91], a[108:111], a[140:143]
v_mfma_f32_16x16x32_bf16 v[236:239], a[84:87], a[108:111], v[236:239]
ds_read_b64_tr_b16 a[48:49], v14 offset:32768
v_mfma_f32_16x16x32_bf16 v[204:207], a[80:83], a[108:111], v[204:207]
v_mfma_f32_16x16x32_bf16 v[172:175], a[76:79], a[108:111], v[172:175]
ds_read_b64_tr_b16 a[50:51], v14 offset:36864
buffer_load_dwordx4 v2, s[4:7], s60 offen offset:3072 sc1 lds
s_add_u32 s60, s60, 4096
v_mfma_f32_16x16x32_bf16 v[140:143], a[72:75], a[108:111], v[140:143]
v_mfma_f32_16x16x32_bf16 v[108:111], a[68:71], a[108:111], v[108:111]
ds_read_b128 a[20:23], v8 offset:37888
v_mfma_f32_16x16x32_bf16 v[76:79], a[64:67], a[108:111], v[76:79]
v_mfma_f32_16x16x32_bf16 v[80:83], a[64:67], a[112:115], v[80:83]
ds_read_b64_tr_b16 a[52:53], v15 offset:32768
v_mfma_f32_16x16x32_bf16 v[112:115], a[68:71], a[112:115], v[112:115]
v_mfma_f32_16x16x32_bf16 v[144:147], a[72:75], a[112:115], v[144:147]
ds_read_b64_tr_b16 a[54:55], v15 offset:36864
v_mfma_f32_16x16x32_bf16 v[176:179], a[76:79], a[112:115], v[176:179]
v_mfma_f32_16x16x32_bf16 v[208:211], a[80:83], a[112:115], v[208:211]
ds_read_b128 a[24:27], v8 offset:38912
s_add_u32 m0, s64, 16384
s_nop 0
buffer_load_dwordx4 v4, s[8:11], s61 offen offset:0 lds
v_mfma_f32_16x16x32_bf16 v[240:243], a[84:87], a[112:115], v[240:243]
v_mfma_f32_16x16x32_bf16 a[144:147], a[88:91], a[112:115], a[144:147]
ds_read_b64_tr_b16 a[56:57], v16 offset:32768
v_mfma_f32_16x16x32_bf16 a[176:179], a[92:95], a[112:115], a[176:179]
v_mfma_f32_16x16x32_bf16 a[180:183], a[92:95], a[116:119], a[180:183]
ds_read_b64_tr_b16 a[58:59], v16 offset:36864
v_mfma_f32_16x16x32_bf16 a[148:151], a[88:91], a[116:119], a[148:151]
v_mfma_f32_16x16x32_bf16 v[244:247], a[84:87], a[116:119], v[244:247]
ds_read_b128 a[28:31], v8 offset:39936
v_mfma_f32_16x16x32_bf16 v[212:215], a[80:83], a[116:119], v[212:215]
v_mfma_f32_16x16x32_bf16 v[180:183], a[76:79], a[116:119], v[180:183]
ds_read_b64_tr_b16 a[60:61], v17 offset:32768
buffer_load_dwordx4 v5, s[8:11], s61 offen offset:1024 lds
v_mfma_f32_16x16x32_bf16 v[148:151], a[72:75], a[116:119], v[148:151]
v_mfma_f32_16x16x32_bf16 v[116:119], a[68:71], a[116:119], v[116:119]
ds_read_b64_tr_b16 a[62:63], v17 offset:36864
v_mfma_f32_16x16x32_bf16 v[84:87], a[64:67], a[116:119], v[84:87]
v_mfma_f32_16x16x32_bf16 v[88:91], a[64:67], a[120:123], v[88:91]
v_mfma_f32_16x16x32_bf16 v[120:123], a[68:71], a[120:123], v[120:123]
v_mfma_f32_16x16x32_bf16 v[152:155], a[72:75], a[120:123], v[152:155]
v_mfma_f32_16x16x32_bf16 v[184:187], a[76:79], a[120:123], v[184:187]
v_mfma_f32_16x16x32_bf16 v[216:219], a[80:83], a[120:123], v[216:219]
buffer_load_dwordx4 v6, s[8:11], s61 offen offset:2048 lds
v_mfma_f32_16x16x32_bf16 v[248:251], a[84:87], a[120:123], v[248:251]
v_mfma_f32_16x16x32_bf16 a[152:155], a[88:91], a[120:123], a[152:155]
v_mfma_f32_16x16x32_bf16 a[184:187], a[92:95], a[120:123], a[184:187]
v_mfma_f32_16x16x32_bf16 a[188:191], a[92:95], a[124:127], a[188:191]
v_mfma_f32_16x16x32_bf16 a[156:159], a[88:91], a[124:127], a[156:159]
v_mfma_f32_16x16x32_bf16 v[252:255], a[84:87], a[124:127], v[252:255]
v_mfma_f32_16x16x32_bf16 v[220:223], a[80:83], a[124:127], v[220:223]
v_mfma_f32_16x16x32_bf16 v[188:191], a[76:79], a[124:127], v[188:191]
buffer_load_dwordx4 v7, s[8:11], s61 offen offset:3072 lds
s_add_u32 s61, s61, s65
v_mfma_f32_16x16x32_bf16 v[156:159], a[72:75], a[124:127], v[156:159]
v_mfma_f32_16x16x32_bf16 v[124:127], a[68:71], a[124:127], v[124:127]
v_mfma_f32_16x16x32_bf16 v[92:95], a[64:67], a[124:127], v[92:95]
s_waitcnt vmcnt(16) lgkmcnt(0)
s_barrier
v_mfma_f32_16x16x32_bf16 v[64:67], a[0:3], a[32:35], v[64:67]
ds_read_b128 a[64:67], v8 offset:49152
v_mfma_f32_16x16x32_bf16 v[96:99], a[4:7], a[32:35], v[96:99]
v_mfma_f32_16x16x32_bf16 v[128:131], a[8:11], a[32:35], v[128:131]
ds_read_b64_tr_b16 a[96:97], v10 offset:49152
v_mfma_f32_16x16x32_bf16 v[160:163], a[12:15], a[32:35], v[160:163]
v_mfma_f32_16x16x32_bf16 v[192:195], a[16:19], a[32:35], v[192:195]
ds_read_b64_tr_b16 a[98:99], v10 offset:53248
s_add_u32 m0, s63, 32768
s_nop 0
buffer_load_dwordx4 v2, s[4:7], s60 offen offset:0 sc1 lds
v_mfma_f32_16x16x32_bf16 v[224:227], a[20:23], a[32:35], v[224:227]
v_mfma_f32_16x16x32_bf16 a[128:131], a[24:27], a[32:35], a[128:131]
ds_read_b128 a[68:71], v8 offset:50176
v_mfma_f32_16x16x32_bf16 a[160:163], a[28:31], a[32:35], a[160:163]
v_mfma_f32_16x16x32_bf16 a[164:167], a[28:31], a[36:39], a[164:167]
ds_read_b64_tr_b16 a[100:101], v11 offset:49152
v_mfma_f32_16x16x32_bf16 a[132:135], a[24:27], a[36:39], a[132:135]
v_mfma_f32_16x16x32_bf16 v[228:231], a[20:23], a[36:39], v[228:231]
ds_read_b64_tr_b16 a[102:103], v11 offset:53248
v_mfma_f32_16x16x32_bf16 v[196:199], a[16:19], a[36:39], v[196:199]
v_mfma_f32_16x16x32_bf16 v[164:167], a[12:15], a[36:39], v[164:167]
ds_read_b128 a[72:75], v8 offset:51200
buffer_load_dwordx4 v2, s[4:7], s60 offen offset:1024 sc1 lds
v_mfma_f32_16x16x32_bf16 v[132:135], a[8:11], a[36:39], v[132:135]
v_mfma_f32_16x16x32_bf16 v[100:103], a[4:7], a[36:39], v[100:103]
ds_read_b64_tr_b16 a[104:105], v12 offset:49152
v_mfma_f32_16x16x32_bf16 v[68:71], a[0:3], a[36:39], v[68:71]
v_mfma_f32_16x16x32_bf16 v[72:75], a[0:3], a[40:43], v[72:75]
ds_read_b64_tr_b16 a[106:107], v12 offset:53248
v_mfma_f32_16x16x32_bf16 v[104:107], a[4:7], a[40:43], v[104:107]
v_mfma_f32_16x16x32_bf16 v[136:139], a[8:11], a[40:43], v[136:139]
ds_read_b128 a[76:79], v8 offset:52224
v_mfma_f32_16x16x32_bf16 v[168:171], a[12:15], a[40:43], v[168:171]
v_mfma_f32_16x16x32_bf16 v[200:203], a[16:19], a[40:43], v[200:203]
ds_read_b64_tr_b16 a[108:109], v13 offset:49152
buffer_load_dwordx4 v2, s[4:7], s60 offen offset:2048 sc1 lds
v_mfma_f32_16x16x32_bf16 v[232:235], a[20:23], a[40:43], v[232:235]
v_mfma_f32_16x16x32_bf16 a[136:139], a[24:27], a[40:43], a[136:139]
ds_read_b64_tr_b16 a[110:111], v13 offset:53248
v_mfma_f32_16x16x32_bf16 a[168:171], a[28:31], a[40:43], a[168:171]
v_mfma_f32_16x16x32_bf16 a[172:175], a[28:31], a[44:47], a[172:175]
ds_read_b128 a[80:83], v8 offset:53248
v_mfma_f32_16x16x32_bf16 a[140:143], a[24:27], a[44:47], a[140:143]
v_mfma_f32_16x16x32_bf16 v[236:239], a[20:23], a[44:47], v[236:239]
ds_read_b64_tr_b16 a[112:113], v14 offset:49152
v_mfma_f32_16x16x32_bf16 v[204:207], a[16:19], a[44:47], v[204:207]
v_mfma_f32_16x16x32_bf16 v[172:175], a[12:15], a[44:47], v[172:175]
ds_read_b64_tr_b16 a[114:115], v14 offset:53248
buffer_load_dwordx4 v2, s[4:7], s60 offen offset:3072 sc1 lds
s_add_u32 s60, s60, 4096
v_mfma_f32_16x16x32_bf16 v[140:143], a[8:11], a[44:47], v[140:143]
v_mfma_f32_16x16x32_bf16 v[108:111], a[4:7], a[44:47], v[108:111]
ds_read_b128 a[84:87], v8 offset:54272
v_mfma_f32_16x16x32_bf16 v[76:79], a[0:3], a[44:47], v[76:79]
v_mfma_f32_16x16x32_bf16 v[80:83], a[0:3], a[48:51], v[80:83]
ds_read_b64_tr_b16 a[116:117], v15 offset:49152
v_mfma_f32_16x16x32_bf16 v[112:115], a[4:7], a[48:51], v[112:115]
v_mfma_f32_16x16x32_bf16 v[144:147], a[8:11], a[48:51], v[144:147]
ds_read_b64_tr_b16 a[118:119], v15 offset:53248
v_mfma_f32_16x16x32_bf16 v[176:179], a[12:15], a[48:51], v[176:179]
v_mfma_f32_16x16x32_bf16 v[208:211], a[16:19], a[48:51], v[208:211]
ds_read_b128 a[88:91], v8 offset:55296
s_add_u32 m0, s64, 32768
s_nop 0
buffer_load_dwordx4 v4, s[8:11], s61 offen offset:0 lds
v_mfma_f32_16x16x32_bf16 v[240:243], a[20:23], a[48:51], v[240:243]
v_mfma_f32_16x16x32_bf16 a[144:147], a[24:27], a[48:51], a[144:147]
ds_read_b64_tr_b16 a[120:121], v16 offset:49152
v_mfma_f32_16x16x32_bf16 a[176:179], a[28:31], a[48:51], a[176:179]
v_mfma_f32_16x16x32_bf16 a[180:183], a[28:31], a[52:55], a[180:183]
ds_read_b64_tr_b16 a[122:123], v16 offset:53248
v_mfma_f32_16x16x32_bf16 a[148:151], a[24:27], a[52:55], a[148:151]
v_mfma_f32_16x16x32_bf16 v[244:247], a[20:23], a[52:55], v[244:247]
ds_read_b128 a[92:95], v8 offset:56320
v_mfma_f32_16x16x32_bf16 v[212:215], a[16:19], a[52:55], v[212:215]
v_mfma_f32_16x16x32_bf16 v[180:183], a[12:15], a[52:55], v[180:183]
ds_read_b64_tr_b16 a[124:125], v17 offset:49152
buffer_load_dwordx4 v5, s[8:11], s61 offen offset:1024 lds
v_mfma_f32_16x16x32_bf16 v[148:151], a[8:11], a[52:55], v[148:151]
v_mfma_f32_16x16x32_bf16 v[116:119], a[4:7], a[52:55], v[116:119]
ds_read_b64_tr_b16 a[126:127], v17 offset:53248
v_mfma_f32_16x16x32_bf16 v[84:87], a[0:3], a[52:55], v[84:87]
v_mfma_f32_16x16x32_bf16 v[88:91], a[0:3], a[56:59], v[88:91]
v_mfma_f32_16x16x32_bf16 v[120:123], a[4:7], a[56:59], v[120:123]
v_mfma_f32_16x16x32_bf16 v[152:155], a[8:11], a[56:59], v[152:155]
v_mfma_f32_16x16x32_bf16 v[184:187], a[12:15], a[56:59], v[184:187]
v_mfma_f32_16x16x32_bf16 v[216:219], a[16:19], a[56:59], v[216:219]
buffer_load_dwordx4 v6, s[8:11], s61 offen offset:2048 lds
v_mfma_f32_16x16x32_bf16 v[248:251], a[20:23], a[56:59], v[248:251]
v_mfma_f32_16x16x32_bf16 a[152:155], a[24:27], a[56:59], a[152:155]
v_mfma_f32_16x16x32_bf16 a[184:187], a[28:31], a[56:59], a[184:187]
v_mfma_f32_16x16x32_bf16 a[188:191], a[28:31], a[60:63], a[188:191]
v_mfma_f32_16x16x32_bf16 a[156:159], a[24:27], a[60:63], a[156:159]
v_mfma_f32_16x16x32_bf16 v[252:255], a[20:23], a[60:63], v[252:255]
v_mfma_f32_16x16x32_bf16 v[220:223], a[16:19], a[60:63], v[220:223]
v_mfma_f32_16x16x32_bf16 v[188:191], a[12:15], a[60:63], v[188:191]
buffer_load_dwordx4 v7, s[8:11], s61 offen offset:3072 lds
s_add_u32 s61, s61, s65
v_mfma_f32_16x16x32_bf16 v[156:159], a[8:11], a[60:63], v[156:159]
v_mfma_f32_16x16x32_bf16 v[124:127], a[4:7], a[60:63], v[124:127]
v_mfma_f32_16x16x32_bf16 v[92:95], a[0:3], a[60:63], v[92:95]
s_waitcnt vmcnt(16) lgkmcnt(0)
s_barrier
v_mfma_f32_16x16x32_bf16 v[64:67], a[64:67], a[96:99], v[64:67]
ds_read_b128 a[0:3], v8 offset:0
v_mfma_f32_16x16x32_bf16 v[96:99], a[68:71], a[96:99], v[96:99]
v_mfma_f32_16x16x32_bf16 v[128:131], a[72:75], a[96:99], v[128:131]
ds_read_b64_tr_b16 a[32:33], v10 offset:0
v_mfma_f32_16x16x32_bf16 v[160:163], a[76:79], a[96:99], v[160:163]
v_mfma_f32_16x16x32_bf16 v[192:195], a[80:83], a[96:99], v[192:195]
ds_read_b64_tr_b16 a[34:35], v10 offset:4096
s_add_u32 m0, s63, 49152
s_nop 0
buffer_load_dwordx4 v2, s[4:7], s60 offen offset:0 sc1 lds
v_mfma_f32_16x16x32_bf16 v[224:227], a[84:87], a[96:99], v[224:227]
v_mfma_f32_16x16x32_bf16 a[128:131], a[88:91], a[96:99], a[128:131]
ds_read_b128 a[4:7], v8 offset:1024
v_mfma_f32_16x16x32_bf16 a[160:163], a[92:95], a[96:99], a[160:163]
v_mfma_f32_16x16x32_bf16 a[164:167], a[92:95], a[100:103], a[164:167]
ds_read_b64_tr_b16 a[36:37], v11 offset:0
v_mfma_f32_16x16x32_bf16 a[132:135], a[88:91], a[100:103], a[132:135]
v_mfma_f32_16x16x32_bf16 v[228:231], a[84:87], a[100:103], v[228:231]
ds_read_b64_tr_b16 a[38:39], v11 offset:4096
v_mfma_f32_16x16x32_bf16 v[196:199], a[80:83], a[100:103], v[196:199]
v_mfma_f32_16x16x32_bf16 v[164:167], a[76:79], a[100:103], v[164:167]
ds_read_b128 a[8:11], v8 offset:2048
buffer_load_dwordx4 v2, s[4:7], s60 offen offset:1024 sc1 lds
v_mfma_f32_16x16x32_bf16 v[132:135], a[72:75], a[100:103], v[132:135]
v_mfma_f32_16x16x32_bf16 v[100:103], a[68:71], a[100:103], v[100:103]
ds_read_b64_tr_b16 a[40:41], v12 offset:0
v_mfma_f32_16x16x32_bf16 v[68:71], a[64:67], a[100:103], v[68:71]
v_mfma_f32_16x16x32_bf16 v[72:75], a[64:67], a[104:107], v[72:75]
ds_read_b64_tr_b16 a[42:43], v12 offset:4096
v_mfma_f32_16x16x32_bf16 v[104:107], a[68:71], a[104:107], v[104:107]
v_mfma_f32_16x16x32_bf16 v[136:139], a[72:75], a[104:107], v[136:139]
ds_read_b128 a[12:15], v8 offset:3072
v_mfma_f32_16x16x32_bf16 v[168:171], a[76:79], a[104:107], v[168:171]
v_mfma_f32_16x16x32_bf16 v[200:203], a[80:83], a[104:107], v[200:203]
ds_read_b64_tr_b16 a[44:45], v13 offset:0
buffer_load_dwordx4 v2, s[4:7], s60 offen offset:2048 sc1 lds
v_mfma_f32_16x16x32_bf16 v[232:235], a[84:87], a[104:107], v[232:235]
v_mfma_f32_16x16x32_bf16 a[136:139], a[88:91], a[104:107], a[136:139]
ds_read_b64_tr_b16 a[46:47], v13 offset:4096
v_mfma_f32_16x16x32_bf16 a[168:171], a[92:95], a[104:107], a[168:171]
v_mfma_f32_16x16x32_bf16 a[172:175], a[92:95], a[108:111], a[172:175]
ds_read_b128 a[16:19], v8 offset:4096
v_mfma_f32_16x16x32_bf16 a[140:143], a[88:91], a[108:111], a[140:143]
v_mfma_f32_16x16x32_bf16 v[236:239], a[84:87], a[108:111], v[236:239]
ds_read_b64_tr_b16 a[48:49], v14 offset:0
v_mfma_f32_16x16x32_bf16 v[204:207], a[80:83], a[108:111], v[204:207]
v_mfma_f32_16x16x32_bf16 v[172:175], a[76:79], a[108:111], v[172:175]
ds_read_b64_tr_b16 a[50:51], v14 offset:4096
buffer_load_dwordx4 v2, s[4:7], s60 offen offset:3072 sc1 lds
s_add_u32 s60, s60, 4096
v_mfma_f32_16x16x32_bf16 v[140:143], a[72:75], a[108:111], v[140:143]
v_mfma_f32_16x16x32_bf16 v[108:111], a[68:71], a[108:111], v[108:111]
ds_read_b128 a[20:23], v8 offset:5120
v_mfma_f32_16x16x32_bf16 v[76:79], a[64:67], a[108:111], v[76:79]
v_mfma_f32_16x16x32_bf16 v[80:83], a[64:67], a[112:115], v[80:83]
ds_read_b64_tr_b16 a[52:53], v15 offset:0
v_mfma_f32_16x16x32_bf16 v[112:115], a[68:71], a[112:115], v[112:115]
v_mfma_f32_16x16x32_bf16 v[144:147], a[72:75], a[112:115], v[144:147]
ds_read_b64_tr_b16 a[54:55], v15 offset:4096
v_mfma_f32_16x16x32_bf16 v[176:179], a[76:79], a[112:115], v[176:179]
v_mfma_f32_16x16x32_bf16 v[208:211], a[80:83], a[112:115], v[208:211]
ds_read_b128 a[24:27], v8 offset:6144
s_add_u32 m0, s64, 49152
s_nop 0
buffer_load_dwordx4 v4, s[8:11], s61 offen offset:0 lds
v_mfma_f32_16x16x32_bf16 v[240:243], a[84:87], a[112:115], v[240:243]
v_mfma_f32_16x16x32_bf16 a[144:147], a[88:91], a[112:115], a[144:147]
ds_read_b64_tr_b16 a[56:57], v16 offset:0
v_mfma_f32_16x16x32_bf16 a[176:179], a[92:95], a[112:115], a[176:179]
v_mfma_f32_16x16x32_bf16 a[180:183], a[92:95], a[116:119], a[180:183]
ds_read_b64_tr_b16 a[58:59], v16 offset:4096
v_mfma_f32_16x16x32_bf16 a[148:151], a[88:91], a[116:119], a[148:151]
v_mfma_f32_16x16x32_bf16 v[244:247], a[84:87], a[116:119], v[244:247]
ds_read_b128 a[28:31], v8 offset:7168
v_mfma_f32_16x16x32_bf16 v[212:215], a[80:83], a[116:119], v[212:215]
v_mfma_f32_16x16x32_bf16 v[180:183], a[76:79], a[116:119], v[180:183]
ds_read_b64_tr_b16 a[60:61], v17 offset:0
buffer_load_dwordx4 v5, s[8:11], s61 offen offset:1024 lds
v_mfma_f32_16x16x32_bf16 v[148:151], a[72:75], a[116:119], v[148:151]
v_mfma_f32_16x16x32_bf16 v[116:119], a[68:71], a[116:119], v[116:119]
ds_read_b64_tr_b16 a[62:63], v17 offset:4096
v_mfma_f32_16x16x32_bf16 v[84:87], a[64:67], a[116:119], v[84:87]
v_mfma_f32_16x16x32_bf16 v[88:91], a[64:67], a[120:123], v[88:91]
v_mfma_f32_16x16x32_bf16 v[120:123], a[68:71], a[120:123], v[120:123]
v_mfma_f32_16x16x32_bf16 v[152:155], a[72:75], a[120:123], v[152:155]
v_mfma_f32_16x16x32_bf16 v[184:187], a[76:79], a[120:123], v[184:187]
v_mfma_f32_16x16x32_bf16 v[216:219], a[80:83], a[120:123], v[216:219]
buffer_load_dwordx4 v6, s[8:11], s61 offen offset:2048 lds
v_mfma_f32_16x16x32_bf16 v[248:251], a[84:87], a[120:123], v[248:251]
v_mfma_f32_16x16x32_bf16 a[152:155], a[88:91], a[120:123], a[152:155]
v_mfma_f32_16x16x32_bf16 a[184:187], a[92:95], a[120:123], a[184:187]
v_mfma_f32_16x16x32_bf16 a[188:191], a[92:95], a[124:127], a[188:191]
v_mfma_f32_16x16x32_bf16 a[156:159], a[88:91], a[124:127], a[156:159]
v_mfma_f32_16x16x32_bf16 v[252:255], a[84:87], a[124:127], v[252:255]
v_mfma_f32_16x16x32_bf16 v[220:223], a[80:83], a[124:127], v[220:223]
v_mfma_f32_16x16x32_bf16 v[188:191], a[76:79], a[124:127], v[188:191]
buffer_load_dwordx4 v7, s[8:11], s61 offen offset:3072 lds
s_add_u32 s61, s61, s65
v_mfma_f32_16x16x32_bf16 v[156:159], a[72:75], a[124:127], v[156:159]
v_mfma_f32_16x16x32_bf16 v[124:127], a[68:71], a[124:127], v[124:127]
v_mfma_f32_16x16x32_bf16 v[92:95], a[64:67], a[124:127], v[92:95]
s_mov_b32 s62, 6
Lgl_7:
s_waitcnt vmcnt(16) lgkmcnt(0)
s_barrier
v_mfma_f32_16x16x32_bf16 v[64:67], a[0:3], a[32:35], v[64:67]
ds_read_b128 a[64:67], v8 offset:16384
v_mfma_f32_16x16x32_bf16 v[96:99], a[4:7], a[32:35], v[96:99]
v_mfma_f32_16x16x32_bf16 v[128:131], a[8:11], a[32:35], v[128:131]
ds_read_b64_tr_b16 a[96:97], v10 offset:16384
v_mfma_f32_16x16x32_bf16 v[160:163], a[12:15], a[32:35], v[160:163]
v_mfma_f32_16x16x32_bf16 v[192:195], a[16:19], a[32:35], v[192:195]
ds_read_b64_tr_b16 a[98:99], v10 offset:20480
s_add_u32 m0, s63, 0
s_nop 0
buffer_load_dwordx4 v2, s[4:7], s60 offen offset:0 sc1 lds
v_mfma_f32_16x16x32_bf16 v[224:227], a[20:23], a[32:35], v[224:227]
v_mfma_f32_16x16x32_bf16 a[128:131], a[24:27], a[32:35], a[128:131]
ds_read_b128 a[68:71], v8 offset:17408
v_mfma_f32_16x16x32_bf16 a[160:163], a[28:31], a[32:35], a[160:163]
v_mfma_f32_16x16x32_bf16 a[164:167], a[28:31], a[36:39], a[164:167]
ds_read_b64_tr_b16 a[100:101], v11 offset:16384
v_mfma_f32_16x16x32_bf16 a[132:135], a[24:27], a[36:39], a[132:135]
v_mfma_f32_16x16x32_bf16 v[228:231], a[20:23], a[36:39], v[228:231]
ds_read_b64_tr_b16 a[102:103], v11 offset:20480
v_mfma_f32_16x16x32_bf16 v[196:199], a[16:19], a[36:39], v[196:199]
v_mfma_f32_16x16x32_bf16 v[164:167], a[12:15], a[36:39], v[164:167]
ds_read_b128 a[72:75], v8 offset:18432
buffer_load_dwordx4 v2, s[4:7], s60 offen offset:1024 sc1 lds
v_mfma_f32_16x16x32_bf16 v[132:135], a[8:11], a[36:39], v[132:135]
v_mfma_f32_16x16x32_bf16 v[100:103], a[4:7], a[36:39], v[100:103]
ds_read_b64_tr_b16 a[104:105], v12 offset:16384
v_mfma_f32_16x16x32_bf16 v[68:71], a[0:3], a[36:39], v[68:71]
v_mfma_f32_16x16x32_bf16 v[72:75], a[0:3], a[40:43], v[72:75]
ds_read_b64_tr_b16 a[106:107], v12 offset:20480
v_mfma_f32_16x16x32_bf16 v[104:107], a[4:7], a[40:43], v[104:107]
v_mfma_f32_16x16x32_bf16 v[136:139], a[8:11], a[40:43], v[136:139]
ds_read_b128 a[76:79], v8 offset:19456
v_mfma_f32_16x16x32_bf16 v[168:171], a[12:15], a[40:43], v[168:171]
v_mfma_f32_16x16x32_bf16 v[200:203], a[16:19], a[40:43], v[200:203]
ds_read_b64_tr_b16 a[108:109], v13 offset:16384
buffer_load_dwordx4 v2, s[4:7], s60 offen offset:2048 sc1 lds
v_mfma_f32_16x16x32_bf16 v[232:235], a[20:23], a[40:43], v[232:235]
v_mfma_f32_16x16x32_bf16 a[136:139], a[24:27], a[40:43], a[136:139]
ds_read_b64_tr_b16 a[110:111], v13 offset:20480
v_mfma_f32_16x16x32_bf16 a[168:171], a[28:31], a[40:43], a[168:171]
v_mfma_f32_16x16x32_bf16 a[172:175], a[28:31], a[44:47], a[172:175]
ds_read_b128 a[80:83], v8 offset:20480
v_mfma_f32_16x16x32_bf16 a[140:143], a[24:27], a[44:47], a[140:143]
v_mfma_f32_16x16x32_bf16 v[236:239], a[20:23], a[44:47], v[236:239]
ds_read_b64_tr_b16 a[112:113], v14 offset:16384
v_mfma_f32_16x16x32_bf16 v[204:207], a[16:19], a[44:47], v[204:207]
v_mfma_f32_16x16x32_bf16 v[172:175], a[12:15], a[44:47], v[172:175]
ds_read_b64_tr_b16 a[114:115], v14 offset:20480
buffer_load_dwordx4 v2, s[4:7], s60 offen offset:3072 sc1 lds
s_add_u32 s60, s60, 4096
v_mfma_f32_16x16x32_bf16 v[140:143], a[8:11], a[44:47], v[140:143]
v_mfma_f32_16x16x32_bf16 v[108:111], a[4:7], a[44:47], v[108:111]
ds_read_b128 a[84:87], v8 offset:21504
v_mfma_f32_16x16x32_bf16 v[76:79], a[0:3], a[44:47], v[76:79]
v_mfma_f32_16x16x32_bf16 v[80:83], a[0:3], a[48:51], v[80:83]
ds_read_b64_tr_b16 a[116:117], v15 offset:16384
v_mfma_f32_16x16x32_bf16 v[112:115], a[4:7], a[48:51], v[112:115]
v_mfma_f32_16x16x32_bf16 v[144:147], a[8:11], a[48:51], v[144:147]
ds_read_b64_tr_b16 a[118:119], v15 offset:20480
v_mfma_f32_16x16x32_bf16 v[176:179], a[12:15], a[48:51], v[176:179]
v_mfma_f32_16x16x32_bf16 v[208:211], a[16:19], a[48:51], v[208:211]
ds_read_b128 a[88:91], v8 offset:22528
s_add_u32 m0, s64, 0
s_nop 0
buffer_load_dwordx4 v4, s[8:11], s61 offen offset:0 lds
v_mfma_f32_16x16x32_bf16 v[240:243], a[20:23], a[48:51], v[240:243]
v_mfma_f32_16x16x32_bf16 a[144:147], a[24:27], a[48:51], a[144:147]
ds_read_b64_tr_b16 a[120:121], v16 offset:16384
v_mfma_f32_16x16x32_bf16 a[176:179], a[28:31], a[48:51], a[176:179]
v_mfma_f32_16x16x32_bf16 a[180:183], a[28:31], a[52:55], a[180:183]
ds_read_b64_tr_b16 a[122:123], v16 offset:20480
v_mfma_f32_16x16x32_bf16 a[148:151], a[24:27], a[52:55], a[148:151]
v_mfma_f32_16x16x32_bf16 v[244:247], a[20:23], a[52:55], v[244:247]
ds_read_b128 a[92:95], v8 offset:23552
v_mfma_f32_16x16x32_bf16 v[212:215], a[16:19], a[52:55], v[212:215]
v_mfma_f32_16x16x32_bf16 v[180:183], a[12:15], a[52:55], v[180:183]
ds_read_b64_tr_b16 a[124:125], v17 offset:16384
buffer_load_dwordx4 v5, s[8:11], s61 offen offset:1024 lds
v_mfma_f32_16x16x32_bf16 v[148:151], a[8:11], a[52:55], v[148:151]
v_mfma_f32_16x16x32_bf16 v[116:119], a[4:7], a[52:55], v[116:119]
ds_read_b64_tr_b16 a[126:127], v17 offset:20480
v_mfma_f32_16x16x32_bf16 v[84:87], a[0:3], a[52:55], v[84:87]
v_mfma_f32_16x16x32_bf16 v[88:91], a[0:3], a[56:59], v[88:91]
v_mfma_f32_16x16x32_bf16 v[120:123], a[4:7], a[56:59], v[120:123]
v_mfma_f32_16x16x32_bf16 v[152:155], a[8:11], a[56:59], v[152:155]
v_mfma_f32_16x16x32_bf16 v[184:187], a[12:15], a[56:59], v[184:187]
v_mfma_f32_16x16x32_bf16 v[216:219], a[16:19], a[56:59], v[216:219]
buffer_load_dwordx4 v6, s[8:11], s61 offen offset:2048 lds
v_mfma_f32_16x16x32_bf16 v[248:251], a[20:23], a[56:59], v[248:251]
v_mfma_f32_16x16x32_bf16 a[152:155], a[24:27], a[56:59], a[152:155]
v_mfma_f32_16x16x32_bf16 a[184:187], a[28:31], a[56:59], a[184:187]
v_mfma_f32_16x16x32_bf16 a[188:191], a[28:31], a[60:63], a[188:191]
v_mfma_f32_16x16x32_bf16 a[156:159], a[24:27], a[60:63], a[156:159]
v_mfma_f32_16x16x32_bf16 v[252:255], a[20:23], a[60:63], v[252:255]
v_mfma_f32_16x16x32_bf16 v[220:223], a[16:19], a[60:63], v[220:223]
v_mfma_f32_16x16x32_bf16 v[188:191], a[12:15], a[60:63], v[188:191]
buffer_load_dwordx4 v7, s[8:11], s61 offen offset:3072 lds
s_add_u32 s61, s61, s65
v_mfma_f32_16x16x32_bf16 v[156:159], a[8:11], a[60:63], v[156:159]
v_mfma_f32_16x16x32_bf16 v[124:127], a[4:7], a[60:63], v[124:127]
v_mfma_f32_16x16x32_bf16 v[92:95], a[0:3], a[60:63], v[92:95]
s_waitcnt vmcnt(16) lgkmcnt(0)
s_barrier
v_mfma_f32_16x16x32_bf16 v[64:67], a[64:67], a[96:99], v[64:67]
ds_read_b128 a[0:3], v8 offset:32768
v_mfma_f32_16x16x32_bf16 v[96:99], a[68:71], a[96:99], v[96:99]
v_mfma_f32_16x16x32_bf16 v[128:131], a[72:75], a[96:99], v[128:131]
ds_read_b64_tr_b16 a[32:33], v10 offset:32768
v_mfma_f32_16x16x32_bf16 v[160:163], a[76:79], a[96:99], v[160:163]
v_mfma_f32_16x16x32_bf16 v[192:195], a[80:83], a[96:99], v[192:195]
ds_read_b64_tr_b16 a[34:35], v10 offset:36864
s_add_u32 m0, s63, 16384
s_nop 0
buffer_load_dwordx4 v2, s[4:7], s60 offen offset:0 sc1 lds
v_mfma_f32_16x16x32_bf16 v[224:227], a[84:87], a[96:99], v[224:227]
v_mfma_f32_16x16x32_bf16 a[128:131], a[88:91], a[96:99], a[128:131]
ds_read_b128 a[4:7], v8 offset:33792
v_mfma_f32_16x16x32_bf16 a[160:163], a[92:95], a[96:99], a[160:163]
v_mfma_f32_16x16x32_bf16 a[164:167], a[92:95], a[100:103], a[164:167]
ds_read_b64_tr_b16 a[36:37], v11 offset:32768
v_mfma_f32_16x16x32_bf16 a[132:135], a[88:91], a[100:103], a[132:135]
v_mfma_f32_16x16x32_bf16 v[228:231], a[84:87], a[100:103], v[228:231]
ds_read_b64_tr_b16 a[38:39], v11 offset:36864
v_mfma_f32_16x16x32_bf16 v[196:199], a[80:83], a[100:103], v[196:199]
v_mfma_f32_16x16x32_bf16 v[164:167], a[76:79], a[100:103], v[164:167]
ds_read_b128 a[8:11], v8 offset:34816
buffer_load_dwordx4 v2, s[4:7], s60 offen offset:1024 sc1 lds
v_mfma_f32_16x16x32_bf16 v[132:135], a[72:75], a[100:103], v[132:135]
v_mfma_f32_16x16x32_bf16 v[100:103], a[68:71], a[100:103], v[100:103]
ds_read_b64_tr_b16 a[40:41], v12 offset:32768
v_mfma_f32_16x16x32_bf16 v[68:71], a[64:67], a[100:103], v[68:71]
v_mfma_f32_16x16x32_bf16 v[72:75], a[64:67], a[104:107], v[72:75]
ds_read_b64_tr_b16 a[42:43], v12 offset:36864
v_mfma_f32_16x16x32_bf16 v[104:107], a[68:71], a[104:107], v[104:107]
v_mfma_f32_16x16x32_bf16 v[136:139], a[72:75], a[104:107], v[136:139]
ds_read_b128 a[12:15], v8 offset:35840
v_mfma_f32_16x16x32_bf16 v[168:171], a[76:79], a[104:107], v[168:171]
v_mfma_f32_16x16x32_bf16 v[200:203], a[80:83], a[104:107], v[200:203]
ds_read_b64_tr_b16 a[44:45], v13 offset:32768
buffer_load_dwordx4 v2, s[4:7], s60 offen offset:2048 sc1 lds
v_mfma_f32_16x16x32_bf16 v[232:235], a[84:87], a[104:107], v[232:235]
v_mfma_f32_16x16x32_bf16 a[136:139], a[88:91], a[104:107], a[136:139]
ds_read_b64_tr_b16 a[46:47], v13 offset:36864
v_mfma_f32_16x16x32_bf16 a[168:171], a[92:95], a[104:107], a[168:171]
v_mfma_f32_16x16x32_bf16 a[172:175], a[92:95], a[108:111], a[172:175]
ds_read_b128 a[16:19], v8 offset:36864
v_mfma_f32_16x16x32_bf16 a[140:143], a[88:91], a[108:111], a[140:143]
v_mfma_f32_16x16x32_bf16 v[236:239], a[84:87], a[108:111], v[236:239]
ds_read_b64_tr_b16 a[48:49], v14 offset:32768
v_mfma_f32_16x16x32_bf16 v[204:207], a[80:83], a[108:111], v[204:207]
v_mfma_f32_16x16x32_bf16 v[172:175], a[76:79], a[108:111], v[172:175]
ds_read_b64_tr_b16 a[50:51], v14 offset:36864
buffer_load_dwordx4 v2, s[4:7], s60 offen offset:3072 sc1 lds
s_add_u32 s60, s60, 4096
v_mfma_f32_16x16x32_bf16 v[140:143], a[72:75], a[108:111], v[140:143]
v_mfma_f32_16x16x32_bf16 v[108:111], a[68:71], a[108:111], v[108:111]
ds_read_b128 a[20:23], v8 offset:37888
v_mfma_f32_16x16x32_bf16 v[76:79], a[64:67], a[108:111], v[76:79]
v_mfma_f32_16x16x32_bf16 v[80:83], a[64:67], a[112:115], v[80:83]
ds_read_b64_tr_b16 a[52:53], v15 offset:32768
v_mfma_f32_16x16x32_bf16 v[112:115], a[68:71], a[112:115], v[112:115]
v_mfma_f32_16x16x32_bf16 v[144:147], a[72:75], a[112:115], v[144:147]
ds_read_b64_tr_b16 a[54:55], v15 offset:36864
v_mfma_f32_16x16x32_bf16 v[176:179], a[76:79], a[112:115], v[176:179]
v_mfma_f32_16x16x32_bf16 v[208:211], a[80:83], a[112:115], v[208:211]
ds_read_b128 a[24:27], v8 offset:38912
s_add_u32 m0, s64, 16384
s_nop 0
buffer_load_dwordx4 v4, s[8:11], s61 offen offset:0 lds
v_mfma_f32_16x16x32_bf16 v[240:243], a[84:87], a[112:115], v[240:243]
v_mfma_f32_16x16x32_bf16 a[144:147], a[88:91], a[112:115], a[144:147]
ds_read_b64_tr_b16 a[56:57], v16 offset:32768
v_mfma_f32_16x16x32_bf16 a[176:179], a[92:95], a[112:115], a[176:179]
v_mfma_f32_16x16x32_bf16 a[180:183], a[92:95], a[116:119], a[180:183]
ds_read_b64_tr_b16 a[58:59], v16 offset:36864
v_mfma_f32_16x16x32_bf16 a[148:151], a[88:91], a[116:119], a[148:151]
v_mfma_f32_16x16x32_bf16 v[244:247], a[84:87], a[116:119], v[244:247]
ds_read_b128 a[28:31], v8 offset:39936
v_mfma_f32_16x16x32_bf16 v[212:215], a[80:83], a[116:119], v[212:215]
v_mfma_f32_16x16x32_bf16 v[180:183], a[76:79], a[116:119], v[180:183]
ds_read_b64_tr_b16 a[60:61], v17 offset:32768
buffer_load_dwordx4 v5, s[8:11], s61 offen offset:1024 lds
v_mfma_f32_16x16x32_bf16 v[148:151], a[72:75], a[116:119], v[148:151]
v_mfma_f32_16x16x32_bf16 v[116:119], a[68:71], a[116:119], v[116:119]
ds_read_b64_tr_b16 a[62:63], v17 offset:36864
v_mfma_f32_16x16x32_bf16 v[84:87], a[64:67], a[116:119], v[84:87]
v_mfma_f32_16x16x32_bf16 v[88:91], a[64:67], a[120:123], v[88:91]
v_mfma_f32_16x16x32_bf16 v[120:123], a[68:71], a[120:123], v[120:123]
v_mfma_f32_16x16x32_bf16 v[152:155], a[72:75], a[120:123], v[152:155]
v_mfma_f32_16x16x32_bf16 v[184:187], a[76:79], a[120:123], v[184:187]
v_mfma_f32_16x16x32_bf16 v[216:219], a[80:83], a[120:123], v[216:219]
buffer_load_dwordx4 v6, s[8:11], s61 offen offset:2048 lds
v_mfma_f32_16x16x32_bf16 v[248:251], a[84:87], a[120:123], v[248:251]
v_mfma_f32_16x16x32_bf16 a[152:155], a[88:91], a[120:123], a[152:155]
v_mfma_f32_16x16x32_bf16 a[184:187], a[92:95], a[120:123], a[184:187]
v_mfma_f32_16x16x32_bf16 a[188:191], a[92:95], a[124:127], a[188:191]
v_mfma_f32_16x16x32_bf16 a[156:159], a[88:91], a[124:127], a[156:159]
v_mfma_f32_16x16x32_bf16 v[252:255], a[84:87], a[124:127], v[252:255]
v_mfma_f32_16x16x32_bf16 v[220:223], a[80:83], a[124:127], v[220:223]
v_mfma_f32_16x16x32_bf16 v[188:191], a[76:79], a[124:127], v[188:191]
buffer_load_dwordx4 v7, s[8:11], s61 offen offset:3072 lds
s_add_u32 s61, s61, s65
v_mfma_f32_16x16x32_bf16 v[156:159], a[72:75], a[124:127], v[156:159]
v_mfma_f32_16x16x32_bf16 v[124:127], a[68:71], a[124:127], v[124:127]
v_mfma_f32_16x16x32_bf16 v[92:95], a[64:67], a[124:127], v[92:95]
s_waitcnt vmcnt(16) lgkmcnt(0)
s_barrier
v_mfma_f32_16x16x32_bf16 v[64:67], a[0:3], a[32:35], v[64:67]
ds_read_b128 a[64:67], v8 offset:49152
v_mfma_f32_16x16x32_bf16 v[96:99], a[4:7], a[32:35], v[96:99]
v_mfma_f32_16x16x32_bf16 v[128:131], a[8:11], a[32:35], v[128:131]
ds_read_b64_tr_b16 a[96:97], v10 offset:49152
v_mfma_f32_16x16x32_bf16 v[160:163], a[12:15], a[32:35], v[160:163]
v_mfma_f32_16x16x32_bf16 v[192:195], a[16:19], a[32:35], v[192:195]
ds_read_b64_tr_b16 a[98:99], v10 offset:53248
s_add_u32 m0, s63, 32768
s_nop 0
buffer_load_dwordx4 v2, s[4:7], s60 offen offset:0 sc1 lds
v_mfma_f32_16x16x32_bf16 v[224:227], a[20:23], a[32:35], v[224:227]
v_mfma_f32_16x16x32_bf16 a[128:131], a[24:27], a[32:35], a[128:131]
ds_read_b128 a[68:71], v8 offset:50176
v_mfma_f32_16x16x32_bf16 a[160:163], a[28:31], a[32:35], a[160:163]
v_mfma_f32_16x16x32_bf16 a[164:167], a[28:31], a[36:39], a[164:167]
ds_read_b64_tr_b16 a[100:101], v11 offset:49152
v_mfma_f32_16x16x32_bf16 a[132:135], a[24:27], a[36:39], a[132:135]
v_mfma_f32_16x16x32_bf16 v[228:231], a[20:23], a[36:39], v[228:231]
ds_read_b64_tr_b16 a[102:103], v11 offset:53248
v_mfma_f32_16x16x32_bf16 v[196:199], a[16:19], a[36:39], v[196:199]
v_mfma_f32_16x16x32_bf16 v[164:167], a[12:15], a[36:39], v[164:167]
ds_read_b128 a[72:75], v8 offset:51200
buffer_load_dwordx4 v2, s[4:7], s60 offen offset:1024 sc1 lds
v_mfma_f32_16x16x32_bf16 v[132:135], a[8:11], a[36:39], v[132:135]
v_mfma_f32_16x16x32_bf16 v[100:103], a[4:7], a[36:39], v[100:103]
ds_read_b64_tr_b16 a[104:105], v12 offset:49152
v_mfma_f32_16x16x32_bf16 v[68:71], a[0:3], a[36:39], v[68:71]
v_mfma_f32_16x16x32_bf16 v[72:75], a[0:3], a[40:43], v[72:75]
ds_read_b64_tr_b16 a[106:107], v12 offset:53248
v_mfma_f32_16x16x32_bf16 v[104:107], a[4:7], a[40:43], v[104:107]
v_mfma_f32_16x16x32_bf16 v[136:139], a[8:11], a[40:43], v[136:139]
ds_read_b128 a[76:79], v8 offset:52224
v_mfma_f32_16x16x32_bf16 v[168:171], a[12:15], a[40:43], v[168:171]
v_mfma_f32_16x16x32_bf16 v[200:203], a[16:19], a[40:43], v[200:203]
ds_read_b64_tr_b16 a[108:109], v13 offset:49152
buffer_load_dwordx4 v2, s[4:7], s60 offen offset:2048 sc1 lds
v_mfma_f32_16x16x32_bf16 v[232:235], a[20:23], a[40:43], v[232:235]
v_mfma_f32_16x16x32_bf16 a[136:139], a[24:27], a[40:43], a[136:139]
ds_read_b64_tr_b16 a[110:111], v13 offset:53248
v_mfma_f32_16x16x32_bf16 a[168:171], a[28:31], a[40:43], a[168:171]
v_mfma_f32_16x16x32_bf16 a[172:175], a[28:31], a[44:47], a[172:175]
ds_read_b128 a[80:83], v8 offset:53248
v_mfma_f32_16x16x32_bf16 a[140:143], a[24:27], a[44:47], a[140:143]
v_mfma_f32_16x16x32_bf16 v[236:239], a[20:23], a[44:47], v[236:239]
ds_read_b64_tr_b16 a[112:113], v14 offset:49152
v_mfma_f32_16x16x32_bf16 v[204:207], a[16:19], a[44:47], v[204:207]
v_mfma_f32_16x16x32_bf16 v[172:175], a[12:15], a[44:47], v[172:175]
ds_read_b64_tr_b16 a[114:115], v14 offset:53248
buffer_load_dwordx4 v2, s[4:7], s60 offen offset:3072 sc1 lds
s_add_u32 s60, s60, 4096
v_mfma_f32_16x16x32_bf16 v[140:143], a[8:11], a[44:47], v[140:143]
v_mfma_f32_16x16x32_bf16 v[108:111], a[4:7], a[44:47], v[108:111]
ds_read_b128 a[84:87], v8 offset:54272
v_mfma_f32_16x16x32_bf16 v[76:79], a[0:3], a[44:47], v[76:79]
v_mfma_f32_16x16x32_bf16 v[80:83], a[0:3], a[48:51], v[80:83]
ds_read_b64_tr_b16 a[116:117], v15 offset:49152
v_mfma_f32_16x16x32_bf16 v[112:115], a[4:7], a[48:51], v[112:115]
v_mfma_f32_16x16x32_bf16 v[144:147], a[8:11], a[48:51], v[144:147]
ds_read_b64_tr_b16 a[118:119], v15 offset:53248
v_mfma_f32_16x16x32_bf16 v[176:179], a[12:15], a[48:51], v[176:179]
v_mfma_f32_16x16x32_bf16 v[208:211], a[16:19], a[48:51], v[208:211]
ds_read_b128 a[88:91], v8 offset:55296
s_add_u32 m0, s64, 32768
s_nop 0
buffer_load_dwordx4 v4, s[8:11], s61 offen offset:0 lds
v_mfma_f32_16x16x32_bf16 v[240:243], a[20:23], a[48:51], v[240:243]
v_mfma_f32_16x16x32_bf16 a[144:147], a[24:27], a[48:51], a[144:147]
ds_read_b64_tr_b16 a[120:121], v16 offset:49152
v_mfma_f32_16x16x32_bf16 a[176:179], a[28:31], a[48:51], a[176:179]
v_mfma_f32_16x16x32_bf16 a[180:183], a[28:31], a[52:55], a[180:183]
ds_read_b64_tr_b16 a[122:123], v16 offset:53248
v_mfma_f32_16x16x32_bf16 a[148:151], a[24:27], a[52:55], a[148:151]
v_mfma_f32_16x16x32_bf16 v[244:247], a[20:23], a[52:55], v[244:247]
ds_read_b128 a[92:95], v8 offset:56320
v_mfma_f32_16x16x32_bf16 v[212:215], a[16:19], a[52:55], v[212:215]
v_mfma_f32_16x16x32_bf16 v[180:183], a[12:15], a[52:55], v[180:183]
ds_read_b64_tr_b16 a[124:125], v17 offset:49152
buffer_load_dwordx4 v5, s[8:11], s61 offen offset:1024 lds
v_mfma_f32_16x16x32_bf16 v[148:151], a[8:11], a[52:55], v[148:151]
v_mfma_f32_16x16x32_bf16 v[116:119], a[4:7], a[52:55], v[116:119]
ds_read_b64_tr_b16 a[126:127], v17 offset:53248
v_mfma_f32_16x16x32_bf16 v[84:87], a[0:3], a[52:55], v[84:87]
v_mfma_f32_16x16x32_bf16 v[88:91], a[0:3], a[56:59], v[88:91]
v_mfma_f32_16x16x32_bf16 v[120:123], a[4:7], a[56:59], v[120:123]
v_mfma_f32_16x16x32_bf16 v[152:155], a[8:11], a[56:59], v[152:155]
v_mfma_f32_16x16x32_bf16 v[184:187], a[12:15], a[56:59], v[184:187]
v_mfma_f32_16x16x32_bf16 v[216:219], a[16:19], a[56:59], v[216:219]
buffer_load_dwordx4 v6, s[8:11], s61 offen offset:2048 lds
v_mfma_f32_16x16x32_bf16 v[248:251], a[20:23], a[56:59], v[248:251]
v_mfma_f32_16x16x32_bf16 a[152:155], a[24:27], a[56:59], a[152:155]
v_mfma_f32_16x16x32_bf16 a[184:187], a[28:31], a[56:59], a[184:187]
v_mfma_f32_16x16x32_bf16 a[188:191], a[28:31], a[60:63], a[188:191]
v_mfma_f32_16x16x32_bf16 a[156:159], a[24:27], a[60:63], a[156:159]
v_mfma_f32_16x16x32_bf16 v[252:255], a[20:23], a[60:63], v[252:255]
v_mfma_f32_16x16x32_bf16 v[220:223], a[16:19], a[60:63], v[220:223]
v_mfma_f32_16x16x32_bf16 v[188:191], a[12:15], a[60:63], v[188:191]
buffer_load_dwordx4 v7, s[8:11], s61 offen offset:3072 lds
s_add_u32 s61, s61, s65
v_mfma_f32_16x16x32_bf16 v[156:159], a[8:11], a[60:63], v[156:159]
v_mfma_f32_16x16x32_bf16 v[124:127], a[4:7], a[60:63], v[124:127]
v_mfma_f32_16x16x32_bf16 v[92:95], a[0:3], a[60:63], v[92:95]
s_waitcnt vmcnt(16) lgkmcnt(0)
s_barrier
v_mfma_f32_16x16x32_bf16 v[64:67], a[64:67], a[96:99], v[64:67]
ds_read_b128 a[0:3], v8 offset:0
v_mfma_f32_16x16x32_bf16 v[96:99], a[68:71], a[96:99], v[96:99]
v_mfma_f32_16x16x32_bf16 v[128:131], a[72:75], a[96:99], v[128:131]
ds_read_b64_tr_b16 a[32:33], v10 offset:0
v_mfma_f32_16x16x32_bf16 v[160:163], a[76:79], a[96:99], v[160:163]
v_mfma_f32_16x16x32_bf16 v[192:195], a[80:83], a[96:99], v[192:195]
ds_read_b64_tr_b16 a[34:35], v10 offset:4096
s_add_u32 m0, s63, 49152
s_nop 0
buffer_load_dwordx4 v2, s[4:7], s60 offen offset:0 sc1 lds
v_mfma_f32_16x16x32_bf16 v[224:227], a[84:87], a[96:99], v[224:227]
v_mfma_f32_16x16x32_bf16 a[128:131], a[88:91], a[96:99], a[128:131]
ds_read_b128 a[4:7], v8 offset:1024
v_mfma_f32_16x16x32_bf16 a[160:163], a[92:95], a[96:99], a[160:163]
v_mfma_f32_16x16x32_bf16 a[164:167], a[92:95], a[100:103], a[164:167]
ds_read_b64_tr_b16 a[36:37], v11 offset:0
v_mfma_f32_16x16x32_bf16 a[132:135], a[88:91], a[100:103], a[132:135]
v_mfma_f32_16x16x32_bf16 v[228:231], a[84:87], a[100:103], v[228:231]
ds_read_b64_tr_b16 a[38:39], v11 offset:4096
v_mfma_f32_16x16x32_bf16 v[196:199], a[80:83], a[100:103], v[196:199]
v_mfma_f32_16x16x32_bf16 v[164:167], a[76:79], a[100:103], v[164:167]
ds_read_b128 a[8:11], v8 offset:2048
buffer_load_dwordx4 v2, s[4:7], s60 offen offset:1024 sc1 lds
v_mfma_f32_16x16x32_bf16 v[132:135], a[72:75], a[100:103], v[132:135]
v_mfma_f32_16x16x32_bf16 v[100:103], a[68:71], a[100:103], v[100:103]
ds_read_b64_tr_b16 a[40:41], v12 offset:0
v_mfma_f32_16x16x32_bf16 v[68:71], a[64:67], a[100:103], v[68:71]
v_mfma_f32_16x16x32_bf16 v[72:75], a[64:67], a[104:107], v[72:75]
ds_read_b64_tr_b16 a[42:43], v12 offset:4096
v_mfma_f32_16x16x32_bf16 v[104:107], a[68:71], a[104:107], v[104:107]
v_mfma_f32_16x16x32_bf16 v[136:139], a[72:75], a[104:107], v[136:139]
ds_read_b128 a[12:15], v8 offset:3072
v_mfma_f32_16x16x32_bf16 v[168:171], a[76:79], a[104:107], v[168:171]
v_mfma_f32_16x16x32_bf16 v[200:203], a[80:83], a[104:107], v[200:203]
ds_read_b64_tr_b16 a[44:45], v13 offset:0
buffer_load_dwordx4 v2, s[4:7], s60 offen offset:2048 sc1 lds
v_mfma_f32_16x16x32_bf16 v[232:235], a[84:87], a[104:107], v[232:235]
v_mfma_f32_16x16x32_bf16 a[136:139], a[88:91], a[104:107], a[136:139]
ds_read_b64_tr_b16 a[46:47], v13 offset:4096
v_mfma_f32_16x16x32_bf16 a[168:171], a[92:95], a[104:107], a[168:171]
v_mfma_f32_16x16x32_bf16 a[172:175], a[92:95], a[108:111], a[172:175]
ds_read_b128 a[16:19], v8 offset:4096
v_mfma_f32_16x16x32_bf16 a[140:143], a[88:91], a[108:111], a[140:143]
v_mfma_f32_16x16x32_bf16 v[236:239], a[84:87], a[108:111], v[236:239]
ds_read_b64_tr_b16 a[48:49], v14 offset:0
v_mfma_f32_16x16x32_bf16 v[204:207], a[80:83], a[108:111], v[204:207]
v_mfma_f32_16x16x32_bf16 v[172:175], a[76:79], a[108:111], v[172:175]
ds_read_b64_tr_b16 a[50:51], v14 offset:4096
buffer_load_dwordx4 v2, s[4:7], s60 offen offset:3072 sc1 lds
s_add_u32 s60, s60, 4096
v_mfma_f32_16x16x32_bf16 v[140:143], a[72:75], a[108:111], v[140:143]
v_mfma_f32_16x16x32_bf16 v[108:111], a[68:71], a[108:111], v[108:111]
ds_read_b128 a[20:23], v8 offset:5120
v_mfma_f32_16x16x32_bf16 v[76:79], a[64:67], a[108:111], v[76:79]
v_mfma_f32_16x16x32_bf16 v[80:83], a[64:67], a[112:115], v[80:83]
ds_read_b64_tr_b16 a[52:53], v15 offset:0
v_mfma_f32_16x16x32_bf16 v[112:115], a[68:71], a[112:115], v[112:115]
v_mfma_f32_16x16x32_bf16 v[144:147], a[72:75], a[112:115], v[144:147]
ds_read_b64_tr_b16 a[54:55], v15 offset:4096
v_mfma_f32_16x16x32_bf16 v[176:179], a[76:79], a[112:115], v[176:179]
v_mfma_f32_16x16x32_bf16 v[208:211], a[80:83], a[112:115], v[208:211]
ds_read_b128 a[24:27], v8 offset:6144
s_add_u32 m0, s64, 49152
s_nop 0
buffer_load_dwordx4 v4, s[8:11], s61 offen offset:0 lds
v_mfma_f32_16x16x32_bf16 v[240:243], a[84:87], a[112:115], v[240:243]
v_mfma_f32_16x16x32_bf16 a[144:147], a[88:91], a[112:115], a[144:147]
ds_read_b64_tr_b16 a[56:57], v16 offset:0
v_mfma_f32_16x16x32_bf16 a[176:179], a[92:95], a[112:115], a[176:179]
v_mfma_f32_16x16x32_bf16 a[180:183], a[92:95], a[116:119], a[180:183]
ds_read_b64_tr_b16 a[58:59], v16 offset:4096
v_mfma_f32_16x16x32_bf16 a[148:151], a[88:91], a[116:119], a[148:151]
v_mfma_f32_16x16x32_bf16 v[244:247], a[84:87], a[116:119], v[244:247]
ds_read_b128 a[28:31], v8 offset:7168
v_mfma_f32_16x16x32_bf16 v[212:215], a[80:83], a[116:119], v[212:215]
v_mfma_f32_16x16x32_bf16 v[180:183], a[76:79], a[116:119], v[180:183]
ds_read_b64_tr_b16 a[60:61], v17 offset:0
buffer_load_dwordx4 v5, s[8:11], s61 offen offset:1024 lds
v_mfma_f32_16x16x32_bf16 v[148:151], a[72:75], a[116:119], v[148:151]
v_mfma_f32_16x16x32_bf16 v[116:119], a[68:71], a[116:119], v[116:119]
ds_read_b64_tr_b16 a[62:63], v17 offset:4096
v_mfma_f32_16x16x32_bf16 v[84:87], a[64:67], a[116:119], v[84:87]
v_mfma_f32_16x16x32_bf16 v[88:91], a[64:67], a[120:123], v[88:91]
v_mfma_f32_16x16x32_bf16 v[120:123], a[68:71], a[120:123], v[120:123]
v_mfma_f32_16x16x32_bf16 v[152:155], a[72:75], a[120:123], v[152:155]
v_mfma_f32_16x16x32_bf16 v[184:187], a[76:79], a[120:123], v[184:187]
v_mfma_f32_16x16x32_bf16 v[216:219], a[80:83], a[120:123], v[216:219]
buffer_load_dwordx4 v6, s[8:11], s61 offen offset:2048 lds
v_mfma_f32_16x16x32_bf16 v[248:251], a[84:87], a[120:123], v[248:251]
v_mfma_f32_16x16x32_bf16 a[152:155], a[88:91], a[120:123], a[152:155]
v_mfma_f32_16x16x32_bf16 a[184:187], a[92:95], a[120:123], a[184:187]
v_mfma_f32_16x16x32_bf16 a[188:191], a[92:95], a[124:127], a[188:191]
v_mfma_f32_16x16x32_bf16 a[156:159], a[88:91], a[124:127], a[156:159]
v_mfma_f32_16x16x32_bf16 v[252:255], a[84:87], a[124:127], v[252:255]
v_mfma_f32_16x16x32_bf16 v[220:223], a[80:83], a[124:127], v[220:223]
v_mfma_f32_16x16x32_bf16 v[188:191], a[76:79], a[124:127], v[188:191]
buffer_load_dwordx4 v7, s[8:11], s61 offen offset:3072 lds
s_add_u32 s61, s61, s65
v_mfma_f32_16x16x32_bf16 v[156:159], a[72:75], a[124:127], v[156:159]
v_mfma_f32_16x16x32_bf16 v[124:127], a[68:71], a[124:127], v[124:127]
v_mfma_f32_16x16x32_bf16 v[92:95], a[64:67], a[124:127], v[92:95]
s_sub_u32 s62, s62, 1
s_cmp_lg_u32 s62, 0
s_cbranch_scc1 Lgl_7
s_waitcnt vmcnt(16) lgkmcnt(0)
s_barrier
v_mfma_f32_16x16x32_bf16 v[64:67], a[0:3], a[32:35], v[64:67]
ds_read_b128 a[64:67], v8 offset:16384
v_mfma_f32_16x16x32_bf16 v[96:99], a[4:7], a[32:35], v[96:99]
v_mfma_f32_16x16x32_bf16 v[128:131], a[8:11], a[32:35], v[128:131]
ds_read_b64_tr_b16 a[96:97], v10 offset:16384
v_mfma_f32_16x16x32_bf16 v[160:163], a[12:15], a[32:35], v[160:163]
v_mfma_f32_16x16x32_bf16 v[192:195], a[16:19], a[32:35], v[192:195]
ds_read_b64_tr_b16 a[98:99], v10 offset:20480
v_mfma_f32_16x16x32_bf16 v[224:227], a[20:23], a[32:35], v[224:227]
v_mfma_f32_16x16x32_bf16 a[128:131], a[24:27], a[32:35], a[128:131]
ds_read_b128 a[68:71], v8 offset:17408
v_mfma_f32_16x16x32_bf16 a[160:163], a[28:31], a[32:35], a[160:163]
v_mfma_f32_16x16x32_bf16 a[164:167], a[28:31], a[36:39], a[164:167]
ds_read_b64_tr_b16 a[100:101], v11 offset:16384
v_mfma_f32_16x16x32_bf16 a[132:135], a[24:27], a[36:39], a[132:135]
v_mfma_f32_16x16x32_bf16 v[228:231], a[20:23], a[36:39], v[228:231]
ds_read_b64_tr_b16 a[102:103], v11 offset:20480
v_mfma_f32_16x16x32_bf16 v[196:199], a[16:19], a[36:39], v[196:199]
v_mfma_f32_16x16x32_bf16 v[164:167], a[12:15], a[36:39], v[164:167]
ds_read_b128 a[72:75], v8 offset:18432
v_mfma_f32_16x16x32_bf16 v[132:135], a[8:11], a[36:39], v[132:135]
v_mfma_f32_16x16x32_bf16 v[100:103], a[4:7], a[36:39], v[100:103]
ds_read_b64_tr_b16 a[104:105], v12 offset:16384
v_mfma_f32_16x16x32_bf16 v[68:71], a[0:3], a[36:39], v[68:71]
v_mfma_f32_16x16x32_bf16 v[72:75], a[0:3], a[40:43], v[72:75]
ds_read_b64_tr_b16 a[106:107], v12 offset:20480
v_mfma_f32_16x16x32_bf16 v[104:107], a[4:7], a[40:43], v[104:107]
v_mfma_f32_16x16x32_bf16 v[136:139], a[8:11], a[40:43], v[136:139]
ds_read_b128 a[76:79], v8 offset:19456
v_mfma_f32_16x16x32_bf16 v[168:171], a[12:15], a[40:43], v[168:171]
v_mfma_f32_16x16x32_bf16 v[200:203], a[16:19], a[40:43], v[200:203]
ds_read_b64_tr_b16 a[108:109], v13 offset:16384
v_mfma_f32_16x16x32_bf16 v[232:235], a[20:23], a[40:43], v[232:235]
v_mfma_f32_16x16x32_bf16 a[136:139], a[24:27], a[40:43], a[136:139]
ds_read_b64_tr_b16 a[110:111], v13 offset:20480
v_mfma_f32_16x16x32_bf16 a[168:171], a[28:31], a[40:43], a[168:171]
v_mfma_f32_16x16x32_bf16 a[172:175], a[28:31], a[44:47], a[172:175]
ds_read_b128 a[80:83], v8 offset:20480
v_mfma_f32_16x16x32_bf16 a[140:143], a[24:27], a[44:47], a[140:143]
v_mfma_f32_16x16x32_bf16 v[236:239], a[20:23], a[44:47], v[236:239]
ds_read_b64_tr_b16 a[112:113], v14 offset:16384
v_mfma_f32_16x16x32_bf16 v[204:207], a[16:19], a[44:47], v[204:207]
v_mfma_f32_16x16x32_bf16 v[172:175], a[12:15], a[44:47], v[172:175]
ds_read_b64_tr_b16 a[114:115], v14 offset:20480
v_mfma_f32_16x16x32_bf16 v[140:143], a[8:11], a[44:47], v[140:143]
v_mfma_f32_16x16x32_bf16 v[108:111], a[4:7], a[44:47], v[108:111]
ds_read_b128 a[84:87], v8 offset:21504
v_mfma_f32_16x16x32_bf16 v[76:79], a[0:3], a[44:47], v[76:79]
v_mfma_f32_16x16x32_bf16 v[80:83], a[0:3], a[48:51], v[80:83]
ds_read_b64_tr_b16 a[116:117], v15 offset:16384
v_mfma_f32_16x16x32_bf16 v[112:115], a[4:7], a[48:51], v[112:115]
v_mfma_f32_16x16x32_bf16 v[144:147], a[8:11], a[48:51], v[144:147]
ds_read_b64_tr_b16 a[118:119], v15 offset:20480
v_mfma_f32_16x16x32_bf16 v[176:179], a[12:15], a[48:51], v[176:179]
v_mfma_f32_16x16x32_bf16 v[208:211], a[16:19], a[48:51], v[208:211]
ds_read_b128 a[88:91], v8 offset:22528
v_mfma_f32_16x16x32_bf16 v[240:243], a[20:23], a[48:51], v[240:243]
v_mfma_f32_16x16x32_bf16 a[144:147], a[24:27], a[48:51], a[144:147]
ds_read_b64_tr_b16 a[120:121], v16 offset:16384
v_mfma_f32_16x16x32_bf16 a[176:179], a[28:31], a[48:51], a[176:179]
v_mfma_f32_16x16x32_bf16 a[180:183], a[28:31], a[52:55], a[180:183]
ds_read_b64_tr_b16 a[122:123], v16 offset:20480
v_mfma_f32_16x16x32_bf16 a[148:151], a[24:27], a[52:55], a[148:151]
v_mfma_f32_16x16x32_bf16 v[244:247], a[20:23], a[52:55], v[244:247]
ds_read_b128 a[92:95], v8 offset:23552
v_mfma_f32_16x16x32_bf16 v[212:215], a[16:19], a[52:55], v[212:215]
v_mfma_f32_16x16x32_bf16 v[180:183], a[12:15], a[52:55], v[180:183]
ds_read_b64_tr_b16 a[124:125], v17 offset:16384
v_mfma_f32_16x16x32_bf16 v[148:151], a[8:11], a[52:55], v[148:151]
v_mfma_f32_16x16x32_bf16 v[116:119], a[4:7], a[52:55], v[116:119]
ds_read_b64_tr_b16 a[126:127], v17 offset:20480
v_mfma_f32_16x16x32_bf16 v[84:87], a[0:3], a[52:55], v[84:87]
v_mfma_f32_16x16x32_bf16 v[88:91], a[0:3], a[56:59], v[88:91]
v_mfma_f32_16x16x32_bf16 v[120:123], a[4:7], a[56:59], v[120:123]
v_mfma_f32_16x16x32_bf16 v[152:155], a[8:11], a[56:59], v[152:155]
v_mfma_f32_16x16x32_bf16 v[184:187], a[12:15], a[56:59], v[184:187]
v_mfma_f32_16x16x32_bf16 v[216:219], a[16:19], a[56:59], v[216:219]
v_mfma_f32_16x16x32_bf16 v[248:251], a[20:23], a[56:59], v[248:251]
v_mfma_f32_16x16x32_bf16 a[152:155], a[24:27], a[56:59], a[152:155]
v_mfma_f32_16x16x32_bf16 a[184:187], a[28:31], a[56:59], a[184:187]
v_mfma_f32_16x16x32_bf16 a[188:191], a[28:31], a[60:63], a[188:191]
v_mfma_f32_16x16x32_bf16 a[156:159], a[24:27], a[60:63], a[156:159]
v_mfma_f32_16x16x32_bf16 v[252:255], a[20:23], a[60:63], v[252:255]
v_mfma_f32_16x16x32_bf16 v[220:223], a[16:19], a[60:63], v[220:223]
v_mfma_f32_16x16x32_bf16 v[188:191], a[12:15], a[60:63], v[188:191]
v_mfma_f32_16x16x32_bf16 v[156:159], a[8:11], a[60:63], v[156:159]
v_mfma_f32_16x16x32_bf16 v[124:127], a[4:7], a[60:63], v[124:127]
v_mfma_f32_16x16x32_bf16 v[92:95], a[0:3], a[60:63], v[92:95]
s_waitcnt vmcnt(8) lgkmcnt(0)
s_barrier
v_mfma_f32_16x16x32_bf16 v[64:67], a[64:67], a[96:99], v[64:67]
ds_read_b128 a[0:3], v8 offset:32768
v_mfma_f32_16x16x32_bf16 v[96:99], a[68:71], a[96:99], v[96:99]
v_mfma_f32_16x16x32_bf16 v[128:131], a[72:75], a[96:99], v[128:131]
ds_read_b64_tr_b16 a[32:33], v10 offset:32768
v_mfma_f32_16x16x32_bf16 v[160:163], a[76:79], a[96:99], v[160:163]
v_mfma_f32_16x16x32_bf16 v[192:195], a[80:83], a[96:99], v[192:195]
ds_read_b64_tr_b16 a[34:35], v10 offset:36864
v_mfma_f32_16x16x32_bf16 v[224:227], a[84:87], a[96:99], v[224:227]
v_mfma_f32_16x16x32_bf16 a[128:131], a[88:91], a[96:99], a[128:131]
ds_read_b128 a[4:7], v8 offset:33792
v_mfma_f32_16x16x32_bf16 a[160:163], a[92:95], a[96:99], a[160:163]
v_mfma_f32_16x16x32_bf16 a[164:167], a[92:95], a[100:103], a[164:167]
ds_read_b64_tr_b16 a[36:37], v11 offset:32768
v_mfma_f32_16x16x32_bf16 a[132:135], a[88:91], a[100:103], a[132:135]
v_mfma_f32_16x16x32_bf16 v[228:231], a[84:87], a[100:103], v[228:231]
ds_read_b64_tr_b16 a[38:39], v11 offset:36864
v_mfma_f32_16x16x32_bf16 v[196:199], a[80:83], a[100:103], v[196:199]
v_mfma_f32_16x16x32_bf16 v[164:167], a[76:79], a[100:103], v[164:167]
ds_read_b128 a[8:11], v8 offset:34816
v_mfma_f32_16x16x32_bf16 v[132:135], a[72:75], a[100:103], v[132:135]
v_mfma_f32_16x16x32_bf16 v[100:103], a[68:71], a[100:103], v[100:103]
ds_read_b64_tr_b16 a[40:41], v12 offset:32768
v_mfma_f32_16x16x32_bf16 v[68:71], a[64:67], a[100:103], v[68:71]
v_mfma_f32_16x16x32_bf16 v[72:75], a[64:67], a[104:107], v[72:75]
ds_read_b64_tr_b16 a[42:43], v12 offset:36864
v_mfma_f32_16x16x32_bf16 v[104:107], a[68:71], a[104:107], v[104:107]
v_mfma_f32_16x16x32_bf16 v[136:139], a[72:75], a[104:107], v[136:139]
ds_read_b128 a[12:15], v8 offset:35840
v_mfma_f32_16x16x32_bf16 v[168:171], a[76:79], a[104:107], v[168:171]
v_mfma_f32_16x16x32_bf16 v[200:203], a[80:83], a[104:107], v[200:203]
ds_read_b64_tr_b16 a[44:45], v13 offset:32768
v_mfma_f32_16x16x32_bf16 v[232:235], a[84:87], a[104:107], v[232:235]
v_mfma_f32_16x16x32_bf16 a[136:139], a[88:91], a[104:107], a[136:139]
ds_read_b64_tr_b16 a[46:47], v13 offset:36864
v_mfma_f32_16x16x32_bf16 a[168:171], a[92:95], a[104:107], a[168:171]
v_mfma_f32_16x16x32_bf16 a[172:175], a[92:95], a[108:111], a[172:175]
ds_read_b128 a[16:19], v8 offset:36864
v_mfma_f32_16x16x32_bf16 a[140:143], a[88:91], a[108:111], a[140:143]
v_mfma_f32_16x16x32_bf16 v[236:239], a[84:87], a[108:111], v[236:239]
ds_read_b64_tr_b16 a[48:49], v14 offset:32768
v_mfma_f32_16x16x32_bf16 v[204:207], a[80:83], a[108:111], v[204:207]
v_mfma_f32_16x16x32_bf16 v[172:175], a[76:79], a[108:111], v[172:175]
ds_read_b64_tr_b16 a[50:51], v14 offset:36864
v_mfma_f32_16x16x32_bf16 v[140:143], a[72:75], a[108:111], v[140:143]
v_mfma_f32_16x16x32_bf16 v[108:111], a[68:71], a[108:111], v[108:111]
ds_read_b128 a[20:23], v8 offset:37888
v_mfma_f32_16x16x32_bf16 v[76:79], a[64:67], a[108:111], v[76:79]
v_mfma_f32_16x16x32_bf16 v[80:83], a[64:67], a[112:115], v[80:83]
ds_read_b64_tr_b16 a[52:53], v15 offset:32768
v_mfma_f32_16x16x32_bf16 v[112:115], a[68:71], a[112:115], v[112:115]
v_mfma_f32_16x16x32_bf16 v[144:147], a[72:75], a[112:115], v[144:147]
ds_read_b64_tr_b16 a[54:55], v15 offset:36864
v_mfma_f32_16x16x32_bf16 v[176:179], a[76:79], a[112:115], v[176:179]
v_mfma_f32_16x16x32_bf16 v[208:211], a[80:83], a[112:115], v[208:211]
ds_read_b128 a[24:27], v8 offset:38912
v_mfma_f32_16x16x32_bf16 v[240:243], a[84:87], a[112:115], v[240:243]
v_mfma_f32_16x16x32_bf16 a[144:147], a[88:91], a[112:115], a[144:147]
ds_read_b64_tr_b16 a[56:57], v16 offset:32768
v_mfma_f32_16x16x32_bf16 a[176:179], a[92:95], a[112:115], a[176:179]
v_mfma_f32_16x16x32_bf16 a[180:183], a[92:95], a[116:119], a[180:183]
ds_read_b64_tr_b16 a[58:59], v16 offset:36864
v_mfma_f32_16x16x32_bf16 a[148:151], a[88:91], a[116:119], a[148:151]
v_mfma_f32_16x16x32_bf16 v[244:247], a[84:87], a[116:119], v[244:247]
ds_read_b128 a[28:31], v8 offset:39936
v_mfma_f32_16x16x32_bf16 v[212:215], a[80:83], a[116:119], v[212:215]
v_mfma_f32_16x16x32_bf16 v[180:183], a[76:79], a[116:119], v[180:183]
ds_read_b64_tr_b16 a[60:61], v17 offset:32768
v_mfma_f32_16x16x32_bf16 v[148:151], a[72:75], a[116:119], v[148:151]
v_mfma_f32_16x16x32_bf16 v[116:119], a[68:71], a[116:119], v[116:119]
ds_read_b64_tr_b16 a[62:63], v17 offset:36864
v_mfma_f32_16x16x32_bf16 v[84:87], a[64:67], a[116:119], v[84:87]
v_mfma_f32_16x16x32_bf16 v[88:91], a[64:67], a[120:123], v[88:91]
v_mfma_f32_16x16x32_bf16 v[120:123], a[68:71], a[120:123], v[120:123]
v_mfma_f32_16x16x32_bf16 v[152:155], a[72:75], a[120:123], v[152:155]
v_mfma_f32_16x16x32_bf16 v[184:187], a[76:79], a[120:123], v[184:187]
v_mfma_f32_16x16x32_bf16 v[216:219], a[80:83], a[120:123], v[216:219]
v_mfma_f32_16x16x32_bf16 v[248:251], a[84:87], a[120:123], v[248:251]
v_mfma_f32_16x16x32_bf16 a[152:155], a[88:91], a[120:123], a[152:155]
v_mfma_f32_16x16x32_bf16 a[184:187], a[92:95], a[120:123], a[184:187]
v_mfma_f32_16x16x32_bf16 a[188:191], a[92:95], a[124:127], a[188:191]
v_mfma_f32_16x16x32_bf16 a[156:159], a[88:91], a[124:127], a[156:159]
v_mfma_f32_16x16x32_bf16 v[252:255], a[84:87], a[124:127], v[252:255]
v_mfma_f32_16x16x32_bf16 v[220:223], a[80:83], a[124:127], v[220:223]
v_mfma_f32_16x16x32_bf16 v[188:191], a[76:79], a[124:127], v[188:191]
v_mfma_f32_16x16x32_bf16 v[156:159], a[72:75], a[124:127], v[156:159]
v_mfma_f32_16x16x32_bf16 v[124:127], a[68:71], a[124:127], v[124:127]
v_mfma_f32_16x16x32_bf16 v[92:95], a[64:67], a[124:127], v[92:95]
s_waitcnt vmcnt(0) lgkmcnt(0)
s_barrier
v_mfma_f32_16x16x32_bf16 v[64:67], a[0:3], a[32:35], v[64:67]
ds_read_b128 a[64:67], v8 offset:49152
v_mfma_f32_16x16x32_bf16 v[96:99], a[4:7], a[32:35], v[96:99]
v_mfma_f32_16x16x32_bf16 v[128:131], a[8:11], a[32:35], v[128:131]
ds_read_b64_tr_b16 a[96:97], v10 offset:49152
v_mfma_f32_16x16x32_bf16 v[160:163], a[12:15], a[32:35], v[160:163]
v_mfma_f32_16x16x32_bf16 v[192:195], a[16:19], a[32:35], v[192:195]
ds_read_b64_tr_b16 a[98:99], v10 offset:53248
v_mfma_f32_16x16x32_bf16 v[224:227], a[20:23], a[32:35], v[224:227]
v_mfma_f32_16x16x32_bf16 a[128:131], a[24:27], a[32:35], a[128:131]
ds_read_b128 a[68:71], v8 offset:50176
v_mfma_f32_16x16x32_bf16 a[160:163], a[28:31], a[32:35], a[160:163]
v_mfma_f32_16x16x32_bf16 a[164:167], a[28:31], a[36:39], a[164:167]
ds_read_b64_tr_b16 a[100:101], v11 offset:49152
v_mfma_f32_16x16x32_bf16 a[132:135], a[24:27], a[36:39], a[132:135]
v_mfma_f32_16x16x32_bf16 v[228:231], a[20:23], a[36:39], v[228:231]
ds_read_b64_tr_b16 a[102:103], v11 offset:53248
v_mfma_f32_16x16x32_bf16 v[196:199], a[16:19], a[36:39], v[196:199]
v_mfma_f32_16x16x32_bf16 v[164:167], a[12:15], a[36:39], v[164:167]
ds_read_b128 a[72:75], v8 offset:51200
v_mfma_f32_16x16x32_bf16 v[132:135], a[8:11], a[36:39], v[132:135]
v_mfma_f32_16x16x32_bf16 v[100:103], a[4:7], a[36:39], v[100:103]
ds_read_b64_tr_b16 a[104:105], v12 offset:49152
v_mfma_f32_16x16x32_bf16 v[68:71], a[0:3], a[36:39], v[68:71]
v_mfma_f32_16x16x32_bf16 v[72:75], a[0:3], a[40:43], v[72:75]
ds_read_b64_tr_b16 a[106:107], v12 offset:53248
v_mfma_f32_16x16x32_bf16 v[104:107], a[4:7], a[40:43], v[104:107]
v_mfma_f32_16x16x32_bf16 v[136:139], a[8:11], a[40:43], v[136:139]
ds_read_b128 a[76:79], v8 offset:52224
v_mfma_f32_16x16x32_bf16 v[168:171], a[12:15], a[40:43], v[168:171]
v_mfma_f32_16x16x32_bf16 v[200:203], a[16:19], a[40:43], v[200:203]
ds_read_b64_tr_b16 a[108:109], v13 offset:49152
v_mfma_f32_16x16x32_bf16 v[232:235], a[20:23], a[40:43], v[232:235]
v_mfma_f32_16x16x32_bf16 a[136:139], a[24:27], a[40:43], a[136:139]
ds_read_b64_tr_b16 a[110:111], v13 offset:53248
v_mfma_f32_16x16x32_bf16 a[168:171], a[28:31], a[40:43], a[168:171]
v_mfma_f32_16x16x32_bf16 a[172:175], a[28:31], a[44:47], a[172:175]
ds_read_b128 a[80:83], v8 offset:53248
v_mfma_f32_16x16x32_bf16 a[140:143], a[24:27], a[44:47], a[140:143]
v_mfma_f32_16x16x32_bf16 v[236:239], a[20:23], a[44:47], v[236:239]
ds_read_b64_tr_b16 a[112:113], v14 offset:49152
v_mfma_f32_16x16x32_bf16 v[204:207], a[16:19], a[44:47], v[204:207]
v_mfma_f32_16x16x32_bf16 v[172:175], a[12:15], a[44:47], v[172:175]
ds_read_b64_tr_b16 a[114:115], v14 offset:53248
v_mfma_f32_16x16x32_bf16 v[140:143], a[8:11], a[44:47], v[140:143]
v_mfma_f32_16x16x32_bf16 v[108:111], a[4:7], a[44:47], v[108:111]
ds_read_b128 a[84:87], v8 offset:54272
v_mfma_f32_16x16x32_bf16 v[76:79], a[0:3], a[44:47], v[76:79]
v_mfma_f32_16x16x32_bf16 v[80:83], a[0:3], a[48:51], v[80:83]
ds_read_b64_tr_b16 a[116:117], v15 offset:49152
v_mfma_f32_16x16x32_bf16 v[112:115], a[4:7], a[48:51], v[112:115]
v_mfma_f32_16x16x32_bf16 v[144:147], a[8:11], a[48:51], v[144:147]
ds_read_b64_tr_b16 a[118:119], v15 offset:53248
v_mfma_f32_16x16x32_bf16 v[176:179], a[12:15], a[48:51], v[176:179]
v_mfma_f32_16x16x32_bf16 v[208:211], a[16:19], a[48:51], v[208:211]
ds_read_b128 a[88:91], v8 offset:55296
v_mfma_f32_16x16x32_bf16 v[240:243], a[20:23], a[48:51], v[240:243]
v_mfma_f32_16x16x32_bf16 a[144:147], a[24:27], a[48:51], a[144:147]
ds_read_b64_tr_b16 a[120:121], v16 offset:49152
v_mfma_f32_16x16x32_bf16 a[176:179], a[28:31], a[48:51], a[176:179]
v_mfma_f32_16x16x32_bf16 a[180:183], a[28:31], a[52:55], a[180:183]
ds_read_b64_tr_b16 a[122:123], v16 offset:53248
v_mfma_f32_16x16x32_bf16 a[148:151], a[24:27], a[52:55], a[148:151]
v_mfma_f32_16x16x32_bf16 v[244:247], a[20:23], a[52:55], v[244:247]
ds_read_b128 a[92:95], v8 offset:56320
v_mfma_f32_16x16x32_bf16 v[212:215], a[16:19], a[52:55], v[212:215]
v_mfma_f32_16x16x32_bf16 v[180:183], a[12:15], a[52:55], v[180:183]
ds_read_b64_tr_b16 a[124:125], v17 offset:49152
v_mfma_f32_16x16x32_bf16 v[148:151], a[8:11], a[52:55], v[148:151]
v_mfma_f32_16x16x32_bf16 v[116:119], a[4:7], a[52:55], v[116:119]
ds_read_b64_tr_b16 a[126:127], v17 offset:53248
v_mfma_f32_16x16x32_bf16 v[84:87], a[0:3], a[52:55], v[84:87]
v_mfma_f32_16x16x32_bf16 v[88:91], a[0:3], a[56:59], v[88:91]
v_mfma_f32_16x16x32_bf16 v[120:123], a[4:7], a[56:59], v[120:123]
v_mfma_f32_16x16x32_bf16 v[152:155], a[8:11], a[56:59], v[152:155]
v_mfma_f32_16x16x32_bf16 v[184:187], a[12:15], a[56:59], v[184:187]
v_mfma_f32_16x16x32_bf16 v[216:219], a[16:19], a[56:59], v[216:219]
v_mfma_f32_16x16x32_bf16 v[248:251], a[20:23], a[56:59], v[248:251]
v_mfma_f32_16x16x32_bf16 a[152:155], a[24:27], a[56:59], a[152:155]
v_mfma_f32_16x16x32_bf16 a[184:187], a[28:31], a[56:59], a[184:187]
v_mfma_f32_16x16x32_bf16 a[188:191], a[28:31], a[60:63], a[188:191]
v_mfma_f32_16x16x32_bf16 a[156:159], a[24:27], a[60:63], a[156:159]
v_mfma_f32_16x16x32_bf16 v[252:255], a[20:23], a[60:63], v[252:255]
v_mfma_f32_16x16x32_bf16 v[220:223], a[16:19], a[60:63], v[220:223]
v_mfma_f32_16x16x32_bf16 v[188:191], a[12:15], a[60:63], v[188:191]
v_mfma_f32_16x16x32_bf16 v[156:159], a[8:11], a[60:63], v[156:159]
v_mfma_f32_16x16x32_bf16 v[124:127], a[4:7], a[60:63], v[124:127]
v_mfma_f32_16x16x32_bf16 v[92:95], a[0:3], a[60:63], v[92:95]
s_waitcnt lgkmcnt(0)
v_mfma_f32_16x16x32_bf16 v[64:67], a[64:67], a[96:99], v[64:67]
v_mfma_f32_16x16x32_bf16 v[96:99], a[68:71], a[96:99], v[96:99]
v_mfma_f32_16x16x32_bf16 v[128:131], a[72:75], a[96:99], v[128:131]
v_mfma_f32_16x16x32_bf16 v[160:163], a[76:79], a[96:99], v[160:163]
v_mfma_f32_16x16x32_bf16 v[192:195], a[80:83], a[96:99], v[192:195]
v_mfma_f32_16x16x32_bf16 v[224:227], a[84:87], a[96:99], v[224:227]
v_mfma_f32_16x16x32_bf16 a[128:131], a[88:91], a[96:99], a[128:131]
v_mfma_f32_16x16x32_bf16 a[160:163], a[92:95], a[96:99], a[160:163]
v_mfma_f32_16x16x32_bf16 a[164:167], a[92:95], a[100:103], a[164:167]
v_mfma_f32_16x16x32_bf16 a[132:135], a[88:91], a[100:103], a[132:135]
v_mfma_f32_16x16x32_bf16 v[228:231], a[84:87], a[100:103], v[228:231]
v_mfma_f32_16x16x32_bf16 v[196:199], a[80:83], a[100:103], v[196:199]
v_mfma_f32_16x16x32_bf16 v[164:167], a[76:79], a[100:103], v[164:167]
v_mfma_f32_16x16x32_bf16 v[132:135], a[72:75], a[100:103], v[132:135]
v_mfma_f32_16x16x32_bf16 v[100:103], a[68:71], a[100:103], v[100:103]
v_mfma_f32_16x16x32_bf16 v[68:71], a[64:67], a[100:103], v[68:71]
v_mfma_f32_16x16x32_bf16 v[72:75], a[64:67], a[104:107], v[72:75]
v_mfma_f32_16x16x32_bf16 v[104:107], a[68:71], a[104:107], v[104:107]
v_mfma_f32_16x16x32_bf16 v[136:139], a[72:75], a[104:107], v[136:139]
v_mfma_f32_16x16x32_bf16 v[168:171], a[76:79], a[104:107], v[168:171]
v_mfma_f32_16x16x32_bf16 v[200:203], a[80:83], a[104:107], v[200:203]
v_mfma_f32_16x16x32_bf16 v[232:235], a[84:87], a[104:107], v[232:235]
v_mfma_f32_16x16x32_bf16 a[136:139], a[88:91], a[104:107], a[136:139]
v_mfma_f32_16x16x32_bf16 a[168:171], a[92:95], a[104:107], a[168:171]
v_mfma_f32_16x16x32_bf16 a[172:175], a[92:95], a[108:111], a[172:175]
v_mfma_f32_16x16x32_bf16 a[140:143], a[88:91], a[108:111], a[140:143]
v_mfma_f32_16x16x32_bf16 v[236:239], a[84:87], a[108:111], v[236:239]
v_mfma_f32_16x16x32_bf16 v[204:207], a[80:83], a[108:111], v[204:207]
v_mfma_f32_16x16x32_bf16 v[172:175], a[76:79], a[108:111], v[172:175]
v_mfma_f32_16x16x32_bf16 v[140:143], a[72:75], a[108:111], v[140:143]
v_mfma_f32_16x16x32_bf16 v[108:111], a[68:71], a[108:111], v[108:111]
v_mfma_f32_16x16x32_bf16 v[76:79], a[64:67], a[108:111], v[76:79]
v_mfma_f32_16x16x32_bf16 v[80:83], a[64:67], a[112:115], v[80:83]
v_mfma_f32_16x16x32_bf16 v[112:115], a[68:71], a[112:115], v[112:115]
v_mfma_f32_16x16x32_bf16 v[144:147], a[72:75], a[112:115], v[144:147]
v_mfma_f32_16x16x32_bf16 v[176:179], a[76:79], a[112:115], v[176:179]
v_mfma_f32_16x16x32_bf16 v[208:211], a[80:83], a[112:115], v[208:211]
v_mfma_f32_16x16x32_bf16 v[240:243], a[84:87], a[112:115], v[240:243]
v_mfma_f32_16x16x32_bf16 a[144:147], a[88:91], a[112:115], a[144:147]
v_mfma_f32_16x16x32_bf16 a[176:179], a[92:95], a[112:115], a[176:179]
v_mfma_f32_16x16x32_bf16 a[180:183], a[92:95], a[116:119], a[180:183]
v_mfma_f32_16x16x32_bf16 a[148:151], a[88:91], a[116:119], a[148:151]
v_mfma_f32_16x16x32_bf16 v[244:247], a[84:87], a[116:119], v[244:247]
v_mfma_f32_16x16x32_bf16 v[212:215], a[80:83], a[116:119], v[212:215]
v_mfma_f32_16x16x32_bf16 v[180:183], a[76:79], a[116:119], v[180:183]
v_mfma_f32_16x16x32_bf16 v[148:151], a[72:75], a[116:119], v[148:151]
v_mfma_f32_16x16x32_bf16 v[116:119], a[68:71], a[116:119], v[116:119]
v_mfma_f32_16x16x32_bf16 v[84:87], a[64:67], a[116:119], v[84:87]
v_mfma_f32_16x16x32_bf16 v[88:91], a[64:67], a[120:123], v[88:91]
v_mfma_f32_16x16x32_bf16 v[120:123], a[68:71], a[120:123], v[120:123]
v_mfma_f32_16x16x32_bf16 v[152:155], a[72:75], a[120:123], v[152:155]
v_mfma_f32_16x16x32_bf16 v[184:187], a[76:79], a[120:123], v[184:187]
v_mfma_f32_16x16x32_bf16 v[216:219], a[80:83], a[120:123], v[216:219]
v_mfma_f32_16x16x32_bf16 v[248:251], a[84:87], a[120:123], v[248:251]
v_mfma_f32_16x16x32_bf16 a[152:155], a[88:91], a[120:123], a[152:155]
v_mfma_f32_16x16x32_bf16 a[184:187], a[92:95], a[120:123], a[184:187]
v_mfma_f32_16x16x32_bf16 a[188:191], a[92:95], a[124:127], a[188:191]
v_mfma_f32_16x16x32_bf16 a[156:159], a[88:91], a[124:127], a[156:159]
v_mfma_f32_16x16x32_bf16 v[252:255], a[84:87], a[124:127], v[252:255]
v_mfma_f32_16x16x32_bf16 v[220:223], a[80:83], a[124:127], v[220:223]
v_mfma_f32_16x16x32_bf16 v[188:191], a[76:79], a[124:127], v[188:191]
v_mfma_f32_16x16x32_bf16 v[156:159], a[72:75], a[124:127], v[156:159]
v_mfma_f32_16x16x32_bf16 v[124:127], a[68:71], a[124:127], v[124:127]
v_mfma_f32_16x16x32_bf16 v[92:95], a[64:67], a[124:127], v[92:95]
v_lshlrev_b32 v24, 4, v1
v_add_u32 v25, 4096, v24
s_nop 7
s_add_u32 s66, s48, 0
v_cvt_pk_bf16_f32 v40, v64, v65
v_cvt_pk_bf16_f32 v41, v66, v67
v_cvt_pk_bf16_f32 v42, v96, v97
v_cvt_pk_bf16_f32 v43, v98, v99
buffer_store_dwordx4 v[40:43], v24, s[4:7], s66 offen offset:0 sc1
v_cvt_pk_bf16_f32 v44, v68, v69
v_cvt_pk_bf16_f32 v45, v70, v71
v_cvt_pk_bf16_f32 v46, v100, v101
v_cvt_pk_bf16_f32 v47, v102, v103
buffer_store_dwordx4 v[44:47], v24, s[4:7], s66 offen offset:1024 sc1
v_cvt_pk_bf16_f32 v48, v72, v73
v_cvt_pk_bf16_f32 v49, v74, v75
v_cvt_pk_bf16_f32 v50, v104, v105
v_cvt_pk_bf16_f32 v51, v106, v107
buffer_store_dwordx4 v[48:51], v24, s[4:7], s66 offen offset:2048 sc1
v_cvt_pk_bf16_f32 v52, v76, v77
v_cvt_pk_bf16_f32 v53, v78, v79
v_cvt_pk_bf16_f32 v54, v108, v109
v_cvt_pk_bf16_f32 v55, v110, v111
buffer_store_dwordx4 v[52:55], v24, s[4:7], s66 offen offset:3072 sc1
v_cvt_pk_bf16_f32 v56, v80, v81
v_cvt_pk_bf16_f32 v57, v82, v83
v_cvt_pk_bf16_f32 v58, v112, v113
v_cvt_pk_bf16_f32 v59, v114, v115
buffer_store_dwordx4 v[56:59], v25, s[4:7], s66 offen offset:0 sc1
v_cvt_pk_bf16_f32 v36, v84, v85
v_cvt_pk_bf16_f32 v37, v86, v87
v_cvt_pk_bf16_f32 v38, v116, v117
v_cvt_pk_bf16_f32 v39, v118, v119
buffer_store_dwordx4 v[36:39], v25, s[4:7], s66 offen offset:1024 sc1
v_cvt_pk_bf16_f32 v40, v88, v89
v_cvt_pk_bf16_f32 v41, v90, v91
v_cvt_pk_bf16_f32 v42, v120, v121
v_cvt_pk_bf16_f32 v43, v122, v123
buffer_store_dwordx4 v[40:43], v25, s[4:7], s66 offen offset:2048 sc1
v_cvt_pk_bf16_f32 v44, v92, v93
v_cvt_pk_bf16_f32 v45, v94, v95
v_cvt_pk_bf16_f32 v46, v124, v125
v_cvt_pk_bf16_f32 v47, v126, v127
buffer_store_dwordx4 v[44:47], v25, s[4:7], s66 offen offset:3072 sc1
s_add_u32 s66, s48, 786432
v_cvt_pk_bf16_f32 v48, v128, v129
v_cvt_pk_bf16_f32 v49, v130, v131
v_cvt_pk_bf16_f32 v50, v160, v161
v_cvt_pk_bf16_f32 v51, v162, v163
buffer_store_dwordx4 v[48:51], v24, s[4:7], s66 offen offset:0 sc1
v_cvt_pk_bf16_f32 v52, v132, v133
v_cvt_pk_bf16_f32 v53, v134, v135
v_cvt_pk_bf16_f32 v54, v164, v165
v_cvt_pk_bf16_f32 v55, v166, v167
buffer_store_dwordx4 v[52:55], v24, s[4:7], s66 offen offset:1024 sc1
v_cvt_pk_bf16_f32 v56, v136, v137
v_cvt_pk_bf16_f32 v57, v138, v139
v_cvt_pk_bf16_f32 v58, v168, v169
v_cvt_pk_bf16_f32 v59, v170, v171
buffer_store_dwordx4 v[56:59], v24, s[4:7], s66 offen offset:2048 sc1
v_cvt_pk_bf16_f32 v36, v140, v141
v_cvt_pk_bf16_f32 v37, v142, v143
v_cvt_pk_bf16_f32 v38, v172, v173
v_cvt_pk_bf16_f32 v39, v174, v175
buffer_store_dwordx4 v[36:39], v24, s[4:7], s66 offen offset:3072 sc1
v_cvt_pk_bf16_f32 v40, v144, v145
v_cvt_pk_bf16_f32 v41, v146, v147
v_cvt_pk_bf16_f32 v42, v176, v177
v_cvt_pk_bf16_f32 v43, v178, v179
buffer_store_dwordx4 v[40:43], v25, s[4:7], s66 offen offset:0 sc1
v_cvt_pk_bf16_f32 v44, v148, v149
v_cvt_pk_bf16_f32 v45, v150, v151
v_cvt_pk_bf16_f32 v46, v180, v181
v_cvt_pk_bf16_f32 v47, v182, v183
buffer_store_dwordx4 v[44:47], v25, s[4:7], s66 offen offset:1024 sc1
v_cvt_pk_bf16_f32 v48, v152, v153
v_cvt_pk_bf16_f32 v49, v154, v155
v_cvt_pk_bf16_f32 v50, v184, v185
v_cvt_pk_bf16_f32 v51, v186, v187
buffer_store_dwordx4 v[48:51], v25, s[4:7], s66 offen offset:2048 sc1
v_cvt_pk_bf16_f32 v52, v156, v157
v_cvt_pk_bf16_f32 v53, v158, v159
v_cvt_pk_bf16_f32 v54, v188, v189
v_cvt_pk_bf16_f32 v55, v190, v191
buffer_store_dwordx4 v[52:55], v25, s[4:7], s66 offen offset:3072 sc1
s_add_u32 s66, s48, 1572864
v_cvt_pk_bf16_f32 v56, v192, v193
v_cvt_pk_bf16_f32 v57, v194, v195
v_cvt_pk_bf16_f32 v58, v224, v225
v_cvt_pk_bf16_f32 v59, v226, v227
buffer_store_dwordx4 v[56:59], v24, s[4:7], s66 offen offset:0 sc1
v_cvt_pk_bf16_f32 v36, v196, v197
v_cvt_pk_bf16_f32 v37, v198, v199
v_cvt_pk_bf16_f32 v38, v228, v229
v_cvt_pk_bf16_f32 v39, v230, v231
buffer_store_dwordx4 v[36:39], v24, s[4:7], s66 offen offset:1024 sc1
v_cvt_pk_bf16_f32 v40, v200, v201
v_cvt_pk_bf16_f32 v41, v202, v203
v_cvt_pk_bf16_f32 v42, v232, v233
v_cvt_pk_bf16_f32 v43, v234, v235
buffer_store_dwordx4 v[40:43], v24, s[4:7], s66 offen offset:2048 sc1
v_cvt_pk_bf16_f32 v44, v204, v205
v_cvt_pk_bf16_f32 v45, v206, v207
v_cvt_pk_bf16_f32 v46, v236, v237
v_cvt_pk_bf16_f32 v47, v238, v239
buffer_store_dwordx4 v[44:47], v24, s[4:7], s66 offen offset:3072 sc1
v_cvt_pk_bf16_f32 v48, v208, v209
v_cvt_pk_bf16_f32 v49, v210, v211
v_cvt_pk_bf16_f32 v50, v240, v241
v_cvt_pk_bf16_f32 v51, v242, v243
buffer_store_dwordx4 v[48:51], v25, s[4:7], s66 offen offset:0 sc1
v_cvt_pk_bf16_f32 v52, v212, v213
v_cvt_pk_bf16_f32 v53, v214, v215
v_cvt_pk_bf16_f32 v54, v244, v245
v_cvt_pk_bf16_f32 v55, v246, v247
buffer_store_dwordx4 v[52:55], v25, s[4:7], s66 offen offset:1024 sc1
v_cvt_pk_bf16_f32 v56, v216, v217
v_cvt_pk_bf16_f32 v57, v218, v219
v_cvt_pk_bf16_f32 v58, v248, v249
v_cvt_pk_bf16_f32 v59, v250, v251
buffer_store_dwordx4 v[56:59], v25, s[4:7], s66 offen offset:2048 sc1
v_cvt_pk_bf16_f32 v36, v220, v221
v_cvt_pk_bf16_f32 v37, v222, v223
v_cvt_pk_bf16_f32 v38, v252, v253
v_cvt_pk_bf16_f32 v39, v254, v255
buffer_store_dwordx4 v[36:39], v25, s[4:7], s66 offen offset:3072 sc1
s_add_u32 s66, s48, 2359296
v_accvgpr_read_b32 v26, a128
v_accvgpr_read_b32 v27, a129
v_accvgpr_read_b32 v28, a130
v_accvgpr_read_b32 v29, a131
v_accvgpr_read_b32 v30, a160
v_accvgpr_read_b32 v31, a161
v_accvgpr_read_b32 v32, a162
v_accvgpr_read_b32 v33, a163
v_cvt_pk_bf16_f32 v40, v26, v27
v_cvt_pk_bf16_f32 v41, v28, v29
v_cvt_pk_bf16_f32 v42, v30, v31
v_cvt_pk_bf16_f32 v43, v32, v33
buffer_store_dwordx4 v[40:43], v24, s[4:7], s66 offen offset:0 sc1
v_accvgpr_read_b32 v26, a132
v_accvgpr_read_b32 v27, a133
v_accvgpr_read_b32 v28, a134
v_accvgpr_read_b32 v29, a135
v_accvgpr_read_b32 v30, a164
v_accvgpr_read_b32 v31, a165
v_accvgpr_read_b32 v32, a166
v_accvgpr_read_b32 v33, a167
v_cvt_pk_bf16_f32 v44, v26, v27
v_cvt_pk_bf16_f32 v45, v28, v29
v_cvt_pk_bf16_f32 v46, v30, v31
v_cvt_pk_bf16_f32 v47, v32, v33
buffer_store_dwordx4 v[44:47], v24, s[4:7], s66 offen offset:1024 sc1
v_accvgpr_read_b32 v26, a136
v_accvgpr_read_b32 v27, a137
v_accvgpr_read_b32 v28, a138
v_accvgpr_read_b32 v29, a139
v_accvgpr_read_b32 v30, a168
v_accvgpr_read_b32 v31, a169
v_accvgpr_read_b32 v32, a170
v_accvgpr_read_b32 v33, a171
v_cvt_pk_bf16_f32 v48, v26, v27
v_cvt_pk_bf16_f32 v49, v28, v29
v_cvt_pk_bf16_f32 v50, v30, v31
v_cvt_pk_bf16_f32 v51, v32, v33
buffer_store_dwordx4 v[48:51], v24, s[4:7], s66 offen offset:2048 sc1
v_accvgpr_read_b32 v26, a140
v_accvgpr_read_b32 v27, a141
v_accvgpr_read_b32 v28, a142
v_accvgpr_read_b32 v29, a143
v_accvgpr_read_b32 v30, a172
v_accvgpr_read_b32 v31, a173
v_accvgpr_read_b32 v32, a174
v_accvgpr_read_b32 v33, a175
v_cvt_pk_bf16_f32 v52, v26, v27
v_cvt_pk_bf16_f32 v53, v28, v29
v_cvt_pk_bf16_f32 v54, v30, v31
v_cvt_pk_bf16_f32 v55, v32, v33
buffer_store_dwordx4 v[52:55], v24, s[4:7], s66 offen offset:3072 sc1
v_accvgpr_read_b32 v26, a144
v_accvgpr_read_b32 v27, a145
v_accvgpr_read_b32 v28, a146
v_accvgpr_read_b32 v29, a147
v_accvgpr_read_b32 v30, a176
v_accvgpr_read_b32 v31, a177
v_accvgpr_read_b32 v32, a178
v_accvgpr_read_b32 v33, a179
v_cvt_pk_bf16_f32 v56, v26, v27
v_cvt_pk_bf16_f32 v57, v28, v29
v_cvt_pk_bf16_f32 v58, v30, v31
v_cvt_pk_bf16_f32 v59, v32, v33
buffer_store_dwordx4 v[56:59], v25, s[4:7], s66 offen offset:0 sc1
v_accvgpr_read_b32 v26, a148
v_accvgpr_read_b32 v27, a149
v_accvgpr_read_b32 v28, a150
v_accvgpr_read_b32 v29, a151
v_accvgpr_read_b32 v30, a180
v_accvgpr_read_b32 v31, a181
v_accvgpr_read_b32 v32, a182
v_accvgpr_read_b32 v33, a183
v_cvt_pk_bf16_f32 v36, v26, v27
v_cvt_pk_bf16_f32 v37, v28, v29
v_cvt_pk_bf16_f32 v38, v30, v31
v_cvt_pk_bf16_f32 v39, v32, v33
buffer_store_dwordx4 v[36:39], v25, s[4:7], s66 offen offset:1024 sc1
v_accvgpr_read_b32 v26, a152
v_accvgpr_read_b32 v27, a153
v_accvgpr_read_b32 v28, a154
v_accvgpr_read_b32 v29, a155
v_accvgpr_read_b32 v30, a184
v_accvgpr_read_b32 v31, a185
v_accvgpr_read_b32 v32, a186
v_accvgpr_read_b32 v33, a187
v_cvt_pk_bf16_f32 v40, v26, v27
v_cvt_pk_bf16_f32 v41, v28, v29
v_cvt_pk_bf16_f32 v42, v30, v31
v_cvt_pk_bf16_f32 v43, v32, v33
buffer_store_dwordx4 v[40:43], v25, s[4:7], s66 offen offset:2048 sc1
v_accvgpr_read_b32 v26, a156
v_accvgpr_read_b32 v27, a157
v_accvgpr_read_b32 v28, a158
v_accvgpr_read_b32 v29, a159
v_accvgpr_read_b32 v30, a188
v_accvgpr_read_b32 v31, a189
v_accvgpr_read_b32 v32, a190
v_accvgpr_read_b32 v33, a191
v_cvt_pk_bf16_f32 v44, v26, v27
v_cvt_pk_bf16_f32 v45, v28, v29
v_cvt_pk_bf16_f32 v46, v30, v31
v_cvt_pk_bf16_f32 v47, v32, v33
buffer_store_dwordx4 v[44:47], v25, s[4:7], s66 offen offset:3072 sc1
s_endpgm
Lend_4:
s_endpgm
.globl chain_kernel
.p2align 8
.type chain_kernel,@function
chain_kernel:
s_cmp_ge_u32 s2, 256
s_cbranch_scc1 Lend_8
s_load_dwordx8 s[16:23], s[0:1], 8
s_load_dwordx2 s[24:25], s[0:1], 40
s_load_dwordx4 s[28:31], s[0:1], 112
s_getreg_b32 s51, hwreg(HW_REG_XCC_ID, 0, 4)
s_and_b32 s51, s51, 7
v_lshrrev_b32 v1, 6, v0
s_nop 0
v_readfirstlane_b32 s32, v1
v_and_b32 v1, 63, v0
s_waitcnt lgkmcnt(0)
s_mov_b32 s4, s30
s_and_b32 s5, s31, 0xffff
s_mov_b32 s6, 0x10000000
s_mov_b32 s7, 0x20000
s_mov_b32 s12, s28
s_and_b32 s13, s29, 0xffff
s_mov_b32 s14, 0x100
s_mov_b32 s15, 0x20000
s_mov_b32 s37, 200000
s_mov_b32 s80, 0
s_mov_b32 s81, 0
s_mov_b32 s82, 0
s_mov_b32 s83, 0
s_cmp_lg_u32 s32, 0
s_cbranch_scc1 Lrs_12
s_mov_b32 s33, s51
s_mov_b32 s35, 0
s_mov_b64 exec, 1
Lrl_11:
v_lshlrev_b32 v2, 2, s33
v_mov_b32 v3, 1
buffer_atomic_add v3, v2, s[12:15], 0 offen sc0 sc1
s_waitcnt vmcnt(0)
v_readfirstlane_b32 s34, v3
s_nop 3
s_cmp_lt_u32 s34, 32
s_cbranch_scc1 Lrg_10
s_add_u32 s33, s33, 1
s_and_b32 s33, s33, 7
s_add_u32 s35, s35, 1
s_cmp_lt_u32 s35, 8
s_cbranch_scc1 Lrl_11
Lrg_10:
s_lshl_b32 s38, s33, 8
s_min_u32 s34, s34, 255
s_or_b32 s38, s38, s34
s_lshl_b32 s39, s35, 16
s_or_b32 s38, s38, s39
v_mov_b32 v3, s38
v_mov_b32 v2, 0
ds_write_b32 v2, v3
s_mov_b64 exec, -1
Lrs_12:
s_waitcnt lgkmcnt(0)
s_barrier
v_mov_b32 v2, 0
ds_read_b32 v3, v2
s_waitcnt lgkmcnt(0)
v_readfirstlane_b32 s38, v3
s_barrier
s_and_b32 s34, s38, 255
s_bfe_u32 s33, s38, 0x80008
s_lshr_b32 s35, s38, 16
s_min_u32 s35, s35, 1
s_cmp_ge_u32 s34, 32
s_cbranch_scc1 Lend_8
s_cmp_ge_u32 s33, 4
s_cbranch_scc1 Lend_8
s_cmp_ge_u32 s34, 24
s_cbranch_scc1 Lend_8
s_cmp_ge_u32 s34, 8
s_cbranch_scc1 Lkvo_role_9
v_mov_b32 v48, v0
v_mov_b32 v50, v1
s_lshl_b32 s54, s33, 3
s_add_u32 s54, s54, s34
s_and_b32 s55, s32, 1
s_lshr_b32 s56, s32, 1
s_lshl_b32 s45, s33, 18
s_add_u32 s45, s45, 2097152
s_lshl_b32 s38, s32, 12
v_lshl_add_u32 v10, v50, 4, s38
s_lshl_b32 s38, s34, 11
s_add_u32 s39, s38, 16384
v_lshl_add_u32 v11, v50, 4, s39
s_lshl_b32 s39, s56, 10
s_add_u32 s38, s38, s39
s_lshl_b32 s39, s55, 3
s_add_u32 s39, s39, s38
s_add_u32 s39, s39, 32768
v_lshl_add_u32 v12, v50, 4, s39
v_xor_b32 v13, 8, v12
s_lshl_b32 s39, s55, 9
s_add_u32 s39, s39, s38
s_add_u32 s39, s39, 49152
v_bfe_u32 v51, v50, 5, 1
v_lshl_add_u32 v14, v51, 8, s39
v_and_b32 v51, 7, v50
v_lshl_add_u32 v14, v51, 5, v14
v_and_b32 v51, 16, v50
v_add_u32 v14, v14, v51
v_bfe_u32 v51, v50, 3, 1
v_lshl_add_u32 v14, v51, 30, v14
v_and_b32 v51, 1, v50
v_mul_u32_u24 v51, 0xaaaa, v51
v_add_u32 v15, 0x4444, v51
v_mov_b32 v200, 0
v_mov_b32 v201, 0
v_mov_b32 v202, 0
v_mov_b32 v203, 0
v_mov_b32 v204, 0
v_mov_b32 v205, 0
v_mov_b32 v206, 0
v_mov_b32 v207, 0
v_bfe_u32 v51, v50, 1, 2
v_lshlrev_b32 v51, 4, v51
v_bfe_u32 v52, v50, 3, 2
v_lshl_add_u32 v51, v52, 2, v51
v_and_b32 v53, 1, v50
v_lshlrev_b32 v51, 2, v51
v_mul_u32_u24 v53, 384, v53
v_lshrrev_b32 v54, 5, v50
v_mul_u32_u24 v52, 640, v54
v_add3_u32 v51, v51, v52, v53
s_mul_i32 s38, s32, 1280
v_add_u32 v18, s38, v51
v_and_b32 v51, 31, v50
v_lshlrev_b32 v51, 4, v51
v_lshl_add_u32 v51, v54, 3, v51
s_lshl_b32 s38, s32, 9
v_add_u32 v19, s38, v51
v_lshrrev_b32 v51, 4, v50
v_and_b32 v52, 7, v50
v_lshlrev_b32 v52, 4, v52
v_lshl_add_u32 v20, v51, 7, v52
v_lshlrev_b32 v51, 4, v50
s_mul_i32 s38, s32, 6144
v_add_u32 v21, s38, v51
s_add_u32 s57, s38, 32768
v_add_u32 v22, 40960, v51
s_lshl_b32 s38, s55, 12
s_add_u32 s38, s38, 32768
v_add_u32 v23, s38, v51
s_lshl_b32 s38, s32, 11
s_add_u32 s38, s38, 49152
v_add_u32 v24, s38, v51
v_xor_b32 v25, 2048, v24
s_lshl_b32 s59, s33, 12
s_add_u32 s59, s59, 3276800
s_lshl_b32 s38, s32, 8
v_lshl_add_u32 v192, v50, 2, s38
s_lshr_b32 s38, s34, 1
s_lshl_b32 s38, s38, 8
s_and_b32 s39, s34, 1
s_lshl_b32 s39, s39, 2
s_add_u32 s38, s38, s39
s_add_u32 s38, s38, 2048
v_min_u32 v52, 1, v48
v_lshl_add_u32 v193, v52, 30, s38
v_mov_b32 v197, 0
buffer_store_dword v197, v193, s[4:7], s59 offen sc1
s_lshr_b32 s38, s34, 2
s_lshl_b32 s38, s38, 14
s_and_b32 s39, s34, 3
s_lshl_b32 s39, s39, 11
s_add_u32 s38, s38, s39
s_lshl_b32 s39, s33, 16
s_add_u32 s38, s38, s39
v_lshl_add_u32 v198, v48, 3, s38
v_lshlrev_b32 v52, 2, v50
s_mov_b32 s38, 1048576
buffer_load_dword v53, v52, s[4:7], s38 offen
s_waitcnt vmcnt(0)
v_cmp_eq_u32 vcc, 1, v53
s_nop 4
s_and_b32 s46, vcc_lo, 0xff
s_lshl_b32 s38, s54, 2
s_add_u32 s38, s38, s32
s_lshl_b32 s38, s38, 12
s_lshl_b32 s39, s55, 10
s_add_u32 s38, s38, s39
v_add_u32 v26, s38, v51
v_xor_b32 v27, 4096, v26
v_mov_b32 v28, -1
v_mov_b32 v32, 0x3f803f80
v_mov_b32 v29, -1
v_mov_b32 v33, 0x3f803f80
v_mov_b32 v30, -1
v_mov_b32 v34, 0x3f803f80
v_mov_b32 v31, -1
v_mov_b32 v35, 0x3f803f80
v_and_b32 v51, 15, v50
s_lshl_b32 s38, s55, 4
v_add_u32 v51, s38, v51
v_lshrrev_b32 v52, 4, v50
v_lshlrev_b32 v52, 2, v52
v_mov_b32 v54, 0xf149f2ca
v_add_u32 v53, 0, v52
v_cmp_gt_u32 vcc, v53, v51
s_nop 1
v_cndmask_b32 v36, 0, v54, vcc
v_add_u32 v53, 1, v52
v_cmp_gt_u32 vcc, v53, v51
s_nop 1
v_cndmask_b32 v37, 0, v54, vcc
v_add_u32 v53, 2, v52
v_cmp_gt_u32 vcc, v53, v51
s_nop 1
v_cndmask_b32 v38, 0, v54, vcc
v_add_u32 v53, 3, v52
v_cmp_gt_u32 vcc, v53, v51
s_nop 1
v_cndmask_b32 v39, 0, v54, vcc
v_add_u32 v53, 16, v52
v_cmp_gt_u32 vcc, v53, v51
s_nop 1
v_cndmask_b32 v40, 0, v54, vcc
v_add_u32 v53, 17, v52
v_cmp_gt_u32 vcc, v53, v51
s_nop 1
v_cndmask_b32 v41, 0, v54, vcc
v_add_u32 v53, 18, v52
v_cmp_gt_u32 vcc, v53, v51
s_nop 1
v_cndmask_b32 v42, 0, v54, vcc
v_add_u32 v53, 19, v52
v_cmp_gt_u32 vcc, v53, v51
s_nop 1
v_cndmask_b32 v43, 0, v54, vcc
v_mov_b32 v0, 0
v_mov_b32 v1, 0
v_mov_b32 v2, 0
v_mov_b32 v3, 0
v_mov_b32 v4, 0
v_mov_b32 v5, 0
v_mov_b32 v6, 0
v_mov_b32 v7, 0
v_mov_b32 v8, 0
v_mov_b32 v9, 0
s_mov_b32 s48, 0x3e0293ee
s_mov_b32 s49, 0xbe0293ee
s_add_u32 s38, s45, 0
buffer_store_dwordx4 v[28:31], v14, s[4:7], s38 offen sc1
s_add_u32 s38, s45, 65536
buffer_store_dwordx4 v[28:31], v14, s[4:7], s38 offen sc1
s_add_u32 s38, s45, 131072
buffer_store_dwordx4 v[28:31], v14, s[4:7], s38 offen sc1
s_add_u32 s38, s45, 196608
buffer_store_dwordx4 v[28:31], v14, s[4:7], s38 offen sc1
s_lshl_b32 s52, s35, 16
s_or_b32 s52, s52, 1
s_waitcnt vmcnt(0)
s_barrier
s_cmp_lg_u32 s32, 0
s_cbranch_scc1 Lar_13
s_mov_b64 exec, 1
v_mov_b32 v48, 32
v_mov_b32 v49, s52
buffer_atomic_add v49, v48, s[12:15], 0 offen sc1
s_mov_b64 exec, -1
Lar_13:
v_lshrrev_b32 v55, 3, v50
v_and_b32 v56, 7, v50
v_lshlrev_b32 v56, 4, v56
v_lshl_add_u32 v51, v55, 13, v56
v_lshl_add_u32 v52, v55, 11, v56
s_mul_i32 s38, s32, 40960
v_and_b32 v56, 3, v50
v_lshl_add_u32 v56, v56, 3, s38
v_lshrrev_b32 v55, 2, v50
v_lshl_add_u32 v53, v55, 7, v56
v_and_b32 v54, 16, v50
v_bfe_u32 v55, v50, 5, 1
v_lshl_add_u32 v54, v55, 3, v54
v_bfe_u32 v55, v50, 3, 1
v_lshl_add_u32 v54, v55, 2, v54
v_bfe_u32 v55, v50, 2, 1
v_add_u32 v54, v54, v55
v_lshl_add_u32 v54, v54, 7, v56
s_mov_b32 s8, s18
s_and_b32 s9, s19, 0xffff
s_mov_b32 s10, 0x800000
s_mov_b32 s11, 0x20000
s_lshl_b32 s39, s32, 21
s_lshl_b32 s38, s54, 8
s_add_u32 s39, s39, s38
s_add_u32 s39, s39, 0
s_mul_i32 s38, s32, 40960
s_add_u32 m0, s38, 0
s_nop 0
buffer_load_dwordx4 v51, s[8:11], s39 offen lds
s_add_u32 m0, m0, 1024
s_add_u32 s39, s39, 65536
buffer_load_dwordx4 v51, s[8:11], s39 offen lds
s_add_u32 m0, m0, 1024
s_add_u32 s39, s39, 65536
buffer_load_dwordx4 v51, s[8:11], s39 offen lds
s_add_u32 m0, m0, 1024
s_add_u32 s39, s39, 65536
buffer_load_dwordx4 v51, s[8:11], s39 offen lds
s_add_u32 m0, m0, 1024
s_add_u32 s39, s39, 65536
buffer_load_dwordx4 v51, s[8:11], s39 offen lds
s_add_u32 m0, m0, 1024
s_add_u32 s39, s39, 65536
buffer_load_dwordx4 v51, s[8:11], s39 offen lds
s_add_u32 m0, m0, 1024
s_add_u32 s39, s39, 65536
buffer_load_dwordx4 v51, s[8:11], s39 offen lds
s_add_u32 m0, m0, 1024
s_add_u32 s39, s39, 65536
buffer_load_dwordx4 v51, s[8:11], s39 offen lds
s_lshl_b32 s39, s32, 21
s_lshl_b32 s38, s54, 8
s_add_u32 s39, s39, s38
s_add_u32 s39, s39, 128
s_mul_i32 s38, s32, 40960
s_add_u32 m0, s38, 8192
s_nop 0
buffer_load_dwordx4 v51, s[8:11], s39 offen lds
s_add_u32 m0, m0, 1024
s_add_u32 s39, s39, 65536
buffer_load_dwordx4 v51, s[8:11], s39 offen lds
s_add_u32 m0, m0, 1024
s_add_u32 s39, s39, 65536
buffer_load_dwordx4 v51, s[8:11], s39 offen lds
s_add_u32 m0, m0, 1024
s_add_u32 s39, s39, 65536
buffer_load_dwordx4 v51, s[8:11], s39 offen lds
s_add_u32 m0, m0, 1024
s_add_u32 s39, s39, 65536
buffer_load_dwordx4 v51, s[8:11], s39 offen lds
s_add_u32 m0, m0, 1024
s_add_u32 s39, s39, 65536
buffer_load_dwordx4 v51, s[8:11], s39 offen lds
s_add_u32 m0, m0, 1024
s_add_u32 s39, s39, 65536
buffer_load_dwordx4 v51, s[8:11], s39 offen lds
s_add_u32 m0, m0, 1024
s_add_u32 s39, s39, 65536
buffer_load_dwordx4 v51, s[8:11], s39 offen lds
s_lshl_b32 s39, s32, 21
s_lshl_b32 s38, s54, 8
s_add_u32 s39, s39, s38
s_add_u32 s39, s39, 524288
s_mul_i32 s38, s32, 40960
s_add_u32 m0, s38, 16384
s_nop 0
buffer_load_dwordx4 v51, s[8:11], s39 offen lds
s_add_u32 m0, m0, 1024
s_add_u32 s39, s39, 65536
buffer_load_dwordx4 v51, s[8:11], s39 offen lds
s_add_u32 m0, m0, 1024
s_add_u32 s39, s39, 65536
buffer_load_dwordx4 v51, s[8:11], s39 offen lds
s_add_u32 m0, m0, 1024
s_add_u32 s39, s39, 65536
buffer_load_dwordx4 v51, s[8:11], s39 offen lds
s_add_u32 m0, m0, 1024
s_add_u32 s39, s39, 65536
buffer_load_dwordx4 v51, s[8:11], s39 offen lds
s_add_u32 m0, m0, 1024
s_add_u32 s39, s39, 65536
buffer_load_dwordx4 v51, s[8:11], s39 offen lds
s_add_u32 m0, m0, 1024
s_add_u32 s39, s39, 65536
buffer_load_dwordx4 v51, s[8:11], s39 offen lds
s_add_u32 m0, m0, 1024
s_add_u32 s39, s39, 65536
buffer_load_dwordx4 v51, s[8:11], s39 offen lds
s_lshl_b32 s39, s32, 21
s_lshl_b32 s38, s54, 8
s_add_u32 s39, s39, s38
s_add_u32 s39, s39, 524416
s_mul_i32 s38, s32, 40960
s_add_u32 m0, s38, 24576
s_nop 0
buffer_load_dwordx4 v51, s[8:11], s39 offen lds
s_add_u32 m0, m0, 1024
s_add_u32 s39, s39, 65536
buffer_load_dwordx4 v51, s[8:11], s39 offen lds
s_add_u32 m0, m0, 1024
s_add_u32 s39, s39, 65536
buffer_load_dwordx4 v51, s[8:11], s39 offen lds
s_add_u32 m0, m0, 1024
s_add_u32 s39, s39, 65536
buffer_load_dwordx4 v51, s[8:11], s39 offen lds
s_add_u32 m0, m0, 1024
s_add_u32 s39, s39, 65536
buffer_load_dwordx4 v51, s[8:11], s39 offen lds
s_add_u32 m0, m0, 1024
s_add_u32 s39, s39, 65536
buffer_load_dwordx4 v51, s[8:11], s39 offen lds
s_add_u32 m0, m0, 1024
s_add_u32 s39, s39, 65536
buffer_load_dwordx4 v51, s[8:11], s39 offen lds
s_add_u32 m0, m0, 1024
s_add_u32 s39, s39, 65536
buffer_load_dwordx4 v51, s[8:11], s39 offen lds
s_lshl_b32 s39, s32, 21
s_lshl_b32 s38, s54, 8
s_add_u32 s39, s39, s38
s_add_u32 s39, s39, 1048576
s_mul_i32 s38, s32, 40960
s_add_u32 m0, s38, 32768
s_nop 0
buffer_load_dwordx4 v51, s[8:11], s39 offen lds
s_add_u32 m0, m0, 1024
s_add_u32 s39, s39, 65536
buffer_load_dwordx4 v51, s[8:11], s39 offen lds
s_add_u32 m0, m0, 1024
s_add_u32 s39, s39, 65536
buffer_load_dwordx4 v51, s[8:11], s39 offen lds
s_add_u32 m0, m0, 1024
s_add_u32 s39, s39, 65536
buffer_load_dwordx4 v51, s[8:11], s39 offen lds
s_add_u32 m0, m0, 1024
s_add_u32 s39, s39, 65536
buffer_load_dwordx4 v51, s[8:11], s39 offen lds
s_add_u32 m0, m0, 1024
s_add_u32 s39, s39, 65536
buffer_load_dwordx4 v51, s[8:11], s39 offen lds
s_add_u32 m0, m0, 1024
s_add_u32 s39, s39, 65536
buffer_load_dwordx4 v51, s[8:11], s39 offen lds
s_add_u32 m0, m0, 1024
s_add_u32 s39, s39, 65536
buffer_load_dwordx4 v51, s[8:11], s39 offen lds
s_waitcnt vmcnt(32)
ds_read_b64_tr_b16 a[0:1], v53 offset:0
ds_read_b64_tr_b16 a[2:3], v53 offset:2048
ds_read_b64_tr_b16 a[4:5], v53 offset:4096
ds_read_b64_tr_b16 a[6:7], v53 offset:6144
ds_read_b64_tr_b16 a[8:9], v53 offset:32
ds_read_b64_tr_b16 a[10:11], v53 offset:2080
ds_read_b64_tr_b16 a[12:13], v53 offset:4128
ds_read_b64_tr_b16 a[14:15], v53 offset:6176
ds_read_b64_tr_b16 a[16:17], v53 offset:64
ds_read_b64_tr_b16 a[18:19], v53 offset:2112
ds_read_b64_tr_b16 a[20:21], v53 offset:4160
ds_read_b64_tr_b16 a[22:23], v53 offset:6208
ds_read_b64_tr_b16 a[24:25], v53 offset:96
ds_read_b64_tr_b16 a[26:27], v53 offset:2144
ds_read_b64_tr_b16 a[28:29], v53 offset:4192
ds_read_b64_tr_b16 a[30:31], v53 offset:6240
s_waitcnt lgkmcnt(0)
s_lshl_b32 s39, s32, 21
s_lshl_b32 s38, s54, 8
s_add_u32 s39, s39, s38
s_add_u32 s39, s39, 1048704
s_mul_i32 s38, s32, 40960
s_add_u32 m0, s38, 0
s_nop 0
buffer_load_dwordx4 v51, s[8:11], s39 offen lds
s_add_u32 m0, m0, 1024
s_add_u32 s39, s39, 65536
buffer_load_dwordx4 v51, s[8:11], s39 offen lds
s_add_u32 m0, m0, 1024
s_add_u32 s39, s39, 65536
buffer_load_dwordx4 v51, s[8:11], s39 offen lds
s_add_u32 m0, m0, 1024
s_add_u32 s39, s39, 65536
buffer_load_dwordx4 v51, s[8:11], s39 offen lds
s_add_u32 m0, m0, 1024
s_add_u32 s39, s39, 65536
buffer_load_dwordx4 v51, s[8:11], s39 offen lds
s_add_u32 m0, m0, 1024
s_add_u32 s39, s39, 65536
buffer_load_dwordx4 v51, s[8:11], s39 offen lds
s_add_u32 m0, m0, 1024
s_add_u32 s39, s39, 65536
buffer_load_dwordx4 v51, s[8:11], s39 offen lds
s_add_u32 m0, m0, 1024
s_add_u32 s39, s39, 65536
buffer_load_dwordx4 v51, s[8:11], s39 offen lds
s_waitcnt vmcnt(32)
ds_read_b64_tr_b16 a[32:33], v53 offset:8192
ds_read_b64_tr_b16 a[34:35], v53 offset:10240
ds_read_b64_tr_b16 a[36:37], v53 offset:12288
ds_read_b64_tr_b16 a[38:39], v53 offset:14336
ds_read_b64_tr_b16 a[40:41], v53 offset:8224
ds_read_b64_tr_b16 a[42:43], v53 offset:10272
ds_read_b64_tr_b16 a[44:45], v53 offset:12320
ds_read_b64_tr_b16 a[46:47], v53 offset:14368
ds_read_b64_tr_b16 a[48:49], v53 offset:8256
ds_read_b64_tr_b16 a[50:51], v53 offset:10304
ds_read_b64_tr_b16 a[52:53], v53 offset:12352
ds_read_b64_tr_b16 a[54:55], v53 offset:14400
ds_read_b64_tr_b16 a[56:57], v53 offset:8288
ds_read_b64_tr_b16 a[58:59], v53 offset:10336
ds_read_b64_tr_b16 a[60:61], v53 offset:12384
ds_read_b64_tr_b16 a[62:63], v53 offset:14432
s_waitcnt lgkmcnt(0)
s_lshl_b32 s39, s32, 21
s_lshl_b32 s38, s54, 8
s_add_u32 s39, s39, s38
s_add_u32 s39, s39, 1572864
s_mul_i32 s38, s32, 40960
s_add_u32 m0, s38, 8192
s_nop 0
buffer_load_dwordx4 v51, s[8:11], s39 offen lds
s_add_u32 m0, m0, 1024
s_add_u32 s39, s39, 65536
buffer_load_dwordx4 v51, s[8:11], s39 offen lds
s_add_u32 m0, m0, 1024
s_add_u32 s39, s39, 65536
buffer_load_dwordx4 v51, s[8:11], s39 offen lds
s_add_u32 m0, m0, 1024
s_add_u32 s39, s39, 65536
buffer_load_dwordx4 v51, s[8:11], s39 offen lds
s_add_u32 m0, m0, 1024
s_add_u32 s39, s39, 65536
buffer_load_dwordx4 v51, s[8:11], s39 offen lds
s_add_u32 m0, m0, 1024
s_add_u32 s39, s39, 65536
buffer_load_dwordx4 v51, s[8:11], s39 offen lds
s_add_u32 m0, m0, 1024
s_add_u32 s39, s39, 65536
buffer_load_dwordx4 v51, s[8:11], s39 offen lds
s_add_u32 m0, m0, 1024
s_add_u32 s39, s39, 65536
buffer_load_dwordx4 v51, s[8:11], s39 offen lds
s_waitcnt vmcnt(32)
ds_read_b64_tr_b16 a[64:65], v53 offset:16384
ds_read_b64_tr_b16 a[66:67], v53 offset:18432
ds_read_b64_tr_b16 a[68:69], v53 offset:20480
ds_read_b64_tr_b16 a[70:71], v53 offset:22528
ds_read_b64_tr_b16 a[72:73], v53 offset:16416
ds_read_b64_tr_b16 a[74:75], v53 offset:18464
ds_read_b64_tr_b16 a[76:77], v53 offset:20512
ds_read_b64_tr_b16 a[78:79], v53 offset:22560
ds_read_b64_tr_b16 a[80:81], v53 offset:16448
ds_read_b64_tr_b16 a[82:83], v53 offset:18496
ds_read_b64_tr_b16 a[84:85], v53 offset:20544
ds_read_b64_tr_b16 a[86:87], v53 offset:22592
ds_read_b64_tr_b16 a[88:89], v53 offset:16480
ds_read_b64_tr_b16 a[90:91], v53 offset:18528
ds_read_b64_tr_b16 a[92:93], v53 offset:20576
ds_read_b64_tr_b16 a[94:95], v53 offset:22624
s_waitcnt lgkmcnt(0)
s_lshl_b32 s39, s32, 21
s_lshl_b32 s38, s54, 8
s_add_u32 s39, s39, s38
s_add_u32 s39, s39, 1572992
s_mul_i32 s38, s32, 40960
s_add_u32 m0, s38, 16384
s_nop 0
buffer_load_dwordx4 v51, s[8:11], s39 offen lds
s_add_u32 m0, m0, 1024
s_add_u32 s39, s39, 65536
buffer_load_dwordx4 v51, s[8:11], s39 offen lds
s_add_u32 m0, m0, 1024
s_add_u32 s39, s39, 65536
buffer_load_dwordx4 v51, s[8:11], s39 offen lds
s_add_u32 m0, m0, 1024
s_add_u32 s39, s39, 65536
buffer_load_dwordx4 v51, s[8:11], s39 offen lds
s_add_u32 m0, m0, 1024
s_add_u32 s39, s39, 65536
buffer_load_dwordx4 v51, s[8:11], s39 offen lds
s_add_u32 m0, m0, 1024
s_add_u32 s39, s39, 65536
buffer_load_dwordx4 v51, s[8:11], s39 offen lds
s_add_u32 m0, m0, 1024
s_add_u32 s39, s39, 65536
buffer_load_dwordx4 v51, s[8:11], s39 offen lds
s_add_u32 m0, m0, 1024
s_add_u32 s39, s39, 65536
buffer_load_dwordx4 v51, s[8:11], s39 offen lds
s_waitcnt vmcnt(32)
ds_read_b64_tr_b16 a[96:97], v53 offset:24576
ds_read_b64_tr_b16 a[98:99], v53 offset:26624
ds_read_b64_tr_b16 a[100:101], v53 offset:28672
ds_read_b64_tr_b16 a[102:103], v53 offset:30720
ds_read_b64_tr_b16 a[104:105], v53 offset:24608
ds_read_b64_tr_b16 a[106:107], v53 offset:26656
ds_read_b64_tr_b16 a[108:109], v53 offset:28704
ds_read_b64_tr_b16 a[110:111], v53 offset:30752
ds_read_b64_tr_b16 a[112:113], v53 offset:24640
ds_read_b64_tr_b16 a[114:115], v53 offset:26688
ds_read_b64_tr_b16 a[116:117], v53 offset:28736
ds_read_b64_tr_b16 a[118:119], v53 offset:30784
ds_read_b64_tr_b16 a[120:121], v53 offset:24672
ds_read_b64_tr_b16 a[122:123], v53 offset:26720
ds_read_b64_tr_b16 a[124:125], v53 offset:28768
ds_read_b64_tr_b16 a[126:127], v53 offset:30816
s_waitcnt lgkmcnt(0)
s_waitcnt vmcnt(24)
ds_read_b64_tr_b16 a[128:129], v53 offset:32768
ds_read_b64_tr_b16 a[130:131], v53 offset:34816
ds_read_b64_tr_b16 a[132:133], v53 offset:36864
ds_read_b64_tr_b16 a[134:135], v53 offset:38912
ds_read_b64_tr_b16 a[136:137], v53 offset:32800
ds_read_b64_tr_b16 a[138:139], v53 offset:34848
ds_read_b64_tr_b16 a[140:141], v53 offset:36896
ds_read_b64_tr_b16 a[142:143], v53 offset:38944
ds_read_b64_tr_b16 a[144:145], v53 offset:32832
ds_read_b64_tr_b16 a[146:147], v53 offset:34880
ds_read_b64_tr_b16 a[148:149], v53 offset:36928
ds_read_b64_tr_b16 a[150:151], v53 offset:38976
ds_read_b64_tr_b16 a[152:153], v53 offset:32864
ds_read_b64_tr_b16 a[154:155], v53 offset:34912
ds_read_b64_tr_b16 a[156:157], v53 offset:36960
ds_read_b64_tr_b16 a[158:159], v53 offset:39008
s_waitcnt lgkmcnt(0)
s_waitcnt vmcnt(16)
ds_read_b64_tr_b16 a[160:161], v53 offset:0
ds_read_b64_tr_b16 a[162:163], v53 offset:2048
ds_read_b64_tr_b16 a[164:165], v53 offset:4096
ds_read_b64_tr_b16 a[166:167], v53 offset:6144
ds_read_b64_tr_b16 a[168:169], v53 offset:32
ds_read_b64_tr_b16 a[170:171], v53 offset:2080
ds_read_b64_tr_b16 a[172:173], v53 offset:4128
ds_read_b64_tr_b16 a[174:175], v53 offset:6176
ds_read_b64_tr_b16 a[176:177], v53 offset:64
ds_read_b64_tr_b16 a[178:179], v53 offset:2112
ds_read_b64_tr_b16 a[180:181], v53 offset:4160
ds_read_b64_tr_b16 a[182:183], v53 offset:6208
ds_read_b64_tr_b16 a[184:185], v53 offset:96
ds_read_b64_tr_b16 a[186:187], v53 offset:2144
ds_read_b64_tr_b16 a[188:189], v53 offset:4192
ds_read_b64_tr_b16 a[190:191], v53 offset:6240
s_waitcnt lgkmcnt(0)
s_waitcnt vmcnt(8)
ds_read_b64_tr_b16 a[192:193], v53 offset:8192
ds_read_b64_tr_b16 a[194:195], v53 offset:10240
ds_read_b64_tr_b16 a[196:197], v53 offset:12288
ds_read_b64_tr_b16 a[198:199], v53 offset:14336
ds_read_b64_tr_b16 a[200:201], v53 offset:8224
ds_read_b64_tr_b16 a[202:203], v53 offset:10272
ds_read_b64_tr_b16 a[204:205], v53 offset:12320
ds_read_b64_tr_b16 a[206:207], v53 offset:14368
ds_read_b64_tr_b16 a[208:209], v53 offset:8256
ds_read_b64_tr_b16 a[210:211], v53 offset:10304
ds_read_b64_tr_b16 a[212:213], v53 offset:12352
ds_read_b64_tr_b16 a[214:215], v53 offset:14400
ds_read_b64_tr_b16 a[216:217], v53 offset:8288
ds_read_b64_tr_b16 a[218:219], v53 offset:10336
ds_read_b64_tr_b16 a[220:221], v53 offset:12384
ds_read_b64_tr_b16 a[222:223], v53 offset:14432
s_waitcnt lgkmcnt(0)
s_waitcnt vmcnt(0)
ds_read_b64_tr_b16 a[224:225], v53 offset:16384
ds_read_b64_tr_b16 a[226:227], v53 offset:18432
ds_read_b64_tr_b16 a[228:229], v53 offset:20480
ds_read_b64_tr_b16 a[230:231], v53 offset:22528
ds_read_b64_tr_b16 a[232:233], v53 offset:16416
ds_read_b64_tr_b16 a[234:235], v53 offset:18464
ds_read_b64_tr_b16 a[236:237], v53 offset:20512
ds_read_b64_tr_b16 a[238:239], v53 offset:22560
ds_read_b64_tr_b16 a[240:241], v53 offset:16448
ds_read_b64_tr_b16 a[242:243], v53 offset:18496
ds_read_b64_tr_b16 a[244:245], v53 offset:20544
ds_read_b64_tr_b16 a[246:247], v53 offset:22592
ds_read_b64_tr_b16 a[248:249], v53 offset:16480
ds_read_b64_tr_b16 a[250:251], v53 offset:18528
ds_read_b64_tr_b16 a[252:253], v53 offset:20576
ds_read_b64_tr_b16 a[254:255], v53 offset:22624
s_waitcnt lgkmcnt(0)
v_mov_b32 v48, 32
Lst_14:
s_sub_u32 s37, s37, 1
s_cbranch_scc1 Lend_8
buffer_load_dword v49, v48, s[12:15], 0 offen sc1
s_waitcnt vmcnt(0)
v_readfirstlane_b32 s38, v49
s_nop 3
s_and_b32 s39, s38, 0xffff
s_cmp_lg_u32 s39, 96
s_cbranch_scc1 Lst_14
s_bfe_u32 s35, s38, 0x80010
s_barrier
s_mul_i32 s47, s54, 24576
s_add_u32 s47, s47, 33554432
s_mov_b32 s36, 0
s_mov_b32 m0, s57
s_add_u32 s38, s47, 3072
buffer_load_dwordx4 v21, s[4:7], s47 offen offset:0 sc1 lds
buffer_load_dwordx4 v21, s[4:7], s47 offen offset:1024 sc1 lds
buffer_load_dwordx4 v21, s[4:7], s47 offen offset:2048 sc1 lds
s_add_u32 m0, s57, 3072
s_xor_b32 s57, s57, 98304
buffer_load_dwordx4 v21, s[4:7], s38 offen offset:0 sc1 lds
buffer_load_dwordx4 v21, s[4:7], s38 offen offset:1024 sc1 lds
buffer_load_dwordx4 v21, s[4:7], s38 offen offset:2048 sc1 lds
s_add_u32 s47, s47, 786432
s_mov_b32 m0, s57
s_add_u32 s38, s47, 3072
buffer_load_dwordx4 v21, s[4:7], s47 offen offset:0 sc1 lds
buffer_load_dwordx4 v21, s[4:7], s47 offen offset:1024 sc1 lds
buffer_load_dwordx4 v21, s[4:7], s47 offen offset:2048 sc1 lds
s_add_u32 m0, s57, 3072
s_xor_b32 s57, s57, 98304
buffer_load_dwordx4 v21, s[4:7], s38 offen offset:0 sc1 lds
buffer_load_dwordx4 v21, s[4:7], s38 offen offset:1024 sc1 lds
buffer_load_dwordx4 v21, s[4:7], s38 offen offset:2048 sc1 lds
s_add_u32 s47, s47, 786432
s_waitcnt vmcnt(6)
s_barrier
s_cmp_lg_u32 s35, 0
s_cbranch_scc1 Lq_sc1_15
Lq_16:
ds_read_b128 v[128:131], v22 offset:0
ds_read_b128 v[132:135], v22 offset:1024
ds_read_b128 v[136:139], v22 offset:2048
ds_read_b128 v[140:143], v22 offset:3072
ds_read_b128 v[144:147], v22 offset:4096
ds_read_b128 v[148:151], v22 offset:5120
ds_read_b128 v[152:155], v22 offset:6144
ds_read_b128 v[156:159], v22 offset:7168
ds_read_b128 v[160:163], v24 offset:0
ds_read_b128 v[164:167], v24 offset:1024
ds_read_b128 v[168:171], v25 offset:0
ds_read_b128 v[172:175], v25 offset:1024
ds_read_b128 v[176:179], v23 offset:0
ds_read_b128 v[180:183], v23 offset:1024
ds_read_b128 v[184:187], v23 offset:2048
ds_read_b128 v[188:191], v23 offset:3072
v_xor_b32 v22, 98304, v22
v_xor_b32 v24, 98304, v24
v_xor_b32 v25, 98304, v25
v_xor_b32 v23, 98304, v23
s_mul_i32 m0, s32, 5120
s_and_b32 s38, s36, 3
s_lshl_b32 s39, s38, 16
s_add_u32 s40, s39, s45
s_xor_b32 s42, s40, 0x20000
s_add_u32 s26, s36, 1
v_add_u32 v197, 1, v197
v_mov_b32 v64, 0
v_mov_b32 v65, 0
v_mov_b32 v66, 0
v_mov_b32 v67, 0
v_mov_b32 v68, 0
v_mov_b32 v69, 0
v_mov_b32 v70, 0
v_mov_b32 v71, 0
v_mov_b32 v72, 0
v_mov_b32 v73, 0
v_mov_b32 v74, 0
v_mov_b32 v75, 0
v_mov_b32 v76, 0
v_mov_b32 v77, 0
v_mov_b32 v78, 0
v_mov_b32 v79, 0
v_mov_b32 v80, 0
v_mov_b32 v81, 0
v_mov_b32 v82, 0
v_mov_b32 v83, 0
v_mov_b32 v84, 0
v_mov_b32 v85, 0
v_mov_b32 v86, 0
v_mov_b32 v87, 0
v_mov_b32 v88, 0
v_mov_b32 v89, 0
v_mov_b32 v90, 0
v_mov_b32 v91, 0
v_mov_b32 v92, 0
v_mov_b32 v93, 0
v_mov_b32 v94, 0
v_mov_b32 v95, 0
s_mov_b64 exec, 15
buffer_load_dword v194, v192, s[4:7], s59 offen sc1
s_nop 11
buffer_load_dword v195, v192, s[4:7], s59 offen sc1
s_nop 11
buffer_load_dword v196, v192, s[4:7], s59 offen sc1
Lft_18:
s_waitcnt vmcnt(2)
v_cmp_gt_u32 vcc, s26, v194
s_cbranch_vccz Lfg_17
buffer_load_dword v194, v192, s[4:7], s59 offen sc1
s_waitcnt vmcnt(2)
v_cmp_gt_u32 vcc, s26, v195
s_cbranch_vccz Lfg_17
buffer_load_dword v195, v192, s[4:7], s59 offen sc1
s_waitcnt vmcnt(2)
v_cmp_gt_u32 vcc, s26, v196
s_cbranch_vccz Lfg_17
buffer_load_dword v196, v192, s[4:7], s59 offen sc1
s_sub_u32 s37, s37, 1
s_cbranch_scc1 Lend_8
s_branch Lft_18
Lfg_17:
s_mov_b64 exec, -1
buffer_load_dwordx4 v[48:51], v10, s[4:7], s40 offen offset:0 sc1
v_mfma_f32_16x16x32_bf16 v[200:203], v[204:207], v[204:207], 0
v_mfma_f32_16x16x32_bf16 v[200:203], v[204:207], v[204:207], 0
v_mfma_f32_16x16x32_bf16 v[200:203], v[204:207], v[204:207], 0
v_mfma_f32_16x16x32_bf16 v[200:203], v[204:207], v[204:207], 0
buffer_load_dwordx4 v[52:55], v10, s[4:7], s40 offen offset:1024 sc1
v_mfma_f32_16x16x32_bf16 v[200:203], v[204:207], v[204:207], 0
v_mfma_f32_16x16x32_bf16 v[200:203], v[204:207], v[204:207], 0
v_mfma_f32_16x16x32_bf16 v[200:203], v[204:207], v[204:207], 0
v_mfma_f32_16x16x32_bf16 v[200:203], v[204:207], v[204:207], 0
buffer_load_dwordx4 v[56:59], v10, s[4:7], s40 offen offset:2048 sc1
v_mfma_f32_16x16x32_bf16 v[200:203], v[204:207], v[204:207], 0
v_mfma_f32_16x16x32_bf16 v[200:203], v[204:207], v[204:207], 0
v_mfma_f32_16x16x32_bf16 v[200:203], v[204:207], v[204:207], 0
v_mfma_f32_16x16x32_bf16 v[200:203], v[204:207], v[204:207], 0
buffer_load_dwordx4 v[60:63], v10, s[4:7], s40 offen offset:3072 sc1
v_mfma_f32_16x16x32_bf16 v[200:203], v[204:207], v[204:207], 0
s_waitcnt vmcnt(3)
v_max3_u32 v44, v48, v49, v50
v_max_u32 v44, v44, v51
v_cmp_eq_u32 vcc, -1, v44
s_cbranch_vccnz Lpf_21
v_smfmac_f32_16x16x64_bf16 v[64:67], v[48:51], a[0:7], v15
v_smfmac_f32_16x16x64_bf16 v[68:71], v[48:51], a[8:15], v15
v_smfmac_f32_16x16x64_bf16 v[72:75], v[48:51], a[16:23], v15
v_smfmac_f32_16x16x64_bf16 v[76:79], v[48:51], a[24:31], v15
v_smfmac_f32_16x16x64_bf16 v[80:83], v[48:51], a[32:39], v15
s_waitcnt vmcnt(2)
v_max3_u32 v44, v52, v53, v54
v_max_u32 v44, v44, v55
v_cmp_eq_u32 vcc, -1, v44
v_smfmac_f32_16x16x64_bf16 v[84:87], v[48:51], a[40:47], v15
v_smfmac_f32_16x16x64_bf16 v[88:91], v[48:51], a[48:55], v15
v_smfmac_f32_16x16x64_bf16 v[92:95], v[48:51], a[56:63], v15
s_cbranch_vccnz Lpf_22
v_smfmac_f32_16x16x64_bf16 v[64:67], v[52:55], a[64:71], v15
v_smfmac_f32_16x16x64_bf16 v[68:71], v[52:55], a[72:79], v15
v_smfmac_f32_16x16x64_bf16 v[72:75], v[52:55], a[80:87], v15
v_smfmac_f32_16x16x64_bf16 v[76:79], v[52:55], a[88:95], v15
v_smfmac_f32_16x16x64_bf16 v[80:83], v[52:55], a[96:103], v15
s_waitcnt vmcnt(1)
v_max3_u32 v44, v56, v57, v58
v_max_u32 v44, v44, v59
v_cmp_eq_u32 vcc, -1, v44
v_smfmac_f32_16x16x64_bf16 v[84:87], v[52:55], a[104:111], v15
v_smfmac_f32_16x16x64_bf16 v[88:91], v[52:55], a[112:119], v15
v_smfmac_f32_16x16x64_bf16 v[92:95], v[52:55], a[120:127], v15
s_cbranch_vccnz Lpf_23
v_smfmac_f32_16x16x64_bf16 v[64:67], v[56:59], a[128:135], v15
v_smfmac_f32_16x16x64_bf16 v[68:71], v[56:59], a[136:143], v15
v_smfmac_f32_16x16x64_bf16 v[72:75], v[56:59], a[144:151], v15
v_smfmac_f32_16x16x64_bf16 v[76:79], v[56:59], a[152:159], v15
v_smfmac_f32_16x16x64_bf16 v[80:83], v[56:59], a[160:167], v15
s_waitcnt vmcnt(0)
v_max3_u32 v44, v60, v61, v62
v_max_u32 v44, v44, v63
v_cmp_eq_u32 vcc, -1, v44
v_smfmac_f32_16x16x64_bf16 v[84:87], v[56:59], a[168:175], v15
v_smfmac_f32_16x16x64_bf16 v[88:91], v[56:59], a[176:183], v15
v_smfmac_f32_16x16x64_bf16 v[92:95], v[56:59], a[184:191], v15
s_cbranch_vccnz Lpf_24
v_smfmac_f32_16x16x64_bf16 v[64:67], v[60:63], a[192:199], v15
v_smfmac_f32_16x16x64_bf16 v[68:71], v[60:63], a[200:207], v15
v_smfmac_f32_16x16x64_bf16 v[72:75], v[60:63], a[208:215], v15
v_smfmac_f32_16x16x64_bf16 v[76:79], v[60:63], a[216:223], v15
v_smfmac_f32_16x16x64_bf16 v[80:83], v[60:63], a[224:231], v15
v_smfmac_f32_16x16x64_bf16 v[84:87], v[60:63], a[232:239], v15
v_smfmac_f32_16x16x64_bf16 v[88:91], v[60:63], a[240:247], v15
v_smfmac_f32_16x16x64_bf16 v[92:95], v[60:63], a[248:255], v15
Lpd_20:
s_nop 0
v_add_f32 v64, v64, v65
v_add_f32 v66, v66, v67
v_add_f32 v68, v68, v69
v_add_f32 v70, v70, v71
v_add_f32 v72, v72, v73
ds_write_addtid_b32 v64 offset:0
v_add_f32 v74, v74, v75
ds_write_addtid_b32 v66 offset:384
v_add_f32 v76, v76, v77
ds_write_addtid_b32 v68 offset:640
v_add_f32 v78, v78, v79
ds_write_addtid_b32 v70 offset:1024
v_add_f32 v80, v80, v81
ds_write_addtid_b32 v72 offset:1280
v_add_f32 v82, v82, v83
ds_write_addtid_b32 v74 offset:1664
v_add_f32 v84, v84, v85
ds_write_addtid_b32 v76 offset:1920
v_add_f32 v86, v86, v87
ds_write_addtid_b32 v78 offset:2304
v_add_f32 v88, v88, v89
ds_write_addtid_b32 v80 offset:2560
v_add_f32 v90, v90, v91
ds_write_addtid_b32 v82 offset:2944
v_add_f32 v92, v92, v93
ds_write_addtid_b32 v84 offset:3200
v_add_f32 v94, v94, v95
ds_write_addtid_b32 v86 offset:3584
ds_write_addtid_b32 v88 offset:3840
ds_write_addtid_b32 v90 offset:4224
ds_write_addtid_b32 v92 offset:4480
ds_write_addtid_b32 v94 offset:4864
Lqj_19:
v_mfma_f32_16x16x32_bf16 v[200:203], v[204:207], v[204:207], 0
v_mfma_f32_16x16x32_bf16 v[200:203], v[204:207], v[204:207], 0
s_waitcnt lgkmcnt(0)
s_barrier
ds_read_b128 v[76:79], v18 offset:0
ds_read_b128 v[80:83], v18 offset:5120
ds_read_b128 v[84:87], v18 offset:10240
ds_read_b128 v[88:91], v18 offset:15360
v_mov_b32 v72, 0
v_mov_b32 v73, 0
v_mov_b32 v74, 0
v_mov_b32 v75, 0
v_mfma_f32_16x16x32_bf16 v[200:203], v[204:207], v[204:207], 0
v_mfma_f32_16x16x32_bf16 v[200:203], v[204:207], v[204:207], 0
s_waitcnt lgkmcnt(0)
v_pk_add_f32 v[76:77], v[76:77], v[80:81]
v_pk_add_f32 v[84:85], v[84:85], v[88:89]
v_pk_add_f32 v[78:79], v[78:79], v[82:83]
v_pk_add_f32 v[86:87], v[86:87], v[90:91]
v_pk_add_f32 v[76:77], v[76:77], v[84:85]
v_pk_add_f32 v[78:79], v[78:79], v[86:87]
v_cvt_pk_bf16_f32 v76, v76, v77
v_cvt_pk_bf16_f32 v77, v78, v79
ds_write_b64 v19, v[76:77] offset:20480
buffer_load_dwordx4 v[112:115], v11, s[4:7], s40 offen offset:0 sc1
buffer_load_dwordx4 v[116:119], v11, s[4:7], s40 offen offset:1024 sc1
v_mfma_f32_16x16x32_bf16 v[200:203], v[204:207], v[204:207], 0
v_mfma_f32_16x16x32_bf16 v[200:203], v[204:207], v[204:207], 0
s_waitcnt lgkmcnt(0)
s_barrier
ds_read_b128 v[96:99], v20 offset:20480
ds_read_b128 v[100:103], v20 offset:20992
ds_read_b128 v[104:107], v20 offset:21504
ds_read_b128 v[108:111], v20 offset:22016
v_mfma_f32_16x16x32_bf16 v[200:203], v[204:207], v[204:207], 0
v_mfma_f32_16x16x32_bf16 v[200:203], v[204:207], v[204:207], 0
s_waitcnt lgkmcnt(3)
v_mfma_f32_16x16x32_bf16 v[64:67], v[128:131], v[96:99], 0
v_mfma_f32_16x16x32_bf16 v[68:71], v[144:147], v[96:99], 0
s_waitcnt lgkmcnt(2)
buffer_load_dwordx4 v[48:51], v11, s[4:7], s40 offen offset:0 sc1
v_mfma_f32_16x16x32_bf16 v[64:67], v[132:135], v[100:103], v[64:67]
v_mfma_f32_16x16x32_bf16 v[68:71], v[148:151], v[100:103], v[68:71]
s_waitcnt lgkmcnt(1)
buffer_load_dwordx4 v[52:55], v11, s[4:7], s40 offen offset:1024 sc1
v_mfma_f32_16x16x32_bf16 v[64:67], v[136:139], v[104:107], v[64:67]
v_mfma_f32_16x16x32_bf16 v[68:71], v[152:155], v[104:107], v[68:71]
s_waitcnt lgkmcnt(0)
s_waitcnt vmcnt(2)
v_max3_u32 v44, v112, v113, v114
v_max3_u32 v44, v44, v115, v116
v_max3_u32 v44, v44, v117, v118
v_max_u32 v44, v44, v119
v_cmp_eq_u32 vcc, -1, v44
v_mfma_f32_16x16x32_bf16 v[64:67], v[140:143], v[108:111], v[64:67]
v_mfma_f32_16x16x32_bf16 v[68:71], v[156:159], v[108:111], v[68:71]
s_cbranch_vccnz Lkr_25
v_smfmac_f32_16x16x64_bf16 v[72:75], v[112:115], v[96:103], v15
v_smfmac_f32_16x16x64_bf16 v[72:75], v[116:119], v[104:111], v15
Lko_26:
s_nop 3
v_max3_f32 v45, v64, v65, v66
v_max3_f32 v45, v45, v67, v68
v_max3_f32 v45, v45, v69, v70
v_max_f32 v45, v45, v71
v_add_f32 v72, v72, v73
v_add_f32 v73, v74, v75
v_max3_f32 v46, v45, v72, v73
v_max3_f32 v47, v45, v72, v73
buffer_load_dwordx2 v[120:121], v12, s[4:7], s40 offen sc1
buffer_load_dwordx2 v[122:123], v13, s[4:7], s40 offen sc1
s_nop 1
v_permlane32_swap_b32 v46, v47
s_nop 0
v_max_f32 v45, v46, v47
v_max_f32 v46, v46, v47
s_nop 1
v_permlane16_swap_b32 v45, v46
s_nop 0
v_max_f32 v45, v45, v46
v_mul_f32 v46, s49, v45
v_pk_fma_f32 v[64:65], v[64:65], s[48:49], v[46:47] op_sel_hi:[1,0,0]
v_pk_fma_f32 v[66:67], v[66:67], s[48:49], v[46:47] op_sel_hi:[1,0,0]
v_pk_fma_f32 v[68:69], v[68:69], s[48:49], v[46:47] op_sel_hi:[1,0,0]
v_pk_fma_f32 v[70:71], v[70:71], s[48:49], v[46:47] op_sel_hi:[1,0,0]
v_pk_fma_f32 v[72:73], v[72:73], s[48:49], v[46:47] op_sel_hi:[1,0,0]
v_exp_f32 v64, v64
v_exp_f32 v65, v65
v_exp_f32 v66, v66
v_exp_f32 v67, v67
v_exp_f32 v68, v68
v_exp_f32 v69, v69
v_exp_f32 v70, v70
v_exp_f32 v71, v71
v_exp_f32 v72, v72
v_exp_f32 v73, v73
buffer_store_dword v197, v193, s[4:7], s59 offen
v_cvt_pk_bf16_f32 v76, v64, v65
v_cvt_pk_bf16_f32 v77, v66, v67
v_cvt_pk_bf16_f32 v78, v68, v69
v_cvt_pk_bf16_f32 v79, v70, v71
v_cvt_pk_bf16_f32 v2, v72, v73
v_cvt_pk_bf16_f32 v7, v72, v73
v_mfma_f32_16x16x32_bf16 v[84:87], v[32:35], v[76:79], 0
v_mfma_f32_16x16x32_bf16 v[96:99], v[160:163], v[76:79], 0
s_waitcnt vmcnt(1)
v_max3_u32 v44, v120, v121, v122
v_max_u32 v44, v44, v123
v_cmp_eq_u32 vcc, -1, v44
v_mfma_f32_16x16x32_bf16 v[100:103], v[164:167], v[76:79], 0
v_mfma_f32_16x16x32_bf16 v[84:87], v[32:35], v[2:5], v[84:87]
s_cbranch_vccnz Lvr_27
Lvo_28:
v_mfma_f32_16x16x32_bf16 v[96:99], v[120:123], v[2:5], v[96:99]
v_mfma_f32_16x16x32_bf16 v[100:103], v[120:123], v[6:9], v[100:103]
v_mfma_f32_16x16x32_bf16 v[200:203], v[204:207], v[204:207], 0
s_nop 4
v_rcp_f32 v46, v84
s_nop 0
v_pk_mul_f32 v[96:97], v[96:97], v[46:47] op_sel_hi:[1,0]
v_pk_mul_f32 v[98:99], v[98:99], v[46:47] op_sel_hi:[1,0]
v_pk_mul_f32 v[100:101], v[100:101], v[46:47] op_sel_hi:[1,0]
v_pk_mul_f32 v[102:103], v[102:103], v[46:47] op_sel_hi:[1,0]
v_cvt_pk_bf16_f32 v124, v96, v97
v_cvt_pk_bf16_f32 v125, v98, v99
v_cvt_pk_bf16_f32 v126, v100, v101
v_cvt_pk_bf16_f32 v127, v102, v103
v_min_u32 v124, -2, v124
v_min_u32 v125, -2, v125
v_min_u32 v126, -2, v126
v_min_u32 v127, -2, v127
buffer_store_dwordx4 v[124:127], v14, s[4:7], s40 offen
s_barrier
buffer_store_dwordx4 v[28:31], v14, s[4:7], s42 offen
s_cmp_ge_u32 s36, 62
s_cbranch_scc1 Lnp_29
s_mov_b32 m0, s57
s_add_u32 s38, s47, 3072
buffer_load_dwordx4 v21, s[4:7], s47 offen offset:0 sc1 lds
buffer_load_dwordx4 v21, s[4:7], s47 offen offset:1024 sc1 lds
buffer_load_dwordx4 v21, s[4:7], s47 offen offset:2048 sc1 lds
s_add_u32 m0, s57, 3072
s_xor_b32 s57, s57, 98304
buffer_load_dwordx4 v21, s[4:7], s38 offen offset:0 sc1 lds
buffer_load_dwordx4 v21, s[4:7], s38 offen offset:1024 sc1 lds
buffer_load_dwordx4 v21, s[4:7], s38 offen offset:2048 sc1 lds
s_add_u32 s47, s47, 786432
s_add_u32 s38, s36, 2
s_and_b32 s38, s38, 3
s_lshl_b32 s39, s38, 1
s_lshr_b32 s52, s46, s39
s_and_b32 s52, s52, 1
s_lshl_b32 s52, s52, 13
s_lshl_b32 s39, s39, 21
s_add_u32 s39, s39, s52
s_add_u32 s88, s39, 134217728
s_lshl_b32 s39, s38, 1
s_lshr_b32 s52, s46, s39
s_and_b32 s52, s52, 1
s_lshl_b32 s52, s52, 13
s_lshl_b32 s39, s39, 21
s_add_u32 s39, s39, s52
s_add_u32 s89, s39, 135266304
buffer_store_dwordx2 v[28:29], v198, s[4:7], s88 offen sc1
buffer_store_dwordx2 v[28:29], v198, s[4:7], s89 offen sc1
Lnp_29:
v_mov_b32 v72, 0
v_mov_b32 v73, 0
v_mov_b32 v74, 0
v_mov_b32 v75, 0
v_mfma_f32_16x16x32_bf16 v[64:67], v[128:131], v[176:179], v[36:39]
v_mfma_f32_16x16x32_bf16 v[68:71], v[144:147], v[176:179], v[40:43]
v_mfma_f32_16x16x32_bf16 v[64:67], v[132:135], v[180:183], v[64:67]
v_mfma_f32_16x16x32_bf16 v[68:71], v[148:151], v[180:183], v[68:71]
v_mfma_f32_16x16x32_bf16 v[64:67], v[136:139], v[184:187], v[64:67]
v_mfma_f32_16x16x32_bf16 v[68:71], v[152:155], v[184:187], v[68:71]
v_mfma_f32_16x16x32_bf16 v[64:67], v[140:143], v[188:191], v[64:67]
v_mfma_f32_16x16x32_bf16 v[68:71], v[156:159], v[188:191], v[68:71]
v_smfmac_f32_16x16x64_bf16 v[72:75], v[112:115], v[176:183], v15
v_smfmac_f32_16x16x64_bf16 v[72:75], v[116:119], v[184:191], v15
s_lshr_b32 s38, s36, 1
s_lshl_b32 s38, s38, 19
s_and_b32 s39, s36, 1
s_lshl_b32 s39, s39, 11
s_add_u32 s38, s38, s39
s_add_u32 s50, s38, 83886080
v_max3_f32 v45, v64, v65, v66
v_max3_f32 v45, v45, v67, v68
v_max3_f32 v45, v45, v69, v70
v_max_f32 v45, v45, v71
v_add_f32 v72, v72, v73
v_add_f32 v73, v74, v75
v_max3_f32 v46, v45, v72, v73
v_max3_f32 v47, v45, v72, v73
s_nop 1
v_permlane32_swap_b32 v46, v47
s_nop 0
v_max_f32 v45, v46, v47
v_max_f32 v46, v46, v47
s_nop 1
v_permlane16_swap_b32 v45, v46
s_nop 0
v_max_f32 v45, v45, v46
v_mul_f32 v46, s49, v45
v_pk_fma_f32 v[64:65], v[64:65], s[48:49], v[46:47] op_sel_hi:[1,0,0]
v_pk_fma_f32 v[66:67], v[66:67], s[48:49], v[46:47] op_sel_hi:[1,0,0]
v_pk_fma_f32 v[68:69], v[68:69], s[48:49], v[46:47] op_sel_hi:[1,0,0]
v_pk_fma_f32 v[70:71], v[70:71], s[48:49], v[46:47] op_sel_hi:[1,0,0]
v_pk_fma_f32 v[72:73], v[72:73], s[48:49], v[46:47] op_sel_hi:[1,0,0]
v_exp_f32 v64, v64
v_exp_f32 v65, v65
v_exp_f32 v66, v66
v_exp_f32 v67, v67
v_exp_f32 v68, v68
v_exp_f32 v69, v69
v_exp_f32 v70, v70
v_exp_f32 v71, v71
v_exp_f32 v72, v72
v_exp_f32 v73, v73
v_cvt_pk_bf16_f32 v76, v64, v65
v_cvt_pk_bf16_f32 v77, v66, v67
v_cvt_pk_bf16_f32 v78, v68, v69
v_cvt_pk_bf16_f32 v79, v70, v71
v_cvt_pk_bf16_f32 v2, v72, v73
v_cvt_pk_bf16_f32 v7, v72, v73
v_mfma_f32_16x16x32_bf16 v[84:87], v[32:35], v[76:79], 0
v_mfma_f32_16x16x32_bf16 v[96:99], v[160:163], v[76:79], 0
v_mfma_f32_16x16x32_bf16 v[100:103], v[164:167], v[76:79], 0
v_mfma_f32_16x16x32_bf16 v[104:107], v[168:171], v[76:79], 0
v_mfma_f32_16x16x32_bf16 v[108:111], v[172:175], v[76:79], 0
v_mfma_f32_16x16x32_bf16 v[84:87], v[32:35], v[2:5], v[84:87]
v_mfma_f32_16x16x32_bf16 v[96:99], v[120:123], v[2:5], v[96:99]
v_mfma_f32_16x16x32_bf16 v[100:103], v[120:123], v[6:9], v[100:103]
v_mfma_f32_16x16x32_bf16 v[104:107], v[120:123], v[0:3], v[104:107]
v_mfma_f32_16x16x32_bf16 v[108:111], v[120:123], v[4:7], v[108:111]
v_mfma_f32_16x16x32_bf16 v[200:203], v[204:207], v[204:207], 0
s_nop 2
v_rcp_f32 v46, v84
s_nop 0
v_pk_mul_f32 v[96:97], v[96:97], v[46:47] op_sel_hi:[1,0]
v_pk_mul_f32 v[98:99], v[98:99], v[46:47] op_sel_hi:[1,0]
v_pk_mul_f32 v[100:101], v[100:101], v[46:47] op_sel_hi:[1,0]
v_pk_mul_f32 v[102:103], v[102:103], v[46:47] op_sel_hi:[1,0]
v_pk_mul_f32 v[104:105], v[104:105], v[46:47] op_sel_hi:[1,0]
v_pk_mul_f32 v[106:107], v[106:107], v[46:47] op_sel_hi:[1,0]
v_pk_mul_f32 v[108:109], v[108:109], v[46:47] op_sel_hi:[1,0]
v_pk_mul_f32 v[110:111], v[110:111], v[46:47] op_sel_hi:[1,0]
v_cvt_pk_bf16_f32 v96, v96, v97
v_cvt_pk_bf16_f32 v97, v98, v99
v_cvt_pk_bf16_f32 v98, v100, v101
v_cvt_pk_bf16_f32 v99, v102, v103
v_cvt_pk_bf16_f32 v100, v104, v105
v_cvt_pk_bf16_f32 v101, v106, v107
v_cvt_pk_bf16_f32 v102, v108, v109
v_cvt_pk_bf16_f32 v103, v110, v111
buffer_store_dwordx4 v[96:99], v26, s[4:7], s50 offen sc1
buffer_store_dwordx4 v[100:103], v27, s[4:7], s50 offen sc1
s_add_u32 s36, s36, 1
s_cmp_lt_u32 s36, 64
s_cbranch_scc1 Lq_16
s_branch Lend_8
Lpf_21:
buffer_load_dwordx4 v[48:51], v10, s[4:7], s40 offen offset:0 sc1
v_mfma_f32_16x16x32_bf16 v[200:203], v[204:207], v[204:207], 0
s_sub_u32 s37, s37, 1
s_cbranch_scc1 Lend_8
Lps_30:
s_waitcnt vmcnt(3)
v_max3_u32 v44, v52, v53, v54
v_max_u32 v44, v44, v55
v_cmp_eq_u32 vcc, -1, v44
s_cbranch_vccnz Lpf_31
v_smfmac_f32_16x16x64_bf16 v[64:67], v[52:55], a[64:71], v15
v_smfmac_f32_16x16x64_bf16 v[68:71], v[52:55], a[72:79], v15
v_smfmac_f32_16x16x64_bf16 v[72:75], v[52:55], a[80:87], v15
v_smfmac_f32_16x16x64_bf16 v[76:79], v[52:55], a[88:95], v15
v_smfmac_f32_16x16x64_bf16 v[80:83], v[52:55], a[96:103], v15
v_smfmac_f32_16x16x64_bf16 v[84:87], v[52:55], a[104:111], v15
v_smfmac_f32_16x16x64_bf16 v[88:91], v[52:55], a[112:119], v15
v_smfmac_f32_16x16x64_bf16 v[92:95], v[52:55], a[120:127], v15
Lps_32:
s_waitcnt vmcnt(2)
v_max3_u32 v44, v56, v57, v58
v_max_u32 v44, v44, v59
v_cmp_eq_u32 vcc, -1, v44
s_cbranch_vccnz Lpf_33
v_smfmac_f32_16x16x64_bf16 v[64:67], v[56:59], a[128:135], v15
v_smfmac_f32_16x16x64_bf16 v[68:71], v[56:59], a[136:143], v15
v_smfmac_f32_16x16x64_bf16 v[72:75], v[56:59], a[144:151], v15
v_smfmac_f32_16x16x64_bf16 v[76:79], v[56:59], a[152:159], v15
v_smfmac_f32_16x16x64_bf16 v[80:83], v[56:59], a[160:167], v15
v_smfmac_f32_16x16x64_bf16 v[84:87], v[56:59], a[168:175], v15
v_smfmac_f32_16x16x64_bf16 v[88:91], v[56:59], a[176:183], v15
v_smfmac_f32_16x16x64_bf16 v[92:95], v[56:59], a[184:191], v15
Lps_34:
s_waitcnt vmcnt(1)
v_max3_u32 v44, v60, v61, v62
v_max_u32 v44, v44, v63
v_cmp_eq_u32 vcc, -1, v44
s_cbranch_vccnz Lpf_35
v_smfmac_f32_16x16x64_bf16 v[64:67], v[60:63], a[192:199], v15
v_smfmac_f32_16x16x64_bf16 v[68:71], v[60:63], a[200:207], v15
v_smfmac_f32_16x16x64_bf16 v[72:75], v[60:63], a[208:215], v15
v_smfmac_f32_16x16x64_bf16 v[76:79], v[60:63], a[216:223], v15
v_smfmac_f32_16x16x64_bf16 v[80:83], v[60:63], a[224:231], v15
v_smfmac_f32_16x16x64_bf16 v[84:87], v[60:63], a[232:239], v15
v_smfmac_f32_16x16x64_bf16 v[88:91], v[60:63], a[240:247], v15
v_smfmac_f32_16x16x64_bf16 v[92:95], v[60:63], a[248:255], v15
Lps_36:
s_waitcnt vmcnt(0)
v_max3_u32 v44, v48, v49, v50
v_max_u32 v44, v44, v51
v_cmp_eq_u32 vcc, -1, v44
s_cbranch_vccnz Lpf_37
v_smfmac_f32_16x16x64_bf16 v[64:67], v[48:51], a[0:7], v15
v_smfmac_f32_16x16x64_bf16 v[68:71], v[48:51], a[8:15], v15
v_smfmac_f32_16x16x64_bf16 v[72:75], v[48:51], a[16:23], v15
v_smfmac_f32_16x16x64_bf16 v[76:79], v[48:51], a[24:31], v15
v_smfmac_f32_16x16x64_bf16 v[80:83], v[48:51], a[32:39], v15
v_smfmac_f32_16x16x64_bf16 v[84:87], v[48:51], a[40:47], v15
v_smfmac_f32_16x16x64_bf16 v[88:91], v[48:51], a[48:55], v15
v_smfmac_f32_16x16x64_bf16 v[92:95], v[48:51], a[56:63], v15
s_branch Lpd_20
Lpf_22:
buffer_load_dwordx4 v[52:55], v10, s[4:7], s40 offen offset:1024 sc1
v_mfma_f32_16x16x32_bf16 v[200:203], v[204:207], v[204:207], 0
s_sub_u32 s37, s37, 1
s_cbranch_scc1 Lend_8
Lps_38:
s_waitcnt vmcnt(2)
v_max3_u32 v44, v56, v57, v58
v_max_u32 v44, v44, v59
v_cmp_eq_u32 vcc, -1, v44
s_cbranch_vccnz Lpf_39
v_smfmac_f32_16x16x64_bf16 v[64:67], v[56:59], a[128:135], v15
v_smfmac_f32_16x16x64_bf16 v[68:71], v[56:59], a[136:143], v15
v_smfmac_f32_16x16x64_bf16 v[72:75], v[56:59], a[144:151], v15
v_smfmac_f32_16x16x64_bf16 v[76:79], v[56:59], a[152:159], v15
v_smfmac_f32_16x16x64_bf16 v[80:83], v[56:59], a[160:167], v15
v_smfmac_f32_16x16x64_bf16 v[84:87], v[56:59], a[168:175], v15
v_smfmac_f32_16x16x64_bf16 v[88:91], v[56:59], a[176:183], v15
v_smfmac_f32_16x16x64_bf16 v[92:95], v[56:59], a[184:191], v15
Lps_40:
s_waitcnt vmcnt(1)
v_max3_u32 v44, v60, v61, v62
v_max_u32 v44, v44, v63
v_cmp_eq_u32 vcc, -1, v44
s_cbranch_vccnz Lpf_41
v_smfmac_f32_16x16x64_bf16 v[64:67], v[60:63], a[192:199], v15
v_smfmac_f32_16x16x64_bf16 v[68:71], v[60:63], a[200:207], v15
v_smfmac_f32_16x16x64_bf16 v[72:75], v[60:63], a[208:215], v15
v_smfmac_f32_16x16x64_bf16 v[76:79], v[60:63], a[216:223], v15
v_smfmac_f32_16x16x64_bf16 v[80:83], v[60:63], a[224:231], v15
v_smfmac_f32_16x16x64_bf16 v[84:87], v[60:63], a[232:239], v15
v_smfmac_f32_16x16x64_bf16 v[88:91], v[60:63], a[240:247], v15
v_smfmac_f32_16x16x64_bf16 v[92:95], v[60:63], a[248:255], v15
Lps_42:
s_waitcnt vmcnt(0)
v_max3_u32 v44, v52, v53, v54
v_max_u32 v44, v44, v55
v_cmp_eq_u32 vcc, -1, v44
s_cbranch_vccnz Lpf_43
v_smfmac_f32_16x16x64_bf16 v[64:67], v[52:55], a[64:71], v15
v_smfmac_f32_16x16x64_bf16 v[68:71], v[52:55], a[72:79], v15
v_smfmac_f32_16x16x64_bf16 v[72:75], v[52:55], a[80:87], v15
v_smfmac_f32_16x16x64_bf16 v[76:79], v[52:55], a[88:95], v15
v_smfmac_f32_16x16x64_bf16 v[80:83], v[52:55], a[96:103], v15
v_smfmac_f32_16x16x64_bf16 v[84:87], v[52:55], a[104:111], v15
v_smfmac_f32_16x16x64_bf16 v[88:91], v[52:55], a[112:119], v15
v_smfmac_f32_16x16x64_bf16 v[92:95], v[52:55], a[120:127], v15
s_branch Lpd_20
Lpf_23:
buffer_load_dwordx4 v[56:59], v10, s[4:7], s40 offen offset:2048 sc1
v_mfma_f32_16x16x32_bf16 v[200:203], v[204:207], v[204:207], 0
s_sub_u32 s37, s37, 1
s_cbranch_scc1 Lend_8
Lps_44:
s_waitcnt vmcnt(1)
v_max3_u32 v44, v60, v61, v62
v_max_u32 v44, v44, v63
v_cmp_eq_u32 vcc, -1, v44
s_cbranch_vccnz Lpf_45
v_smfmac_f32_16x16x64_bf16 v[64:67], v[60:63], a[192:199], v15
v_smfmac_f32_16x16x64_bf16 v[68:71], v[60:63], a[200:207], v15
v_smfmac_f32_16x16x64_bf16 v[72:75], v[60:63], a[208:215], v15
v_smfmac_f32_16x16x64_bf16 v[76:79], v[60:63], a[216:223], v15
v_smfmac_f32_16x16x64_bf16 v[80:83], v[60:63], a[224:231], v15
v_smfmac_f32_16x16x64_bf16 v[84:87], v[60:63], a[232:239], v15
v_smfmac_f32_16x16x64_bf16 v[88:91], v[60:63], a[240:247], v15
v_smfmac_f32_16x16x64_bf16 v[92:95], v[60:63], a[248:255], v15
Lps_46:
s_waitcnt vmcnt(0)
v_max3_u32 v44, v56, v57, v58
v_max_u32 v44, v44, v59
v_cmp_eq_u32 vcc, -1, v44
s_cbranch_vccnz Lpf_47
v_smfmac_f32_16x16x64_bf16 v[64:67], v[56:59], a[128:135], v15
v_smfmac_f32_16x16x64_bf16 v[68:71], v[56:59], a[136:143], v15
v_smfmac_f32_16x16x64_bf16 v[72:75], v[56:59], a[144:151], v15
v_smfmac_f32_16x16x64_bf16 v[76:79], v[56:59], a[152:159], v15
v_smfmac_f32_16x16x64_bf16 v[80:83], v[56:59], a[160:167], v15
v_smfmac_f32_16x16x64_bf16 v[84:87], v[56:59], a[168:175], v15
v_smfmac_f32_16x16x64_bf16 v[88:91], v[56:59], a[176:183], v15
v_smfmac_f32_16x16x64_bf16 v[92:95], v[56:59], a[184:191], v15
s_branch Lpd_20
Lpf_24:
buffer_load_dwordx4 v[60:63], v10, s[4:7], s40 offen offset:3072 sc1
v_mfma_f32_16x16x32_bf16 v[200:203], v[204:207], v[204:207], 0
s_sub_u32 s37, s37, 1
s_cbranch_scc1 Lend_8
Lps_48:
s_waitcnt vmcnt(0)
v_max3_u32 v44, v60, v61, v62
v_max_u32 v44, v44, v63
v_cmp_eq_u32 vcc, -1, v44
s_cbranch_vccnz Lpf_49
v_smfmac_f32_16x16x64_bf16 v[64:67], v[60:63], a[192:199], v15
v_smfmac_f32_16x16x64_bf16 v[68:71], v[60:63], a[200:207], v15
v_smfmac_f32_16x16x64_bf16 v[72:75], v[60:63], a[208:215], v15
v_smfmac_f32_16x16x64_bf16 v[76:79], v[60:63], a[216:223], v15
v_smfmac_f32_16x16x64_bf16 v[80:83], v[60:63], a[224:231], v15
v_smfmac_f32_16x16x64_bf16 v[84:87], v[60:63], a[232:239], v15
v_smfmac_f32_16x16x64_bf16 v[88:91], v[60:63], a[240:247], v15
v_smfmac_f32_16x16x64_bf16 v[92:95], v[60:63], a[248:255], v15
s_branch Lpd_20
Lpf_31:
buffer_load_dwordx4 v[52:55], v10, s[4:7], s40 offen offset:1024 sc1
v_mfma_f32_16x16x32_bf16 v[200:203], v[204:207], v[204:207], 0
Lps_50:
s_waitcnt vmcnt(3)
v_max3_u32 v44, v56, v57, v58
v_max_u32 v44, v44, v59
v_cmp_eq_u32 vcc, -1, v44
s_cbranch_vccnz Lpf_51
v_smfmac_f32_16x16x64_bf16 v[64:67], v[56:59], a[128:135], v15
v_smfmac_f32_16x16x64_bf16 v[68:71], v[56:59], a[136:143], v15
v_smfmac_f32_16x16x64_bf16 v[72:75], v[56:59], a[144:151], v15
v_smfmac_f32_16x16x64_bf16 v[76:79], v[56:59], a[152:159], v15
v_smfmac_f32_16x16x64_bf16 v[80:83], v[56:59], a[160:167], v15
v_smfmac_f32_16x16x64_bf16 v[84:87], v[56:59], a[168:175], v15
v_smfmac_f32_16x16x64_bf16 v[88:91], v[56:59], a[176:183], v15
v_smfmac_f32_16x16x64_bf16 v[92:95], v[56:59], a[184:191], v15
Lps_52:
s_waitcnt vmcnt(2)
v_max3_u32 v44, v60, v61, v62
v_max_u32 v44, v44, v63
v_cmp_eq_u32 vcc, -1, v44
s_cbranch_vccnz Lpf_53
v_smfmac_f32_16x16x64_bf16 v[64:67], v[60:63], a[192:199], v15
v_smfmac_f32_16x16x64_bf16 v[68:71], v[60:63], a[200:207], v15
v_smfmac_f32_16x16x64_bf16 v[72:75], v[60:63], a[208:215], v15
v_smfmac_f32_16x16x64_bf16 v[76:79], v[60:63], a[216:223], v15
v_smfmac_f32_16x16x64_bf16 v[80:83], v[60:63], a[224:231], v15
v_smfmac_f32_16x16x64_bf16 v[84:87], v[60:63], a[232:239], v15
v_smfmac_f32_16x16x64_bf16 v[88:91], v[60:63], a[240:247], v15
v_smfmac_f32_16x16x64_bf16 v[92:95], v[60:63], a[248:255], v15
Lps_54:
s_waitcnt vmcnt(1)
v_max3_u32 v44, v48, v49, v50
v_max_u32 v44, v44, v51
v_cmp_eq_u32 vcc, -1, v44
s_cbranch_vccnz Lpf_55
v_smfmac_f32_16x16x64_bf16 v[64:67], v[48:51], a[0:7], v15
v_smfmac_f32_16x16x64_bf16 v[68:71], v[48:51], a[8:15], v15
v_smfmac_f32_16x16x64_bf16 v[72:75], v[48:51], a[16:23], v15
v_smfmac_f32_16x16x64_bf16 v[76:79], v[48:51], a[24:31], v15
v_smfmac_f32_16x16x64_bf16 v[80:83], v[48:51], a[32:39], v15
v_smfmac_f32_16x16x64_bf16 v[84:87], v[48:51], a[40:47], v15
v_smfmac_f32_16x16x64_bf16 v[88:91], v[48:51], a[48:55], v15
v_smfmac_f32_16x16x64_bf16 v[92:95], v[48:51], a[56:63], v15
s_branch Lps_42
Lpf_33:
buffer_load_dwordx4 v[56:59], v10, s[4:7], s40 offen offset:2048 sc1
v_mfma_f32_16x16x32_bf16 v[200:203], v[204:207], v[204:207], 0
Lps_56:
s_waitcnt vmcnt(2)
v_max3_u32 v44, v60, v61, v62
v_max_u32 v44, v44, v63
v_cmp_eq_u32 vcc, -1, v44
s_cbranch_vccnz Lpf_57
v_smfmac_f32_16x16x64_bf16 v[64:67], v[60:63], a[192:199], v15
v_smfmac_f32_16x16x64_bf16 v[68:71], v[60:63], a[200:207], v15
v_smfmac_f32_16x16x64_bf16 v[72:75], v[60:63], a[208:215], v15
v_smfmac_f32_16x16x64_bf16 v[76:79], v[60:63], a[216:223], v15
v_smfmac_f32_16x16x64_bf16 v[80:83], v[60:63], a[224:231], v15
v_smfmac_f32_16x16x64_bf16 v[84:87], v[60:63], a[232:239], v15
v_smfmac_f32_16x16x64_bf16 v[88:91], v[60:63], a[240:247], v15
v_smfmac_f32_16x16x64_bf16 v[92:95], v[60:63], a[248:255], v15
Lps_58:
s_waitcnt vmcnt(1)
v_max3_u32 v44, v48, v49, v50
v_max_u32 v44, v44, v51
v_cmp_eq_u32 vcc, -1, v44
s_cbranch_vccnz Lpf_59
v_smfmac_f32_16x16x64_bf16 v[64:67], v[48:51], a[0:7], v15
v_smfmac_f32_16x16x64_bf16 v[68:71], v[48:51], a[8:15], v15
v_smfmac_f32_16x16x64_bf16 v[72:75], v[48:51], a[16:23], v15
v_smfmac_f32_16x16x64_bf16 v[76:79], v[48:51], a[24:31], v15
v_smfmac_f32_16x16x64_bf16 v[80:83], v[48:51], a[32:39], v15
v_smfmac_f32_16x16x64_bf16 v[84:87], v[48:51], a[40:47], v15
v_smfmac_f32_16x16x64_bf16 v[88:91], v[48:51], a[48:55], v15
v_smfmac_f32_16x16x64_bf16 v[92:95], v[48:51], a[56:63], v15
s_branch Lps_46
Lpf_35:
buffer_load_dwordx4 v[60:63], v10, s[4:7], s40 offen offset:3072 sc1
v_mfma_f32_16x16x32_bf16 v[200:203], v[204:207], v[204:207], 0
Lps_60:
s_waitcnt vmcnt(1)
v_max3_u32 v44, v48, v49, v50
v_max_u32 v44, v44, v51
v_cmp_eq_u32 vcc, -1, v44
s_cbranch_vccnz Lpf_61
v_smfmac_f32_16x16x64_bf16 v[64:67], v[48:51], a[0:7], v15
v_smfmac_f32_16x16x64_bf16 v[68:71], v[48:51], a[8:15], v15
v_smfmac_f32_16x16x64_bf16 v[72:75], v[48:51], a[16:23], v15
v_smfmac_f32_16x16x64_bf16 v[76:79], v[48:51], a[24:31], v15
v_smfmac_f32_16x16x64_bf16 v[80:83], v[48:51], a[32:39], v15
v_smfmac_f32_16x16x64_bf16 v[84:87], v[48:51], a[40:47], v15
v_smfmac_f32_16x16x64_bf16 v[88:91], v[48:51], a[48:55], v15
v_smfmac_f32_16x16x64_bf16 v[92:95], v[48:51], a[56:63], v15
s_branch Lps_48
Lpf_37:
buffer_load_dwordx4 v[48:51], v10, s[4:7], s40 offen offset:0 sc1
v_mfma_f32_16x16x32_bf16 v[200:203], v[204:207], v[204:207], 0
s_sub_u32 s37, s37, 1
s_cbranch_scc1 Lend_8
s_branch Lps_36
Lpf_39:
buffer_load_dwordx4 v[56:59], v10, s[4:7], s40 offen offset:2048 sc1
v_mfma_f32_16x16x32_bf16 v[200:203], v[204:207], v[204:207], 0
Lps_62:
s_waitcnt vmcnt(2)
v_max3_u32 v44, v60, v61, v62
v_max_u32 v44, v44, v63
v_cmp_eq_u32 vcc, -1, v44
s_cbranch_vccnz Lpf_63
v_smfmac_f32_16x16x64_bf16 v[64:67], v[60:63], a[192:199], v15
v_smfmac_f32_16x16x64_bf16 v[68:71], v[60:63], a[200:207], v15
v_smfmac_f32_16x16x64_bf16 v[72:75], v[60:63], a[208:215], v15
v_smfmac_f32_16x16x64_bf16 v[76:79], v[60:63], a[216:223], v15
v_smfmac_f32_16x16x64_bf16 v[80:83], v[60:63], a[224:231], v15
v_smfmac_f32_16x16x64_bf16 v[84:87], v[60:63], a[232:239], v15
v_smfmac_f32_16x16x64_bf16 v[88:91], v[60:63], a[240:247], v15
v_smfmac_f32_16x16x64_bf16 v[92:95], v[60:63], a[248:255], v15
Lps_64:
s_waitcnt vmcnt(1)
v_max3_u32 v44, v52, v53, v54
v_max_u32 v44, v44, v55
v_cmp_eq_u32 vcc, -1, v44
s_cbranch_vccnz Lpf_65
v_smfmac_f32_16x16x64_bf16 v[64:67], v[52:55], a[64:71], v15
v_smfmac_f32_16x16x64_bf16 v[68:71], v[52:55], a[72:79], v15
v_smfmac_f32_16x16x64_bf16 v[72:75], v[52:55], a[80:87], v15
v_smfmac_f32_16x16x64_bf16 v[76:79], v[52:55], a[88:95], v15
v_smfmac_f32_16x16x64_bf16 v[80:83], v[52:55], a[96:103], v15
v_smfmac_f32_16x16x64_bf16 v[84:87], v[52:55], a[104:111], v15
v_smfmac_f32_16x16x64_bf16 v[88:91], v[52:55], a[112:119], v15
v_smfmac_f32_16x16x64_bf16 v[92:95], v[52:55], a[120:127], v15
s_branch Lps_46
Lpf_41:
buffer_load_dwordx4 v[60:63], v10, s[4:7], s40 offen offset:3072 sc1
v_mfma_f32_16x16x32_bf16 v[200:203], v[204:207], v[204:207], 0
Lps_66:
s_waitcnt vmcnt(1)
v_max3_u32 v44, v52, v53, v54
v_max_u32 v44, v44, v55
v_cmp_eq_u32 vcc, -1, v44
s_cbranch_vccnz Lpf_67
v_smfmac_f32_16x16x64_bf16 v[64:67], v[52:55], a[64:71], v15
v_smfmac_f32_16x16x64_bf16 v[68:71], v[52:55], a[72:79], v15
v_smfmac_f32_16x16x64_bf16 v[72:75], v[52:55], a[80:87], v15
v_smfmac_f32_16x16x64_bf16 v[76:79], v[52:55], a[88:95], v15
v_smfmac_f32_16x16x64_bf16 v[80:83], v[52:55], a[96:103], v15
v_smfmac_f32_16x16x64_bf16 v[84:87], v[52:55], a[104:111], v15
v_smfmac_f32_16x16x64_bf16 v[88:91], v[52:55], a[112:119], v15
v_smfmac_f32_16x16x64_bf16 v[92:95], v[52:55], a[120:127], v15
s_branch Lps_48
Lpf_43:
buffer_load_dwordx4 v[52:55], v10, s[4:7], s40 offen offset:1024 sc1
v_mfma_f32_16x16x32_bf16 v[200:203], v[204:207], v[204:207], 0
s_sub_u32 s37, s37, 1
s_cbranch_scc1 Lend_8
s_branch Lps_42
Lpf_45:
buffer_load_dwordx4 v[60:63], v10, s[4:7], s40 offen offset:3072 sc1
v_mfma_f32_16x16x32_bf16 v[200:203], v[204:207], v[204:207], 0
Lps_68:
s_waitcnt vmcnt(1)
v_max3_u32 v44, v56, v57, v58
v_max_u32 v44, v44, v59
v_cmp_eq_u32 vcc, -1, v44
s_cbranch_vccnz Lpf_69
v_smfmac_f32_16x16x64_bf16 v[64:67], v[56:59], a[128:135], v15
v_smfmac_f32_16x16x64_bf16 v[68:71], v[56:59], a[136:143], v15
v_smfmac_f32_16x16x64_bf16 v[72:75], v[56:59], a[144:151], v15
v_smfmac_f32_16x16x64_bf16 v[76:79], v[56:59], a[152:159], v15
v_smfmac_f32_16x16x64_bf16 v[80:83], v[56:59], a[160:167], v15
v_smfmac_f32_16x16x64_bf16 v[84:87], v[56:59], a[168:175], v15
v_smfmac_f32_16x16x64_bf16 v[88:91], v[56:59], a[176:183], v15
v_smfmac_f32_16x16x64_bf16 v[92:95], v[56:59], a[184:191], v15
s_branch Lps_48
Lpf_47:
buffer_load_dwordx4 v[56:59], v10, s[4:7], s40 offen offset:2048 sc1
v_mfma_f32_16x16x32_bf16 v[200:203], v[204:207], v[204:207], 0
s_sub_u32 s37, s37, 1
s_cbranch_scc1 Lend_8
s_branch Lps_46
Lpf_49:
buffer_load_dwordx4 v[60:63], v10, s[4:7], s40 offen offset:3072 sc1
v_mfma_f32_16x16x32_bf16 v[200:203], v[204:207], v[204:207], 0
s_sub_u32 s37, s37, 1
s_cbranch_scc1 Lend_8
s_branch Lps_48
Lpf_51:
buffer_load_dwordx4 v[56:59], v10, s[4:7], s40 offen offset:2048 sc1
v_mfma_f32_16x16x32_bf16 v[200:203], v[204:207], v[204:207], 0
Lps_70:
s_waitcnt vmcnt(3)
v_max3_u32 v44, v60, v61, v62
v_max_u32 v44, v44, v63
v_cmp_eq_u32 vcc, -1, v44
s_cbranch_vccnz Lpf_71
v_smfmac_f32_16x16x64_bf16 v[64:67], v[60:63], a[192:199], v15
v_smfmac_f32_16x16x64_bf16 v[68:71], v[60:63], a[200:207], v15
v_smfmac_f32_16x16x64_bf16 v[72:75], v[60:63], a[208:215], v15
v_smfmac_f32_16x16x64_bf16 v[76:79], v[60:63], a[216:223], v15
v_smfmac_f32_16x16x64_bf16 v[80:83], v[60:63], a[224:231], v15
v_smfmac_f32_16x16x64_bf16 v[84:87], v[60:63], a[232:239], v15
v_smfmac_f32_16x16x64_bf16 v[88:91], v[60:63], a[240:247], v15
v_smfmac_f32_16x16x64_bf16 v[92:95], v[60:63], a[248:255], v15
Lps_72:
s_waitcnt vmcnt(2)
v_max3_u32 v44, v48, v49, v50
v_max_u32 v44, v44, v51
v_cmp_eq_u32 vcc, -1, v44
s_cbranch_vccnz Lpf_73
v_smfmac_f32_16x16x64_bf16 v[64:67], v[48:51], a[0:7], v15
v_smfmac_f32_16x16x64_bf16 v[68:71], v[48:51], a[8:15], v15
v_smfmac_f32_16x16x64_bf16 v[72:75], v[48:51], a[16:23], v15
v_smfmac_f32_16x16x64_bf16 v[76:79], v[48:51], a[24:31], v15
v_smfmac_f32_16x16x64_bf16 v[80:83], v[48:51], a[32:39], v15
v_smfmac_f32_16x16x64_bf16 v[84:87], v[48:51], a[40:47], v15
v_smfmac_f32_16x16x64_bf16 v[88:91], v[48:51], a[48:55], v15
v_smfmac_f32_16x16x64_bf16 v[92:95], v[48:51], a[56:63], v15
s_branch Lps_64
Lpf_53:
buffer_load_dwordx4 v[60:63], v10, s[4:7], s40 offen offset:3072 sc1
v_mfma_f32_16x16x32_bf16 v[200:203], v[204:207], v[204:207], 0
Lps_74:
s_waitcnt vmcnt(2)
v_max3_u32 v44, v48, v49, v50
v_max_u32 v44, v44, v51
v_cmp_eq_u32 vcc, -1, v44
s_cbranch_vccnz Lpf_75
v_smfmac_f32_16x16x64_bf16 v[64:67], v[48:51], a[0:7], v15
v_smfmac_f32_16x16x64_bf16 v[68:71], v[48:51], a[8:15], v15
v_smfmac_f32_16x16x64_bf16 v[72:75], v[48:51], a[16:23], v15
v_smfmac_f32_16x16x64_bf16 v[76:79], v[48:51], a[24:31], v15
v_smfmac_f32_16x16x64_bf16 v[80:83], v[48:51], a[32:39], v15
v_smfmac_f32_16x16x64_bf16 v[84:87], v[48:51], a[40:47], v15
v_smfmac_f32_16x16x64_bf16 v[88:91], v[48:51], a[48:55], v15
v_smfmac_f32_16x16x64_bf16 v[92:95], v[48:51], a[56:63], v15
s_branch Lps_66
Lpf_55:
buffer_load_dwordx4 v[48:51], v10, s[4:7], s40 offen offset:0 sc1
v_mfma_f32_16x16x32_bf16 v[200:203], v[204:207], v[204:207], 0
s_sub_u32 s37, s37, 1
s_cbranch_scc1 Lend_8
Lps_76:
s_waitcnt vmcnt(1)
v_max3_u32 v44, v52, v53, v54
v_max_u32 v44, v44, v55
v_cmp_eq_u32 vcc, -1, v44
s_cbranch_vccnz Lpf_77
v_smfmac_f32_16x16x64_bf16 v[64:67], v[52:55], a[64:71], v15
v_smfmac_f32_16x16x64_bf16 v[68:71], v[52:55], a[72:79], v15
v_smfmac_f32_16x16x64_bf16 v[72:75], v[52:55], a[80:87], v15
v_smfmac_f32_16x16x64_bf16 v[76:79], v[52:55], a[88:95], v15
v_smfmac_f32_16x16x64_bf16 v[80:83], v[52:55], a[96:103], v15
v_smfmac_f32_16x16x64_bf16 v[84:87], v[52:55], a[104:111], v15
v_smfmac_f32_16x16x64_bf16 v[88:91], v[52:55], a[112:119], v15
v_smfmac_f32_16x16x64_bf16 v[92:95], v[52:55], a[120:127], v15
s_branch Lps_36
Lpf_57:
buffer_load_dwordx4 v[60:63], v10, s[4:7], s40 offen offset:3072 sc1
v_mfma_f32_16x16x32_bf16 v[200:203], v[204:207], v[204:207], 0
Lps_78:
s_waitcnt vmcnt(2)
v_max3_u32 v44, v48, v49, v50
v_max_u32 v44, v44, v51
v_cmp_eq_u32 vcc, -1, v44
s_cbranch_vccnz Lpf_79
v_smfmac_f32_16x16x64_bf16 v[64:67], v[48:51], a[0:7], v15
v_smfmac_f32_16x16x64_bf16 v[68:71], v[48:51], a[8:15], v15
v_smfmac_f32_16x16x64_bf16 v[72:75], v[48:51], a[16:23], v15
v_smfmac_f32_16x16x64_bf16 v[76:79], v[48:51], a[24:31], v15
v_smfmac_f32_16x16x64_bf16 v[80:83], v[48:51], a[32:39], v15
v_smfmac_f32_16x16x64_bf16 v[84:87], v[48:51], a[40:47], v15
v_smfmac_f32_16x16x64_bf16 v[88:91], v[48:51], a[48:55], v15
v_smfmac_f32_16x16x64_bf16 v[92:95], v[48:51], a[56:63], v15
s_branch Lps_68
Lpf_59:
buffer_load_dwordx4 v[48:51], v10, s[4:7], s40 offen offset:0 sc1
v_mfma_f32_16x16x32_bf16 v[200:203], v[204:207], v[204:207], 0
s_sub_u32 s37, s37, 1
s_cbranch_scc1 Lend_8
Lps_80:
s_waitcnt vmcnt(1)
v_max3_u32 v44, v56, v57, v58
v_max_u32 v44, v44, v59
v_cmp_eq_u32 vcc, -1, v44
s_cbranch_vccnz Lpf_81
v_smfmac_f32_16x16x64_bf16 v[64:67], v[56:59], a[128:135], v15
v_smfmac_f32_16x16x64_bf16 v[68:71], v[56:59], a[136:143], v15
v_smfmac_f32_16x16x64_bf16 v[72:75], v[56:59], a[144:151], v15
v_smfmac_f32_16x16x64_bf16 v[76:79], v[56:59], a[152:159], v15
v_smfmac_f32_16x16x64_bf16 v[80:83], v[56:59], a[160:167], v15
v_smfmac_f32_16x16x64_bf16 v[84:87], v[56:59], a[168:175], v15
v_smfmac_f32_16x16x64_bf16 v[88:91], v[56:59], a[176:183], v15
v_smfmac_f32_16x16x64_bf16 v[92:95], v[56:59], a[184:191], v15
s_branch Lps_36
Lpf_61:
buffer_load_dwordx4 v[48:51], v10, s[4:7], s40 offen offset:0 sc1
v_mfma_f32_16x16x32_bf16 v[200:203], v[204:207], v[204:207], 0
s_sub_u32 s37, s37, 1
s_cbranch_scc1 Lend_8
s_branch Lps_34
Lpf_63:
buffer_load_dwordx4 v[60:63], v10, s[4:7], s40 offen offset:3072 sc1
v_mfma_f32_16x16x32_bf16 v[200:203], v[204:207], v[204:207], 0
Lps_82:
s_waitcnt vmcnt(2)
v_max3_u32 v44, v52, v53, v54
v_max_u32 v44, v44, v55
v_cmp_eq_u32 vcc, -1, v44
s_cbranch_vccnz Lpf_83
v_smfmac_f32_16x16x64_bf16 v[64:67], v[52:55], a[64:71], v15
v_smfmac_f32_16x16x64_bf16 v[68:71], v[52:55], a[72:79], v15
v_smfmac_f32_16x16x64_bf16 v[72:75], v[52:55], a[80:87], v15
v_smfmac_f32_16x16x64_bf16 v[76:79], v[52:55], a[88:95], v15
v_smfmac_f32_16x16x64_bf16 v[80:83], v[52:55], a[96:103], v15
v_smfmac_f32_16x16x64_bf16 v[84:87], v[52:55], a[104:111], v15
v_smfmac_f32_16x16x64_bf16 v[88:91], v[52:55], a[112:119], v15
v_smfmac_f32_16x16x64_bf16 v[92:95], v[52:55], a[120:127], v15
s_branch Lps_68
Lpf_65:
buffer_load_dwordx4 v[52:55], v10, s[4:7], s40 offen offset:1024 sc1
v_mfma_f32_16x16x32_bf16 v[200:203], v[204:207], v[204:207], 0
s_sub_u32 s37, s37, 1
s_cbranch_scc1 Lend_8
Lps_84:
s_waitcnt vmcnt(1)
v_max3_u32 v44, v56, v57, v58
v_max_u32 v44, v44, v59
v_cmp_eq_u32 vcc, -1, v44
s_cbranch_vccnz Lpf_85
v_smfmac_f32_16x16x64_bf16 v[64:67], v[56:59], a[128:135], v15
v_smfmac_f32_16x16x64_bf16 v[68:71], v[56:59], a[136:143], v15
v_smfmac_f32_16x16x64_bf16 v[72:75], v[56:59], a[144:151], v15
v_smfmac_f32_16x16x64_bf16 v[76:79], v[56:59], a[152:159], v15
v_smfmac_f32_16x16x64_bf16 v[80:83], v[56:59], a[160:167], v15
v_smfmac_f32_16x16x64_bf16 v[84:87], v[56:59], a[168:175], v15
v_smfmac_f32_16x16x64_bf16 v[88:91], v[56:59], a[176:183], v15
v_smfmac_f32_16x16x64_bf16 v[92:95], v[56:59], a[184:191], v15
s_branch Lps_42
Lpf_67:
buffer_load_dwordx4 v[52:55], v10, s[4:7], s40 offen offset:1024 sc1
v_mfma_f32_16x16x32_bf16 v[200:203], v[204:207], v[204:207], 0
s_sub_u32 s37, s37, 1
s_cbranch_scc1 Lend_8
s_branch Lps_40
Lpf_69:
buffer_load_dwordx4 v[56:59], v10, s[4:7], s40 offen offset:2048 sc1
v_mfma_f32_16x16x32_bf16 v[200:203], v[204:207], v[204:207], 0
s_sub_u32 s37, s37, 1
s_cbranch_scc1 Lend_8
s_branch Lps_44
Lpf_71:
buffer_load_dwordx4 v[60:63], v10, s[4:7], s40 offen offset:3072 sc1
v_mfma_f32_16x16x32_bf16 v[200:203], v[204:207], v[204:207], 0
Lps_86:
s_waitcnt vmcnt(3)
v_max3_u32 v44, v48, v49, v50
v_max_u32 v44, v44, v51
v_cmp_eq_u32 vcc, -1, v44
s_cbranch_vccnz Lpf_87
v_smfmac_f32_16x16x64_bf16 v[64:67], v[48:51], a[0:7], v15
v_smfmac_f32_16x16x64_bf16 v[68:71], v[48:51], a[8:15], v15
v_smfmac_f32_16x16x64_bf16 v[72:75], v[48:51], a[16:23], v15
v_smfmac_f32_16x16x64_bf16 v[76:79], v[48:51], a[24:31], v15
v_smfmac_f32_16x16x64_bf16 v[80:83], v[48:51], a[32:39], v15
v_smfmac_f32_16x16x64_bf16 v[84:87], v[48:51], a[40:47], v15
v_smfmac_f32_16x16x64_bf16 v[88:91], v[48:51], a[48:55], v15
v_smfmac_f32_16x16x64_bf16 v[92:95], v[48:51], a[56:63], v15
s_branch Lps_82
Lpf_73:
buffer_load_dwordx4 v[48:51], v10, s[4:7], s40 offen offset:0 sc1
v_mfma_f32_16x16x32_bf16 v[200:203], v[204:207], v[204:207], 0
s_sub_u32 s37, s37, 1
s_cbranch_scc1 Lend_8
Lps_88:
s_waitcnt vmcnt(2)
v_max3_u32 v44, v52, v53, v54
v_max_u32 v44, v44, v55
v_cmp_eq_u32 vcc, -1, v44
s_cbranch_vccnz Lpf_89
v_smfmac_f32_16x16x64_bf16 v[64:67], v[52:55], a[64:71], v15
v_smfmac_f32_16x16x64_bf16 v[68:71], v[52:55], a[72:79], v15
v_smfmac_f32_16x16x64_bf16 v[72:75], v[52:55], a[80:87], v15
v_smfmac_f32_16x16x64_bf16 v[76:79], v[52:55], a[88:95], v15
v_smfmac_f32_16x16x64_bf16 v[80:83], v[52:55], a[96:103], v15
v_smfmac_f32_16x16x64_bf16 v[84:87], v[52:55], a[104:111], v15
v_smfmac_f32_16x16x64_bf16 v[88:91], v[52:55], a[112:119], v15
v_smfmac_f32_16x16x64_bf16 v[92:95], v[52:55], a[120:127], v15
s_branch Lps_80
Lpf_75:
buffer_load_dwordx4 v[48:51], v10, s[4:7], s40 offen offset:0 sc1
v_mfma_f32_16x16x32_bf16 v[200:203], v[204:207], v[204:207], 0
s_sub_u32 s37, s37, 1
s_cbranch_scc1 Lend_8
Lps_90:
s_waitcnt vmcnt(2)
v_max3_u32 v44, v52, v53, v54
v_max_u32 v44, v44, v55
v_cmp_eq_u32 vcc, -1, v44
s_cbranch_vccnz Lpf_91
v_smfmac_f32_16x16x64_bf16 v[64:67], v[52:55], a[64:71], v15
v_smfmac_f32_16x16x64_bf16 v[68:71], v[52:55], a[72:79], v15
v_smfmac_f32_16x16x64_bf16 v[72:75], v[52:55], a[80:87], v15
v_smfmac_f32_16x16x64_bf16 v[76:79], v[52:55], a[88:95], v15
v_smfmac_f32_16x16x64_bf16 v[80:83], v[52:55], a[96:103], v15
v_smfmac_f32_16x16x64_bf16 v[84:87], v[52:55], a[104:111], v15
v_smfmac_f32_16x16x64_bf16 v[88:91], v[52:55], a[112:119], v15
v_smfmac_f32_16x16x64_bf16 v[92:95], v[52:55], a[120:127], v15
s_branch Lps_34
Lpf_77:
buffer_load_dwordx4 v[52:55], v10, s[4:7], s40 offen offset:1024 sc1
v_mfma_f32_16x16x32_bf16 v[200:203], v[204:207], v[204:207], 0
s_branch Lps_54
Lpf_79:
buffer_load_dwordx4 v[48:51], v10, s[4:7], s40 offen offset:0 sc1
v_mfma_f32_16x16x32_bf16 v[200:203], v[204:207], v[204:207], 0
s_sub_u32 s37, s37, 1
s_cbranch_scc1 Lend_8
s_branch Lps_32
Lpf_81:
buffer_load_dwordx4 v[56:59], v10, s[4:7], s40 offen offset:2048 sc1
v_mfma_f32_16x16x32_bf16 v[200:203], v[204:207], v[204:207], 0
s_branch Lps_58
Lpf_83:
buffer_load_dwordx4 v[52:55], v10, s[4:7], s40 offen offset:1024 sc1
v_mfma_f32_16x16x32_bf16 v[200:203], v[204:207], v[204:207], 0
s_sub_u32 s37, s37, 1
s_cbranch_scc1 Lend_8
s_branch Lps_38
Lpf_85:
buffer_load_dwordx4 v[56:59], v10, s[4:7], s40 offen offset:2048 sc1
v_mfma_f32_16x16x32_bf16 v[200:203], v[204:207], v[204:207], 0
s_branch Lps_64
Lpf_87:
buffer_load_dwordx4 v[48:51], v10, s[4:7], s40 offen offset:0 sc1
v_mfma_f32_16x16x32_bf16 v[200:203], v[204:207], v[204:207], 0
s_sub_u32 s37, s37, 1
s_cbranch_scc1 Lend_8
s_branch Lps_30
Lpf_89:
buffer_load_dwordx4 v[52:55], v10, s[4:7], s40 offen offset:1024 sc1
v_mfma_f32_16x16x32_bf16 v[200:203], v[204:207], v[204:207], 0
Lps_92:
s_waitcnt vmcnt(2)
v_max3_u32 v44, v56, v57, v58
v_max_u32 v44, v44, v59
v_cmp_eq_u32 vcc, -1, v44
s_cbranch_vccnz Lpf_93
v_smfmac_f32_16x16x64_bf16 v[64:67], v[56:59], a[128:135], v15
v_smfmac_f32_16x16x64_bf16 v[68:71], v[56:59], a[136:143], v15
v_smfmac_f32_16x16x64_bf16 v[72:75], v[56:59], a[144:151], v15
v_smfmac_f32_16x16x64_bf16 v[76:79], v[56:59], a[152:159], v15
v_smfmac_f32_16x16x64_bf16 v[80:83], v[56:59], a[160:167], v15
v_smfmac_f32_16x16x64_bf16 v[84:87], v[56:59], a[168:175], v15
v_smfmac_f32_16x16x64_bf16 v[88:91], v[56:59], a[176:183], v15
v_smfmac_f32_16x16x64_bf16 v[92:95], v[56:59], a[184:191], v15
s_branch Lps_54
Lpf_91:
buffer_load_dwordx4 v[52:55], v10, s[4:7], s40 offen offset:1024 sc1
v_mfma_f32_16x16x32_bf16 v[200:203], v[204:207], v[204:207], 0
s_branch Lps_52
Lpf_93:
buffer_load_dwordx4 v[56:59], v10, s[4:7], s40 offen offset:2048 sc1
v_mfma_f32_16x16x32_bf16 v[200:203], v[204:207], v[204:207], 0
s_branch Lps_72
Lkr_25:
buffer_load_dwordx4 v[56:59], v11, s[4:7], s40 offen offset:0 sc1
buffer_load_dwordx4 v[60:63], v11, s[4:7], s40 offen offset:1024 sc1
Lps_95:
s_waitcnt vmcnt(3)
v_max3_u32 v44, v48, v49, v50
v_max_u32 v44, v44, v51
v_cmp_eq_u32 vcc, -1, v44
s_cbranch_vccnz Lpf_96
v_smfmac_f32_16x16x64_bf16 v[72:75], v[48:51], v[96:103], v15
v_mov_b32 v112, v48
v_mov_b32 v113, v49
v_mov_b32 v114, v50
v_mov_b32 v115, v51
Lps_97:
s_waitcnt vmcnt(2)
v_max3_u32 v44, v52, v53, v54
v_max_u32 v44, v44, v55
v_cmp_eq_u32 vcc, -1, v44
s_cbranch_vccnz Lpf_98
v_smfmac_f32_16x16x64_bf16 v[72:75], v[52:55], v[104:111], v15
v_mov_b32 v116, v52
v_mov_b32 v117, v53
v_mov_b32 v118, v54
v_mov_b32 v119, v55
Lpd_94:
s_branch Lko_26
Lpf_96:
buffer_load_dwordx4 v[48:51], v11, s[4:7], s40 offen offset:0 sc1
s_sub_u32 s37, s37, 1
s_cbranch_scc1 Lend_8
Lps_99:
s_waitcnt vmcnt(3)
v_max3_u32 v44, v52, v53, v54
v_max_u32 v44, v44, v55
v_cmp_eq_u32 vcc, -1, v44
s_cbranch_vccnz Lpf_100
v_smfmac_f32_16x16x64_bf16 v[72:75], v[52:55], v[104:111], v15
v_mov_b32 v116, v52
v_mov_b32 v117, v53
v_mov_b32 v118, v54
v_mov_b32 v119, v55
Lps_101:
s_waitcnt vmcnt(2)
v_max3_u32 v44, v56, v57, v58
v_max_u32 v44, v44, v59
v_cmp_eq_u32 vcc, -1, v44
s_cbranch_vccnz Lpf_102
v_smfmac_f32_16x16x64_bf16 v[72:75], v[56:59], v[96:103], v15
v_mov_b32 v112, v56
v_mov_b32 v113, v57
v_mov_b32 v114, v58
v_mov_b32 v115, v59
s_branch Lpd_94
Lpf_98:
buffer_load_dwordx4 v[52:55], v11, s[4:7], s40 offen offset:1024 sc1
s_sub_u32 s37, s37, 1
s_cbranch_scc1 Lend_8
Lps_103:
s_waitcnt vmcnt(2)
v_max3_u32 v44, v56, v57, v58
v_max_u32 v44, v44, v59
v_cmp_eq_u32 vcc, -1, v44
s_cbranch_vccnz Lpf_104
Lps_105:
s_waitcnt vmcnt(1)
v_max3_u32 v44, v60, v61, v62
v_max_u32 v44, v44, v63
v_cmp_eq_u32 vcc, -1, v44
s_cbranch_vccnz Lpf_106
v_smfmac_f32_16x16x64_bf16 v[72:75], v[60:63], v[104:111], v15
v_mov_b32 v116, v60
v_mov_b32 v117, v61
v_mov_b32 v118, v62
v_mov_b32 v119, v63
s_branch Lpd_94
Lpf_100:
buffer_load_dwordx4 v[52:55], v11, s[4:7], s40 offen offset:1024 sc1
Lps_107:
s_waitcnt vmcnt(3)
v_max3_u32 v44, v56, v57, v58
v_max_u32 v44, v44, v59
v_cmp_eq_u32 vcc, -1, v44
s_cbranch_vccnz Lpf_108
v_smfmac_f32_16x16x64_bf16 v[72:75], v[56:59], v[96:103], v15
v_mov_b32 v112, v56
v_mov_b32 v113, v57
v_mov_b32 v114, v58
v_mov_b32 v115, v59
Lps_109:
s_waitcnt vmcnt(2)
v_max3_u32 v44, v60, v61, v62
v_max_u32 v44, v44, v63
v_cmp_eq_u32 vcc, -1, v44
s_cbranch_vccnz Lpf_110
v_smfmac_f32_16x16x64_bf16 v[72:75], v[60:63], v[104:111], v15
v_mov_b32 v116, v60
v_mov_b32 v117, v61
v_mov_b32 v118, v62
v_mov_b32 v119, v63
s_branch Lpd_94
Lpf_102:
buffer_load_dwordx4 v[56:59], v11, s[4:7], s40 offen offset:0 sc1
Lps_111:
s_waitcnt vmcnt(2)
v_max3_u32 v44, v60, v61, v62
v_max_u32 v44, v44, v63
v_cmp_eq_u32 vcc, -1, v44
s_cbranch_vccnz Lpf_112
Lps_113:
s_waitcnt vmcnt(1)
v_max3_u32 v44, v48, v49, v50
v_max_u32 v44, v44, v51
v_cmp_eq_u32 vcc, -1, v44
s_cbranch_vccnz Lpf_114
v_smfmac_f32_16x16x64_bf16 v[72:75], v[48:51], v[96:103], v15
v_mov_b32 v112, v48
v_mov_b32 v113, v49
v_mov_b32 v114, v50
v_mov_b32 v115, v51
s_branch Lpd_94
Lpf_104:
buffer_load_dwordx4 v[56:59], v11, s[4:7], s40 offen offset:0 sc1
Lps_115:
s_waitcnt vmcnt(2)
v_max3_u32 v44, v60, v61, v62
v_max_u32 v44, v44, v63
v_cmp_eq_u32 vcc, -1, v44
s_cbranch_vccnz Lpf_116
v_smfmac_f32_16x16x64_bf16 v[72:75], v[60:63], v[104:111], v15
v_mov_b32 v116, v60
v_mov_b32 v117, v61
v_mov_b32 v118, v62
v_mov_b32 v119, v63
s_branch Lpd_94
Lpf_106:
buffer_load_dwordx4 v[60:63], v11, s[4:7], s40 offen offset:1024 sc1
Lps_117:
s_waitcnt vmcnt(1)
v_max3_u32 v44, v52, v53, v54
v_max_u32 v44, v44, v55
v_cmp_eq_u32 vcc, -1, v44
s_cbranch_vccnz Lpf_118
v_smfmac_f32_16x16x64_bf16 v[72:75], v[52:55], v[104:111], v15
v_mov_b32 v116, v52
v_mov_b32 v117, v53
v_mov_b32 v118, v54
v_mov_b32 v119, v55
s_branch Lpd_94
Lpf_108:
buffer_load_dwordx4 v[56:59], v11, s[4:7], s40 offen offset:0 sc1
Lps_119:
s_waitcnt vmcnt(3)
v_max3_u32 v44, v60, v61, v62
v_max_u32 v44, v44, v63
v_cmp_eq_u32 vcc, -1, v44
s_cbranch_vccnz Lpf_120
v_smfmac_f32_16x16x64_bf16 v[72:75], v[60:63], v[104:111], v15
v_mov_b32 v116, v60
v_mov_b32 v117, v61
v_mov_b32 v118, v62
v_mov_b32 v119, v63
Lps_121:
s_waitcnt vmcnt(2)
v_max3_u32 v44, v48, v49, v50
v_max_u32 v44, v44, v51
v_cmp_eq_u32 vcc, -1, v44
s_cbranch_vccnz Lpf_122
v_smfmac_f32_16x16x64_bf16 v[72:75], v[48:51], v[96:103], v15
v_mov_b32 v112, v48
v_mov_b32 v113, v49
v_mov_b32 v114, v50
v_mov_b32 v115, v51
s_branch Lpd_94
Lpf_110:
buffer_load_dwordx4 v[60:63], v11, s[4:7], s40 offen offset:1024 sc1
Lps_123:
s_waitcnt vmcnt(2)
v_max3_u32 v44, v48, v49, v50
v_max_u32 v44, v44, v51
v_cmp_eq_u32 vcc, -1, v44
s_cbranch_vccnz Lpf_124
s_branch Lps_117
Lpf_112:
buffer_load_dwordx4 v[60:63], v11, s[4:7], s40 offen offset:1024 sc1
Lps_125:
s_waitcnt vmcnt(2)
v_max3_u32 v44, v48, v49, v50
v_max_u32 v44, v44, v51
v_cmp_eq_u32 vcc, -1, v44
s_cbranch_vccnz Lpf_126
v_smfmac_f32_16x16x64_bf16 v[72:75], v[48:51], v[96:103], v15
v_mov_b32 v112, v48
v_mov_b32 v113, v49
v_mov_b32 v114, v50
v_mov_b32 v115, v51
s_branch Lpd_94
Lpf_114:
buffer_load_dwordx4 v[48:51], v11, s[4:7], s40 offen offset:0 sc1
s_sub_u32 s37, s37, 1
s_cbranch_scc1 Lend_8
Lps_127:
s_waitcnt vmcnt(1)
v_max3_u32 v44, v56, v57, v58
v_max_u32 v44, v44, v59
v_cmp_eq_u32 vcc, -1, v44
s_cbranch_vccnz Lpf_128
v_smfmac_f32_16x16x64_bf16 v[72:75], v[56:59], v[96:103], v15
v_mov_b32 v112, v56
v_mov_b32 v113, v57
v_mov_b32 v114, v58
v_mov_b32 v115, v59
s_branch Lpd_94
Lpf_116:
buffer_load_dwordx4 v[60:63], v11, s[4:7], s40 offen offset:1024 sc1
s_branch Lps_97
Lpf_118:
buffer_load_dwordx4 v[52:55], v11, s[4:7], s40 offen offset:1024 sc1
s_sub_u32 s37, s37, 1
s_cbranch_scc1 Lend_8
s_branch Lps_105
Lpf_120:
buffer_load_dwordx4 v[60:63], v11, s[4:7], s40 offen offset:1024 sc1
s_branch Lps_95
Lpf_122:
buffer_load_dwordx4 v[48:51], v11, s[4:7], s40 offen offset:0 sc1
s_sub_u32 s37, s37, 1
s_cbranch_scc1 Lend_8
Lps_129:
s_waitcnt vmcnt(2)
v_max3_u32 v44, v52, v53, v54
v_max_u32 v44, v44, v55
v_cmp_eq_u32 vcc, -1, v44
s_cbranch_vccnz Lpf_130
s_branch Lps_127
Lpf_124:
buffer_load_dwordx4 v[48:51], v11, s[4:7], s40 offen offset:0 sc1
s_sub_u32 s37, s37, 1
s_cbranch_scc1 Lend_8
Lps_131:
s_waitcnt vmcnt(2)
v_max3_u32 v44, v52, v53, v54
v_max_u32 v44, v44, v55
v_cmp_eq_u32 vcc, -1, v44
s_cbranch_vccnz Lpf_132
v_smfmac_f32_16x16x64_bf16 v[72:75], v[52:55], v[104:111], v15
v_mov_b32 v116, v52
v_mov_b32 v117, v53
v_mov_b32 v118, v54
v_mov_b32 v119, v55
s_branch Lpd_94
Lpf_126:
buffer_load_dwordx4 v[48:51], v11, s[4:7], s40 offen offset:0 sc1
s_sub_u32 s37, s37, 1
s_cbranch_scc1 Lend_8
s_branch Lps_101
Lpf_128:
buffer_load_dwordx4 v[56:59], v11, s[4:7], s40 offen offset:0 sc1
s_branch Lps_113
Lpf_130:
buffer_load_dwordx4 v[52:55], v11, s[4:7], s40 offen offset:1024 sc1
Lps_133:
s_waitcnt vmcnt(2)
v_max3_u32 v44, v56, v57, v58
v_max_u32 v44, v44, v59
v_cmp_eq_u32 vcc, -1, v44
s_cbranch_vccnz Lpf_134
v_smfmac_f32_16x16x64_bf16 v[72:75], v[56:59], v[96:103], v15
v_mov_b32 v112, v56
v_mov_b32 v113, v57
v_mov_b32 v114, v58
v_mov_b32 v115, v59
s_branch Lpd_94
Lpf_132:
buffer_load_dwordx4 v[52:55], v11, s[4:7], s40 offen offset:1024 sc1
s_branch Lps_109
Lpf_134:
buffer_load_dwordx4 v[56:59], v11, s[4:7], s40 offen offset:0 sc1
s_branch Lps_121
Lvr_27:
buffer_load_dwordx2 v[120:121], v12, s[4:7], s40 offen sc1
buffer_load_dwordx2 v[122:123], v13, s[4:7], s40 offen sc1
s_sub_u32 s37, s37, 1
s_cbranch_scc1 Lend_8
s_waitcnt vmcnt(0)
v_max3_u32 v44, v120, v121, v122
v_max_u32 v44, v44, v123
v_cmp_eq_u32 vcc, -1, v44
s_cbranch_vccnz Lvr_27
s_branch Lvo_28
Lq_sc1_15:
Lq_135:
ds_read_b128 v[128:131], v22 offset:0
ds_read_b128 v[132:135], v22 offset:1024
ds_read_b128 v[136:139], v22 offset:2048
ds_read_b128 v[140:143], v22 offset:3072
ds_read_b128 v[144:147], v22 offset:4096
ds_read_b128 v[148:151], v22 offset:5120
ds_read_b128 v[152:155], v22 offset:6144
ds_read_b128 v[156:159], v22 offset:7168
ds_read_b128 v[160:163], v24 offset:0
ds_read_b128 v[164:167], v24 offset:1024
ds_read_b128 v[168:171], v25 offset:0
ds_read_b128 v[172:175], v25 offset:1024
ds_read_b128 v[176:179], v23 offset:0
ds_read_b128 v[180:183], v23 offset:1024
ds_read_b128 v[184:187], v23 offset:2048
ds_read_b128 v[188:191], v23 offset:3072
v_xor_b32 v22, 98304, v22
v_xor_b32 v24, 98304, v24
v_xor_b32 v25, 98304, v25
v_xor_b32 v23, 98304, v23
s_mul_i32 m0, s32, 5120
s_and_b32 s38, s36, 3
s_lshl_b32 s39, s38, 16
s_add_u32 s40, s39, s45
s_xor_b32 s42, s40, 0x20000
s_add_u32 s26, s36, 1
v_add_u32 v197, 1, v197
v_mov_b32 v64, 0
v_mov_b32 v65, 0
v_mov_b32 v66, 0
v_mov_b32 v67, 0
v_mov_b32 v68, 0
v_mov_b32 v69, 0
v_mov_b32 v70, 0
v_mov_b32 v71, 0
v_mov_b32 v72, 0
v_mov_b32 v73, 0
v_mov_b32 v74, 0
v_mov_b32 v75, 0
v_mov_b32 v76, 0
v_mov_b32 v77, 0
v_mov_b32 v78, 0
v_mov_b32 v79, 0
v_mov_b32 v80, 0
v_mov_b32 v81, 0
v_mov_b32 v82, 0
v_mov_b32 v83, 0
v_mov_b32 v84, 0
v_mov_b32 v85, 0
v_mov_b32 v86, 0
v_mov_b32 v87, 0
v_mov_b32 v88, 0
v_mov_b32 v89, 0
v_mov_b32 v90, 0
v_mov_b32 v91, 0
v_mov_b32 v92, 0
v_mov_b32 v93, 0
v_mov_b32 v94, 0
v_mov_b32 v95, 0
s_mov_b64 exec, 15
buffer_load_dword v194, v192, s[4:7], s59 offen sc1
s_nop 11
buffer_load_dword v195, v192, s[4:7], s59 offen sc1
s_nop 11
buffer_load_dword v196, v192, s[4:7], s59 offen sc1
Lft_137:
s_waitcnt vmcnt(2)
v_cmp_gt_u32 vcc, s26, v194
s_cbranch_vccz Lfg_136
buffer_load_dword v194, v192, s[4:7], s59 offen sc1
s_waitcnt vmcnt(2)
v_cmp_gt_u32 vcc, s26, v195
s_cbranch_vccz Lfg_136
buffer_load_dword v195, v192, s[4:7], s59 offen sc1
s_waitcnt vmcnt(2)
v_cmp_gt_u32 vcc, s26, v196
s_cbranch_vccz Lfg_136
buffer_load_dword v196, v192, s[4:7], s59 offen sc1
s_sub_u32 s37, s37, 1
s_cbranch_scc1 Lend_8
s_branch Lft_137
Lfg_136:
s_mov_b64 exec, -1
buffer_load_dwordx4 v[48:51], v10, s[4:7], s40 offen offset:0 sc1
v_mfma_f32_16x16x32_bf16 v[200:203], v[204:207], v[204:207], 0
v_mfma_f32_16x16x32_bf16 v[200:203], v[204:207], v[204:207], 0
v_mfma_f32_16x16x32_bf16 v[200:203], v[204:207], v[204:207], 0
v_mfma_f32_16x16x32_bf16 v[200:203], v[204:207], v[204:207], 0
buffer_load_dwordx4 v[52:55], v10, s[4:7], s40 offen offset:1024 sc1
v_mfma_f32_16x16x32_bf16 v[200:203], v[204:207], v[204:207], 0
v_mfma_f32_16x16x32_bf16 v[200:203], v[204:207], v[204:207], 0
v_mfma_f32_16x16x32_bf16 v[200:203], v[204:207], v[204:207], 0
v_mfma_f32_16x16x32_bf16 v[200:203], v[204:207], v[204:207], 0
buffer_load_dwordx4 v[56:59], v10, s[4:7], s40 offen offset:2048 sc1
v_mfma_f32_16x16x32_bf16 v[200:203], v[204:207], v[204:207], 0
v_mfma_f32_16x16x32_bf16 v[200:203], v[204:207], v[204:207], 0
v_mfma_f32_16x16x32_bf16 v[200:203], v[204:207], v[204:207], 0
v_mfma_f32_16x16x32_bf16 v[200:203], v[204:207], v[204:207], 0
buffer_load_dwordx4 v[60:63], v10, s[4:7], s40 offen offset:3072 sc1
v_mfma_f32_16x16x32_bf16 v[200:203], v[204:207], v[204:207], 0
s_waitcnt vmcnt(3)
v_max3_u32 v44, v48, v49, v50
v_max_u32 v44, v44, v51
v_cmp_eq_u32 vcc, -1, v44
s_cbranch_vccnz Lpf_140
v_smfmac_f32_16x16x64_bf16 v[64:67], v[48:51], a[0:7], v15
v_smfmac_f32_16x16x64_bf16 v[68:71], v[48:51], a[8:15], v15
v_smfmac_f32_16x16x64_bf16 v[72:75], v[48:51], a[16:23], v15
v_smfmac_f32_16x16x64_bf16 v[76:79], v[48:51], a[24:31], v15
v_smfmac_f32_16x16x64_bf16 v[80:83], v[48:51], a[32:39], v15
s_waitcnt vmcnt(2)
v_max3_u32 v44, v52, v53, v54
v_max_u32 v44, v44, v55
v_cmp_eq_u32 vcc, -1, v44
v_smfmac_f32_16x16x64_bf16 v[84:87], v[48:51], a[40:47], v15
v_smfmac_f32_16x16x64_bf16 v[88:91], v[48:51], a[48:55], v15
v_smfmac_f32_16x16x64_bf16 v[92:95], v[48:51], a[56:63], v15
s_cbranch_vccnz Lpf_141
v_smfmac_f32_16x16x64_bf16 v[64:67], v[52:55], a[64:71], v15
v_smfmac_f32_16x16x64_bf16 v[68:71], v[52:55], a[72:79], v15
v_smfmac_f32_16x16x64_bf16 v[72:75], v[52:55], a[80:87], v15
v_smfmac_f32_16x16x64_bf16 v[76:79], v[52:55], a[88:95], v15
v_smfmac_f32_16x16x64_bf16 v[80:83], v[52:55], a[96:103], v15
s_waitcnt vmcnt(1)
v_max3_u32 v44, v56, v57, v58
v_max_u32 v44, v44, v59
v_cmp_eq_u32 vcc, -1, v44
v_smfmac_f32_16x16x64_bf16 v[84:87], v[52:55], a[104:111], v15
v_smfmac_f32_16x16x64_bf16 v[88:91], v[52:55], a[112:119], v15
v_smfmac_f32_16x16x64_bf16 v[92:95], v[52:55], a[120:127], v15
s_cbranch_vccnz Lpf_142
v_smfmac_f32_16x16x64_bf16 v[64:67], v[56:59], a[128:135], v15
v_smfmac_f32_16x16x64_bf16 v[68:71], v[56:59], a[136:143], v15
v_smfmac_f32_16x16x64_bf16 v[72:75], v[56:59], a[144:151], v15
v_smfmac_f32_16x16x64_bf16 v[76:79], v[56:59], a[152:159], v15
v_smfmac_f32_16x16x64_bf16 v[80:83], v[56:59], a[160:167], v15
s_waitcnt vmcnt(0)
v_max3_u32 v44, v60, v61, v62
v_max_u32 v44, v44, v63
v_cmp_eq_u32 vcc, -1, v44
v_smfmac_f32_16x16x64_bf16 v[84:87], v[56:59], a[168:175], v15
v_smfmac_f32_16x16x64_bf16 v[88:91], v[56:59], a[176:183], v15
v_smfmac_f32_16x16x64_bf16 v[92:95], v[56:59], a[184:191], v15
s_cbranch_vccnz Lpf_143
v_smfmac_f32_16x16x64_bf16 v[64:67], v[60:63], a[192:199], v15
v_smfmac_f32_16x16x64_bf16 v[68:71], v[60:63], a[200:207], v15
v_smfmac_f32_16x16x64_bf16 v[72:75], v[60:63], a[208:215], v15
v_smfmac_f32_16x16x64_bf16 v[76:79], v[60:63], a[216:223], v15
v_smfmac_f32_16x16x64_bf16 v[80:83], v[60:63], a[224:231], v15
v_smfmac_f32_16x16x64_bf16 v[84:87], v[60:63], a[232:239], v15
v_smfmac_f32_16x16x64_bf16 v[88:91], v[60:63], a[240:247], v15
v_smfmac_f32_16x16x64_bf16 v[92:95], v[60:63], a[248:255], v15
Lpd_139:
s_nop 0
v_add_f32 v64, v64, v65
v_add_f32 v66, v66, v67
v_add_f32 v68, v68, v69
v_add_f32 v70, v70, v71
v_add_f32 v72, v72, v73
ds_write_addtid_b32 v64 offset:0
v_add_f32 v74, v74, v75
ds_write_addtid_b32 v66 offset:384
v_add_f32 v76, v76, v77
ds_write_addtid_b32 v68 offset:640
v_add_f32 v78, v78, v79
ds_write_addtid_b32 v70 offset:1024
v_add_f32 v80, v80, v81
ds_write_addtid_b32 v72 offset:1280
v_add_f32 v82, v82, v83
ds_write_addtid_b32 v74 offset:1664
v_add_f32 v84, v84, v85
ds_write_addtid_b32 v76 offset:1920
v_add_f32 v86, v86, v87
ds_write_addtid_b32 v78 offset:2304
v_add_f32 v88, v88, v89
ds_write_addtid_b32 v80 offset:2560
v_add_f32 v90, v90, v91
ds_write_addtid_b32 v82 offset:2944
v_add_f32 v92, v92, v93
ds_write_addtid_b32 v84 offset:3200
v_add_f32 v94, v94, v95
ds_write_addtid_b32 v86 offset:3584
ds_write_addtid_b32 v88 offset:3840
ds_write_addtid_b32 v90 offset:4224
ds_write_addtid_b32 v92 offset:4480
ds_write_addtid_b32 v94 offset:4864
Lqj_138:
v_mfma_f32_16x16x32_bf16 v[200:203], v[204:207], v[204:207], 0
v_mfma_f32_16x16x32_bf16 v[200:203], v[204:207], v[204:207], 0
s_waitcnt lgkmcnt(0)
s_barrier
ds_read_b128 v[76:79], v18 offset:0
ds_read_b128 v[80:83], v18 offset:5120
ds_read_b128 v[84:87], v18 offset:10240
ds_read_b128 v[88:91], v18 offset:15360
v_mov_b32 v72, 0
v_mov_b32 v73, 0
v_mov_b32 v74, 0
v_mov_b32 v75, 0
v_mfma_f32_16x16x32_bf16 v[200:203], v[204:207], v[204:207], 0
v_mfma_f32_16x16x32_bf16 v[200:203], v[204:207], v[204:207], 0
s_waitcnt lgkmcnt(0)
v_pk_add_f32 v[76:77], v[76:77], v[80:81]
v_pk_add_f32 v[84:85], v[84:85], v[88:89]
v_pk_add_f32 v[78:79], v[78:79], v[82:83]
v_pk_add_f32 v[86:87], v[86:87], v[90:91]
v_pk_add_f32 v[76:77], v[76:77], v[84:85]
v_pk_add_f32 v[78:79], v[78:79], v[86:87]
v_cvt_pk_bf16_f32 v76, v76, v77
v_cvt_pk_bf16_f32 v77, v78, v79
ds_write_b64 v19, v[76:77] offset:20480
buffer_load_dwordx4 v[112:115], v11, s[4:7], s40 offen offset:0 sc1
buffer_load_dwordx4 v[116:119], v11, s[4:7], s40 offen offset:1024 sc1
v_mfma_f32_16x16x32_bf16 v[200:203], v[204:207], v[204:207], 0
v_mfma_f32_16x16x32_bf16 v[200:203], v[204:207], v[204:207], 0
s_waitcnt lgkmcnt(0)
s_barrier
ds_read_b128 v[96:99], v20 offset:20480
ds_read_b128 v[100:103], v20 offset:20992
ds_read_b128 v[104:107], v20 offset:21504
ds_read_b128 v[108:111], v20 offset:22016
v_mfma_f32_16x16x32_bf16 v[200:203], v[204:207], v[204:207], 0
v_mfma_f32_16x16x32_bf16 v[200:203], v[204:207], v[204:207], 0
s_waitcnt lgkmcnt(3)
v_mfma_f32_16x16x32_bf16 v[64:67], v[128:131], v[96:99], 0
v_mfma_f32_16x16x32_bf16 v[68:71], v[144:147], v[96:99], 0
s_waitcnt lgkmcnt(2)
buffer_load_dwordx4 v[48:51], v11, s[4:7], s40 offen offset:0 sc1
v_mfma_f32_16x16x32_bf16 v[64:67], v[132:135], v[100:103], v[64:67]
v_mfma_f32_16x16x32_bf16 v[68:71], v[148:151], v[100:103], v[68:71]
s_waitcnt lgkmcnt(1)
buffer_load_dwordx4 v[52:55], v11, s[4:7], s40 offen offset:1024 sc1
v_mfma_f32_16x16x32_bf16 v[64:67], v[136:139], v[104:107], v[64:67]
v_mfma_f32_16x16x32_bf16 v[68:71], v[152:155], v[104:107], v[68:71]
s_waitcnt lgkmcnt(0)
s_waitcnt vmcnt(2)
v_max3_u32 v44, v112, v113, v114
v_max3_u32 v44, v44, v115, v116
v_max3_u32 v44, v44, v117, v118
v_max_u32 v44, v44, v119
v_cmp_eq_u32 vcc, -1, v44
v_mfma_f32_16x16x32_bf16 v[64:67], v[140:143], v[108:111], v[64:67]
v_mfma_f32_16x16x32_bf16 v[68:71], v[156:159], v[108:111], v[68:71]
s_cbranch_vccnz Lkr_144
v_smfmac_f32_16x16x64_bf16 v[72:75], v[112:115], v[96:103], v15
v_smfmac_f32_16x16x64_bf16 v[72:75], v[116:119], v[104:111], v15
Lko_145:
s_nop 3
v_max3_f32 v45, v64, v65, v66
v_max3_f32 v45, v45, v67, v68
v_max3_f32 v45, v45, v69, v70
v_max_f32 v45, v45, v71
v_add_f32 v72, v72, v73
v_add_f32 v73, v74, v75
v_max3_f32 v46, v45, v72, v73
v_max3_f32 v47, v45, v72, v73
buffer_load_dwordx2 v[120:121], v12, s[4:7], s40 offen sc1
buffer_load_dwordx2 v[122:123], v13, s[4:7], s40 offen sc1
s_nop 1
v_permlane32_swap_b32 v46, v47
s_nop 0
v_max_f32 v45, v46, v47
v_max_f32 v46, v46, v47
s_nop 1
v_permlane16_swap_b32 v45, v46
s_nop 0
v_max_f32 v45, v45, v46
v_mul_f32 v46, s49, v45
v_pk_fma_f32 v[64:65], v[64:65], s[48:49], v[46:47] op_sel_hi:[1,0,0]
v_pk_fma_f32 v[66:67], v[66:67], s[48:49], v[46:47] op_sel_hi:[1,0,0]
v_pk_fma_f32 v[68:69], v[68:69], s[48:49], v[46:47] op_sel_hi:[1,0,0]
v_pk_fma_f32 v[70:71], v[70:71], s[48:49], v[46:47] op_sel_hi:[1,0,0]
v_pk_fma_f32 v[72:73], v[72:73], s[48:49], v[46:47] op_sel_hi:[1,0,0]
v_exp_f32 v64, v64
v_exp_f32 v65, v65
v_exp_f32 v66, v66
v_exp_f32 v67, v67
v_exp_f32 v68, v68
v_exp_f32 v69, v69
v_exp_f32 v70, v70
v_exp_f32 v71, v71
v_exp_f32 v72, v72
v_exp_f32 v73, v73
buffer_store_dword v197, v193, s[4:7], s59 offen sc1
v_cvt_pk_bf16_f32 v76, v64, v65
v_cvt_pk_bf16_f32 v77, v66, v67
v_cvt_pk_bf16_f32 v78, v68, v69
v_cvt_pk_bf16_f32 v79, v70, v71
v_cvt_pk_bf16_f32 v2, v72, v73
v_cvt_pk_bf16_f32 v7, v72, v73
v_mfma_f32_16x16x32_bf16 v[84:87], v[32:35], v[76:79], 0
v_mfma_f32_16x16x32_bf16 v[96:99], v[160:163], v[76:79], 0
s_waitcnt vmcnt(1)
v_max3_u32 v44, v120, v121, v122
v_max_u32 v44, v44, v123
v_cmp_eq_u32 vcc, -1, v44
v_mfma_f32_16x16x32_bf16 v[100:103], v[164:167], v[76:79], 0
v_mfma_f32_16x16x32_bf16 v[84:87], v[32:35], v[2:5], v[84:87]
s_cbranch_vccnz Lvr_146
Lvo_147:
v_mfma_f32_16x16x32_bf16 v[96:99], v[120:123], v[2:5], v[96:99]
v_mfma_f32_16x16x32_bf16 v[100:103], v[120:123], v[6:9], v[100:103]
v_mfma_f32_16x16x32_bf16 v[200:203], v[204:207], v[204:207], 0
s_nop 4
v_rcp_f32 v46, v84
s_nop 0
v_pk_mul_f32 v[96:97], v[96:97], v[46:47] op_sel_hi:[1,0]
v_pk_mul_f32 v[98:99], v[98:99], v[46:47] op_sel_hi:[1,0]
v_pk_mul_f32 v[100:101], v[100:101], v[46:47] op_sel_hi:[1,0]
v_pk_mul_f32 v[102:103], v[102:103], v[46:47] op_sel_hi:[1,0]
v_cvt_pk_bf16_f32 v124, v96, v97
v_cvt_pk_bf16_f32 v125, v98, v99
v_cvt_pk_bf16_f32 v126, v100, v101
v_cvt_pk_bf16_f32 v127, v102, v103
v_min_u32 v124, -2, v124
v_min_u32 v125, -2, v125
v_min_u32 v126, -2, v126
v_min_u32 v127, -2, v127
buffer_store_dwordx4 v[124:127], v14, s[4:7], s40 offen sc1
s_barrier
buffer_store_dwordx4 v[28:31], v14, s[4:7], s42 offen sc1
s_cmp_ge_u32 s36, 62
s_cbranch_scc1 Lnp_148
s_mov_b32 m0, s57
s_add_u32 s38, s47, 3072
buffer_load_dwordx4 v21, s[4:7], s47 offen offset:0 sc1 lds
buffer_load_dwordx4 v21, s[4:7], s47 offen offset:1024 sc1 lds
buffer_load_dwordx4 v21, s[4:7], s47 offen offset:2048 sc1 lds
s_add_u32 m0, s57, 3072
s_xor_b32 s57, s57, 98304
buffer_load_dwordx4 v21, s[4:7], s38 offen offset:0 sc1 lds
buffer_load_dwordx4 v21, s[4:7], s38 offen offset:1024 sc1 lds
buffer_load_dwordx4 v21, s[4:7], s38 offen offset:2048 sc1 lds
s_add_u32 s47, s47, 786432
s_add_u32 s38, s36, 2
s_and_b32 s38, s38, 3
s_lshl_b32 s39, s38, 1
s_lshr_b32 s52, s46, s39
s_and_b32 s52, s52, 1
s_lshl_b32 s52, s52, 13
s_lshl_b32 s39, s39, 21
s_add_u32 s39, s39, s52
s_add_u32 s88, s39, 134217728
s_lshl_b32 s39, s38, 1
s_lshr_b32 s52, s46, s39
s_and_b32 s52, s52, 1
s_lshl_b32 s52, s52, 13
s_lshl_b32 s39, s39, 21
s_add_u32 s39, s39, s52
s_add_u32 s89, s39, 135266304
buffer_store_dwordx2 v[28:29], v198, s[4:7], s88 offen sc1
buffer_store_dwordx2 v[28:29], v198, s[4:7], s89 offen sc1
Lnp_148:
v_mov_b32 v72, 0
v_mov_b32 v73, 0
v_mov_b32 v74, 0
v_mov_b32 v75, 0
v_mfma_f32_16x16x32_bf16 v[64:67], v[128:131], v[176:179], v[36:39]
v_mfma_f32_16x16x32_bf16 v[68:71], v[144:147], v[176:179], v[40:43]
v_mfma_f32_16x16x32_bf16 v[64:67], v[132:135], v[180:183], v[64:67]
v_mfma_f32_16x16x32_bf16 v[68:71], v[148:151], v[180:183], v[68:71]
v_mfma_f32_16x16x32_bf16 v[64:67], v[136:139], v[184:187], v[64:67]
v_mfma_f32_16x16x32_bf16 v[68:71], v[152:155], v[184:187], v[68:71]
v_mfma_f32_16x16x32_bf16 v[64:67], v[140:143], v[188:191], v[64:67]
v_mfma_f32_16x16x32_bf16 v[68:71], v[156:159], v[188:191], v[68:71]
v_smfmac_f32_16x16x64_bf16 v[72:75], v[112:115], v[176:183], v15
v_smfmac_f32_16x16x64_bf16 v[72:75], v[116:119], v[184:191], v15
s_lshr_b32 s38, s36, 1
s_lshl_b32 s38, s38, 19
s_and_b32 s39, s36, 1
s_lshl_b32 s39, s39, 11
s_add_u32 s38, s38, s39
s_add_u32 s50, s38, 83886080
v_max3_f32 v45, v64, v65, v66
v_max3_f32 v45, v45, v67, v68
v_max3_f32 v45, v45, v69, v70
v_max_f32 v45, v45, v71
v_add_f32 v72, v72, v73
v_add_f32 v73, v74, v75
v_max3_f32 v46, v45, v72, v73
v_max3_f32 v47, v45, v72, v73
s_nop 1
v_permlane32_swap_b32 v46, v47
s_nop 0
v_max_f32 v45, v46, v47
v_max_f32 v46, v46, v47
s_nop 1
v_permlane16_swap_b32 v45, v46
s_nop 0
v_max_f32 v45, v45, v46
v_mul_f32 v46, s49, v45
v_pk_fma_f32 v[64:65], v[64:65], s[48:49], v[46:47] op_sel_hi:[1,0,0]
v_pk_fma_f32 v[66:67], v[66:67], s[48:49], v[46:47] op_sel_hi:[1,0,0]
v_pk_fma_f32 v[68:69], v[68:69], s[48:49], v[46:47] op_sel_hi:[1,0,0]
v_pk_fma_f32 v[70:71], v[70:71], s[48:49], v[46:47] op_sel_hi:[1,0,0]
v_pk_fma_f32 v[72:73], v[72:73], s[48:49], v[46:47] op_sel_hi:[1,0,0]
v_exp_f32 v64, v64
v_exp_f32 v65, v65
v_exp_f32 v66, v66
v_exp_f32 v67, v67
v_exp_f32 v68, v68
v_exp_f32 v69, v69
v_exp_f32 v70, v70
v_exp_f32 v71, v71
v_exp_f32 v72, v72
v_exp_f32 v73, v73
v_cvt_pk_bf16_f32 v76, v64, v65
v_cvt_pk_bf16_f32 v77, v66, v67
v_cvt_pk_bf16_f32 v78, v68, v69
v_cvt_pk_bf16_f32 v79, v70, v71
v_cvt_pk_bf16_f32 v2, v72, v73
v_cvt_pk_bf16_f32 v7, v72, v73
v_mfma_f32_16x16x32_bf16 v[84:87], v[32:35], v[76:79], 0
v_mfma_f32_16x16x32_bf16 v[96:99], v[160:163], v[76:79], 0
v_mfma_f32_16x16x32_bf16 v[100:103], v[164:167], v[76:79], 0
v_mfma_f32_16x16x32_bf16 v[104:107], v[168:171], v[76:79], 0
v_mfma_f32_16x16x32_bf16 v[108:111], v[172:175], v[76:79], 0
v_mfma_f32_16x16x32_bf16 v[84:87], v[32:35], v[2:5], v[84:87]
v_mfma_f32_16x16x32_bf16 v[96:99], v[120:123], v[2:5], v[96:99]
v_mfma_f32_16x16x32_bf16 v[100:103], v[120:123], v[6:9], v[100:103]
v_mfma_f32_16x16x32_bf16 v[104:107], v[120:123], v[0:3], v[104:107]
v_mfma_f32_16x16x32_bf16 v[108:111], v[120:123], v[4:7], v[108:111]
v_mfma_f32_16x16x32_bf16 v[200:203], v[204:207], v[204:207], 0
s_nop 2
v_rcp_f32 v46, v84
s_nop 0
v_pk_mul_f32 v[96:97], v[96:97], v[46:47] op_sel_hi:[1,0]
v_pk_mul_f32 v[98:99], v[98:99], v[46:47] op_sel_hi:[1,0]
v_pk_mul_f32 v[100:101], v[100:101], v[46:47] op_sel_hi:[1,0]
v_pk_mul_f32 v[102:103], v[102:103], v[46:47] op_sel_hi:[1,0]
v_pk_mul_f32 v[104:105], v[104:105], v[46:47] op_sel_hi:[1,0]
v_pk_mul_f32 v[106:107], v[106:107], v[46:47] op_sel_hi:[1,0]
v_pk_mul_f32 v[108:109], v[108:109], v[46:47] op_sel_hi:[1,0]
v_pk_mul_f32 v[110:111], v[110:111], v[46:47] op_sel_hi:[1,0]
v_cvt_pk_bf16_f32 v96, v96, v97
v_cvt_pk_bf16_f32 v97, v98, v99
v_cvt_pk_bf16_f32 v98, v100, v101
v_cvt_pk_bf16_f32 v99, v102, v103
v_cvt_pk_bf16_f32 v100, v104, v105
v_cvt_pk_bf16_f32 v101, v106, v107
v_cvt_pk_bf16_f32 v102, v108, v109
v_cvt_pk_bf16_f32 v103, v110, v111
buffer_store_dwordx4 v[96:99], v26, s[4:7], s50 offen sc1
buffer_store_dwordx4 v[100:103], v27, s[4:7], s50 offen sc1
s_add_u32 s36, s36, 1
s_cmp_lt_u32 s36, 64
s_cbranch_scc1 Lq_135
s_branch Lend_8
Lpf_140:
buffer_load_dwordx4 v[48:51], v10, s[4:7], s40 offen offset:0 sc1
v_mfma_f32_16x16x32_bf16 v[200:203], v[204:207], v[204:207], 0
s_sub_u32 s37, s37, 1
s_cbranch_scc1 Lend_8
Lps_149:
s_waitcnt vmcnt(3)
v_max3_u32 v44, v52, v53, v54
v_max_u32 v44, v44, v55
v_cmp_eq_u32 vcc, -1, v44
s_cbranch_vccnz Lpf_150
v_smfmac_f32_16x16x64_bf16 v[64:67], v[52:55], a[64:71], v15
v_smfmac_f32_16x16x64_bf16 v[68:71], v[52:55], a[72:79], v15
v_smfmac_f32_16x16x64_bf16 v[72:75], v[52:55], a[80:87], v15
v_smfmac_f32_16x16x64_bf16 v[76:79], v[52:55], a[88:95], v15
v_smfmac_f32_16x16x64_bf16 v[80:83], v[52:55], a[96:103], v15
v_smfmac_f32_16x16x64_bf16 v[84:87], v[52:55], a[104:111], v15
v_smfmac_f32_16x16x64_bf16 v[88:91], v[52:55], a[112:119], v15
v_smfmac_f32_16x16x64_bf16 v[92:95], v[52:55], a[120:127], v15
Lps_151:
s_waitcnt vmcnt(2)
v_max3_u32 v44, v56, v57, v58
v_max_u32 v44, v44, v59
v_cmp_eq_u32 vcc, -1, v44
s_cbranch_vccnz Lpf_152
v_smfmac_f32_16x16x64_bf16 v[64:67], v[56:59], a[128:135], v15
v_smfmac_f32_16x16x64_bf16 v[68:71], v[56:59], a[136:143], v15
v_smfmac_f32_16x16x64_bf16 v[72:75], v[56:59], a[144:151], v15
v_smfmac_f32_16x16x64_bf16 v[76:79], v[56:59], a[152:159], v15
v_smfmac_f32_16x16x64_bf16 v[80:83], v[56:59], a[160:167], v15
v_smfmac_f32_16x16x64_bf16 v[84:87], v[56:59], a[168:175], v15
v_smfmac_f32_16x16x64_bf16 v[88:91], v[56:59], a[176:183], v15
v_smfmac_f32_16x16x64_bf16 v[92:95], v[56:59], a[184:191], v15
Lps_153:
s_waitcnt vmcnt(1)
v_max3_u32 v44, v60, v61, v62
v_max_u32 v44, v44, v63
v_cmp_eq_u32 vcc, -1, v44
s_cbranch_vccnz Lpf_154
v_smfmac_f32_16x16x64_bf16 v[64:67], v[60:63], a[192:199], v15
v_smfmac_f32_16x16x64_bf16 v[68:71], v[60:63], a[200:207], v15
v_smfmac_f32_16x16x64_bf16 v[72:75], v[60:63], a[208:215], v15
v_smfmac_f32_16x16x64_bf16 v[76:79], v[60:63], a[216:223], v15
v_smfmac_f32_16x16x64_bf16 v[80:83], v[60:63], a[224:231], v15
v_smfmac_f32_16x16x64_bf16 v[84:87], v[60:63], a[232:239], v15
v_smfmac_f32_16x16x64_bf16 v[88:91], v[60:63], a[240:247], v15
v_smfmac_f32_16x16x64_bf16 v[92:95], v[60:63], a[248:255], v15
Lps_155:
s_waitcnt vmcnt(0)
v_max3_u32 v44, v48, v49, v50
v_max_u32 v44, v44, v51
v_cmp_eq_u32 vcc, -1, v44
s_cbranch_vccnz Lpf_156
v_smfmac_f32_16x16x64_bf16 v[64:67], v[48:51], a[0:7], v15
v_smfmac_f32_16x16x64_bf16 v[68:71], v[48:51], a[8:15], v15
v_smfmac_f32_16x16x64_bf16 v[72:75], v[48:51], a[16:23], v15
v_smfmac_f32_16x16x64_bf16 v[76:79], v[48:51], a[24:31], v15
v_smfmac_f32_16x16x64_bf16 v[80:83], v[48:51], a[32:39], v15
v_smfmac_f32_16x16x64_bf16 v[84:87], v[48:51], a[40:47], v15
v_smfmac_f32_16x16x64_bf16 v[88:91], v[48:51], a[48:55], v15
v_smfmac_f32_16x16x64_bf16 v[92:95], v[48:51], a[56:63], v15
s_branch Lpd_139
Lpf_141:
buffer_load_dwordx4 v[52:55], v10, s[4:7], s40 offen offset:1024 sc1
v_mfma_f32_16x16x32_bf16 v[200:203], v[204:207], v[204:207], 0
s_sub_u32 s37, s37, 1
s_cbranch_scc1 Lend_8
Lps_157:
s_waitcnt vmcnt(2)
v_max3_u32 v44, v56, v57, v58
v_max_u32 v44, v44, v59
v_cmp_eq_u32 vcc, -1, v44
s_cbranch_vccnz Lpf_158
v_smfmac_f32_16x16x64_bf16 v[64:67], v[56:59], a[128:135], v15
v_smfmac_f32_16x16x64_bf16 v[68:71], v[56:59], a[136:143], v15
v_smfmac_f32_16x16x64_bf16 v[72:75], v[56:59], a[144:151], v15
v_smfmac_f32_16x16x64_bf16 v[76:79], v[56:59], a[152:159], v15
v_smfmac_f32_16x16x64_bf16 v[80:83], v[56:59], a[160:167], v15
v_smfmac_f32_16x16x64_bf16 v[84:87], v[56:59], a[168:175], v15
v_smfmac_f32_16x16x64_bf16 v[88:91], v[56:59], a[176:183], v15
v_smfmac_f32_16x16x64_bf16 v[92:95], v[56:59], a[184:191], v15
Lps_159:
s_waitcnt vmcnt(1)
v_max3_u32 v44, v60, v61, v62
v_max_u32 v44, v44, v63
v_cmp_eq_u32 vcc, -1, v44
s_cbranch_vccnz Lpf_160
v_smfmac_f32_16x16x64_bf16 v[64:67], v[60:63], a[192:199], v15
v_smfmac_f32_16x16x64_bf16 v[68:71], v[60:63], a[200:207], v15
v_smfmac_f32_16x16x64_bf16 v[72:75], v[60:63], a[208:215], v15
v_smfmac_f32_16x16x64_bf16 v[76:79], v[60:63], a[216:223], v15
v_smfmac_f32_16x16x64_bf16 v[80:83], v[60:63], a[224:231], v15
v_smfmac_f32_16x16x64_bf16 v[84:87], v[60:63], a[232:239], v15
v_smfmac_f32_16x16x64_bf16 v[88:91], v[60:63], a[240:247], v15
v_smfmac_f32_16x16x64_bf16 v[92:95], v[60:63], a[248:255], v15
Lps_161:
s_waitcnt vmcnt(0)
v_max3_u32 v44, v52, v53, v54
v_max_u32 v44, v44, v55
v_cmp_eq_u32 vcc, -1, v44
s_cbranch_vccnz Lpf_162
v_smfmac_f32_16x16x64_bf16 v[64:67], v[52:55], a[64:71], v15
v_smfmac_f32_16x16x64_bf16 v[68:71], v[52:55], a[72:79], v15
v_smfmac_f32_16x16x64_bf16 v[72:75], v[52:55], a[80:87], v15
v_smfmac_f32_16x16x64_bf16 v[76:79], v[52:55], a[88:95], v15
v_smfmac_f32_16x16x64_bf16 v[80:83], v[52:55], a[96:103], v15
v_smfmac_f32_16x16x64_bf16 v[84:87], v[52:55], a[104:111], v15
v_smfmac_f32_16x16x64_bf16 v[88:91], v[52:55], a[112:119], v15
v_smfmac_f32_16x16x64_bf16 v[92:95], v[52:55], a[120:127], v15
s_branch Lpd_139
Lpf_142:
buffer_load_dwordx4 v[56:59], v10, s[4:7], s40 offen offset:2048 sc1
v_mfma_f32_16x16x32_bf16 v[200:203], v[204:207], v[204:207], 0
s_sub_u32 s37, s37, 1
s_cbranch_scc1 Lend_8
Lps_163:
s_waitcnt vmcnt(1)
v_max3_u32 v44, v60, v61, v62
v_max_u32 v44, v44, v63
v_cmp_eq_u32 vcc, -1, v44
s_cbranch_vccnz Lpf_164
v_smfmac_f32_16x16x64_bf16 v[64:67], v[60:63], a[192:199], v15
v_smfmac_f32_16x16x64_bf16 v[68:71], v[60:63], a[200:207], v15
v_smfmac_f32_16x16x64_bf16 v[72:75], v[60:63], a[208:215], v15
v_smfmac_f32_16x16x64_bf16 v[76:79], v[60:63], a[216:223], v15
v_smfmac_f32_16x16x64_bf16 v[80:83], v[60:63], a[224:231], v15
v_smfmac_f32_16x16x64_bf16 v[84:87], v[60:63], a[232:239], v15
v_smfmac_f32_16x16x64_bf16 v[88:91], v[60:63], a[240:247], v15
v_smfmac_f32_16x16x64_bf16 v[92:95], v[60:63], a[248:255], v15
Lps_165:
s_waitcnt vmcnt(0)
v_max3_u32 v44, v56, v57, v58
v_max_u32 v44, v44, v59
v_cmp_eq_u32 vcc, -1, v44
s_cbranch_vccnz Lpf_166
v_smfmac_f32_16x16x64_bf16 v[64:67], v[56:59], a[128:135], v15
v_smfmac_f32_16x16x64_bf16 v[68:71], v[56:59], a[136:143], v15
v_smfmac_f32_16x16x64_bf16 v[72:75], v[56:59], a[144:151], v15
v_smfmac_f32_16x16x64_bf16 v[76:79], v[56:59], a[152:159], v15
v_smfmac_f32_16x16x64_bf16 v[80:83], v[56:59], a[160:167], v15
v_smfmac_f32_16x16x64_bf16 v[84:87], v[56:59], a[168:175], v15
v_smfmac_f32_16x16x64_bf16 v[88:91], v[56:59], a[176:183], v15
v_smfmac_f32_16x16x64_bf16 v[92:95], v[56:59], a[184:191], v15
s_branch Lpd_139
Lpf_143:
buffer_load_dwordx4 v[60:63], v10, s[4:7], s40 offen offset:3072 sc1
v_mfma_f32_16x16x32_bf16 v[200:203], v[204:207], v[204:207], 0
s_sub_u32 s37, s37, 1
s_cbranch_scc1 Lend_8
Lps_167:
s_waitcnt vmcnt(0)
v_max3_u32 v44, v60, v61, v62
v_max_u32 v44, v44, v63
v_cmp_eq_u32 vcc, -1, v44
s_cbranch_vccnz Lpf_168
v_smfmac_f32_16x16x64_bf16 v[64:67], v[60:63], a[192:199], v15
v_smfmac_f32_16x16x64_bf16 v[68:71], v[60:63], a[200:207], v15
v_smfmac_f32_16x16x64_bf16 v[72:75], v[60:63], a[208:215], v15
v_smfmac_f32_16x16x64_bf16 v[76:79], v[60:63], a[216:223], v15
v_smfmac_f32_16x16x64_bf16 v[80:83], v[60:63], a[224:231], v15
v_smfmac_f32_16x16x64_bf16 v[84:87], v[60:63], a[232:239], v15
v_smfmac_f32_16x16x64_bf16 v[88:91], v[60:63], a[240:247], v15
v_smfmac_f32_16x16x64_bf16 v[92:95], v[60:63], a[248:255], v15
s_branch Lpd_139
Lpf_150:
buffer_load_dwordx4 v[52:55], v10, s[4:7], s40 offen offset:1024 sc1
v_mfma_f32_16x16x32_bf16 v[200:203], v[204:207], v[204:207], 0
Lps_169:
s_waitcnt vmcnt(3)
v_max3_u32 v44, v56, v57, v58
v_max_u32 v44, v44, v59
v_cmp_eq_u32 vcc, -1, v44
s_cbranch_vccnz Lpf_170
v_smfmac_f32_16x16x64_bf16 v[64:67], v[56:59], a[128:135], v15
v_smfmac_f32_16x16x64_bf16 v[68:71], v[56:59], a[136:143], v15
v_smfmac_f32_16x16x64_bf16 v[72:75], v[56:59], a[144:151], v15
v_smfmac_f32_16x16x64_bf16 v[76:79], v[56:59], a[152:159], v15
v_smfmac_f32_16x16x64_bf16 v[80:83], v[56:59], a[160:167], v15
v_smfmac_f32_16x16x64_bf16 v[84:87], v[56:59], a[168:175], v15
v_smfmac_f32_16x16x64_bf16 v[88:91], v[56:59], a[176:183], v15
v_smfmac_f32_16x16x64_bf16 v[92:95], v[56:59], a[184:191], v15
Lps_171:
s_waitcnt vmcnt(2)
v_max3_u32 v44, v60, v61, v62
v_max_u32 v44, v44, v63
v_cmp_eq_u32 vcc, -1, v44
s_cbranch_vccnz Lpf_172
v_smfmac_f32_16x16x64_bf16 v[64:67], v[60:63], a[192:199], v15
v_smfmac_f32_16x16x64_bf16 v[68:71], v[60:63], a[200:207], v15
v_smfmac_f32_16x16x64_bf16 v[72:75], v[60:63], a[208:215], v15
v_smfmac_f32_16x16x64_bf16 v[76:79], v[60:63], a[216:223], v15
v_smfmac_f32_16x16x64_bf16 v[80:83], v[60:63], a[224:231], v15
v_smfmac_f32_16x16x64_bf16 v[84:87], v[60:63], a[232:239], v15
v_smfmac_f32_16x16x64_bf16 v[88:91], v[60:63], a[240:247], v15
v_smfmac_f32_16x16x64_bf16 v[92:95], v[60:63], a[248:255], v15
Lps_173:
s_waitcnt vmcnt(1)
v_max3_u32 v44, v48, v49, v50
v_max_u32 v44, v44, v51
v_cmp_eq_u32 vcc, -1, v44
s_cbranch_vccnz Lpf_174
v_smfmac_f32_16x16x64_bf16 v[64:67], v[48:51], a[0:7], v15
v_smfmac_f32_16x16x64_bf16 v[68:71], v[48:51], a[8:15], v15
v_smfmac_f32_16x16x64_bf16 v[72:75], v[48:51], a[16:23], v15
v_smfmac_f32_16x16x64_bf16 v[76:79], v[48:51], a[24:31], v15
v_smfmac_f32_16x16x64_bf16 v[80:83], v[48:51], a[32:39], v15
v_smfmac_f32_16x16x64_bf16 v[84:87], v[48:51], a[40:47], v15
v_smfmac_f32_16x16x64_bf16 v[88:91], v[48:51], a[48:55], v15
v_smfmac_f32_16x16x64_bf16 v[92:95], v[48:51], a[56:63], v15
s_branch Lps_161
Lpf_152:
buffer_load_dwordx4 v[56:59], v10, s[4:7], s40 offen offset:2048 sc1
v_mfma_f32_16x16x32_bf16 v[200:203], v[204:207], v[204:207], 0
Lps_175:
s_waitcnt vmcnt(2)
v_max3_u32 v44, v60, v61, v62
v_max_u32 v44, v44, v63
v_cmp_eq_u32 vcc, -1, v44
s_cbranch_vccnz Lpf_176
v_smfmac_f32_16x16x64_bf16 v[64:67], v[60:63], a[192:199], v15
v_smfmac_f32_16x16x64_bf16 v[68:71], v[60:63], a[200:207], v15
v_smfmac_f32_16x16x64_bf16 v[72:75], v[60:63], a[208:215], v15
v_smfmac_f32_16x16x64_bf16 v[76:79], v[60:63], a[216:223], v15
v_smfmac_f32_16x16x64_bf16 v[80:83], v[60:63], a[224:231], v15
v_smfmac_f32_16x16x64_bf16 v[84:87], v[60:63], a[232:239], v15
v_smfmac_f32_16x16x64_bf16 v[88:91], v[60:63], a[240:247], v15
v_smfmac_f32_16x16x64_bf16 v[92:95], v[60:63], a[248:255], v15
Lps_177:
s_waitcnt vmcnt(1)
v_max3_u32 v44, v48, v49, v50
v_max_u32 v44, v44, v51
v_cmp_eq_u32 vcc, -1, v44
s_cbranch_vccnz Lpf_178
v_smfmac_f32_16x16x64_bf16 v[64:67], v[48:51], a[0:7], v15
v_smfmac_f32_16x16x64_bf16 v[68:71], v[48:51], a[8:15], v15
v_smfmac_f32_16x16x64_bf16 v[72:75], v[48:51], a[16:23], v15
v_smfmac_f32_16x16x64_bf16 v[76:79], v[48:51], a[24:31], v15
v_smfmac_f32_16x16x64_bf16 v[80:83], v[48:51], a[32:39], v15
v_smfmac_f32_16x16x64_bf16 v[84:87], v[48:51], a[40:47], v15
v_smfmac_f32_16x16x64_bf16 v[88:91], v[48:51], a[48:55], v15
v_smfmac_f32_16x16x64_bf16 v[92:95], v[48:51], a[56:63], v15
s_branch Lps_165
Lpf_154:
buffer_load_dwordx4 v[60:63], v10, s[4:7], s40 offen offset:3072 sc1
v_mfma_f32_16x16x32_bf16 v[200:203], v[204:207], v[204:207], 0
Lps_179:
s_waitcnt vmcnt(1)
v_max3_u32 v44, v48, v49, v50
v_max_u32 v44, v44, v51
v_cmp_eq_u32 vcc, -1, v44
s_cbranch_vccnz Lpf_180
v_smfmac_f32_16x16x64_bf16 v[64:67], v[48:51], a[0:7], v15
v_smfmac_f32_16x16x64_bf16 v[68:71], v[48:51], a[8:15], v15
v_smfmac_f32_16x16x64_bf16 v[72:75], v[48:51], a[16:23], v15
v_smfmac_f32_16x16x64_bf16 v[76:79], v[48:51], a[24:31], v15
v_smfmac_f32_16x16x64_bf16 v[80:83], v[48:51], a[32:39], v15
v_smfmac_f32_16x16x64_bf16 v[84:87], v[48:51], a[40:47], v15
v_smfmac_f32_16x16x64_bf16 v[88:91], v[48:51], a[48:55], v15
v_smfmac_f32_16x16x64_bf16 v[92:95], v[48:51], a[56:63], v15
s_branch Lps_167
Lpf_156:
buffer_load_dwordx4 v[48:51], v10, s[4:7], s40 offen offset:0 sc1
v_mfma_f32_16x16x32_bf16 v[200:203], v[204:207], v[204:207], 0
s_sub_u32 s37, s37, 1
s_cbranch_scc1 Lend_8
s_branch Lps_155
Lpf_158:
buffer_load_dwordx4 v[56:59], v10, s[4:7], s40 offen offset:2048 sc1
v_mfma_f32_16x16x32_bf16 v[200:203], v[204:207], v[204:207], 0
Lps_181:
s_waitcnt vmcnt(2)
v_max3_u32 v44, v60, v61, v62
v_max_u32 v44, v44, v63
v_cmp_eq_u32 vcc, -1, v44
s_cbranch_vccnz Lpf_182
v_smfmac_f32_16x16x64_bf16 v[64:67], v[60:63], a[192:199], v15
v_smfmac_f32_16x16x64_bf16 v[68:71], v[60:63], a[200:207], v15
v_smfmac_f32_16x16x64_bf16 v[72:75], v[60:63], a[208:215], v15
v_smfmac_f32_16x16x64_bf16 v[76:79], v[60:63], a[216:223], v15
v_smfmac_f32_16x16x64_bf16 v[80:83], v[60:63], a[224:231], v15
v_smfmac_f32_16x16x64_bf16 v[84:87], v[60:63], a[232:239], v15
v_smfmac_f32_16x16x64_bf16 v[88:91], v[60:63], a[240:247], v15
v_smfmac_f32_16x16x64_bf16 v[92:95], v[60:63], a[248:255], v15
Lps_183:
s_waitcnt vmcnt(1)
v_max3_u32 v44, v52, v53, v54
v_max_u32 v44, v44, v55
v_cmp_eq_u32 vcc, -1, v44
s_cbranch_vccnz Lpf_184
v_smfmac_f32_16x16x64_bf16 v[64:67], v[52:55], a[64:71], v15
v_smfmac_f32_16x16x64_bf16 v[68:71], v[52:55], a[72:79], v15
v_smfmac_f32_16x16x64_bf16 v[72:75], v[52:55], a[80:87], v15
v_smfmac_f32_16x16x64_bf16 v[76:79], v[52:55], a[88:95], v15
v_smfmac_f32_16x16x64_bf16 v[80:83], v[52:55], a[96:103], v15
v_smfmac_f32_16x16x64_bf16 v[84:87], v[52:55], a[104:111], v15
v_smfmac_f32_16x16x64_bf16 v[88:91], v[52:55], a[112:119], v15
v_smfmac_f32_16x16x64_bf16 v[92:95], v[52:55], a[120:127], v15
s_branch Lps_165
Lpf_160:
buffer_load_dwordx4 v[60:63], v10, s[4:7], s40 offen offset:3072 sc1
v_mfma_f32_16x16x32_bf16 v[200:203], v[204:207], v[204:207], 0
Lps_185:
s_waitcnt vmcnt(1)
v_max3_u32 v44, v52, v53, v54
v_max_u32 v44, v44, v55
v_cmp_eq_u32 vcc, -1, v44
s_cbranch_vccnz Lpf_186
v_smfmac_f32_16x16x64_bf16 v[64:67], v[52:55], a[64:71], v15
v_smfmac_f32_16x16x64_bf16 v[68:71], v[52:55], a[72:79], v15
v_smfmac_f32_16x16x64_bf16 v[72:75], v[52:55], a[80:87], v15
v_smfmac_f32_16x16x64_bf16 v[76:79], v[52:55], a[88:95], v15
v_smfmac_f32_16x16x64_bf16 v[80:83], v[52:55], a[96:103], v15
v_smfmac_f32_16x16x64_bf16 v[84:87], v[52:55], a[104:111], v15
v_smfmac_f32_16x16x64_bf16 v[88:91], v[52:55], a[112:119], v15
v_smfmac_f32_16x16x64_bf16 v[92:95], v[52:55], a[120:127], v15
s_branch Lps_167
Lpf_162:
buffer_load_dwordx4 v[52:55], v10, s[4:7], s40 offen offset:1024 sc1
v_mfma_f32_16x16x32_bf16 v[200:203], v[204:207], v[204:207], 0
s_sub_u32 s37, s37, 1
s_cbranch_scc1 Lend_8
s_branch Lps_161
Lpf_164:
buffer_load_dwordx4 v[60:63], v10, s[4:7], s40 offen offset:3072 sc1
v_mfma_f32_16x16x32_bf16 v[200:203], v[204:207], v[204:207], 0
Lps_187:
s_waitcnt vmcnt(1)
v_max3_u32 v44, v56, v57, v58
v_max_u32 v44, v44, v59
v_cmp_eq_u32 vcc, -1, v44
s_cbranch_vccnz Lpf_188
v_smfmac_f32_16x16x64_bf16 v[64:67], v[56:59], a[128:135], v15
v_smfmac_f32_16x16x64_bf16 v[68:71], v[56:59], a[136:143], v15
v_smfmac_f32_16x16x64_bf16 v[72:75], v[56:59], a[144:151], v15
v_smfmac_f32_16x16x64_bf16 v[76:79], v[56:59], a[152:159], v15
v_smfmac_f32_16x16x64_bf16 v[80:83], v[56:59], a[160:167], v15
v_smfmac_f32_16x16x64_bf16 v[84:87], v[56:59], a[168:175], v15
v_smfmac_f32_16x16x64_bf16 v[88:91], v[56:59], a[176:183], v15
v_smfmac_f32_16x16x64_bf16 v[92:95], v[56:59], a[184:191], v15
s_branch Lps_167
Lpf_166:
buffer_load_dwordx4 v[56:59], v10, s[4:7], s40 offen offset:2048 sc1
v_mfma_f32_16x16x32_bf16 v[200:203], v[204:207], v[204:207], 0
s_sub_u32 s37, s37, 1
s_cbranch_scc1 Lend_8
s_branch Lps_165
Lpf_168:
buffer_load_dwordx4 v[60:63], v10, s[4:7], s40 offen offset:3072 sc1
v_mfma_f32_16x16x32_bf16 v[200:203], v[204:207], v[204:207], 0
s_sub_u32 s37, s37, 1
s_cbranch_scc1 Lend_8
s_branch Lps_167
Lpf_170:
buffer_load_dwordx4 v[56:59], v10, s[4:7], s40 offen offset:2048 sc1
v_mfma_f32_16x16x32_bf16 v[200:203], v[204:207], v[204:207], 0
Lps_189:
s_waitcnt vmcnt(3)
v_max3_u32 v44, v60, v61, v62
v_max_u32 v44, v44, v63
v_cmp_eq_u32 vcc, -1, v44
s_cbranch_vccnz Lpf_190
v_smfmac_f32_16x16x64_bf16 v[64:67], v[60:63], a[192:199], v15
v_smfmac_f32_16x16x64_bf16 v[68:71], v[60:63], a[200:207], v15
v_smfmac_f32_16x16x64_bf16 v[72:75], v[60:63], a[208:215], v15
v_smfmac_f32_16x16x64_bf16 v[76:79], v[60:63], a[216:223], v15
v_smfmac_f32_16x16x64_bf16 v[80:83], v[60:63], a[224:231], v15
v_smfmac_f32_16x16x64_bf16 v[84:87], v[60:63], a[232:239], v15
v_smfmac_f32_16x16x64_bf16 v[88:91], v[60:63], a[240:247], v15
v_smfmac_f32_16x16x64_bf16 v[92:95], v[60:63], a[248:255], v15
Lps_191:
s_waitcnt vmcnt(2)
v_max3_u32 v44, v48, v49, v50
v_max_u32 v44, v44, v51
v_cmp_eq_u32 vcc, -1, v44
s_cbranch_vccnz Lpf_192
v_smfmac_f32_16x16x64_bf16 v[64:67], v[48:51], a[0:7], v15
v_smfmac_f32_16x16x64_bf16 v[68:71], v[48:51], a[8:15], v15
v_smfmac_f32_16x16x64_bf16 v[72:75], v[48:51], a[16:23], v15
v_smfmac_f32_16x16x64_bf16 v[76:79], v[48:51], a[24:31], v15
v_smfmac_f32_16x16x64_bf16 v[80:83], v[48:51], a[32:39], v15
v_smfmac_f32_16x16x64_bf16 v[84:87], v[48:51], a[40:47], v15
v_smfmac_f32_16x16x64_bf16 v[88:91], v[48:51], a[48:55], v15
v_smfmac_f32_16x16x64_bf16 v[92:95], v[48:51], a[56:63], v15
s_branch Lps_183
Lpf_172:
buffer_load_dwordx4 v[60:63], v10, s[4:7], s40 offen offset:3072 sc1
v_mfma_f32_16x16x32_bf16 v[200:203], v[204:207], v[204:207], 0
Lps_193:
s_waitcnt vmcnt(2)
v_max3_u32 v44, v48, v49, v50
v_max_u32 v44, v44, v51
v_cmp_eq_u32 vcc, -1, v44
s_cbranch_vccnz Lpf_194
v_smfmac_f32_16x16x64_bf16 v[64:67], v[48:51], a[0:7], v15
v_smfmac_f32_16x16x64_bf16 v[68:71], v[48:51], a[8:15], v15
v_smfmac_f32_16x16x64_bf16 v[72:75], v[48:51], a[16:23], v15
v_smfmac_f32_16x16x64_bf16 v[76:79], v[48:51], a[24:31], v15
v_smfmac_f32_16x16x64_bf16 v[80:83], v[48:51], a[32:39], v15
v_smfmac_f32_16x16x64_bf16 v[84:87], v[48:51], a[40:47], v15
v_smfmac_f32_16x16x64_bf16 v[88:91], v[48:51], a[48:55], v15
v_smfmac_f32_16x16x64_bf16 v[92:95], v[48:51], a[56:63], v15
s_branch Lps_185
Lpf_174:
buffer_load_dwordx4 v[48:51], v10, s[4:7], s40 offen offset:0 sc1
v_mfma_f32_16x16x32_bf16 v[200:203], v[204:207], v[204:207], 0
s_sub_u32 s37, s37, 1
s_cbranch_scc1 Lend_8
Lps_195:
s_waitcnt vmcnt(1)
v_max3_u32 v44, v52, v53, v54
v_max_u32 v44, v44, v55
v_cmp_eq_u32 vcc, -1, v44
s_cbranch_vccnz Lpf_196
v_smfmac_f32_16x16x64_bf16 v[64:67], v[52:55], a[64:71], v15
v_smfmac_f32_16x16x64_bf16 v[68:71], v[52:55], a[72:79], v15
v_smfmac_f32_16x16x64_bf16 v[72:75], v[52:55], a[80:87], v15
v_smfmac_f32_16x16x64_bf16 v[76:79], v[52:55], a[88:95], v15
v_smfmac_f32_16x16x64_bf16 v[80:83], v[52:55], a[96:103], v15
v_smfmac_f32_16x16x64_bf16 v[84:87], v[52:55], a[104:111], v15
v_smfmac_f32_16x16x64_bf16 v[88:91], v[52:55], a[112:119], v15
v_smfmac_f32_16x16x64_bf16 v[92:95], v[52:55], a[120:127], v15
s_branch Lps_155
Lpf_176:
buffer_load_dwordx4 v[60:63], v10, s[4:7], s40 offen offset:3072 sc1
v_mfma_f32_16x16x32_bf16 v[200:203], v[204:207], v[204:207], 0
Lps_197:
s_waitcnt vmcnt(2)
v_max3_u32 v44, v48, v49, v50
v_max_u32 v44, v44, v51
v_cmp_eq_u32 vcc, -1, v44
s_cbranch_vccnz Lpf_198
v_smfmac_f32_16x16x64_bf16 v[64:67], v[48:51], a[0:7], v15
v_smfmac_f32_16x16x64_bf16 v[68:71], v[48:51], a[8:15], v15
v_smfmac_f32_16x16x64_bf16 v[72:75], v[48:51], a[16:23], v15
v_smfmac_f32_16x16x64_bf16 v[76:79], v[48:51], a[24:31], v15
v_smfmac_f32_16x16x64_bf16 v[80:83], v[48:51], a[32:39], v15
v_smfmac_f32_16x16x64_bf16 v[84:87], v[48:51], a[40:47], v15
v_smfmac_f32_16x16x64_bf16 v[88:91], v[48:51], a[48:55], v15
v_smfmac_f32_16x16x64_bf16 v[92:95], v[48:51], a[56:63], v15
s_branch Lps_187
Lpf_178:
buffer_load_dwordx4 v[48:51], v10, s[4:7], s40 offen offset:0 sc1
v_mfma_f32_16x16x32_bf16 v[200:203], v[204:207], v[204:207], 0
s_sub_u32 s37, s37, 1
s_cbranch_scc1 Lend_8
Lps_199:
s_waitcnt vmcnt(1)
v_max3_u32 v44, v56, v57, v58
v_max_u32 v44, v44, v59
v_cmp_eq_u32 vcc, -1, v44
s_cbranch_vccnz Lpf_200
v_smfmac_f32_16x16x64_bf16 v[64:67], v[56:59], a[128:135], v15
v_smfmac_f32_16x16x64_bf16 v[68:71], v[56:59], a[136:143], v15
v_smfmac_f32_16x16x64_bf16 v[72:75], v[56:59], a[144:151], v15
v_smfmac_f32_16x16x64_bf16 v[76:79], v[56:59], a[152:159], v15
v_smfmac_f32_16x16x64_bf16 v[80:83], v[56:59], a[160:167], v15
v_smfmac_f32_16x16x64_bf16 v[84:87], v[56:59], a[168:175], v15
v_smfmac_f32_16x16x64_bf16 v[88:91], v[56:59], a[176:183], v15
v_smfmac_f32_16x16x64_bf16 v[92:95], v[56:59], a[184:191], v15
s_branch Lps_155
Lpf_180:
buffer_load_dwordx4 v[48:51], v10, s[4:7], s40 offen offset:0 sc1
v_mfma_f32_16x16x32_bf16 v[200:203], v[204:207], v[204:207], 0
s_sub_u32 s37, s37, 1
s_cbranch_scc1 Lend_8
s_branch Lps_153
Lpf_182:
buffer_load_dwordx4 v[60:63], v10, s[4:7], s40 offen offset:3072 sc1
v_mfma_f32_16x16x32_bf16 v[200:203], v[204:207], v[204:207], 0
Lps_201:
s_waitcnt vmcnt(2)
v_max3_u32 v44, v52, v53, v54
v_max_u32 v44, v44, v55
v_cmp_eq_u32 vcc, -1, v44
s_cbranch_vccnz Lpf_202
v_smfmac_f32_16x16x64_bf16 v[64:67], v[52:55], a[64:71], v15
v_smfmac_f32_16x16x64_bf16 v[68:71], v[52:55], a[72:79], v15
v_smfmac_f32_16x16x64_bf16 v[72:75], v[52:55], a[80:87], v15
v_smfmac_f32_16x16x64_bf16 v[76:79], v[52:55], a[88:95], v15
v_smfmac_f32_16x16x64_bf16 v[80:83], v[52:55], a[96:103], v15
v_smfmac_f32_16x16x64_bf16 v[84:87], v[52:55], a[104:111], v15
v_smfmac_f32_16x16x64_bf16 v[88:91], v[52:55], a[112:119], v15
v_smfmac_f32_16x16x64_bf16 v[92:95], v[52:55], a[120:127], v15
s_branch Lps_187
Lpf_184:
buffer_load_dwordx4 v[52:55], v10, s[4:7], s40 offen offset:1024 sc1
v_mfma_f32_16x16x32_bf16 v[200:203], v[204:207], v[204:207], 0
s_sub_u32 s37, s37, 1
s_cbranch_scc1 Lend_8
Lps_203:
s_waitcnt vmcnt(1)
v_max3_u32 v44, v56, v57, v58
v_max_u32 v44, v44, v59
v_cmp_eq_u32 vcc, -1, v44
s_cbranch_vccnz Lpf_204
v_smfmac_f32_16x16x64_bf16 v[64:67], v[56:59], a[128:135], v15
v_smfmac_f32_16x16x64_bf16 v[68:71], v[56:59], a[136:143], v15
v_smfmac_f32_16x16x64_bf16 v[72:75], v[56:59], a[144:151], v15
v_smfmac_f32_16x16x64_bf16 v[76:79], v[56:59], a[152:159], v15
v_smfmac_f32_16x16x64_bf16 v[80:83], v[56:59], a[160:167], v15
v_smfmac_f32_16x16x64_bf16 v[84:87], v[56:59], a[168:175], v15
v_smfmac_f32_16x16x64_bf16 v[88:91], v[56:59], a[176:183], v15
v_smfmac_f32_16x16x64_bf16 v[92:95], v[56:59], a[184:191], v15
s_branch Lps_161
Lpf_186:
buffer_load_dwordx4 v[52:55], v10, s[4:7], s40 offen offset:1024 sc1
v_mfma_f32_16x16x32_bf16 v[200:203], v[204:207], v[204:207], 0
s_sub_u32 s37, s37, 1
s_cbranch_scc1 Lend_8
s_branch Lps_159
Lpf_188:
buffer_load_dwordx4 v[56:59], v10, s[4:7], s40 offen offset:2048 sc1
v_mfma_f32_16x16x32_bf16 v[200:203], v[204:207], v[204:207], 0
s_sub_u32 s37, s37, 1
s_cbranch_scc1 Lend_8
s_branch Lps_163
Lpf_190:
buffer_load_dwordx4 v[60:63], v10, s[4:7], s40 offen offset:3072 sc1
v_mfma_f32_16x16x32_bf16 v[200:203], v[204:207], v[204:207], 0
Lps_205:
s_waitcnt vmcnt(3)
v_max3_u32 v44, v48, v49, v50
v_max_u32 v44, v44, v51
v_cmp_eq_u32 vcc, -1, v44
s_cbranch_vccnz Lpf_206
v_smfmac_f32_16x16x64_bf16 v[64:67], v[48:51], a[0:7], v15
v_smfmac_f32_16x16x64_bf16 v[68:71], v[48:51], a[8:15], v15
v_smfmac_f32_16x16x64_bf16 v[72:75], v[48:51], a[16:23], v15
v_smfmac_f32_16x16x64_bf16 v[76:79], v[48:51], a[24:31], v15
v_smfmac_f32_16x16x64_bf16 v[80:83], v[48:51], a[32:39], v15
v_smfmac_f32_16x16x64_bf16 v[84:87], v[48:51], a[40:47], v15
v_smfmac_f32_16x16x64_bf16 v[88:91], v[48:51], a[48:55], v15
v_smfmac_f32_16x16x64_bf16 v[92:95], v[48:51], a[56:63], v15
s_branch Lps_201
Lpf_192:
buffer_load_dwordx4 v[48:51], v10, s[4:7], s40 offen offset:0 sc1
v_mfma_f32_16x16x32_bf16 v[200:203], v[204:207], v[204:207], 0
s_sub_u32 s37, s37, 1
s_cbranch_scc1 Lend_8
Lps_207:
s_waitcnt vmcnt(2)
v_max3_u32 v44, v52, v53, v54
v_max_u32 v44, v44, v55
v_cmp_eq_u32 vcc, -1, v44
s_cbranch_vccnz Lpf_208
v_smfmac_f32_16x16x64_bf16 v[64:67], v[52:55], a[64:71], v15
v_smfmac_f32_16x16x64_bf16 v[68:71], v[52:55], a[72:79], v15
v_smfmac_f32_16x16x64_bf16 v[72:75], v[52:55], a[80:87], v15
v_smfmac_f32_16x16x64_bf16 v[76:79], v[52:55], a[88:95], v15
v_smfmac_f32_16x16x64_bf16 v[80:83], v[52:55], a[96:103], v15
v_smfmac_f32_16x16x64_bf16 v[84:87], v[52:55], a[104:111], v15
v_smfmac_f32_16x16x64_bf16 v[88:91], v[52:55], a[112:119], v15
v_smfmac_f32_16x16x64_bf16 v[92:95], v[52:55], a[120:127], v15
s_branch Lps_199
Lpf_194:
buffer_load_dwordx4 v[48:51], v10, s[4:7], s40 offen offset:0 sc1
v_mfma_f32_16x16x32_bf16 v[200:203], v[204:207], v[204:207], 0
s_sub_u32 s37, s37, 1
s_cbranch_scc1 Lend_8
Lps_209:
s_waitcnt vmcnt(2)
v_max3_u32 v44, v52, v53, v54
v_max_u32 v44, v44, v55
v_cmp_eq_u32 vcc, -1, v44
s_cbranch_vccnz Lpf_210
v_smfmac_f32_16x16x64_bf16 v[64:67], v[52:55], a[64:71], v15
v_smfmac_f32_16x16x64_bf16 v[68:71], v[52:55], a[72:79], v15
v_smfmac_f32_16x16x64_bf16 v[72:75], v[52:55], a[80:87], v15
v_smfmac_f32_16x16x64_bf16 v[76:79], v[52:55], a[88:95], v15
v_smfmac_f32_16x16x64_bf16 v[80:83], v[52:55], a[96:103], v15
v_smfmac_f32_16x16x64_bf16 v[84:87], v[52:55], a[104:111], v15
v_smfmac_f32_16x16x64_bf16 v[88:91], v[52:55], a[112:119], v15
v_smfmac_f32_16x16x64_bf16 v[92:95], v[52:55], a[120:127], v15
s_branch Lps_153
Lpf_196:
buffer_load_dwordx4 v[52:55], v10, s[4:7], s40 offen offset:1024 sc1
v_mfma_f32_16x16x32_bf16 v[200:203], v[204:207], v[204:207], 0
s_branch Lps_173
Lpf_198:
buffer_load_dwordx4 v[48:51], v10, s[4:7], s40 offen offset:0 sc1
v_mfma_f32_16x16x32_bf16 v[200:203], v[204:207], v[204:207], 0
s_sub_u32 s37, s37, 1
s_cbranch_scc1 Lend_8
s_branch Lps_151
Lpf_200:
buffer_load_dwordx4 v[56:59], v10, s[4:7], s40 offen offset:2048 sc1
v_mfma_f32_16x16x32_bf16 v[200:203], v[204:207], v[204:207], 0
s_branch Lps_177
Lpf_202:
buffer_load_dwordx4 v[52:55], v10, s[4:7], s40 offen offset:1024 sc1
v_mfma_f32_16x16x32_bf16 v[200:203], v[204:207], v[204:207], 0
s_sub_u32 s37, s37, 1
s_cbranch_scc1 Lend_8
s_branch Lps_157
Lpf_204:
buffer_load_dwordx4 v[56:59], v10, s[4:7], s40 offen offset:2048 sc1
v_mfma_f32_16x16x32_bf16 v[200:203], v[204:207], v[204:207], 0
s_branch Lps_183
Lpf_206:
buffer_load_dwordx4 v[48:51], v10, s[4:7], s40 offen offset:0 sc1
v_mfma_f32_16x16x32_bf16 v[200:203], v[204:207], v[204:207], 0
s_sub_u32 s37, s37, 1
s_cbranch_scc1 Lend_8
s_branch Lps_149
Lpf_208:
buffer_load_dwordx4 v[52:55], v10, s[4:7], s40 offen offset:1024 sc1
v_mfma_f32_16x16x32_bf16 v[200:203], v[204:207], v[204:207], 0
Lps_211:
s_waitcnt vmcnt(2)
v_max3_u32 v44, v56, v57, v58
v_max_u32 v44, v44, v59
v_cmp_eq_u32 vcc, -1, v44
s_cbranch_vccnz Lpf_212
v_smfmac_f32_16x16x64_bf16 v[64:67], v[56:59], a[128:135], v15
v_smfmac_f32_16x16x64_bf16 v[68:71], v[56:59], a[136:143], v15
v_smfmac_f32_16x16x64_bf16 v[72:75], v[56:59], a[144:151], v15
v_smfmac_f32_16x16x64_bf16 v[76:79], v[56:59], a[152:159], v15
v_smfmac_f32_16x16x64_bf16 v[80:83], v[56:59], a[160:167], v15
v_smfmac_f32_16x16x64_bf16 v[84:87], v[56:59], a[168:175], v15
v_smfmac_f32_16x16x64_bf16 v[88:91], v[56:59], a[176:183], v15
v_smfmac_f32_16x16x64_bf16 v[92:95], v[56:59], a[184:191], v15
s_branch Lps_173
Lpf_210:
buffer_load_dwordx4 v[52:55], v10, s[4:7], s40 offen offset:1024 sc1
v_mfma_f32_16x16x32_bf16 v[200:203], v[204:207], v[204:207], 0
s_branch Lps_171
Lpf_212:
buffer_load_dwordx4 v[56:59], v10, s[4:7], s40 offen offset:2048 sc1
v_mfma_f32_16x16x32_bf16 v[200:203], v[204:207], v[204:207], 0
s_branch Lps_191
Lkr_144:
buffer_load_dwordx4 v[56:59], v11, s[4:7], s40 offen offset:0 sc1
buffer_load_dwordx4 v[60:63], v11, s[4:7], s40 offen offset:1024 sc1
Lps_214:
s_waitcnt vmcnt(3)
v_max3_u32 v44, v48, v49, v50
v_max_u32 v44, v44, v51
v_cmp_eq_u32 vcc, -1, v44
s_cbranch_vccnz Lpf_215
v_smfmac_f32_16x16x64_bf16 v[72:75], v[48:51], v[96:103], v15
v_mov_b32 v112, v48
v_mov_b32 v113, v49
v_mov_b32 v114, v50
v_mov_b32 v115, v51
Lps_216:
s_waitcnt vmcnt(2)
v_max3_u32 v44, v52, v53, v54
v_max_u32 v44, v44, v55
v_cmp_eq_u32 vcc, -1, v44
s_cbranch_vccnz Lpf_217
v_smfmac_f32_16x16x64_bf16 v[72:75], v[52:55], v[104:111], v15
v_mov_b32 v116, v52
v_mov_b32 v117, v53
v_mov_b32 v118, v54
v_mov_b32 v119, v55
Lpd_213:
s_branch Lko_145
Lpf_215:
buffer_load_dwordx4 v[48:51], v11, s[4:7], s40 offen offset:0 sc1
s_sub_u32 s37, s37, 1
s_cbranch_scc1 Lend_8
Lps_218:
s_waitcnt vmcnt(3)
v_max3_u32 v44, v52, v53, v54
v_max_u32 v44, v44, v55
v_cmp_eq_u32 vcc, -1, v44
s_cbranch_vccnz Lpf_219
v_smfmac_f32_16x16x64_bf16 v[72:75], v[52:55], v[104:111], v15
v_mov_b32 v116, v52
v_mov_b32 v117, v53
v_mov_b32 v118, v54
v_mov_b32 v119, v55
Lps_220:
s_waitcnt vmcnt(2)
v_max3_u32 v44, v56, v57, v58
v_max_u32 v44, v44, v59
v_cmp_eq_u32 vcc, -1, v44
s_cbranch_vccnz Lpf_221
v_smfmac_f32_16x16x64_bf16 v[72:75], v[56:59], v[96:103], v15
v_mov_b32 v112, v56
v_mov_b32 v113, v57
v_mov_b32 v114, v58
v_mov_b32 v115, v59
s_branch Lpd_213
Lpf_217:
buffer_load_dwordx4 v[52:55], v11, s[4:7], s40 offen offset:1024 sc1
s_sub_u32 s37, s37, 1
s_cbranch_scc1 Lend_8
Lps_222:
s_waitcnt vmcnt(2)
v_max3_u32 v44, v56, v57, v58
v_max_u32 v44, v44, v59
v_cmp_eq_u32 vcc, -1, v44
s_cbranch_vccnz Lpf_223
Lps_224:
s_waitcnt vmcnt(1)
v_max3_u32 v44, v60, v61, v62
v_max_u32 v44, v44, v63
v_cmp_eq_u32 vcc, -1, v44
s_cbranch_vccnz Lpf_225
v_smfmac_f32_16x16x64_bf16 v[72:75], v[60:63], v[104:111], v15
v_mov_b32 v116, v60
v_mov_b32 v117, v61
v_mov_b32 v118, v62
v_mov_b32 v119, v63
s_branch Lpd_213
Lpf_219:
buffer_load_dwordx4 v[52:55], v11, s[4:7], s40 offen offset:1024 sc1
Lps_226:
s_waitcnt vmcnt(3)
v_max3_u32 v44, v56, v57, v58
v_max_u32 v44, v44, v59
v_cmp_eq_u32 vcc, -1, v44
s_cbranch_vccnz Lpf_227
v_smfmac_f32_16x16x64_bf16 v[72:75], v[56:59], v[96:103], v15
v_mov_b32 v112, v56
v_mov_b32 v113, v57
v_mov_b32 v114, v58
v_mov_b32 v115, v59
Lps_228:
s_waitcnt vmcnt(2)
v_max3_u32 v44, v60, v61, v62
v_max_u32 v44, v44, v63
v_cmp_eq_u32 vcc, -1, v44
s_cbranch_vccnz Lpf_229
v_smfmac_f32_16x16x64_bf16 v[72:75], v[60:63], v[104:111], v15
v_mov_b32 v116, v60
v_mov_b32 v117, v61
v_mov_b32 v118, v62
v_mov_b32 v119, v63
s_branch Lpd_213
Lpf_221:
buffer_load_dwordx4 v[56:59], v11, s[4:7], s40 offen offset:0 sc1
Lps_230:
s_waitcnt vmcnt(2)
v_max3_u32 v44, v60, v61, v62
v_max_u32 v44, v44, v63
v_cmp_eq_u32 vcc, -1, v44
s_cbranch_vccnz Lpf_231
Lps_232:
s_waitcnt vmcnt(1)
v_max3_u32 v44, v48, v49, v50
v_max_u32 v44, v44, v51
v_cmp_eq_u32 vcc, -1, v44
s_cbranch_vccnz Lpf_233
v_smfmac_f32_16x16x64_bf16 v[72:75], v[48:51], v[96:103], v15
v_mov_b32 v112, v48
v_mov_b32 v113, v49
v_mov_b32 v114, v50
v_mov_b32 v115, v51
s_branch Lpd_213
Lpf_223:
buffer_load_dwordx4 v[56:59], v11, s[4:7], s40 offen offset:0 sc1
Lps_234:
s_waitcnt vmcnt(2)
v_max3_u32 v44, v60, v61, v62
v_max_u32 v44, v44, v63
v_cmp_eq_u32 vcc, -1, v44
s_cbranch_vccnz Lpf_235
v_smfmac_f32_16x16x64_bf16 v[72:75], v[60:63], v[104:111], v15
v_mov_b32 v116, v60
v_mov_b32 v117, v61
v_mov_b32 v118, v62
v_mov_b32 v119, v63
s_branch Lpd_213
Lpf_225:
buffer_load_dwordx4 v[60:63], v11, s[4:7], s40 offen offset:1024 sc1
Lps_236:
s_waitcnt vmcnt(1)
v_max3_u32 v44, v52, v53, v54
v_max_u32 v44, v44, v55
v_cmp_eq_u32 vcc, -1, v44
s_cbranch_vccnz Lpf_237
v_smfmac_f32_16x16x64_bf16 v[72:75], v[52:55], v[104:111], v15
v_mov_b32 v116, v52
v_mov_b32 v117, v53
v_mov_b32 v118, v54
v_mov_b32 v119, v55
s_branch Lpd_213
Lpf_227:
buffer_load_dwordx4 v[56:59], v11, s[4:7], s40 offen offset:0 sc1
Lps_238:
s_waitcnt vmcnt(3)
v_max3_u32 v44, v60, v61, v62
v_max_u32 v44, v44, v63
v_cmp_eq_u32 vcc, -1, v44
s_cbranch_vccnz Lpf_239
v_smfmac_f32_16x16x64_bf16 v[72:75], v[60:63], v[104:111], v15
v_mov_b32 v116, v60
v_mov_b32 v117, v61
v_mov_b32 v118, v62
v_mov_b32 v119, v63
Lps_240:
s_waitcnt vmcnt(2)
v_max3_u32 v44, v48, v49, v50
v_max_u32 v44, v44, v51
v_cmp_eq_u32 vcc, -1, v44
s_cbranch_vccnz Lpf_241
v_smfmac_f32_16x16x64_bf16 v[72:75], v[48:51], v[96:103], v15
v_mov_b32 v112, v48
v_mov_b32 v113, v49
v_mov_b32 v114, v50
v_mov_b32 v115, v51
s_branch Lpd_213
Lpf_229:
buffer_load_dwordx4 v[60:63], v11, s[4:7], s40 offen offset:1024 sc1
Lps_242:
s_waitcnt vmcnt(2)
v_max3_u32 v44, v48, v49, v50
v_max_u32 v44, v44, v51
v_cmp_eq_u32 vcc, -1, v44
s_cbranch_vccnz Lpf_243
s_branch Lps_236
Lpf_231:
buffer_load_dwordx4 v[60:63], v11, s[4:7], s40 offen offset:1024 sc1
Lps_244:
s_waitcnt vmcnt(2)
v_max3_u32 v44, v48, v49, v50
v_max_u32 v44, v44, v51
v_cmp_eq_u32 vcc, -1, v44
s_cbranch_vccnz Lpf_245
v_smfmac_f32_16x16x64_bf16 v[72:75], v[48:51], v[96:103], v15
v_mov_b32 v112, v48
v_mov_b32 v113, v49
v_mov_b32 v114, v50
v_mov_b32 v115, v51
s_branch Lpd_213
Lpf_233:
buffer_load_dwordx4 v[48:51], v11, s[4:7], s40 offen offset:0 sc1
s_sub_u32 s37, s37, 1
s_cbranch_scc1 Lend_8
Lps_246:
s_waitcnt vmcnt(1)
v_max3_u32 v44, v56, v57, v58
v_max_u32 v44, v44, v59
v_cmp_eq_u32 vcc, -1, v44
s_cbranch_vccnz Lpf_247
v_smfmac_f32_16x16x64_bf16 v[72:75], v[56:59], v[96:103], v15
v_mov_b32 v112, v56
v_mov_b32 v113, v57
v_mov_b32 v114, v58
v_mov_b32 v115, v59
s_branch Lpd_213
Lpf_235:
buffer_load_dwordx4 v[60:63], v11, s[4:7], s40 offen offset:1024 sc1
s_branch Lps_216
Lpf_237:
buffer_load_dwordx4 v[52:55], v11, s[4:7], s40 offen offset:1024 sc1
s_sub_u32 s37, s37, 1
s_cbranch_scc1 Lend_8
s_branch Lps_224
Lpf_239:
buffer_load_dwordx4 v[60:63], v11, s[4:7], s40 offen offset:1024 sc1
s_branch Lps_214
Lpf_241:
buffer_load_dwordx4 v[48:51], v11, s[4:7], s40 offen offset:0 sc1
s_sub_u32 s37, s37, 1
s_cbranch_scc1 Lend_8
Lps_248:
s_waitcnt vmcnt(2)
v_max3_u32 v44, v52, v53, v54
v_max_u32 v44, v44, v55
v_cmp_eq_u32 vcc, -1, v44
s_cbranch_vccnz Lpf_249
s_branch Lps_246
Lpf_243:
buffer_load_dwordx4 v[48:51], v11, s[4:7], s40 offen offset:0 sc1
s_sub_u32 s37, s37, 1
s_cbranch_scc1 Lend_8
Lps_250:
s_waitcnt vmcnt(2)
v_max3_u32 v44, v52, v53, v54
v_max_u32 v44, v44, v55
v_cmp_eq_u32 vcc, -1, v44
s_cbranch_vccnz Lpf_251
v_smfmac_f32_16x16x64_bf16 v[72:75], v[52:55], v[104:111], v15
v_mov_b32 v116, v52
v_mov_b32 v117, v53
v_mov_b32 v118, v54
v_mov_b32 v119, v55
s_branch Lpd_213
Lpf_245:
buffer_load_dwordx4 v[48:51], v11, s[4:7], s40 offen offset:0 sc1
s_sub_u32 s37, s37, 1
s_cbranch_scc1 Lend_8
s_branch Lps_220
Lpf_247:
buffer_load_dwordx4 v[56:59], v11, s[4:7], s40 offen offset:0 sc1
s_branch Lps_232
Lpf_249:
buffer_load_dwordx4 v[52:55], v11, s[4:7], s40 offen offset:1024 sc1
Lps_252:
s_waitcnt vmcnt(2)
v_max3_u32 v44, v56, v57, v58
v_max_u32 v44, v44, v59
v_cmp_eq_u32 vcc, -1, v44
s_cbranch_vccnz Lpf_253
v_smfmac_f32_16x16x64_bf16 v[72:75], v[56:59], v[96:103], v15
v_mov_b32 v112, v56
v_mov_b32 v113, v57
v_mov_b32 v114, v58
v_mov_b32 v115, v59
s_branch Lpd_213
Lpf_251:
buffer_load_dwordx4 v[52:55], v11, s[4:7], s40 offen offset:1024 sc1
s_branch Lps_228
Lpf_253:
buffer_load_dwordx4 v[56:59], v11, s[4:7], s40 offen offset:0 sc1
s_branch Lps_240
Lvr_146:
buffer_load_dwordx2 v[120:121], v12, s[4:7], s40 offen sc1
buffer_load_dwordx2 v[122:123], v13, s[4:7], s40 offen sc1
s_sub_u32 s37, s37, 1
s_cbranch_scc1 Lend_8
s_waitcnt vmcnt(0)
v_max3_u32 v44, v120, v121, v122
v_max_u32 v44, v44, v123
v_cmp_eq_u32 vcc, -1, v44
s_cbranch_vccnz Lvr_146
s_branch Lvo_147
Lend_8:
s_endpgm
Lkvo_role_9:
v_mov_b32 v44, v0
v_mov_b32 v45, v1
v_and_b32 v46, 127, v44
s_sub_u32 s54, s34, 8
s_lshl_b32 s45, s33, 18
s_add_u32 s45, s45, 2097152
s_lshl_b32 s59, s33, 12
s_add_u32 s59, s59, 3276800
s_lshl_b32 s38, s32, 12
v_lshl_add_u32 v8, v45, 4, s38
v_add_u32 v9, 49152, v8
s_lshl_b32 s38, s54, 10
v_lshl_add_u32 v10, v46, 3, s38
v_lshl_add_u32 v50, v44, 2, s38
v_add_u32 v11, 16384, v50
v_add_u32 v27, 32768, v50
s_lshl_b32 s38, s32, 8
v_lshl_add_u32 v1, v45, 2, s38
v_add_u32 v2, 2048, v1
s_lshr_b32 s38, s54, 2
s_lshl_b32 s38, s38, 8
s_and_b32 s39, s54, 3
s_lshl_b32 s39, s39, 2
s_add_u32 s38, s38, s39
v_min_u32 v50, 1, v44
v_lshl_add_u32 v3, v50, 30, s38
s_lshr_b32 s38, s54, 3
s_lshl_b32 s38, s38, 14
s_and_b32 s39, s54, 7
s_lshl_b32 s39, s39, 10
s_add_u32 s38, s38, s39
s_lshl_b32 s39, s33, 16
s_add_u32 s38, s38, s39
v_lshl_add_u32 v12, v46, 3, s38
v_xor_b32 v13, 0x10000, v12
v_xor_b32 v14, 0x20000, v12
v_xor_b32 v15, 0x30000, v12
v_lshlrev_b32 v50, 2, v45
s_mov_b32 s38, 1048576
buffer_load_dword v51, v50, s[4:7], s38 offen
s_waitcnt vmcnt(0)
v_cmp_eq_u32 vcc, 1, v51
s_nop 4
s_and_b32 s46, vcc_lo, 0xff
s_mov_b32 s55, 0x00003f80
s_mov_b32 s56, 0x3f800000
v_and_b32 v50, 1, v45
v_mul_u32_u24 v50, 0xaaaa, v50
v_add_u32 v126, 0x4444, v50
s_lshl_b32 s38, s32, 11
v_lshl_add_u32 v25, v45, 5, s38
v_lshlrev_b32 v127, 3, v44
v_bfe_u32 v50, v46, 5, 1
v_lshlrev_b32 v50, 2, v50
v_and_b32 v51, 1, v46
v_lshl_add_u32 v50, v51, 1, v50
v_bfe_u32 v51, v46, 1, 1
v_add_u32 v50, v50, v51
v_and_b32 v51, 24, v46
v_add_u32 v51, v51, v50
v_lshlrev_b32 v51, 3, v51
v_bfe_u32 v52, v46, 2, 1
v_mul_u32_u24 v52, 288, v52
v_add_u32 v51, v51, v52
v_lshrrev_b32 v52, 6, v46
v_mul_u32_u24 v53, 1152, v52
v_add_u32 v0, v51, v53
v_lshl_add_u32 v50, v52, 4, v50
v_bfe_u32 v51, v46, 2, 3
v_lshlrev_b32 v51, 11, v51
v_lshl_add_u32 v50, v50, 2, v51
s_mov_b32 s8, s16
s_and_b32 s9, s17, 0xffff
s_mov_b32 s10, 0x4000
s_mov_b32 s11, 0x20000
s_lshl_b32 s38, s54, 7
buffer_load_dword v56, v50, s[8:11], s38 offen
buffer_load_dword v57, v50, s[8:11], s38 offen offset:32
v_and_b32 v50, 1, v45
s_and_b32 s38, s32, 2
v_add_u32 v51, s38, v50
s_and_b32 s39, s32, 1
s_lshl_b32 s39, s39, 3
v_bfe_u32 v52, v45, 1, 1
v_lshl_add_u32 v52, v52, 2, s39
v_bfe_u32 v53, v45, 2, 1
v_lshl_add_u32 v52, v53, 1, v52
v_bfe_u32 v53, v45, 3, 1
v_and_b32 v54, 48, v45
v_add_u32 v54, v54, v52
v_lshlrev_b32 v54, 2, v54
v_mul_u32_u24 v53, 640, v53
v_mul_u32_u24 v55, 288, v50
v_add3_u32 v54, v54, v53, v55
s_mul_i32 s38, s38, 640
v_add_u32 v24, s38, v54
v_mov_b32 v16, 0
v_mov_b32 v17, 0
v_mov_b32 v18, 0
v_mov_b32 v19, 0
v_mov_b32 v20, 0
v_mov_b32 v21, 0
v_mov_b32 v22, 0
v_mov_b32 v23, 0
v_mov_b32 v120, -1
v_mov_b32 v121, -1
v_mov_b32 v122, -1
v_mov_b32 v123, -1
s_add_u32 s38, s45, 0
buffer_store_dword v120, v11, s[4:7], s38 offen sc1
buffer_store_dword v120, v27, s[4:7], s38 offen sc1
s_mov_b32 s38, 0
s_lshl_b32 s39, s38, 1
s_lshr_b32 s52, s46, s39
s_and_b32 s52, s52, 1
s_lshl_b32 s52, s52, 13
s_lshl_b32 s39, s39, 21
s_add_u32 s39, s39, s52
s_add_u32 s88, s39, 134217728
s_lshl_b32 s39, s38, 1
s_lshr_b32 s52, s46, s39
s_and_b32 s52, s52, 1
s_lshl_b32 s52, s52, 13
s_lshl_b32 s39, s39, 21
s_add_u32 s39, s39, s52
s_add_u32 s89, s39, 135266304
s_cmp_ge_u32 s32, 2
s_cbranch_scc1 Lco_254
buffer_store_dwordx2 v[120:121], v12, s[4:7], s88 offen sc1
buffer_store_dwordx2 v[120:121], v12, s[4:7], s89 offen sc1
Lco_254:
s_add_u32 s38, s45, 65536
buffer_store_dwordx2 v[120:121], v10, s[4:7], s38 offen sc1
buffer_store_dword v120, v11, s[4:7], s38 offen sc1
buffer_store_dword v120, v27, s[4:7], s38 offen sc1
s_mov_b32 s38, 1
s_lshl_b32 s39, s38, 1
s_lshr_b32 s52, s46, s39
s_and_b32 s52, s52, 1
s_lshl_b32 s52, s52, 13
s_lshl_b32 s39, s39, 21
s_add_u32 s39, s39, s52
s_add_u32 s88, s39, 134217728
s_lshl_b32 s39, s38, 1
s_lshr_b32 s52, s46, s39
s_and_b32 s52, s52, 1
s_lshl_b32 s52, s52, 13
s_lshl_b32 s39, s39, 21
s_add_u32 s39, s39, s52
s_add_u32 s89, s39, 135266304
s_cmp_ge_u32 s32, 2
s_cbranch_scc1 Lco_255
buffer_store_dwordx2 v[120:121], v12, s[4:7], s88 offen sc1
buffer_store_dwordx2 v[120:121], v12, s[4:7], s89 offen sc1
Lco_255:
s_add_u32 s38, s45, 131072
buffer_store_dwordx2 v[120:121], v10, s[4:7], s38 offen sc1
buffer_store_dword v120, v11, s[4:7], s38 offen sc1
buffer_store_dword v120, v27, s[4:7], s38 offen sc1
s_mov_b32 s38, 2
s_lshl_b32 s39, s38, 1
s_lshr_b32 s52, s46, s39
s_and_b32 s52, s52, 1
s_lshl_b32 s52, s52, 13
s_lshl_b32 s39, s39, 21
s_add_u32 s39, s39, s52
s_add_u32 s88, s39, 134217728
s_lshl_b32 s39, s38, 1
s_lshr_b32 s52, s46, s39
s_and_b32 s52, s52, 1
s_lshl_b32 s52, s52, 13
s_lshl_b32 s39, s39, 21
s_add_u32 s39, s39, s52
s_add_u32 s89, s39, 135266304
s_cmp_ge_u32 s32, 2
s_cbranch_scc1 Lco_256
buffer_store_dwordx2 v[120:121], v12, s[4:7], s88 offen sc1
buffer_store_dwordx2 v[120:121], v12, s[4:7], s89 offen sc1
Lco_256:
s_add_u32 s38, s45, 196608
buffer_store_dwordx2 v[120:121], v10, s[4:7], s38 offen sc1
buffer_store_dword v120, v11, s[4:7], s38 offen sc1
buffer_store_dword v120, v27, s[4:7], s38 offen sc1
s_mov_b32 s38, 3
s_lshl_b32 s39, s38, 1
s_lshr_b32 s52, s46, s39
s_and_b32 s52, s52, 1
s_lshl_b32 s52, s52, 13
s_lshl_b32 s39, s39, 21
s_add_u32 s39, s39, s52
s_add_u32 s88, s39, 134217728
s_lshl_b32 s39, s38, 1
s_lshr_b32 s52, s46, s39
s_and_b32 s52, s52, 1
s_lshl_b32 s52, s52, 13
s_lshl_b32 s39, s39, 21
s_add_u32 s39, s39, s52
s_add_u32 s89, s39, 135266304
s_cmp_ge_u32 s32, 2
s_cbranch_scc1 Lco_257
buffer_store_dwordx2 v[120:121], v12, s[4:7], s88 offen sc1
buffer_store_dwordx2 v[120:121], v12, s[4:7], s89 offen sc1
Lco_257:
v_mov_b32 v7, 1
buffer_store_dword v7, v3, s[4:7], s59 offen sc1
s_waitcnt vmcnt(0)
v_min_u32 v56, -2, v56
v_min_u32 v57, -2, v57
buffer_store_dwordx2 v[56:57], v10, s[4:7], s45 offen sc1
s_lshl_b32 s52, s35, 16
s_or_b32 s52, s52, 1
s_waitcnt vmcnt(0)
s_barrier
s_cmp_lg_u32 s32, 0
s_cbranch_scc1 Lar_258
s_mov_b64 exec, 1
v_mov_b32 v48, 32
v_mov_b32 v49, s52
buffer_atomic_add v49, v48, s[12:15], 0 offen sc1
s_mov_b64 exec, -1
Lar_258:
v_lshrrev_b32 v54, 3, v45
v_and_b32 v55, 7, v45
v_lshlrev_b32 v55, 4, v55
v_lshl_add_u32 v50, v54, 13, v55
v_lshl_add_u32 v51, v54, 11, v55
s_mul_i32 s38, s32, 40960
v_and_b32 v55, 3, v45
v_lshl_add_u32 v55, v55, 3, s38
v_lshrrev_b32 v54, 2, v45
v_lshl_add_u32 v52, v54, 7, v55
v_and_b32 v53, 16, v45
v_bfe_u32 v54, v45, 5, 1
v_lshl_add_u32 v53, v54, 3, v53
v_bfe_u32 v54, v45, 3, 1
v_lshl_add_u32 v53, v54, 2, v53
v_bfe_u32 v54, v45, 2, 1
v_add_u32 v53, v53, v54
v_lshl_add_u32 v53, v53, 7, v55
s_mov_b32 s8, s20
s_and_b32 s9, s21, 0xffff
s_mov_b32 s10, 0x800000
s_mov_b32 s11, 0x20000
s_lshl_b32 s39, s32, 21
s_lshl_b32 s38, s33, 4
s_add_u32 s38, s38, s54
s_lshl_b32 s38, s38, 7
s_add_u32 s39, s39, s38
s_add_u32 s39, s39, 0
s_mul_i32 s38, s32, 40960
s_add_u32 m0, s38, 0
s_nop 0
buffer_load_dwordx4 v50, s[8:11], s39 offen lds
s_add_u32 m0, m0, 1024
s_add_u32 s39, s39, 65536
buffer_load_dwordx4 v50, s[8:11], s39 offen lds
s_add_u32 m0, m0, 1024
s_add_u32 s39, s39, 65536
buffer_load_dwordx4 v50, s[8:11], s39 offen lds
s_add_u32 m0, m0, 1024
s_add_u32 s39, s39, 65536
buffer_load_dwordx4 v50, s[8:11], s39 offen lds
s_add_u32 m0, m0, 1024
s_add_u32 s39, s39, 65536
buffer_load_dwordx4 v50, s[8:11], s39 offen lds
s_add_u32 m0, m0, 1024
s_add_u32 s39, s39, 65536
buffer_load_dwordx4 v50, s[8:11], s39 offen lds
s_add_u32 m0, m0, 1024
s_add_u32 s39, s39, 65536
buffer_load_dwordx4 v50, s[8:11], s39 offen lds
s_add_u32 m0, m0, 1024
s_add_u32 s39, s39, 65536
buffer_load_dwordx4 v50, s[8:11], s39 offen lds
s_lshl_b32 s39, s32, 21
s_lshl_b32 s38, s33, 4
s_add_u32 s38, s38, s54
s_lshl_b32 s38, s38, 7
s_add_u32 s39, s39, s38
s_add_u32 s39, s39, 524288
s_mul_i32 s38, s32, 40960
s_add_u32 m0, s38, 8192
s_nop 0
buffer_load_dwordx4 v50, s[8:11], s39 offen lds
s_add_u32 m0, m0, 1024
s_add_u32 s39, s39, 65536
buffer_load_dwordx4 v50, s[8:11], s39 offen lds
s_add_u32 m0, m0, 1024
s_add_u32 s39, s39, 65536
buffer_load_dwordx4 v50, s[8:11], s39 offen lds
s_add_u32 m0, m0, 1024
s_add_u32 s39, s39, 65536
buffer_load_dwordx4 v50, s[8:11], s39 offen lds
s_add_u32 m0, m0, 1024
s_add_u32 s39, s39, 65536
buffer_load_dwordx4 v50, s[8:11], s39 offen lds
s_add_u32 m0, m0, 1024
s_add_u32 s39, s39, 65536
buffer_load_dwordx4 v50, s[8:11], s39 offen lds
s_add_u32 m0, m0, 1024
s_add_u32 s39, s39, 65536
buffer_load_dwordx4 v50, s[8:11], s39 offen lds
s_add_u32 m0, m0, 1024
s_add_u32 s39, s39, 65536
buffer_load_dwordx4 v50, s[8:11], s39 offen lds
s_lshl_b32 s39, s32, 21
s_lshl_b32 s38, s33, 4
s_add_u32 s38, s38, s54
s_lshl_b32 s38, s38, 7
s_add_u32 s39, s39, s38
s_add_u32 s39, s39, 1048576
s_mul_i32 s38, s32, 40960
s_add_u32 m0, s38, 16384
s_nop 0
buffer_load_dwordx4 v50, s[8:11], s39 offen lds
s_add_u32 m0, m0, 1024
s_add_u32 s39, s39, 65536
buffer_load_dwordx4 v50, s[8:11], s39 offen lds
s_add_u32 m0, m0, 1024
s_add_u32 s39, s39, 65536
buffer_load_dwordx4 v50, s[8:11], s39 offen lds
s_add_u32 m0, m0, 1024
s_add_u32 s39, s39, 65536
buffer_load_dwordx4 v50, s[8:11], s39 offen lds
s_add_u32 m0, m0, 1024
s_add_u32 s39, s39, 65536
buffer_load_dwordx4 v50, s[8:11], s39 offen lds
s_add_u32 m0, m0, 1024
s_add_u32 s39, s39, 65536
buffer_load_dwordx4 v50, s[8:11], s39 offen lds
s_add_u32 m0, m0, 1024
s_add_u32 s39, s39, 65536
buffer_load_dwordx4 v50, s[8:11], s39 offen lds
s_add_u32 m0, m0, 1024
s_add_u32 s39, s39, 65536
buffer_load_dwordx4 v50, s[8:11], s39 offen lds
s_lshl_b32 s39, s32, 21
s_lshl_b32 s38, s33, 4
s_add_u32 s38, s38, s54
s_lshl_b32 s38, s38, 7
s_add_u32 s39, s39, s38
s_add_u32 s39, s39, 1572864
s_mul_i32 s38, s32, 40960
s_add_u32 m0, s38, 24576
s_nop 0
buffer_load_dwordx4 v50, s[8:11], s39 offen lds
s_add_u32 m0, m0, 1024
s_add_u32 s39, s39, 65536
buffer_load_dwordx4 v50, s[8:11], s39 offen lds
s_add_u32 m0, m0, 1024
s_add_u32 s39, s39, 65536
buffer_load_dwordx4 v50, s[8:11], s39 offen lds
s_add_u32 m0, m0, 1024
s_add_u32 s39, s39, 65536
buffer_load_dwordx4 v50, s[8:11], s39 offen lds
s_add_u32 m0, m0, 1024
s_add_u32 s39, s39, 65536
buffer_load_dwordx4 v50, s[8:11], s39 offen lds
s_add_u32 m0, m0, 1024
s_add_u32 s39, s39, 65536
buffer_load_dwordx4 v50, s[8:11], s39 offen lds
s_add_u32 m0, m0, 1024
s_add_u32 s39, s39, 65536
buffer_load_dwordx4 v50, s[8:11], s39 offen lds
s_add_u32 m0, m0, 1024
s_add_u32 s39, s39, 65536
buffer_load_dwordx4 v50, s[8:11], s39 offen lds
s_mov_b32 s8, s22
s_and_b32 s9, s23, 0xffff
s_mov_b32 s10, 0x800000
s_mov_b32 s11, 0x20000
s_lshl_b32 s39, s32, 21
s_lshl_b32 s38, s33, 4
s_add_u32 s38, s38, s54
s_lshl_b32 s38, s38, 7
s_add_u32 s39, s39, s38
s_add_u32 s39, s39, 0
s_mul_i32 s38, s32, 40960
s_add_u32 m0, s38, 32768
s_nop 0
buffer_load_dwordx4 v50, s[8:11], s39 offen lds
s_add_u32 m0, m0, 1024
s_add_u32 s39, s39, 65536
buffer_load_dwordx4 v50, s[8:11], s39 offen lds
s_add_u32 m0, m0, 1024
s_add_u32 s39, s39, 65536
buffer_load_dwordx4 v50, s[8:11], s39 offen lds
s_add_u32 m0, m0, 1024
s_add_u32 s39, s39, 65536
buffer_load_dwordx4 v50, s[8:11], s39 offen lds
s_add_u32 m0, m0, 1024
s_add_u32 s39, s39, 65536
buffer_load_dwordx4 v50, s[8:11], s39 offen lds
s_add_u32 m0, m0, 1024
s_add_u32 s39, s39, 65536
buffer_load_dwordx4 v50, s[8:11], s39 offen lds
s_add_u32 m0, m0, 1024
s_add_u32 s39, s39, 65536
buffer_load_dwordx4 v50, s[8:11], s39 offen lds
s_add_u32 m0, m0, 1024
s_add_u32 s39, s39, 65536
buffer_load_dwordx4 v50, s[8:11], s39 offen lds
s_waitcnt vmcnt(32)
ds_read_b64_tr_b16 a[0:1], v52 offset:0
ds_read_b64_tr_b16 a[2:3], v52 offset:2048
ds_read_b64_tr_b16 a[4:5], v52 offset:4096
ds_read_b64_tr_b16 a[6:7], v52 offset:6144
ds_read_b64_tr_b16 a[8:9], v52 offset:32
ds_read_b64_tr_b16 a[10:11], v52 offset:2080
ds_read_b64_tr_b16 a[12:13], v52 offset:4128
ds_read_b64_tr_b16 a[14:15], v52 offset:6176
ds_read_b64_tr_b16 a[16:17], v52 offset:64
ds_read_b64_tr_b16 a[18:19], v52 offset:2112
ds_read_b64_tr_b16 a[20:21], v52 offset:4160
ds_read_b64_tr_b16 a[22:23], v52 offset:6208
ds_read_b64_tr_b16 a[24:25], v52 offset:96
ds_read_b64_tr_b16 a[26:27], v52 offset:2144
ds_read_b64_tr_b16 a[28:29], v52 offset:4192
ds_read_b64_tr_b16 a[30:31], v52 offset:6240
s_waitcnt lgkmcnt(0)
s_lshl_b32 s39, s32, 21
s_lshl_b32 s38, s33, 4
s_add_u32 s38, s38, s54
s_lshl_b32 s38, s38, 7
s_add_u32 s39, s39, s38
s_add_u32 s39, s39, 524288
s_mul_i32 s38, s32, 40960
s_add_u32 m0, s38, 0
s_nop 0
buffer_load_dwordx4 v50, s[8:11], s39 offen lds
s_add_u32 m0, m0, 1024
s_add_u32 s39, s39, 65536
buffer_load_dwordx4 v50, s[8:11], s39 offen lds
s_add_u32 m0, m0, 1024
s_add_u32 s39, s39, 65536
buffer_load_dwordx4 v50, s[8:11], s39 offen lds
s_add_u32 m0, m0, 1024
s_add_u32 s39, s39, 65536
buffer_load_dwordx4 v50, s[8:11], s39 offen lds
s_add_u32 m0, m0, 1024
s_add_u32 s39, s39, 65536
buffer_load_dwordx4 v50, s[8:11], s39 offen lds
s_add_u32 m0, m0, 1024
s_add_u32 s39, s39, 65536
buffer_load_dwordx4 v50, s[8:11], s39 offen lds
s_add_u32 m0, m0, 1024
s_add_u32 s39, s39, 65536
buffer_load_dwordx4 v50, s[8:11], s39 offen lds
s_add_u32 m0, m0, 1024
s_add_u32 s39, s39, 65536
buffer_load_dwordx4 v50, s[8:11], s39 offen lds
s_waitcnt vmcnt(32)
ds_read_b64_tr_b16 a[32:33], v52 offset:8192
ds_read_b64_tr_b16 a[34:35], v52 offset:10240
ds_read_b64_tr_b16 a[36:37], v52 offset:12288
ds_read_b64_tr_b16 a[38:39], v52 offset:14336
ds_read_b64_tr_b16 a[40:41], v52 offset:8224
ds_read_b64_tr_b16 a[42:43], v52 offset:10272
ds_read_b64_tr_b16 a[44:45], v52 offset:12320
ds_read_b64_tr_b16 a[46:47], v52 offset:14368
ds_read_b64_tr_b16 a[48:49], v52 offset:8256
ds_read_b64_tr_b16 a[50:51], v52 offset:10304
ds_read_b64_tr_b16 a[52:53], v52 offset:12352
ds_read_b64_tr_b16 a[54:55], v52 offset:14400
ds_read_b64_tr_b16 a[56:57], v52 offset:8288
ds_read_b64_tr_b16 a[58:59], v52 offset:10336
ds_read_b64_tr_b16 a[60:61], v52 offset:12384
ds_read_b64_tr_b16 a[62:63], v52 offset:14432
s_waitcnt lgkmcnt(0)
s_lshl_b32 s39, s32, 21
s_lshl_b32 s38, s33, 4
s_add_u32 s38, s38, s54
s_lshl_b32 s38, s38, 7
s_add_u32 s39, s39, s38
s_add_u32 s39, s39, 1048576
s_mul_i32 s38, s32, 40960
s_add_u32 m0, s38, 8192
s_nop 0
buffer_load_dwordx4 v50, s[8:11], s39 offen lds
s_add_u32 m0, m0, 1024
s_add_u32 s39, s39, 65536
buffer_load_dwordx4 v50, s[8:11], s39 offen lds
s_add_u32 m0, m0, 1024
s_add_u32 s39, s39, 65536
buffer_load_dwordx4 v50, s[8:11], s39 offen lds
s_add_u32 m0, m0, 1024
s_add_u32 s39, s39, 65536
buffer_load_dwordx4 v50, s[8:11], s39 offen lds
s_add_u32 m0, m0, 1024
s_add_u32 s39, s39, 65536
buffer_load_dwordx4 v50, s[8:11], s39 offen lds
s_add_u32 m0, m0, 1024
s_add_u32 s39, s39, 65536
buffer_load_dwordx4 v50, s[8:11], s39 offen lds
s_add_u32 m0, m0, 1024
s_add_u32 s39, s39, 65536
buffer_load_dwordx4 v50, s[8:11], s39 offen lds
s_add_u32 m0, m0, 1024
s_add_u32 s39, s39, 65536
buffer_load_dwordx4 v50, s[8:11], s39 offen lds
s_waitcnt vmcnt(32)
ds_read_b64_tr_b16 a[64:65], v52 offset:16384
ds_read_b64_tr_b16 a[66:67], v52 offset:18432
ds_read_b64_tr_b16 a[68:69], v52 offset:20480
ds_read_b64_tr_b16 a[70:71], v52 offset:22528
ds_read_b64_tr_b16 a[72:73], v52 offset:16416
ds_read_b64_tr_b16 a[74:75], v52 offset:18464
ds_read_b64_tr_b16 a[76:77], v52 offset:20512
ds_read_b64_tr_b16 a[78:79], v52 offset:22560
ds_read_b64_tr_b16 a[80:81], v52 offset:16448
ds_read_b64_tr_b16 a[82:83], v52 offset:18496
ds_read_b64_tr_b16 a[84:85], v52 offset:20544
ds_read_b64_tr_b16 a[86:87], v52 offset:22592
ds_read_b64_tr_b16 a[88:89], v52 offset:16480
ds_read_b64_tr_b16 a[90:91], v52 offset:18528
ds_read_b64_tr_b16 a[92:93], v52 offset:20576
ds_read_b64_tr_b16 a[94:95], v52 offset:22624
s_waitcnt lgkmcnt(0)
s_lshl_b32 s39, s32, 21
s_lshl_b32 s38, s33, 4
s_add_u32 s38, s38, s54
s_lshl_b32 s38, s38, 7
s_add_u32 s39, s39, s38
s_add_u32 s39, s39, 1572864
s_mul_i32 s38, s32, 40960
s_add_u32 m0, s38, 16384
s_nop 0
buffer_load_dwordx4 v50, s[8:11], s39 offen lds
s_add_u32 m0, m0, 1024
s_add_u32 s39, s39, 65536
buffer_load_dwordx4 v50, s[8:11], s39 offen lds
s_add_u32 m0, m0, 1024
s_add_u32 s39, s39, 65536
buffer_load_dwordx4 v50, s[8:11], s39 offen lds
s_add_u32 m0, m0, 1024
s_add_u32 s39, s39, 65536
buffer_load_dwordx4 v50, s[8:11], s39 offen lds
s_add_u32 m0, m0, 1024
s_add_u32 s39, s39, 65536
buffer_load_dwordx4 v50, s[8:11], s39 offen lds
s_add_u32 m0, m0, 1024
s_add_u32 s39, s39, 65536
buffer_load_dwordx4 v50, s[8:11], s39 offen lds
s_add_u32 m0, m0, 1024
s_add_u32 s39, s39, 65536
buffer_load_dwordx4 v50, s[8:11], s39 offen lds
s_add_u32 m0, m0, 1024
s_add_u32 s39, s39, 65536
buffer_load_dwordx4 v50, s[8:11], s39 offen lds
s_waitcnt vmcnt(32)
ds_read_b64_tr_b16 a[96:97], v52 offset:24576
ds_read_b64_tr_b16 a[98:99], v52 offset:26624
ds_read_b64_tr_b16 a[100:101], v52 offset:28672
ds_read_b64_tr_b16 a[102:103], v52 offset:30720
ds_read_b64_tr_b16 a[104:105], v52 offset:24608
ds_read_b64_tr_b16 a[106:107], v52 offset:26656
ds_read_b64_tr_b16 a[108:109], v52 offset:28704
ds_read_b64_tr_b16 a[110:111], v52 offset:30752
ds_read_b64_tr_b16 a[112:113], v52 offset:24640
ds_read_b64_tr_b16 a[114:115], v52 offset:26688
ds_read_b64_tr_b16 a[116:117], v52 offset:28736
ds_read_b64_tr_b16 a[118:119], v52 offset:30784
ds_read_b64_tr_b16 a[120:121], v52 offset:24672
ds_read_b64_tr_b16 a[122:123], v52 offset:26720
ds_read_b64_tr_b16 a[124:125], v52 offset:28768
ds_read_b64_tr_b16 a[126:127], v52 offset:30816
s_waitcnt lgkmcnt(0)
s_mov_b32 s8, s24
s_and_b32 s9, s25, 0xffff
s_mov_b32 s10, 0x800000
s_mov_b32 s11, 0x20000
s_lshl_b32 s39, s33, 2
s_add_u32 s39, s39, s32
s_lshl_b32 s39, s39, 19
s_lshl_b32 s38, s54, 7
s_add_u32 s39, s39, s38
s_add_u32 s39, s39, 0
s_mul_i32 s38, s32, 40960
s_add_u32 m0, s38, 24576
s_nop 0
buffer_load_dwordx4 v51, s[8:11], s39 offen lds
s_add_u32 m0, m0, 1024
s_add_u32 s39, s39, 16384
buffer_load_dwordx4 v51, s[8:11], s39 offen lds
s_add_u32 m0, m0, 1024
s_add_u32 s39, s39, 16384
buffer_load_dwordx4 v51, s[8:11], s39 offen lds
s_add_u32 m0, m0, 1024
s_add_u32 s39, s39, 16384
buffer_load_dwordx4 v51, s[8:11], s39 offen lds
s_add_u32 m0, m0, 1024
s_add_u32 s39, s39, 16384
buffer_load_dwordx4 v51, s[8:11], s39 offen lds
s_add_u32 m0, m0, 1024
s_add_u32 s39, s39, 16384
buffer_load_dwordx4 v51, s[8:11], s39 offen lds
s_add_u32 m0, m0, 1024
s_add_u32 s39, s39, 16384
buffer_load_dwordx4 v51, s[8:11], s39 offen lds
s_add_u32 m0, m0, 1024
s_add_u32 s39, s39, 16384
buffer_load_dwordx4 v51, s[8:11], s39 offen lds
s_waitcnt vmcnt(32)
ds_read_b64_tr_b16 v[128:129], v52 offset:32768
ds_read_b64_tr_b16 v[130:131], v52 offset:34816
ds_read_b64_tr_b16 v[132:133], v52 offset:36864
ds_read_b64_tr_b16 v[134:135], v52 offset:38912
ds_read_b64_tr_b16 v[136:137], v52 offset:32800
ds_read_b64_tr_b16 v[138:139], v52 offset:34848
ds_read_b64_tr_b16 v[140:141], v52 offset:36896
ds_read_b64_tr_b16 v[142:143], v52 offset:38944
ds_read_b64_tr_b16 v[144:145], v52 offset:32832
ds_read_b64_tr_b16 v[146:147], v52 offset:34880
ds_read_b64_tr_b16 v[148:149], v52 offset:36928
ds_read_b64_tr_b16 v[150:151], v52 offset:38976
ds_read_b64_tr_b16 v[152:153], v52 offset:32864
ds_read_b64_tr_b16 v[154:155], v52 offset:34912
ds_read_b64_tr_b16 v[156:157], v52 offset:36960
ds_read_b64_tr_b16 v[158:159], v52 offset:39008
s_waitcnt lgkmcnt(0)
s_lshl_b32 s39, s33, 2
s_add_u32 s39, s39, s32
s_lshl_b32 s39, s39, 19
s_lshl_b32 s38, s54, 7
s_add_u32 s39, s39, s38
s_add_u32 s39, s39, 131072
s_mul_i32 s38, s32, 40960
s_add_u32 m0, s38, 32768
s_nop 0
buffer_load_dwordx4 v51, s[8:11], s39 offen lds
s_add_u32 m0, m0, 1024
s_add_u32 s39, s39, 16384
buffer_load_dwordx4 v51, s[8:11], s39 offen lds
s_add_u32 m0, m0, 1024
s_add_u32 s39, s39, 16384
buffer_load_dwordx4 v51, s[8:11], s39 offen lds
s_add_u32 m0, m0, 1024
s_add_u32 s39, s39, 16384
buffer_load_dwordx4 v51, s[8:11], s39 offen lds
s_add_u32 m0, m0, 1024
s_add_u32 s39, s39, 16384
buffer_load_dwordx4 v51, s[8:11], s39 offen lds
s_add_u32 m0, m0, 1024
s_add_u32 s39, s39, 16384
buffer_load_dwordx4 v51, s[8:11], s39 offen lds
s_add_u32 m0, m0, 1024
s_add_u32 s39, s39, 16384
buffer_load_dwordx4 v51, s[8:11], s39 offen lds
s_add_u32 m0, m0, 1024
s_add_u32 s39, s39, 16384
buffer_load_dwordx4 v51, s[8:11], s39 offen lds
s_waitcnt vmcnt(32)
ds_read_b64_tr_b16 v[160:161], v52 offset:0
ds_read_b64_tr_b16 v[162:163], v52 offset:2048
ds_read_b64_tr_b16 v[164:165], v52 offset:4096
ds_read_b64_tr_b16 v[166:167], v52 offset:6144
ds_read_b64_tr_b16 v[168:169], v52 offset:32
ds_read_b64_tr_b16 v[170:171], v52 offset:2080
ds_read_b64_tr_b16 v[172:173], v52 offset:4128
ds_read_b64_tr_b16 v[174:175], v52 offset:6176
ds_read_b64_tr_b16 v[176:177], v52 offset:64
ds_read_b64_tr_b16 v[178:179], v52 offset:2112
ds_read_b64_tr_b16 v[180:181], v52 offset:4160
ds_read_b64_tr_b16 v[182:183], v52 offset:6208
ds_read_b64_tr_b16 v[184:185], v52 offset:96
ds_read_b64_tr_b16 v[186:187], v52 offset:2144
ds_read_b64_tr_b16 v[188:189], v52 offset:4192
ds_read_b64_tr_b16 v[190:191], v52 offset:6240
s_waitcnt lgkmcnt(0)
s_lshl_b32 s39, s33, 2
s_add_u32 s39, s39, s32
s_lshl_b32 s39, s39, 19
s_lshl_b32 s38, s54, 7
s_add_u32 s39, s39, s38
s_add_u32 s39, s39, 262144
s_mul_i32 s38, s32, 40960
s_add_u32 m0, s38, 0
s_nop 0
buffer_load_dwordx4 v51, s[8:11], s39 offen lds
s_add_u32 m0, m0, 1024
s_add_u32 s39, s39, 16384
buffer_load_dwordx4 v51, s[8:11], s39 offen lds
s_add_u32 m0, m0, 1024
s_add_u32 s39, s39, 16384
buffer_load_dwordx4 v51, s[8:11], s39 offen lds
s_add_u32 m0, m0, 1024
s_add_u32 s39, s39, 16384
buffer_load_dwordx4 v51, s[8:11], s39 offen lds
s_add_u32 m0, m0, 1024
s_add_u32 s39, s39, 16384
buffer_load_dwordx4 v51, s[8:11], s39 offen lds
s_add_u32 m0, m0, 1024
s_add_u32 s39, s39, 16384
buffer_load_dwordx4 v51, s[8:11], s39 offen lds
s_add_u32 m0, m0, 1024
s_add_u32 s39, s39, 16384
buffer_load_dwordx4 v51, s[8:11], s39 offen lds
s_add_u32 m0, m0, 1024
s_add_u32 s39, s39, 16384
buffer_load_dwordx4 v51, s[8:11], s39 offen lds
s_waitcnt vmcnt(32)
ds_read_b64_tr_b16 v[192:193], v52 offset:8192
ds_read_b64_tr_b16 v[194:195], v52 offset:10240
ds_read_b64_tr_b16 v[196:197], v52 offset:12288
ds_read_b64_tr_b16 v[198:199], v52 offset:14336
ds_read_b64_tr_b16 v[200:201], v52 offset:8224
ds_read_b64_tr_b16 v[202:203], v52 offset:10272
ds_read_b64_tr_b16 v[204:205], v52 offset:12320
ds_read_b64_tr_b16 v[206:207], v52 offset:14368
ds_read_b64_tr_b16 v[208:209], v52 offset:8256
ds_read_b64_tr_b16 v[210:211], v52 offset:10304
ds_read_b64_tr_b16 v[212:213], v52 offset:12352
ds_read_b64_tr_b16 v[214:215], v52 offset:14400
ds_read_b64_tr_b16 v[216:217], v52 offset:8288
ds_read_b64_tr_b16 v[218:219], v52 offset:10336
ds_read_b64_tr_b16 v[220:221], v52 offset:12384
ds_read_b64_tr_b16 v[222:223], v52 offset:14432
s_waitcnt lgkmcnt(0)
s_lshl_b32 s39, s33, 2
s_add_u32 s39, s39, s32
s_lshl_b32 s39, s39, 19
s_lshl_b32 s38, s54, 7
s_add_u32 s39, s39, s38
s_add_u32 s39, s39, 393216
s_mul_i32 s38, s32, 40960
s_add_u32 m0, s38, 8192
s_nop 0
buffer_load_dwordx4 v51, s[8:11], s39 offen lds
s_add_u32 m0, m0, 1024
s_add_u32 s39, s39, 16384
buffer_load_dwordx4 v51, s[8:11], s39 offen lds
s_add_u32 m0, m0, 1024
s_add_u32 s39, s39, 16384
buffer_load_dwordx4 v51, s[8:11], s39 offen lds
s_add_u32 m0, m0, 1024
s_add_u32 s39, s39, 16384
buffer_load_dwordx4 v51, s[8:11], s39 offen lds
s_add_u32 m0, m0, 1024
s_add_u32 s39, s39, 16384
buffer_load_dwordx4 v51, s[8:11], s39 offen lds
s_add_u32 m0, m0, 1024
s_add_u32 s39, s39, 16384
buffer_load_dwordx4 v51, s[8:11], s39 offen lds
s_add_u32 m0, m0, 1024
s_add_u32 s39, s39, 16384
buffer_load_dwordx4 v51, s[8:11], s39 offen lds
s_add_u32 m0, m0, 1024
s_add_u32 s39, s39, 16384
buffer_load_dwordx4 v51, s[8:11], s39 offen lds
s_waitcnt vmcnt(32)
ds_read_b64_tr_b16 v[224:225], v52 offset:16384
ds_read_b64_tr_b16 v[226:227], v52 offset:18432
ds_read_b64_tr_b16 v[228:229], v52 offset:20480
ds_read_b64_tr_b16 v[230:231], v52 offset:22528
ds_read_b64_tr_b16 v[232:233], v52 offset:16416
ds_read_b64_tr_b16 v[234:235], v52 offset:18464
ds_read_b64_tr_b16 v[236:237], v52 offset:20512
ds_read_b64_tr_b16 v[238:239], v52 offset:22560
ds_read_b64_tr_b16 v[240:241], v52 offset:16448
ds_read_b64_tr_b16 v[242:243], v52 offset:18496
ds_read_b64_tr_b16 v[244:245], v52 offset:20544
ds_read_b64_tr_b16 v[246:247], v52 offset:22592
ds_read_b64_tr_b16 v[248:249], v52 offset:16480
ds_read_b64_tr_b16 v[250:251], v52 offset:18528
ds_read_b64_tr_b16 v[252:253], v52 offset:20576
ds_read_b64_tr_b16 v[254:255], v52 offset:22624
s_waitcnt lgkmcnt(0)
s_waitcnt vmcnt(24)
ds_read_b64_tr_b16 a[128:129], v53 offset:24576
ds_read_b64_tr_b16 a[130:131], v53 offset:24832
ds_read_b64_tr_b16 a[132:133], v53 offset:28672
ds_read_b64_tr_b16 a[134:135], v53 offset:28928
ds_read_b64_tr_b16 a[136:137], v53 offset:24608
ds_read_b64_tr_b16 a[138:139], v53 offset:24864
ds_read_b64_tr_b16 a[140:141], v53 offset:28704
ds_read_b64_tr_b16 a[142:143], v53 offset:28960
ds_read_b64_tr_b16 a[144:145], v53 offset:24640
ds_read_b64_tr_b16 a[146:147], v53 offset:24896
ds_read_b64_tr_b16 a[148:149], v53 offset:28736
ds_read_b64_tr_b16 a[150:151], v53 offset:28992
ds_read_b64_tr_b16 a[152:153], v53 offset:24672
ds_read_b64_tr_b16 a[154:155], v53 offset:24928
ds_read_b64_tr_b16 a[156:157], v53 offset:28768
ds_read_b64_tr_b16 a[158:159], v53 offset:29024
s_waitcnt lgkmcnt(0)
s_waitcnt vmcnt(16)
ds_read_b64_tr_b16 a[160:161], v53 offset:32768
ds_read_b64_tr_b16 a[162:163], v53 offset:33024
ds_read_b64_tr_b16 a[164:165], v53 offset:36864
ds_read_b64_tr_b16 a[166:167], v53 offset:37120
ds_read_b64_tr_b16 a[168:169], v53 offset:32800
ds_read_b64_tr_b16 a[170:171], v53 offset:33056
ds_read_b64_tr_b16 a[172:173], v53 offset:36896
ds_read_b64_tr_b16 a[174:175], v53 offset:37152
ds_read_b64_tr_b16 a[176:177], v53 offset:32832
ds_read_b64_tr_b16 a[178:179], v53 offset:33088
ds_read_b64_tr_b16 a[180:181], v53 offset:36928
ds_read_b64_tr_b16 a[182:183], v53 offset:37184
ds_read_b64_tr_b16 a[184:185], v53 offset:32864
ds_read_b64_tr_b16 a[186:187], v53 offset:33120
ds_read_b64_tr_b16 a[188:189], v53 offset:36960
ds_read_b64_tr_b16 a[190:191], v53 offset:37216
s_waitcnt lgkmcnt(0)
s_waitcnt vmcnt(8)
ds_read_b64_tr_b16 a[192:193], v53 offset:0
ds_read_b64_tr_b16 a[194:195], v53 offset:256
ds_read_b64_tr_b16 a[196:197], v53 offset:4096
ds_read_b64_tr_b16 a[198:199], v53 offset:4352
ds_read_b64_tr_b16 a[200:201], v53 offset:32
ds_read_b64_tr_b16 a[202:203], v53 offset:288
ds_read_b64_tr_b16 a[204:205], v53 offset:4128
ds_read_b64_tr_b16 a[206:207], v53 offset:4384
ds_read_b64_tr_b16 a[208:209], v53 offset:64
ds_read_b64_tr_b16 a[210:211], v53 offset:320
ds_read_b64_tr_b16 a[212:213], v53 offset:4160
ds_read_b64_tr_b16 a[214:215], v53 offset:4416
ds_read_b64_tr_b16 a[216:217], v53 offset:96
ds_read_b64_tr_b16 a[218:219], v53 offset:352
ds_read_b64_tr_b16 a[220:221], v53 offset:4192
ds_read_b64_tr_b16 a[222:223], v53 offset:4448
s_waitcnt lgkmcnt(0)
s_waitcnt vmcnt(0)
ds_read_b64_tr_b16 a[224:225], v53 offset:8192
ds_read_b64_tr_b16 a[226:227], v53 offset:8448
ds_read_b64_tr_b16 a[228:229], v53 offset:12288
ds_read_b64_tr_b16 a[230:231], v53 offset:12544
ds_read_b64_tr_b16 a[232:233], v53 offset:8224
ds_read_b64_tr_b16 a[234:235], v53 offset:8480
ds_read_b64_tr_b16 a[236:237], v53 offset:12320
ds_read_b64_tr_b16 a[238:239], v53 offset:12576
ds_read_b64_tr_b16 a[240:241], v53 offset:8256
ds_read_b64_tr_b16 a[242:243], v53 offset:8512
ds_read_b64_tr_b16 a[244:245], v53 offset:12352
ds_read_b64_tr_b16 a[246:247], v53 offset:12608
ds_read_b64_tr_b16 a[248:249], v53 offset:8288
ds_read_b64_tr_b16 a[250:251], v53 offset:8544
ds_read_b64_tr_b16 a[252:253], v53 offset:12384
ds_read_b64_tr_b16 a[254:255], v53 offset:12640
s_waitcnt lgkmcnt(0)
v_mov_b32 v48, 32
Lst_259:
s_sub_u32 s37, s37, 1
s_cbranch_scc1 Lend_8
buffer_load_dword v49, v48, s[12:15], 0 offen sc1
s_waitcnt vmcnt(0)
v_readfirstlane_b32 s38, v49
s_nop 3
s_and_b32 s39, s38, 0xffff
s_cmp_lg_u32 s39, 96
s_cbranch_scc1 Lst_259
s_bfe_u32 s35, s38, 0x80010
s_barrier
s_mul_i32 m0, s32, 2560
v_mov_b32 v44, 0
v_mov_b32 v45, 0
v_mov_b32 v46, 0
v_mov_b32 v47, 0
v_mov_b32 v48, 0
v_mov_b32 v49, 0
v_mov_b32 v50, 0
v_mov_b32 v51, 0
v_mov_b32 v52, 0
v_mov_b32 v53, 0
v_mov_b32 v54, 0
v_mov_b32 v55, 0
v_mov_b32 v56, 0
v_mov_b32 v57, 0
v_mov_b32 v58, 0
v_mov_b32 v59, 0
v_mov_b32 v60, 0
v_mov_b32 v61, 0
v_mov_b32 v62, 0
v_mov_b32 v63, 0
v_mov_b32 v64, 0
v_mov_b32 v65, 0
v_mov_b32 v66, 0
v_mov_b32 v67, 0
v_mov_b32 v68, 0
v_mov_b32 v69, 0
v_mov_b32 v70, 0
v_mov_b32 v71, 0
v_mov_b32 v72, 0
v_mov_b32 v73, 0
v_mov_b32 v74, 0
v_mov_b32 v75, 0
s_mov_b32 s36, 0
s_cmp_lg_u32 s35, 0
s_cbranch_scc1 Lkvo_sc1_260
Lkvo_261:
s_and_b32 s38, s36, 3
s_lshl_b32 s39, s38, 16
s_add_u32 s40, s39, s45
s_xor_b32 s42, s40, 0x20000
s_add_u32 s26, s36, 1
s_mov_b64 exec, 15
buffer_load_dword v4, v1, s[4:7], s59 offen sc1
s_nop 11
buffer_load_dword v5, v1, s[4:7], s59 offen sc1
s_nop 11
buffer_load_dword v6, v1, s[4:7], s59 offen sc1
Lft_265:
s_waitcnt vmcnt(2)
v_cmp_gt_u32 vcc, s26, v4
s_cbranch_vccz Lfg_264
buffer_load_dword v4, v1, s[4:7], s59 offen sc1
s_waitcnt vmcnt(2)
v_cmp_gt_u32 vcc, s26, v5
s_cbranch_vccz Lfg_264
buffer_load_dword v5, v1, s[4:7], s59 offen sc1
s_waitcnt vmcnt(2)
v_cmp_gt_u32 vcc, s26, v6
s_cbranch_vccz Lfg_264
buffer_load_dword v6, v1, s[4:7], s59 offen sc1
s_sub_u32 s37, s37, 1
s_cbranch_scc1 Lend_8
s_branch Lft_265
Lfg_264:
s_mov_b64 exec, -1
Lkvo3_263:
buffer_load_dwordx4 v[28:31], v8, s[4:7], s40 offen offset:0 sc1
v_mfma_f32_16x16x32_bf16 v[16:19], v[20:23], v[20:23], 0
v_mfma_f32_16x16x32_bf16 v[16:19], v[20:23], v[20:23], 0
v_mfma_f32_16x16x32_bf16 v[16:19], v[20:23], v[20:23], 0
v_mfma_f32_16x16x32_bf16 v[16:19], v[20:23], v[20:23], 0
buffer_load_dwordx4 v[32:35], v8, s[4:7], s40 offen offset:1024 sc1
v_mfma_f32_16x16x32_bf16 v[16:19], v[20:23], v[20:23], 0
v_mfma_f32_16x16x32_bf16 v[16:19], v[20:23], v[20:23], 0
v_mfma_f32_16x16x32_bf16 v[16:19], v[20:23], v[20:23], 0
v_mfma_f32_16x16x32_bf16 v[16:19], v[20:23], v[20:23], 0
buffer_load_dwordx4 v[36:39], v8, s[4:7], s40 offen offset:2048 sc1
v_mfma_f32_16x16x32_bf16 v[16:19], v[20:23], v[20:23], 0
v_mfma_f32_16x16x32_bf16 v[16:19], v[20:23], v[20:23], 0
v_mfma_f32_16x16x32_bf16 v[16:19], v[20:23], v[20:23], 0
v_mfma_f32_16x16x32_bf16 v[16:19], v[20:23], v[20:23], 0
buffer_load_dwordx4 v[40:43], v8, s[4:7], s40 offen offset:3072 sc1
v_mfma_f32_16x16x32_bf16 v[16:19], v[20:23], v[20:23], 0
s_waitcnt vmcnt(3)
v_max3_u32 v26, v28, v29, v30
v_max_u32 v26, v26, v31
v_cmp_eq_u32 vcc, -1, v26
s_cbranch_vccnz Lpf_267
v_smfmac_f32_16x16x64_bf16 v[44:47], v[28:31], a[0:7], v126
v_smfmac_f32_16x16x64_bf16 v[48:51], v[28:31], a[8:15], v126
v_smfmac_f32_16x16x64_bf16 v[52:55], v[28:31], a[16:23], v126
v_smfmac_f32_16x16x64_bf16 v[56:59], v[28:31], a[24:31], v126
s_waitcnt vmcnt(2)
v_max3_u32 v26, v32, v33, v34
v_max_u32 v26, v26, v35
v_cmp_eq_u32 vcc, -1, v26
v_smfmac_f32_16x16x64_bf16 v[60:63], v[28:31], v[128:135], v126
v_smfmac_f32_16x16x64_bf16 v[64:67], v[28:31], v[136:143], v126
s_cbranch_vccnz Lpf_268
v_smfmac_f32_16x16x64_bf16 v[44:47], v[32:35], a[32:39], v126
v_smfmac_f32_16x16x64_bf16 v[48:51], v[32:35], a[40:47], v126
v_smfmac_f32_16x16x64_bf16 v[52:55], v[32:35], a[48:55], v126
v_smfmac_f32_16x16x64_bf16 v[56:59], v[32:35], a[56:63], v126
s_waitcnt vmcnt(1)
v_max3_u32 v26, v36, v37, v38
v_max_u32 v26, v26, v39
v_cmp_eq_u32 vcc, -1, v26
v_smfmac_f32_16x16x64_bf16 v[60:63], v[32:35], v[160:167], v126
v_smfmac_f32_16x16x64_bf16 v[64:67], v[32:35], v[168:175], v126
s_cbranch_vccnz Lpf_269
v_smfmac_f32_16x16x64_bf16 v[44:47], v[36:39], a[64:71], v126
v_smfmac_f32_16x16x64_bf16 v[48:51], v[36:39], a[72:79], v126
v_smfmac_f32_16x16x64_bf16 v[52:55], v[36:39], a[80:87], v126
v_smfmac_f32_16x16x64_bf16 v[56:59], v[36:39], a[88:95], v126
s_waitcnt vmcnt(0)
v_max3_u32 v26, v40, v41, v42
v_max_u32 v26, v26, v43
v_cmp_eq_u32 vcc, -1, v26
v_smfmac_f32_16x16x64_bf16 v[60:63], v[36:39], v[192:199], v126
v_smfmac_f32_16x16x64_bf16 v[64:67], v[36:39], v[200:207], v126
s_cbranch_vccnz Lpf_270
v_smfmac_f32_16x16x64_bf16 v[44:47], v[40:43], a[96:103], v126
v_smfmac_f32_16x16x64_bf16 v[48:51], v[40:43], a[104:111], v126
v_smfmac_f32_16x16x64_bf16 v[52:55], v[40:43], a[112:119], v126
v_smfmac_f32_16x16x64_bf16 v[56:59], v[40:43], a[120:127], v126
v_smfmac_f32_16x16x64_bf16 v[60:63], v[40:43], v[224:231], v126
v_smfmac_f32_16x16x64_bf16 v[64:67], v[40:43], v[232:239], v126
Lpd_266:
s_nop 2
v_add_f32 v92, v44, v45
v_add_f32 v93, v46, v47
v_add_f32 v94, v48, v49
v_add_f32 v95, v50, v51
v_add_f32 v96, v52, v53
ds_write_addtid_b32 v92 offset:0
v_add_f32 v97, v54, v55
ds_write_addtid_b32 v93 offset:640
v_add_f32 v98, v56, v57
ds_write_addtid_b32 v94 offset:288
v_add_f32 v99, v58, v59
ds_write_addtid_b32 v95 offset:928
ds_write_addtid_b32 v96 offset:1280
ds_write_addtid_b32 v97 offset:1920
ds_write_addtid_b32 v98 offset:1568
v_smfmac_f32_16x16x64_bf16 v[68:71], v[28:31], v[144:151], v126
ds_write_addtid_b32 v99 offset:2208
v_smfmac_f32_16x16x64_bf16 v[72:75], v[28:31], v[152:159], v126
v_smfmac_f32_16x16x64_bf16 v[68:71], v[32:35], v[176:183], v126
v_smfmac_f32_16x16x64_bf16 v[72:75], v[32:35], v[184:191], v126
s_waitcnt lgkmcnt(0)
s_barrier
ds_read_b64 v[100:101], v24 offset:0
ds_read_b64 v[102:103], v24 offset:2560
ds_read_b64 v[104:105], v24 offset:5120
ds_read_b64 v[106:107], v24 offset:7680
v_smfmac_f32_16x16x64_bf16 v[68:71], v[36:39], v[208:215], v126
v_smfmac_f32_16x16x64_bf16 v[72:75], v[36:39], v[216:223], v126
v_smfmac_f32_16x16x64_bf16 v[68:71], v[40:43], v[240:247], v126
s_waitcnt lgkmcnt(0)
v_pk_add_f32 v[100:101], v[100:101], v[102:103]
v_pk_add_f32 v[104:105], v[104:105], v[106:107]
v_pk_add_f32 v[116:117], v[100:101], v[104:105]
v_cvt_pk_bf16_f32 v116, v116, v117
v_min_u32 v116, -2, v116
buffer_store_dword v116, v11, s[4:7], s40 offen
v_smfmac_f32_16x16x64_bf16 v[72:75], v[40:43], v[248:255], v126
s_nop 5
v_add_f32 v92, v60, v61
v_add_f32 v93, v62, v63
v_add_f32 v94, v64, v65
v_add_f32 v95, v66, v67
v_add_f32 v96, v68, v69
v_add_f32 v97, v70, v71
v_add_f32 v98, v72, v73
v_add_f32 v99, v74, v75
ds_write_b128 v25, v[92:95] offset:20480
ds_write_b128 v25, v[96:99] offset:20496
s_waitcnt lgkmcnt(0)
s_barrier
ds_read_b64 v[100:101], v127 offset:20480
ds_read_b64 v[102:103], v127 offset:22528
ds_read_b64 v[104:105], v127 offset:24576
ds_read_b64 v[106:107], v127 offset:26624
s_waitcnt lgkmcnt(0)
v_pk_add_f32 v[100:101], v[100:101], v[102:103]
v_pk_add_f32 v[104:105], v[104:105], v[106:107]
v_pk_add_f32 v[116:117], v[100:101], v[104:105]
v_cvt_pk_bf16_f32 v116, v116, v117
v_min_u32 v116, -2, v116
buffer_store_dword v116, v27, s[4:7], s40 offen
s_cmp_eq_u32 s36, 63
s_cbranch_scc1 Lend_8
buffer_store_dword v120, v11, s[4:7], s42 offen
buffer_store_dword v120, v27, s[4:7], s42 offen
s_cmp_lt_u32 s32, 2
s_cbranch_scc1 Lr1_271
buffer_store_dwordx2 v[120:121], v10, s[4:7], s42 offen
Lr1_271:
v_pk_mul_f32 v[44:45], 0, 0
v_pk_mul_f32 v[46:47], 0, 0
v_pk_mul_f32 v[48:49], 0, 0
v_pk_mul_f32 v[50:51], 0, 0
v_pk_mul_f32 v[52:53], 0, 0
v_pk_mul_f32 v[54:55], 0, 0
v_pk_mul_f32 v[56:57], 0, 0
v_pk_mul_f32 v[58:59], 0, 0
v_pk_mul_f32 v[60:61], 0, 0
v_pk_mul_f32 v[62:63], 0, 0
v_pk_mul_f32 v[64:65], 0, 0
v_pk_mul_f32 v[66:67], 0, 0
v_pk_mul_f32 v[68:69], 0, 0
v_pk_mul_f32 v[70:71], 0, 0
v_pk_mul_f32 v[72:73], 0, 0
v_pk_mul_f32 v[74:75], 0, 0
v_pk_mul_f32 v[76:77], 0, 0
v_pk_mul_f32 v[78:79], 0, 0
v_pk_mul_f32 v[80:81], 0, 0
v_pk_mul_f32 v[82:83], 0, 0
v_pk_mul_f32 v[84:85], 0, 0
v_pk_mul_f32 v[86:87], 0, 0
v_pk_mul_f32 v[88:89], 0, 0
v_pk_mul_f32 v[90:91], 0, 0
v_add_u32 v7, 1, v7
s_and_b32 s38, s36, 3
s_lshl_b32 s39, s38, 1
s_lshr_b32 s52, s46, s39
s_and_b32 s52, s52, 1
s_lshl_b32 s52, s52, 13
s_lshl_b32 s39, s39, 21
s_add_u32 s39, s39, s52
s_add_u32 s84, s39, 134217728
s_lshl_b32 s39, s38, 1
s_lshr_b32 s52, s46, s39
s_and_b32 s52, s52, 1
s_lshl_b32 s52, s52, 13
s_lshl_b32 s39, s39, 21
s_add_u32 s39, s39, s52
s_add_u32 s85, s39, 135266304
s_and_b32 s38, s26, 3
s_lshl_b32 s38, s38, 16
s_add_u32 s41, s38, s45
s_mov_b64 exec, 3
buffer_load_dword v4, v2, s[4:7], s59 offen sc1
s_nop 11
buffer_load_dword v5, v2, s[4:7], s59 offen sc1
s_nop 11
buffer_load_dword v6, v2, s[4:7], s59 offen sc1
Lft_273:
s_waitcnt vmcnt(2)
v_cmp_gt_u32 vcc, s26, v4
s_cbranch_vccz Lfg_272
buffer_load_dword v4, v2, s[4:7], s59 offen sc1
s_waitcnt vmcnt(2)
v_cmp_gt_u32 vcc, s26, v5
s_cbranch_vccz Lfg_272
buffer_load_dword v5, v2, s[4:7], s59 offen sc1
s_waitcnt vmcnt(2)
v_cmp_gt_u32 vcc, s26, v6
s_cbranch_vccz Lfg_272
buffer_load_dword v6, v2, s[4:7], s59 offen sc1
s_sub_u32 s37, s37, 1
s_cbranch_scc1 Lend_8
s_branch Lft_273
Lfg_272:
s_mov_b64 exec, -1
buffer_load_dwordx4 v[28:31], v9, s[4:7], s40 offen offset:0 sc1
v_mfma_f32_16x16x32_bf16 v[16:19], v[20:23], v[20:23], 0
v_mfma_f32_16x16x32_bf16 v[16:19], v[20:23], v[20:23], 0
v_mfma_f32_16x16x32_bf16 v[16:19], v[20:23], v[20:23], 0
v_mfma_f32_16x16x32_bf16 v[16:19], v[20:23], v[20:23], 0
buffer_load_dwordx4 v[32:35], v9, s[4:7], s40 offen offset:1024 sc1
v_mfma_f32_16x16x32_bf16 v[16:19], v[20:23], v[20:23], 0
v_mfma_f32_16x16x32_bf16 v[16:19], v[20:23], v[20:23], 0
v_mfma_f32_16x16x32_bf16 v[16:19], v[20:23], v[20:23], 0
v_mfma_f32_16x16x32_bf16 v[16:19], v[20:23], v[20:23], 0
buffer_load_dwordx4 v[36:39], v9, s[4:7], s40 offen offset:2048 sc1
v_mfma_f32_16x16x32_bf16 v[16:19], v[20:23], v[20:23], 0
v_mfma_f32_16x16x32_bf16 v[16:19], v[20:23], v[20:23], 0
v_mfma_f32_16x16x32_bf16 v[16:19], v[20:23], v[20:23], 0
v_mfma_f32_16x16x32_bf16 v[16:19], v[20:23], v[20:23], 0
buffer_load_dwordx4 v[40:43], v9, s[4:7], s40 offen offset:3072 sc1
v_mfma_f32_16x16x32_bf16 v[16:19], v[20:23], v[20:23], 0
s_waitcnt vmcnt(3)
v_max3_u32 v26, v28, v29, v30
v_max_u32 v26, v26, v31
v_cmp_eq_u32 vcc, -1, v26
s_cbranch_vccnz Lpf_275
v_smfmac_f32_16x16x64_bf16 v[76:79], v[28:31], a[128:135], v126
v_smfmac_f32_16x16x64_bf16 v[80:83], v[28:31], a[136:143], v126
s_waitcnt vmcnt(2)
v_max3_u32 v26, v32, v33, v34
v_max_u32 v26, v26, v35
v_cmp_eq_u32 vcc, -1, v26
v_smfmac_f32_16x16x64_bf16 v[84:87], v[28:31], a[144:151], v126
v_smfmac_f32_16x16x64_bf16 v[88:91], v[28:31], a[152:159], v126
s_cbranch_vccnz Lpf_276
v_smfmac_f32_16x16x64_bf16 v[76:79], v[32:35], a[160:167], v126
v_smfmac_f32_16x16x64_bf16 v[80:83], v[32:35], a[168:175], v126
s_waitcnt vmcnt(1)
v_max3_u32 v26, v36, v37, v38
v_max_u32 v26, v26, v39
v_cmp_eq_u32 vcc, -1, v26
v_smfmac_f32_16x16x64_bf16 v[84:87], v[32:35], a[176:183], v126
v_smfmac_f32_16x16x64_bf16 v[88:91], v[32:35], a[184:191], v126
s_cbranch_vccnz Lpf_277
v_smfmac_f32_16x16x64_bf16 v[76:79], v[36:39], a[192:199], v126
v_smfmac_f32_16x16x64_bf16 v[80:83], v[36:39], a[200:207], v126
s_waitcnt vmcnt(0)
v_max3_u32 v26, v40, v41, v42
v_max_u32 v26, v26, v43
v_cmp_eq_u32 vcc, -1, v26
v_smfmac_f32_16x16x64_bf16 v[84:87], v[36:39], a[208:215], v126
v_smfmac_f32_16x16x64_bf16 v[88:91], v[36:39], a[216:223], v126
s_cbranch_vccnz Lpf_278
v_smfmac_f32_16x16x64_bf16 v[76:79], v[40:43], a[224:231], v126
v_smfmac_f32_16x16x64_bf16 v[80:83], v[40:43], a[232:239], v126
v_smfmac_f32_16x16x64_bf16 v[84:87], v[40:43], a[240:247], v126
v_smfmac_f32_16x16x64_bf16 v[88:91], v[40:43], a[248:255], v126
Lpd_274:
s_nop 4
v_add_f32 v92, v76, v77
v_add_f32 v93, v78, v79
v_add_f32 v94, v80, v81
v_add_f32 v95, v82, v83
v_add_f32 v96, v84, v85
ds_write_addtid_b32 v92 offset:10240
v_add_f32 v97, v86, v87
ds_write_addtid_b32 v93 offset:10528
v_add_f32 v98, v88, v89
ds_write_addtid_b32 v94 offset:10816
v_add_f32 v99, v90, v91
ds_write_addtid_b32 v95 offset:11104
ds_write_addtid_b32 v96 offset:11392
ds_write_addtid_b32 v97 offset:11680
ds_write_addtid_b32 v98 offset:11968
ds_write_addtid_b32 v99 offset:12256
v_mfma_f32_16x16x32_bf16 v[16:19], v[20:23], v[20:23], 0
v_mfma_f32_16x16x32_bf16 v[16:19], v[20:23], v[20:23], 0
s_cmp_ge_u32 s32, 2
s_cbranch_scc1 Lxl_279
s_waitcnt lgkmcnt(0)
s_barrier
ds_read_b64 v[100:101], v0 offset:10240
ds_read_b64 v[102:103], v0 offset:10816
ds_read_b64 v[104:105], v0 offset:12800
ds_read_b64 v[106:107], v0 offset:13376
ds_read_b64 v[108:109], v0 offset:15360
ds_read_b64 v[110:111], v0 offset:15936
ds_read_b64 v[112:113], v0 offset:17920
ds_read_b64 v[114:115], v0 offset:18496
s_waitcnt lgkmcnt(4)
v_pk_add_f32 v[100:101], v[100:101], v[104:105]
v_pk_add_f32 v[102:103], v[102:103], v[106:107]
s_waitcnt lgkmcnt(0)
v_pk_add_f32 v[108:109], v[108:109], v[112:113]
v_pk_add_f32 v[110:111], v[110:111], v[114:115]
v_pk_add_f32 v[116:117], v[100:101], v[108:109]
v_pk_add_f32 v[118:119], v[102:103], v[110:111]
v_cvt_pk_bf16_f32 v116, v116, v117
v_cvt_pk_bf16_f32 v117, v118, v119
v_min_u32 v116, -2, v116
v_min_u32 v117, -2, v117
buffer_store_dwordx2 v[116:117], v12, s[4:7], s84 offen sc1
buffer_store_dwordx2 v[116:117], v12, s[4:7], s85 offen sc1
v_mfma_f32_16x16x32_bf16 v[16:19], v[20:23], v[20:23], 0
v_mfma_f32_16x16x32_bf16 v[16:19], v[20:23], v[20:23], 0
v_mfma_f32_16x16x32_bf16 v[16:19], v[20:23], v[20:23], 0
v_mfma_f32_16x16x32_bf16 v[16:19], v[20:23], v[20:23], 0
v_mfma_f32_16x16x32_bf16 v[16:19], v[20:23], v[20:23], 0
v_mfma_f32_16x16x32_bf16 v[16:19], v[20:23], v[20:23], 0
v_mfma_f32_16x16x32_bf16 v[16:19], v[20:23], v[20:23], 0
v_mfma_f32_16x16x32_bf16 v[16:19], v[20:23], v[20:23], 0
v_mfma_f32_16x16x32_bf16 v[16:19], v[20:23], v[20:23], 0
v_mfma_f32_16x16x32_bf16 v[16:19], v[20:23], v[20:23], 0
v_mfma_f32_16x16x32_bf16 v[16:19], v[20:23], v[20:23], 0
v_mfma_f32_16x16x32_bf16 v[16:19], v[20:23], v[20:23], 0
v_mfma_f32_16x16x32_bf16 v[16:19], v[20:23], v[20:23], 0
v_mfma_f32_16x16x32_bf16 v[16:19], v[20:23], v[20:23], 0
v_mfma_f32_16x16x32_bf16 v[16:19], v[20:23], v[20:23], 0
v_mfma_f32_16x16x32_bf16 v[16:19], v[20:23], v[20:23], 0
v_mfma_f32_16x16x32_bf16 v[16:19], v[20:23], v[20:23], 0
v_mfma_f32_16x16x32_bf16 v[16:19], v[20:23], v[20:23], 0
v_mfma_f32_16x16x32_bf16 v[16:19], v[20:23], v[20:23], 0
v_mfma_f32_16x16x32_bf16 v[16:19], v[20:23], v[20:23], 0
v_mfma_f32_16x16x32_bf16 v[16:19], v[20:23], v[20:23], 0
v_mfma_f32_16x16x32_bf16 v[16:19], v[20:23], v[20:23], 0
v_mfma_f32_16x16x32_bf16 v[16:19], v[20:23], v[20:23], 0
v_mfma_f32_16x16x32_bf16 v[16:19], v[20:23], v[20:23], 0
v_mfma_f32_16x16x32_bf16 v[16:19], v[20:23], v[20:23], 0
v_mfma_f32_16x16x32_bf16 v[16:19], v[20:23], v[20:23], 0
v_mfma_f32_16x16x32_bf16 v[16:19], v[20:23], v[20:23], 0
v_mfma_f32_16x16x32_bf16 v[16:19], v[20:23], v[20:23], 0
v_mfma_f32_16x16x32_bf16 v[16:19], v[20:23], v[20:23], 0
v_mfma_f32_16x16x32_bf16 v[16:19], v[20:23], v[20:23], 0
v_mfma_f32_16x16x32_bf16 v[16:19], v[20:23], v[20:23], 0
v_mfma_f32_16x16x32_bf16 v[16:19], v[20:23], v[20:23], 0
v_mfma_f32_16x16x32_bf16 v[16:19], v[20:23], v[20:23], 0
v_mfma_f32_16x16x32_bf16 v[16:19], v[20:23], v[20:23], 0
v_mfma_f32_16x16x32_bf16 v[16:19], v[20:23], v[20:23], 0
v_mfma_f32_16x16x32_bf16 v[16:19], v[20:23], v[20:23], 0
buffer_store_dword v7, v3, s[4:7], s59 offen
s_add_u32 s36, s36, 1
s_branch Lkvo_261
Lxl_279:
s_waitcnt lgkmcnt(0)
s_barrier
v_mfma_f32_16x16x32_bf16 v[16:19], v[20:23], v[20:23], 0
v_mfma_f32_16x16x32_bf16 v[16:19], v[20:23], v[20:23], 0
v_mfma_f32_16x16x32_bf16 v[16:19], v[20:23], v[20:23], 0
v_mfma_f32_16x16x32_bf16 v[16:19], v[20:23], v[20:23], 0
v_mfma_f32_16x16x32_bf16 v[16:19], v[20:23], v[20:23], 0
v_mfma_f32_16x16x32_bf16 v[16:19], v[20:23], v[20:23], 0
v_mfma_f32_16x16x32_bf16 v[16:19], v[20:23], v[20:23], 0
v_mfma_f32_16x16x32_bf16 v[16:19], v[20:23], v[20:23], 0
v_mfma_f32_16x16x32_bf16 v[16:19], v[20:23], v[20:23], 0
v_mfma_f32_16x16x32_bf16 v[16:19], v[20:23], v[20:23], 0
v_mfma_f32_16x16x32_bf16 v[16:19], v[20:23], v[20:23], 0
v_mfma_f32_16x16x32_bf16 v[16:19], v[20:23], v[20:23], 0
v_mfma_f32_16x16x32_bf16 v[16:19], v[20:23], v[20:23], 0
v_mfma_f32_16x16x32_bf16 v[16:19], v[20:23], v[20:23], 0
v_mfma_f32_16x16x32_bf16 v[16:19], v[20:23], v[20:23], 0
v_mfma_f32_16x16x32_bf16 v[16:19], v[20:23], v[20:23], 0
v_mfma_f32_16x16x32_bf16 v[16:19], v[20:23], v[20:23], 0
v_mfma_f32_16x16x32_bf16 v[16:19], v[20:23], v[20:23], 0
v_mfma_f32_16x16x32_bf16 v[16:19], v[20:23], v[20:23], 0
v_mfma_f32_16x16x32_bf16 v[16:19], v[20:23], v[20:23], 0
v_mfma_f32_16x16x32_bf16 v[16:19], v[20:23], v[20:23], 0
v_mfma_f32_16x16x32_bf16 v[16:19], v[20:23], v[20:23], 0
v_mfma_f32_16x16x32_bf16 v[16:19], v[20:23], v[20:23], 0
v_mfma_f32_16x16x32_bf16 v[16:19], v[20:23], v[20:23], 0
v_mfma_f32_16x16x32_bf16 v[16:19], v[20:23], v[20:23], 0
v_mfma_f32_16x16x32_bf16 v[16:19], v[20:23], v[20:23], 0
v_mfma_f32_16x16x32_bf16 v[16:19], v[20:23], v[20:23], 0
v_mfma_f32_16x16x32_bf16 v[16:19], v[20:23], v[20:23], 0
buffer_load_dwordx2 v[76:77], v13, s[4:7], s84 offen sc1
buffer_load_dwordx2 v[78:79], v14, s[4:7], s84 offen sc1
buffer_load_dwordx2 v[80:81], v15, s[4:7], s84 offen sc1
v_mfma_f32_16x16x32_bf16 v[16:19], v[20:23], v[20:23], 0
v_mfma_f32_16x16x32_bf16 v[16:19], v[20:23], v[20:23], 0
v_mfma_f32_16x16x32_bf16 v[16:19], v[20:23], v[20:23], 0
v_mfma_f32_16x16x32_bf16 v[16:19], v[20:23], v[20:23], 0
v_mfma_f32_16x16x32_bf16 v[16:19], v[20:23], v[20:23], 0
v_mfma_f32_16x16x32_bf16 v[16:19], v[20:23], v[20:23], 0
v_mfma_f32_16x16x32_bf16 v[16:19], v[20:23], v[20:23], 0
v_mfma_f32_16x16x32_bf16 v[16:19], v[20:23], v[20:23], 0
v_mfma_f32_16x16x32_bf16 v[16:19], v[20:23], v[20:23], 0
v_mfma_f32_16x16x32_bf16 v[16:19], v[20:23], v[20:23], 0
v_mfma_f32_16x16x32_bf16 v[16:19], v[20:23], v[20:23], 0
v_mfma_f32_16x16x32_bf16 v[16:19], v[20:23], v[20:23], 0
buffer_load_dwordx2 v[88:89], v13, s[4:7], s85 offen sc1
buffer_load_dwordx2 v[90:91], v14, s[4:7], s85 offen sc1
buffer_load_dwordx2 v[92:93], v15, s[4:7], s85 offen sc1
ds_read_b64 v[100:101], v0 offset:10240
ds_read_b64 v[102:103], v0 offset:10816
ds_read_b64 v[104:105], v0 offset:12800
ds_read_b64 v[106:107], v0 offset:13376
ds_read_b64 v[108:109], v0 offset:15360
ds_read_b64 v[110:111], v0 offset:15936
ds_read_b64 v[112:113], v0 offset:17920
ds_read_b64 v[114:115], v0 offset:18496
s_waitcnt lgkmcnt(4)
v_pk_add_f32 v[100:101], v[100:101], v[104:105]
v_pk_add_f32 v[102:103], v[102:103], v[106:107]
s_waitcnt lgkmcnt(0)
v_pk_add_f32 v[108:109], v[108:109], v[112:113]
v_pk_add_f32 v[110:111], v[110:111], v[114:115]
v_pk_add_f32 v[116:117], v[100:101], v[108:109]
v_pk_add_f32 v[118:119], v[102:103], v[110:111]
v_cvt_pk_bf16_f32 v100, v116, v117
v_cvt_pk_bf16_f32 v101, v118, v119
v_lshlrev_b32 v116, 16, v100
v_and_b32 v117, 0xffff0000, v100
v_lshlrev_b32 v118, 16, v101
v_and_b32 v119, 0xffff0000, v101
v_mfma_f32_16x16x32_bf16 v[16:19], v[20:23], v[20:23], 0
v_mfma_f32_16x16x32_bf16 v[16:19], v[20:23], v[20:23], 0
v_mfma_f32_16x16x32_bf16 v[16:19], v[20:23], v[20:23], 0
v_mfma_f32_16x16x32_bf16 v[16:19], v[20:23], v[20:23], 0
buffer_load_dwordx2 v[28:29], v13, s[4:7], s84 offen sc1
buffer_load_dwordx2 v[30:31], v14, s[4:7], s84 offen sc1
buffer_load_dwordx2 v[32:33], v15, s[4:7], s84 offen sc1
s_waitcnt vmcnt(6)
v_max3_u32 v26, v76, v77, v78
v_max3_u32 v26, v26, v79, v80
v_max_u32 v26, v26, v81
v_cmp_eq_u32 vcc, -1, v26
v_dot2_f32_bf16 v100, v76, s55, v116
v_dot2_f32_bf16 v101, v76, s56, v117
v_dot2_f32_bf16 v102, v77, s55, v118
v_dot2_f32_bf16 v103, v77, s56, v119
v_dot2_f32_bf16 v100, v78, s55, v100
v_dot2_f32_bf16 v101, v78, s56, v101
v_dot2_f32_bf16 v102, v79, s55, v102
v_dot2_f32_bf16 v103, v79, s56, v103
v_dot2_f32_bf16 v100, v80, s55, v100
v_dot2_f32_bf16 v101, v80, s56, v101
v_dot2_f32_bf16 v102, v81, s55, v102
v_dot2_f32_bf16 v103, v81, s56, v103
s_nop 1
v_cvt_pk_bf16_f32 v100, v100, v101
v_cvt_pk_bf16_f32 v101, v102, v103
v_min_u32 v100, -2, v100
v_min_u32 v101, -2, v101
s_cbranch_vccnz Lx2_280
Lxs_281:
buffer_store_dwordx2 v[100:101], v10, s[4:7], s41 offen
s_add_u32 s36, s36, 1
s_and_b32 s38, s36, 3
s_lshl_b32 s39, s38, 16
s_add_u32 s40, s39, s45
s_xor_b32 s42, s40, 0x20000
s_add_u32 s26, s36, 1
v_mfma_f32_16x16x32_bf16 v[16:19], v[20:23], v[20:23], 0
v_mfma_f32_16x16x32_bf16 v[16:19], v[20:23], v[20:23], 0
v_mfma_f32_16x16x32_bf16 v[16:19], v[20:23], v[20:23], 0
v_mfma_f32_16x16x32_bf16 v[16:19], v[20:23], v[20:23], 0
v_mfma_f32_16x16x32_bf16 v[16:19], v[20:23], v[20:23], 0
v_mfma_f32_16x16x32_bf16 v[16:19], v[20:23], v[20:23], 0
v_mfma_f32_16x16x32_bf16 v[16:19], v[20:23], v[20:23], 0
v_mfma_f32_16x16x32_bf16 v[16:19], v[20:23], v[20:23], 0
s_branch Lkvo3_263
Lx2_280:
buffer_load_dwordx2 v[76:77], v13, s[4:7], s85 offen sc1
buffer_load_dwordx2 v[78:79], v14, s[4:7], s85 offen sc1
buffer_load_dwordx2 v[80:81], v15, s[4:7], s85 offen sc1
s_waitcnt vmcnt(6)
v_max3_u32 v26, v88, v89, v90
v_max3_u32 v26, v26, v91, v92
v_max_u32 v26, v26, v93
v_cmp_eq_u32 vcc, -1, v26
v_dot2_f32_bf16 v100, v88, s55, v116
v_dot2_f32_bf16 v101, v88, s56, v117
v_dot2_f32_bf16 v102, v89, s55, v118
v_dot2_f32_bf16 v103, v89, s56, v119
v_dot2_f32_bf16 v100, v90, s55, v100
v_dot2_f32_bf16 v101, v90, s56, v101
v_dot2_f32_bf16 v102, v91, s55, v102
v_dot2_f32_bf16 v103, v91, s56, v103
v_dot2_f32_bf16 v100, v92, s55, v100
v_dot2_f32_bf16 v101, v92, s56, v101
v_dot2_f32_bf16 v102, v93, s55, v102
v_dot2_f32_bf16 v103, v93, s56, v103
s_nop 1
v_cvt_pk_bf16_f32 v100, v100, v101
v_cvt_pk_bf16_f32 v101, v102, v103
v_min_u32 v100, -2, v100
v_min_u32 v101, -2, v101
s_cbranch_vccz Lxs_281
buffer_load_dwordx2 v[88:89], v13, s[4:7], s84 offen sc1
buffer_load_dwordx2 v[90:91], v14, s[4:7], s84 offen sc1
buffer_load_dwordx2 v[92:93], v15, s[4:7], s84 offen sc1
s_waitcnt vmcnt(6)
v_max3_u32 v26, v28, v29, v30
v_max3_u32 v26, v26, v31, v32
v_max_u32 v26, v26, v33
v_cmp_eq_u32 vcc, -1, v26
v_dot2_f32_bf16 v100, v28, s55, v116
v_dot2_f32_bf16 v101, v28, s56, v117
v_dot2_f32_bf16 v102, v29, s55, v118
v_dot2_f32_bf16 v103, v29, s56, v119
v_dot2_f32_bf16 v100, v30, s55, v100
v_dot2_f32_bf16 v101, v30, s56, v101
v_dot2_f32_bf16 v102, v31, s55, v102
v_dot2_f32_bf16 v103, v31, s56, v103
v_dot2_f32_bf16 v100, v32, s55, v100
v_dot2_f32_bf16 v101, v32, s56, v101
v_dot2_f32_bf16 v102, v33, s55, v102
v_dot2_f32_bf16 v103, v33, s56, v103
s_nop 1
v_cvt_pk_bf16_f32 v100, v100, v101
v_cvt_pk_bf16_f32 v101, v102, v103
v_min_u32 v100, -2, v100
v_min_u32 v101, -2, v101
s_cbranch_vccz Lxs_281
buffer_load_dwordx2 v[28:29], v13, s[4:7], s85 offen sc1
buffer_load_dwordx2 v[30:31], v14, s[4:7], s85 offen sc1
buffer_load_dwordx2 v[32:33], v15, s[4:7], s85 offen sc1
s_waitcnt vmcnt(6)
v_max3_u32 v26, v76, v77, v78
v_max3_u32 v26, v26, v79, v80
v_max_u32 v26, v26, v81
v_cmp_eq_u32 vcc, -1, v26
v_dot2_f32_bf16 v100, v76, s55, v116
v_dot2_f32_bf16 v101, v76, s56, v117
v_dot2_f32_bf16 v102, v77, s55, v118
v_dot2_f32_bf16 v103, v77, s56, v119
v_dot2_f32_bf16 v100, v78, s55, v100
v_dot2_f32_bf16 v101, v78, s56, v101
v_dot2_f32_bf16 v102, v79, s55, v102
v_dot2_f32_bf16 v103, v79, s56, v103
v_dot2_f32_bf16 v100, v80, s55, v100
v_dot2_f32_bf16 v101, v80, s56, v101
v_dot2_f32_bf16 v102, v81, s55, v102
v_dot2_f32_bf16 v103, v81, s56, v103
s_nop 1
v_cvt_pk_bf16_f32 v100, v100, v101
v_cvt_pk_bf16_f32 v101, v102, v103
v_min_u32 v100, -2, v100
v_min_u32 v101, -2, v101
s_cbranch_vccz Lxs_281
buffer_load_dwordx2 v[76:77], v13, s[4:7], s84 offen sc1
buffer_load_dwordx2 v[78:79], v14, s[4:7], s84 offen sc1
buffer_load_dwordx2 v[80:81], v15, s[4:7], s84 offen sc1
s_waitcnt vmcnt(6)
v_max3_u32 v26, v88, v89, v90
v_max3_u32 v26, v26, v91, v92
v_max_u32 v26, v26, v93
v_cmp_eq_u32 vcc, -1, v26
v_dot2_f32_bf16 v100, v88, s55, v116
v_dot2_f32_bf16 v101, v88, s56, v117
v_dot2_f32_bf16 v102, v89, s55, v118
v_dot2_f32_bf16 v103, v89, s56, v119
v_dot2_f32_bf16 v100, v90, s55, v100
v_dot2_f32_bf16 v101, v90, s56, v101
v_dot2_f32_bf16 v102, v91, s55, v102
v_dot2_f32_bf16 v103, v91, s56, v103
v_dot2_f32_bf16 v100, v92, s55, v100
v_dot2_f32_bf16 v101, v92, s56, v101
v_dot2_f32_bf16 v102, v93, s55, v102
v_dot2_f32_bf16 v103, v93, s56, v103
s_nop 1
v_cvt_pk_bf16_f32 v100, v100, v101
v_cvt_pk_bf16_f32 v101, v102, v103
v_min_u32 v100, -2, v100
v_min_u32 v101, -2, v101
s_cbranch_vccz Lxs_281
buffer_load_dwordx2 v[88:89], v13, s[4:7], s85 offen sc1
buffer_load_dwordx2 v[90:91], v14, s[4:7], s85 offen sc1
buffer_load_dwordx2 v[92:93], v15, s[4:7], s85 offen sc1
s_waitcnt vmcnt(6)
v_max3_u32 v26, v28, v29, v30
v_max3_u32 v26, v26, v31, v32
v_max_u32 v26, v26, v33
v_cmp_eq_u32 vcc, -1, v26
v_dot2_f32_bf16 v100, v28, s55, v116
v_dot2_f32_bf16 v101, v28, s56, v117
v_dot2_f32_bf16 v102, v29, s55, v118
v_dot2_f32_bf16 v103, v29, s56, v119
v_dot2_f32_bf16 v100, v30, s55, v100
v_dot2_f32_bf16 v101, v30, s56, v101
v_dot2_f32_bf16 v102, v31, s55, v102
v_dot2_f32_bf16 v103, v31, s56, v103
v_dot2_f32_bf16 v100, v32, s55, v100
v_dot2_f32_bf16 v101, v32, s56, v101
v_dot2_f32_bf16 v102, v33, s55, v102
v_dot2_f32_bf16 v103, v33, s56, v103
s_nop 1
v_cvt_pk_bf16_f32 v100, v100, v101
v_cvt_pk_bf16_f32 v101, v102, v103
v_min_u32 v100, -2, v100
v_min_u32 v101, -2, v101
s_cbranch_vccz Lxs_281
buffer_load_dwordx2 v[28:29], v13, s[4:7], s84 offen sc1
buffer_load_dwordx2 v[30:31], v14, s[4:7], s84 offen sc1
buffer_load_dwordx2 v[32:33], v15, s[4:7], s84 offen sc1
s_waitcnt vmcnt(6)
v_max3_u32 v26, v76, v77, v78
v_max3_u32 v26, v26, v79, v80
v_max_u32 v26, v26, v81
v_cmp_eq_u32 vcc, -1, v26
v_dot2_f32_bf16 v100, v76, s55, v116
v_dot2_f32_bf16 v101, v76, s56, v117
v_dot2_f32_bf16 v102, v77, s55, v118
v_dot2_f32_bf16 v103, v77, s56, v119
v_dot2_f32_bf16 v100, v78, s55, v100
v_dot2_f32_bf16 v101, v78, s56, v101
v_dot2_f32_bf16 v102, v79, s55, v102
v_dot2_f32_bf16 v103, v79, s56, v103
v_dot2_f32_bf16 v100, v80, s55, v100
v_dot2_f32_bf16 v101, v80, s56, v101
v_dot2_f32_bf16 v102, v81, s55, v102
v_dot2_f32_bf16 v103, v81, s56, v103
s_nop 1
v_cvt_pk_bf16_f32 v100, v100, v101
v_cvt_pk_bf16_f32 v101, v102, v103
v_min_u32 v100, -2, v100
v_min_u32 v101, -2, v101
s_cbranch_vccz Lxs_281
s_sub_u32 s37, s37, 1
s_cbranch_scc1 Lend_8
s_branch Lx2_280
Lpf_267:
buffer_load_dwordx4 v[28:31], v8, s[4:7], s40 offen offset:0 sc1
v_mfma_f32_16x16x32_bf16 v[16:19], v[20:23], v[20:23], 0
s_sub_u32 s37, s37, 1
s_cbranch_scc1 Lend_8
Lps_282:
s_waitcnt vmcnt(3)
v_max3_u32 v26, v32, v33, v34
v_max_u32 v26, v26, v35
v_cmp_eq_u32 vcc, -1, v26
s_cbranch_vccnz Lpf_283
v_smfmac_f32_16x16x64_bf16 v[44:47], v[32:35], a[32:39], v126
v_smfmac_f32_16x16x64_bf16 v[48:51], v[32:35], a[40:47], v126
v_smfmac_f32_16x16x64_bf16 v[52:55], v[32:35], a[48:55], v126
v_smfmac_f32_16x16x64_bf16 v[56:59], v[32:35], a[56:63], v126
v_smfmac_f32_16x16x64_bf16 v[60:63], v[32:35], v[160:167], v126
v_smfmac_f32_16x16x64_bf16 v[64:67], v[32:35], v[168:175], v126
Lps_284:
s_waitcnt vmcnt(2)
v_max3_u32 v26, v36, v37, v38
v_max_u32 v26, v26, v39
v_cmp_eq_u32 vcc, -1, v26
s_cbranch_vccnz Lpf_285
v_smfmac_f32_16x16x64_bf16 v[44:47], v[36:39], a[64:71], v126
v_smfmac_f32_16x16x64_bf16 v[48:51], v[36:39], a[72:79], v126
v_smfmac_f32_16x16x64_bf16 v[52:55], v[36:39], a[80:87], v126
v_smfmac_f32_16x16x64_bf16 v[56:59], v[36:39], a[88:95], v126
v_smfmac_f32_16x16x64_bf16 v[60:63], v[36:39], v[192:199], v126
v_smfmac_f32_16x16x64_bf16 v[64:67], v[36:39], v[200:207], v126
Lps_286:
s_waitcnt vmcnt(1)
v_max3_u32 v26, v40, v41, v42
v_max_u32 v26, v26, v43
v_cmp_eq_u32 vcc, -1, v26
s_cbranch_vccnz Lpf_287
v_smfmac_f32_16x16x64_bf16 v[44:47], v[40:43], a[96:103], v126
v_smfmac_f32_16x16x64_bf16 v[48:51], v[40:43], a[104:111], v126
v_smfmac_f32_16x16x64_bf16 v[52:55], v[40:43], a[112:119], v126
v_smfmac_f32_16x16x64_bf16 v[56:59], v[40:43], a[120:127], v126
v_smfmac_f32_16x16x64_bf16 v[60:63], v[40:43], v[224:231], v126
v_smfmac_f32_16x16x64_bf16 v[64:67], v[40:43], v[232:239], v126
Lps_288:
s_waitcnt vmcnt(0)
v_max3_u32 v26, v28, v29, v30
v_max_u32 v26, v26, v31
v_cmp_eq_u32 vcc, -1, v26
s_cbranch_vccnz Lpf_289
v_smfmac_f32_16x16x64_bf16 v[44:47], v[28:31], a[0:7], v126
v_smfmac_f32_16x16x64_bf16 v[48:51], v[28:31], a[8:15], v126
v_smfmac_f32_16x16x64_bf16 v[52:55], v[28:31], a[16:23], v126
v_smfmac_f32_16x16x64_bf16 v[56:59], v[28:31], a[24:31], v126
v_smfmac_f32_16x16x64_bf16 v[60:63], v[28:31], v[128:135], v126
v_smfmac_f32_16x16x64_bf16 v[64:67], v[28:31], v[136:143], v126
s_branch Lpd_266
Lpf_268:
buffer_load_dwordx4 v[32:35], v8, s[4:7], s40 offen offset:1024 sc1
v_mfma_f32_16x16x32_bf16 v[16:19], v[20:23], v[20:23], 0
s_sub_u32 s37, s37, 1
s_cbranch_scc1 Lend_8
Lps_290:
s_waitcnt vmcnt(2)
v_max3_u32 v26, v36, v37, v38
v_max_u32 v26, v26, v39
v_cmp_eq_u32 vcc, -1, v26
s_cbranch_vccnz Lpf_291
v_smfmac_f32_16x16x64_bf16 v[44:47], v[36:39], a[64:71], v126
v_smfmac_f32_16x16x64_bf16 v[48:51], v[36:39], a[72:79], v126
v_smfmac_f32_16x16x64_bf16 v[52:55], v[36:39], a[80:87], v126
v_smfmac_f32_16x16x64_bf16 v[56:59], v[36:39], a[88:95], v126
v_smfmac_f32_16x16x64_bf16 v[60:63], v[36:39], v[192:199], v126
v_smfmac_f32_16x16x64_bf16 v[64:67], v[36:39], v[200:207], v126
Lps_292:
s_waitcnt vmcnt(1)
v_max3_u32 v26, v40, v41, v42
v_max_u32 v26, v26, v43
v_cmp_eq_u32 vcc, -1, v26
s_cbranch_vccnz Lpf_293
v_smfmac_f32_16x16x64_bf16 v[44:47], v[40:43], a[96:103], v126
v_smfmac_f32_16x16x64_bf16 v[48:51], v[40:43], a[104:111], v126
v_smfmac_f32_16x16x64_bf16 v[52:55], v[40:43], a[112:119], v126
v_smfmac_f32_16x16x64_bf16 v[56:59], v[40:43], a[120:127], v126
v_smfmac_f32_16x16x64_bf16 v[60:63], v[40:43], v[224:231], v126
v_smfmac_f32_16x16x64_bf16 v[64:67], v[40:43], v[232:239], v126
Lps_294:
s_waitcnt vmcnt(0)
v_max3_u32 v26, v32, v33, v34
v_max_u32 v26, v26, v35
v_cmp_eq_u32 vcc, -1, v26
s_cbranch_vccnz Lpf_295
v_smfmac_f32_16x16x64_bf16 v[44:47], v[32:35], a[32:39], v126
v_smfmac_f32_16x16x64_bf16 v[48:51], v[32:35], a[40:47], v126
v_smfmac_f32_16x16x64_bf16 v[52:55], v[32:35], a[48:55], v126
v_smfmac_f32_16x16x64_bf16 v[56:59], v[32:35], a[56:63], v126
v_smfmac_f32_16x16x64_bf16 v[60:63], v[32:35], v[160:167], v126
v_smfmac_f32_16x16x64_bf16 v[64:67], v[32:35], v[168:175], v126
s_branch Lpd_266
Lpf_269:
buffer_load_dwordx4 v[36:39], v8, s[4:7], s40 offen offset:2048 sc1
v_mfma_f32_16x16x32_bf16 v[16:19], v[20:23], v[20:23], 0
s_sub_u32 s37, s37, 1
s_cbranch_scc1 Lend_8
Lps_296:
s_waitcnt vmcnt(1)
v_max3_u32 v26, v40, v41, v42
v_max_u32 v26, v26, v43
v_cmp_eq_u32 vcc, -1, v26
s_cbranch_vccnz Lpf_297
v_smfmac_f32_16x16x64_bf16 v[44:47], v[40:43], a[96:103], v126
v_smfmac_f32_16x16x64_bf16 v[48:51], v[40:43], a[104:111], v126
v_smfmac_f32_16x16x64_bf16 v[52:55], v[40:43], a[112:119], v126
v_smfmac_f32_16x16x64_bf16 v[56:59], v[40:43], a[120:127], v126
v_smfmac_f32_16x16x64_bf16 v[60:63], v[40:43], v[224:231], v126
v_smfmac_f32_16x16x64_bf16 v[64:67], v[40:43], v[232:239], v126
Lps_298:
s_waitcnt vmcnt(0)
v_max3_u32 v26, v36, v37, v38
v_max_u32 v26, v26, v39
v_cmp_eq_u32 vcc, -1, v26
s_cbranch_vccnz Lpf_299
v_smfmac_f32_16x16x64_bf16 v[44:47], v[36:39], a[64:71], v126
v_smfmac_f32_16x16x64_bf16 v[48:51], v[36:39], a[72:79], v126
v_smfmac_f32_16x16x64_bf16 v[52:55], v[36:39], a[80:87], v126
v_smfmac_f32_16x16x64_bf16 v[56:59], v[36:39], a[88:95], v126
v_smfmac_f32_16x16x64_bf16 v[60:63], v[36:39], v[192:199], v126
v_smfmac_f32_16x16x64_bf16 v[64:67], v[36:39], v[200:207], v126
s_branch Lpd_266
Lpf_270:
buffer_load_dwordx4 v[40:43], v8, s[4:7], s40 offen offset:3072 sc1
v_mfma_f32_16x16x32_bf16 v[16:19], v[20:23], v[20:23], 0
s_sub_u32 s37, s37, 1
s_cbranch_scc1 Lend_8
Lps_300:
s_waitcnt vmcnt(0)
v_max3_u32 v26, v40, v41, v42
v_max_u32 v26, v26, v43
v_cmp_eq_u32 vcc, -1, v26
s_cbranch_vccnz Lpf_301
v_smfmac_f32_16x16x64_bf16 v[44:47], v[40:43], a[96:103], v126
v_smfmac_f32_16x16x64_bf16 v[48:51], v[40:43], a[104:111], v126
v_smfmac_f32_16x16x64_bf16 v[52:55], v[40:43], a[112:119], v126
v_smfmac_f32_16x16x64_bf16 v[56:59], v[40:43], a[120:127], v126
v_smfmac_f32_16x16x64_bf16 v[60:63], v[40:43], v[224:231], v126
v_smfmac_f32_16x16x64_bf16 v[64:67], v[40:43], v[232:239], v126
s_branch Lpd_266
Lpf_283:
buffer_load_dwordx4 v[32:35], v8, s[4:7], s40 offen offset:1024 sc1
v_mfma_f32_16x16x32_bf16 v[16:19], v[20:23], v[20:23], 0
Lps_302:
s_waitcnt vmcnt(3)
v_max3_u32 v26, v36, v37, v38
v_max_u32 v26, v26, v39
v_cmp_eq_u32 vcc, -1, v26
s_cbranch_vccnz Lpf_303
v_smfmac_f32_16x16x64_bf16 v[44:47], v[36:39], a[64:71], v126
v_smfmac_f32_16x16x64_bf16 v[48:51], v[36:39], a[72:79], v126
v_smfmac_f32_16x16x64_bf16 v[52:55], v[36:39], a[80:87], v126
v_smfmac_f32_16x16x64_bf16 v[56:59], v[36:39], a[88:95], v126
v_smfmac_f32_16x16x64_bf16 v[60:63], v[36:39], v[192:199], v126
v_smfmac_f32_16x16x64_bf16 v[64:67], v[36:39], v[200:207], v126
Lps_304:
s_waitcnt vmcnt(2)
v_max3_u32 v26, v40, v41, v42
v_max_u32 v26, v26, v43
v_cmp_eq_u32 vcc, -1, v26
s_cbranch_vccnz Lpf_305
v_smfmac_f32_16x16x64_bf16 v[44:47], v[40:43], a[96:103], v126
v_smfmac_f32_16x16x64_bf16 v[48:51], v[40:43], a[104:111], v126
v_smfmac_f32_16x16x64_bf16 v[52:55], v[40:43], a[112:119], v126
v_smfmac_f32_16x16x64_bf16 v[56:59], v[40:43], a[120:127], v126
v_smfmac_f32_16x16x64_bf16 v[60:63], v[40:43], v[224:231], v126
v_smfmac_f32_16x16x64_bf16 v[64:67], v[40:43], v[232:239], v126
Lps_306:
s_waitcnt vmcnt(1)
v_max3_u32 v26, v28, v29, v30
v_max_u32 v26, v26, v31
v_cmp_eq_u32 vcc, -1, v26
s_cbranch_vccnz Lpf_307
v_smfmac_f32_16x16x64_bf16 v[44:47], v[28:31], a[0:7], v126
v_smfmac_f32_16x16x64_bf16 v[48:51], v[28:31], a[8:15], v126
v_smfmac_f32_16x16x64_bf16 v[52:55], v[28:31], a[16:23], v126
v_smfmac_f32_16x16x64_bf16 v[56:59], v[28:31], a[24:31], v126
v_smfmac_f32_16x16x64_bf16 v[60:63], v[28:31], v[128:135], v126
v_smfmac_f32_16x16x64_bf16 v[64:67], v[28:31], v[136:143], v126
s_branch Lps_294
Lpf_285:
buffer_load_dwordx4 v[36:39], v8, s[4:7], s40 offen offset:2048 sc1
v_mfma_f32_16x16x32_bf16 v[16:19], v[20:23], v[20:23], 0
Lps_308:
s_waitcnt vmcnt(2)
v_max3_u32 v26, v40, v41, v42
v_max_u32 v26, v26, v43
v_cmp_eq_u32 vcc, -1, v26
s_cbranch_vccnz Lpf_309
v_smfmac_f32_16x16x64_bf16 v[44:47], v[40:43], a[96:103], v126
v_smfmac_f32_16x16x64_bf16 v[48:51], v[40:43], a[104:111], v126
v_smfmac_f32_16x16x64_bf16 v[52:55], v[40:43], a[112:119], v126
v_smfmac_f32_16x16x64_bf16 v[56:59], v[40:43], a[120:127], v126
v_smfmac_f32_16x16x64_bf16 v[60:63], v[40:43], v[224:231], v126
v_smfmac_f32_16x16x64_bf16 v[64:67], v[40:43], v[232:239], v126
Lps_310:
s_waitcnt vmcnt(1)
v_max3_u32 v26, v28, v29, v30
v_max_u32 v26, v26, v31
v_cmp_eq_u32 vcc, -1, v26
s_cbranch_vccnz Lpf_311
v_smfmac_f32_16x16x64_bf16 v[44:47], v[28:31], a[0:7], v126
v_smfmac_f32_16x16x64_bf16 v[48:51], v[28:31], a[8:15], v126
v_smfmac_f32_16x16x64_bf16 v[52:55], v[28:31], a[16:23], v126
v_smfmac_f32_16x16x64_bf16 v[56:59], v[28:31], a[24:31], v126
v_smfmac_f32_16x16x64_bf16 v[60:63], v[28:31], v[128:135], v126
v_smfmac_f32_16x16x64_bf16 v[64:67], v[28:31], v[136:143], v126
s_branch Lps_298
Lpf_287:
buffer_load_dwordx4 v[40:43], v8, s[4:7], s40 offen offset:3072 sc1
v_mfma_f32_16x16x32_bf16 v[16:19], v[20:23], v[20:23], 0
Lps_312:
s_waitcnt vmcnt(1)
v_max3_u32 v26, v28, v29, v30
v_max_u32 v26, v26, v31
v_cmp_eq_u32 vcc, -1, v26
s_cbranch_vccnz Lpf_313
v_smfmac_f32_16x16x64_bf16 v[44:47], v[28:31], a[0:7], v126
v_smfmac_f32_16x16x64_bf16 v[48:51], v[28:31], a[8:15], v126
v_smfmac_f32_16x16x64_bf16 v[52:55], v[28:31], a[16:23], v126
v_smfmac_f32_16x16x64_bf16 v[56:59], v[28:31], a[24:31], v126
v_smfmac_f32_16x16x64_bf16 v[60:63], v[28:31], v[128:135], v126
v_smfmac_f32_16x16x64_bf16 v[64:67], v[28:31], v[136:143], v126
s_branch Lps_300
Lpf_289:
buffer_load_dwordx4 v[28:31], v8, s[4:7], s40 offen offset:0 sc1
v_mfma_f32_16x16x32_bf16 v[16:19], v[20:23], v[20:23], 0
s_sub_u32 s37, s37, 1
s_cbranch_scc1 Lend_8
s_branch Lps_288
Lpf_291:
buffer_load_dwordx4 v[36:39], v8, s[4:7], s40 offen offset:2048 sc1
v_mfma_f32_16x16x32_bf16 v[16:19], v[20:23], v[20:23], 0
Lps_314:
s_waitcnt vmcnt(2)
v_max3_u32 v26, v40, v41, v42
v_max_u32 v26, v26, v43
v_cmp_eq_u32 vcc, -1, v26
s_cbranch_vccnz Lpf_315
v_smfmac_f32_16x16x64_bf16 v[44:47], v[40:43], a[96:103], v126
v_smfmac_f32_16x16x64_bf16 v[48:51], v[40:43], a[104:111], v126
v_smfmac_f32_16x16x64_bf16 v[52:55], v[40:43], a[112:119], v126
v_smfmac_f32_16x16x64_bf16 v[56:59], v[40:43], a[120:127], v126
v_smfmac_f32_16x16x64_bf16 v[60:63], v[40:43], v[224:231], v126
v_smfmac_f32_16x16x64_bf16 v[64:67], v[40:43], v[232:239], v126
Lps_316:
s_waitcnt vmcnt(1)
v_max3_u32 v26, v32, v33, v34
v_max_u32 v26, v26, v35
v_cmp_eq_u32 vcc, -1, v26
s_cbranch_vccnz Lpf_317
v_smfmac_f32_16x16x64_bf16 v[44:47], v[32:35], a[32:39], v126
v_smfmac_f32_16x16x64_bf16 v[48:51], v[32:35], a[40:47], v126
v_smfmac_f32_16x16x64_bf16 v[52:55], v[32:35], a[48:55], v126
v_smfmac_f32_16x16x64_bf16 v[56:59], v[32:35], a[56:63], v126
v_smfmac_f32_16x16x64_bf16 v[60:63], v[32:35], v[160:167], v126
v_smfmac_f32_16x16x64_bf16 v[64:67], v[32:35], v[168:175], v126
s_branch Lps_298
Lpf_293:
buffer_load_dwordx4 v[40:43], v8, s[4:7], s40 offen offset:3072 sc1
v_mfma_f32_16x16x32_bf16 v[16:19], v[20:23], v[20:23], 0
Lps_318:
s_waitcnt vmcnt(1)
v_max3_u32 v26, v32, v33, v34
v_max_u32 v26, v26, v35
v_cmp_eq_u32 vcc, -1, v26
s_cbranch_vccnz Lpf_319
v_smfmac_f32_16x16x64_bf16 v[44:47], v[32:35], a[32:39], v126
v_smfmac_f32_16x16x64_bf16 v[48:51], v[32:35], a[40:47], v126
v_smfmac_f32_16x16x64_bf16 v[52:55], v[32:35], a[48:55], v126
v_smfmac_f32_16x16x64_bf16 v[56:59], v[32:35], a[56:63], v126
v_smfmac_f32_16x16x64_bf16 v[60:63], v[32:35], v[160:167], v126
v_smfmac_f32_16x16x64_bf16 v[64:67], v[32:35], v[168:175], v126
s_branch Lps_300
Lpf_295:
buffer_load_dwordx4 v[32:35], v8, s[4:7], s40 offen offset:1024 sc1
v_mfma_f32_16x16x32_bf16 v[16:19], v[20:23], v[20:23], 0
s_sub_u32 s37, s37, 1
s_cbranch_scc1 Lend_8
s_branch Lps_294
Lpf_297:
buffer_load_dwordx4 v[40:43], v8, s[4:7], s40 offen offset:3072 sc1
v_mfma_f32_16x16x32_bf16 v[16:19], v[20:23], v[20:23], 0
Lps_320:
s_waitcnt vmcnt(1)
v_max3_u32 v26, v36, v37, v38
v_max_u32 v26, v26, v39
v_cmp_eq_u32 vcc, -1, v26
s_cbranch_vccnz Lpf_321
v_smfmac_f32_16x16x64_bf16 v[44:47], v[36:39], a[64:71], v126
v_smfmac_f32_16x16x64_bf16 v[48:51], v[36:39], a[72:79], v126
v_smfmac_f32_16x16x64_bf16 v[52:55], v[36:39], a[80:87], v126
v_smfmac_f32_16x16x64_bf16 v[56:59], v[36:39], a[88:95], v126
v_smfmac_f32_16x16x64_bf16 v[60:63], v[36:39], v[192:199], v126
v_smfmac_f32_16x16x64_bf16 v[64:67], v[36:39], v[200:207], v126
s_branch Lps_300
Lpf_299:
buffer_load_dwordx4 v[36:39], v8, s[4:7], s40 offen offset:2048 sc1
v_mfma_f32_16x16x32_bf16 v[16:19], v[20:23], v[20:23], 0
s_sub_u32 s37, s37, 1
s_cbranch_scc1 Lend_8
s_branch Lps_298
Lpf_301:
buffer_load_dwordx4 v[40:43], v8, s[4:7], s40 offen offset:3072 sc1
v_mfma_f32_16x16x32_bf16 v[16:19], v[20:23], v[20:23], 0
s_sub_u32 s37, s37, 1
s_cbranch_scc1 Lend_8
s_branch Lps_300
Lpf_303:
buffer_load_dwordx4 v[36:39], v8, s[4:7], s40 offen offset:2048 sc1
v_mfma_f32_16x16x32_bf16 v[16:19], v[20:23], v[20:23], 0
Lps_322:
s_waitcnt vmcnt(3)
v_max3_u32 v26, v40, v41, v42
v_max_u32 v26, v26, v43
v_cmp_eq_u32 vcc, -1, v26
s_cbranch_vccnz Lpf_323
v_smfmac_f32_16x16x64_bf16 v[44:47], v[40:43], a[96:103], v126
v_smfmac_f32_16x16x64_bf16 v[48:51], v[40:43], a[104:111], v126
v_smfmac_f32_16x16x64_bf16 v[52:55], v[40:43], a[112:119], v126
v_smfmac_f32_16x16x64_bf16 v[56:59], v[40:43], a[120:127], v126
v_smfmac_f32_16x16x64_bf16 v[60:63], v[40:43], v[224:231], v126
v_smfmac_f32_16x16x64_bf16 v[64:67], v[40:43], v[232:239], v126
Lps_324:
s_waitcnt vmcnt(2)
v_max3_u32 v26, v28, v29, v30
v_max_u32 v26, v26, v31
v_cmp_eq_u32 vcc, -1, v26
s_cbranch_vccnz Lpf_325
v_smfmac_f32_16x16x64_bf16 v[44:47], v[28:31], a[0:7], v126
v_smfmac_f32_16x16x64_bf16 v[48:51], v[28:31], a[8:15], v126
v_smfmac_f32_16x16x64_bf16 v[52:55], v[28:31], a[16:23], v126
v_smfmac_f32_16x16x64_bf16 v[56:59], v[28:31], a[24:31], v126
v_smfmac_f32_16x16x64_bf16 v[60:63], v[28:31], v[128:135], v126
v_smfmac_f32_16x16x64_bf16 v[64:67], v[28:31], v[136:143], v126
s_branch Lps_316
Lpf_305:
buffer_load_dwordx4 v[40:43], v8, s[4:7], s40 offen offset:3072 sc1
v_mfma_f32_16x16x32_bf16 v[16:19], v[20:23], v[20:23], 0
Lps_326:
s_waitcnt vmcnt(2)
v_max3_u32 v26, v28, v29, v30
v_max_u32 v26, v26, v31
v_cmp_eq_u32 vcc, -1, v26
s_cbranch_vccnz Lpf_327
v_smfmac_f32_16x16x64_bf16 v[44:47], v[28:31], a[0:7], v126
v_smfmac_f32_16x16x64_bf16 v[48:51], v[28:31], a[8:15], v126
v_smfmac_f32_16x16x64_bf16 v[52:55], v[28:31], a[16:23], v126
v_smfmac_f32_16x16x64_bf16 v[56:59], v[28:31], a[24:31], v126
v_smfmac_f32_16x16x64_bf16 v[60:63], v[28:31], v[128:135], v126
v_smfmac_f32_16x16x64_bf16 v[64:67], v[28:31], v[136:143], v126
s_branch Lps_318
Lpf_307:
buffer_load_dwordx4 v[28:31], v8, s[4:7], s40 offen offset:0 sc1
v_mfma_f32_16x16x32_bf16 v[16:19], v[20:23], v[20:23], 0
s_sub_u32 s37, s37, 1
s_cbranch_scc1 Lend_8
Lps_328:
s_waitcnt vmcnt(1)
v_max3_u32 v26, v32, v33, v34
v_max_u32 v26, v26, v35
v_cmp_eq_u32 vcc, -1, v26
s_cbranch_vccnz Lpf_329
v_smfmac_f32_16x16x64_bf16 v[44:47], v[32:35], a[32:39], v126
v_smfmac_f32_16x16x64_bf16 v[48:51], v[32:35], a[40:47], v126
v_smfmac_f32_16x16x64_bf16 v[52:55], v[32:35], a[48:55], v126
v_smfmac_f32_16x16x64_bf16 v[56:59], v[32:35], a[56:63], v126
v_smfmac_f32_16x16x64_bf16 v[60:63], v[32:35], v[160:167], v126
v_smfmac_f32_16x16x64_bf16 v[64:67], v[32:35], v[168:175], v126
s_branch Lps_288
Lpf_309:
buffer_load_dwordx4 v[40:43], v8, s[4:7], s40 offen offset:3072 sc1
v_mfma_f32_16x16x32_bf16 v[16:19], v[20:23], v[20:23], 0
Lps_330:
s_waitcnt vmcnt(2)
v_max3_u32 v26, v28, v29, v30
v_max_u32 v26, v26, v31
v_cmp_eq_u32 vcc, -1, v26
s_cbranch_vccnz Lpf_331
v_smfmac_f32_16x16x64_bf16 v[44:47], v[28:31], a[0:7], v126
v_smfmac_f32_16x16x64_bf16 v[48:51], v[28:31], a[8:15], v126
v_smfmac_f32_16x16x64_bf16 v[52:55], v[28:31], a[16:23], v126
v_smfmac_f32_16x16x64_bf16 v[56:59], v[28:31], a[24:31], v126
v_smfmac_f32_16x16x64_bf16 v[60:63], v[28:31], v[128:135], v126
v_smfmac_f32_16x16x64_bf16 v[64:67], v[28:31], v[136:143], v126
s_branch Lps_320
Lpf_311:
buffer_load_dwordx4 v[28:31], v8, s[4:7], s40 offen offset:0 sc1
v_mfma_f32_16x16x32_bf16 v[16:19], v[20:23], v[20:23], 0
s_sub_u32 s37, s37, 1
s_cbranch_scc1 Lend_8
Lps_332:
s_waitcnt vmcnt(1)
v_max3_u32 v26, v36, v37, v38
v_max_u32 v26, v26, v39
v_cmp_eq_u32 vcc, -1, v26
s_cbranch_vccnz Lpf_333
v_smfmac_f32_16x16x64_bf16 v[44:47], v[36:39], a[64:71], v126
v_smfmac_f32_16x16x64_bf16 v[48:51], v[36:39], a[72:79], v126
v_smfmac_f32_16x16x64_bf16 v[52:55], v[36:39], a[80:87], v126
v_smfmac_f32_16x16x64_bf16 v[56:59], v[36:39], a[88:95], v126
v_smfmac_f32_16x16x64_bf16 v[60:63], v[36:39], v[192:199], v126
v_smfmac_f32_16x16x64_bf16 v[64:67], v[36:39], v[200:207], v126
s_branch Lps_288
Lpf_313:
buffer_load_dwordx4 v[28:31], v8, s[4:7], s40 offen offset:0 sc1
v_mfma_f32_16x16x32_bf16 v[16:19], v[20:23], v[20:23], 0
s_sub_u32 s37, s37, 1
s_cbranch_scc1 Lend_8
s_branch Lps_286
Lpf_315:
buffer_load_dwordx4 v[40:43], v8, s[4:7], s40 offen offset:3072 sc1
v_mfma_f32_16x16x32_bf16 v[16:19], v[20:23], v[20:23], 0
Lps_334:
s_waitcnt vmcnt(2)
v_max3_u32 v26, v32, v33, v34
v_max_u32 v26, v26, v35
v_cmp_eq_u32 vcc, -1, v26
s_cbranch_vccnz Lpf_335
v_smfmac_f32_16x16x64_bf16 v[44:47], v[32:35], a[32:39], v126
v_smfmac_f32_16x16x64_bf16 v[48:51], v[32:35], a[40:47], v126
v_smfmac_f32_16x16x64_bf16 v[52:55], v[32:35], a[48:55], v126
v_smfmac_f32_16x16x64_bf16 v[56:59], v[32:35], a[56:63], v126
v_smfmac_f32_16x16x64_bf16 v[60:63], v[32:35], v[160:167], v126
v_smfmac_f32_16x16x64_bf16 v[64:67], v[32:35], v[168:175], v126
s_branch Lps_320
Lpf_317:
buffer_load_dwordx4 v[32:35], v8, s[4:7], s40 offen offset:1024 sc1
v_mfma_f32_16x16x32_bf16 v[16:19], v[20:23], v[20:23], 0
s_sub_u32 s37, s37, 1
s_cbranch_scc1 Lend_8
Lps_336:
s_waitcnt vmcnt(1)
v_max3_u32 v26, v36, v37, v38
v_max_u32 v26, v26, v39
v_cmp_eq_u32 vcc, -1, v26
s_cbranch_vccnz Lpf_337
v_smfmac_f32_16x16x64_bf16 v[44:47], v[36:39], a[64:71], v126
v_smfmac_f32_16x16x64_bf16 v[48:51], v[36:39], a[72:79], v126
v_smfmac_f32_16x16x64_bf16 v[52:55], v[36:39], a[80:87], v126
v_smfmac_f32_16x16x64_bf16 v[56:59], v[36:39], a[88:95], v126
v_smfmac_f32_16x16x64_bf16 v[60:63], v[36:39], v[192:199], v126
v_smfmac_f32_16x16x64_bf16 v[64:67], v[36:39], v[200:207], v126
s_branch Lps_294
Lpf_319:
buffer_load_dwordx4 v[32:35], v8, s[4:7], s40 offen offset:1024 sc1
v_mfma_f32_16x16x32_bf16 v[16:19], v[20:23], v[20:23], 0
s_sub_u32 s37, s37, 1
s_cbranch_scc1 Lend_8
s_branch Lps_292
Lpf_321:
buffer_load_dwordx4 v[36:39], v8, s[4:7], s40 offen offset:2048 sc1
v_mfma_f32_16x16x32_bf16 v[16:19], v[20:23], v[20:23], 0
s_sub_u32 s37, s37, 1
s_cbranch_scc1 Lend_8
s_branch Lps_296
Lpf_323:
buffer_load_dwordx4 v[40:43], v8, s[4:7], s40 offen offset:3072 sc1
v_mfma_f32_16x16x32_bf16 v[16:19], v[20:23], v[20:23], 0
Lps_338:
s_waitcnt vmcnt(3)
v_max3_u32 v26, v28, v29, v30
v_max_u32 v26, v26, v31
v_cmp_eq_u32 vcc, -1, v26
s_cbranch_vccnz Lpf_339
v_smfmac_f32_16x16x64_bf16 v[44:47], v[28:31], a[0:7], v126
v_smfmac_f32_16x16x64_bf16 v[48:51], v[28:31], a[8:15], v126
v_smfmac_f32_16x16x64_bf16 v[52:55], v[28:31], a[16:23], v126
v_smfmac_f32_16x16x64_bf16 v[56:59], v[28:31], a[24:31], v126
v_smfmac_f32_16x16x64_bf16 v[60:63], v[28:31], v[128:135], v126
v_smfmac_f32_16x16x64_bf16 v[64:67], v[28:31], v[136:143], v126
s_branch Lps_334
Lpf_325:
buffer_load_dwordx4 v[28:31], v8, s[4:7], s40 offen offset:0 sc1
v_mfma_f32_16x16x32_bf16 v[16:19], v[20:23], v[20:23], 0
s_sub_u32 s37, s37, 1
s_cbranch_scc1 Lend_8
Lps_340:
s_waitcnt vmcnt(2)
v_max3_u32 v26, v32, v33, v34
v_max_u32 v26, v26, v35
v_cmp_eq_u32 vcc, -1, v26
s_cbranch_vccnz Lpf_341
v_smfmac_f32_16x16x64_bf16 v[44:47], v[32:35], a[32:39], v126
v_smfmac_f32_16x16x64_bf16 v[48:51], v[32:35], a[40:47], v126
v_smfmac_f32_16x16x64_bf16 v[52:55], v[32:35], a[48:55], v126
v_smfmac_f32_16x16x64_bf16 v[56:59], v[32:35], a[56:63], v126
v_smfmac_f32_16x16x64_bf16 v[60:63], v[32:35], v[160:167], v126
v_smfmac_f32_16x16x64_bf16 v[64:67], v[32:35], v[168:175], v126
s_branch Lps_332
Lpf_327:
buffer_load_dwordx4 v[28:31], v8, s[4:7], s40 offen offset:0 sc1
v_mfma_f32_16x16x32_bf16 v[16:19], v[20:23], v[20:23], 0
s_sub_u32 s37, s37, 1
s_cbranch_scc1 Lend_8
Lps_342:
s_waitcnt vmcnt(2)
v_max3_u32 v26, v32, v33, v34
v_max_u32 v26, v26, v35
v_cmp_eq_u32 vcc, -1, v26
s_cbranch_vccnz Lpf_343
v_smfmac_f32_16x16x64_bf16 v[44:47], v[32:35], a[32:39], v126
v_smfmac_f32_16x16x64_bf16 v[48:51], v[32:35], a[40:47], v126
v_smfmac_f32_16x16x64_bf16 v[52:55], v[32:35], a[48:55], v126
v_smfmac_f32_16x16x64_bf16 v[56:59], v[32:35], a[56:63], v126
v_smfmac_f32_16x16x64_bf16 v[60:63], v[32:35], v[160:167], v126
v_smfmac_f32_16x16x64_bf16 v[64:67], v[32:35], v[168:175], v126
s_branch Lps_286
Lpf_329:
buffer_load_dwordx4 v[32:35], v8, s[4:7], s40 offen offset:1024 sc1
v_mfma_f32_16x16x32_bf16 v[16:19], v[20:23], v[20:23], 0
s_branch Lps_306
Lpf_331:
buffer_load_dwordx4 v[28:31], v8, s[4:7], s40 offen offset:0 sc1
v_mfma_f32_16x16x32_bf16 v[16:19], v[20:23], v[20:23], 0
s_sub_u32 s37, s37, 1
s_cbranch_scc1 Lend_8
s_branch Lps_284
Lpf_333:
buffer_load_dwordx4 v[36:39], v8, s[4:7], s40 offen offset:2048 sc1
v_mfma_f32_16x16x32_bf16 v[16:19], v[20:23], v[20:23], 0
s_branch Lps_310
Lpf_335:
buffer_load_dwordx4 v[32:35], v8, s[4:7], s40 offen offset:1024 sc1
v_mfma_f32_16x16x32_bf16 v[16:19], v[20:23], v[20:23], 0
s_sub_u32 s37, s37, 1
s_cbranch_scc1 Lend_8
s_branch Lps_290
Lpf_337:
buffer_load_dwordx4 v[36:39], v8, s[4:7], s40 offen offset:2048 sc1
v_mfma_f32_16x16x32_bf16 v[16:19], v[20:23], v[20:23], 0
s_branch Lps_316
Lpf_339:
buffer_load_dwordx4 v[28:31], v8, s[4:7], s40 offen offset:0 sc1
v_mfma_f32_16x16x32_bf16 v[16:19], v[20:23], v[20:23], 0
s_sub_u32 s37, s37, 1
s_cbranch_scc1 Lend_8
s_branch Lps_282
Lpf_341:
buffer_load_dwordx4 v[32:35], v8, s[4:7], s40 offen offset:1024 sc1
v_mfma_f32_16x16x32_bf16 v[16:19], v[20:23], v[20:23], 0
Lps_344:
s_waitcnt vmcnt(2)
v_max3_u32 v26, v36, v37, v38
v_max_u32 v26, v26, v39
v_cmp_eq_u32 vcc, -1, v26
s_cbranch_vccnz Lpf_345
v_smfmac_f32_16x16x64_bf16 v[44:47], v[36:39], a[64:71], v126
v_smfmac_f32_16x16x64_bf16 v[48:51], v[36:39], a[72:79], v126
v_smfmac_f32_16x16x64_bf16 v[52:55], v[36:39], a[80:87], v126
v_smfmac_f32_16x16x64_bf16 v[56:59], v[36:39], a[88:95], v126
v_smfmac_f32_16x16x64_bf16 v[60:63], v[36:39], v[192:199], v126
v_smfmac_f32_16x16x64_bf16 v[64:67], v[36:39], v[200:207], v126
s_branch Lps_306
Lpf_343:
buffer_load_dwordx4 v[32:35], v8, s[4:7], s40 offen offset:1024 sc1
v_mfma_f32_16x16x32_bf16 v[16:19], v[20:23], v[20:23], 0
s_branch Lps_304
Lpf_345:
buffer_load_dwordx4 v[36:39], v8, s[4:7], s40 offen offset:2048 sc1
v_mfma_f32_16x16x32_bf16 v[16:19], v[20:23], v[20:23], 0
s_branch Lps_324
Lpf_275:
buffer_load_dwordx4 v[28:31], v9, s[4:7], s40 offen offset:0 sc1
v_mfma_f32_16x16x32_bf16 v[16:19], v[20:23], v[20:23], 0
s_sub_u32 s37, s37, 1
s_cbranch_scc1 Lend_8
Lps_346:
s_waitcnt vmcnt(3)
v_max3_u32 v26, v32, v33, v34
v_max_u32 v26, v26, v35
v_cmp_eq_u32 vcc, -1, v26
s_cbranch_vccnz Lpf_347
v_smfmac_f32_16x16x64_bf16 v[76:79], v[32:35], a[160:167], v126
v_smfmac_f32_16x16x64_bf16 v[80:83], v[32:35], a[168:175], v126
v_smfmac_f32_16x16x64_bf16 v[84:87], v[32:35], a[176:183], v126
v_smfmac_f32_16x16x64_bf16 v[88:91], v[32:35], a[184:191], v126
Lps_348:
s_waitcnt vmcnt(2)
v_max3_u32 v26, v36, v37, v38
v_max_u32 v26, v26, v39
v_cmp_eq_u32 vcc, -1, v26
s_cbranch_vccnz Lpf_349
v_smfmac_f32_16x16x64_bf16 v[76:79], v[36:39], a[192:199], v126
v_smfmac_f32_16x16x64_bf16 v[80:83], v[36:39], a[200:207], v126
v_smfmac_f32_16x16x64_bf16 v[84:87], v[36:39], a[208:215], v126
v_smfmac_f32_16x16x64_bf16 v[88:91], v[36:39], a[216:223], v126
Lps_350:
s_waitcnt vmcnt(1)
v_max3_u32 v26, v40, v41, v42
v_max_u32 v26, v26, v43
v_cmp_eq_u32 vcc, -1, v26
s_cbranch_vccnz Lpf_351
v_smfmac_f32_16x16x64_bf16 v[76:79], v[40:43], a[224:231], v126
v_smfmac_f32_16x16x64_bf16 v[80:83], v[40:43], a[232:239], v126
v_smfmac_f32_16x16x64_bf16 v[84:87], v[40:43], a[240:247], v126
v_smfmac_f32_16x16x64_bf16 v[88:91], v[40:43], a[248:255], v126
Lps_352:
s_waitcnt vmcnt(0)
v_max3_u32 v26, v28, v29, v30
v_max_u32 v26, v26, v31
v_cmp_eq_u32 vcc, -1, v26
s_cbranch_vccnz Lpf_353
v_smfmac_f32_16x16x64_bf16 v[76:79], v[28:31], a[128:135], v126
v_smfmac_f32_16x16x64_bf16 v[80:83], v[28:31], a[136:143], v126
v_smfmac_f32_16x16x64_bf16 v[84:87], v[28:31], a[144:151], v126
v_smfmac_f32_16x16x64_bf16 v[88:91], v[28:31], a[152:159], v126
s_branch Lpd_274
Lpf_276:
buffer_load_dwordx4 v[32:35], v9, s[4:7], s40 offen offset:1024 sc1
v_mfma_f32_16x16x32_bf16 v[16:19], v[20:23], v[20:23], 0
s_sub_u32 s37, s37, 1
s_cbranch_scc1 Lend_8
Lps_354:
s_waitcnt vmcnt(2)
v_max3_u32 v26, v36, v37, v38
v_max_u32 v26, v26, v39
v_cmp_eq_u32 vcc, -1, v26
s_cbranch_vccnz Lpf_355
v_smfmac_f32_16x16x64_bf16 v[76:79], v[36:39], a[192:199], v126
v_smfmac_f32_16x16x64_bf16 v[80:83], v[36:39], a[200:207], v126
v_smfmac_f32_16x16x64_bf16 v[84:87], v[36:39], a[208:215], v126
v_smfmac_f32_16x16x64_bf16 v[88:91], v[36:39], a[216:223], v126
Lps_356:
s_waitcnt vmcnt(1)
v_max3_u32 v26, v40, v41, v42
v_max_u32 v26, v26, v43
v_cmp_eq_u32 vcc, -1, v26
s_cbranch_vccnz Lpf_357
v_smfmac_f32_16x16x64_bf16 v[76:79], v[40:43], a[224:231], v126
v_smfmac_f32_16x16x64_bf16 v[80:83], v[40:43], a[232:239], v126
v_smfmac_f32_16x16x64_bf16 v[84:87], v[40:43], a[240:247], v126
v_smfmac_f32_16x16x64_bf16 v[88:91], v[40:43], a[248:255], v126
Lps_358:
s_waitcnt vmcnt(0)
v_max3_u32 v26, v32, v33, v34
v_max_u32 v26, v26, v35
v_cmp_eq_u32 vcc, -1, v26
s_cbranch_vccnz Lpf_359
v_smfmac_f32_16x16x64_bf16 v[76:79], v[32:35], a[160:167], v126
v_smfmac_f32_16x16x64_bf16 v[80:83], v[32:35], a[168:175], v126
v_smfmac_f32_16x16x64_bf16 v[84:87], v[32:35], a[176:183], v126
v_smfmac_f32_16x16x64_bf16 v[88:91], v[32:35], a[184:191], v126
s_branch Lpd_274
Lpf_277:
buffer_load_dwordx4 v[36:39], v9, s[4:7], s40 offen offset:2048 sc1
v_mfma_f32_16x16x32_bf16 v[16:19], v[20:23], v[20:23], 0
s_sub_u32 s37, s37, 1
s_cbranch_scc1 Lend_8
Lps_360:
s_waitcnt vmcnt(1)
v_max3_u32 v26, v40, v41, v42
v_max_u32 v26, v26, v43
v_cmp_eq_u32 vcc, -1, v26
s_cbranch_vccnz Lpf_361
v_smfmac_f32_16x16x64_bf16 v[76:79], v[40:43], a[224:231], v126
v_smfmac_f32_16x16x64_bf16 v[80:83], v[40:43], a[232:239], v126
v_smfmac_f32_16x16x64_bf16 v[84:87], v[40:43], a[240:247], v126
v_smfmac_f32_16x16x64_bf16 v[88:91], v[40:43], a[248:255], v126
Lps_362:
s_waitcnt vmcnt(0)
v_max3_u32 v26, v36, v37, v38
v_max_u32 v26, v26, v39
v_cmp_eq_u32 vcc, -1, v26
s_cbranch_vccnz Lpf_363
v_smfmac_f32_16x16x64_bf16 v[76:79], v[36:39], a[192:199], v126
v_smfmac_f32_16x16x64_bf16 v[80:83], v[36:39], a[200:207], v126
v_smfmac_f32_16x16x64_bf16 v[84:87], v[36:39], a[208:215], v126
v_smfmac_f32_16x16x64_bf16 v[88:91], v[36:39], a[216:223], v126
s_branch Lpd_274
Lpf_278:
buffer_load_dwordx4 v[40:43], v9, s[4:7], s40 offen offset:3072 sc1
v_mfma_f32_16x16x32_bf16 v[16:19], v[20:23], v[20:23], 0
s_sub_u32 s37, s37, 1
s_cbranch_scc1 Lend_8
Lps_364:
s_waitcnt vmcnt(0)
v_max3_u32 v26, v40, v41, v42
v_max_u32 v26, v26, v43
v_cmp_eq_u32 vcc, -1, v26
s_cbranch_vccnz Lpf_365
v_smfmac_f32_16x16x64_bf16 v[76:79], v[40:43], a[224:231], v126
v_smfmac_f32_16x16x64_bf16 v[80:83], v[40:43], a[232:239], v126
v_smfmac_f32_16x16x64_bf16 v[84:87], v[40:43], a[240:247], v126
v_smfmac_f32_16x16x64_bf16 v[88:91], v[40:43], a[248:255], v126
s_branch Lpd_274
Lpf_347:
buffer_load_dwordx4 v[32:35], v9, s[4:7], s40 offen offset:1024 sc1
v_mfma_f32_16x16x32_bf16 v[16:19], v[20:23], v[20:23], 0
Lps_366:
s_waitcnt vmcnt(3)
v_max3_u32 v26, v36, v37, v38
v_max_u32 v26, v26, v39
v_cmp_eq_u32 vcc, -1, v26
s_cbranch_vccnz Lpf_367
v_smfmac_f32_16x16x64_bf16 v[76:79], v[36:39], a[192:199], v126
v_smfmac_f32_16x16x64_bf16 v[80:83], v[36:39], a[200:207], v126
v_smfmac_f32_16x16x64_bf16 v[84:87], v[36:39], a[208:215], v126
v_smfmac_f32_16x16x64_bf16 v[88:91], v[36:39], a[216:223], v126
Lps_368:
s_waitcnt vmcnt(2)
v_max3_u32 v26, v40, v41, v42
v_max_u32 v26, v26, v43
v_cmp_eq_u32 vcc, -1, v26
s_cbranch_vccnz Lpf_369
v_smfmac_f32_16x16x64_bf16 v[76:79], v[40:43], a[224:231], v126
v_smfmac_f32_16x16x64_bf16 v[80:83], v[40:43], a[232:239], v126
v_smfmac_f32_16x16x64_bf16 v[84:87], v[40:43], a[240:247], v126
v_smfmac_f32_16x16x64_bf16 v[88:91], v[40:43], a[248:255], v126
Lps_370:
s_waitcnt vmcnt(1)
v_max3_u32 v26, v28, v29, v30
v_max_u32 v26, v26, v31
v_cmp_eq_u32 vcc, -1, v26
s_cbranch_vccnz Lpf_371
v_smfmac_f32_16x16x64_bf16 v[76:79], v[28:31], a[128:135], v126
v_smfmac_f32_16x16x64_bf16 v[80:83], v[28:31], a[136:143], v126
v_smfmac_f32_16x16x64_bf16 v[84:87], v[28:31], a[144:151], v126
v_smfmac_f32_16x16x64_bf16 v[88:91], v[28:31], a[152:159], v126
s_branch Lps_358
Lpf_349:
buffer_load_dwordx4 v[36:39], v9, s[4:7], s40 offen offset:2048 sc1
v_mfma_f32_16x16x32_bf16 v[16:19], v[20:23], v[20:23], 0
Lps_372:
s_waitcnt vmcnt(2)
v_max3_u32 v26, v40, v41, v42
v_max_u32 v26, v26, v43
v_cmp_eq_u32 vcc, -1, v26
s_cbranch_vccnz Lpf_373
v_smfmac_f32_16x16x64_bf16 v[76:79], v[40:43], a[224:231], v126
v_smfmac_f32_16x16x64_bf16 v[80:83], v[40:43], a[232:239], v126
v_smfmac_f32_16x16x64_bf16 v[84:87], v[40:43], a[240:247], v126
v_smfmac_f32_16x16x64_bf16 v[88:91], v[40:43], a[248:255], v126
Lps_374:
s_waitcnt vmcnt(1)
v_max3_u32 v26, v28, v29, v30
v_max_u32 v26, v26, v31
v_cmp_eq_u32 vcc, -1, v26
s_cbranch_vccnz Lpf_375
v_smfmac_f32_16x16x64_bf16 v[76:79], v[28:31], a[128:135], v126
v_smfmac_f32_16x16x64_bf16 v[80:83], v[28:31], a[136:143], v126
v_smfmac_f32_16x16x64_bf16 v[84:87], v[28:31], a[144:151], v126
v_smfmac_f32_16x16x64_bf16 v[88:91], v[28:31], a[152:159], v126
s_branch Lps_362
Lpf_351:
buffer_load_dwordx4 v[40:43], v9, s[4:7], s40 offen offset:3072 sc1
v_mfma_f32_16x16x32_bf16 v[16:19], v[20:23], v[20:23], 0
Lps_376:
s_waitcnt vmcnt(1)
v_max3_u32 v26, v28, v29, v30
v_max_u32 v26, v26, v31
v_cmp_eq_u32 vcc, -1, v26
s_cbranch_vccnz Lpf_377
v_smfmac_f32_16x16x64_bf16 v[76:79], v[28:31], a[128:135], v126
v_smfmac_f32_16x16x64_bf16 v[80:83], v[28:31], a[136:143], v126
v_smfmac_f32_16x16x64_bf16 v[84:87], v[28:31], a[144:151], v126
v_smfmac_f32_16x16x64_bf16 v[88:91], v[28:31], a[152:159], v126
s_branch Lps_364
Lpf_353:
buffer_load_dwordx4 v[28:31], v9, s[4:7], s40 offen offset:0 sc1
v_mfma_f32_16x16x32_bf16 v[16:19], v[20:23], v[20:23], 0
s_sub_u32 s37, s37, 1
s_cbranch_scc1 Lend_8
s_branch Lps_352
Lpf_355:
buffer_load_dwordx4 v[36:39], v9, s[4:7], s40 offen offset:2048 sc1
v_mfma_f32_16x16x32_bf16 v[16:19], v[20:23], v[20:23], 0
Lps_378:
s_waitcnt vmcnt(2)
v_max3_u32 v26, v40, v41, v42
v_max_u32 v26, v26, v43
v_cmp_eq_u32 vcc, -1, v26
s_cbranch_vccnz Lpf_379
v_smfmac_f32_16x16x64_bf16 v[76:79], v[40:43], a[224:231], v126
v_smfmac_f32_16x16x64_bf16 v[80:83], v[40:43], a[232:239], v126
v_smfmac_f32_16x16x64_bf16 v[84:87], v[40:43], a[240:247], v126
v_smfmac_f32_16x16x64_bf16 v[88:91], v[40:43], a[248:255], v126
Lps_380:
s_waitcnt vmcnt(1)
v_max3_u32 v26, v32, v33, v34
v_max_u32 v26, v26, v35
v_cmp_eq_u32 vcc, -1, v26
s_cbranch_vccnz Lpf_381
v_smfmac_f32_16x16x64_bf16 v[76:79], v[32:35], a[160:167], v126
v_smfmac_f32_16x16x64_bf16 v[80:83], v[32:35], a[168:175], v126
v_smfmac_f32_16x16x64_bf16 v[84:87], v[32:35], a[176:183], v126
v_smfmac_f32_16x16x64_bf16 v[88:91], v[32:35], a[184:191], v126
s_branch Lps_362
Lpf_357:
buffer_load_dwordx4 v[40:43], v9, s[4:7], s40 offen offset:3072 sc1
v_mfma_f32_16x16x32_bf16 v[16:19], v[20:23], v[20:23], 0
Lps_382:
s_waitcnt vmcnt(1)
v_max3_u32 v26, v32, v33, v34
v_max_u32 v26, v26, v35
v_cmp_eq_u32 vcc, -1, v26
s_cbranch_vccnz Lpf_383
v_smfmac_f32_16x16x64_bf16 v[76:79], v[32:35], a[160:167], v126
v_smfmac_f32_16x16x64_bf16 v[80:83], v[32:35], a[168:175], v126
v_smfmac_f32_16x16x64_bf16 v[84:87], v[32:35], a[176:183], v126
v_smfmac_f32_16x16x64_bf16 v[88:91], v[32:35], a[184:191], v126
s_branch Lps_364
Lpf_359:
buffer_load_dwordx4 v[32:35], v9, s[4:7], s40 offen offset:1024 sc1
v_mfma_f32_16x16x32_bf16 v[16:19], v[20:23], v[20:23], 0
s_sub_u32 s37, s37, 1
s_cbranch_scc1 Lend_8
s_branch Lps_358
Lpf_361:
buffer_load_dwordx4 v[40:43], v9, s[4:7], s40 offen offset:3072 sc1
v_mfma_f32_16x16x32_bf16 v[16:19], v[20:23], v[20:23], 0
Lps_384:
s_waitcnt vmcnt(1)
v_max3_u32 v26, v36, v37, v38
v_max_u32 v26, v26, v39
v_cmp_eq_u32 vcc, -1, v26
s_cbranch_vccnz Lpf_385
v_smfmac_f32_16x16x64_bf16 v[76:79], v[36:39], a[192:199], v126
v_smfmac_f32_16x16x64_bf16 v[80:83], v[36:39], a[200:207], v126
v_smfmac_f32_16x16x64_bf16 v[84:87], v[36:39], a[208:215], v126
v_smfmac_f32_16x16x64_bf16 v[88:91], v[36:39], a[216:223], v126
s_branch Lps_364
Lpf_363:
buffer_load_dwordx4 v[36:39], v9, s[4:7], s40 offen offset:2048 sc1
v_mfma_f32_16x16x32_bf16 v[16:19], v[20:23], v[20:23], 0
s_sub_u32 s37, s37, 1
s_cbranch_scc1 Lend_8
s_branch Lps_362
Lpf_365:
buffer_load_dwordx4 v[40:43], v9, s[4:7], s40 offen offset:3072 sc1
v_mfma_f32_16x16x32_bf16 v[16:19], v[20:23], v[20:23], 0
s_sub_u32 s37, s37, 1
s_cbranch_scc1 Lend_8
s_branch Lps_364
Lpf_367:
buffer_load_dwordx4 v[36:39], v9, s[4:7], s40 offen offset:2048 sc1
v_mfma_f32_16x16x32_bf16 v[16:19], v[20:23], v[20:23], 0
Lps_386:
s_waitcnt vmcnt(3)
v_max3_u32 v26, v40, v41, v42
v_max_u32 v26, v26, v43
v_cmp_eq_u32 vcc, -1, v26
s_cbranch_vccnz Lpf_387
v_smfmac_f32_16x16x64_bf16 v[76:79], v[40:43], a[224:231], v126
v_smfmac_f32_16x16x64_bf16 v[80:83], v[40:43], a[232:239], v126
v_smfmac_f32_16x16x64_bf16 v[84:87], v[40:43], a[240:247], v126
v_smfmac_f32_16x16x64_bf16 v[88:91], v[40:43], a[248:255], v126
Lps_388:
s_waitcnt vmcnt(2)
v_max3_u32 v26, v28, v29, v30
v_max_u32 v26, v26, v31
v_cmp_eq_u32 vcc, -1, v26
s_cbranch_vccnz Lpf_389
v_smfmac_f32_16x16x64_bf16 v[76:79], v[28:31], a[128:135], v126
v_smfmac_f32_16x16x64_bf16 v[80:83], v[28:31], a[136:143], v126
v_smfmac_f32_16x16x64_bf16 v[84:87], v[28:31], a[144:151], v126
v_smfmac_f32_16x16x64_bf16 v[88:91], v[28:31], a[152:159], v126
s_branch Lps_380
Lpf_369:
buffer_load_dwordx4 v[40:43], v9, s[4:7], s40 offen offset:3072 sc1
v_mfma_f32_16x16x32_bf16 v[16:19], v[20:23], v[20:23], 0
Lps_390:
s_waitcnt vmcnt(2)
v_max3_u32 v26, v28, v29, v30
v_max_u32 v26, v26, v31
v_cmp_eq_u32 vcc, -1, v26
s_cbranch_vccnz Lpf_391
v_smfmac_f32_16x16x64_bf16 v[76:79], v[28:31], a[128:135], v126
v_smfmac_f32_16x16x64_bf16 v[80:83], v[28:31], a[136:143], v126
v_smfmac_f32_16x16x64_bf16 v[84:87], v[28:31], a[144:151], v126
v_smfmac_f32_16x16x64_bf16 v[88:91], v[28:31], a[152:159], v126
s_branch Lps_382
Lpf_371:
buffer_load_dwordx4 v[28:31], v9, s[4:7], s40 offen offset:0 sc1
v_mfma_f32_16x16x32_bf16 v[16:19], v[20:23], v[20:23], 0
s_sub_u32 s37, s37, 1
s_cbranch_scc1 Lend_8
Lps_392:
s_waitcnt vmcnt(1)
v_max3_u32 v26, v32, v33, v34
v_max_u32 v26, v26, v35
v_cmp_eq_u32 vcc, -1, v26
s_cbranch_vccnz Lpf_393
v_smfmac_f32_16x16x64_bf16 v[76:79], v[32:35], a[160:167], v126
v_smfmac_f32_16x16x64_bf16 v[80:83], v[32:35], a[168:175], v126
v_smfmac_f32_16x16x64_bf16 v[84:87], v[32:35], a[176:183], v126
v_smfmac_f32_16x16x64_bf16 v[88:91], v[32:35], a[184:191], v126
s_branch Lps_352
Lpf_373:
buffer_load_dwordx4 v[40:43], v9, s[4:7], s40 offen offset:3072 sc1
v_mfma_f32_16x16x32_bf16 v[16:19], v[20:23], v[20:23], 0
Lps_394:
s_waitcnt vmcnt(2)
v_max3_u32 v26, v28, v29, v30
v_max_u32 v26, v26, v31
v_cmp_eq_u32 vcc, -1, v26
s_cbranch_vccnz Lpf_395
v_smfmac_f32_16x16x64_bf16 v[76:79], v[28:31], a[128:135], v126
v_smfmac_f32_16x16x64_bf16 v[80:83], v[28:31], a[136:143], v126
v_smfmac_f32_16x16x64_bf16 v[84:87], v[28:31], a[144:151], v126
v_smfmac_f32_16x16x64_bf16 v[88:91], v[28:31], a[152:159], v126
s_branch Lps_384
Lpf_375:
buffer_load_dwordx4 v[28:31], v9, s[4:7], s40 offen offset:0 sc1
v_mfma_f32_16x16x32_bf16 v[16:19], v[20:23], v[20:23], 0
s_sub_u32 s37, s37, 1
s_cbranch_scc1 Lend_8
Lps_396:
s_waitcnt vmcnt(1)
v_max3_u32 v26, v36, v37, v38
v_max_u32 v26, v26, v39
v_cmp_eq_u32 vcc, -1, v26
s_cbranch_vccnz Lpf_397
v_smfmac_f32_16x16x64_bf16 v[76:79], v[36:39], a[192:199], v126
v_smfmac_f32_16x16x64_bf16 v[80:83], v[36:39], a[200:207], v126
v_smfmac_f32_16x16x64_bf16 v[84:87], v[36:39], a[208:215], v126
v_smfmac_f32_16x16x64_bf16 v[88:91], v[36:39], a[216:223], v126
s_branch Lps_352
Lpf_377:
buffer_load_dwordx4 v[28:31], v9, s[4:7], s40 offen offset:0 sc1
v_mfma_f32_16x16x32_bf16 v[16:19], v[20:23], v[20:23], 0
s_sub_u32 s37, s37, 1
s_cbranch_scc1 Lend_8
s_branch Lps_350
Lpf_379:
buffer_load_dwordx4 v[40:43], v9, s[4:7], s40 offen offset:3072 sc1
v_mfma_f32_16x16x32_bf16 v[16:19], v[20:23], v[20:23], 0
Lps_398:
s_waitcnt vmcnt(2)
v_max3_u32 v26, v32, v33, v34
v_max_u32 v26, v26, v35
v_cmp_eq_u32 vcc, -1, v26
s_cbranch_vccnz Lpf_399
v_smfmac_f32_16x16x64_bf16 v[76:79], v[32:35], a[160:167], v126
v_smfmac_f32_16x16x64_bf16 v[80:83], v[32:35], a[168:175], v126
v_smfmac_f32_16x16x64_bf16 v[84:87], v[32:35], a[176:183], v126
v_smfmac_f32_16x16x64_bf16 v[88:91], v[32:35], a[184:191], v126
s_branch Lps_384
Lpf_381:
buffer_load_dwordx4 v[32:35], v9, s[4:7], s40 offen offset:1024 sc1
v_mfma_f32_16x16x32_bf16 v[16:19], v[20:23], v[20:23], 0
s_sub_u32 s37, s37, 1
s_cbranch_scc1 Lend_8
Lps_400:
s_waitcnt vmcnt(1)
v_max3_u32 v26, v36, v37, v38
v_max_u32 v26, v26, v39
v_cmp_eq_u32 vcc, -1, v26
s_cbranch_vccnz Lpf_401
v_smfmac_f32_16x16x64_bf16 v[76:79], v[36:39], a[192:199], v126
v_smfmac_f32_16x16x64_bf16 v[80:83], v[36:39], a[200:207], v126
v_smfmac_f32_16x16x64_bf16 v[84:87], v[36:39], a[208:215], v126
v_smfmac_f32_16x16x64_bf16 v[88:91], v[36:39], a[216:223], v126
s_branch Lps_358
Lpf_383:
buffer_load_dwordx4 v[32:35], v9, s[4:7], s40 offen offset:1024 sc1
v_mfma_f32_16x16x32_bf16 v[16:19], v[20:23], v[20:23], 0
s_sub_u32 s37, s37, 1
s_cbranch_scc1 Lend_8
s_branch Lps_356
Lpf_385:
buffer_load_dwordx4 v[36:39], v9, s[4:7], s40 offen offset:2048 sc1
v_mfma_f32_16x16x32_bf16 v[16:19], v[20:23], v[20:23], 0
s_sub_u32 s37, s37, 1
s_cbranch_scc1 Lend_8
s_branch Lps_360
Lpf_387:
buffer_load_dwordx4 v[40:43], v9, s[4:7], s40 offen offset:3072 sc1
v_mfma_f32_16x16x32_bf16 v[16:19], v[20:23], v[20:23], 0
Lps_402:
s_waitcnt vmcnt(3)
v_max3_u32 v26, v28, v29, v30
v_max_u32 v26, v26, v31
v_cmp_eq_u32 vcc, -1, v26
s_cbranch_vccnz Lpf_403
v_smfmac_f32_16x16x64_bf16 v[76:79], v[28:31], a[128:135], v126
v_smfmac_f32_16x16x64_bf16 v[80:83], v[28:31], a[136:143], v126
v_smfmac_f32_16x16x64_bf16 v[84:87], v[28:31], a[144:151], v126
v_smfmac_f32_16x16x64_bf16 v[88:91], v[28:31], a[152:159], v126
s_branch Lps_398
Lpf_389:
buffer_load_dwordx4 v[28:31], v9, s[4:7], s40 offen offset:0 sc1
v_mfma_f32_16x16x32_bf16 v[16:19], v[20:23], v[20:23], 0
s_sub_u32 s37, s37, 1
s_cbranch_scc1 Lend_8
Lps_404:
s_waitcnt vmcnt(2)
v_max3_u32 v26, v32, v33, v34
v_max_u32 v26, v26, v35
v_cmp_eq_u32 vcc, -1, v26
s_cbranch_vccnz Lpf_405
v_smfmac_f32_16x16x64_bf16 v[76:79], v[32:35], a[160:167], v126
v_smfmac_f32_16x16x64_bf16 v[80:83], v[32:35], a[168:175], v126
v_smfmac_f32_16x16x64_bf16 v[84:87], v[32:35], a[176:183], v126
v_smfmac_f32_16x16x64_bf16 v[88:91], v[32:35], a[184:191], v126
s_branch Lps_396
Lpf_391:
buffer_load_dwordx4 v[28:31], v9, s[4:7], s40 offen offset:0 sc1
v_mfma_f32_16x16x32_bf16 v[16:19], v[20:23], v[20:23], 0
s_sub_u32 s37, s37, 1
s_cbranch_scc1 Lend_8
Lps_406:
s_waitcnt vmcnt(2)
v_max3_u32 v26, v32, v33, v34
v_max_u32 v26, v26, v35
v_cmp_eq_u32 vcc, -1, v26
s_cbranch_vccnz Lpf_407
v_smfmac_f32_16x16x64_bf16 v[76:79], v[32:35], a[160:167], v126
v_smfmac_f32_16x16x64_bf16 v[80:83], v[32:35], a[168:175], v126
v_smfmac_f32_16x16x64_bf16 v[84:87], v[32:35], a[176:183], v126
v_smfmac_f32_16x16x64_bf16 v[88:91], v[32:35], a[184:191], v126
s_branch Lps_350
Lpf_393:
buffer_load_dwordx4 v[32:35], v9, s[4:7], s40 offen offset:1024 sc1
v_mfma_f32_16x16x32_bf16 v[16:19], v[20:23], v[20:23], 0
s_branch Lps_370
Lpf_395:
buffer_load_dwordx4 v[28:31], v9, s[4:7], s40 offen offset:0 sc1
v_mfma_f32_16x16x32_bf16 v[16:19], v[20:23], v[20:23], 0
s_sub_u32 s37, s37, 1
s_cbranch_scc1 Lend_8
s_branch Lps_348
Lpf_397:
buffer_load_dwordx4 v[36:39], v9, s[4:7], s40 offen offset:2048 sc1
v_mfma_f32_16x16x32_bf16 v[16:19], v[20:23], v[20:23], 0
s_branch Lps_374
Lpf_399:
buffer_load_dwordx4 v[32:35], v9, s[4:7], s40 offen offset:1024 sc1
v_mfma_f32_16x16x32_bf16 v[16:19], v[20:23], v[20:23], 0
s_sub_u32 s37, s37, 1
s_cbranch_scc1 Lend_8
s_branch Lps_354
Lpf_401:
buffer_load_dwordx4 v[36:39], v9, s[4:7], s40 offen offset:2048 sc1
v_mfma_f32_16x16x32_bf16 v[16:19], v[20:23], v[20:23], 0
s_branch Lps_380
Lpf_403:
buffer_load_dwordx4 v[28:31], v9, s[4:7], s40 offen offset:0 sc1
v_mfma_f32_16x16x32_bf16 v[16:19], v[20:23], v[20:23], 0
s_sub_u32 s37, s37, 1
s_cbranch_scc1 Lend_8
s_branch Lps_346
Lpf_405:
buffer_load_dwordx4 v[32:35], v9, s[4:7], s40 offen offset:1024 sc1
v_mfma_f32_16x16x32_bf16 v[16:19], v[20:23], v[20:23], 0
Lps_408:
s_waitcnt vmcnt(2)
v_max3_u32 v26, v36, v37, v38
v_max_u32 v26, v26, v39
v_cmp_eq_u32 vcc, -1, v26
s_cbranch_vccnz Lpf_409
v_smfmac_f32_16x16x64_bf16 v[76:79], v[36:39], a[192:199], v126
v_smfmac_f32_16x16x64_bf16 v[80:83], v[36:39], a[200:207], v126
v_smfmac_f32_16x16x64_bf16 v[84:87], v[36:39], a[208:215], v126
v_smfmac_f32_16x16x64_bf16 v[88:91], v[36:39], a[216:223], v126
s_branch Lps_370
Lpf_407:
buffer_load_dwordx4 v[32:35], v9, s[4:7], s40 offen offset:1024 sc1
v_mfma_f32_16x16x32_bf16 v[16:19], v[20:23], v[20:23], 0
s_branch Lps_368
Lpf_409:
buffer_load_dwordx4 v[36:39], v9, s[4:7], s40 offen offset:2048 sc1
v_mfma_f32_16x16x32_bf16 v[16:19], v[20:23], v[20:23], 0
s_branch Lps_388
Lkvo_sc1_260:
Lkvo_410:
s_and_b32 s38, s36, 3
s_lshl_b32 s39, s38, 16
s_add_u32 s40, s39, s45
s_xor_b32 s42, s40, 0x20000
s_add_u32 s26, s36, 1
s_mov_b64 exec, 15
buffer_load_dword v4, v1, s[4:7], s59 offen sc1
s_nop 11
buffer_load_dword v5, v1, s[4:7], s59 offen sc1
s_nop 11
buffer_load_dword v6, v1, s[4:7], s59 offen sc1
Lft_414:
s_waitcnt vmcnt(2)
v_cmp_gt_u32 vcc, s26, v4
s_cbranch_vccz Lfg_413
buffer_load_dword v4, v1, s[4:7], s59 offen sc1
s_waitcnt vmcnt(2)
v_cmp_gt_u32 vcc, s26, v5
s_cbranch_vccz Lfg_413
buffer_load_dword v5, v1, s[4:7], s59 offen sc1
s_waitcnt vmcnt(2)
v_cmp_gt_u32 vcc, s26, v6
s_cbranch_vccz Lfg_413
buffer_load_dword v6, v1, s[4:7], s59 offen sc1
s_sub_u32 s37, s37, 1
s_cbranch_scc1 Lend_8
s_branch Lft_414
Lfg_413:
s_mov_b64 exec, -1
Lkvo3_412:
buffer_load_dwordx4 v[28:31], v8, s[4:7], s40 offen offset:0 sc1
v_mfma_f32_16x16x32_bf16 v[16:19], v[20:23], v[20:23], 0
v_mfma_f32_16x16x32_bf16 v[16:19], v[20:23], v[20:23], 0
v_mfma_f32_16x16x32_bf16 v[16:19], v[20:23], v[20:23], 0
v_mfma_f32_16x16x32_bf16 v[16:19], v[20:23], v[20:23], 0
buffer_load_dwordx4 v[32:35], v8, s[4:7], s40 offen offset:1024 sc1
v_mfma_f32_16x16x32_bf16 v[16:19], v[20:23], v[20:23], 0
v_mfma_f32_16x16x32_bf16 v[16:19], v[20:23], v[20:23], 0
v_mfma_f32_16x16x32_bf16 v[16:19], v[20:23], v[20:23], 0
v_mfma_f32_16x16x32_bf16 v[16:19], v[20:23], v[20:23], 0
buffer_load_dwordx4 v[36:39], v8, s[4:7], s40 offen offset:2048 sc1
v_mfma_f32_16x16x32_bf16 v[16:19], v[20:23], v[20:23], 0
v_mfma_f32_16x16x32_bf16 v[16:19], v[20:23], v[20:23], 0
v_mfma_f32_16x16x32_bf16 v[16:19], v[20:23], v[20:23], 0
v_mfma_f32_16x16x32_bf16 v[16:19], v[20:23], v[20:23], 0
buffer_load_dwordx4 v[40:43], v8, s[4:7], s40 offen offset:3072 sc1
v_mfma_f32_16x16x32_bf16 v[16:19], v[20:23], v[20:23], 0
s_waitcnt vmcnt(3)
v_max3_u32 v26, v28, v29, v30
v_max_u32 v26, v26, v31
v_cmp_eq_u32 vcc, -1, v26
s_cbranch_vccnz Lpf_416
v_smfmac_f32_16x16x64_bf16 v[44:47], v[28:31], a[0:7], v126
v_smfmac_f32_16x16x64_bf16 v[48:51], v[28:31], a[8:15], v126
v_smfmac_f32_16x16x64_bf16 v[52:55], v[28:31], a[16:23], v126
v_smfmac_f32_16x16x64_bf16 v[56:59], v[28:31], a[24:31], v126
s_waitcnt vmcnt(2)
v_max3_u32 v26, v32, v33, v34
v_max_u32 v26, v26, v35
v_cmp_eq_u32 vcc, -1, v26
v_smfmac_f32_16x16x64_bf16 v[60:63], v[28:31], v[128:135], v126
v_smfmac_f32_16x16x64_bf16 v[64:67], v[28:31], v[136:143], v126
s_cbranch_vccnz Lpf_417
v_smfmac_f32_16x16x64_bf16 v[44:47], v[32:35], a[32:39], v126
v_smfmac_f32_16x16x64_bf16 v[48:51], v[32:35], a[40:47], v126
v_smfmac_f32_16x16x64_bf16 v[52:55], v[32:35], a[48:55], v126
v_smfmac_f32_16x16x64_bf16 v[56:59], v[32:35], a[56:63], v126
s_waitcnt vmcnt(1)
v_max3_u32 v26, v36, v37, v38
v_max_u32 v26, v26, v39
v_cmp_eq_u32 vcc, -1, v26
v_smfmac_f32_16x16x64_bf16 v[60:63], v[32:35], v[160:167], v126
v_smfmac_f32_16x16x64_bf16 v[64:67], v[32:35], v[168:175], v126
s_cbranch_vccnz Lpf_418
v_smfmac_f32_16x16x64_bf16 v[44:47], v[36:39], a[64:71], v126
v_smfmac_f32_16x16x64_bf16 v[48:51], v[36:39], a[72:79], v126
v_smfmac_f32_16x16x64_bf16 v[52:55], v[36:39], a[80:87], v126
v_smfmac_f32_16x16x64_bf16 v[56:59], v[36:39], a[88:95], v126
s_waitcnt vmcnt(0)
v_max3_u32 v26, v40, v41, v42
v_max_u32 v26, v26, v43
v_cmp_eq_u32 vcc, -1, v26
v_smfmac_f32_16x16x64_bf16 v[60:63], v[36:39], v[192:199], v126
v_smfmac_f32_16x16x64_bf16 v[64:67], v[36:39], v[200:207], v126
s_cbranch_vccnz Lpf_419
v_smfmac_f32_16x16x64_bf16 v[44:47], v[40:43], a[96:103], v126
v_smfmac_f32_16x16x64_bf16 v[48:51], v[40:43], a[104:111], v126
v_smfmac_f32_16x16x64_bf16 v[52:55], v[40:43], a[112:119], v126
v_smfmac_f32_16x16x64_bf16 v[56:59], v[40:43], a[120:127], v126
v_smfmac_f32_16x16x64_bf16 v[60:63], v[40:43], v[224:231], v126
v_smfmac_f32_16x16x64_bf16 v[64:67], v[40:43], v[232:239], v126
Lpd_415:
s_nop 2
v_add_f32 v92, v44, v45
v_add_f32 v93, v46, v47
v_add_f32 v94, v48, v49
v_add_f32 v95, v50, v51
v_add_f32 v96, v52, v53
ds_write_addtid_b32 v92 offset:0
v_add_f32 v97, v54, v55
ds_write_addtid_b32 v93 offset:640
v_add_f32 v98, v56, v57
ds_write_addtid_b32 v94 offset:288
v_add_f32 v99, v58, v59
ds_write_addtid_b32 v95 offset:928
ds_write_addtid_b32 v96 offset:1280
ds_write_addtid_b32 v97 offset:1920
ds_write_addtid_b32 v98 offset:1568
v_smfmac_f32_16x16x64_bf16 v[68:71], v[28:31], v[144:151], v126
ds_write_addtid_b32 v99 offset:2208
v_smfmac_f32_16x16x64_bf16 v[72:75], v[28:31], v[152:159], v126
v_smfmac_f32_16x16x64_bf16 v[68:71], v[32:35], v[176:183], v126
v_smfmac_f32_16x16x64_bf16 v[72:75], v[32:35], v[184:191], v126
s_waitcnt lgkmcnt(0)
s_barrier
ds_read_b64 v[100:101], v24 offset:0
ds_read_b64 v[102:103], v24 offset:2560
ds_read_b64 v[104:105], v24 offset:5120
ds_read_b64 v[106:107], v24 offset:7680
v_smfmac_f32_16x16x64_bf16 v[68:71], v[36:39], v[208:215], v126
v_smfmac_f32_16x16x64_bf16 v[72:75], v[36:39], v[216:223], v126
v_smfmac_f32_16x16x64_bf16 v[68:71], v[40:43], v[240:247], v126
s_waitcnt lgkmcnt(0)
v_pk_add_f32 v[100:101], v[100:101], v[102:103]
v_pk_add_f32 v[104:105], v[104:105], v[106:107]
v_pk_add_f32 v[116:117], v[100:101], v[104:105]
v_cvt_pk_bf16_f32 v116, v116, v117
v_min_u32 v116, -2, v116
buffer_store_dword v116, v11, s[4:7], s40 offen sc1
v_smfmac_f32_16x16x64_bf16 v[72:75], v[40:43], v[248:255], v126
s_nop 5
v_add_f32 v92, v60, v61
v_add_f32 v93, v62, v63
v_add_f32 v94, v64, v65
v_add_f32 v95, v66, v67
v_add_f32 v96, v68, v69
v_add_f32 v97, v70, v71
v_add_f32 v98, v72, v73
v_add_f32 v99, v74, v75
ds_write_b128 v25, v[92:95] offset:20480
ds_write_b128 v25, v[96:99] offset:20496
s_waitcnt lgkmcnt(0)
s_barrier
ds_read_b64 v[100:101], v127 offset:20480
ds_read_b64 v[102:103], v127 offset:22528
ds_read_b64 v[104:105], v127 offset:24576
ds_read_b64 v[106:107], v127 offset:26624
s_waitcnt lgkmcnt(0)
v_pk_add_f32 v[100:101], v[100:101], v[102:103]
v_pk_add_f32 v[104:105], v[104:105], v[106:107]
v_pk_add_f32 v[116:117], v[100:101], v[104:105]
v_cvt_pk_bf16_f32 v116, v116, v117
v_min_u32 v116, -2, v116
buffer_store_dword v116, v27, s[4:7], s40 offen sc1
s_cmp_eq_u32 s36, 63
s_cbranch_scc1 Lend_8
buffer_store_dword v120, v11, s[4:7], s42 offen sc1
buffer_store_dword v120, v27, s[4:7], s42 offen sc1
s_cmp_lt_u32 s32, 2
s_cbranch_scc1 Lr1_420
buffer_store_dwordx2 v[120:121], v10, s[4:7], s42 offen sc1
Lr1_420:
v_pk_mul_f32 v[44:45], 0, 0
v_pk_mul_f32 v[46:47], 0, 0
v_pk_mul_f32 v[48:49], 0, 0
v_pk_mul_f32 v[50:51], 0, 0
v_pk_mul_f32 v[52:53], 0, 0
v_pk_mul_f32 v[54:55], 0, 0
v_pk_mul_f32 v[56:57], 0, 0
v_pk_mul_f32 v[58:59], 0, 0
v_pk_mul_f32 v[60:61], 0, 0
v_pk_mul_f32 v[62:63], 0, 0
v_pk_mul_f32 v[64:65], 0, 0
v_pk_mul_f32 v[66:67], 0, 0
v_pk_mul_f32 v[68:69], 0, 0
v_pk_mul_f32 v[70:71], 0, 0
v_pk_mul_f32 v[72:73], 0, 0
v_pk_mul_f32 v[74:75], 0, 0
v_pk_mul_f32 v[76:77], 0, 0
v_pk_mul_f32 v[78:79], 0, 0
v_pk_mul_f32 v[80:81], 0, 0
v_pk_mul_f32 v[82:83], 0, 0
v_pk_mul_f32 v[84:85], 0, 0
v_pk_mul_f32 v[86:87], 0, 0
v_pk_mul_f32 v[88:89], 0, 0
v_pk_mul_f32 v[90:91], 0, 0
v_add_u32 v7, 1, v7
s_and_b32 s38, s36, 3
s_lshl_b32 s39, s38, 1
s_lshr_b32 s52, s46, s39
s_and_b32 s52, s52, 1
s_lshl_b32 s52, s52, 13
s_lshl_b32 s39, s39, 21
s_add_u32 s39, s39, s52
s_add_u32 s84, s39, 134217728
s_lshl_b32 s39, s38, 1
s_lshr_b32 s52, s46, s39
s_and_b32 s52, s52, 1
s_lshl_b32 s52, s52, 13
s_lshl_b32 s39, s39, 21
s_add_u32 s39, s39, s52
s_add_u32 s85, s39, 135266304
s_and_b32 s38, s26, 3
s_lshl_b32 s38, s38, 16
s_add_u32 s41, s38, s45
s_mov_b64 exec, 3
buffer_load_dword v4, v2, s[4:7], s59 offen sc1
s_nop 11
buffer_load_dword v5, v2, s[4:7], s59 offen sc1
s_nop 11
buffer_load_dword v6, v2, s[4:7], s59 offen sc1
Lft_422:
s_waitcnt vmcnt(2)
v_cmp_gt_u32 vcc, s26, v4
s_cbranch_vccz Lfg_421
buffer_load_dword v4, v2, s[4:7], s59 offen sc1
s_waitcnt vmcnt(2)
v_cmp_gt_u32 vcc, s26, v5
s_cbranch_vccz Lfg_421
buffer_load_dword v5, v2, s[4:7], s59 offen sc1
s_waitcnt vmcnt(2)
v_cmp_gt_u32 vcc, s26, v6
s_cbranch_vccz Lfg_421
buffer_load_dword v6, v2, s[4:7], s59 offen sc1
s_sub_u32 s37, s37, 1
s_cbranch_scc1 Lend_8
s_branch Lft_422
Lfg_421:
s_mov_b64 exec, -1
buffer_load_dwordx4 v[28:31], v9, s[4:7], s40 offen offset:0 sc1
v_mfma_f32_16x16x32_bf16 v[16:19], v[20:23], v[20:23], 0
v_mfma_f32_16x16x32_bf16 v[16:19], v[20:23], v[20:23], 0
v_mfma_f32_16x16x32_bf16 v[16:19], v[20:23], v[20:23], 0
v_mfma_f32_16x16x32_bf16 v[16:19], v[20:23], v[20:23], 0
buffer_load_dwordx4 v[32:35], v9, s[4:7], s40 offen offset:1024 sc1
v_mfma_f32_16x16x32_bf16 v[16:19], v[20:23], v[20:23], 0
v_mfma_f32_16x16x32_bf16 v[16:19], v[20:23], v[20:23], 0
v_mfma_f32_16x16x32_bf16 v[16:19], v[20:23], v[20:23], 0
v_mfma_f32_16x16x32_bf16 v[16:19], v[20:23], v[20:23], 0
buffer_load_dwordx4 v[36:39], v9, s[4:7], s40 offen offset:2048 sc1
v_mfma_f32_16x16x32_bf16 v[16:19], v[20:23], v[20:23], 0
v_mfma_f32_16x16x32_bf16 v[16:19], v[20:23], v[20:23], 0
v_mfma_f32_16x16x32_bf16 v[16:19], v[20:23], v[20:23], 0
v_mfma_f32_16x16x32_bf16 v[16:19], v[20:23], v[20:23], 0
buffer_load_dwordx4 v[40:43], v9, s[4:7], s40 offen offset:3072 sc1
v_mfma_f32_16x16x32_bf16 v[16:19], v[20:23], v[20:23], 0
s_waitcnt vmcnt(3)
v_max3_u32 v26, v28, v29, v30
v_max_u32 v26, v26, v31
v_cmp_eq_u32 vcc, -1, v26
s_cbranch_vccnz Lpf_424
v_smfmac_f32_16x16x64_bf16 v[76:79], v[28:31], a[128:135], v126
v_smfmac_f32_16x16x64_bf16 v[80:83], v[28:31], a[136:143], v126
s_waitcnt vmcnt(2)
v_max3_u32 v26, v32, v33, v34
v_max_u32 v26, v26, v35
v_cmp_eq_u32 vcc, -1, v26
v_smfmac_f32_16x16x64_bf16 v[84:87], v[28:31], a[144:151], v126
v_smfmac_f32_16x16x64_bf16 v[88:91], v[28:31], a[152:159], v126
s_cbranch_vccnz Lpf_425
v_smfmac_f32_16x16x64_bf16 v[76:79], v[32:35], a[160:167], v126
v_smfmac_f32_16x16x64_bf16 v[80:83], v[32:35], a[168:175], v126
s_waitcnt vmcnt(1)
v_max3_u32 v26, v36, v37, v38
v_max_u32 v26, v26, v39
v_cmp_eq_u32 vcc, -1, v26
v_smfmac_f32_16x16x64_bf16 v[84:87], v[32:35], a[176:183], v126
v_smfmac_f32_16x16x64_bf16 v[88:91], v[32:35], a[184:191], v126
s_cbranch_vccnz Lpf_426
v_smfmac_f32_16x16x64_bf16 v[76:79], v[36:39], a[192:199], v126
v_smfmac_f32_16x16x64_bf16 v[80:83], v[36:39], a[200:207], v126
s_waitcnt vmcnt(0)
v_max3_u32 v26, v40, v41, v42
v_max_u32 v26, v26, v43
v_cmp_eq_u32 vcc, -1, v26
v_smfmac_f32_16x16x64_bf16 v[84:87], v[36:39], a[208:215], v126
v_smfmac_f32_16x16x64_bf16 v[88:91], v[36:39], a[216:223], v126
s_cbranch_vccnz Lpf_427
v_smfmac_f32_16x16x64_bf16 v[76:79], v[40:43], a[224:231], v126
v_smfmac_f32_16x16x64_bf16 v[80:83], v[40:43], a[232:239], v126
v_smfmac_f32_16x16x64_bf16 v[84:87], v[40:43], a[240:247], v126
v_smfmac_f32_16x16x64_bf16 v[88:91], v[40:43], a[248:255], v126
Lpd_423:
s_nop 4
v_add_f32 v92, v76, v77
v_add_f32 v93, v78, v79
v_add_f32 v94, v80, v81
v_add_f32 v95, v82, v83
v_add_f32 v96, v84, v85
ds_write_addtid_b32 v92 offset:10240
v_add_f32 v97, v86, v87
ds_write_addtid_b32 v93 offset:10528
v_add_f32 v98, v88, v89
ds_write_addtid_b32 v94 offset:10816
v_add_f32 v99, v90, v91
ds_write_addtid_b32 v95 offset:11104
ds_write_addtid_b32 v96 offset:11392
ds_write_addtid_b32 v97 offset:11680
ds_write_addtid_b32 v98 offset:11968
ds_write_addtid_b32 v99 offset:12256
v_mfma_f32_16x16x32_bf16 v[16:19], v[20:23], v[20:23], 0
v_mfma_f32_16x16x32_bf16 v[16:19], v[20:23], v[20:23], 0
s_cmp_ge_u32 s32, 2
s_cbranch_scc1 Lxl_428
s_waitcnt lgkmcnt(0)
s_barrier
ds_read_b64 v[100:101], v0 offset:10240
ds_read_b64 v[102:103], v0 offset:10816
ds_read_b64 v[104:105], v0 offset:12800
ds_read_b64 v[106:107], v0 offset:13376
ds_read_b64 v[108:109], v0 offset:15360
ds_read_b64 v[110:111], v0 offset:15936
ds_read_b64 v[112:113], v0 offset:17920
ds_read_b64 v[114:115], v0 offset:18496
s_waitcnt lgkmcnt(4)
v_pk_add_f32 v[100:101], v[100:101], v[104:105]
v_pk_add_f32 v[102:103], v[102:103], v[106:107]
s_waitcnt lgkmcnt(0)
v_pk_add_f32 v[108:109], v[108:109], v[112:113]
v_pk_add_f32 v[110:111], v[110:111], v[114:115]
v_pk_add_f32 v[116:117], v[100:101], v[108:109]
v_pk_add_f32 v[118:119], v[102:103], v[110:111]
v_cvt_pk_bf16_f32 v116, v116, v117
v_cvt_pk_bf16_f32 v117, v118, v119
v_min_u32 v116, -2, v116
v_min_u32 v117, -2, v117
buffer_store_dwordx2 v[116:117], v12, s[4:7], s84 offen sc1
buffer_store_dwordx2 v[116:117], v12, s[4:7], s85 offen sc1
v_mfma_f32_16x16x32_bf16 v[16:19], v[20:23], v[20:23], 0
v_mfma_f32_16x16x32_bf16 v[16:19], v[20:23], v[20:23], 0
v_mfma_f32_16x16x32_bf16 v[16:19], v[20:23], v[20:23], 0
v_mfma_f32_16x16x32_bf16 v[16:19], v[20:23], v[20:23], 0
v_mfma_f32_16x16x32_bf16 v[16:19], v[20:23], v[20:23], 0
v_mfma_f32_16x16x32_bf16 v[16:19], v[20:23], v[20:23], 0
v_mfma_f32_16x16x32_bf16 v[16:19], v[20:23], v[20:23], 0
v_mfma_f32_16x16x32_bf16 v[16:19], v[20:23], v[20:23], 0
v_mfma_f32_16x16x32_bf16 v[16:19], v[20:23], v[20:23], 0
v_mfma_f32_16x16x32_bf16 v[16:19], v[20:23], v[20:23], 0
v_mfma_f32_16x16x32_bf16 v[16:19], v[20:23], v[20:23], 0
v_mfma_f32_16x16x32_bf16 v[16:19], v[20:23], v[20:23], 0
v_mfma_f32_16x16x32_bf16 v[16:19], v[20:23], v[20:23], 0
v_mfma_f32_16x16x32_bf16 v[16:19], v[20:23], v[20:23], 0
v_mfma_f32_16x16x32_bf16 v[16:19], v[20:23], v[20:23], 0
v_mfma_f32_16x16x32_bf16 v[16:19], v[20:23], v[20:23], 0
v_mfma_f32_16x16x32_bf16 v[16:19], v[20:23], v[20:23], 0
v_mfma_f32_16x16x32_bf16 v[16:19], v[20:23], v[20:23], 0
v_mfma_f32_16x16x32_bf16 v[16:19], v[20:23], v[20:23], 0
v_mfma_f32_16x16x32_bf16 v[16:19], v[20:23], v[20:23], 0
v_mfma_f32_16x16x32_bf16 v[16:19], v[20:23], v[20:23], 0
v_mfma_f32_16x16x32_bf16 v[16:19], v[20:23], v[20:23], 0
v_mfma_f32_16x16x32_bf16 v[16:19], v[20:23], v[20:23], 0
v_mfma_f32_16x16x32_bf16 v[16:19], v[20:23], v[20:23], 0
v_mfma_f32_16x16x32_bf16 v[16:19], v[20:23], v[20:23], 0
v_mfma_f32_16x16x32_bf16 v[16:19], v[20:23], v[20:23], 0
v_mfma_f32_16x16x32_bf16 v[16:19], v[20:23], v[20:23], 0
v_mfma_f32_16x16x32_bf16 v[16:19], v[20:23], v[20:23], 0
v_mfma_f32_16x16x32_bf16 v[16:19], v[20:23], v[20:23], 0
v_mfma_f32_16x16x32_bf16 v[16:19], v[20:23], v[20:23], 0
v_mfma_f32_16x16x32_bf16 v[16:19], v[20:23], v[20:23], 0
v_mfma_f32_16x16x32_bf16 v[16:19], v[20:23], v[20:23], 0
v_mfma_f32_16x16x32_bf16 v[16:19], v[20:23], v[20:23], 0
v_mfma_f32_16x16x32_bf16 v[16:19], v[20:23], v[20:23], 0
v_mfma_f32_16x16x32_bf16 v[16:19], v[20:23], v[20:23], 0
v_mfma_f32_16x16x32_bf16 v[16:19], v[20:23], v[20:23], 0
buffer_store_dword v7, v3, s[4:7], s59 offen sc1
s_add_u32 s36, s36, 1
s_branch Lkvo_410
Lxl_428:
s_waitcnt lgkmcnt(0)
s_barrier
v_mfma_f32_16x16x32_bf16 v[16:19], v[20:23], v[20:23], 0
v_mfma_f32_16x16x32_bf16 v[16:19], v[20:23], v[20:23], 0
v_mfma_f32_16x16x32_bf16 v[16:19], v[20:23], v[20:23], 0
v_mfma_f32_16x16x32_bf16 v[16:19], v[20:23], v[20:23], 0
v_mfma_f32_16x16x32_bf16 v[16:19], v[20:23], v[20:23], 0
v_mfma_f32_16x16x32_bf16 v[16:19], v[20:23], v[20:23], 0
v_mfma_f32_16x16x32_bf16 v[16:19], v[20:23], v[20:23], 0
v_mfma_f32_16x16x32_bf16 v[16:19], v[20:23], v[20:23], 0
v_mfma_f32_16x16x32_bf16 v[16:19], v[20:23], v[20:23], 0
v_mfma_f32_16x16x32_bf16 v[16:19], v[20:23], v[20:23], 0
v_mfma_f32_16x16x32_bf16 v[16:19], v[20:23], v[20:23], 0
v_mfma_f32_16x16x32_bf16 v[16:19], v[20:23], v[20:23], 0
v_mfma_f32_16x16x32_bf16 v[16:19], v[20:23], v[20:23], 0
v_mfma_f32_16x16x32_bf16 v[16:19], v[20:23], v[20:23], 0
v_mfma_f32_16x16x32_bf16 v[16:19], v[20:23], v[20:23], 0
v_mfma_f32_16x16x32_bf16 v[16:19], v[20:23], v[20:23], 0
v_mfma_f32_16x16x32_bf16 v[16:19], v[20:23], v[20:23], 0
v_mfma_f32_16x16x32_bf16 v[16:19], v[20:23], v[20:23], 0
v_mfma_f32_16x16x32_bf16 v[16:19], v[20:23], v[20:23], 0
v_mfma_f32_16x16x32_bf16 v[16:19], v[20:23], v[20:23], 0
v_mfma_f32_16x16x32_bf16 v[16:19], v[20:23], v[20:23], 0
v_mfma_f32_16x16x32_bf16 v[16:19], v[20:23], v[20:23], 0
v_mfma_f32_16x16x32_bf16 v[16:19], v[20:23], v[20:23], 0
v_mfma_f32_16x16x32_bf16 v[16:19], v[20:23], v[20:23], 0
v_mfma_f32_16x16x32_bf16 v[16:19], v[20:23], v[20:23], 0
v_mfma_f32_16x16x32_bf16 v[16:19], v[20:23], v[20:23], 0
v_mfma_f32_16x16x32_bf16 v[16:19], v[20:23], v[20:23], 0
v_mfma_f32_16x16x32_bf16 v[16:19], v[20:23], v[20:23], 0
buffer_load_dwordx2 v[76:77], v13, s[4:7], s84 offen sc1
buffer_load_dwordx2 v[78:79], v14, s[4:7], s84 offen sc1
buffer_load_dwordx2 v[80:81], v15, s[4:7], s84 offen sc1
v_mfma_f32_16x16x32_bf16 v[16:19], v[20:23], v[20:23], 0
v_mfma_f32_16x16x32_bf16 v[16:19], v[20:23], v[20:23], 0
v_mfma_f32_16x16x32_bf16 v[16:19], v[20:23], v[20:23], 0
v_mfma_f32_16x16x32_bf16 v[16:19], v[20:23], v[20:23], 0
v_mfma_f32_16x16x32_bf16 v[16:19], v[20:23], v[20:23], 0
v_mfma_f32_16x16x32_bf16 v[16:19], v[20:23], v[20:23], 0
v_mfma_f32_16x16x32_bf16 v[16:19], v[20:23], v[20:23], 0
v_mfma_f32_16x16x32_bf16 v[16:19], v[20:23], v[20:23], 0
v_mfma_f32_16x16x32_bf16 v[16:19], v[20:23], v[20:23], 0
v_mfma_f32_16x16x32_bf16 v[16:19], v[20:23], v[20:23], 0
v_mfma_f32_16x16x32_bf16 v[16:19], v[20:23], v[20:23], 0
v_mfma_f32_16x16x32_bf16 v[16:19], v[20:23], v[20:23], 0
buffer_load_dwordx2 v[88:89], v13, s[4:7], s85 offen sc1
buffer_load_dwordx2 v[90:91], v14, s[4:7], s85 offen sc1
buffer_load_dwordx2 v[92:93], v15, s[4:7], s85 offen sc1
ds_read_b64 v[100:101], v0 offset:10240
ds_read_b64 v[102:103], v0 offset:10816
ds_read_b64 v[104:105], v0 offset:12800
ds_read_b64 v[106:107], v0 offset:13376
ds_read_b64 v[108:109], v0 offset:15360
ds_read_b64 v[110:111], v0 offset:15936
ds_read_b64 v[112:113], v0 offset:17920
ds_read_b64 v[114:115], v0 offset:18496
s_waitcnt lgkmcnt(4)
v_pk_add_f32 v[100:101], v[100:101], v[104:105]
v_pk_add_f32 v[102:103], v[102:103], v[106:107]
s_waitcnt lgkmcnt(0)
v_pk_add_f32 v[108:109], v[108:109], v[112:113]
v_pk_add_f32 v[110:111], v[110:111], v[114:115]
v_pk_add_f32 v[116:117], v[100:101], v[108:109]
v_pk_add_f32 v[118:119], v[102:103], v[110:111]
v_cvt_pk_bf16_f32 v100, v116, v117
v_cvt_pk_bf16_f32 v101, v118, v119
v_lshlrev_b32 v116, 16, v100
v_and_b32 v117, 0xffff0000, v100
v_lshlrev_b32 v118, 16, v101
v_and_b32 v119, 0xffff0000, v101
v_mfma_f32_16x16x32_bf16 v[16:19], v[20:23], v[20:23], 0
v_mfma_f32_16x16x32_bf16 v[16:19], v[20:23], v[20:23], 0
v_mfma_f32_16x16x32_bf16 v[16:19], v[20:23], v[20:23], 0
v_mfma_f32_16x16x32_bf16 v[16:19], v[20:23], v[20:23], 0
buffer_load_dwordx2 v[28:29], v13, s[4:7], s84 offen sc1
buffer_load_dwordx2 v[30:31], v14, s[4:7], s84 offen sc1
buffer_load_dwordx2 v[32:33], v15, s[4:7], s84 offen sc1
s_waitcnt vmcnt(6)
v_max3_u32 v26, v76, v77, v78
v_max3_u32 v26, v26, v79, v80
v_max_u32 v26, v26, v81
v_cmp_eq_u32 vcc, -1, v26
v_dot2_f32_bf16 v100, v76, s55, v116
v_dot2_f32_bf16 v101, v76, s56, v117
v_dot2_f32_bf16 v102, v77, s55, v118
v_dot2_f32_bf16 v103, v77, s56, v119
v_dot2_f32_bf16 v100, v78, s55, v100
v_dot2_f32_bf16 v101, v78, s56, v101
v_dot2_f32_bf16 v102, v79, s55, v102
v_dot2_f32_bf16 v103, v79, s56, v103
v_dot2_f32_bf16 v100, v80, s55, v100
v_dot2_f32_bf16 v101, v80, s56, v101
v_dot2_f32_bf16 v102, v81, s55, v102
v_dot2_f32_bf16 v103, v81, s56, v103
s_nop 1
v_cvt_pk_bf16_f32 v100, v100, v101
v_cvt_pk_bf16_f32 v101, v102, v103
v_min_u32 v100, -2, v100
v_min_u32 v101, -2, v101
s_cbranch_vccnz Lx2_429
Lxs_430:
buffer_store_dwordx2 v[100:101], v10, s[4:7], s41 offen sc1
s_add_u32 s36, s36, 1
s_and_b32 s38, s36, 3
s_lshl_b32 s39, s38, 16
s_add_u32 s40, s39, s45
s_xor_b32 s42, s40, 0x20000
s_add_u32 s26, s36, 1
v_mfma_f32_16x16x32_bf16 v[16:19], v[20:23], v[20:23], 0
v_mfma_f32_16x16x32_bf16 v[16:19], v[20:23], v[20:23], 0
v_mfma_f32_16x16x32_bf16 v[16:19], v[20:23], v[20:23], 0
v_mfma_f32_16x16x32_bf16 v[16:19], v[20:23], v[20:23], 0
v_mfma_f32_16x16x32_bf16 v[16:19], v[20:23], v[20:23], 0
v_mfma_f32_16x16x32_bf16 v[16:19], v[20:23], v[20:23], 0
v_mfma_f32_16x16x32_bf16 v[16:19], v[20:23], v[20:23], 0
v_mfma_f32_16x16x32_bf16 v[16:19], v[20:23], v[20:23], 0
s_branch Lkvo3_412
Lx2_429:
buffer_load_dwordx2 v[76:77], v13, s[4:7], s85 offen sc1
buffer_load_dwordx2 v[78:79], v14, s[4:7], s85 offen sc1
buffer_load_dwordx2 v[80:81], v15, s[4:7], s85 offen sc1
s_waitcnt vmcnt(6)
v_max3_u32 v26, v88, v89, v90
v_max3_u32 v26, v26, v91, v92
v_max_u32 v26, v26, v93
v_cmp_eq_u32 vcc, -1, v26
v_dot2_f32_bf16 v100, v88, s55, v116
v_dot2_f32_bf16 v101, v88, s56, v117
v_dot2_f32_bf16 v102, v89, s55, v118
v_dot2_f32_bf16 v103, v89, s56, v119
v_dot2_f32_bf16 v100, v90, s55, v100
v_dot2_f32_bf16 v101, v90, s56, v101
v_dot2_f32_bf16 v102, v91, s55, v102
v_dot2_f32_bf16 v103, v91, s56, v103
v_dot2_f32_bf16 v100, v92, s55, v100
v_dot2_f32_bf16 v101, v92, s56, v101
v_dot2_f32_bf16 v102, v93, s55, v102
v_dot2_f32_bf16 v103, v93, s56, v103
s_nop 1
v_cvt_pk_bf16_f32 v100, v100, v101
v_cvt_pk_bf16_f32 v101, v102, v103
v_min_u32 v100, -2, v100
v_min_u32 v101, -2, v101
s_cbranch_vccz Lxs_430
buffer_load_dwordx2 v[88:89], v13, s[4:7], s84 offen sc1
buffer_load_dwordx2 v[90:91], v14, s[4:7], s84 offen sc1
buffer_load_dwordx2 v[92:93], v15, s[4:7], s84 offen sc1
s_waitcnt vmcnt(6)
v_max3_u32 v26, v28, v29, v30
v_max3_u32 v26, v26, v31, v32
v_max_u32 v26, v26, v33
v_cmp_eq_u32 vcc, -1, v26
v_dot2_f32_bf16 v100, v28, s55, v116
v_dot2_f32_bf16 v101, v28, s56, v117
v_dot2_f32_bf16 v102, v29, s55, v118
v_dot2_f32_bf16 v103, v29, s56, v119
v_dot2_f32_bf16 v100, v30, s55, v100
v_dot2_f32_bf16 v101, v30, s56, v101
v_dot2_f32_bf16 v102, v31, s55, v102
v_dot2_f32_bf16 v103, v31, s56, v103
v_dot2_f32_bf16 v100, v32, s55, v100
v_dot2_f32_bf16 v101, v32, s56, v101
v_dot2_f32_bf16 v102, v33, s55, v102
v_dot2_f32_bf16 v103, v33, s56, v103
s_nop 1
v_cvt_pk_bf16_f32 v100, v100, v101
v_cvt_pk_bf16_f32 v101, v102, v103
v_min_u32 v100, -2, v100
v_min_u32 v101, -2, v101
s_cbranch_vccz Lxs_430
buffer_load_dwordx2 v[28:29], v13, s[4:7], s85 offen sc1
buffer_load_dwordx2 v[30:31], v14, s[4:7], s85 offen sc1
buffer_load_dwordx2 v[32:33], v15, s[4:7], s85 offen sc1
s_waitcnt vmcnt(6)
v_max3_u32 v26, v76, v77, v78
v_max3_u32 v26, v26, v79, v80
v_max_u32 v26, v26, v81
v_cmp_eq_u32 vcc, -1, v26
v_dot2_f32_bf16 v100, v76, s55, v116
v_dot2_f32_bf16 v101, v76, s56, v117
v_dot2_f32_bf16 v102, v77, s55, v118
v_dot2_f32_bf16 v103, v77, s56, v119
v_dot2_f32_bf16 v100, v78, s55, v100
v_dot2_f32_bf16 v101, v78, s56, v101
v_dot2_f32_bf16 v102, v79, s55, v102
v_dot2_f32_bf16 v103, v79, s56, v103
v_dot2_f32_bf16 v100, v80, s55, v100
v_dot2_f32_bf16 v101, v80, s56, v101
v_dot2_f32_bf16 v102, v81, s55, v102
v_dot2_f32_bf16 v103, v81, s56, v103
s_nop 1
v_cvt_pk_bf16_f32 v100, v100, v101
v_cvt_pk_bf16_f32 v101, v102, v103
v_min_u32 v100, -2, v100
v_min_u32 v101, -2, v101
s_cbranch_vccz Lxs_430
buffer_load_dwordx2 v[76:77], v13, s[4:7], s84 offen sc1
buffer_load_dwordx2 v[78:79], v14, s[4:7], s84 offen sc1
buffer_load_dwordx2 v[80:81], v15, s[4:7], s84 offen sc1
s_waitcnt vmcnt(6)
v_max3_u32 v26, v88, v89, v90
v_max3_u32 v26, v26, v91, v92
v_max_u32 v26, v26, v93
v_cmp_eq_u32 vcc, -1, v26
v_dot2_f32_bf16 v100, v88, s55, v116
v_dot2_f32_bf16 v101, v88, s56, v117
v_dot2_f32_bf16 v102, v89, s55, v118
v_dot2_f32_bf16 v103, v89, s56, v119
v_dot2_f32_bf16 v100, v90, s55, v100
v_dot2_f32_bf16 v101, v90, s56, v101
v_dot2_f32_bf16 v102, v91, s55, v102
v_dot2_f32_bf16 v103, v91, s56, v103
v_dot2_f32_bf16 v100, v92, s55, v100
v_dot2_f32_bf16 v101, v92, s56, v101
v_dot2_f32_bf16 v102, v93, s55, v102
v_dot2_f32_bf16 v103, v93, s56, v103
s_nop 1
v_cvt_pk_bf16_f32 v100, v100, v101
v_cvt_pk_bf16_f32 v101, v102, v103
v_min_u32 v100, -2, v100
v_min_u32 v101, -2, v101
s_cbranch_vccz Lxs_430
buffer_load_dwordx2 v[88:89], v13, s[4:7], s85 offen sc1
buffer_load_dwordx2 v[90:91], v14, s[4:7], s85 offen sc1
buffer_load_dwordx2 v[92:93], v15, s[4:7], s85 offen sc1
s_waitcnt vmcnt(6)
v_max3_u32 v26, v28, v29, v30
v_max3_u32 v26, v26, v31, v32
v_max_u32 v26, v26, v33
v_cmp_eq_u32 vcc, -1, v26
v_dot2_f32_bf16 v100, v28, s55, v116
v_dot2_f32_bf16 v101, v28, s56, v117
v_dot2_f32_bf16 v102, v29, s55, v118
v_dot2_f32_bf16 v103, v29, s56, v119
v_dot2_f32_bf16 v100, v30, s55, v100
v_dot2_f32_bf16 v101, v30, s56, v101
v_dot2_f32_bf16 v102, v31, s55, v102
v_dot2_f32_bf16 v103, v31, s56, v103
v_dot2_f32_bf16 v100, v32, s55, v100
v_dot2_f32_bf16 v101, v32, s56, v101
v_dot2_f32_bf16 v102, v33, s55, v102
v_dot2_f32_bf16 v103, v33, s56, v103
s_nop 1
v_cvt_pk_bf16_f32 v100, v100, v101
v_cvt_pk_bf16_f32 v101, v102, v103
v_min_u32 v100, -2, v100
v_min_u32 v101, -2, v101
s_cbranch_vccz Lxs_430
buffer_load_dwordx2 v[28:29], v13, s[4:7], s84 offen sc1
buffer_load_dwordx2 v[30:31], v14, s[4:7], s84 offen sc1
buffer_load_dwordx2 v[32:33], v15, s[4:7], s84 offen sc1
s_waitcnt vmcnt(6)
v_max3_u32 v26, v76, v77, v78
v_max3_u32 v26, v26, v79, v80
v_max_u32 v26, v26, v81
v_cmp_eq_u32 vcc, -1, v26
v_dot2_f32_bf16 v100, v76, s55, v116
v_dot2_f32_bf16 v101, v76, s56, v117
v_dot2_f32_bf16 v102, v77, s55, v118
v_dot2_f32_bf16 v103, v77, s56, v119
v_dot2_f32_bf16 v100, v78, s55, v100
v_dot2_f32_bf16 v101, v78, s56, v101
v_dot2_f32_bf16 v102, v79, s55, v102
v_dot2_f32_bf16 v103, v79, s56, v103
v_dot2_f32_bf16 v100, v80, s55, v100
v_dot2_f32_bf16 v101, v80, s56, v101
v_dot2_f32_bf16 v102, v81, s55, v102
v_dot2_f32_bf16 v103, v81, s56, v103
s_nop 1
v_cvt_pk_bf16_f32 v100, v100, v101
v_cvt_pk_bf16_f32 v101, v102, v103
v_min_u32 v100, -2, v100
v_min_u32 v101, -2, v101
s_cbranch_vccz Lxs_430
s_sub_u32 s37, s37, 1
s_cbranch_scc1 Lend_8
s_branch Lx2_429
Lpf_416:
buffer_load_dwordx4 v[28:31], v8, s[4:7], s40 offen offset:0 sc1
v_mfma_f32_16x16x32_bf16 v[16:19], v[20:23], v[20:23], 0
s_sub_u32 s37, s37, 1
s_cbranch_scc1 Lend_8
Lps_431:
s_waitcnt vmcnt(3)
v_max3_u32 v26, v32, v33, v34
v_max_u32 v26, v26, v35
v_cmp_eq_u32 vcc, -1, v26
s_cbranch_vccnz Lpf_432
v_smfmac_f32_16x16x64_bf16 v[44:47], v[32:35], a[32:39], v126
v_smfmac_f32_16x16x64_bf16 v[48:51], v[32:35], a[40:47], v126
v_smfmac_f32_16x16x64_bf16 v[52:55], v[32:35], a[48:55], v126
v_smfmac_f32_16x16x64_bf16 v[56:59], v[32:35], a[56:63], v126
v_smfmac_f32_16x16x64_bf16 v[60:63], v[32:35], v[160:167], v126
v_smfmac_f32_16x16x64_bf16 v[64:67], v[32:35], v[168:175], v126
Lps_433:
s_waitcnt vmcnt(2)
v_max3_u32 v26, v36, v37, v38
v_max_u32 v26, v26, v39
v_cmp_eq_u32 vcc, -1, v26
s_cbranch_vccnz Lpf_434
v_smfmac_f32_16x16x64_bf16 v[44:47], v[36:39], a[64:71], v126
v_smfmac_f32_16x16x64_bf16 v[48:51], v[36:39], a[72:79], v126
v_smfmac_f32_16x16x64_bf16 v[52:55], v[36:39], a[80:87], v126
v_smfmac_f32_16x16x64_bf16 v[56:59], v[36:39], a[88:95], v126
v_smfmac_f32_16x16x64_bf16 v[60:63], v[36:39], v[192:199], v126
v_smfmac_f32_16x16x64_bf16 v[64:67], v[36:39], v[200:207], v126
Lps_435:
s_waitcnt vmcnt(1)
v_max3_u32 v26, v40, v41, v42
v_max_u32 v26, v26, v43
v_cmp_eq_u32 vcc, -1, v26
s_cbranch_vccnz Lpf_436
v_smfmac_f32_16x16x64_bf16 v[44:47], v[40:43], a[96:103], v126
v_smfmac_f32_16x16x64_bf16 v[48:51], v[40:43], a[104:111], v126
v_smfmac_f32_16x16x64_bf16 v[52:55], v[40:43], a[112:119], v126
v_smfmac_f32_16x16x64_bf16 v[56:59], v[40:43], a[120:127], v126
v_smfmac_f32_16x16x64_bf16 v[60:63], v[40:43], v[224:231], v126
v_smfmac_f32_16x16x64_bf16 v[64:67], v[40:43], v[232:239], v126
Lps_437:
s_waitcnt vmcnt(0)
v_max3_u32 v26, v28, v29, v30
v_max_u32 v26, v26, v31
v_cmp_eq_u32 vcc, -1, v26
s_cbranch_vccnz Lpf_438
v_smfmac_f32_16x16x64_bf16 v[44:47], v[28:31], a[0:7], v126
v_smfmac_f32_16x16x64_bf16 v[48:51], v[28:31], a[8:15], v126
v_smfmac_f32_16x16x64_bf16 v[52:55], v[28:31], a[16:23], v126
v_smfmac_f32_16x16x64_bf16 v[56:59], v[28:31], a[24:31], v126
v_smfmac_f32_16x16x64_bf16 v[60:63], v[28:31], v[128:135], v126
v_smfmac_f32_16x16x64_bf16 v[64:67], v[28:31], v[136:143], v126
s_branch Lpd_415
Lpf_417:
buffer_load_dwordx4 v[32:35], v8, s[4:7], s40 offen offset:1024 sc1
v_mfma_f32_16x16x32_bf16 v[16:19], v[20:23], v[20:23], 0
s_sub_u32 s37, s37, 1
s_cbranch_scc1 Lend_8
Lps_439:
s_waitcnt vmcnt(2)
v_max3_u32 v26, v36, v37, v38
v_max_u32 v26, v26, v39
v_cmp_eq_u32 vcc, -1, v26
s_cbranch_vccnz Lpf_440
v_smfmac_f32_16x16x64_bf16 v[44:47], v[36:39], a[64:71], v126
v_smfmac_f32_16x16x64_bf16 v[48:51], v[36:39], a[72:79], v126
v_smfmac_f32_16x16x64_bf16 v[52:55], v[36:39], a[80:87], v126
v_smfmac_f32_16x16x64_bf16 v[56:59], v[36:39], a[88:95], v126
v_smfmac_f32_16x16x64_bf16 v[60:63], v[36:39], v[192:199], v126
v_smfmac_f32_16x16x64_bf16 v[64:67], v[36:39], v[200:207], v126
Lps_441:
s_waitcnt vmcnt(1)
v_max3_u32 v26, v40, v41, v42
v_max_u32 v26, v26, v43
v_cmp_eq_u32 vcc, -1, v26
s_cbranch_vccnz Lpf_442
v_smfmac_f32_16x16x64_bf16 v[44:47], v[40:43], a[96:103], v126
v_smfmac_f32_16x16x64_bf16 v[48:51], v[40:43], a[104:111], v126
v_smfmac_f32_16x16x64_bf16 v[52:55], v[40:43], a[112:119], v126
v_smfmac_f32_16x16x64_bf16 v[56:59], v[40:43], a[120:127], v126
v_smfmac_f32_16x16x64_bf16 v[60:63], v[40:43], v[224:231], v126
v_smfmac_f32_16x16x64_bf16 v[64:67], v[40:43], v[232:239], v126
Lps_443:
s_waitcnt vmcnt(0)
v_max3_u32 v26, v32, v33, v34
v_max_u32 v26, v26, v35
v_cmp_eq_u32 vcc, -1, v26
s_cbranch_vccnz Lpf_444
v_smfmac_f32_16x16x64_bf16 v[44:47], v[32:35], a[32:39], v126
v_smfmac_f32_16x16x64_bf16 v[48:51], v[32:35], a[40:47], v126
v_smfmac_f32_16x16x64_bf16 v[52:55], v[32:35], a[48:55], v126
v_smfmac_f32_16x16x64_bf16 v[56:59], v[32:35], a[56:63], v126
v_smfmac_f32_16x16x64_bf16 v[60:63], v[32:35], v[160:167], v126
v_smfmac_f32_16x16x64_bf16 v[64:67], v[32:35], v[168:175], v126
s_branch Lpd_415
Lpf_418:
buffer_load_dwordx4 v[36:39], v8, s[4:7], s40 offen offset:2048 sc1
v_mfma_f32_16x16x32_bf16 v[16:19], v[20:23], v[20:23], 0
s_sub_u32 s37, s37, 1
s_cbranch_scc1 Lend_8
Lps_445:
s_waitcnt vmcnt(1)
v_max3_u32 v26, v40, v41, v42
v_max_u32 v26, v26, v43
v_cmp_eq_u32 vcc, -1, v26
s_cbranch_vccnz Lpf_446
v_smfmac_f32_16x16x64_bf16 v[44:47], v[40:43], a[96:103], v126
v_smfmac_f32_16x16x64_bf16 v[48:51], v[40:43], a[104:111], v126
v_smfmac_f32_16x16x64_bf16 v[52:55], v[40:43], a[112:119], v126
v_smfmac_f32_16x16x64_bf16 v[56:59], v[40:43], a[120:127], v126
v_smfmac_f32_16x16x64_bf16 v[60:63], v[40:43], v[224:231], v126
v_smfmac_f32_16x16x64_bf16 v[64:67], v[40:43], v[232:239], v126
Lps_447:
s_waitcnt vmcnt(0)
v_max3_u32 v26, v36, v37, v38
v_max_u32 v26, v26, v39
v_cmp_eq_u32 vcc, -1, v26
s_cbranch_vccnz Lpf_448
v_smfmac_f32_16x16x64_bf16 v[44:47], v[36:39], a[64:71], v126
v_smfmac_f32_16x16x64_bf16 v[48:51], v[36:39], a[72:79], v126
v_smfmac_f32_16x16x64_bf16 v[52:55], v[36:39], a[80:87], v126
v_smfmac_f32_16x16x64_bf16 v[56:59], v[36:39], a[88:95], v126
v_smfmac_f32_16x16x64_bf16 v[60:63], v[36:39], v[192:199], v126
v_smfmac_f32_16x16x64_bf16 v[64:67], v[36:39], v[200:207], v126
s_branch Lpd_415
Lpf_419:
buffer_load_dwordx4 v[40:43], v8, s[4:7], s40 offen offset:3072 sc1
v_mfma_f32_16x16x32_bf16 v[16:19], v[20:23], v[20:23], 0
s_sub_u32 s37, s37, 1
s_cbranch_scc1 Lend_8
Lps_449:
s_waitcnt vmcnt(0)
v_max3_u32 v26, v40, v41, v42
v_max_u32 v26, v26, v43
v_cmp_eq_u32 vcc, -1, v26
s_cbranch_vccnz Lpf_450
v_smfmac_f32_16x16x64_bf16 v[44:47], v[40:43], a[96:103], v126
v_smfmac_f32_16x16x64_bf16 v[48:51], v[40:43], a[104:111], v126
v_smfmac_f32_16x16x64_bf16 v[52:55], v[40:43], a[112:119], v126
v_smfmac_f32_16x16x64_bf16 v[56:59], v[40:43], a[120:127], v126
v_smfmac_f32_16x16x64_bf16 v[60:63], v[40:43], v[224:231], v126
v_smfmac_f32_16x16x64_bf16 v[64:67], v[40:43], v[232:239], v126
s_branch Lpd_415
Lpf_432:
buffer_load_dwordx4 v[32:35], v8, s[4:7], s40 offen offset:1024 sc1
v_mfma_f32_16x16x32_bf16 v[16:19], v[20:23], v[20:23], 0
Lps_451:
s_waitcnt vmcnt(3)
v_max3_u32 v26, v36, v37, v38
v_max_u32 v26, v26, v39
v_cmp_eq_u32 vcc, -1, v26
s_cbranch_vccnz Lpf_452
v_smfmac_f32_16x16x64_bf16 v[44:47], v[36:39], a[64:71], v126
v_smfmac_f32_16x16x64_bf16 v[48:51], v[36:39], a[72:79], v126
v_smfmac_f32_16x16x64_bf16 v[52:55], v[36:39], a[80:87], v126
v_smfmac_f32_16x16x64_bf16 v[56:59], v[36:39], a[88:95], v126
v_smfmac_f32_16x16x64_bf16 v[60:63], v[36:39], v[192:199], v126
v_smfmac_f32_16x16x64_bf16 v[64:67], v[36:39], v[200:207], v126
Lps_453:
s_waitcnt vmcnt(2)
v_max3_u32 v26, v40, v41, v42
v_max_u32 v26, v26, v43
v_cmp_eq_u32 vcc, -1, v26
s_cbranch_vccnz Lpf_454
v_smfmac_f32_16x16x64_bf16 v[44:47], v[40:43], a[96:103], v126
v_smfmac_f32_16x16x64_bf16 v[48:51], v[40:43], a[104:111], v126
v_smfmac_f32_16x16x64_bf16 v[52:55], v[40:43], a[112:119], v126
v_smfmac_f32_16x16x64_bf16 v[56:59], v[40:43], a[120:127], v126
v_smfmac_f32_16x16x64_bf16 v[60:63], v[40:43], v[224:231], v126
v_smfmac_f32_16x16x64_bf16 v[64:67], v[40:43], v[232:239], v126
Lps_455:
s_waitcnt vmcnt(1)
v_max3_u32 v26, v28, v29, v30
v_max_u32 v26, v26, v31
v_cmp_eq_u32 vcc, -1, v26
s_cbranch_vccnz Lpf_456
v_smfmac_f32_16x16x64_bf16 v[44:47], v[28:31], a[0:7], v126
v_smfmac_f32_16x16x64_bf16 v[48:51], v[28:31], a[8:15], v126
v_smfmac_f32_16x16x64_bf16 v[52:55], v[28:31], a[16:23], v126
v_smfmac_f32_16x16x64_bf16 v[56:59], v[28:31], a[24:31], v126
v_smfmac_f32_16x16x64_bf16 v[60:63], v[28:31], v[128:135], v126
v_smfmac_f32_16x16x64_bf16 v[64:67], v[28:31], v[136:143], v126
s_branch Lps_443
Lpf_434:
buffer_load_dwordx4 v[36:39], v8, s[4:7], s40 offen offset:2048 sc1
v_mfma_f32_16x16x32_bf16 v[16:19], v[20:23], v[20:23], 0
Lps_457:
s_waitcnt vmcnt(2)
v_max3_u32 v26, v40, v41, v42
v_max_u32 v26, v26, v43
v_cmp_eq_u32 vcc, -1, v26
s_cbranch_vccnz Lpf_458
v_smfmac_f32_16x16x64_bf16 v[44:47], v[40:43], a[96:103], v126
v_smfmac_f32_16x16x64_bf16 v[48:51], v[40:43], a[104:111], v126
v_smfmac_f32_16x16x64_bf16 v[52:55], v[40:43], a[112:119], v126
v_smfmac_f32_16x16x64_bf16 v[56:59], v[40:43], a[120:127], v126
v_smfmac_f32_16x16x64_bf16 v[60:63], v[40:43], v[224:231], v126
v_smfmac_f32_16x16x64_bf16 v[64:67], v[40:43], v[232:239], v126
Lps_459:
s_waitcnt vmcnt(1)
v_max3_u32 v26, v28, v29, v30
v_max_u32 v26, v26, v31
v_cmp_eq_u32 vcc, -1, v26
s_cbranch_vccnz Lpf_460
v_smfmac_f32_16x16x64_bf16 v[44:47], v[28:31], a[0:7], v126
v_smfmac_f32_16x16x64_bf16 v[48:51], v[28:31], a[8:15], v126
v_smfmac_f32_16x16x64_bf16 v[52:55], v[28:31], a[16:23], v126
v_smfmac_f32_16x16x64_bf16 v[56:59], v[28:31], a[24:31], v126
v_smfmac_f32_16x16x64_bf16 v[60:63], v[28:31], v[128:135], v126
v_smfmac_f32_16x16x64_bf16 v[64:67], v[28:31], v[136:143], v126
s_branch Lps_447
Lpf_436:
buffer_load_dwordx4 v[40:43], v8, s[4:7], s40 offen offset:3072 sc1
v_mfma_f32_16x16x32_bf16 v[16:19], v[20:23], v[20:23], 0
Lps_461:
s_waitcnt vmcnt(1)
v_max3_u32 v26, v28, v29, v30
v_max_u32 v26, v26, v31
v_cmp_eq_u32 vcc, -1, v26
s_cbranch_vccnz Lpf_462
v_smfmac_f32_16x16x64_bf16 v[44:47], v[28:31], a[0:7], v126
v_smfmac_f32_16x16x64_bf16 v[48:51], v[28:31], a[8:15], v126
v_smfmac_f32_16x16x64_bf16 v[52:55], v[28:31], a[16:23], v126
v_smfmac_f32_16x16x64_bf16 v[56:59], v[28:31], a[24:31], v126
v_smfmac_f32_16x16x64_bf16 v[60:63], v[28:31], v[128:135], v126
v_smfmac_f32_16x16x64_bf16 v[64:67], v[28:31], v[136:143], v126
s_branch Lps_449
Lpf_438:
buffer_load_dwordx4 v[28:31], v8, s[4:7], s40 offen offset:0 sc1
v_mfma_f32_16x16x32_bf16 v[16:19], v[20:23], v[20:23], 0
s_sub_u32 s37, s37, 1
s_cbranch_scc1 Lend_8
s_branch Lps_437
Lpf_440:
buffer_load_dwordx4 v[36:39], v8, s[4:7], s40 offen offset:2048 sc1
v_mfma_f32_16x16x32_bf16 v[16:19], v[20:23], v[20:23], 0
Lps_463:
s_waitcnt vmcnt(2)
v_max3_u32 v26, v40, v41, v42
v_max_u32 v26, v26, v43
v_cmp_eq_u32 vcc, -1, v26
s_cbranch_vccnz Lpf_464
v_smfmac_f32_16x16x64_bf16 v[44:47], v[40:43], a[96:103], v126
v_smfmac_f32_16x16x64_bf16 v[48:51], v[40:43], a[104:111], v126
v_smfmac_f32_16x16x64_bf16 v[52:55], v[40:43], a[112:119], v126
v_smfmac_f32_16x16x64_bf16 v[56:59], v[40:43], a[120:127], v126
v_smfmac_f32_16x16x64_bf16 v[60:63], v[40:43], v[224:231], v126
v_smfmac_f32_16x16x64_bf16 v[64:67], v[40:43], v[232:239], v126
Lps_465:
s_waitcnt vmcnt(1)
v_max3_u32 v26, v32, v33, v34
v_max_u32 v26, v26, v35
v_cmp_eq_u32 vcc, -1, v26
s_cbranch_vccnz Lpf_466
v_smfmac_f32_16x16x64_bf16 v[44:47], v[32:35], a[32:39], v126
v_smfmac_f32_16x16x64_bf16 v[48:51], v[32:35], a[40:47], v126
v_smfmac_f32_16x16x64_bf16 v[52:55], v[32:35], a[48:55], v126
v_smfmac_f32_16x16x64_bf16 v[56:59], v[32:35], a[56:63], v126
v_smfmac_f32_16x16x64_bf16 v[60:63], v[32:35], v[160:167], v126
v_smfmac_f32_16x16x64_bf16 v[64:67], v[32:35], v[168:175], v126
s_branch Lps_447
Lpf_442:
buffer_load_dwordx4 v[40:43], v8, s[4:7], s40 offen offset:3072 sc1
v_mfma_f32_16x16x32_bf16 v[16:19], v[20:23], v[20:23], 0
Lps_467:
s_waitcnt vmcnt(1)
v_max3_u32 v26, v32, v33, v34
v_max_u32 v26, v26, v35
v_cmp_eq_u32 vcc, -1, v26
s_cbranch_vccnz Lpf_468
v_smfmac_f32_16x16x64_bf16 v[44:47], v[32:35], a[32:39], v126
v_smfmac_f32_16x16x64_bf16 v[48:51], v[32:35], a[40:47], v126
v_smfmac_f32_16x16x64_bf16 v[52:55], v[32:35], a[48:55], v126
v_smfmac_f32_16x16x64_bf16 v[56:59], v[32:35], a[56:63], v126
v_smfmac_f32_16x16x64_bf16 v[60:63], v[32:35], v[160:167], v126
v_smfmac_f32_16x16x64_bf16 v[64:67], v[32:35], v[168:175], v126
s_branch Lps_449
Lpf_444:
buffer_load_dwordx4 v[32:35], v8, s[4:7], s40 offen offset:1024 sc1
v_mfma_f32_16x16x32_bf16 v[16:19], v[20:23], v[20:23], 0
s_sub_u32 s37, s37, 1
s_cbranch_scc1 Lend_8
s_branch Lps_443
Lpf_446:
buffer_load_dwordx4 v[40:43], v8, s[4:7], s40 offen offset:3072 sc1
v_mfma_f32_16x16x32_bf16 v[16:19], v[20:23], v[20:23], 0
Lps_469:
s_waitcnt vmcnt(1)
v_max3_u32 v26, v36, v37, v38
v_max_u32 v26, v26, v39
v_cmp_eq_u32 vcc, -1, v26
s_cbranch_vccnz Lpf_470
v_smfmac_f32_16x16x64_bf16 v[44:47], v[36:39], a[64:71], v126
v_smfmac_f32_16x16x64_bf16 v[48:51], v[36:39], a[72:79], v126
v_smfmac_f32_16x16x64_bf16 v[52:55], v[36:39], a[80:87], v126
v_smfmac_f32_16x16x64_bf16 v[56:59], v[36:39], a[88:95], v126
v_smfmac_f32_16x16x64_bf16 v[60:63], v[36:39], v[192:199], v126
v_smfmac_f32_16x16x64_bf16 v[64:67], v[36:39], v[200:207], v126
s_branch Lps_449
Lpf_448:
buffer_load_dwordx4 v[36:39], v8, s[4:7], s40 offen offset:2048 sc1
v_mfma_f32_16x16x32_bf16 v[16:19], v[20:23], v[20:23], 0
s_sub_u32 s37, s37, 1
s_cbranch_scc1 Lend_8
s_branch Lps_447
Lpf_450:
buffer_load_dwordx4 v[40:43], v8, s[4:7], s40 offen offset:3072 sc1
v_mfma_f32_16x16x32_bf16 v[16:19], v[20:23], v[20:23], 0
s_sub_u32 s37, s37, 1
s_cbranch_scc1 Lend_8
s_branch Lps_449
Lpf_452:
buffer_load_dwordx4 v[36:39], v8, s[4:7], s40 offen offset:2048 sc1
v_mfma_f32_16x16x32_bf16 v[16:19], v[20:23], v[20:23], 0
Lps_471:
s_waitcnt vmcnt(3)
v_max3_u32 v26, v40, v41, v42
v_max_u32 v26, v26, v43
v_cmp_eq_u32 vcc, -1, v26
s_cbranch_vccnz Lpf_472
v_smfmac_f32_16x16x64_bf16 v[44:47], v[40:43], a[96:103], v126
v_smfmac_f32_16x16x64_bf16 v[48:51], v[40:43], a[104:111], v126
v_smfmac_f32_16x16x64_bf16 v[52:55], v[40:43], a[112:119], v126
v_smfmac_f32_16x16x64_bf16 v[56:59], v[40:43], a[120:127], v126
v_smfmac_f32_16x16x64_bf16 v[60:63], v[40:43], v[224:231], v126
v_smfmac_f32_16x16x64_bf16 v[64:67], v[40:43], v[232:239], v126
Lps_473:
s_waitcnt vmcnt(2)
v_max3_u32 v26, v28, v29, v30
v_max_u32 v26, v26, v31
v_cmp_eq_u32 vcc, -1, v26
s_cbranch_vccnz Lpf_474
v_smfmac_f32_16x16x64_bf16 v[44:47], v[28:31], a[0:7], v126
v_smfmac_f32_16x16x64_bf16 v[48:51], v[28:31], a[8:15], v126
v_smfmac_f32_16x16x64_bf16 v[52:55], v[28:31], a[16:23], v126
v_smfmac_f32_16x16x64_bf16 v[56:59], v[28:31], a[24:31], v126
v_smfmac_f32_16x16x64_bf16 v[60:63], v[28:31], v[128:135], v126
v_smfmac_f32_16x16x64_bf16 v[64:67], v[28:31], v[136:143], v126
s_branch Lps_465
Lpf_454:
buffer_load_dwordx4 v[40:43], v8, s[4:7], s40 offen offset:3072 sc1
v_mfma_f32_16x16x32_bf16 v[16:19], v[20:23], v[20:23], 0
Lps_475:
s_waitcnt vmcnt(2)
v_max3_u32 v26, v28, v29, v30
v_max_u32 v26, v26, v31
v_cmp_eq_u32 vcc, -1, v26
s_cbranch_vccnz Lpf_476
v_smfmac_f32_16x16x64_bf16 v[44:47], v[28:31], a[0:7], v126
v_smfmac_f32_16x16x64_bf16 v[48:51], v[28:31], a[8:15], v126
v_smfmac_f32_16x16x64_bf16 v[52:55], v[28:31], a[16:23], v126
v_smfmac_f32_16x16x64_bf16 v[56:59], v[28:31], a[24:31], v126
v_smfmac_f32_16x16x64_bf16 v[60:63], v[28:31], v[128:135], v126
v_smfmac_f32_16x16x64_bf16 v[64:67], v[28:31], v[136:143], v126
s_branch Lps_467
Lpf_456:
buffer_load_dwordx4 v[28:31], v8, s[4:7], s40 offen offset:0 sc1
v_mfma_f32_16x16x32_bf16 v[16:19], v[20:23], v[20:23], 0
s_sub_u32 s37, s37, 1
s_cbranch_scc1 Lend_8
Lps_477:
s_waitcnt vmcnt(1)
v_max3_u32 v26, v32, v33, v34
v_max_u32 v26, v26, v35
v_cmp_eq_u32 vcc, -1, v26
s_cbranch_vccnz Lpf_478
v_smfmac_f32_16x16x64_bf16 v[44:47], v[32:35], a[32:39], v126
v_smfmac_f32_16x16x64_bf16 v[48:51], v[32:35], a[40:47], v126
v_smfmac_f32_16x16x64_bf16 v[52:55], v[32:35], a[48:55], v126
v_smfmac_f32_16x16x64_bf16 v[56:59], v[32:35], a[56:63], v126
v_smfmac_f32_16x16x64_bf16 v[60:63], v[32:35], v[160:167], v126
v_smfmac_f32_16x16x64_bf16 v[64:67], v[32:35], v[168:175], v126
s_branch Lps_437
Lpf_458:
buffer_load_dwordx4 v[40:43], v8, s[4:7], s40 offen offset:3072 sc1
v_mfma_f32_16x16x32_bf16 v[16:19], v[20:23], v[20:23], 0
Lps_479:
s_waitcnt vmcnt(2)
v_max3_u32 v26, v28, v29, v30
v_max_u32 v26, v26, v31
v_cmp_eq_u32 vcc, -1, v26
s_cbranch_vccnz Lpf_480
v_smfmac_f32_16x16x64_bf16 v[44:47], v[28:31], a[0:7], v126
v_smfmac_f32_16x16x64_bf16 v[48:51], v[28:31], a[8:15], v126
v_smfmac_f32_16x16x64_bf16 v[52:55], v[28:31], a[16:23], v126
v_smfmac_f32_16x16x64_bf16 v[56:59], v[28:31], a[24:31], v126
v_smfmac_f32_16x16x64_bf16 v[60:63], v[28:31], v[128:135], v126
v_smfmac_f32_16x16x64_bf16 v[64:67], v[28:31], v[136:143], v126
s_branch Lps_469
Lpf_460:
buffer_load_dwordx4 v[28:31], v8, s[4:7], s40 offen offset:0 sc1
v_mfma_f32_16x16x32_bf16 v[16:19], v[20:23], v[20:23], 0
s_sub_u32 s37, s37, 1
s_cbranch_scc1 Lend_8
Lps_481:
s_waitcnt vmcnt(1)
v_max3_u32 v26, v36, v37, v38
v_max_u32 v26, v26, v39
v_cmp_eq_u32 vcc, -1, v26
s_cbranch_vccnz Lpf_482
v_smfmac_f32_16x16x64_bf16 v[44:47], v[36:39], a[64:71], v126
v_smfmac_f32_16x16x64_bf16 v[48:51], v[36:39], a[72:79], v126
v_smfmac_f32_16x16x64_bf16 v[52:55], v[36:39], a[80:87], v126
v_smfmac_f32_16x16x64_bf16 v[56:59], v[36:39], a[88:95], v126
v_smfmac_f32_16x16x64_bf16 v[60:63], v[36:39], v[192:199], v126
v_smfmac_f32_16x16x64_bf16 v[64:67], v[36:39], v[200:207], v126
s_branch Lps_437
Lpf_462:
buffer_load_dwordx4 v[28:31], v8, s[4:7], s40 offen offset:0 sc1
v_mfma_f32_16x16x32_bf16 v[16:19], v[20:23], v[20:23], 0
s_sub_u32 s37, s37, 1
s_cbranch_scc1 Lend_8
s_branch Lps_435
Lpf_464:
buffer_load_dwordx4 v[40:43], v8, s[4:7], s40 offen offset:3072 sc1
v_mfma_f32_16x16x32_bf16 v[16:19], v[20:23], v[20:23], 0
Lps_483:
s_waitcnt vmcnt(2)
v_max3_u32 v26, v32, v33, v34
v_max_u32 v26, v26, v35
v_cmp_eq_u32 vcc, -1, v26
s_cbranch_vccnz Lpf_484
v_smfmac_f32_16x16x64_bf16 v[44:47], v[32:35], a[32:39], v126
v_smfmac_f32_16x16x64_bf16 v[48:51], v[32:35], a[40:47], v126
v_smfmac_f32_16x16x64_bf16 v[52:55], v[32:35], a[48:55], v126
v_smfmac_f32_16x16x64_bf16 v[56:59], v[32:35], a[56:63], v126
v_smfmac_f32_16x16x64_bf16 v[60:63], v[32:35], v[160:167], v126
v_smfmac_f32_16x16x64_bf16 v[64:67], v[32:35], v[168:175], v126
s_branch Lps_469
Lpf_466:
buffer_load_dwordx4 v[32:35], v8, s[4:7], s40 offen offset:1024 sc1
v_mfma_f32_16x16x32_bf16 v[16:19], v[20:23], v[20:23], 0
s_sub_u32 s37, s37, 1
s_cbranch_scc1 Lend_8
Lps_485:
s_waitcnt vmcnt(1)
v_max3_u32 v26, v36, v37, v38
v_max_u32 v26, v26, v39
v_cmp_eq_u32 vcc, -1, v26
s_cbranch_vccnz Lpf_486
v_smfmac_f32_16x16x64_bf16 v[44:47], v[36:39], a[64:71], v126
v_smfmac_f32_16x16x64_bf16 v[48:51], v[36:39], a[72:79], v126
v_smfmac_f32_16x16x64_bf16 v[52:55], v[36:39], a[80:87], v126
v_smfmac_f32_16x16x64_bf16 v[56:59], v[36:39], a[88:95], v126
v_smfmac_f32_16x16x64_bf16 v[60:63], v[36:39], v[192:199], v126
v_smfmac_f32_16x16x64_bf16 v[64:67], v[36:39], v[200:207], v126
s_branch Lps_443
Lpf_468:
buffer_load_dwordx4 v[32:35], v8, s[4:7], s40 offen offset:1024 sc1
v_mfma_f32_16x16x32_bf16 v[16:19], v[20:23], v[20:23], 0
s_sub_u32 s37, s37, 1
s_cbranch_scc1 Lend_8
s_branch Lps_441
Lpf_470:
buffer_load_dwordx4 v[36:39], v8, s[4:7], s40 offen offset:2048 sc1
v_mfma_f32_16x16x32_bf16 v[16:19], v[20:23], v[20:23], 0
s_sub_u32 s37, s37, 1
s_cbranch_scc1 Lend_8
s_branch Lps_445
Lpf_472:
buffer_load_dwordx4 v[40:43], v8, s[4:7], s40 offen offset:3072 sc1
v_mfma_f32_16x16x32_bf16 v[16:19], v[20:23], v[20:23], 0
Lps_487:
s_waitcnt vmcnt(3)
v_max3_u32 v26, v28, v29, v30
v_max_u32 v26, v26, v31
v_cmp_eq_u32 vcc, -1, v26
s_cbranch_vccnz Lpf_488
v_smfmac_f32_16x16x64_bf16 v[44:47], v[28:31], a[0:7], v126
v_smfmac_f32_16x16x64_bf16 v[48:51], v[28:31], a[8:15], v126
v_smfmac_f32_16x16x64_bf16 v[52:55], v[28:31], a[16:23], v126
v_smfmac_f32_16x16x64_bf16 v[56:59], v[28:31], a[24:31], v126
v_smfmac_f32_16x16x64_bf16 v[60:63], v[28:31], v[128:135], v126
v_smfmac_f32_16x16x64_bf16 v[64:67], v[28:31], v[136:143], v126
s_branch Lps_483
Lpf_474:
buffer_load_dwordx4 v[28:31], v8, s[4:7], s40 offen offset:0 sc1
v_mfma_f32_16x16x32_bf16 v[16:19], v[20:23], v[20:23], 0
s_sub_u32 s37, s37, 1
s_cbranch_scc1 Lend_8
Lps_489:
s_waitcnt vmcnt(2)
v_max3_u32 v26, v32, v33, v34
v_max_u32 v26, v26, v35
v_cmp_eq_u32 vcc, -1, v26
s_cbranch_vccnz Lpf_490
v_smfmac_f32_16x16x64_bf16 v[44:47], v[32:35], a[32:39], v126
v_smfmac_f32_16x16x64_bf16 v[48:51], v[32:35], a[40:47], v126
v_smfmac_f32_16x16x64_bf16 v[52:55], v[32:35], a[48:55], v126
v_smfmac_f32_16x16x64_bf16 v[56:59], v[32:35], a[56:63], v126
v_smfmac_f32_16x16x64_bf16 v[60:63], v[32:35], v[160:167], v126
v_smfmac_f32_16x16x64_bf16 v[64:67], v[32:35], v[168:175], v126
s_branch Lps_481
Lpf_476:
buffer_load_dwordx4 v[28:31], v8, s[4:7], s40 offen offset:0 sc1
v_mfma_f32_16x16x32_bf16 v[16:19], v[20:23], v[20:23], 0
s_sub_u32 s37, s37, 1
s_cbranch_scc1 Lend_8
Lps_491:
s_waitcnt vmcnt(2)
v_max3_u32 v26, v32, v33, v34
v_max_u32 v26, v26, v35
v_cmp_eq_u32 vcc, -1, v26
s_cbranch_vccnz Lpf_492
v_smfmac_f32_16x16x64_bf16 v[44:47], v[32:35], a[32:39], v126
v_smfmac_f32_16x16x64_bf16 v[48:51], v[32:35], a[40:47], v126
v_smfmac_f32_16x16x64_bf16 v[52:55], v[32:35], a[48:55], v126
v_smfmac_f32_16x16x64_bf16 v[56:59], v[32:35], a[56:63], v126
v_smfmac_f32_16x16x64_bf16 v[60:63], v[32:35], v[160:167], v126
v_smfmac_f32_16x16x64_bf16 v[64:67], v[32:35], v[168:175], v126
s_branch Lps_435
Lpf_478:
buffer_load_dwordx4 v[32:35], v8, s[4:7], s40 offen offset:1024 sc1
v_mfma_f32_16x16x32_bf16 v[16:19], v[20:23], v[20:23], 0
s_branch Lps_455
Lpf_480:
buffer_load_dwordx4 v[28:31], v8, s[4:7], s40 offen offset:0 sc1
v_mfma_f32_16x16x32_bf16 v[16:19], v[20:23], v[20:23], 0
s_sub_u32 s37, s37, 1
s_cbranch_scc1 Lend_8
s_branch Lps_433
Lpf_482:
buffer_load_dwordx4 v[36:39], v8, s[4:7], s40 offen offset:2048 sc1
v_mfma_f32_16x16x32_bf16 v[16:19], v[20:23], v[20:23], 0
s_branch Lps_459
Lpf_484:
buffer_load_dwordx4 v[32:35], v8, s[4:7], s40 offen offset:1024 sc1
v_mfma_f32_16x16x32_bf16 v[16:19], v[20:23], v[20:23], 0
s_sub_u32 s37, s37, 1
s_cbranch_scc1 Lend_8
s_branch Lps_439
Lpf_486:
buffer_load_dwordx4 v[36:39], v8, s[4:7], s40 offen offset:2048 sc1
v_mfma_f32_16x16x32_bf16 v[16:19], v[20:23], v[20:23], 0
s_branch Lps_465
Lpf_488:
buffer_load_dwordx4 v[28:31], v8, s[4:7], s40 offen offset:0 sc1
v_mfma_f32_16x16x32_bf16 v[16:19], v[20:23], v[20:23], 0
s_sub_u32 s37, s37, 1
s_cbranch_scc1 Lend_8
s_branch Lps_431
Lpf_490:
buffer_load_dwordx4 v[32:35], v8, s[4:7], s40 offen offset:1024 sc1
v_mfma_f32_16x16x32_bf16 v[16:19], v[20:23], v[20:23], 0
Lps_493:
s_waitcnt vmcnt(2)
v_max3_u32 v26, v36, v37, v38
v_max_u32 v26, v26, v39
v_cmp_eq_u32 vcc, -1, v26
s_cbranch_vccnz Lpf_494
v_smfmac_f32_16x16x64_bf16 v[44:47], v[36:39], a[64:71], v126
v_smfmac_f32_16x16x64_bf16 v[48:51], v[36:39], a[72:79], v126
v_smfmac_f32_16x16x64_bf16 v[52:55], v[36:39], a[80:87], v126
v_smfmac_f32_16x16x64_bf16 v[56:59], v[36:39], a[88:95], v126
v_smfmac_f32_16x16x64_bf16 v[60:63], v[36:39], v[192:199], v126
v_smfmac_f32_16x16x64_bf16 v[64:67], v[36:39], v[200:207], v126
s_branch Lps_455
Lpf_492:
buffer_load_dwordx4 v[32:35], v8, s[4:7], s40 offen offset:1024 sc1
v_mfma_f32_16x16x32_bf16 v[16:19], v[20:23], v[20:23], 0
s_branch Lps_453
Lpf_494:
buffer_load_dwordx4 v[36:39], v8, s[4:7], s40 offen offset:2048 sc1
v_mfma_f32_16x16x32_bf16 v[16:19], v[20:23], v[20:23], 0
s_branch Lps_473
Lpf_424:
buffer_load_dwordx4 v[28:31], v9, s[4:7], s40 offen offset:0 sc1
v_mfma_f32_16x16x32_bf16 v[16:19], v[20:23], v[20:23], 0
s_sub_u32 s37, s37, 1
s_cbranch_scc1 Lend_8
Lps_495:
s_waitcnt vmcnt(3)
v_max3_u32 v26, v32, v33, v34
v_max_u32 v26, v26, v35
v_cmp_eq_u32 vcc, -1, v26
s_cbranch_vccnz Lpf_496
v_smfmac_f32_16x16x64_bf16 v[76:79], v[32:35], a[160:167], v126
v_smfmac_f32_16x16x64_bf16 v[80:83], v[32:35], a[168:175], v126
v_smfmac_f32_16x16x64_bf16 v[84:87], v[32:35], a[176:183], v126
v_smfmac_f32_16x16x64_bf16 v[88:91], v[32:35], a[184:191], v126
Lps_497:
s_waitcnt vmcnt(2)
v_max3_u32 v26, v36, v37, v38
v_max_u32 v26, v26, v39
v_cmp_eq_u32 vcc, -1, v26
s_cbranch_vccnz Lpf_498
v_smfmac_f32_16x16x64_bf16 v[76:79], v[36:39], a[192:199], v126
v_smfmac_f32_16x16x64_bf16 v[80:83], v[36:39], a[200:207], v126
v_smfmac_f32_16x16x64_bf16 v[84:87], v[36:39], a[208:215], v126
v_smfmac_f32_16x16x64_bf16 v[88:91], v[36:39], a[216:223], v126
Lps_499:
s_waitcnt vmcnt(1)
v_max3_u32 v26, v40, v41, v42
v_max_u32 v26, v26, v43
v_cmp_eq_u32 vcc, -1, v26
s_cbranch_vccnz Lpf_500
v_smfmac_f32_16x16x64_bf16 v[76:79], v[40:43], a[224:231], v126
v_smfmac_f32_16x16x64_bf16 v[80:83], v[40:43], a[232:239], v126
v_smfmac_f32_16x16x64_bf16 v[84:87], v[40:43], a[240:247], v126
v_smfmac_f32_16x16x64_bf16 v[88:91], v[40:43], a[248:255], v126
Lps_501:
s_waitcnt vmcnt(0)
v_max3_u32 v26, v28, v29, v30
v_max_u32 v26, v26, v31
v_cmp_eq_u32 vcc, -1, v26
s_cbranch_vccnz Lpf_502
v_smfmac_f32_16x16x64_bf16 v[76:79], v[28:31], a[128:135], v126
v_smfmac_f32_16x16x64_bf16 v[80:83], v[28:31], a[136:143], v126
v_smfmac_f32_16x16x64_bf16 v[84:87], v[28:31], a[144:151], v126
v_smfmac_f32_16x16x64_bf16 v[88:91], v[28:31], a[152:159], v126
s_branch Lpd_423
Lpf_425:
buffer_load_dwordx4 v[32:35], v9, s[4:7], s40 offen offset:1024 sc1
v_mfma_f32_16x16x32_bf16 v[16:19], v[20:23], v[20:23], 0
s_sub_u32 s37, s37, 1
s_cbranch_scc1 Lend_8
Lps_503:
s_waitcnt vmcnt(2)
v_max3_u32 v26, v36, v37, v38
v_max_u32 v26, v26, v39
v_cmp_eq_u32 vcc, -1, v26
s_cbranch_vccnz Lpf_504
v_smfmac_f32_16x16x64_bf16 v[76:79], v[36:39], a[192:199], v126
v_smfmac_f32_16x16x64_bf16 v[80:83], v[36:39], a[200:207], v126
v_smfmac_f32_16x16x64_bf16 v[84:87], v[36:39], a[208:215], v126
v_smfmac_f32_16x16x64_bf16 v[88:91], v[36:39], a[216:223], v126
Lps_505:
s_waitcnt vmcnt(1)
v_max3_u32 v26, v40, v41, v42
v_max_u32 v26, v26, v43
v_cmp_eq_u32 vcc, -1, v26
s_cbranch_vccnz Lpf_506
v_smfmac_f32_16x16x64_bf16 v[76:79], v[40:43], a[224:231], v126
v_smfmac_f32_16x16x64_bf16 v[80:83], v[40:43], a[232:239], v126
v_smfmac_f32_16x16x64_bf16 v[84:87], v[40:43], a[240:247], v126
v_smfmac_f32_16x16x64_bf16 v[88:91], v[40:43], a[248:255], v126
Lps_507:
s_waitcnt vmcnt(0)
v_max3_u32 v26, v32, v33, v34
v_max_u32 v26, v26, v35
v_cmp_eq_u32 vcc, -1, v26
s_cbranch_vccnz Lpf_508
v_smfmac_f32_16x16x64_bf16 v[76:79], v[32:35], a[160:167], v126
v_smfmac_f32_16x16x64_bf16 v[80:83], v[32:35], a[168:175], v126
v_smfmac_f32_16x16x64_bf16 v[84:87], v[32:35], a[176:183], v126
v_smfmac_f32_16x16x64_bf16 v[88:91], v[32:35], a[184:191], v126
s_branch Lpd_423
Lpf_426:
buffer_load_dwordx4 v[36:39], v9, s[4:7], s40 offen offset:2048 sc1
v_mfma_f32_16x16x32_bf16 v[16:19], v[20:23], v[20:23], 0
s_sub_u32 s37, s37, 1
s_cbranch_scc1 Lend_8
Lps_509:
s_waitcnt vmcnt(1)
v_max3_u32 v26, v40, v41, v42
v_max_u32 v26, v26, v43
v_cmp_eq_u32 vcc, -1, v26
s_cbranch_vccnz Lpf_510
v_smfmac_f32_16x16x64_bf16 v[76:79], v[40:43], a[224:231], v126
v_smfmac_f32_16x16x64_bf16 v[80:83], v[40:43], a[232:239], v126
v_smfmac_f32_16x16x64_bf16 v[84:87], v[40:43], a[240:247], v126
v_smfmac_f32_16x16x64_bf16 v[88:91], v[40:43], a[248:255], v126
Lps_511:
s_waitcnt vmcnt(0)
v_max3_u32 v26, v36, v37, v38
v_max_u32 v26, v26, v39
v_cmp_eq_u32 vcc, -1, v26
s_cbranch_vccnz Lpf_512
v_smfmac_f32_16x16x64_bf16 v[76:79], v[36:39], a[192:199], v126
v_smfmac_f32_16x16x64_bf16 v[80:83], v[36:39], a[200:207], v126
v_smfmac_f32_16x16x64_bf16 v[84:87], v[36:39], a[208:215], v126
v_smfmac_f32_16x16x64_bf16 v[88:91], v[36:39], a[216:223], v126
s_branch Lpd_423
Lpf_427:
buffer_load_dwordx4 v[40:43], v9, s[4:7], s40 offen offset:3072 sc1
v_mfma_f32_16x16x32_bf16 v[16:19], v[20:23], v[20:23], 0
s_sub_u32 s37, s37, 1
s_cbranch_scc1 Lend_8
Lps_513:
s_waitcnt vmcnt(0)
v_max3_u32 v26, v40, v41, v42
v_max_u32 v26, v26, v43
v_cmp_eq_u32 vcc, -1, v26
s_cbranch_vccnz Lpf_514
v_smfmac_f32_16x16x64_bf16 v[76:79], v[40:43], a[224:231], v126
v_smfmac_f32_16x16x64_bf16 v[80:83], v[40:43], a[232:239], v126
v_smfmac_f32_16x16x64_bf16 v[84:87], v[40:43], a[240:247], v126
v_smfmac_f32_16x16x64_bf16 v[88:91], v[40:43], a[248:255], v126
s_branch Lpd_423
Lpf_496:
buffer_load_dwordx4 v[32:35], v9, s[4:7], s40 offen offset:1024 sc1
v_mfma_f32_16x16x32_bf16 v[16:19], v[20:23], v[20:23], 0
Lps_515:
s_waitcnt vmcnt(3)
v_max3_u32 v26, v36, v37, v38
v_max_u32 v26, v26, v39
v_cmp_eq_u32 vcc, -1, v26
s_cbranch_vccnz Lpf_516
v_smfmac_f32_16x16x64_bf16 v[76:79], v[36:39], a[192:199], v126
v_smfmac_f32_16x16x64_bf16 v[80:83], v[36:39], a[200:207], v126
v_smfmac_f32_16x16x64_bf16 v[84:87], v[36:39], a[208:215], v126
v_smfmac_f32_16x16x64_bf16 v[88:91], v[36:39], a[216:223], v126
Lps_517:
s_waitcnt vmcnt(2)
v_max3_u32 v26, v40, v41, v42
v_max_u32 v26, v26, v43
v_cmp_eq_u32 vcc, -1, v26
s_cbranch_vccnz Lpf_518
v_smfmac_f32_16x16x64_bf16 v[76:79], v[40:43], a[224:231], v126
v_smfmac_f32_16x16x64_bf16 v[80:83], v[40:43], a[232:239], v126
v_smfmac_f32_16x16x64_bf16 v[84:87], v[40:43], a[240:247], v126
v_smfmac_f32_16x16x64_bf16 v[88:91], v[40:43], a[248:255], v126
Lps_519:
s_waitcnt vmcnt(1)
v_max3_u32 v26, v28, v29, v30
v_max_u32 v26, v26, v31
v_cmp_eq_u32 vcc, -1, v26
s_cbranch_vccnz Lpf_520
v_smfmac_f32_16x16x64_bf16 v[76:79], v[28:31], a[128:135], v126
v_smfmac_f32_16x16x64_bf16 v[80:83], v[28:31], a[136:143], v126
v_smfmac_f32_16x16x64_bf16 v[84:87], v[28:31], a[144:151], v126
v_smfmac_f32_16x16x64_bf16 v[88:91], v[28:31], a[152:159], v126
s_branch Lps_507
Lpf_498:
buffer_load_dwordx4 v[36:39], v9, s[4:7], s40 offen offset:2048 sc1
v_mfma_f32_16x16x32_bf16 v[16:19], v[20:23], v[20:23], 0
Lps_521:
s_waitcnt vmcnt(2)
v_max3_u32 v26, v40, v41, v42
v_max_u32 v26, v26, v43
v_cmp_eq_u32 vcc, -1, v26
s_cbranch_vccnz Lpf_522
v_smfmac_f32_16x16x64_bf16 v[76:79], v[40:43], a[224:231], v126
v_smfmac_f32_16x16x64_bf16 v[80:83], v[40:43], a[232:239], v126
v_smfmac_f32_16x16x64_bf16 v[84:87], v[40:43], a[240:247], v126
v_smfmac_f32_16x16x64_bf16 v[88:91], v[40:43], a[248:255], v126
Lps_523:
s_waitcnt vmcnt(1)
v_max3_u32 v26, v28, v29, v30
v_max_u32 v26, v26, v31
v_cmp_eq_u32 vcc, -1, v26
s_cbranch_vccnz Lpf_524
v_smfmac_f32_16x16x64_bf16 v[76:79], v[28:31], a[128:135], v126
v_smfmac_f32_16x16x64_bf16 v[80:83], v[28:31], a[136:143], v126
v_smfmac_f32_16x16x64_bf16 v[84:87], v[28:31], a[144:151], v126
v_smfmac_f32_16x16x64_bf16 v[88:91], v[28:31], a[152:159], v126
s_branch Lps_511
Lpf_500:
buffer_load_dwordx4 v[40:43], v9, s[4:7], s40 offen offset:3072 sc1
v_mfma_f32_16x16x32_bf16 v[16:19], v[20:23], v[20:23], 0
Lps_525:
s_waitcnt vmcnt(1)
v_max3_u32 v26, v28, v29, v30
v_max_u32 v26, v26, v31
v_cmp_eq_u32 vcc, -1, v26
s_cbranch_vccnz Lpf_526
v_smfmac_f32_16x16x64_bf16 v[76:79], v[28:31], a[128:135], v126
v_smfmac_f32_16x16x64_bf16 v[80:83], v[28:31], a[136:143], v126
v_smfmac_f32_16x16x64_bf16 v[84:87], v[28:31], a[144:151], v126
v_smfmac_f32_16x16x64_bf16 v[88:91], v[28:31], a[152:159], v126
s_branch Lps_513
Lpf_502:
buffer_load_dwordx4 v[28:31], v9, s[4:7], s40 offen offset:0 sc1
v_mfma_f32_16x16x32_bf16 v[16:19], v[20:23], v[20:23], 0
s_sub_u32 s37, s37, 1
s_cbranch_scc1 Lend_8
s_branch Lps_501
Lpf_504:
buffer_load_dwordx4 v[36:39], v9, s[4:7], s40 offen offset:2048 sc1
v_mfma_f32_16x16x32_bf16 v[16:19], v[20:23], v[20:23], 0
Lps_527:
s_waitcnt vmcnt(2)
v_max3_u32 v26, v40, v41, v42
v_max_u32 v26, v26, v43
v_cmp_eq_u32 vcc, -1, v26
s_cbranch_vccnz Lpf_528
v_smfmac_f32_16x16x64_bf16 v[76:79], v[40:43], a[224:231], v126
v_smfmac_f32_16x16x64_bf16 v[80:83], v[40:43], a[232:239], v126
v_smfmac_f32_16x16x64_bf16 v[84:87], v[40:43], a[240:247], v126
v_smfmac_f32_16x16x64_bf16 v[88:91], v[40:43], a[248:255], v126
Lps_529:
s_waitcnt vmcnt(1)
v_max3_u32 v26, v32, v33, v34
v_max_u32 v26, v26, v35
v_cmp_eq_u32 vcc, -1, v26
s_cbranch_vccnz Lpf_530
v_smfmac_f32_16x16x64_bf16 v[76:79], v[32:35], a[160:167], v126
v_smfmac_f32_16x16x64_bf16 v[80:83], v[32:35], a[168:175], v126
v_smfmac_f32_16x16x64_bf16 v[84:87], v[32:35], a[176:183], v126
v_smfmac_f32_16x16x64_bf16 v[88:91], v[32:35], a[184:191], v126
s_branch Lps_511
Lpf_506:
buffer_load_dwordx4 v[40:43], v9, s[4:7], s40 offen offset:3072 sc1
v_mfma_f32_16x16x32_bf16 v[16:19], v[20:23], v[20:23], 0
Lps_531:
s_waitcnt vmcnt(1)
v_max3_u32 v26, v32, v33, v34
v_max_u32 v26, v26, v35
v_cmp_eq_u32 vcc, -1, v26
s_cbranch_vccnz Lpf_532
v_smfmac_f32_16x16x64_bf16 v[76:79], v[32:35], a[160:167], v126
v_smfmac_f32_16x16x64_bf16 v[80:83], v[32:35], a[168:175], v126
v_smfmac_f32_16x16x64_bf16 v[84:87], v[32:35], a[176:183], v126
v_smfmac_f32_16x16x64_bf16 v[88:91], v[32:35], a[184:191], v126
s_branch Lps_513
Lpf_508:
buffer_load_dwordx4 v[32:35], v9, s[4:7], s40 offen offset:1024 sc1
v_mfma_f32_16x16x32_bf16 v[16:19], v[20:23], v[20:23], 0
s_sub_u32 s37, s37, 1
s_cbranch_scc1 Lend_8
s_branch Lps_507
Lpf_510:
buffer_load_dwordx4 v[40:43], v9, s[4:7], s40 offen offset:3072 sc1
v_mfma_f32_16x16x32_bf16 v[16:19], v[20:23], v[20:23], 0
Lps_533:
s_waitcnt vmcnt(1)
v_max3_u32 v26, v36, v37, v38
v_max_u32 v26, v26, v39
v_cmp_eq_u32 vcc, -1, v26
s_cbranch_vccnz Lpf_534
v_smfmac_f32_16x16x64_bf16 v[76:79], v[36:39], a[192:199], v126
v_smfmac_f32_16x16x64_bf16 v[80:83], v[36:39], a[200:207], v126
v_smfmac_f32_16x16x64_bf16 v[84:87], v[36:39], a[208:215], v126
v_smfmac_f32_16x16x64_bf16 v[88:91], v[36:39], a[216:223], v126
s_branch Lps_513
Lpf_512:
buffer_load_dwordx4 v[36:39], v9, s[4:7], s40 offen offset:2048 sc1
v_mfma_f32_16x16x32_bf16 v[16:19], v[20:23], v[20:23], 0
s_sub_u32 s37, s37, 1
s_cbranch_scc1 Lend_8
s_branch Lps_511
Lpf_514:
buffer_load_dwordx4 v[40:43], v9, s[4:7], s40 offen offset:3072 sc1
v_mfma_f32_16x16x32_bf16 v[16:19], v[20:23], v[20:23], 0
s_sub_u32 s37, s37, 1
s_cbranch_scc1 Lend_8
s_branch Lps_513
Lpf_516:
buffer_load_dwordx4 v[36:39], v9, s[4:7], s40 offen offset:2048 sc1
v_mfma_f32_16x16x32_bf16 v[16:19], v[20:23], v[20:23], 0
Lps_535:
s_waitcnt vmcnt(3)
v_max3_u32 v26, v40, v41, v42
v_max_u32 v26, v26, v43
v_cmp_eq_u32 vcc, -1, v26
s_cbranch_vccnz Lpf_536
v_smfmac_f32_16x16x64_bf16 v[76:79], v[40:43], a[224:231], v126
v_smfmac_f32_16x16x64_bf16 v[80:83], v[40:43], a[232:239], v126
v_smfmac_f32_16x16x64_bf16 v[84:87], v[40:43], a[240:247], v126
v_smfmac_f32_16x16x64_bf16 v[88:91], v[40:43], a[248:255], v126
Lps_537:
s_waitcnt vmcnt(2)
v_max3_u32 v26, v28, v29, v30
v_max_u32 v26, v26, v31
v_cmp_eq_u32 vcc, -1, v26
s_cbranch_vccnz Lpf_538
v_smfmac_f32_16x16x64_bf16 v[76:79], v[28:31], a[128:135], v126
v_smfmac_f32_16x16x64_bf16 v[80:83], v[28:31], a[136:143], v126
v_smfmac_f32_16x16x64_bf16 v[84:87], v[28:31], a[144:151], v126
v_smfmac_f32_16x16x64_bf16 v[88:91], v[28:31], a[152:159], v126
s_branch Lps_529
Lpf_518:
buffer_load_dwordx4 v[40:43], v9, s[4:7], s40 offen offset:3072 sc1
v_mfma_f32_16x16x32_bf16 v[16:19], v[20:23], v[20:23], 0
Lps_539:
s_waitcnt vmcnt(2)
v_max3_u32 v26, v28, v29, v30
v_max_u32 v26, v26, v31
v_cmp_eq_u32 vcc, -1, v26
s_cbranch_vccnz Lpf_540
v_smfmac_f32_16x16x64_bf16 v[76:79], v[28:31], a[128:135], v126
v_smfmac_f32_16x16x64_bf16 v[80:83], v[28:31], a[136:143], v126
v_smfmac_f32_16x16x64_bf16 v[84:87], v[28:31], a[144:151], v126
v_smfmac_f32_16x16x64_bf16 v[88:91], v[28:31], a[152:159], v126
s_branch Lps_531
Lpf_520:
buffer_load_dwordx4 v[28:31], v9, s[4:7], s40 offen offset:0 sc1
v_mfma_f32_16x16x32_bf16 v[16:19], v[20:23], v[20:23], 0
s_sub_u32 s37, s37, 1
s_cbranch_scc1 Lend_8
Lps_541:
s_waitcnt vmcnt(1)
v_max3_u32 v26, v32, v33, v34
v_max_u32 v26, v26, v35
v_cmp_eq_u32 vcc, -1, v26
s_cbranch_vccnz Lpf_542
v_smfmac_f32_16x16x64_bf16 v[76:79], v[32:35], a[160:167], v126
v_smfmac_f32_16x16x64_bf16 v[80:83], v[32:35], a[168:175], v126
v_smfmac_f32_16x16x64_bf16 v[84:87], v[32:35], a[176:183], v126
v_smfmac_f32_16x16x64_bf16 v[88:91], v[32:35], a[184:191], v126
s_branch Lps_501
Lpf_522:
buffer_load_dwordx4 v[40:43], v9, s[4:7], s40 offen offset:3072 sc1
v_mfma_f32_16x16x32_bf16 v[16:19], v[20:23], v[20:23], 0
Lps_543:
s_waitcnt vmcnt(2)
v_max3_u32 v26, v28, v29, v30
v_max_u32 v26, v26, v31
v_cmp_eq_u32 vcc, -1, v26
s_cbranch_vccnz Lpf_544
v_smfmac_f32_16x16x64_bf16 v[76:79], v[28:31], a[128:135], v126
v_smfmac_f32_16x16x64_bf16 v[80:83], v[28:31], a[136:143], v126
v_smfmac_f32_16x16x64_bf16 v[84:87], v[28:31], a[144:151], v126
v_smfmac_f32_16x16x64_bf16 v[88:91], v[28:31], a[152:159], v126
s_branch Lps_533
Lpf_524:
buffer_load_dwordx4 v[28:31], v9, s[4:7], s40 offen offset:0 sc1
v_mfma_f32_16x16x32_bf16 v[16:19], v[20:23], v[20:23], 0
s_sub_u32 s37, s37, 1
s_cbranch_scc1 Lend_8
Lps_545:
s_waitcnt vmcnt(1)
v_max3_u32 v26, v36, v37, v38
v_max_u32 v26, v26, v39
v_cmp_eq_u32 vcc, -1, v26
s_cbranch_vccnz Lpf_546
v_smfmac_f32_16x16x64_bf16 v[76:79], v[36:39], a[192:199], v126
v_smfmac_f32_16x16x64_bf16 v[80:83], v[36:39], a[200:207], v126
v_smfmac_f32_16x16x64_bf16 v[84:87], v[36:39], a[208:215], v126
v_smfmac_f32_16x16x64_bf16 v[88:91], v[36:39], a[216:223], v126
s_branch Lps_501
Lpf_526:
buffer_load_dwordx4 v[28:31], v9, s[4:7], s40 offen offset:0 sc1
v_mfma_f32_16x16x32_bf16 v[16:19], v[20:23], v[20:23], 0
s_sub_u32 s37, s37, 1
s_cbranch_scc1 Lend_8
s_branch Lps_499
Lpf_528:
buffer_load_dwordx4 v[40:43], v9, s[4:7], s40 offen offset:3072 sc1
v_mfma_f32_16x16x32_bf16 v[16:19], v[20:23], v[20:23], 0
Lps_547:
s_waitcnt vmcnt(2)
v_max3_u32 v26, v32, v33, v34
v_max_u32 v26, v26, v35
v_cmp_eq_u32 vcc, -1, v26
s_cbranch_vccnz Lpf_548
v_smfmac_f32_16x16x64_bf16 v[76:79], v[32:35], a[160:167], v126
v_smfmac_f32_16x16x64_bf16 v[80:83], v[32:35], a[168:175], v126
v_smfmac_f32_16x16x64_bf16 v[84:87], v[32:35], a[176:183], v126
v_smfmac_f32_16x16x64_bf16 v[88:91], v[32:35], a[184:191], v126
s_branch Lps_533
Lpf_530:
buffer_load_dwordx4 v[32:35], v9, s[4:7], s40 offen offset:1024 sc1
v_mfma_f32_16x16x32_bf16 v[16:19], v[20:23], v[20:23], 0
s_sub_u32 s37, s37, 1
s_cbranch_scc1 Lend_8
Lps_549:
s_waitcnt vmcnt(1)
v_max3_u32 v26, v36, v37, v38
v_max_u32 v26, v26, v39
v_cmp_eq_u32 vcc, -1, v26
s_cbranch_vccnz Lpf_550
v_smfmac_f32_16x16x64_bf16 v[76:79], v[36:39], a[192:199], v126
v_smfmac_f32_16x16x64_bf16 v[80:83], v[36:39], a[200:207], v126
v_smfmac_f32_16x16x64_bf16 v[84:87], v[36:39], a[208:215], v126
v_smfmac_f32_16x16x64_bf16 v[88:91], v[36:39], a[216:223], v126
s_branch Lps_507
Lpf_532:
buffer_load_dwordx4 v[32:35], v9, s[4:7], s40 offen offset:1024 sc1
v_mfma_f32_16x16x32_bf16 v[16:19], v[20:23], v[20:23], 0
s_sub_u32 s37, s37, 1
s_cbranch_scc1 Lend_8
s_branch Lps_505
Lpf_534:
buffer_load_dwordx4 v[36:39], v9, s[4:7], s40 offen offset:2048 sc1
v_mfma_f32_16x16x32_bf16 v[16:19], v[20:23], v[20:23], 0
s_sub_u32 s37, s37, 1
s_cbranch_scc1 Lend_8
s_branch Lps_509
Lpf_536:
buffer_load_dwordx4 v[40:43], v9, s[4:7], s40 offen offset:3072 sc1
v_mfma_f32_16x16x32_bf16 v[16:19], v[20:23], v[20:23], 0
Lps_551:
s_waitcnt vmcnt(3)
v_max3_u32 v26, v28, v29, v30
v_max_u32 v26, v26, v31
v_cmp_eq_u32 vcc, -1, v26
s_cbranch_vccnz Lpf_552
v_smfmac_f32_16x16x64_bf16 v[76:79], v[28:31], a[128:135], v126
v_smfmac_f32_16x16x64_bf16 v[80:83], v[28:31], a[136:143], v126
v_smfmac_f32_16x16x64_bf16 v[84:87], v[28:31], a[144:151], v126
v_smfmac_f32_16x16x64_bf16 v[88:91], v[28:31], a[152:159], v126
s_branch Lps_547
Lpf_538:
buffer_load_dwordx4 v[28:31], v9, s[4:7], s40 offen offset:0 sc1
v_mfma_f32_16x16x32_bf16 v[16:19], v[20:23], v[20:23], 0
s_sub_u32 s37, s37, 1
s_cbranch_scc1 Lend_8
Lps_553:
s_waitcnt vmcnt(2)
v_max3_u32 v26, v32, v33, v34
v_max_u32 v26, v26, v35
v_cmp_eq_u32 vcc, -1, v26
s_cbranch_vccnz Lpf_554
v_smfmac_f32_16x16x64_bf16 v[76:79], v[32:35], a[160:167], v126
v_smfmac_f32_16x16x64_bf16 v[80:83], v[32:35], a[168:175], v126
v_smfmac_f32_16x16x64_bf16 v[84:87], v[32:35], a[176:183], v126
v_smfmac_f32_16x16x64_bf16 v[88:91], v[32:35], a[184:191], v126
s_branch Lps_545
Lpf_540:
buffer_load_dwordx4 v[28:31], v9, s[4:7], s40 offen offset:0 sc1
v_mfma_f32_16x16x32_bf16 v[16:19], v[20:23], v[20:23], 0
s_sub_u32 s37, s37, 1
s_cbranch_scc1 Lend_8
Lps_555:
s_waitcnt vmcnt(2)
v_max3_u32 v26, v32, v33, v34
v_max_u32 v26, v26, v35
v_cmp_eq_u32 vcc, -1, v26
s_cbranch_vccnz Lpf_556
v_smfmac_f32_16x16x64_bf16 v[76:79], v[32:35], a[160:167], v126
v_smfmac_f32_16x16x64_bf16 v[80:83], v[32:35], a[168:175], v126
v_smfmac_f32_16x16x64_bf16 v[84:87], v[32:35], a[176:183], v126
v_smfmac_f32_16x16x64_bf16 v[88:91], v[32:35], a[184:191], v126
s_branch Lps_499
Lpf_542:
buffer_load_dwordx4 v[32:35], v9, s[4:7], s40 offen offset:1024 sc1
v_mfma_f32_16x16x32_bf16 v[16:19], v[20:23], v[20:23], 0
s_branch Lps_519
Lpf_544:
buffer_load_dwordx4 v[28:31], v9, s[4:7], s40 offen offset:0 sc1
v_mfma_f32_16x16x32_bf16 v[16:19], v[20:23], v[20:23], 0
s_sub_u32 s37, s37, 1
s_cbranch_scc1 Lend_8
s_branch Lps_497
Lpf_546:
buffer_load_dwordx4 v[36:39], v9, s[4:7], s40 offen offset:2048 sc1
v_mfma_f32_16x16x32_bf16 v[16:19], v[20:23], v[20:23], 0
s_branch Lps_523
Lpf_548:
buffer_load_dwordx4 v[32:35], v9, s[4:7], s40 offen offset:1024 sc1
v_mfma_f32_16x16x32_bf16 v[16:19], v[20:23], v[20:23], 0
s_sub_u32 s37, s37, 1
s_cbranch_scc1 Lend_8
s_branch Lps_503
Lpf_550:
buffer_load_dwordx4 v[36:39], v9, s[4:7], s40 offen offset:2048 sc1
v_mfma_f32_16x16x32_bf16 v[16:19], v[20:23], v[20:23], 0
s_branch Lps_529
Lpf_552:
buffer_load_dwordx4 v[28:31], v9, s[4:7], s40 offen offset:0 sc1
v_mfma_f32_16x16x32_bf16 v[16:19], v[20:23], v[20:23], 0
s_sub_u32 s37, s37, 1
s_cbranch_scc1 Lend_8
s_branch Lps_495
Lpf_554:
buffer_load_dwordx4 v[32:35], v9, s[4:7], s40 offen offset:1024 sc1
v_mfma_f32_16x16x32_bf16 v[16:19], v[20:23], v[20:23], 0
Lps_557:
s_waitcnt vmcnt(2)
v_max3_u32 v26, v36, v37, v38
v_max_u32 v26, v26, v39
v_cmp_eq_u32 vcc, -1, v26
s_cbranch_vccnz Lpf_558
v_smfmac_f32_16x16x64_bf16 v[76:79], v[36:39], a[192:199], v126
v_smfmac_f32_16x16x64_bf16 v[80:83], v[36:39], a[200:207], v126
v_smfmac_f32_16x16x64_bf16 v[84:87], v[36:39], a[208:215], v126
v_smfmac_f32_16x16x64_bf16 v[88:91], v[36:39], a[216:223], v126
s_branch Lps_519
Lpf_556:
buffer_load_dwordx4 v[32:35], v9, s[4:7], s40 offen offset:1024 sc1
v_mfma_f32_16x16x32_bf16 v[16:19], v[20:23], v[20:23], 0
s_branch Lps_517
Lpf_558:
buffer_load_dwordx4 v[36:39], v9, s[4:7], s40 offen offset:2048 sc1
v_mfma_f32_16x16x32_bf16 v[16:19], v[20:23], v[20:23], 0
s_branch Lps_537
.globl wo_kernel
.p2align 8
.type wo_kernel,@function
wo_kernel:
s_cmp_ge_u32 s2, 128
s_cbranch_scc1 Lend_559
s_load_dwordx2 s[16:17], s[0:1], 40
s_load_dwordx2 s[18:19], s[0:1], 104
s_load_dwordx2 s[30:31], s[0:1], 120
v_lshrrev_b32 v1, 6, v0
s_nop 0
v_readfirstlane_b32 s32, v1
v_and_b32 v1, 63, v0
s_waitcnt lgkmcnt(0)
s_mov_b32 s4, s30
s_and_b32 s5, s31, 0xffff
s_mov_b32 s6, 0x10000000
s_mov_b32 s7, 0x20000
s_mov_b32 s12, s18
s_and_b32 s13, s19, 0xffff
s_mov_b32 s14, 0x400000
s_mov_b32 s15, 0x20000
s_and_b32 s40, s2, 7
s_lshr_b32 s41, s2, 3
s_lshr_b32 s42, s40, 1
s_lshl_b32 s42, s42, 2
s_and_b32 s43, s41, 3
s_add_u32 s42, s42, s43
s_and_b32 s40, s40, 1
s_lshl_b32 s40, s40, 2
s_lshr_b32 s41, s41, 2
s_add_u32 s41, s41, s40
s_mov_b32 s8, s16
s_and_b32 s9, s17, 0xffff
s_mov_b32 s10, 0x800000
s_mov_b32 s11, 0x20000
v_lshlrev_b32 v2, 4, v1
v_lshrrev_b32 v20, 4, v1
v_and_b32 v21, 15, v1
s_mov_b32 s66, 2048
v_lshlrev_b32 v22, 2, v20
v_or_b32 v22, 0, v22
v_xor_b32 v22, v22, v21
v_lshlrev_b32 v22, 4, v22
v_mad_u32_u24 v22, v20, s66, v22
v_add_u32 v4, 0, v22
v_lshlrev_b32 v22, 2, v20
v_or_b32 v22, 2, v22
v_xor_b32 v22, v22, v21
v_lshlrev_b32 v22, 4, v22
v_mad_u32_u24 v22, v20, s66, v22
v_add_u32 v5, 7168, v22
v_lshlrev_b32 v22, 2, v20
v_or_b32 v22, 0, v22
v_xor_b32 v22, v22, v21
v_lshlrev_b32 v22, 4, v22
v_mad_u32_u24 v22, v20, s66, v22
v_add_u32 v6, 14336, v22
v_lshlrev_b32 v22, 2, v20
v_or_b32 v22, 2, v22
v_xor_b32 v22, v22, v21
v_lshlrev_b32 v22, 4, v22
v_mad_u32_u24 v22, v20, s66, v22
v_add_u32 v7, 21504, v22
s_mul_i32 s63, s32, 4096
s_add_u32 s63, s63, 65536
s_mul_i32 s64, s32, 4096
s_mov_b32 s65, 131072
s_lshr_b32 s66, s32, 1
s_mul_i32 s66, s66, 8192
s_add_u32 s66, s66, 65536
v_add_u32 v8, s66, v2
v_bfe_u32 v20, v1, 2, 2
v_lshrrev_b32 v21, 4, v1
v_lshl_add_u32 v22, v21, 2, v20
v_lshlrev_b32 v22, 8, v22
v_and_b32 v23, 3, v1
v_lshl_add_u32 v22, v23, 3, v22
v_and_b32 v21, 1, v21
v_lshl_add_u32 v20, v20, 1, v21
s_and_b32 s66, s32, 1
s_lshl_b32 s66, s66, 2
v_xor_b32 v20, s66, v20
v_xor_b32 v21, 0, v20
v_lshl_add_u32 v10, v21, 5, v22
v_xor_b32 v21, 1, v20
v_lshl_add_u32 v11, v21, 5, v22
v_xor_b32 v21, 2, v20
v_lshl_add_u32 v12, v21, 5, v22
v_xor_b32 v21, 3, v20
v_lshl_add_u32 v13, v21, 5, v22
s_mul_i32 s60, s42, 1048576
s_add_u32 s60, s60, 83886080
s_lshl_b32 s61, s41, 8
s_lshr_b32 s66, s32, 0
s_and_b32 s67, s66, 1
s_lshl_b32 s67, s67, 12
s_add_u32 s60, s60, s67
s_lshr_b32 s66, s66, 1
s_mul_i32 s66, s66, 524288
s_add_u32 s60, s60, s66
s_and_b32 s66, s32, 3
s_mul_i32 s66, s66, 32768
s_add_u32 s61, s61, s66
s_add_u32 m0, s63, 0
s_nop 0
buffer_load_dwordx4 v2, s[4:7], s60 offen offset:0 sc1 lds
buffer_load_dwordx4 v2, s[4:7], s60 offen offset:1024 sc1 lds
buffer_load_dwordx4 v2, s[4:7], s60 offen offset:2048 sc1 lds
buffer_load_dwordx4 v2, s[4:7], s60 offen offset:3072 sc1 lds
s_add_u32 s60, s60, 8192
s_add_u32 m0, s64, 0
s_nop 0
buffer_load_dwordx4 v4, s[8:11], s61 offen offset:0 lds
buffer_load_dwordx4 v5, s[8:11], s61 offen offset:1024 lds
buffer_load_dwordx4 v6, s[8:11], s61 offen offset:2048 lds
buffer_load_dwordx4 v7, s[8:11], s61 offen offset:3072 lds
s_add_u32 s61, s61, s65
s_add_u32 m0, s63, 16384
s_nop 0
buffer_load_dwordx4 v2, s[4:7], s60 offen offset:0 sc1 lds
buffer_load_dwordx4 v2, s[4:7], s60 offen offset:1024 sc1 lds
buffer_load_dwordx4 v2, s[4:7], s60 offen offset:2048 sc1 lds
buffer_load_dwordx4 v2, s[4:7], s60 offen offset:3072 sc1 lds
s_add_u32 s60, s60, 8192
s_add_u32 m0, s64, 16384
s_nop 0
buffer_load_dwordx4 v4, s[8:11], s61 offen offset:0 lds
buffer_load_dwordx4 v5, s[8:11], s61 offen offset:1024 lds
buffer_load_dwordx4 v6, s[8:11], s61 offen offset:2048 lds
buffer_load_dwordx4 v7, s[8:11], s61 offen offset:3072 lds
s_add_u32 s61, s61, s65
s_add_u32 m0, s63, 32768
s_nop 0
buffer_load_dwordx4 v2, s[4:7], s60 offen offset:0 sc1 lds
buffer_load_dwordx4 v2, s[4:7], s60 offen offset:1024 sc1 lds
buffer_load_dwordx4 v2, s[4:7], s60 offen offset:2048 sc1 lds
buffer_load_dwordx4 v2, s[4:7], s60 offen offset:3072 sc1 lds
s_add_u32 s60, s60, 8192
s_add_u32 m0, s64, 32768
s_nop 0
buffer_load_dwordx4 v4, s[8:11], s61 offen offset:0 lds
buffer_load_dwordx4 v5, s[8:11], s61 offen offset:1024 lds
buffer_load_dwordx4 v6, s[8:11], s61 offen offset:2048 lds
buffer_load_dwordx4 v7, s[8:11], s61 offen offset:3072 lds
s_add_u32 s61, s61, s65
s_add_u32 m0, s63, 49152
s_nop 0
buffer_load_dwordx4 v2, s[4:7], s60 offen offset:0 sc1 lds
buffer_load_dwordx4 v2, s[4:7], s60 offen offset:1024 sc1 lds
buffer_load_dwordx4 v2, s[4:7], s60 offen offset:2048 sc1 lds
buffer_load_dwordx4 v2, s[4:7], s60 offen offset:3072 sc1 lds
s_add_u32 s60, s60, 8192
s_add_u32 m0, s64, 49152
s_nop 0
buffer_load_dwordx4 v4, s[8:11], s61 offen offset:0 lds
buffer_load_dwordx4 v5, s[8:11], s61 offen offset:1024 lds
buffer_load_dwordx4 v6, s[8:11], s61 offen offset:2048 lds
buffer_load_dwordx4 v7, s[8:11], s61 offen offset:3072 lds
s_add_u32 s61, s61, s65
s_lshr_b32 s46, s32, 1
s_lshl_b32 s47, s42, 1
s_add_u32 s46, s46, s47
s_and_b32 s47, s32, 1
s_lshl_b32 s48, s41, 1
s_add_u32 s47, s47, s48
s_lshl_b32 s48, s46, 17
s_lshl_b32 s49, s47, 13
s_add_u32 s49, s49, s48
s_add_u32 s50, s49, 12582912
s_add_u32 s49, s49, 20971520
s_lshl_b32 s51, s47, 8
s_add_u32 s51, s51, 3153920
s_waitcnt vmcnt(24)
s_barrier
ds_read_b128 a[0:3], v8 offset:0
ds_read_b64_tr_b16 a[32:33], v10 offset:0
ds_read_b64_tr_b16 a[34:35], v10 offset:4096
ds_read_b128 a[4:7], v8 offset:1024
ds_read_b64_tr_b16 a[36:37], v11 offset:0
ds_read_b64_tr_b16 a[38:39], v11 offset:4096
ds_read_b128 a[8:11], v8 offset:2048
ds_read_b64_tr_b16 a[40:41], v12 offset:0
ds_read_b64_tr_b16 a[42:43], v12 offset:4096
ds_read_b128 a[12:15], v8 offset:3072
ds_read_b64_tr_b16 a[44:45], v13 offset:0
ds_read_b64_tr_b16 a[46:47], v13 offset:4096
ds_read_b128 a[16:19], v8 offset:4096
ds_read_b64_tr_b16 a[48:49], v10 offset:8192
ds_read_b64_tr_b16 a[50:51], v10 offset:12288
ds_read_b128 a[20:23], v8 offset:5120
ds_read_b64_tr_b16 a[52:53], v11 offset:8192
ds_read_b64_tr_b16 a[54:55], v11 offset:12288
ds_read_b128 a[24:27], v8 offset:6144
ds_read_b64_tr_b16 a[56:57], v12 offset:8192
ds_read_b64_tr_b16 a[58:59], v12 offset:12288
ds_read_b128 a[28:31], v8 offset:7168
ds_read_b64_tr_b16 a[60:61], v13 offset:8192
ds_read_b64_tr_b16 a[62:63], v13 offset:12288
s_waitcnt vmcnt(16) lgkmcnt(0)
s_barrier
v_mfma_f32_16x16x32_bf16 v[64:67], a[32:35], a[0:3], 0
ds_read_b128 a[64:67], v8 offset:16384
v_mfma_f32_16x16x32_bf16 v[80:83], a[32:35], a[4:7], 0
ds_read_b64_tr_b16 a[96:97], v10 offset:16384
v_mfma_f32_16x16x32_bf16 v[96:99], a[32:35], a[8:11], 0
ds_read_b64_tr_b16 a[98:99], v10 offset:20480
s_add_u32 m0, s63, 0
s_nop 0
buffer_load_dwordx4 v2, s[4:7], s60 offen offset:0 sc1 lds
v_mfma_f32_16x16x32_bf16 v[112:115], a[32:35], a[12:15], 0
ds_read_b128 a[68:71], v8 offset:17408
v_mfma_f32_16x16x32_bf16 v[116:119], a[36:39], a[12:15], 0
ds_read_b64_tr_b16 a[100:101], v11 offset:16384
v_mfma_f32_16x16x32_bf16 v[100:103], a[36:39], a[8:11], 0
ds_read_b64_tr_b16 a[102:103], v11 offset:20480
v_mfma_f32_16x16x32_bf16 v[84:87], a[36:39], a[4:7], 0
ds_read_b128 a[72:75], v8 offset:18432
buffer_load_dwordx4 v2, s[4:7], s60 offen offset:1024 sc1 lds
v_mfma_f32_16x16x32_bf16 v[68:71], a[36:39], a[0:3], 0
ds_read_b64_tr_b16 a[104:105], v12 offset:16384
v_mfma_f32_16x16x32_bf16 v[72:75], a[40:43], a[0:3], 0
ds_read_b64_tr_b16 a[106:107], v12 offset:20480
v_mfma_f32_16x16x32_bf16 v[88:91], a[40:43], a[4:7], 0
ds_read_b128 a[76:79], v8 offset:19456
v_mfma_f32_16x16x32_bf16 v[104:107], a[40:43], a[8:11], 0
ds_read_b64_tr_b16 a[108:109], v13 offset:16384
buffer_load_dwordx4 v2, s[4:7], s60 offen offset:2048 sc1 lds
v_mfma_f32_16x16x32_bf16 v[120:123], a[40:43], a[12:15], 0
ds_read_b64_tr_b16 a[110:111], v13 offset:20480
v_mfma_f32_16x16x32_bf16 v[124:127], a[44:47], a[12:15], 0
ds_read_b128 a[80:83], v8 offset:20480
v_mfma_f32_16x16x32_bf16 v[108:111], a[44:47], a[8:11], 0
ds_read_b64_tr_b16 a[112:113], v10 offset:24576
v_mfma_f32_16x16x32_bf16 v[92:95], a[44:47], a[4:7], 0
ds_read_b64_tr_b16 a[114:115], v10 offset:28672
buffer_load_dwordx4 v2, s[4:7], s60 offen offset:3072 sc1 lds
s_add_u32 s60, s60, 8192
v_mfma_f32_16x16x32_bf16 v[76:79], a[44:47], a[0:3], 0
ds_read_b128 a[84:87], v8 offset:21504
v_mfma_f32_16x16x32_bf16 v[64:67], a[48:51], a[16:19], v[64:67]
ds_read_b64_tr_b16 a[116:117], v11 offset:24576
v_mfma_f32_16x16x32_bf16 v[80:83], a[48:51], a[20:23], v[80:83]
ds_read_b64_tr_b16 a[118:119], v11 offset:28672
v_mfma_f32_16x16x32_bf16 v[96:99], a[48:51], a[24:27], v[96:99]
ds_read_b128 a[88:91], v8 offset:22528
s_add_u32 m0, s64, 0
s_nop 0
buffer_load_dwordx4 v4, s[8:11], s61 offen offset:0 lds
v_mfma_f32_16x16x32_bf16 v[112:115], a[48:51], a[28:31], v[112:115]
ds_read_b64_tr_b16 a[120:121], v12 offset:24576
v_mfma_f32_16x16x32_bf16 v[116:119], a[52:55], a[28:31], v[116:119]
ds_read_b64_tr_b16 a[122:123], v12 offset:28672
v_mfma_f32_16x16x32_bf16 v[100:103], a[52:55], a[24:27], v[100:103]
ds_read_b128 a[92:95], v8 offset:23552
v_mfma_f32_16x16x32_bf16 v[84:87], a[52:55], a[20:23], v[84:87]
ds_read_b64_tr_b16 a[124:125], v13 offset:24576
buffer_load_dwordx4 v5, s[8:11], s61 offen offset:1024 lds
v_mfma_f32_16x16x32_bf16 v[68:71], a[52:55], a[16:19], v[68:71]
ds_read_b64_tr_b16 a[126:127], v13 offset:28672
v_mfma_f32_16x16x32_bf16 v[72:75], a[56:59], a[16:19], v[72:75]
v_mfma_f32_16x16x32_bf16 v[88:91], a[56:59], a[20:23], v[88:91]
v_mfma_f32_16x16x32_bf16 v[104:107], a[56:59], a[24:27], v[104:107]
buffer_load_dwordx4 v6, s[8:11], s61 offen offset:2048 lds
v_mfma_f32_16x16x32_bf16 v[120:123], a[56:59], a[28:31], v[120:123]
v_mfma_f32_16x16x32_bf16 v[124:127], a[60:63], a[28:31], v[124:127]
v_mfma_f32_16x16x32_bf16 v[108:111], a[60:63], a[24:27], v[108:111]
v_mfma_f32_16x16x32_bf16 v[92:95], a[60:63], a[20:23], v[92:95]
buffer_load_dwordx4 v7, s[8:11], s61 offen offset:3072 lds
s_add_u32 s61, s61, s65
v_mfma_f32_16x16x32_bf16 v[76:79], a[60:63], a[16:19], v[76:79]
s_waitcnt vmcnt(16) lgkmcnt(0)
s_barrier
v_mfma_f32_16x16x32_bf16 v[64:67], a[96:99], a[64:67], v[64:67]
ds_read_b128 a[0:3], v8 offset:32768
v_mfma_f32_16x16x32_bf16 v[80:83], a[96:99], a[68:71], v[80:83]
ds_read_b64_tr_b16 a[32:33], v10 offset:32768
v_mfma_f32_16x16x32_bf16 v[96:99], a[96:99], a[72:75], v[96:99]
ds_read_b64_tr_b16 a[34:35], v10 offset:36864
s_add_u32 m0, s63, 16384
s_nop 0
buffer_load_dwordx4 v2, s[4:7], s60 offen offset:0 sc1 lds
v_mfma_f32_16x16x32_bf16 v[112:115], a[96:99], a[76:79], v[112:115]
ds_read_b128 a[4:7], v8 offset:33792
v_mfma_f32_16x16x32_bf16 v[116:119], a[100:103], a[76:79], v[116:119]
ds_read_b64_tr_b16 a[36:37], v11 offset:32768
v_mfma_f32_16x16x32_bf16 v[100:103], a[100:103], a[72:75], v[100:103]
ds_read_b64_tr_b16 a[38:39], v11 offset:36864
v_mfma_f32_16x16x32_bf16 v[84:87], a[100:103], a[68:71], v[84:87]
ds_read_b128 a[8:11], v8 offset:34816
buffer_load_dwordx4 v2, s[4:7], s60 offen offset:1024 sc1 lds
v_mfma_f32_16x16x32_bf16 v[68:71], a[100:103], a[64:67], v[68:71]
ds_read_b64_tr_b16 a[40:41], v12 offset:32768
v_mfma_f32_16x16x32_bf16 v[72:75], a[104:107], a[64:67], v[72:75]
ds_read_b64_tr_b16 a[42:43], v12 offset:36864
v_mfma_f32_16x16x32_bf16 v[88:91], a[104:107], a[68:71], v[88:91]
ds_read_b128 a[12:15], v8 offset:35840
v_mfma_f32_16x16x32_bf16 v[104:107], a[104:107], a[72:75], v[104:107]
ds_read_b64_tr_b16 a[44:45], v13 offset:32768
buffer_load_dwordx4 v2, s[4:7], s60 offen offset:2048 sc1 lds
v_mfma_f32_16x16x32_bf16 v[120:123], a[104:107], a[76:79], v[120:123]
ds_read_b64_tr_b16 a[46:47], v13 offset:36864
v_mfma_f32_16x16x32_bf16 v[124:127], a[108:111], a[76:79], v[124:127]
ds_read_b128 a[16:19], v8 offset:36864
v_mfma_f32_16x16x32_bf16 v[108:111], a[108:111], a[72:75], v[108:111]
ds_read_b64_tr_b16 a[48:49], v10 offset:40960
v_mfma_f32_16x16x32_bf16 v[92:95], a[108:111], a[68:71], v[92:95]
ds_read_b64_tr_b16 a[50:51], v10 offset:45056
buffer_load_dwordx4 v2, s[4:7], s60 offen offset:3072 sc1 lds
s_add_u32 s60, s60, 8192
v_mfma_f32_16x16x32_bf16 v[76:79], a[108:111], a[64:67], v[76:79]
ds_read_b128 a[20:23], v8 offset:37888
v_mfma_f32_16x16x32_bf16 v[64:67], a[112:115], a[80:83], v[64:67]
ds_read_b64_tr_b16 a[52:53], v11 offset:40960
v_mfma_f32_16x16x32_bf16 v[80:83], a[112:115], a[84:87], v[80:83]
ds_read_b64_tr_b16 a[54:55], v11 offset:45056
v_mfma_f32_16x16x32_bf16 v[96:99], a[112:115], a[88:91], v[96:99]
ds_read_b128 a[24:27], v8 offset:38912
s_add_u32 m0, s64, 16384
s_nop 0
buffer_load_dwordx4 v4, s[8:11], s61 offen offset:0 lds
v_mfma_f32_16x16x32_bf16 v[112:115], a[112:115], a[92:95], v[112:115]
ds_read_b64_tr_b16 a[56:57], v12 offset:40960
v_mfma_f32_16x16x32_bf16 v[116:119], a[116:119], a[92:95], v[116:119]
ds_read_b64_tr_b16 a[58:59], v12 offset:45056
v_mfma_f32_16x16x32_bf16 v[100:103], a[116:119], a[88:91], v[100:103]
ds_read_b128 a[28:31], v8 offset:39936
v_mfma_f32_16x16x32_bf16 v[84:87], a[116:119], a[84:87], v[84:87]
ds_read_b64_tr_b16 a[60:61], v13 offset:40960
buffer_load_dwordx4 v5, s[8:11], s61 offen offset:1024 lds
v_mfma_f32_16x16x32_bf16 v[68:71], a[116:119], a[80:83], v[68:71]
ds_read_b64_tr_b16 a[62:63], v13 offset:45056
v_mfma_f32_16x16x32_bf16 v[72:75], a[120:123], a[80:83], v[72:75]
v_mfma_f32_16x16x32_bf16 v[88:91], a[120:123], a[84:87], v[88:91]
v_mfma_f32_16x16x32_bf16 v[104:107], a[120:123], a[88:91], v[104:107]
buffer_load_dwordx4 v6, s[8:11], s61 offen offset:2048 lds
v_mfma_f32_16x16x32_bf16 v[120:123], a[120:123], a[92:95], v[120:123]
v_mfma_f32_16x16x32_bf16 v[124:127], a[124:127], a[92:95], v[124:127]
v_mfma_f32_16x16x32_bf16 v[108:111], a[124:127], a[88:91], v[108:111]
v_mfma_f32_16x16x32_bf16 v[92:95], a[124:127], a[84:87], v[92:95]
buffer_load_dwordx4 v7, s[8:11], s61 offen offset:3072 lds
s_add_u32 s61, s61, s65
v_mfma_f32_16x16x32_bf16 v[76:79], a[124:127], a[80:83], v[76:79]
s_waitcnt vmcnt(16) lgkmcnt(0)
s_barrier
v_mfma_f32_16x16x32_bf16 v[64:67], a[32:35], a[0:3], v[64:67]
ds_read_b128 a[64:67], v8 offset:49152
v_mfma_f32_16x16x32_bf16 v[80:83], a[32:35], a[4:7], v[80:83]
ds_read_b64_tr_b16 a[96:97], v10 offset:49152
v_mfma_f32_16x16x32_bf16 v[96:99], a[32:35], a[8:11], v[96:99]
ds_read_b64_tr_b16 a[98:99], v10 offset:53248
s_add_u32 m0, s63, 32768
s_nop 0
buffer_load_dwordx4 v2, s[4:7], s60 offen offset:0 sc1 lds
v_mfma_f32_16x16x32_bf16 v[112:115], a[32:35], a[12:15], v[112:115]
ds_read_b128 a[68:71], v8 offset:50176
v_mfma_f32_16x16x32_bf16 v[116:119], a[36:39], a[12:15], v[116:119]
ds_read_b64_tr_b16 a[100:101], v11 offset:49152
v_mfma_f32_16x16x32_bf16 v[100:103], a[36:39], a[8:11], v[100:103]
ds_read_b64_tr_b16 a[102:103], v11 offset:53248
v_mfma_f32_16x16x32_bf16 v[84:87], a[36:39], a[4:7], v[84:87]
ds_read_b128 a[72:75], v8 offset:51200
buffer_load_dwordx4 v2, s[4:7], s60 offen offset:1024 sc1 lds
v_mfma_f32_16x16x32_bf16 v[68:71], a[36:39], a[0:3], v[68:71]
ds_read_b64_tr_b16 a[104:105], v12 offset:49152
v_mfma_f32_16x16x32_bf16 v[72:75], a[40:43], a[0:3], v[72:75]
ds_read_b64_tr_b16 a[106:107], v12 offset:53248
v_mfma_f32_16x16x32_bf16 v[88:91], a[40:43], a[4:7], v[88:91]
ds_read_b128 a[76:79], v8 offset:52224
v_mfma_f32_16x16x32_bf16 v[104:107], a[40:43], a[8:11], v[104:107]
ds_read_b64_tr_b16 a[108:109], v13 offset:49152
buffer_load_dwordx4 v2, s[4:7], s60 offen offset:2048 sc1 lds
v_mfma_f32_16x16x32_bf16 v[120:123], a[40:43], a[12:15], v[120:123]
ds_read_b64_tr_b16 a[110:111], v13 offset:53248
v_mfma_f32_16x16x32_bf16 v[124:127], a[44:47], a[12:15], v[124:127]
ds_read_b128 a[80:83], v8 offset:53248
v_mfma_f32_16x16x32_bf16 v[108:111], a[44:47], a[8:11], v[108:111]
ds_read_b64_tr_b16 a[112:113], v10 offset:57344
v_mfma_f32_16x16x32_bf16 v[92:95], a[44:47], a[4:7], v[92:95]
ds_read_b64_tr_b16 a[114:115], v10 offset:61440
buffer_load_dwordx4 v2, s[4:7], s60 offen offset:3072 sc1 lds
s_add_u32 s60, s60, 8192
v_mfma_f32_16x16x32_bf16 v[76:79], a[44:47], a[0:3], v[76:79]
ds_read_b128 a[84:87], v8 offset:54272
v_mfma_f32_16x16x32_bf16 v[64:67], a[48:51], a[16:19], v[64:67]
ds_read_b64_tr_b16 a[116:117], v11 offset:57344
v_mfma_f32_16x16x32_bf16 v[80:83], a[48:51], a[20:23], v[80:83]
ds_read_b64_tr_b16 a[118:119], v11 offset:61440
v_mfma_f32_16x16x32_bf16 v[96:99], a[48:51], a[24:27], v[96:99]
ds_read_b128 a[88:91], v8 offset:55296
s_add_u32 m0, s64, 32768
s_nop 0
buffer_load_dwordx4 v4, s[8:11], s61 offen offset:0 lds
v_mfma_f32_16x16x32_bf16 v[112:115], a[48:51], a[28:31], v[112:115]
ds_read_b64_tr_b16 a[120:121], v12 offset:57344
v_mfma_f32_16x16x32_bf16 v[116:119], a[52:55], a[28:31], v[116:119]
ds_read_b64_tr_b16 a[122:123], v12 offset:61440
v_mfma_f32_16x16x32_bf16 v[100:103], a[52:55], a[24:27], v[100:103]
ds_read_b128 a[92:95], v8 offset:56320
v_mfma_f32_16x16x32_bf16 v[84:87], a[52:55], a[20:23], v[84:87]
ds_read_b64_tr_b16 a[124:125], v13 offset:57344
buffer_load_dwordx4 v5, s[8:11], s61 offen offset:1024 lds
v_mfma_f32_16x16x32_bf16 v[68:71], a[52:55], a[16:19], v[68:71]
ds_read_b64_tr_b16 a[126:127], v13 offset:61440
v_mfma_f32_16x16x32_bf16 v[72:75], a[56:59], a[16:19], v[72:75]
v_mfma_f32_16x16x32_bf16 v[88:91], a[56:59], a[20:23], v[88:91]
v_mfma_f32_16x16x32_bf16 v[104:107], a[56:59], a[24:27], v[104:107]
buffer_load_dwordx4 v6, s[8:11], s61 offen offset:2048 lds
v_mfma_f32_16x16x32_bf16 v[120:123], a[56:59], a[28:31], v[120:123]
v_mfma_f32_16x16x32_bf16 v[124:127], a[60:63], a[28:31], v[124:127]
v_mfma_f32_16x16x32_bf16 v[108:111], a[60:63], a[24:27], v[108:111]
v_mfma_f32_16x16x32_bf16 v[92:95], a[60:63], a[20:23], v[92:95]
buffer_load_dwordx4 v7, s[8:11], s61 offen offset:3072 lds
s_add_u32 s61, s61, s65
v_mfma_f32_16x16x32_bf16 v[76:79], a[60:63], a[16:19], v[76:79]
s_waitcnt vmcnt(16) lgkmcnt(0)
s_barrier
v_mfma_f32_16x16x32_bf16 v[64:67], a[96:99], a[64:67], v[64:67]
ds_read_b128 a[0:3], v8 offset:0
v_mfma_f32_16x16x32_bf16 v[80:83], a[96:99], a[68:71], v[80:83]
ds_read_b64_tr_b16 a[32:33], v10 offset:0
v_mfma_f32_16x16x32_bf16 v[96:99], a[96:99], a[72:75], v[96:99]
ds_read_b64_tr_b16 a[34:35], v10 offset:4096
s_add_u32 m0, s63, 49152
s_nop 0
buffer_load_dwordx4 v2, s[4:7], s60 offen offset:0 sc1 lds
v_mfma_f32_16x16x32_bf16 v[112:115], a[96:99], a[76:79], v[112:115]
ds_read_b128 a[4:7], v8 offset:1024
v_mfma_f32_16x16x32_bf16 v[116:119], a[100:103], a[76:79], v[116:119]
ds_read_b64_tr_b16 a[36:37], v11 offset:0
v_mfma_f32_16x16x32_bf16 v[100:103], a[100:103], a[72:75], v[100:103]
ds_read_b64_tr_b16 a[38:39], v11 offset:4096
v_mfma_f32_16x16x32_bf16 v[84:87], a[100:103], a[68:71], v[84:87]
ds_read_b128 a[8:11], v8 offset:2048
buffer_load_dwordx4 v2, s[4:7], s60 offen offset:1024 sc1 lds
v_mfma_f32_16x16x32_bf16 v[68:71], a[100:103], a[64:67], v[68:71]
ds_read_b64_tr_b16 a[40:41], v12 offset:0
v_mfma_f32_16x16x32_bf16 v[72:75], a[104:107], a[64:67], v[72:75]
ds_read_b64_tr_b16 a[42:43], v12 offset:4096
v_mfma_f32_16x16x32_bf16 v[88:91], a[104:107], a[68:71], v[88:91]
ds_read_b128 a[12:15], v8 offset:3072
v_mfma_f32_16x16x32_bf16 v[104:107], a[104:107], a[72:75], v[104:107]
ds_read_b64_tr_b16 a[44:45], v13 offset:0
buffer_load_dwordx4 v2, s[4:7], s60 offen offset:2048 sc1 lds
v_mfma_f32_16x16x32_bf16 v[120:123], a[104:107], a[76:79], v[120:123]
ds_read_b64_tr_b16 a[46:47], v13 offset:4096
v_mfma_f32_16x16x32_bf16 v[124:127], a[108:111], a[76:79], v[124:127]
ds_read_b128 a[16:19], v8 offset:4096
v_mfma_f32_16x16x32_bf16 v[108:111], a[108:111], a[72:75], v[108:111]
ds_read_b64_tr_b16 a[48:49], v10 offset:8192
v_mfma_f32_16x16x32_bf16 v[92:95], a[108:111], a[68:71], v[92:95]
ds_read_b64_tr_b16 a[50:51], v10 offset:12288
buffer_load_dwordx4 v2, s[4:7], s60 offen offset:3072 sc1 lds
s_add_u32 s60, s60, 8192
v_mfma_f32_16x16x32_bf16 v[76:79], a[108:111], a[64:67], v[76:79]
ds_read_b128 a[20:23], v8 offset:5120
v_mfma_f32_16x16x32_bf16 v[64:67], a[112:115], a[80:83], v[64:67]
ds_read_b64_tr_b16 a[52:53], v11 offset:8192
v_mfma_f32_16x16x32_bf16 v[80:83], a[112:115], a[84:87], v[80:83]
ds_read_b64_tr_b16 a[54:55], v11 offset:12288
v_mfma_f32_16x16x32_bf16 v[96:99], a[112:115], a[88:91], v[96:99]
ds_read_b128 a[24:27], v8 offset:6144
s_add_u32 m0, s64, 49152
s_nop 0
buffer_load_dwordx4 v4, s[8:11], s61 offen offset:0 lds
v_mfma_f32_16x16x32_bf16 v[112:115], a[112:115], a[92:95], v[112:115]
ds_read_b64_tr_b16 a[56:57], v12 offset:8192
v_mfma_f32_16x16x32_bf16 v[116:119], a[116:119], a[92:95], v[116:119]
ds_read_b64_tr_b16 a[58:59], v12 offset:12288
v_mfma_f32_16x16x32_bf16 v[100:103], a[116:119], a[88:91], v[100:103]
ds_read_b128 a[28:31], v8 offset:7168
v_mfma_f32_16x16x32_bf16 v[84:87], a[116:119], a[84:87], v[84:87]
ds_read_b64_tr_b16 a[60:61], v13 offset:8192
buffer_load_dwordx4 v5, s[8:11], s61 offen offset:1024 lds
v_mfma_f32_16x16x32_bf16 v[68:71], a[116:119], a[80:83], v[68:71]
ds_read_b64_tr_b16 a[62:63], v13 offset:12288
v_mfma_f32_16x16x32_bf16 v[72:75], a[120:123], a[80:83], v[72:75]
v_mfma_f32_16x16x32_bf16 v[88:91], a[120:123], a[84:87], v[88:91]
v_mfma_f32_16x16x32_bf16 v[104:107], a[120:123], a[88:91], v[104:107]
buffer_load_dwordx4 v6, s[8:11], s61 offen offset:2048 lds
v_mfma_f32_16x16x32_bf16 v[120:123], a[120:123], a[92:95], v[120:123]
v_mfma_f32_16x16x32_bf16 v[124:127], a[124:127], a[92:95], v[124:127]
v_mfma_f32_16x16x32_bf16 v[108:111], a[124:127], a[88:91], v[108:111]
v_mfma_f32_16x16x32_bf16 v[92:95], a[124:127], a[84:87], v[92:95]
buffer_load_dwordx4 v7, s[8:11], s61 offen offset:3072 lds
s_add_u32 s61, s61, s65
v_mfma_f32_16x16x32_bf16 v[76:79], a[124:127], a[80:83], v[76:79]
s_mov_b32 s62, 14
Lgl_560:
s_waitcnt vmcnt(16) lgkmcnt(0)
s_barrier
v_mfma_f32_16x16x32_bf16 v[64:67], a[32:35], a[0:3], v[64:67]
ds_read_b128 a[64:67], v8 offset:16384
v_mfma_f32_16x16x32_bf16 v[80:83], a[32:35], a[4:7], v[80:83]
ds_read_b64_tr_b16 a[96:97], v10 offset:16384
v_mfma_f32_16x16x32_bf16 v[96:99], a[32:35], a[8:11], v[96:99]
ds_read_b64_tr_b16 a[98:99], v10 offset:20480
s_add_u32 m0, s63, 0
s_nop 0
buffer_load_dwordx4 v2, s[4:7], s60 offen offset:0 sc1 lds
v_mfma_f32_16x16x32_bf16 v[112:115], a[32:35], a[12:15], v[112:115]
ds_read_b128 a[68:71], v8 offset:17408
v_mfma_f32_16x16x32_bf16 v[116:119], a[36:39], a[12:15], v[116:119]
ds_read_b64_tr_b16 a[100:101], v11 offset:16384
v_mfma_f32_16x16x32_bf16 v[100:103], a[36:39], a[8:11], v[100:103]
ds_read_b64_tr_b16 a[102:103], v11 offset:20480
v_mfma_f32_16x16x32_bf16 v[84:87], a[36:39], a[4:7], v[84:87]
ds_read_b128 a[72:75], v8 offset:18432
buffer_load_dwordx4 v2, s[4:7], s60 offen offset:1024 sc1 lds
v_mfma_f32_16x16x32_bf16 v[68:71], a[36:39], a[0:3], v[68:71]
ds_read_b64_tr_b16 a[104:105], v12 offset:16384
v_mfma_f32_16x16x32_bf16 v[72:75], a[40:43], a[0:3], v[72:75]
ds_read_b64_tr_b16 a[106:107], v12 offset:20480
v_mfma_f32_16x16x32_bf16 v[88:91], a[40:43], a[4:7], v[88:91]
ds_read_b128 a[76:79], v8 offset:19456
v_mfma_f32_16x16x32_bf16 v[104:107], a[40:43], a[8:11], v[104:107]
ds_read_b64_tr_b16 a[108:109], v13 offset:16384
buffer_load_dwordx4 v2, s[4:7], s60 offen offset:2048 sc1 lds
v_mfma_f32_16x16x32_bf16 v[120:123], a[40:43], a[12:15], v[120:123]
ds_read_b64_tr_b16 a[110:111], v13 offset:20480
v_mfma_f32_16x16x32_bf16 v[124:127], a[44:47], a[12:15], v[124:127]
ds_read_b128 a[80:83], v8 offset:20480
v_mfma_f32_16x16x32_bf16 v[108:111], a[44:47], a[8:11], v[108:111]
ds_read_b64_tr_b16 a[112:113], v10 offset:24576
v_mfma_f32_16x16x32_bf16 v[92:95], a[44:47], a[4:7], v[92:95]
ds_read_b64_tr_b16 a[114:115], v10 offset:28672
buffer_load_dwordx4 v2, s[4:7], s60 offen offset:3072 sc1 lds
s_add_u32 s60, s60, 8192
v_mfma_f32_16x16x32_bf16 v[76:79], a[44:47], a[0:3], v[76:79]
ds_read_b128 a[84:87], v8 offset:21504
v_mfma_f32_16x16x32_bf16 v[64:67], a[48:51], a[16:19], v[64:67]
ds_read_b64_tr_b16 a[116:117], v11 offset:24576
v_mfma_f32_16x16x32_bf16 v[80:83], a[48:51], a[20:23], v[80:83]
ds_read_b64_tr_b16 a[118:119], v11 offset:28672
v_mfma_f32_16x16x32_bf16 v[96:99], a[48:51], a[24:27], v[96:99]
ds_read_b128 a[88:91], v8 offset:22528
s_add_u32 m0, s64, 0
s_nop 0
buffer_load_dwordx4 v4, s[8:11], s61 offen offset:0 lds
v_mfma_f32_16x16x32_bf16 v[112:115], a[48:51], a[28:31], v[112:115]
ds_read_b64_tr_b16 a[120:121], v12 offset:24576
v_mfma_f32_16x16x32_bf16 v[116:119], a[52:55], a[28:31], v[116:119]
ds_read_b64_tr_b16 a[122:123], v12 offset:28672
v_mfma_f32_16x16x32_bf16 v[100:103], a[52:55], a[24:27], v[100:103]
ds_read_b128 a[92:95], v8 offset:23552
v_mfma_f32_16x16x32_bf16 v[84:87], a[52:55], a[20:23], v[84:87]
ds_read_b64_tr_b16 a[124:125], v13 offset:24576
buffer_load_dwordx4 v5, s[8:11], s61 offen offset:1024 lds
v_mfma_f32_16x16x32_bf16 v[68:71], a[52:55], a[16:19], v[68:71]
ds_read_b64_tr_b16 a[126:127], v13 offset:28672
v_mfma_f32_16x16x32_bf16 v[72:75], a[56:59], a[16:19], v[72:75]
v_mfma_f32_16x16x32_bf16 v[88:91], a[56:59], a[20:23], v[88:91]
v_mfma_f32_16x16x32_bf16 v[104:107], a[56:59], a[24:27], v[104:107]
buffer_load_dwordx4 v6, s[8:11], s61 offen offset:2048 lds
v_mfma_f32_16x16x32_bf16 v[120:123], a[56:59], a[28:31], v[120:123]
v_mfma_f32_16x16x32_bf16 v[124:127], a[60:63], a[28:31], v[124:127]
v_mfma_f32_16x16x32_bf16 v[108:111], a[60:63], a[24:27], v[108:111]
v_mfma_f32_16x16x32_bf16 v[92:95], a[60:63], a[20:23], v[92:95]
buffer_load_dwordx4 v7, s[8:11], s61 offen offset:3072 lds
s_add_u32 s61, s61, s65
v_mfma_f32_16x16x32_bf16 v[76:79], a[60:63], a[16:19], v[76:79]
s_waitcnt vmcnt(16) lgkmcnt(0)
s_barrier
v_mfma_f32_16x16x32_bf16 v[64:67], a[96:99], a[64:67], v[64:67]
ds_read_b128 a[0:3], v8 offset:32768
v_mfma_f32_16x16x32_bf16 v[80:83], a[96:99], a[68:71], v[80:83]
ds_read_b64_tr_b16 a[32:33], v10 offset:32768
v_mfma_f32_16x16x32_bf16 v[96:99], a[96:99], a[72:75], v[96:99]
ds_read_b64_tr_b16 a[34:35], v10 offset:36864
s_add_u32 m0, s63, 16384
s_nop 0
buffer_load_dwordx4 v2, s[4:7], s60 offen offset:0 sc1 lds
v_mfma_f32_16x16x32_bf16 v[112:115], a[96:99], a[76:79], v[112:115]
ds_read_b128 a[4:7], v8 offset:33792
v_mfma_f32_16x16x32_bf16 v[116:119], a[100:103], a[76:79], v[116:119]
ds_read_b64_tr_b16 a[36:37], v11 offset:32768
v_mfma_f32_16x16x32_bf16 v[100:103], a[100:103], a[72:75], v[100:103]
ds_read_b64_tr_b16 a[38:39], v11 offset:36864
v_mfma_f32_16x16x32_bf16 v[84:87], a[100:103], a[68:71], v[84:87]
ds_read_b128 a[8:11], v8 offset:34816
buffer_load_dwordx4 v2, s[4:7], s60 offen offset:1024 sc1 lds
v_mfma_f32_16x16x32_bf16 v[68:71], a[100:103], a[64:67], v[68:71]
ds_read_b64_tr_b16 a[40:41], v12 offset:32768
v_mfma_f32_16x16x32_bf16 v[72:75], a[104:107], a[64:67], v[72:75]
ds_read_b64_tr_b16 a[42:43], v12 offset:36864
v_mfma_f32_16x16x32_bf16 v[88:91], a[104:107], a[68:71], v[88:91]
ds_read_b128 a[12:15], v8 offset:35840
v_mfma_f32_16x16x32_bf16 v[104:107], a[104:107], a[72:75], v[104:107]
ds_read_b64_tr_b16 a[44:45], v13 offset:32768
buffer_load_dwordx4 v2, s[4:7], s60 offen offset:2048 sc1 lds
v_mfma_f32_16x16x32_bf16 v[120:123], a[104:107], a[76:79], v[120:123]
ds_read_b64_tr_b16 a[46:47], v13 offset:36864
v_mfma_f32_16x16x32_bf16 v[124:127], a[108:111], a[76:79], v[124:127]
ds_read_b128 a[16:19], v8 offset:36864
v_mfma_f32_16x16x32_bf16 v[108:111], a[108:111], a[72:75], v[108:111]
ds_read_b64_tr_b16 a[48:49], v10 offset:40960
v_mfma_f32_16x16x32_bf16 v[92:95], a[108:111], a[68:71], v[92:95]
ds_read_b64_tr_b16 a[50:51], v10 offset:45056
buffer_load_dwordx4 v2, s[4:7], s60 offen offset:3072 sc1 lds
s_add_u32 s60, s60, 8192
v_mfma_f32_16x16x32_bf16 v[76:79], a[108:111], a[64:67], v[76:79]
ds_read_b128 a[20:23], v8 offset:37888
v_mfma_f32_16x16x32_bf16 v[64:67], a[112:115], a[80:83], v[64:67]
ds_read_b64_tr_b16 a[52:53], v11 offset:40960
v_mfma_f32_16x16x32_bf16 v[80:83], a[112:115], a[84:87], v[80:83]
ds_read_b64_tr_b16 a[54:55], v11 offset:45056
v_mfma_f32_16x16x32_bf16 v[96:99], a[112:115], a[88:91], v[96:99]
ds_read_b128 a[24:27], v8 offset:38912
s_add_u32 m0, s64, 16384
s_nop 0
buffer_load_dwordx4 v4, s[8:11], s61 offen offset:0 lds
v_mfma_f32_16x16x32_bf16 v[112:115], a[112:115], a[92:95], v[112:115]
ds_read_b64_tr_b16 a[56:57], v12 offset:40960
v_mfma_f32_16x16x32_bf16 v[116:119], a[116:119], a[92:95], v[116:119]
ds_read_b64_tr_b16 a[58:59], v12 offset:45056
v_mfma_f32_16x16x32_bf16 v[100:103], a[116:119], a[88:91], v[100:103]
ds_read_b128 a[28:31], v8 offset:39936
v_mfma_f32_16x16x32_bf16 v[84:87], a[116:119], a[84:87], v[84:87]
ds_read_b64_tr_b16 a[60:61], v13 offset:40960
buffer_load_dwordx4 v5, s[8:11], s61 offen offset:1024 lds
v_mfma_f32_16x16x32_bf16 v[68:71], a[116:119], a[80:83], v[68:71]
ds_read_b64_tr_b16 a[62:63], v13 offset:45056
v_mfma_f32_16x16x32_bf16 v[72:75], a[120:123], a[80:83], v[72:75]
v_mfma_f32_16x16x32_bf16 v[88:91], a[120:123], a[84:87], v[88:91]
v_mfma_f32_16x16x32_bf16 v[104:107], a[120:123], a[88:91], v[104:107]
buffer_load_dwordx4 v6, s[8:11], s61 offen offset:2048 lds
v_mfma_f32_16x16x32_bf16 v[120:123], a[120:123], a[92:95], v[120:123]
v_mfma_f32_16x16x32_bf16 v[124:127], a[124:127], a[92:95], v[124:127]
v_mfma_f32_16x16x32_bf16 v[108:111], a[124:127], a[88:91], v[108:111]
v_mfma_f32_16x16x32_bf16 v[92:95], a[124:127], a[84:87], v[92:95]
buffer_load_dwordx4 v7, s[8:11], s61 offen offset:3072 lds
s_add_u32 s61, s61, s65
v_mfma_f32_16x16x32_bf16 v[76:79], a[124:127], a[80:83], v[76:79]
s_waitcnt vmcnt(16) lgkmcnt(0)
s_barrier
v_mfma_f32_16x16x32_bf16 v[64:67], a[32:35], a[0:3], v[64:67]
ds_read_b128 a[64:67], v8 offset:49152
v_mfma_f32_16x16x32_bf16 v[80:83], a[32:35], a[4:7], v[80:83]
ds_read_b64_tr_b16 a[96:97], v10 offset:49152
v_mfma_f32_16x16x32_bf16 v[96:99], a[32:35], a[8:11], v[96:99]
ds_read_b64_tr_b16 a[98:99], v10 offset:53248
s_add_u32 m0, s63, 32768
s_nop 0
buffer_load_dwordx4 v2, s[4:7], s60 offen offset:0 sc1 lds
v_mfma_f32_16x16x32_bf16 v[112:115], a[32:35], a[12:15], v[112:115]
ds_read_b128 a[68:71], v8 offset:50176
v_mfma_f32_16x16x32_bf16 v[116:119], a[36:39], a[12:15], v[116:119]
ds_read_b64_tr_b16 a[100:101], v11 offset:49152
v_mfma_f32_16x16x32_bf16 v[100:103], a[36:39], a[8:11], v[100:103]
ds_read_b64_tr_b16 a[102:103], v11 offset:53248
v_mfma_f32_16x16x32_bf16 v[84:87], a[36:39], a[4:7], v[84:87]
ds_read_b128 a[72:75], v8 offset:51200
buffer_load_dwordx4 v2, s[4:7], s60 offen offset:1024 sc1 lds
v_mfma_f32_16x16x32_bf16 v[68:71], a[36:39], a[0:3], v[68:71]
ds_read_b64_tr_b16 a[104:105], v12 offset:49152
v_mfma_f32_16x16x32_bf16 v[72:75], a[40:43], a[0:3], v[72:75]
ds_read_b64_tr_b16 a[106:107], v12 offset:53248
v_mfma_f32_16x16x32_bf16 v[88:91], a[40:43], a[4:7], v[88:91]
ds_read_b128 a[76:79], v8 offset:52224
v_mfma_f32_16x16x32_bf16 v[104:107], a[40:43], a[8:11], v[104:107]
ds_read_b64_tr_b16 a[108:109], v13 offset:49152
buffer_load_dwordx4 v2, s[4:7], s60 offen offset:2048 sc1 lds
v_mfma_f32_16x16x32_bf16 v[120:123], a[40:43], a[12:15], v[120:123]
ds_read_b64_tr_b16 a[110:111], v13 offset:53248
v_mfma_f32_16x16x32_bf16 v[124:127], a[44:47], a[12:15], v[124:127]
ds_read_b128 a[80:83], v8 offset:53248
v_mfma_f32_16x16x32_bf16 v[108:111], a[44:47], a[8:11], v[108:111]
ds_read_b64_tr_b16 a[112:113], v10 offset:57344
v_mfma_f32_16x16x32_bf16 v[92:95], a[44:47], a[4:7], v[92:95]
ds_read_b64_tr_b16 a[114:115], v10 offset:61440
buffer_load_dwordx4 v2, s[4:7], s60 offen offset:3072 sc1 lds
s_add_u32 s60, s60, 8192
v_mfma_f32_16x16x32_bf16 v[76:79], a[44:47], a[0:3], v[76:79]
ds_read_b128 a[84:87], v8 offset:54272
v_mfma_f32_16x16x32_bf16 v[64:67], a[48:51], a[16:19], v[64:67]
ds_read_b64_tr_b16 a[116:117], v11 offset:57344
v_mfma_f32_16x16x32_bf16 v[80:83], a[48:51], a[20:23], v[80:83]
ds_read_b64_tr_b16 a[118:119], v11 offset:61440
v_mfma_f32_16x16x32_bf16 v[96:99], a[48:51], a[24:27], v[96:99]
ds_read_b128 a[88:91], v8 offset:55296
s_add_u32 m0, s64, 32768
s_nop 0
buffer_load_dwordx4 v4, s[8:11], s61 offen offset:0 lds
v_mfma_f32_16x16x32_bf16 v[112:115], a[48:51], a[28:31], v[112:115]
ds_read_b64_tr_b16 a[120:121], v12 offset:57344
v_mfma_f32_16x16x32_bf16 v[116:119], a[52:55], a[28:31], v[116:119]
ds_read_b64_tr_b16 a[122:123], v12 offset:61440
v_mfma_f32_16x16x32_bf16 v[100:103], a[52:55], a[24:27], v[100:103]
ds_read_b128 a[92:95], v8 offset:56320
v_mfma_f32_16x16x32_bf16 v[84:87], a[52:55], a[20:23], v[84:87]
ds_read_b64_tr_b16 a[124:125], v13 offset:57344
buffer_load_dwordx4 v5, s[8:11], s61 offen offset:1024 lds
v_mfma_f32_16x16x32_bf16 v[68:71], a[52:55], a[16:19], v[68:71]
ds_read_b64_tr_b16 a[126:127], v13 offset:61440
v_mfma_f32_16x16x32_bf16 v[72:75], a[56:59], a[16:19], v[72:75]
v_mfma_f32_16x16x32_bf16 v[88:91], a[56:59], a[20:23], v[88:91]
v_mfma_f32_16x16x32_bf16 v[104:107], a[56:59], a[24:27], v[104:107]
buffer_load_dwordx4 v6, s[8:11], s61 offen offset:2048 lds
v_mfma_f32_16x16x32_bf16 v[120:123], a[56:59], a[28:31], v[120:123]
v_mfma_f32_16x16x32_bf16 v[124:127], a[60:63], a[28:31], v[124:127]
v_mfma_f32_16x16x32_bf16 v[108:111], a[60:63], a[24:27], v[108:111]
v_mfma_f32_16x16x32_bf16 v[92:95], a[60:63], a[20:23], v[92:95]
buffer_load_dwordx4 v7, s[8:11], s61 offen offset:3072 lds
s_add_u32 s61, s61, s65
v_mfma_f32_16x16x32_bf16 v[76:79], a[60:63], a[16:19], v[76:79]
s_waitcnt vmcnt(16) lgkmcnt(0)
s_barrier
v_mfma_f32_16x16x32_bf16 v[64:67], a[96:99], a[64:67], v[64:67]
ds_read_b128 a[0:3], v8 offset:0
v_mfma_f32_16x16x32_bf16 v[80:83], a[96:99], a[68:71], v[80:83]
ds_read_b64_tr_b16 a[32:33], v10 offset:0
v_mfma_f32_16x16x32_bf16 v[96:99], a[96:99], a[72:75], v[96:99]
ds_read_b64_tr_b16 a[34:35], v10 offset:4096
s_add_u32 m0, s63, 49152
s_nop 0
buffer_load_dwordx4 v2, s[4:7], s60 offen offset:0 sc1 lds
v_mfma_f32_16x16x32_bf16 v[112:115], a[96:99], a[76:79], v[112:115]
ds_read_b128 a[4:7], v8 offset:1024
v_mfma_f32_16x16x32_bf16 v[116:119], a[100:103], a[76:79], v[116:119]
ds_read_b64_tr_b16 a[36:37], v11 offset:0
v_mfma_f32_16x16x32_bf16 v[100:103], a[100:103], a[72:75], v[100:103]
ds_read_b64_tr_b16 a[38:39], v11 offset:4096
v_mfma_f32_16x16x32_bf16 v[84:87], a[100:103], a[68:71], v[84:87]
ds_read_b128 a[8:11], v8 offset:2048
buffer_load_dwordx4 v2, s[4:7], s60 offen offset:1024 sc1 lds
v_mfma_f32_16x16x32_bf16 v[68:71], a[100:103], a[64:67], v[68:71]
ds_read_b64_tr_b16 a[40:41], v12 offset:0
v_mfma_f32_16x16x32_bf16 v[72:75], a[104:107], a[64:67], v[72:75]
ds_read_b64_tr_b16 a[42:43], v12 offset:4096
v_mfma_f32_16x16x32_bf16 v[88:91], a[104:107], a[68:71], v[88:91]
ds_read_b128 a[12:15], v8 offset:3072
v_mfma_f32_16x16x32_bf16 v[104:107], a[104:107], a[72:75], v[104:107]
ds_read_b64_tr_b16 a[44:45], v13 offset:0
buffer_load_dwordx4 v2, s[4:7], s60 offen offset:2048 sc1 lds
v_mfma_f32_16x16x32_bf16 v[120:123], a[104:107], a[76:79], v[120:123]
ds_read_b64_tr_b16 a[46:47], v13 offset:4096
v_mfma_f32_16x16x32_bf16 v[124:127], a[108:111], a[76:79], v[124:127]
ds_read_b128 a[16:19], v8 offset:4096
v_mfma_f32_16x16x32_bf16 v[108:111], a[108:111], a[72:75], v[108:111]
ds_read_b64_tr_b16 a[48:49], v10 offset:8192
v_mfma_f32_16x16x32_bf16 v[92:95], a[108:111], a[68:71], v[92:95]
ds_read_b64_tr_b16 a[50:51], v10 offset:12288
buffer_load_dwordx4 v2, s[4:7], s60 offen offset:3072 sc1 lds
s_add_u32 s60, s60, 8192
v_mfma_f32_16x16x32_bf16 v[76:79], a[108:111], a[64:67], v[76:79]
ds_read_b128 a[20:23], v8 offset:5120
v_mfma_f32_16x16x32_bf16 v[64:67], a[112:115], a[80:83], v[64:67]
ds_read_b64_tr_b16 a[52:53], v11 offset:8192
v_mfma_f32_16x16x32_bf16 v[80:83], a[112:115], a[84:87], v[80:83]
ds_read_b64_tr_b16 a[54:55], v11 offset:12288
v_mfma_f32_16x16x32_bf16 v[96:99], a[112:115], a[88:91], v[96:99]
ds_read_b128 a[24:27], v8 offset:6144
s_add_u32 m0, s64, 49152
s_nop 0
buffer_load_dwordx4 v4, s[8:11], s61 offen offset:0 lds
v_mfma_f32_16x16x32_bf16 v[112:115], a[112:115], a[92:95], v[112:115]
ds_read_b64_tr_b16 a[56:57], v12 offset:8192
v_mfma_f32_16x16x32_bf16 v[116:119], a[116:119], a[92:95], v[116:119]
ds_read_b64_tr_b16 a[58:59], v12 offset:12288
v_mfma_f32_16x16x32_bf16 v[100:103], a[116:119], a[88:91], v[100:103]
ds_read_b128 a[28:31], v8 offset:7168
v_mfma_f32_16x16x32_bf16 v[84:87], a[116:119], a[84:87], v[84:87]
ds_read_b64_tr_b16 a[60:61], v13 offset:8192
buffer_load_dwordx4 v5, s[8:11], s61 offen offset:1024 lds
v_mfma_f32_16x16x32_bf16 v[68:71], a[116:119], a[80:83], v[68:71]
ds_read_b64_tr_b16 a[62:63], v13 offset:12288
v_mfma_f32_16x16x32_bf16 v[72:75], a[120:123], a[80:83], v[72:75]
v_mfma_f32_16x16x32_bf16 v[88:91], a[120:123], a[84:87], v[88:91]
v_mfma_f32_16x16x32_bf16 v[104:107], a[120:123], a[88:91], v[104:107]
buffer_load_dwordx4 v6, s[8:11], s61 offen offset:2048 lds
v_mfma_f32_16x16x32_bf16 v[120:123], a[120:123], a[92:95], v[120:123]
v_mfma_f32_16x16x32_bf16 v[124:127], a[124:127], a[92:95], v[124:127]
v_mfma_f32_16x16x32_bf16 v[108:111], a[124:127], a[88:91], v[108:111]
v_mfma_f32_16x16x32_bf16 v[92:95], a[124:127], a[84:87], v[92:95]
buffer_load_dwordx4 v7, s[8:11], s61 offen offset:3072 lds
s_add_u32 s61, s61, s65
v_mfma_f32_16x16x32_bf16 v[76:79], a[124:127], a[80:83], v[76:79]
s_sub_u32 s62, s62, 1
s_cmp_lg_u32 s62, 0
s_cbranch_scc1 Lgl_560
s_waitcnt vmcnt(16) lgkmcnt(0)
s_barrier
v_mfma_f32_16x16x32_bf16 v[64:67], a[32:35], a[0:3], v[64:67]
ds_read_b128 a[64:67], v8 offset:16384
v_mfma_f32_16x16x32_bf16 v[80:83], a[32:35], a[4:7], v[80:83]
ds_read_b64_tr_b16 a[96:97], v10 offset:16384
v_mfma_f32_16x16x32_bf16 v[96:99], a[32:35], a[8:11], v[96:99]
ds_read_b64_tr_b16 a[98:99], v10 offset:20480
v_mfma_f32_16x16x32_bf16 v[112:115], a[32:35], a[12:15], v[112:115]
ds_read_b128 a[68:71], v8 offset:17408
v_mfma_f32_16x16x32_bf16 v[116:119], a[36:39], a[12:15], v[116:119]
ds_read_b64_tr_b16 a[100:101], v11 offset:16384
v_mfma_f32_16x16x32_bf16 v[100:103], a[36:39], a[8:11], v[100:103]
ds_read_b64_tr_b16 a[102:103], v11 offset:20480
v_mfma_f32_16x16x32_bf16 v[84:87], a[36:39], a[4:7], v[84:87]
ds_read_b128 a[72:75], v8 offset:18432
v_mfma_f32_16x16x32_bf16 v[68:71], a[36:39], a[0:3], v[68:71]
ds_read_b64_tr_b16 a[104:105], v12 offset:16384
v_mfma_f32_16x16x32_bf16 v[72:75], a[40:43], a[0:3], v[72:75]
ds_read_b64_tr_b16 a[106:107], v12 offset:20480
v_mfma_f32_16x16x32_bf16 v[88:91], a[40:43], a[4:7], v[88:91]
ds_read_b128 a[76:79], v8 offset:19456
v_mfma_f32_16x16x32_bf16 v[104:107], a[40:43], a[8:11], v[104:107]
ds_read_b64_tr_b16 a[108:109], v13 offset:16384
v_mfma_f32_16x16x32_bf16 v[120:123], a[40:43], a[12:15], v[120:123]
ds_read_b64_tr_b16 a[110:111], v13 offset:20480
v_mfma_f32_16x16x32_bf16 v[124:127], a[44:47], a[12:15], v[124:127]
ds_read_b128 a[80:83], v8 offset:20480
v_mfma_f32_16x16x32_bf16 v[108:111], a[44:47], a[8:11], v[108:111]
ds_read_b64_tr_b16 a[112:113], v10 offset:24576
v_mfma_f32_16x16x32_bf16 v[92:95], a[44:47], a[4:7], v[92:95]
ds_read_b64_tr_b16 a[114:115], v10 offset:28672
v_mfma_f32_16x16x32_bf16 v[76:79], a[44:47], a[0:3], v[76:79]
ds_read_b128 a[84:87], v8 offset:21504
v_mfma_f32_16x16x32_bf16 v[64:67], a[48:51], a[16:19], v[64:67]
ds_read_b64_tr_b16 a[116:117], v11 offset:24576
v_mfma_f32_16x16x32_bf16 v[80:83], a[48:51], a[20:23], v[80:83]
ds_read_b64_tr_b16 a[118:119], v11 offset:28672
v_mfma_f32_16x16x32_bf16 v[96:99], a[48:51], a[24:27], v[96:99]
ds_read_b128 a[88:91], v8 offset:22528
v_mfma_f32_16x16x32_bf16 v[112:115], a[48:51], a[28:31], v[112:115]
ds_read_b64_tr_b16 a[120:121], v12 offset:24576
v_mfma_f32_16x16x32_bf16 v[116:119], a[52:55], a[28:31], v[116:119]
ds_read_b64_tr_b16 a[122:123], v12 offset:28672
v_mfma_f32_16x16x32_bf16 v[100:103], a[52:55], a[24:27], v[100:103]
ds_read_b128 a[92:95], v8 offset:23552
v_mfma_f32_16x16x32_bf16 v[84:87], a[52:55], a[20:23], v[84:87]
ds_read_b64_tr_b16 a[124:125], v13 offset:24576
v_mfma_f32_16x16x32_bf16 v[68:71], a[52:55], a[16:19], v[68:71]
ds_read_b64_tr_b16 a[126:127], v13 offset:28672
v_mfma_f32_16x16x32_bf16 v[72:75], a[56:59], a[16:19], v[72:75]
v_mfma_f32_16x16x32_bf16 v[88:91], a[56:59], a[20:23], v[88:91]
v_mfma_f32_16x16x32_bf16 v[104:107], a[56:59], a[24:27], v[104:107]
v_mfma_f32_16x16x32_bf16 v[120:123], a[56:59], a[28:31], v[120:123]
v_mfma_f32_16x16x32_bf16 v[124:127], a[60:63], a[28:31], v[124:127]
v_mfma_f32_16x16x32_bf16 v[108:111], a[60:63], a[24:27], v[108:111]
v_mfma_f32_16x16x32_bf16 v[92:95], a[60:63], a[20:23], v[92:95]
v_mfma_f32_16x16x32_bf16 v[76:79], a[60:63], a[16:19], v[76:79]
s_waitcnt vmcnt(8) lgkmcnt(0)
s_barrier
v_mfma_f32_16x16x32_bf16 v[64:67], a[96:99], a[64:67], v[64:67]
ds_read_b128 a[0:3], v8 offset:32768
v_mfma_f32_16x16x32_bf16 v[80:83], a[96:99], a[68:71], v[80:83]
ds_read_b64_tr_b16 a[32:33], v10 offset:32768
v_mfma_f32_16x16x32_bf16 v[96:99], a[96:99], a[72:75], v[96:99]
ds_read_b64_tr_b16 a[34:35], v10 offset:36864
v_mfma_f32_16x16x32_bf16 v[112:115], a[96:99], a[76:79], v[112:115]
ds_read_b128 a[4:7], v8 offset:33792
v_mfma_f32_16x16x32_bf16 v[116:119], a[100:103], a[76:79], v[116:119]
ds_read_b64_tr_b16 a[36:37], v11 offset:32768
v_mfma_f32_16x16x32_bf16 v[100:103], a[100:103], a[72:75], v[100:103]
ds_read_b64_tr_b16 a[38:39], v11 offset:36864
v_mfma_f32_16x16x32_bf16 v[84:87], a[100:103], a[68:71], v[84:87]
ds_read_b128 a[8:11], v8 offset:34816
v_mfma_f32_16x16x32_bf16 v[68:71], a[100:103], a[64:67], v[68:71]
ds_read_b64_tr_b16 a[40:41], v12 offset:32768
v_mfma_f32_16x16x32_bf16 v[72:75], a[104:107], a[64:67], v[72:75]
ds_read_b64_tr_b16 a[42:43], v12 offset:36864
v_mfma_f32_16x16x32_bf16 v[88:91], a[104:107], a[68:71], v[88:91]
ds_read_b128 a[12:15], v8 offset:35840
v_mfma_f32_16x16x32_bf16 v[104:107], a[104:107], a[72:75], v[104:107]
ds_read_b64_tr_b16 a[44:45], v13 offset:32768
v_mfma_f32_16x16x32_bf16 v[120:123], a[104:107], a[76:79], v[120:123]
ds_read_b64_tr_b16 a[46:47], v13 offset:36864
v_mfma_f32_16x16x32_bf16 v[124:127], a[108:111], a[76:79], v[124:127]
ds_read_b128 a[16:19], v8 offset:36864
v_mfma_f32_16x16x32_bf16 v[108:111], a[108:111], a[72:75], v[108:111]
ds_read_b64_tr_b16 a[48:49], v10 offset:40960
v_mfma_f32_16x16x32_bf16 v[92:95], a[108:111], a[68:71], v[92:95]
ds_read_b64_tr_b16 a[50:51], v10 offset:45056
v_mfma_f32_16x16x32_bf16 v[76:79], a[108:111], a[64:67], v[76:79]
ds_read_b128 a[20:23], v8 offset:37888
v_mfma_f32_16x16x32_bf16 v[64:67], a[112:115], a[80:83], v[64:67]
ds_read_b64_tr_b16 a[52:53], v11 offset:40960
v_mfma_f32_16x16x32_bf16 v[80:83], a[112:115], a[84:87], v[80:83]
ds_read_b64_tr_b16 a[54:55], v11 offset:45056
v_mfma_f32_16x16x32_bf16 v[96:99], a[112:115], a[88:91], v[96:99]
ds_read_b128 a[24:27], v8 offset:38912
v_mfma_f32_16x16x32_bf16 v[112:115], a[112:115], a[92:95], v[112:115]
ds_read_b64_tr_b16 a[56:57], v12 offset:40960
v_mfma_f32_16x16x32_bf16 v[116:119], a[116:119], a[92:95], v[116:119]
ds_read_b64_tr_b16 a[58:59], v12 offset:45056
v_mfma_f32_16x16x32_bf16 v[100:103], a[116:119], a[88:91], v[100:103]
ds_read_b128 a[28:31], v8 offset:39936
v_mfma_f32_16x16x32_bf16 v[84:87], a[116:119], a[84:87], v[84:87]
ds_read_b64_tr_b16 a[60:61], v13 offset:40960
v_mfma_f32_16x16x32_bf16 v[68:71], a[116:119], a[80:83], v[68:71]
ds_read_b64_tr_b16 a[62:63], v13 offset:45056
v_mfma_f32_16x16x32_bf16 v[72:75], a[120:123], a[80:83], v[72:75]
v_mfma_f32_16x16x32_bf16 v[88:91], a[120:123], a[84:87], v[88:91]
v_mfma_f32_16x16x32_bf16 v[104:107], a[120:123], a[88:91], v[104:107]
v_mfma_f32_16x16x32_bf16 v[120:123], a[120:123], a[92:95], v[120:123]
v_mfma_f32_16x16x32_bf16 v[124:127], a[124:127], a[92:95], v[124:127]
v_mfma_f32_16x16x32_bf16 v[108:111], a[124:127], a[88:91], v[108:111]
v_mfma_f32_16x16x32_bf16 v[92:95], a[124:127], a[84:87], v[92:95]
v_mfma_f32_16x16x32_bf16 v[76:79], a[124:127], a[80:83], v[76:79]
s_waitcnt vmcnt(0) lgkmcnt(0)
s_barrier
v_mfma_f32_16x16x32_bf16 v[64:67], a[32:35], a[0:3], v[64:67]
ds_read_b128 a[64:67], v8 offset:49152
v_mfma_f32_16x16x32_bf16 v[80:83], a[32:35], a[4:7], v[80:83]
ds_read_b64_tr_b16 a[96:97], v10 offset:49152
v_mfma_f32_16x16x32_bf16 v[96:99], a[32:35], a[8:11], v[96:99]
ds_read_b64_tr_b16 a[98:99], v10 offset:53248
v_mfma_f32_16x16x32_bf16 v[112:115], a[32:35], a[12:15], v[112:115]
ds_read_b128 a[68:71], v8 offset:50176
v_mfma_f32_16x16x32_bf16 v[116:119], a[36:39], a[12:15], v[116:119]
ds_read_b64_tr_b16 a[100:101], v11 offset:49152
v_mfma_f32_16x16x32_bf16 v[100:103], a[36:39], a[8:11], v[100:103]
ds_read_b64_tr_b16 a[102:103], v11 offset:53248
v_mfma_f32_16x16x32_bf16 v[84:87], a[36:39], a[4:7], v[84:87]
ds_read_b128 a[72:75], v8 offset:51200
v_mfma_f32_16x16x32_bf16 v[68:71], a[36:39], a[0:3], v[68:71]
ds_read_b64_tr_b16 a[104:105], v12 offset:49152
v_mfma_f32_16x16x32_bf16 v[72:75], a[40:43], a[0:3], v[72:75]
ds_read_b64_tr_b16 a[106:107], v12 offset:53248
v_mfma_f32_16x16x32_bf16 v[88:91], a[40:43], a[4:7], v[88:91]
ds_read_b128 a[76:79], v8 offset:52224
v_mfma_f32_16x16x32_bf16 v[104:107], a[40:43], a[8:11], v[104:107]
ds_read_b64_tr_b16 a[108:109], v13 offset:49152
v_mfma_f32_16x16x32_bf16 v[120:123], a[40:43], a[12:15], v[120:123]
ds_read_b64_tr_b16 a[110:111], v13 offset:53248
v_mfma_f32_16x16x32_bf16 v[124:127], a[44:47], a[12:15], v[124:127]
ds_read_b128 a[80:83], v8 offset:53248
v_mfma_f32_16x16x32_bf16 v[108:111], a[44:47], a[8:11], v[108:111]
ds_read_b64_tr_b16 a[112:113], v10 offset:57344
v_mfma_f32_16x16x32_bf16 v[92:95], a[44:47], a[4:7], v[92:95]
ds_read_b64_tr_b16 a[114:115], v10 offset:61440
v_mfma_f32_16x16x32_bf16 v[76:79], a[44:47], a[0:3], v[76:79]
ds_read_b128 a[84:87], v8 offset:54272
v_mfma_f32_16x16x32_bf16 v[64:67], a[48:51], a[16:19], v[64:67]
ds_read_b64_tr_b16 a[116:117], v11 offset:57344
v_mfma_f32_16x16x32_bf16 v[80:83], a[48:51], a[20:23], v[80:83]
ds_read_b64_tr_b16 a[118:119], v11 offset:61440
v_mfma_f32_16x16x32_bf16 v[96:99], a[48:51], a[24:27], v[96:99]
ds_read_b128 a[88:91], v8 offset:55296
v_mfma_f32_16x16x32_bf16 v[112:115], a[48:51], a[28:31], v[112:115]
ds_read_b64_tr_b16 a[120:121], v12 offset:57344
v_mfma_f32_16x16x32_bf16 v[116:119], a[52:55], a[28:31], v[116:119]
ds_read_b64_tr_b16 a[122:123], v12 offset:61440
v_mfma_f32_16x16x32_bf16 v[100:103], a[52:55], a[24:27], v[100:103]
ds_read_b128 a[92:95], v8 offset:56320
v_mfma_f32_16x16x32_bf16 v[84:87], a[52:55], a[20:23], v[84:87]
ds_read_b64_tr_b16 a[124:125], v13 offset:57344
v_mfma_f32_16x16x32_bf16 v[68:71], a[52:55], a[16:19], v[68:71]
ds_read_b64_tr_b16 a[126:127], v13 offset:61440
v_mfma_f32_16x16x32_bf16 v[72:75], a[56:59], a[16:19], v[72:75]
v_mfma_f32_16x16x32_bf16 v[88:91], a[56:59], a[20:23], v[88:91]
v_mfma_f32_16x16x32_bf16 v[104:107], a[56:59], a[24:27], v[104:107]
v_mfma_f32_16x16x32_bf16 v[120:123], a[56:59], a[28:31], v[120:123]
v_mfma_f32_16x16x32_bf16 v[124:127], a[60:63], a[28:31], v[124:127]
v_mfma_f32_16x16x32_bf16 v[108:111], a[60:63], a[24:27], v[108:111]
v_mfma_f32_16x16x32_bf16 v[92:95], a[60:63], a[20:23], v[92:95]
v_mfma_f32_16x16x32_bf16 v[76:79], a[60:63], a[16:19], v[76:79]
s_waitcnt lgkmcnt(0)
v_mfma_f32_16x16x32_bf16 v[64:67], a[96:99], a[64:67], v[64:67]
v_mfma_f32_16x16x32_bf16 v[80:83], a[96:99], a[68:71], v[80:83]
v_mfma_f32_16x16x32_bf16 v[96:99], a[96:99], a[72:75], v[96:99]
v_mfma_f32_16x16x32_bf16 v[112:115], a[96:99], a[76:79], v[112:115]
v_mfma_f32_16x16x32_bf16 v[116:119], a[100:103], a[76:79], v[116:119]
v_mfma_f32_16x16x32_bf16 v[100:103], a[100:103], a[72:75], v[100:103]
v_mfma_f32_16x16x32_bf16 v[84:87], a[100:103], a[68:71], v[84:87]
v_mfma_f32_16x16x32_bf16 v[68:71], a[100:103], a[64:67], v[68:71]
v_mfma_f32_16x16x32_bf16 v[72:75], a[104:107], a[64:67], v[72:75]
v_mfma_f32_16x16x32_bf16 v[88:91], a[104:107], a[68:71], v[88:91]
v_mfma_f32_16x16x32_bf16 v[104:107], a[104:107], a[72:75], v[104:107]
v_mfma_f32_16x16x32_bf16 v[120:123], a[104:107], a[76:79], v[120:123]
v_mfma_f32_16x16x32_bf16 v[124:127], a[108:111], a[76:79], v[124:127]
v_mfma_f32_16x16x32_bf16 v[108:111], a[108:111], a[72:75], v[108:111]
v_mfma_f32_16x16x32_bf16 v[92:95], a[108:111], a[68:71], v[92:95]
v_mfma_f32_16x16x32_bf16 v[76:79], a[108:111], a[64:67], v[76:79]
v_mfma_f32_16x16x32_bf16 v[64:67], a[112:115], a[80:83], v[64:67]
v_mfma_f32_16x16x32_bf16 v[80:83], a[112:115], a[84:87], v[80:83]
v_mfma_f32_16x16x32_bf16 v[96:99], a[112:115], a[88:91], v[96:99]
v_mfma_f32_16x16x32_bf16 v[112:115], a[112:115], a[92:95], v[112:115]
v_mfma_f32_16x16x32_bf16 v[116:119], a[116:119], a[92:95], v[116:119]
v_mfma_f32_16x16x32_bf16 v[100:103], a[116:119], a[88:91], v[100:103]
v_mfma_f32_16x16x32_bf16 v[84:87], a[116:119], a[84:87], v[84:87]
v_mfma_f32_16x16x32_bf16 v[68:71], a[116:119], a[80:83], v[68:71]
v_mfma_f32_16x16x32_bf16 v[72:75], a[120:123], a[80:83], v[72:75]
v_mfma_f32_16x16x32_bf16 v[88:91], a[120:123], a[84:87], v[88:91]
v_mfma_f32_16x16x32_bf16 v[104:107], a[120:123], a[88:91], v[104:107]
v_mfma_f32_16x16x32_bf16 v[120:123], a[120:123], a[92:95], v[120:123]
v_mfma_f32_16x16x32_bf16 v[124:127], a[124:127], a[92:95], v[124:127]
v_mfma_f32_16x16x32_bf16 v[108:111], a[124:127], a[88:91], v[108:111]
v_mfma_f32_16x16x32_bf16 v[92:95], a[124:127], a[84:87], v[92:95]
v_mfma_f32_16x16x32_bf16 v[76:79], a[124:127], a[80:83], v[76:79]
v_lshlrev_b32 v24, 4, v1
v_lshrrev_b32 v25, 4, v1
v_lshlrev_b32 v25, 4, v25
buffer_load_dwordx4 a[0:3], v25, s[4:7], s51 offen offset:0
buffer_load_dwordx4 a[4:7], v25, s[4:7], s51 offen offset:64
buffer_load_dwordx4 a[8:11], v25, s[4:7], s51 offen offset:128
buffer_load_dwordx4 a[12:15], v25, s[4:7], s51 offen offset:192
s_add_u32 s66, s49, 0
buffer_load_dwordx4 a[16:19], v24, s[4:7], s66 offen offset:0 sc1
buffer_load_dwordx4 a[20:23], v24, s[4:7], s66 offen offset:1024 sc1
buffer_load_dwordx4 a[24:27], v24, s[4:7], s66 offen offset:2048 sc1
buffer_load_dwordx4 a[28:31], v24, s[4:7], s66 offen offset:3072 sc1
s_add_u32 s66, s49, 4096
buffer_load_dwordx4 a[32:35], v24, s[4:7], s66 offen offset:0 sc1
buffer_load_dwordx4 a[36:39], v24, s[4:7], s66 offen offset:1024 sc1
buffer_load_dwordx4 a[40:43], v24, s[4:7], s66 offen offset:2048 sc1
buffer_load_dwordx4 a[44:47], v24, s[4:7], s66 offen offset:3072 sc1
s_waitcnt vmcnt(7)
v_accvgpr_read_b32 v28, a0
v_accvgpr_read_b32 v29, a1
v_accvgpr_read_b32 v30, a2
v_accvgpr_read_b32 v31, a3
v_accvgpr_read_b32 v32, a4
v_accvgpr_read_b32 v33, a5
v_accvgpr_read_b32 v34, a6
v_accvgpr_read_b32 v35, a7
v_accvgpr_read_b32 v36, a16
v_accvgpr_read_b32 v37, a17
v_accvgpr_read_b32 v38, a18
v_accvgpr_read_b32 v39, a19
v_lshlrev_b32 v40, 16, v36
v_and_b32 v41, 0xffff0000, v36
v_lshlrev_b32 v42, 16, v37
v_and_b32 v43, 0xffff0000, v37
v_lshlrev_b32 v44, 16, v38
v_and_b32 v45, 0xffff0000, v38
v_lshlrev_b32 v46, 16, v39
v_and_b32 v47, 0xffff0000, v39
v_pk_fma_f32 v[40:41], v[64:65], v[28:29], v[40:41]
v_pk_fma_f32 v[42:43], v[66:67], v[30:31], v[42:43]
v_pk_fma_f32 v[44:45], v[68:69], v[32:33], v[44:45]
v_pk_fma_f32 v[46:47], v[70:71], v[34:35], v[46:47]
v_cvt_pk_bf16_f32 v56, v40, v41
v_cvt_pk_bf16_f32 v57, v42, v43
v_cvt_pk_bf16_f32 v58, v44, v45
v_cvt_pk_bf16_f32 v59, v46, v47
s_add_u32 s66, s50, 0
buffer_store_dwordx4 v[56:59], v24, s[4:7], s66 offen offset:0 sc1
s_waitcnt vmcnt(7)
v_accvgpr_read_b32 v36, a20
v_accvgpr_read_b32 v37, a21
v_accvgpr_read_b32 v38, a22
v_accvgpr_read_b32 v39, a23
v_lshlrev_b32 v40, 16, v36
v_and_b32 v41, 0xffff0000, v36
v_lshlrev_b32 v42, 16, v37
v_and_b32 v43, 0xffff0000, v37
v_lshlrev_b32 v44, 16, v38
v_and_b32 v45, 0xffff0000, v38
v_lshlrev_b32 v46, 16, v39
v_and_b32 v47, 0xffff0000, v39
v_pk_fma_f32 v[40:41], v[80:81], v[28:29], v[40:41]
v_pk_fma_f32 v[42:43], v[82:83], v[30:31], v[42:43]
v_pk_fma_f32 v[44:45], v[84:85], v[32:33], v[44:45]
v_pk_fma_f32 v[46:47], v[86:87], v[34:35], v[46:47]
v_cvt_pk_bf16_f32 v60, v40, v41
v_cvt_pk_bf16_f32 v61, v42, v43
v_cvt_pk_bf16_f32 v62, v44, v45
v_cvt_pk_bf16_f32 v63, v46, v47
s_add_u32 s66, s50, 0
buffer_store_dwordx4 v[60:63], v24, s[4:7], s66 offen offset:1024 sc1
s_waitcnt vmcnt(7)
v_accvgpr_read_b32 v36, a24
v_accvgpr_read_b32 v37, a25
v_accvgpr_read_b32 v38, a26
v_accvgpr_read_b32 v39, a27
v_lshlrev_b32 v40, 16, v36
v_and_b32 v41, 0xffff0000, v36
v_lshlrev_b32 v42, 16, v37
v_and_b32 v43, 0xffff0000, v37
v_lshlrev_b32 v44, 16, v38
v_and_b32 v45, 0xffff0000, v38
v_lshlrev_b32 v46, 16, v39
v_and_b32 v47, 0xffff0000, v39
v_pk_fma_f32 v[40:41], v[96:97], v[28:29], v[40:41]
v_pk_fma_f32 v[42:43], v[98:99], v[30:31], v[42:43]
v_pk_fma_f32 v[44:45], v[100:101], v[32:33], v[44:45]
v_pk_fma_f32 v[46:47], v[102:103], v[34:35], v[46:47]
v_cvt_pk_bf16_f32 v52, v40, v41
v_cvt_pk_bf16_f32 v53, v42, v43
v_cvt_pk_bf16_f32 v54, v44, v45
v_cvt_pk_bf16_f32 v55, v46, v47
s_add_u32 s66, s50, 0
buffer_store_dwordx4 v[52:55], v24, s[4:7], s66 offen offset:2048 sc1
s_waitcnt vmcnt(7)
v_accvgpr_read_b32 v36, a28
v_accvgpr_read_b32 v37, a29
v_accvgpr_read_b32 v38, a30
v_accvgpr_read_b32 v39, a31
v_lshlrev_b32 v40, 16, v36
v_and_b32 v41, 0xffff0000, v36
v_lshlrev_b32 v42, 16, v37
v_and_b32 v43, 0xffff0000, v37
v_lshlrev_b32 v44, 16, v38
v_and_b32 v45, 0xffff0000, v38
v_lshlrev_b32 v46, 16, v39
v_and_b32 v47, 0xffff0000, v39
v_pk_fma_f32 v[40:41], v[112:113], v[28:29], v[40:41]
v_pk_fma_f32 v[42:43], v[114:115], v[30:31], v[42:43]
v_pk_fma_f32 v[44:45], v[116:117], v[32:33], v[44:45]
v_pk_fma_f32 v[46:47], v[118:119], v[34:35], v[46:47]
v_cvt_pk_bf16_f32 v56, v40, v41
v_cvt_pk_bf16_f32 v57, v42, v43
v_cvt_pk_bf16_f32 v58, v44, v45
v_cvt_pk_bf16_f32 v59, v46, v47
s_add_u32 s66, s50, 0
buffer_store_dwordx4 v[56:59], v24, s[4:7], s66 offen offset:3072 sc1
s_waitcnt vmcnt(7)
v_accvgpr_read_b32 v28, a8
v_accvgpr_read_b32 v29, a9
v_accvgpr_read_b32 v30, a10
v_accvgpr_read_b32 v31, a11
v_accvgpr_read_b32 v32, a12
v_accvgpr_read_b32 v33, a13
v_accvgpr_read_b32 v34, a14
v_accvgpr_read_b32 v35, a15
v_accvgpr_read_b32 v36, a32
v_accvgpr_read_b32 v37, a33
v_accvgpr_read_b32 v38, a34
v_accvgpr_read_b32 v39, a35
v_lshlrev_b32 v40, 16, v36
v_and_b32 v41, 0xffff0000, v36
v_lshlrev_b32 v42, 16, v37
v_and_b32 v43, 0xffff0000, v37
v_lshlrev_b32 v44, 16, v38
v_and_b32 v45, 0xffff0000, v38
v_lshlrev_b32 v46, 16, v39
v_and_b32 v47, 0xffff0000, v39
v_pk_fma_f32 v[40:41], v[72:73], v[28:29], v[40:41]
v_pk_fma_f32 v[42:43], v[74:75], v[30:31], v[42:43]
v_pk_fma_f32 v[44:45], v[76:77], v[32:33], v[44:45]
v_pk_fma_f32 v[46:47], v[78:79], v[34:35], v[46:47]
v_cvt_pk_bf16_f32 v60, v40, v41
v_cvt_pk_bf16_f32 v61, v42, v43
v_cvt_pk_bf16_f32 v62, v44, v45
v_cvt_pk_bf16_f32 v63, v46, v47
s_add_u32 s66, s50, 4096
buffer_store_dwordx4 v[60:63], v24, s[4:7], s66 offen offset:0 sc1
s_waitcnt vmcnt(7)
v_accvgpr_read_b32 v36, a36
v_accvgpr_read_b32 v37, a37
v_accvgpr_read_b32 v38, a38
v_accvgpr_read_b32 v39, a39
v_lshlrev_b32 v40, 16, v36
v_and_b32 v41, 0xffff0000, v36
v_lshlrev_b32 v42, 16, v37
v_and_b32 v43, 0xffff0000, v37
v_lshlrev_b32 v44, 16, v38
v_and_b32 v45, 0xffff0000, v38
v_lshlrev_b32 v46, 16, v39
v_and_b32 v47, 0xffff0000, v39
v_pk_fma_f32 v[40:41], v[88:89], v[28:29], v[40:41]
v_pk_fma_f32 v[42:43], v[90:91], v[30:31], v[42:43]
v_pk_fma_f32 v[44:45], v[92:93], v[32:33], v[44:45]
v_pk_fma_f32 v[46:47], v[94:95], v[34:35], v[46:47]
v_cvt_pk_bf16_f32 v52, v40, v41
v_cvt_pk_bf16_f32 v53, v42, v43
v_cvt_pk_bf16_f32 v54, v44, v45
v_cvt_pk_bf16_f32 v55, v46, v47
s_add_u32 s66, s50, 4096
buffer_store_dwordx4 v[52:55], v24, s[4:7], s66 offen offset:1024 sc1
s_waitcnt vmcnt(7)
v_accvgpr_read_b32 v36, a40
v_accvgpr_read_b32 v37, a41
v_accvgpr_read_b32 v38, a42
v_accvgpr_read_b32 v39, a43
v_lshlrev_b32 v40, 16, v36
v_and_b32 v41, 0xffff0000, v36
v_lshlrev_b32 v42, 16, v37
v_and_b32 v43, 0xffff0000, v37
v_lshlrev_b32 v44, 16, v38
v_and_b32 v45, 0xffff0000, v38
v_lshlrev_b32 v46, 16, v39
v_and_b32 v47, 0xffff0000, v39
v_pk_fma_f32 v[40:41], v[104:105], v[28:29], v[40:41]
v_pk_fma_f32 v[42:43], v[106:107], v[30:31], v[42:43]
v_pk_fma_f32 v[44:45], v[108:109], v[32:33], v[44:45]
v_pk_fma_f32 v[46:47], v[110:111], v[34:35], v[46:47]
v_cvt_pk_bf16_f32 v56, v40, v41
v_cvt_pk_bf16_f32 v57, v42, v43
v_cvt_pk_bf16_f32 v58, v44, v45
v_cvt_pk_bf16_f32 v59, v46, v47
s_add_u32 s66, s50, 4096
buffer_store_dwordx4 v[56:59], v24, s[4:7], s66 offen offset:2048 sc1
s_waitcnt vmcnt(7)
v_accvgpr_read_b32 v36, a44
v_accvgpr_read_b32 v37, a45
v_accvgpr_read_b32 v38, a46
v_accvgpr_read_b32 v39, a47
v_lshlrev_b32 v40, 16, v36
v_and_b32 v41, 0xffff0000, v36
v_lshlrev_b32 v42, 16, v37
v_and_b32 v43, 0xffff0000, v37
v_lshlrev_b32 v44, 16, v38
v_and_b32 v45, 0xffff0000, v38
v_lshlrev_b32 v46, 16, v39
v_and_b32 v47, 0xffff0000, v39
v_pk_fma_f32 v[40:41], v[120:121], v[28:29], v[40:41]
v_pk_fma_f32 v[42:43], v[122:123], v[30:31], v[42:43]
v_pk_fma_f32 v[44:45], v[124:125], v[32:33], v[44:45]
v_pk_fma_f32 v[46:47], v[126:127], v[34:35], v[46:47]
v_cvt_pk_bf16_f32 v60, v40, v41
v_cvt_pk_bf16_f32 v61, v42, v43
v_cvt_pk_bf16_f32 v62, v44, v45
v_cvt_pk_bf16_f32 v63, v46, v47
s_add_u32 s66, s50, 4096
buffer_store_dwordx4 v[60:63], v24, s[4:7], s66 offen offset:3072 sc1
Lend_559:
s_endpgm
.globl ln2_kernel
.p2align 8
.type ln2_kernel,@function
ln2_kernel:
s_cmp_ge_u32 s2, 128
s_cbranch_scc1 Lend_561
s_load_dwordx2 s[16:17], s[0:1], 0
s_load_dwordx2 s[30:31], s[0:1], 120
v_lshrrev_b32 v1, 6, v0
s_nop 0
v_readfirstlane_b32 s32, v1
v_and_b32 v1, 63, v0
s_waitcnt lgkmcnt(0)
s_mov_b32 s4, s30
s_and_b32 s5, s31, 0xffff
s_mov_b32 s6, 0x10000000
s_mov_b32 s7, 0x20000
s_mov_b32 s8, s16
s_and_b32 s9, s17, 0xffff
s_mov_b32 s10, 0x400000
s_mov_b32 s11, 0x20000
s_lshr_b32 s40, s2, 2
s_lshl_b32 s40, s40, 2
s_add_u32 s40, s40, s32
s_lshl_b32 s40, s40, 15
s_and_b32 s41, s2, 3
s_lshl_b32 s41, s41, 10
s_add_u32 s40, s40, s41
v_lshlrev_b32 v2, 4, v1
v_lshrrev_b32 v3, 4, v1
s_add_u32 s41, s40, 12582912
buffer_load_dwordx4 v[16:19], v2, s[4:7], s41 offen sc1
s_add_u32 s41, s40, 12587008
buffer_load_dwordx4 v[20:23], v2, s[4:7], s41 offen sc1
s_add_u32 s41, s40, 12591104
buffer_load_dwordx4 v[24:27], v2, s[4:7], s41 offen sc1
s_add_u32 s41, s40, 12595200
buffer_load_dwordx4 v[28:31], v2, s[4:7], s41 offen sc1
s_add_u32 s41, s40, 12599296
buffer_load_dwordx4 v[32:35], v2, s[4:7], s41 offen sc1
s_add_u32 s41, s40, 12603392
buffer_load_dwordx4 v[36:39], v2, s[4:7], s41 offen sc1
s_add_u32 s41, s40, 12607488
buffer_load_dwordx4 v[40:43], v2, s[4:7], s41 offen sc1
s_add_u32 s41, s40, 12611584
buffer_load_dwordx4 v[44:47], v2, s[4:7], s41 offen sc1
v_lshlrev_b32 v3, 4, v3
s_lshl_b32 s42, s32, 10
s_add_u32 s43, s42, 3162112
s_add_u32 s42, s42, 3158016
buffer_load_dwordx4 v[176:179], v3, s[4:7], s43 offen offset:0 sc1
buffer_load_dwordx4 v[112:115], v3, s[4:7], s42 offen offset:0 sc1
buffer_load_dwordx4 v[180:183], v3, s[4:7], s43 offen offset:64 sc1
buffer_load_dwordx4 v[116:119], v3, s[4:7], s42 offen offset:64 sc1
buffer_load_dwordx4 v[184:187], v3, s[4:7], s43 offen offset:128 sc1
buffer_load_dwordx4 v[120:123], v3, s[4:7], s42 offen offset:128 sc1
buffer_load_dwordx4 v[188:191], v3, s[4:7], s43 offen offset:192 sc1
buffer_load_dwordx4 v[124:127], v3, s[4:7], s42 offen offset:192 sc1
buffer_load_dwordx4 v[192:195], v3, s[4:7], s43 offen offset:256 sc1
buffer_load_dwordx4 v[128:131], v3, s[4:7], s42 offen offset:256 sc1
buffer_load_dwordx4 v[196:199], v3, s[4:7], s43 offen offset:320 sc1
buffer_load_dwordx4 v[132:135], v3, s[4:7], s42 offen offset:320 sc1
buffer_load_dwordx4 v[200:203], v3, s[4:7], s43 offen offset:384 sc1
buffer_load_dwordx4 v[136:139], v3, s[4:7], s42 offen offset:384 sc1
buffer_load_dwordx4 v[204:207], v3, s[4:7], s43 offen offset:448 sc1
buffer_load_dwordx4 v[140:143], v3, s[4:7], s42 offen offset:448 sc1
buffer_load_dwordx4 v[208:211], v3, s[4:7], s43 offen offset:512 sc1
buffer_load_dwordx4 v[144:147], v3, s[4:7], s42 offen offset:512 sc1
buffer_load_dwordx4 v[212:215], v3, s[4:7], s43 offen offset:576 sc1
buffer_load_dwordx4 v[148:151], v3, s[4:7], s42 offen offset:576 sc1
buffer_load_dwordx4 v[216:219], v3, s[4:7], s43 offen offset:640 sc1
buffer_load_dwordx4 v[152:155], v3, s[4:7], s42 offen offset:640 sc1
buffer_load_dwordx4 v[220:223], v3, s[4:7], s43 offen offset:704 sc1
buffer_load_dwordx4 v[156:159], v3, s[4:7], s42 offen offset:704 sc1
buffer_load_dwordx4 v[224:227], v3, s[4:7], s43 offen offset:768 sc1
buffer_load_dwordx4 v[160:163], v3, s[4:7], s42 offen offset:768 sc1
buffer_load_dwordx4 v[228:231], v3, s[4:7], s43 offen offset:832 sc1
buffer_load_dwordx4 v[164:167], v3, s[4:7], s42 offen offset:832 sc1
buffer_load_dwordx4 v[232:235], v3, s[4:7], s43 offen offset:896 sc1
buffer_load_dwordx4 v[168:171], v3, s[4:7], s42 offen offset:896 sc1
buffer_load_dwordx4 v[236:239], v3, s[4:7], s43 offen offset:960 sc1
buffer_load_dwordx4 v[172:175], v3, s[4:7], s42 offen offset:960 sc1
s_waitcnt vmcnt(32)
v_lshlrev_b32 v48, 16, v16
v_and_b32 v49, 0xffff0000, v16
v_lshlrev_b32 v50, 16, v17
v_and_b32 v51, 0xffff0000, v17
v_lshlrev_b32 v52, 16, v18
v_and_b32 v53, 0xffff0000, v18
v_lshlrev_b32 v54, 16, v19
v_and_b32 v55, 0xffff0000, v19
v_lshlrev_b32 v56, 16, v20
v_and_b32 v57, 0xffff0000, v20
v_lshlrev_b32 v58, 16, v21
v_and_b32 v59, 0xffff0000, v21
v_lshlrev_b32 v60, 16, v22
v_and_b32 v61, 0xffff0000, v22
v_lshlrev_b32 v62, 16, v23
v_and_b32 v63, 0xffff0000, v23
v_lshlrev_b32 v64, 16, v24
v_and_b32 v65, 0xffff0000, v24
v_lshlrev_b32 v66, 16, v25
v_and_b32 v67, 0xffff0000, v25
v_lshlrev_b32 v68, 16, v26
v_and_b32 v69, 0xffff0000, v26
v_lshlrev_b32 v70, 16, v27
v_and_b32 v71, 0xffff0000, v27
v_lshlrev_b32 v72, 16, v28
v_and_b32 v73, 0xffff0000, v28
v_lshlrev_b32 v74, 16, v29
v_and_b32 v75, 0xffff0000, v29
v_lshlrev_b32 v76, 16, v30
v_and_b32 v77, 0xffff0000, v30
v_lshlrev_b32 v78, 16, v31
v_and_b32 v79, 0xffff0000, v31
v_lshlrev_b32 v80, 16, v32
v_and_b32 v81, 0xffff0000, v32
v_lshlrev_b32 v82, 16, v33
v_and_b32 v83, 0xffff0000, v33
v_lshlrev_b32 v84, 16, v34
v_and_b32 v85, 0xffff0000, v34
v_lshlrev_b32 v86, 16, v35
v_and_b32 v87, 0xffff0000, v35
v_lshlrev_b32 v88, 16, v36
v_and_b32 v89, 0xffff0000, v36
v_lshlrev_b32 v90, 16, v37
v_and_b32 v91, 0xffff0000, v37
v_lshlrev_b32 v92, 16, v38
v_and_b32 v93, 0xffff0000, v38
v_lshlrev_b32 v94, 16, v39
v_and_b32 v95, 0xffff0000, v39
v_lshlrev_b32 v96, 16, v40
v_and_b32 v97, 0xffff0000, v40
v_lshlrev_b32 v98, 16, v41
v_and_b32 v99, 0xffff0000, v41
v_lshlrev_b32 v100, 16, v42
v_and_b32 v101, 0xffff0000, v42
v_lshlrev_b32 v102, 16, v43
v_and_b32 v103, 0xffff0000, v43
v_lshlrev_b32 v104, 16, v44
v_and_b32 v105, 0xffff0000, v44
v_lshlrev_b32 v106, 16, v45
v_and_b32 v107, 0xffff0000, v45
v_lshlrev_b32 v108, 16, v46
v_and_b32 v109, 0xffff0000, v46
v_lshlrev_b32 v110, 16, v47
v_and_b32 v111, 0xffff0000, v47
v_and_b32 v8, 15, v1
v_lshlrev_b32 v8, 4, v8
s_lshl_b32 s41, s32, 2
v_add_u32 v9, s41, v8
v_pk_add_f32 v[4:5], v[48:49], v[50:51]
v_pk_add_f32 v[4:5], v[4:5], v[52:53]
v_pk_add_f32 v[4:5], v[4:5], v[54:55]
v_pk_add_f32 v[4:5], v[4:5], v[56:57]
v_pk_add_f32 v[4:5], v[4:5], v[58:59]
v_pk_add_f32 v[4:5], v[4:5], v[60:61]
v_pk_add_f32 v[4:5], v[4:5], v[62:63]
v_pk_add_f32 v[4:5], v[4:5], v[64:65]
v_pk_add_f32 v[4:5], v[4:5], v[66:67]
v_pk_add_f32 v[4:5], v[4:5], v[68:69]
v_pk_add_f32 v[4:5], v[4:5], v[70:71]
v_pk_add_f32 v[4:5], v[4:5], v[72:73]
v_pk_add_f32 v[4:5], v[4:5], v[74:75]
v_pk_add_f32 v[4:5], v[4:5], v[76:77]
v_pk_add_f32 v[4:5], v[4:5], v[78:79]
v_pk_add_f32 v[4:5], v[4:5], v[80:81]
v_pk_add_f32 v[4:5], v[4:5], v[82:83]
v_pk_add_f32 v[4:5], v[4:5], v[84:85]
v_pk_add_f32 v[4:5], v[4:5], v[86:87]
v_pk_add_f32 v[4:5], v[4:5], v[88:89]
v_pk_add_f32 v[4:5], v[4:5], v[90:91]
v_pk_add_f32 v[4:5], v[4:5], v[92:93]
v_pk_add_f32 v[4:5], v[4:5], v[94:95]
v_pk_add_f32 v[4:5], v[4:5], v[96:97]
v_pk_add_f32 v[4:5], v[4:5], v[98:99]
v_pk_add_f32 v[4:5], v[4:5], v[100:101]
v_pk_add_f32 v[4:5], v[4:5], v[102:103]
v_pk_add_f32 v[4:5], v[4:5], v[104:105]
v_pk_add_f32 v[4:5], v[4:5], v[106:107]
v_pk_add_f32 v[4:5], v[4:5], v[108:109]
v_pk_add_f32 v[4:5], v[4:5], v[110:111]
v_add_f32 v4, v4, v5
v_mov_b32 v5, v4
s_nop 1
v_permlane16_swap_b32 v4, v5
s_nop 0
v_add_f32 v4, v4, v5
v_mov_b32 v5, v4
s_nop 1
v_permlane32_swap_b32 v4, v5
s_nop 0
v_add_f32 v4, v4, v5
ds_write_b32 v9, v4 offset:0
s_waitcnt lgkmcnt(0)
s_barrier
ds_read_b128 v[4:7], v8 offset:0
s_waitcnt lgkmcnt(0)
v_pk_add_f32 v[4:5], v[4:5], v[6:7]
v_add_f32 v4, v4, v5
v_mul_f32 v4, 0x3a800000, v4
v_pk_add_f32 v[48:49], v[48:49], v[4:5] op_sel_hi:[1,0] neg_lo:[0,1] neg_hi:[0,1]
v_pk_add_f32 v[50:51], v[50:51], v[4:5] op_sel_hi:[1,0] neg_lo:[0,1] neg_hi:[0,1]
v_pk_add_f32 v[52:53], v[52:53], v[4:5] op_sel_hi:[1,0] neg_lo:[0,1] neg_hi:[0,1]
v_pk_add_f32 v[54:55], v[54:55], v[4:5] op_sel_hi:[1,0] neg_lo:[0,1] neg_hi:[0,1]
v_pk_add_f32 v[56:57], v[56:57], v[4:5] op_sel_hi:[1,0] neg_lo:[0,1] neg_hi:[0,1]
v_pk_add_f32 v[58:59], v[58:59], v[4:5] op_sel_hi:[1,0] neg_lo:[0,1] neg_hi:[0,1]
v_pk_add_f32 v[60:61], v[60:61], v[4:5] op_sel_hi:[1,0] neg_lo:[0,1] neg_hi:[0,1]
v_pk_add_f32 v[62:63], v[62:63], v[4:5] op_sel_hi:[1,0] neg_lo:[0,1] neg_hi:[0,1]
v_pk_add_f32 v[64:65], v[64:65], v[4:5] op_sel_hi:[1,0] neg_lo:[0,1] neg_hi:[0,1]
v_pk_add_f32 v[66:67], v[66:67], v[4:5] op_sel_hi:[1,0] neg_lo:[0,1] neg_hi:[0,1]
v_pk_add_f32 v[68:69], v[68:69], v[4:5] op_sel_hi:[1,0] neg_lo:[0,1] neg_hi:[0,1]
v_pk_add_f32 v[70:71], v[70:71], v[4:5] op_sel_hi:[1,0] neg_lo:[0,1] neg_hi:[0,1]
v_pk_add_f32 v[72:73], v[72:73], v[4:5] op_sel_hi:[1,0] neg_lo:[0,1] neg_hi:[0,1]
v_pk_add_f32 v[74:75], v[74:75], v[4:5] op_sel_hi:[1,0] neg_lo:[0,1] neg_hi:[0,1]
v_pk_add_f32 v[76:77], v[76:77], v[4:5] op_sel_hi:[1,0] neg_lo:[0,1] neg_hi:[0,1]
v_pk_add_f32 v[78:79], v[78:79], v[4:5] op_sel_hi:[1,0] neg_lo:[0,1] neg_hi:[0,1]
v_pk_add_f32 v[80:81], v[80:81], v[4:5] op_sel_hi:[1,0] neg_lo:[0,1] neg_hi:[0,1]
v_pk_add_f32 v[82:83], v[82:83], v[4:5] op_sel_hi:[1,0] neg_lo:[0,1] neg_hi:[0,1]
v_pk_add_f32 v[84:85], v[84:85], v[4:5] op_sel_hi:[1,0] neg_lo:[0,1] neg_hi:[0,1]
v_pk_add_f32 v[86:87], v[86:87], v[4:5] op_sel_hi:[1,0] neg_lo:[0,1] neg_hi:[0,1]
v_pk_add_f32 v[88:89], v[88:89], v[4:5] op_sel_hi:[1,0] neg_lo:[0,1] neg_hi:[0,1]
v_pk_add_f32 v[90:91], v[90:91], v[4:5] op_sel_hi:[1,0] neg_lo:[0,1] neg_hi:[0,1]
v_pk_add_f32 v[92:93], v[92:93], v[4:5] op_sel_hi:[1,0] neg_lo:[0,1] neg_hi:[0,1]
v_pk_add_f32 v[94:95], v[94:95], v[4:5] op_sel_hi:[1,0] neg_lo:[0,1] neg_hi:[0,1]
v_pk_add_f32 v[96:97], v[96:97], v[4:5] op_sel_hi:[1,0] neg_lo:[0,1] neg_hi:[0,1]
v_pk_add_f32 v[98:99], v[98:99], v[4:5] op_sel_hi:[1,0] neg_lo:[0,1] neg_hi:[0,1]
v_pk_add_f32 v[100:101], v[100:101], v[4:5] op_sel_hi:[1,0] neg_lo:[0,1] neg_hi:[0,1]
v_pk_add_f32 v[102:103], v[102:103], v[4:5] op_sel_hi:[1,0] neg_lo:[0,1] neg_hi:[0,1]
v_pk_add_f32 v[104:105], v[104:105], v[4:5] op_sel_hi:[1,0] neg_lo:[0,1] neg_hi:[0,1]
v_pk_add_f32 v[106:107], v[106:107], v[4:5] op_sel_hi:[1,0] neg_lo:[0,1] neg_hi:[0,1]
v_pk_add_f32 v[108:109], v[108:109], v[4:5] op_sel_hi:[1,0] neg_lo:[0,1] neg_hi:[0,1]
v_pk_add_f32 v[110:111], v[110:111], v[4:5] op_sel_hi:[1,0] neg_lo:[0,1] neg_hi:[0,1]
v_pk_mul_f32 v[4:5], v[48:49], v[48:49]
v_pk_fma_f32 v[4:5], v[50:51], v[50:51], v[4:5]
v_pk_fma_f32 v[4:5], v[52:53], v[52:53], v[4:5]
v_pk_fma_f32 v[4:5], v[54:55], v[54:55], v[4:5]
v_pk_fma_f32 v[4:5], v[56:57], v[56:57], v[4:5]
v_pk_fma_f32 v[4:5], v[58:59], v[58:59], v[4:5]
v_pk_fma_f32 v[4:5], v[60:61], v[60:61], v[4:5]
v_pk_fma_f32 v[4:5], v[62:63], v[62:63], v[4:5]
v_pk_fma_f32 v[4:5], v[64:65], v[64:65], v[4:5]
v_pk_fma_f32 v[4:5], v[66:67], v[66:67], v[4:5]
v_pk_fma_f32 v[4:5], v[68:69], v[68:69], v[4:5]
v_pk_fma_f32 v[4:5], v[70:71], v[70:71], v[4:5]
v_pk_fma_f32 v[4:5], v[72:73], v[72:73], v[4:5]
v_pk_fma_f32 v[4:5], v[74:75], v[74:75], v[4:5]
v_pk_fma_f32 v[4:5], v[76:77], v[76:77], v[4:5]
v_pk_fma_f32 v[4:5], v[78:79], v[78:79], v[4:5]
v_pk_fma_f32 v[4:5], v[80:81], v[80:81], v[4:5]
v_pk_fma_f32 v[4:5], v[82:83], v[82:83], v[4:5]
v_pk_fma_f32 v[4:5], v[84:85], v[84:85], v[4:5]
v_pk_fma_f32 v[4:5], v[86:87], v[86:87], v[4:5]
v_pk_fma_f32 v[4:5], v[88:89], v[88:89], v[4:5]
v_pk_fma_f32 v[4:5], v[90:91], v[90:91], v[4:5]
v_pk_fma_f32 v[4:5], v[92:93], v[92:93], v[4:5]
v_pk_fma_f32 v[4:5], v[94:95], v[94:95], v[4:5]
v_pk_fma_f32 v[4:5], v[96:97], v[96:97], v[4:5]
v_pk_fma_f32 v[4:5], v[98:99], v[98:99], v[4:5]
v_pk_fma_f32 v[4:5], v[100:101], v[100:101], v[4:5]
v_pk_fma_f32 v[4:5], v[102:103], v[102:103], v[4:5]
v_pk_fma_f32 v[4:5], v[104:105], v[104:105], v[4:5]
v_pk_fma_f32 v[4:5], v[106:107], v[106:107], v[4:5]
v_pk_fma_f32 v[4:5], v[108:109], v[108:109], v[4:5]
v_pk_fma_f32 v[4:5], v[110:111], v[110:111], v[4:5]
v_add_f32 v4, v4, v5
v_mov_b32 v5, v4
s_nop 1
v_permlane16_swap_b32 v4, v5
s_nop 0
v_add_f32 v4, v4, v5
v_mov_b32 v5, v4
s_nop 1
v_permlane32_swap_b32 v4, v5
s_nop 0
v_add_f32 v4, v4, v5
ds_write_b32 v9, v4 offset:256
s_waitcnt lgkmcnt(0)
s_barrier
ds_read_b128 v[4:7], v8 offset:256
s_waitcnt lgkmcnt(0)
v_pk_add_f32 v[4:5], v[4:5], v[6:7]
v_add_f32 v4, v4, v5
v_mul_f32 v4, 0x3a800000, v4
v_add_f32 v4, 0x3727c5ac, v4
v_rsq_f32 v4, v4
s_waitcnt vmcnt(0)
v_pk_mul_f32 v[48:49], v[48:49], v[4:5] op_sel_hi:[1,0]
v_pk_add_f32 v[112:113], v[112:113], v[48:49]
v_pk_fma_f32 v[48:49], v[48:49], v[176:177], v[112:113]
v_pk_mul_f32 v[50:51], v[50:51], v[4:5] op_sel_hi:[1,0]
v_pk_add_f32 v[114:115], v[114:115], v[50:51]
v_pk_fma_f32 v[50:51], v[50:51], v[178:179], v[114:115]
v_pk_mul_f32 v[52:53], v[52:53], v[4:5] op_sel_hi:[1,0]
v_pk_add_f32 v[116:117], v[116:117], v[52:53]
v_pk_fma_f32 v[52:53], v[52:53], v[180:181], v[116:117]
v_pk_mul_f32 v[54:55], v[54:55], v[4:5] op_sel_hi:[1,0]
v_pk_add_f32 v[118:119], v[118:119], v[54:55]
v_pk_fma_f32 v[54:55], v[54:55], v[182:183], v[118:119]
v_cvt_pk_bf16_f32 v176, v48, v49
v_cvt_pk_bf16_f32 v177, v50, v51
v_cvt_pk_bf16_f32 v178, v52, v53
v_cvt_pk_bf16_f32 v179, v54, v55
s_add_u32 s41, s40, 16777216
buffer_store_dwordx4 v[176:179], v2, s[4:7], s41 offen sc1
v_pk_mul_f32 v[56:57], v[56:57], v[4:5] op_sel_hi:[1,0]
v_pk_add_f32 v[120:121], v[120:121], v[56:57]
v_pk_fma_f32 v[56:57], v[56:57], v[184:185], v[120:121]
v_pk_mul_f32 v[58:59], v[58:59], v[4:5] op_sel_hi:[1,0]
v_pk_add_f32 v[122:123], v[122:123], v[58:59]
v_pk_fma_f32 v[58:59], v[58:59], v[186:187], v[122:123]
v_pk_mul_f32 v[60:61], v[60:61], v[4:5] op_sel_hi:[1,0]
v_pk_add_f32 v[124:125], v[124:125], v[60:61]
v_pk_fma_f32 v[60:61], v[60:61], v[188:189], v[124:125]
v_pk_mul_f32 v[62:63], v[62:63], v[4:5] op_sel_hi:[1,0]
v_pk_add_f32 v[126:127], v[126:127], v[62:63]
v_pk_fma_f32 v[62:63], v[62:63], v[190:191], v[126:127]
v_cvt_pk_bf16_f32 v180, v56, v57
v_cvt_pk_bf16_f32 v181, v58, v59
v_cvt_pk_bf16_f32 v182, v60, v61
v_cvt_pk_bf16_f32 v183, v62, v63
s_add_u32 s41, s40, 16781312
buffer_store_dwordx4 v[180:183], v2, s[4:7], s41 offen sc1
v_pk_mul_f32 v[64:65], v[64:65], v[4:5] op_sel_hi:[1,0]
v_pk_add_f32 v[128:129], v[128:129], v[64:65]
v_pk_fma_f32 v[64:65], v[64:65], v[192:193], v[128:129]
v_pk_mul_f32 v[66:67], v[66:67], v[4:5] op_sel_hi:[1,0]
v_pk_add_f32 v[130:131], v[130:131], v[66:67]
v_pk_fma_f32 v[66:67], v[66:67], v[194:195], v[130:131]
v_pk_mul_f32 v[68:69], v[68:69], v[4:5] op_sel_hi:[1,0]
v_pk_add_f32 v[132:133], v[132:133], v[68:69]
v_pk_fma_f32 v[68:69], v[68:69], v[196:197], v[132:133]
v_pk_mul_f32 v[70:71], v[70:71], v[4:5] op_sel_hi:[1,0]
v_pk_add_f32 v[134:135], v[134:135], v[70:71]
v_pk_fma_f32 v[70:71], v[70:71], v[198:199], v[134:135]
v_cvt_pk_bf16_f32 v184, v64, v65
v_cvt_pk_bf16_f32 v185, v66, v67
v_cvt_pk_bf16_f32 v186, v68, v69
v_cvt_pk_bf16_f32 v187, v70, v71
s_add_u32 s41, s40, 16785408
buffer_store_dwordx4 v[184:187], v2, s[4:7], s41 offen sc1
v_pk_mul_f32 v[72:73], v[72:73], v[4:5] op_sel_hi:[1,0]
v_pk_add_f32 v[136:137], v[136:137], v[72:73]
v_pk_fma_f32 v[72:73], v[72:73], v[200:201], v[136:137]
v_pk_mul_f32 v[74:75], v[74:75], v[4:5] op_sel_hi:[1,0]
v_pk_add_f32 v[138:139], v[138:139], v[74:75]
v_pk_fma_f32 v[74:75], v[74:75], v[202:203], v[138:139]
v_pk_mul_f32 v[76:77], v[76:77], v[4:5] op_sel_hi:[1,0]
v_pk_add_f32 v[140:141], v[140:141], v[76:77]
v_pk_fma_f32 v[76:77], v[76:77], v[204:205], v[140:141]
v_pk_mul_f32 v[78:79], v[78:79], v[4:5] op_sel_hi:[1,0]
v_pk_add_f32 v[142:143], v[142:143], v[78:79]
v_pk_fma_f32 v[78:79], v[78:79], v[206:207], v[142:143]
v_cvt_pk_bf16_f32 v188, v72, v73
v_cvt_pk_bf16_f32 v189, v74, v75
v_cvt_pk_bf16_f32 v190, v76, v77
v_cvt_pk_bf16_f32 v191, v78, v79
s_add_u32 s41, s40, 16789504
buffer_store_dwordx4 v[188:191], v2, s[4:7], s41 offen sc1
v_pk_mul_f32 v[80:81], v[80:81], v[4:5] op_sel_hi:[1,0]
v_pk_add_f32 v[144:145], v[144:145], v[80:81]
v_pk_fma_f32 v[80:81], v[80:81], v[208:209], v[144:145]
v_pk_mul_f32 v[82:83], v[82:83], v[4:5] op_sel_hi:[1,0]
v_pk_add_f32 v[146:147], v[146:147], v[82:83]
v_pk_fma_f32 v[82:83], v[82:83], v[210:211], v[146:147]
v_pk_mul_f32 v[84:85], v[84:85], v[4:5] op_sel_hi:[1,0]
v_pk_add_f32 v[148:149], v[148:149], v[84:85]
v_pk_fma_f32 v[84:85], v[84:85], v[212:213], v[148:149]
v_pk_mul_f32 v[86:87], v[86:87], v[4:5] op_sel_hi:[1,0]
v_pk_add_f32 v[150:151], v[150:151], v[86:87]
v_pk_fma_f32 v[86:87], v[86:87], v[214:215], v[150:151]
v_cvt_pk_bf16_f32 v192, v80, v81
v_cvt_pk_bf16_f32 v193, v82, v83
v_cvt_pk_bf16_f32 v194, v84, v85
v_cvt_pk_bf16_f32 v195, v86, v87
s_add_u32 s41, s40, 16793600
buffer_store_dwordx4 v[192:195], v2, s[4:7], s41 offen sc1
v_pk_mul_f32 v[88:89], v[88:89], v[4:5] op_sel_hi:[1,0]
v_pk_add_f32 v[152:153], v[152:153], v[88:89]
v_pk_fma_f32 v[88:89], v[88:89], v[216:217], v[152:153]
v_pk_mul_f32 v[90:91], v[90:91], v[4:5] op_sel_hi:[1,0]
v_pk_add_f32 v[154:155], v[154:155], v[90:91]
v_pk_fma_f32 v[90:91], v[90:91], v[218:219], v[154:155]
v_pk_mul_f32 v[92:93], v[92:93], v[4:5] op_sel_hi:[1,0]
v_pk_add_f32 v[156:157], v[156:157], v[92:93]
v_pk_fma_f32 v[92:93], v[92:93], v[220:221], v[156:157]
v_pk_mul_f32 v[94:95], v[94:95], v[4:5] op_sel_hi:[1,0]
v_pk_add_f32 v[158:159], v[158:159], v[94:95]
v_pk_fma_f32 v[94:95], v[94:95], v[222:223], v[158:159]
v_cvt_pk_bf16_f32 v196, v88, v89
v_cvt_pk_bf16_f32 v197, v90, v91
v_cvt_pk_bf16_f32 v198, v92, v93
v_cvt_pk_bf16_f32 v199, v94, v95
s_add_u32 s41, s40, 16797696
buffer_store_dwordx4 v[196:199], v2, s[4:7], s41 offen sc1
v_pk_mul_f32 v[96:97], v[96:97], v[4:5] op_sel_hi:[1,0]
v_pk_add_f32 v[160:161], v[160:161], v[96:97]
v_pk_fma_f32 v[96:97], v[96:97], v[224:225], v[160:161]
v_pk_mul_f32 v[98:99], v[98:99], v[4:5] op_sel_hi:[1,0]
v_pk_add_f32 v[162:163], v[162:163], v[98:99]
v_pk_fma_f32 v[98:99], v[98:99], v[226:227], v[162:163]
v_pk_mul_f32 v[100:101], v[100:101], v[4:5] op_sel_hi:[1,0]
v_pk_add_f32 v[164:165], v[164:165], v[100:101]
v_pk_fma_f32 v[100:101], v[100:101], v[228:229], v[164:165]
v_pk_mul_f32 v[102:103], v[102:103], v[4:5] op_sel_hi:[1,0]
v_pk_add_f32 v[166:167], v[166:167], v[102:103]
v_pk_fma_f32 v[102:103], v[102:103], v[230:231], v[166:167]
v_cvt_pk_bf16_f32 v200, v96, v97
v_cvt_pk_bf16_f32 v201, v98, v99
v_cvt_pk_bf16_f32 v202, v100, v101
v_cvt_pk_bf16_f32 v203, v102, v103
s_add_u32 s41, s40, 16801792
buffer_store_dwordx4 v[200:203], v2, s[4:7], s41 offen sc1
v_pk_mul_f32 v[104:105], v[104:105], v[4:5] op_sel_hi:[1,0]
v_pk_add_f32 v[168:169], v[168:169], v[104:105]
v_pk_fma_f32 v[104:105], v[104:105], v[232:233], v[168:169]
v_pk_mul_f32 v[106:107], v[106:107], v[4:5] op_sel_hi:[1,0]
v_pk_add_f32 v[170:171], v[170:171], v[106:107]
v_pk_fma_f32 v[106:107], v[106:107], v[234:235], v[170:171]
v_pk_mul_f32 v[108:109], v[108:109], v[4:5] op_sel_hi:[1,0]
v_pk_add_f32 v[172:173], v[172:173], v[108:109]
v_pk_fma_f32 v[108:109], v[108:109], v[236:237], v[172:173]
v_pk_mul_f32 v[110:111], v[110:111], v[4:5] op_sel_hi:[1,0]
v_pk_add_f32 v[174:175], v[174:175], v[110:111]
v_pk_fma_f32 v[110:111], v[110:111], v[238:239], v[174:175]
v_cvt_pk_bf16_f32 v204, v104, v105
v_cvt_pk_bf16_f32 v205, v106, v107
v_cvt_pk_bf16_f32 v206, v108, v109
v_cvt_pk_bf16_f32 v207, v110, v111
s_add_u32 s41, s40, 16805888
buffer_store_dwordx4 v[204:207], v2, s[4:7], s41 offen sc1
Lend_561:
s_endpgm
.globl up_kernel
.p2align 8
.type up_kernel,@function
up_kernel:
s_cmp_ge_u32 s2, 224
s_cbranch_scc1 Lend_562
s_load_dwordx2 s[16:17], s[0:1], 64
s_load_dwordx2 s[18:19], s[0:1], 72
s_load_dwordx2 s[30:31], s[0:1], 120
v_lshrrev_b32 v1, 6, v0
s_nop 0
v_readfirstlane_b32 s32, v1
v_and_b32 v1, 63, v0
s_waitcnt lgkmcnt(0)
s_mov_b32 s4, s30
s_and_b32 s5, s31, 0xffff
s_mov_b32 s6, 0x10000000
s_mov_b32 s7, 0x20000
s_and_b32 s40, s2, 7
s_lshr_b32 s41, s2, 3
s_and_b32 s42, s41, 3
s_and_b32 s43, s40, 1
s_lshl_b32 s43, s43, 2
s_add_u32 s42, s42, s43
s_lshr_b32 s41, s41, 2
s_lshr_b32 s40, s40, 1
s_mul_i32 s40, s40, 7
s_add_u32 s41, s41, s40
s_cmp_ge_u32 s32, 2
s_cselect_b64 s[44:45], s[18:19], s[16:17]
s_mov_b32 s8, s44
s_and_b32 s9, s45, 0xffff
s_mov_b32 s10, 0x700000
s_mov_b32 s11, 0x20000
v_lshlrev_b32 v2, 4, v1
v_lshrrev_b32 v20, 4, v1
v_and_b32 v21, 15, v1
s_mov_b32 s66, 7168
v_lshlrev_b32 v22, 2, v20
v_or_b32 v22, 0, v22
v_xor_b32 v22, v22, v21
v_lshlrev_b32 v22, 4, v22
v_mad_u32_u24 v22, v20, s66, v22
v_add_u32 v4, 0, v22
v_lshlrev_b32 v22, 2, v20
v_or_b32 v22, 2, v22
v_xor_b32 v22, v22, v21
v_lshlrev_b32 v22, 4, v22
v_mad_u32_u24 v22, v20, s66, v22
v_add_u32 v5, 27648, v22
v_lshlrev_b32 v22, 2, v20
v_or_b32 v22, 0, v22
v_xor_b32 v22, v22, v21
v_lshlrev_b32 v22, 4, v22
v_mad_u32_u24 v22, v20, s66, v22
v_add_u32 v6, 55296, v22
v_lshlrev_b32 v22, 2, v20
v_or_b32 v22, 2, v22
v_xor_b32 v22, v22, v21
v_lshlrev_b32 v22, 4, v22
v_mad_u32_u24 v22, v20, s66, v22
v_add_u32 v7, 82944, v22
s_mul_i32 s63, s32, 4096
s_add_u32 s63, s63, 65536
s_mul_i32 s64, s32, 4096
s_mov_b32 s65, 229376
s_lshr_b32 s66, s32, 1
s_mul_i32 s66, s66, 8192
s_add_u32 s66, s66, 65536
v_add_u32 v8, s66, v2
v_bfe_u32 v20, v1, 2, 2
v_lshrrev_b32 v21, 4, v1
v_lshl_add_u32 v22, v21, 2, v20
v_lshlrev_b32 v22, 8, v22
v_and_b32 v23, 3, v1
v_lshl_add_u32 v22, v23, 3, v22
v_and_b32 v21, 1, v21
v_lshl_add_u32 v20, v20, 1, v21
s_and_b32 s66, s32, 1
s_lshl_b32 s66, s66, 2
v_xor_b32 v20, s66, v20
v_xor_b32 v21, 0, v20
v_lshl_add_u32 v10, v21, 5, v22
v_xor_b32 v21, 1, v20
v_lshl_add_u32 v11, v21, 5, v22
v_xor_b32 v21, 2, v20
v_lshl_add_u32 v12, v21, 5, v22
v_xor_b32 v21, 3, v20
v_lshl_add_u32 v13, v21, 5, v22
s_mul_i32 s60, s42, 524288
s_add_u32 s60, s60, 16777216
s_lshl_b32 s61, s41, 8
s_lshr_b32 s66, s32, 0
s_mul_i32 s66, s66, 131072
s_add_u32 s60, s60, s66
s_and_b32 s66, s32, 1
s_mul_i32 s66, s66, 114688
s_add_u32 s61, s61, s66
s_add_u32 m0, s63, 0
s_nop 0
buffer_load_dwordx4 v2, s[4:7], s60 offen offset:0 sc1 lds
buffer_load_dwordx4 v2, s[4:7], s60 offen offset:1024 sc1 lds
buffer_load_dwordx4 v2, s[4:7], s60 offen offset:2048 sc1 lds
buffer_load_dwordx4 v2, s[4:7], s60 offen offset:3072 sc1 lds
s_add_u32 s60, s60, 4096
s_add_u32 m0, s64, 0
s_nop 0
buffer_load_dwordx4 v4, s[8:11], s61 offen offset:0 lds
buffer_load_dwordx4 v5, s[8:11], s61 offen offset:1024 lds
buffer_load_dwordx4 v6, s[8:11], s61 offen offset:2048 lds
buffer_load_dwordx4 v7, s[8:11], s61 offen offset:3072 lds
s_add_u32 s61, s61, s65
s_add_u32 m0, s63, 16384
s_nop 0
buffer_load_dwordx4 v2, s[4:7], s60 offen offset:0 sc1 lds
buffer_load_dwordx4 v2, s[4:7], s60 offen offset:1024 sc1 lds
buffer_load_dwordx4 v2, s[4:7], s60 offen offset:2048 sc1 lds
buffer_load_dwordx4 v2, s[4:7], s60 offen offset:3072 sc1 lds
s_add_u32 s60, s60, 4096
s_add_u32 m0, s64, 16384
s_nop 0
buffer_load_dwordx4 v4, s[8:11], s61 offen offset:0 lds
buffer_load_dwordx4 v5, s[8:11], s61 offen offset:1024 lds
buffer_load_dwordx4 v6, s[8:11], s61 offen offset:2048 lds
buffer_load_dwordx4 v7, s[8:11], s61 offen offset:3072 lds
s_add_u32 s61, s61, s65
s_add_u32 m0, s63, 32768
s_nop 0
buffer_load_dwordx4 v2, s[4:7], s60 offen offset:0 sc1 lds
buffer_load_dwordx4 v2, s[4:7], s60 offen offset:1024 sc1 lds
buffer_load_dwordx4 v2, s[4:7], s60 offen offset:2048 sc1 lds
buffer_load_dwordx4 v2, s[4:7], s60 offen offset:3072 sc1 lds
s_add_u32 s60, s60, 4096
s_add_u32 m0, s64, 32768
s_nop 0
buffer_load_dwordx4 v4, s[8:11], s61 offen offset:0 lds
buffer_load_dwordx4 v5, s[8:11], s61 offen offset:1024 lds
buffer_load_dwordx4 v6, s[8:11], s61 offen offset:2048 lds
buffer_load_dwordx4 v7, s[8:11], s61 offen offset:3072 lds
s_add_u32 s61, s61, s65
s_add_u32 m0, s63, 49152
s_nop 0
buffer_load_dwordx4 v2, s[4:7], s60 offen offset:0 sc1 lds
buffer_load_dwordx4 v2, s[4:7], s60 offen offset:1024 sc1 lds
buffer_load_dwordx4 v2, s[4:7], s60 offen offset:2048 sc1 lds
buffer_load_dwordx4 v2, s[4:7], s60 offen offset:3072 sc1 lds
s_add_u32 s60, s60, 4096
s_add_u32 m0, s64, 49152
s_nop 0
buffer_load_dwordx4 v4, s[8:11], s61 offen offset:0 lds
buffer_load_dwordx4 v5, s[8:11], s61 offen offset:1024 lds
buffer_load_dwordx4 v6, s[8:11], s61 offen offset:2048 lds
buffer_load_dwordx4 v7, s[8:11], s61 offen offset:3072 lds
s_add_u32 s61, s61, s65
s_lshr_b32 s46, s32, 1
s_lshl_b32 s47, s42, 1
s_add_u32 s46, s46, s47
s_mul_i32 s46, s46, 224
s_and_b32 s47, s32, 1
s_lshl_b32 s48, s41, 1
s_add_u32 s47, s47, s48
s_lshl_b32 s47, s47, 1
s_add_u32 s46, s46, s47
s_lshl_b32 s46, s46, 12
s_add_u32 s48, s46, 100663296
s_waitcnt vmcnt(24)
s_barrier
ds_read_b128 a[0:3], v8 offset:0
ds_read_b64_tr_b16 a[32:33], v10 offset:0
ds_read_b64_tr_b16 a[34:35], v10 offset:4096
ds_read_b128 a[4:7], v8 offset:1024
ds_read_b64_tr_b16 a[36:37], v11 offset:0
ds_read_b64_tr_b16 a[38:39], v11 offset:4096
ds_read_b128 a[8:11], v8 offset:2048
ds_read_b64_tr_b16 a[40:41], v12 offset:0
ds_read_b64_tr_b16 a[42:43], v12 offset:4096
ds_read_b128 a[12:15], v8 offset:3072
ds_read_b64_tr_b16 a[44:45], v13 offset:0
ds_read_b64_tr_b16 a[46:47], v13 offset:4096
ds_read_b128 a[16:19], v8 offset:4096
ds_read_b64_tr_b16 a[48:49], v10 offset:8192
ds_read_b64_tr_b16 a[50:51], v10 offset:12288
ds_read_b128 a[20:23], v8 offset:5120
ds_read_b64_tr_b16 a[52:53], v11 offset:8192
ds_read_b64_tr_b16 a[54:55], v11 offset:12288
ds_read_b128 a[24:27], v8 offset:6144
ds_read_b64_tr_b16 a[56:57], v12 offset:8192
ds_read_b64_tr_b16 a[58:59], v12 offset:12288
ds_read_b128 a[28:31], v8 offset:7168
ds_read_b64_tr_b16 a[60:61], v13 offset:8192
ds_read_b64_tr_b16 a[62:63], v13 offset:12288
s_waitcnt vmcnt(16) lgkmcnt(0)
s_barrier
v_mfma_f32_16x16x32_bf16 v[64:67], a[32:35], a[0:3], 0
ds_read_b128 a[64:67], v8 offset:16384
v_mfma_f32_16x16x32_bf16 v[96:99], a[32:35], a[4:7], 0
v_mfma_f32_16x16x32_bf16 v[128:131], a[32:35], a[8:11], 0
ds_read_b64_tr_b16 a[96:97], v10 offset:16384
v_mfma_f32_16x16x32_bf16 v[160:163], a[32:35], a[12:15], 0
v_mfma_f32_16x16x32_bf16 v[192:195], a[32:35], a[16:19], 0
ds_read_b64_tr_b16 a[98:99], v10 offset:20480
s_add_u32 m0, s63, 0
s_nop 0
buffer_load_dwordx4 v2, s[4:7], s60 offen offset:0 sc1 lds
v_mfma_f32_16x16x32_bf16 v[224:227], a[32:35], a[20:23], 0
v_mfma_f32_16x16x32_bf16 a[128:131], a[32:35], a[24:27], 0
ds_read_b128 a[68:71], v8 offset:17408
v_mfma_f32_16x16x32_bf16 a[160:163], a[32:35], a[28:31], 0
v_mfma_f32_16x16x32_bf16 a[164:167], a[36:39], a[28:31], 0
ds_read_b64_tr_b16 a[100:101], v11 offset:16384
v_mfma_f32_16x16x32_bf16 a[132:135], a[36:39], a[24:27], 0
v_mfma_f32_16x16x32_bf16 v[228:231], a[36:39], a[20:23], 0
ds_read_b64_tr_b16 a[102:103], v11 offset:20480
v_mfma_f32_16x16x32_bf16 v[196:199], a[36:39], a[16:19], 0
v_mfma_f32_16x16x32_bf16 v[164:167], a[36:39], a[12:15], 0
ds_read_b128 a[72:75], v8 offset:18432
buffer_load_dwordx4 v2, s[4:7], s60 offen offset:1024 sc1 lds
v_mfma_f32_16x16x32_bf16 v[132:135], a[36:39], a[8:11], 0
v_mfma_f32_16x16x32_bf16 v[100:103], a[36:39], a[4:7], 0
ds_read_b64_tr_b16 a[104:105], v12 offset:16384
v_mfma_f32_16x16x32_bf16 v[68:71], a[36:39], a[0:3], 0
v_mfma_f32_16x16x32_bf16 v[72:75], a[40:43], a[0:3], 0
ds_read_b64_tr_b16 a[106:107], v12 offset:20480
v_mfma_f32_16x16x32_bf16 v[104:107], a[40:43], a[4:7], 0
v_mfma_f32_16x16x32_bf16 v[136:139], a[40:43], a[8:11], 0
ds_read_b128 a[76:79], v8 offset:19456
v_mfma_f32_16x16x32_bf16 v[168:171], a[40:43], a[12:15], 0
v_mfma_f32_16x16x32_bf16 v[200:203], a[40:43], a[16:19], 0
ds_read_b64_tr_b16 a[108:109], v13 offset:16384
buffer_load_dwordx4 v2, s[4:7], s60 offen offset:2048 sc1 lds
v_mfma_f32_16x16x32_bf16 v[232:235], a[40:43], a[20:23], 0
v_mfma_f32_16x16x32_bf16 a[136:139], a[40:43], a[24:27], 0
ds_read_b64_tr_b16 a[110:111], v13 offset:20480
v_mfma_f32_16x16x32_bf16 a[168:171], a[40:43], a[28:31], 0
v_mfma_f32_16x16x32_bf16 a[172:175], a[44:47], a[28:31], 0
ds_read_b128 a[80:83], v8 offset:20480
v_mfma_f32_16x16x32_bf16 a[140:143], a[44:47], a[24:27], 0
v_mfma_f32_16x16x32_bf16 v[236:239], a[44:47], a[20:23], 0
ds_read_b64_tr_b16 a[112:113], v10 offset:24576
v_mfma_f32_16x16x32_bf16 v[204:207], a[44:47], a[16:19], 0
v_mfma_f32_16x16x32_bf16 v[172:175], a[44:47], a[12:15], 0
ds_read_b64_tr_b16 a[114:115], v10 offset:28672
buffer_load_dwordx4 v2, s[4:7], s60 offen offset:3072 sc1 lds
s_add_u32 s60, s60, 4096
v_mfma_f32_16x16x32_bf16 v[140:143], a[44:47], a[8:11], 0
v_mfma_f32_16x16x32_bf16 v[108:111], a[44:47], a[4:7], 0
ds_read_b128 a[84:87], v8 offset:21504
v_mfma_f32_16x16x32_bf16 v[76:79], a[44:47], a[0:3], 0
v_mfma_f32_16x16x32_bf16 v[80:83], a[48:51], a[0:3], 0
ds_read_b64_tr_b16 a[116:117], v11 offset:24576
v_mfma_f32_16x16x32_bf16 v[112:115], a[48:51], a[4:7], 0
v_mfma_f32_16x16x32_bf16 v[144:147], a[48:51], a[8:11], 0
ds_read_b64_tr_b16 a[118:119], v11 offset:28672
v_mfma_f32_16x16x32_bf16 v[176:179], a[48:51], a[12:15], 0
v_mfma_f32_16x16x32_bf16 v[208:211], a[48:51], a[16:19], 0
ds_read_b128 a[88:91], v8 offset:22528
s_add_u32 m0, s64, 0
s_nop 0
buffer_load_dwordx4 v4, s[8:11], s61 offen offset:0 lds
v_mfma_f32_16x16x32_bf16 v[240:243], a[48:51], a[20:23], 0
v_mfma_f32_16x16x32_bf16 a[144:147], a[48:51], a[24:27], 0
ds_read_b64_tr_b16 a[120:121], v12 offset:24576
v_mfma_f32_16x16x32_bf16 a[176:179], a[48:51], a[28:31], 0
v_mfma_f32_16x16x32_bf16 a[180:183], a[52:55], a[28:31], 0
ds_read_b64_tr_b16 a[122:123], v12 offset:28672
v_mfma_f32_16x16x32_bf16 a[148:151], a[52:55], a[24:27], 0
v_mfma_f32_16x16x32_bf16 v[244:247], a[52:55], a[20:23], 0
ds_read_b128 a[92:95], v8 offset:23552
v_mfma_f32_16x16x32_bf16 v[212:215], a[52:55], a[16:19], 0
v_mfma_f32_16x16x32_bf16 v[180:183], a[52:55], a[12:15], 0
ds_read_b64_tr_b16 a[124:125], v13 offset:24576
buffer_load_dwordx4 v5, s[8:11], s61 offen offset:1024 lds
v_mfma_f32_16x16x32_bf16 v[148:151], a[52:55], a[8:11], 0
v_mfma_f32_16x16x32_bf16 v[116:119], a[52:55], a[4:7], 0
ds_read_b64_tr_b16 a[126:127], v13 offset:28672
v_mfma_f32_16x16x32_bf16 v[84:87], a[52:55], a[0:3], 0
v_mfma_f32_16x16x32_bf16 v[88:91], a[56:59], a[0:3], 0
v_mfma_f32_16x16x32_bf16 v[120:123], a[56:59], a[4:7], 0
v_mfma_f32_16x16x32_bf16 v[152:155], a[56:59], a[8:11], 0
v_mfma_f32_16x16x32_bf16 v[184:187], a[56:59], a[12:15], 0
v_mfma_f32_16x16x32_bf16 v[216:219], a[56:59], a[16:19], 0
buffer_load_dwordx4 v6, s[8:11], s61 offen offset:2048 lds
v_mfma_f32_16x16x32_bf16 v[248:251], a[56:59], a[20:23], 0
v_mfma_f32_16x16x32_bf16 a[152:155], a[56:59], a[24:27], 0
v_mfma_f32_16x16x32_bf16 a[184:187], a[56:59], a[28:31], 0
v_mfma_f32_16x16x32_bf16 a[188:191], a[60:63], a[28:31], 0
v_mfma_f32_16x16x32_bf16 a[156:159], a[60:63], a[24:27], 0
v_mfma_f32_16x16x32_bf16 v[252:255], a[60:63], a[20:23], 0
v_mfma_f32_16x16x32_bf16 v[220:223], a[60:63], a[16:19], 0
v_mfma_f32_16x16x32_bf16 v[188:191], a[60:63], a[12:15], 0
buffer_load_dwordx4 v7, s[8:11], s61 offen offset:3072 lds
s_add_u32 s61, s61, s65
v_mfma_f32_16x16x32_bf16 v[156:159], a[60:63], a[8:11], 0
v_mfma_f32_16x16x32_bf16 v[124:127], a[60:63], a[4:7], 0
v_mfma_f32_16x16x32_bf16 v[92:95], a[60:63], a[0:3], 0
s_waitcnt vmcnt(16) lgkmcnt(0)
s_barrier
v_mfma_f32_16x16x32_bf16 v[64:67], a[96:99], a[64:67], v[64:67]
ds_read_b128 a[0:3], v8 offset:32768
v_mfma_f32_16x16x32_bf16 v[96:99], a[96:99], a[68:71], v[96:99]
v_mfma_f32_16x16x32_bf16 v[128:131], a[96:99], a[72:75], v[128:131]
ds_read_b64_tr_b16 a[32:33], v10 offset:32768
v_mfma_f32_16x16x32_bf16 v[160:163], a[96:99], a[76:79], v[160:163]
v_mfma_f32_16x16x32_bf16 v[192:195], a[96:99], a[80:83], v[192:195]
ds_read_b64_tr_b16 a[34:35], v10 offset:36864
s_add_u32 m0, s63, 16384
s_nop 0
buffer_load_dwordx4 v2, s[4:7], s60 offen offset:0 sc1 lds
v_mfma_f32_16x16x32_bf16 v[224:227], a[96:99], a[84:87], v[224:227]
v_mfma_f32_16x16x32_bf16 a[128:131], a[96:99], a[88:91], a[128:131]
ds_read_b128 a[4:7], v8 offset:33792
v_mfma_f32_16x16x32_bf16 a[160:163], a[96:99], a[92:95], a[160:163]
v_mfma_f32_16x16x32_bf16 a[164:167], a[100:103], a[92:95], a[164:167]
ds_read_b64_tr_b16 a[36:37], v11 offset:32768
v_mfma_f32_16x16x32_bf16 a[132:135], a[100:103], a[88:91], a[132:135]
v_mfma_f32_16x16x32_bf16 v[228:231], a[100:103], a[84:87], v[228:231]
ds_read_b64_tr_b16 a[38:39], v11 offset:36864
v_mfma_f32_16x16x32_bf16 v[196:199], a[100:103], a[80:83], v[196:199]
v_mfma_f32_16x16x32_bf16 v[164:167], a[100:103], a[76:79], v[164:167]
ds_read_b128 a[8:11], v8 offset:34816
buffer_load_dwordx4 v2, s[4:7], s60 offen offset:1024 sc1 lds
v_mfma_f32_16x16x32_bf16 v[132:135], a[100:103], a[72:75], v[132:135]
v_mfma_f32_16x16x32_bf16 v[100:103], a[100:103], a[68:71], v[100:103]
ds_read_b64_tr_b16 a[40:41], v12 offset:32768
v_mfma_f32_16x16x32_bf16 v[68:71], a[100:103], a[64:67], v[68:71]
v_mfma_f32_16x16x32_bf16 v[72:75], a[104:107], a[64:67], v[72:75]
ds_read_b64_tr_b16 a[42:43], v12 offset:36864
v_mfma_f32_16x16x32_bf16 v[104:107], a[104:107], a[68:71], v[104:107]
v_mfma_f32_16x16x32_bf16 v[136:139], a[104:107], a[72:75], v[136:139]
ds_read_b128 a[12:15], v8 offset:35840
v_mfma_f32_16x16x32_bf16 v[168:171], a[104:107], a[76:79], v[168:171]
v_mfma_f32_16x16x32_bf16 v[200:203], a[104:107], a[80:83], v[200:203]
ds_read_b64_tr_b16 a[44:45], v13 offset:32768
buffer_load_dwordx4 v2, s[4:7], s60 offen offset:2048 sc1 lds
v_mfma_f32_16x16x32_bf16 v[232:235], a[104:107], a[84:87], v[232:235]
v_mfma_f32_16x16x32_bf16 a[136:139], a[104:107], a[88:91], a[136:139]
ds_read_b64_tr_b16 a[46:47], v13 offset:36864
v_mfma_f32_16x16x32_bf16 a[168:171], a[104:107], a[92:95], a[168:171]
v_mfma_f32_16x16x32_bf16 a[172:175], a[108:111], a[92:95], a[172:175]
ds_read_b128 a[16:19], v8 offset:36864
v_mfma_f32_16x16x32_bf16 a[140:143], a[108:111], a[88:91], a[140:143]
v_mfma_f32_16x16x32_bf16 v[236:239], a[108:111], a[84:87], v[236:239]
ds_read_b64_tr_b16 a[48:49], v10 offset:40960
v_mfma_f32_16x16x32_bf16 v[204:207], a[108:111], a[80:83], v[204:207]
v_mfma_f32_16x16x32_bf16 v[172:175], a[108:111], a[76:79], v[172:175]
ds_read_b64_tr_b16 a[50:51], v10 offset:45056
buffer_load_dwordx4 v2, s[4:7], s60 offen offset:3072 sc1 lds
s_add_u32 s60, s60, 4096
v_mfma_f32_16x16x32_bf16 v[140:143], a[108:111], a[72:75], v[140:143]
v_mfma_f32_16x16x32_bf16 v[108:111], a[108:111], a[68:71], v[108:111]
ds_read_b128 a[20:23], v8 offset:37888
v_mfma_f32_16x16x32_bf16 v[76:79], a[108:111], a[64:67], v[76:79]
v_mfma_f32_16x16x32_bf16 v[80:83], a[112:115], a[64:67], v[80:83]
ds_read_b64_tr_b16 a[52:53], v11 offset:40960
v_mfma_f32_16x16x32_bf16 v[112:115], a[112:115], a[68:71], v[112:115]
v_mfma_f32_16x16x32_bf16 v[144:147], a[112:115], a[72:75], v[144:147]
ds_read_b64_tr_b16 a[54:55], v11 offset:45056
v_mfma_f32_16x16x32_bf16 v[176:179], a[112:115], a[76:79], v[176:179]
v_mfma_f32_16x16x32_bf16 v[208:211], a[112:115], a[80:83], v[208:211]
ds_read_b128 a[24:27], v8 offset:38912
s_add_u32 m0, s64, 16384
s_nop 0
buffer_load_dwordx4 v4, s[8:11], s61 offen offset:0 lds
v_mfma_f32_16x16x32_bf16 v[240:243], a[112:115], a[84:87], v[240:243]
v_mfma_f32_16x16x32_bf16 a[144:147], a[112:115], a[88:91], a[144:147]
ds_read_b64_tr_b16 a[56:57], v12 offset:40960
v_mfma_f32_16x16x32_bf16 a[176:179], a[112:115], a[92:95], a[176:179]
v_mfma_f32_16x16x32_bf16 a[180:183], a[116:119], a[92:95], a[180:183]
ds_read_b64_tr_b16 a[58:59], v12 offset:45056
v_mfma_f32_16x16x32_bf16 a[148:151], a[116:119], a[88:91], a[148:151]
v_mfma_f32_16x16x32_bf16 v[244:247], a[116:119], a[84:87], v[244:247]
ds_read_b128 a[28:31], v8 offset:39936
v_mfma_f32_16x16x32_bf16 v[212:215], a[116:119], a[80:83], v[212:215]
v_mfma_f32_16x16x32_bf16 v[180:183], a[116:119], a[76:79], v[180:183]
ds_read_b64_tr_b16 a[60:61], v13 offset:40960
buffer_load_dwordx4 v5, s[8:11], s61 offen offset:1024 lds
v_mfma_f32_16x16x32_bf16 v[148:151], a[116:119], a[72:75], v[148:151]
v_mfma_f32_16x16x32_bf16 v[116:119], a[116:119], a[68:71], v[116:119]
ds_read_b64_tr_b16 a[62:63], v13 offset:45056
v_mfma_f32_16x16x32_bf16 v[84:87], a[116:119], a[64:67], v[84:87]
v_mfma_f32_16x16x32_bf16 v[88:91], a[120:123], a[64:67], v[88:91]
v_mfma_f32_16x16x32_bf16 v[120:123], a[120:123], a[68:71], v[120:123]
v_mfma_f32_16x16x32_bf16 v[152:155], a[120:123], a[72:75], v[152:155]
v_mfma_f32_16x16x32_bf16 v[184:187], a[120:123], a[76:79], v[184:187]
v_mfma_f32_16x16x32_bf16 v[216:219], a[120:123], a[80:83], v[216:219]
buffer_load_dwordx4 v6, s[8:11], s61 offen offset:2048 lds
v_mfma_f32_16x16x32_bf16 v[248:251], a[120:123], a[84:87], v[248:251]
v_mfma_f32_16x16x32_bf16 a[152:155], a[120:123], a[88:91], a[152:155]
v_mfma_f32_16x16x32_bf16 a[184:187], a[120:123], a[92:95], a[184:187]
v_mfma_f32_16x16x32_bf16 a[188:191], a[124:127], a[92:95], a[188:191]
v_mfma_f32_16x16x32_bf16 a[156:159], a[124:127], a[88:91], a[156:159]
v_mfma_f32_16x16x32_bf16 v[252:255], a[124:127], a[84:87], v[252:255]
v_mfma_f32_16x16x32_bf16 v[220:223], a[124:127], a[80:83], v[220:223]
v_mfma_f32_16x16x32_bf16 v[188:191], a[124:127], a[76:79], v[188:191]
buffer_load_dwordx4 v7, s[8:11], s61 offen offset:3072 lds
s_add_u32 s61, s61, s65
v_mfma_f32_16x16x32_bf16 v[156:159], a[124:127], a[72:75], v[156:159]
v_mfma_f32_16x16x32_bf16 v[124:127], a[124:127], a[68:71], v[124:127]
v_mfma_f32_16x16x32_bf16 v[92:95], a[124:127], a[64:67], v[92:95]
s_waitcnt vmcnt(16) lgkmcnt(0)
s_barrier
v_mfma_f32_16x16x32_bf16 v[64:67], a[32:35], a[0:3], v[64:67]
ds_read_b128 a[64:67], v8 offset:49152
v_mfma_f32_16x16x32_bf16 v[96:99], a[32:35], a[4:7], v[96:99]
v_mfma_f32_16x16x32_bf16 v[128:131], a[32:35], a[8:11], v[128:131]
ds_read_b64_tr_b16 a[96:97], v10 offset:49152
v_mfma_f32_16x16x32_bf16 v[160:163], a[32:35], a[12:15], v[160:163]
v_mfma_f32_16x16x32_bf16 v[192:195], a[32:35], a[16:19], v[192:195]
ds_read_b64_tr_b16 a[98:99], v10 offset:53248
s_add_u32 m0, s63, 32768
s_nop 0
buffer_load_dwordx4 v2, s[4:7], s60 offen offset:0 sc1 lds
v_mfma_f32_16x16x32_bf16 v[224:227], a[32:35], a[20:23], v[224:227]
v_mfma_f32_16x16x32_bf16 a[128:131], a[32:35], a[24:27], a[128:131]
ds_read_b128 a[68:71], v8 offset:50176
v_mfma_f32_16x16x32_bf16 a[160:163], a[32:35], a[28:31], a[160:163]
v_mfma_f32_16x16x32_bf16 a[164:167], a[36:39], a[28:31], a[164:167]
ds_read_b64_tr_b16 a[100:101], v11 offset:49152
v_mfma_f32_16x16x32_bf16 a[132:135], a[36:39], a[24:27], a[132:135]
v_mfma_f32_16x16x32_bf16 v[228:231], a[36:39], a[20:23], v[228:231]
ds_read_b64_tr_b16 a[102:103], v11 offset:53248
v_mfma_f32_16x16x32_bf16 v[196:199], a[36:39], a[16:19], v[196:199]
v_mfma_f32_16x16x32_bf16 v[164:167], a[36:39], a[12:15], v[164:167]
ds_read_b128 a[72:75], v8 offset:51200
buffer_load_dwordx4 v2, s[4:7], s60 offen offset:1024 sc1 lds
v_mfma_f32_16x16x32_bf16 v[132:135], a[36:39], a[8:11], v[132:135]
v_mfma_f32_16x16x32_bf16 v[100:103], a[36:39], a[4:7], v[100:103]
ds_read_b64_tr_b16 a[104:105], v12 offset:49152
v_mfma_f32_16x16x32_bf16 v[68:71], a[36:39], a[0:3], v[68:71]
v_mfma_f32_16x16x32_bf16 v[72:75], a[40:43], a[0:3], v[72:75]
ds_read_b64_tr_b16 a[106:107], v12 offset:53248
v_mfma_f32_16x16x32_bf16 v[104:107], a[40:43], a[4:7], v[104:107]
v_mfma_f32_16x16x32_bf16 v[136:139], a[40:43], a[8:11], v[136:139]
ds_read_b128 a[76:79], v8 offset:52224
v_mfma_f32_16x16x32_bf16 v[168:171], a[40:43], a[12:15], v[168:171]
v_mfma_f32_16x16x32_bf16 v[200:203], a[40:43], a[16:19], v[200:203]
ds_read_b64_tr_b16 a[108:109], v13 offset:49152
buffer_load_dwordx4 v2, s[4:7], s60 offen offset:2048 sc1 lds
v_mfma_f32_16x16x32_bf16 v[232:235], a[40:43], a[20:23], v[232:235]
v_mfma_f32_16x16x32_bf16 a[136:139], a[40:43], a[24:27], a[136:139]
ds_read_b64_tr_b16 a[110:111], v13 offset:53248
v_mfma_f32_16x16x32_bf16 a[168:171], a[40:43], a[28:31], a[168:171]
v_mfma_f32_16x16x32_bf16 a[172:175], a[44:47], a[28:31], a[172:175]
ds_read_b128 a[80:83], v8 offset:53248
v_mfma_f32_16x16x32_bf16 a[140:143], a[44:47], a[24:27], a[140:143]
v_mfma_f32_16x16x32_bf16 v[236:239], a[44:47], a[20:23], v[236:239]
ds_read_b64_tr_b16 a[112:113], v10 offset:57344
v_mfma_f32_16x16x32_bf16 v[204:207], a[44:47], a[16:19], v[204:207]
v_mfma_f32_16x16x32_bf16 v[172:175], a[44:47], a[12:15], v[172:175]
ds_read_b64_tr_b16 a[114:115], v10 offset:61440
buffer_load_dwordx4 v2, s[4:7], s60 offen offset:3072 sc1 lds
s_add_u32 s60, s60, 4096
v_mfma_f32_16x16x32_bf16 v[140:143], a[44:47], a[8:11], v[140:143]
v_mfma_f32_16x16x32_bf16 v[108:111], a[44:47], a[4:7], v[108:111]
ds_read_b128 a[84:87], v8 offset:54272
v_mfma_f32_16x16x32_bf16 v[76:79], a[44:47], a[0:3], v[76:79]
v_mfma_f32_16x16x32_bf16 v[80:83], a[48:51], a[0:3], v[80:83]
ds_read_b64_tr_b16 a[116:117], v11 offset:57344
v_mfma_f32_16x16x32_bf16 v[112:115], a[48:51], a[4:7], v[112:115]
v_mfma_f32_16x16x32_bf16 v[144:147], a[48:51], a[8:11], v[144:147]
ds_read_b64_tr_b16 a[118:119], v11 offset:61440
v_mfma_f32_16x16x32_bf16 v[176:179], a[48:51], a[12:15], v[176:179]
v_mfma_f32_16x16x32_bf16 v[208:211], a[48:51], a[16:19], v[208:211]
ds_read_b128 a[88:91], v8 offset:55296
s_add_u32 m0, s64, 32768
s_nop 0
buffer_load_dwordx4 v4, s[8:11], s61 offen offset:0 lds
v_mfma_f32_16x16x32_bf16 v[240:243], a[48:51], a[20:23], v[240:243]
v_mfma_f32_16x16x32_bf16 a[144:147], a[48:51], a[24:27], a[144:147]
ds_read_b64_tr_b16 a[120:121], v12 offset:57344
v_mfma_f32_16x16x32_bf16 a[176:179], a[48:51], a[28:31], a[176:179]
v_mfma_f32_16x16x32_bf16 a[180:183], a[52:55], a[28:31], a[180:183]
ds_read_b64_tr_b16 a[122:123], v12 offset:61440
v_mfma_f32_16x16x32_bf16 a[148:151], a[52:55], a[24:27], a[148:151]
v_mfma_f32_16x16x32_bf16 v[244:247], a[52:55], a[20:23], v[244:247]
ds_read_b128 a[92:95], v8 offset:56320
v_mfma_f32_16x16x32_bf16 v[212:215], a[52:55], a[16:19], v[212:215]
v_mfma_f32_16x16x32_bf16 v[180:183], a[52:55], a[12:15], v[180:183]
ds_read_b64_tr_b16 a[124:125], v13 offset:57344
buffer_load_dwordx4 v5, s[8:11], s61 offen offset:1024 lds
v_mfma_f32_16x16x32_bf16 v[148:151], a[52:55], a[8:11], v[148:151]
v_mfma_f32_16x16x32_bf16 v[116:119], a[52:55], a[4:7], v[116:119]
ds_read_b64_tr_b16 a[126:127], v13 offset:61440
v_mfma_f32_16x16x32_bf16 v[84:87], a[52:55], a[0:3], v[84:87]
v_mfma_f32_16x16x32_bf16 v[88:91], a[56:59], a[0:3], v[88:91]
v_mfma_f32_16x16x32_bf16 v[120:123], a[56:59], a[4:7], v[120:123]
v_mfma_f32_16x16x32_bf16 v[152:155], a[56:59], a[8:11], v[152:155]
v_mfma_f32_16x16x32_bf16 v[184:187], a[56:59], a[12:15], v[184:187]
v_mfma_f32_16x16x32_bf16 v[216:219], a[56:59], a[16:19], v[216:219]
buffer_load_dwordx4 v6, s[8:11], s61 offen offset:2048 lds
v_mfma_f32_16x16x32_bf16 v[248:251], a[56:59], a[20:23], v[248:251]
v_mfma_f32_16x16x32_bf16 a[152:155], a[56:59], a[24:27], a[152:155]
v_mfma_f32_16x16x32_bf16 a[184:187], a[56:59], a[28:31], a[184:187]
v_mfma_f32_16x16x32_bf16 a[188:191], a[60:63], a[28:31], a[188:191]
v_mfma_f32_16x16x32_bf16 a[156:159], a[60:63], a[24:27], a[156:159]
v_mfma_f32_16x16x32_bf16 v[252:255], a[60:63], a[20:23], v[252:255]
v_mfma_f32_16x16x32_bf16 v[220:223], a[60:63], a[16:19], v[220:223]
v_mfma_f32_16x16x32_bf16 v[188:191], a[60:63], a[12:15], v[188:191]
buffer_load_dwordx4 v7, s[8:11], s61 offen offset:3072 lds
s_add_u32 s61, s61, s65
v_mfma_f32_16x16x32_bf16 v[156:159], a[60:63], a[8:11], v[156:159]
v_mfma_f32_16x16x32_bf16 v[124:127], a[60:63], a[4:7], v[124:127]
v_mfma_f32_16x16x32_bf16 v[92:95], a[60:63], a[0:3], v[92:95]
s_waitcnt vmcnt(16) lgkmcnt(0)
s_barrier
v_mfma_f32_16x16x32_bf16 v[64:67], a[96:99], a[64:67], v[64:67]
ds_read_b128 a[0:3], v8 offset:0
v_mfma_f32_16x16x32_bf16 v[96:99], a[96:99], a[68:71], v[96:99]
v_mfma_f32_16x16x32_bf16 v[128:131], a[96:99], a[72:75], v[128:131]
ds_read_b64_tr_b16 a[32:33], v10 offset:0
v_mfma_f32_16x16x32_bf16 v[160:163], a[96:99], a[76:79], v[160:163]
v_mfma_f32_16x16x32_bf16 v[192:195], a[96:99], a[80:83], v[192:195]
ds_read_b64_tr_b16 a[34:35], v10 offset:4096
s_add_u32 m0, s63, 49152
s_nop 0
buffer_load_dwordx4 v2, s[4:7], s60 offen offset:0 sc1 lds
v_mfma_f32_16x16x32_bf16 v[224:227], a[96:99], a[84:87], v[224:227]
v_mfma_f32_16x16x32_bf16 a[128:131], a[96:99], a[88:91], a[128:131]
ds_read_b128 a[4:7], v8 offset:1024
v_mfma_f32_16x16x32_bf16 a[160:163], a[96:99], a[92:95], a[160:163]
v_mfma_f32_16x16x32_bf16 a[164:167], a[100:103], a[92:95], a[164:167]
ds_read_b64_tr_b16 a[36:37], v11 offset:0
v_mfma_f32_16x16x32_bf16 a[132:135], a[100:103], a[88:91], a[132:135]
v_mfma_f32_16x16x32_bf16 v[228:231], a[100:103], a[84:87], v[228:231]
ds_read_b64_tr_b16 a[38:39], v11 offset:4096
v_mfma_f32_16x16x32_bf16 v[196:199], a[100:103], a[80:83], v[196:199]
v_mfma_f32_16x16x32_bf16 v[164:167], a[100:103], a[76:79], v[164:167]
ds_read_b128 a[8:11], v8 offset:2048
buffer_load_dwordx4 v2, s[4:7], s60 offen offset:1024 sc1 lds
v_mfma_f32_16x16x32_bf16 v[132:135], a[100:103], a[72:75], v[132:135]
v_mfma_f32_16x16x32_bf16 v[100:103], a[100:103], a[68:71], v[100:103]
ds_read_b64_tr_b16 a[40:41], v12 offset:0
v_mfma_f32_16x16x32_bf16 v[68:71], a[100:103], a[64:67], v[68:71]
v_mfma_f32_16x16x32_bf16 v[72:75], a[104:107], a[64:67], v[72:75]
ds_read_b64_tr_b16 a[42:43], v12 offset:4096
v_mfma_f32_16x16x32_bf16 v[104:107], a[104:107], a[68:71], v[104:107]
v_mfma_f32_16x16x32_bf16 v[136:139], a[104:107], a[72:75], v[136:139]
ds_read_b128 a[12:15], v8 offset:3072
v_mfma_f32_16x16x32_bf16 v[168:171], a[104:107], a[76:79], v[168:171]
v_mfma_f32_16x16x32_bf16 v[200:203], a[104:107], a[80:83], v[200:203]
ds_read_b64_tr_b16 a[44:45], v13 offset:0
buffer_load_dwordx4 v2, s[4:7], s60 offen offset:2048 sc1 lds
v_mfma_f32_16x16x32_bf16 v[232:235], a[104:107], a[84:87], v[232:235]
v_mfma_f32_16x16x32_bf16 a[136:139], a[104:107], a[88:91], a[136:139]
ds_read_b64_tr_b16 a[46:47], v13 offset:4096
v_mfma_f32_16x16x32_bf16 a[168:171], a[104:107], a[92:95], a[168:171]
v_mfma_f32_16x16x32_bf16 a[172:175], a[108:111], a[92:95], a[172:175]
ds_read_b128 a[16:19], v8 offset:4096
v_mfma_f32_16x16x32_bf16 a[140:143], a[108:111], a[88:91], a[140:143]
v_mfma_f32_16x16x32_bf16 v[236:239], a[108:111], a[84:87], v[236:239]
ds_read_b64_tr_b16 a[48:49], v10 offset:8192
v_mfma_f32_16x16x32_bf16 v[204:207], a[108:111], a[80:83], v[204:207]
v_mfma_f32_16x16x32_bf16 v[172:175], a[108:111], a[76:79], v[172:175]
ds_read_b64_tr_b16 a[50:51], v10 offset:12288
buffer_load_dwordx4 v2, s[4:7], s60 offen offset:3072 sc1 lds
s_add_u32 s60, s60, 4096
v_mfma_f32_16x16x32_bf16 v[140:143], a[108:111], a[72:75], v[140:143]
v_mfma_f32_16x16x32_bf16 v[108:111], a[108:111], a[68:71], v[108:111]
ds_read_b128 a[20:23], v8 offset:5120
v_mfma_f32_16x16x32_bf16 v[76:79], a[108:111], a[64:67], v[76:79]
v_mfma_f32_16x16x32_bf16 v[80:83], a[112:115], a[64:67], v[80:83]
ds_read_b64_tr_b16 a[52:53], v11 offset:8192
v_mfma_f32_16x16x32_bf16 v[112:115], a[112:115], a[68:71], v[112:115]
v_mfma_f32_16x16x32_bf16 v[144:147], a[112:115], a[72:75], v[144:147]
ds_read_b64_tr_b16 a[54:55], v11 offset:12288
v_mfma_f32_16x16x32_bf16 v[176:179], a[112:115], a[76:79], v[176:179]
v_mfma_f32_16x16x32_bf16 v[208:211], a[112:115], a[80:83], v[208:211]
ds_read_b128 a[24:27], v8 offset:6144
s_add_u32 m0, s64, 49152
s_nop 0
buffer_load_dwordx4 v4, s[8:11], s61 offen offset:0 lds
v_mfma_f32_16x16x32_bf16 v[240:243], a[112:115], a[84:87], v[240:243]
v_mfma_f32_16x16x32_bf16 a[144:147], a[112:115], a[88:91], a[144:147]
ds_read_b64_tr_b16 a[56:57], v12 offset:8192
v_mfma_f32_16x16x32_bf16 a[176:179], a[112:115], a[92:95], a[176:179]
v_mfma_f32_16x16x32_bf16 a[180:183], a[116:119], a[92:95], a[180:183]
ds_read_b64_tr_b16 a[58:59], v12 offset:12288
v_mfma_f32_16x16x32_bf16 a[148:151], a[116:119], a[88:91], a[148:151]
v_mfma_f32_16x16x32_bf16 v[244:247], a[116:119], a[84:87], v[244:247]
ds_read_b128 a[28:31], v8 offset:7168
v_mfma_f32_16x16x32_bf16 v[212:215], a[116:119], a[80:83], v[212:215]
v_mfma_f32_16x16x32_bf16 v[180:183], a[116:119], a[76:79], v[180:183]
ds_read_b64_tr_b16 a[60:61], v13 offset:8192
buffer_load_dwordx4 v5, s[8:11], s61 offen offset:1024 lds
v_mfma_f32_16x16x32_bf16 v[148:151], a[116:119], a[72:75], v[148:151]
v_mfma_f32_16x16x32_bf16 v[116:119], a[116:119], a[68:71], v[116:119]
ds_read_b64_tr_b16 a[62:63], v13 offset:12288
v_mfma_f32_16x16x32_bf16 v[84:87], a[116:119], a[64:67], v[84:87]
v_mfma_f32_16x16x32_bf16 v[88:91], a[120:123], a[64:67], v[88:91]
v_mfma_f32_16x16x32_bf16 v[120:123], a[120:123], a[68:71], v[120:123]
v_mfma_f32_16x16x32_bf16 v[152:155], a[120:123], a[72:75], v[152:155]
v_mfma_f32_16x16x32_bf16 v[184:187], a[120:123], a[76:79], v[184:187]
v_mfma_f32_16x16x32_bf16 v[216:219], a[120:123], a[80:83], v[216:219]
buffer_load_dwordx4 v6, s[8:11], s61 offen offset:2048 lds
v_mfma_f32_16x16x32_bf16 v[248:251], a[120:123], a[84:87], v[248:251]
v_mfma_f32_16x16x32_bf16 a[152:155], a[120:123], a[88:91], a[152:155]
v_mfma_f32_16x16x32_bf16 a[184:187], a[120:123], a[92:95], a[184:187]
v_mfma_f32_16x16x32_bf16 a[188:191], a[124:127], a[92:95], a[188:191]
v_mfma_f32_16x16x32_bf16 a[156:159], a[124:127], a[88:91], a[156:159]
v_mfma_f32_16x16x32_bf16 v[252:255], a[124:127], a[84:87], v[252:255]
v_mfma_f32_16x16x32_bf16 v[220:223], a[124:127], a[80:83], v[220:223]
v_mfma_f32_16x16x32_bf16 v[188:191], a[124:127], a[76:79], v[188:191]
buffer_load_dwordx4 v7, s[8:11], s61 offen offset:3072 lds
s_add_u32 s61, s61, s65
v_mfma_f32_16x16x32_bf16 v[156:159], a[124:127], a[72:75], v[156:159]
v_mfma_f32_16x16x32_bf16 v[124:127], a[124:127], a[68:71], v[124:127]
v_mfma_f32_16x16x32_bf16 v[92:95], a[124:127], a[64:67], v[92:95]
s_mov_b32 s62, 6
Lgl_563:
s_waitcnt vmcnt(16) lgkmcnt(0)
s_barrier
v_mfma_f32_16x16x32_bf16 v[64:67], a[32:35], a[0:3], v[64:67]
ds_read_b128 a[64:67], v8 offset:16384
v_mfma_f32_16x16x32_bf16 v[96:99], a[32:35], a[4:7], v[96:99]
v_mfma_f32_16x16x32_bf16 v[128:131], a[32:35], a[8:11], v[128:131]
ds_read_b64_tr_b16 a[96:97], v10 offset:16384
v_mfma_f32_16x16x32_bf16 v[160:163], a[32:35], a[12:15], v[160:163]
v_mfma_f32_16x16x32_bf16 v[192:195], a[32:35], a[16:19], v[192:195]
ds_read_b64_tr_b16 a[98:99], v10 offset:20480
s_add_u32 m0, s63, 0
s_nop 0
buffer_load_dwordx4 v2, s[4:7], s60 offen offset:0 sc1 lds
v_mfma_f32_16x16x32_bf16 v[224:227], a[32:35], a[20:23], v[224:227]
v_mfma_f32_16x16x32_bf16 a[128:131], a[32:35], a[24:27], a[128:131]
ds_read_b128 a[68:71], v8 offset:17408
v_mfma_f32_16x16x32_bf16 a[160:163], a[32:35], a[28:31], a[160:163]
v_mfma_f32_16x16x32_bf16 a[164:167], a[36:39], a[28:31], a[164:167]
ds_read_b64_tr_b16 a[100:101], v11 offset:16384
v_mfma_f32_16x16x32_bf16 a[132:135], a[36:39], a[24:27], a[132:135]
v_mfma_f32_16x16x32_bf16 v[228:231], a[36:39], a[20:23], v[228:231]
ds_read_b64_tr_b16 a[102:103], v11 offset:20480
v_mfma_f32_16x16x32_bf16 v[196:199], a[36:39], a[16:19], v[196:199]
v_mfma_f32_16x16x32_bf16 v[164:167], a[36:39], a[12:15], v[164:167]
ds_read_b128 a[72:75], v8 offset:18432
buffer_load_dwordx4 v2, s[4:7], s60 offen offset:1024 sc1 lds
v_mfma_f32_16x16x32_bf16 v[132:135], a[36:39], a[8:11], v[132:135]
v_mfma_f32_16x16x32_bf16 v[100:103], a[36:39], a[4:7], v[100:103]
ds_read_b64_tr_b16 a[104:105], v12 offset:16384
v_mfma_f32_16x16x32_bf16 v[68:71], a[36:39], a[0:3], v[68:71]
v_mfma_f32_16x16x32_bf16 v[72:75], a[40:43], a[0:3], v[72:75]
ds_read_b64_tr_b16 a[106:107], v12 offset:20480
v_mfma_f32_16x16x32_bf16 v[104:107], a[40:43], a[4:7], v[104:107]
v_mfma_f32_16x16x32_bf16 v[136:139], a[40:43], a[8:11], v[136:139]
ds_read_b128 a[76:79], v8 offset:19456
v_mfma_f32_16x16x32_bf16 v[168:171], a[40:43], a[12:15], v[168:171]
v_mfma_f32_16x16x32_bf16 v[200:203], a[40:43], a[16:19], v[200:203]
ds_read_b64_tr_b16 a[108:109], v13 offset:16384
buffer_load_dwordx4 v2, s[4:7], s60 offen offset:2048 sc1 lds
v_mfma_f32_16x16x32_bf16 v[232:235], a[40:43], a[20:23], v[232:235]
v_mfma_f32_16x16x32_bf16 a[136:139], a[40:43], a[24:27], a[136:139]
ds_read_b64_tr_b16 a[110:111], v13 offset:20480
v_mfma_f32_16x16x32_bf16 a[168:171], a[40:43], a[28:31], a[168:171]
v_mfma_f32_16x16x32_bf16 a[172:175], a[44:47], a[28:31], a[172:175]
ds_read_b128 a[80:83], v8 offset:20480
v_mfma_f32_16x16x32_bf16 a[140:143], a[44:47], a[24:27], a[140:143]
v_mfma_f32_16x16x32_bf16 v[236:239], a[44:47], a[20:23], v[236:239]
ds_read_b64_tr_b16 a[112:113], v10 offset:24576
v_mfma_f32_16x16x32_bf16 v[204:207], a[44:47], a[16:19], v[204:207]
v_mfma_f32_16x16x32_bf16 v[172:175], a[44:47], a[12:15], v[172:175]
ds_read_b64_tr_b16 a[114:115], v10 offset:28672
buffer_load_dwordx4 v2, s[4:7], s60 offen offset:3072 sc1 lds
s_add_u32 s60, s60, 4096
v_mfma_f32_16x16x32_bf16 v[140:143], a[44:47], a[8:11], v[140:143]
v_mfma_f32_16x16x32_bf16 v[108:111], a[44:47], a[4:7], v[108:111]
ds_read_b128 a[84:87], v8 offset:21504
v_mfma_f32_16x16x32_bf16 v[76:79], a[44:47], a[0:3], v[76:79]
v_mfma_f32_16x16x32_bf16 v[80:83], a[48:51], a[0:3], v[80:83]
ds_read_b64_tr_b16 a[116:117], v11 offset:24576
v_mfma_f32_16x16x32_bf16 v[112:115], a[48:51], a[4:7], v[112:115]
v_mfma_f32_16x16x32_bf16 v[144:147], a[48:51], a[8:11], v[144:147]
ds_read_b64_tr_b16 a[118:119], v11 offset:28672
v_mfma_f32_16x16x32_bf16 v[176:179], a[48:51], a[12:15], v[176:179]
v_mfma_f32_16x16x32_bf16 v[208:211], a[48:51], a[16:19], v[208:211]
ds_read_b128 a[88:91], v8 offset:22528
s_add_u32 m0, s64, 0
s_nop 0
buffer_load_dwordx4 v4, s[8:11], s61 offen offset:0 lds
v_mfma_f32_16x16x32_bf16 v[240:243], a[48:51], a[20:23], v[240:243]
v_mfma_f32_16x16x32_bf16 a[144:147], a[48:51], a[24:27], a[144:147]
ds_read_b64_tr_b16 a[120:121], v12 offset:24576
v_mfma_f32_16x16x32_bf16 a[176:179], a[48:51], a[28:31], a[176:179]
v_mfma_f32_16x16x32_bf16 a[180:183], a[52:55], a[28:31], a[180:183]
ds_read_b64_tr_b16 a[122:123], v12 offset:28672
v_mfma_f32_16x16x32_bf16 a[148:151], a[52:55], a[24:27], a[148:151]
v_mfma_f32_16x16x32_bf16 v[244:247], a[52:55], a[20:23], v[244:247]
ds_read_b128 a[92:95], v8 offset:23552
v_mfma_f32_16x16x32_bf16 v[212:215], a[52:55], a[16:19], v[212:215]
v_mfma_f32_16x16x32_bf16 v[180:183], a[52:55], a[12:15], v[180:183]
ds_read_b64_tr_b16 a[124:125], v13 offset:24576
buffer_load_dwordx4 v5, s[8:11], s61 offen offset:1024 lds
v_mfma_f32_16x16x32_bf16 v[148:151], a[52:55], a[8:11], v[148:151]
v_mfma_f32_16x16x32_bf16 v[116:119], a[52:55], a[4:7], v[116:119]
ds_read_b64_tr_b16 a[126:127], v13 offset:28672
v_mfma_f32_16x16x32_bf16 v[84:87], a[52:55], a[0:3], v[84:87]
v_mfma_f32_16x16x32_bf16 v[88:91], a[56:59], a[0:3], v[88:91]
v_mfma_f32_16x16x32_bf16 v[120:123], a[56:59], a[4:7], v[120:123]
v_mfma_f32_16x16x32_bf16 v[152:155], a[56:59], a[8:11], v[152:155]
v_mfma_f32_16x16x32_bf16 v[184:187], a[56:59], a[12:15], v[184:187]
v_mfma_f32_16x16x32_bf16 v[216:219], a[56:59], a[16:19], v[216:219]
buffer_load_dwordx4 v6, s[8:11], s61 offen offset:2048 lds
v_mfma_f32_16x16x32_bf16 v[248:251], a[56:59], a[20:23], v[248:251]
v_mfma_f32_16x16x32_bf16 a[152:155], a[56:59], a[24:27], a[152:155]
v_mfma_f32_16x16x32_bf16 a[184:187], a[56:59], a[28:31], a[184:187]
v_mfma_f32_16x16x32_bf16 a[188:191], a[60:63], a[28:31], a[188:191]
v_mfma_f32_16x16x32_bf16 a[156:159], a[60:63], a[24:27], a[156:159]
v_mfma_f32_16x16x32_bf16 v[252:255], a[60:63], a[20:23], v[252:255]
v_mfma_f32_16x16x32_bf16 v[220:223], a[60:63], a[16:19], v[220:223]
v_mfma_f32_16x16x32_bf16 v[188:191], a[60:63], a[12:15], v[188:191]
buffer_load_dwordx4 v7, s[8:11], s61 offen offset:3072 lds
s_add_u32 s61, s61, s65
v_mfma_f32_16x16x32_bf16 v[156:159], a[60:63], a[8:11], v[156:159]
v_mfma_f32_16x16x32_bf16 v[124:127], a[60:63], a[4:7], v[124:127]
v_mfma_f32_16x16x32_bf16 v[92:95], a[60:63], a[0:3], v[92:95]
s_waitcnt vmcnt(16) lgkmcnt(0)
s_barrier
v_mfma_f32_16x16x32_bf16 v[64:67], a[96:99], a[64:67], v[64:67]
ds_read_b128 a[0:3], v8 offset:32768
v_mfma_f32_16x16x32_bf16 v[96:99], a[96:99], a[68:71], v[96:99]
v_mfma_f32_16x16x32_bf16 v[128:131], a[96:99], a[72:75], v[128:131]
ds_read_b64_tr_b16 a[32:33], v10 offset:32768
v_mfma_f32_16x16x32_bf16 v[160:163], a[96:99], a[76:79], v[160:163]
v_mfma_f32_16x16x32_bf16 v[192:195], a[96:99], a[80:83], v[192:195]
ds_read_b64_tr_b16 a[34:35], v10 offset:36864
s_add_u32 m0, s63, 16384
s_nop 0
buffer_load_dwordx4 v2, s[4:7], s60 offen offset:0 sc1 lds
v_mfma_f32_16x16x32_bf16 v[224:227], a[96:99], a[84:87], v[224:227]
v_mfma_f32_16x16x32_bf16 a[128:131], a[96:99], a[88:91], a[128:131]
ds_read_b128 a[4:7], v8 offset:33792
v_mfma_f32_16x16x32_bf16 a[160:163], a[96:99], a[92:95], a[160:163]
v_mfma_f32_16x16x32_bf16 a[164:167], a[100:103], a[92:95], a[164:167]
ds_read_b64_tr_b16 a[36:37], v11 offset:32768
v_mfma_f32_16x16x32_bf16 a[132:135], a[100:103], a[88:91], a[132:135]
v_mfma_f32_16x16x32_bf16 v[228:231], a[100:103], a[84:87], v[228:231]
ds_read_b64_tr_b16 a[38:39], v11 offset:36864
v_mfma_f32_16x16x32_bf16 v[196:199], a[100:103], a[80:83], v[196:199]
v_mfma_f32_16x16x32_bf16 v[164:167], a[100:103], a[76:79], v[164:167]
ds_read_b128 a[8:11], v8 offset:34816
buffer_load_dwordx4 v2, s[4:7], s60 offen offset:1024 sc1 lds
v_mfma_f32_16x16x32_bf16 v[132:135], a[100:103], a[72:75], v[132:135]
v_mfma_f32_16x16x32_bf16 v[100:103], a[100:103], a[68:71], v[100:103]
ds_read_b64_tr_b16 a[40:41], v12 offset:32768
v_mfma_f32_16x16x32_bf16 v[68:71], a[100:103], a[64:67], v[68:71]
v_mfma_f32_16x16x32_bf16 v[72:75], a[104:107], a[64:67], v[72:75]
ds_read_b64_tr_b16 a[42:43], v12 offset:36864
v_mfma_f32_16x16x32_bf16 v[104:107], a[104:107], a[68:71], v[104:107]
v_mfma_f32_16x16x32_bf16 v[136:139], a[104:107], a[72:75], v[136:139]
ds_read_b128 a[12:15], v8 offset:35840
v_mfma_f32_16x16x32_bf16 v[168:171], a[104:107], a[76:79], v[168:171]
v_mfma_f32_16x16x32_bf16 v[200:203], a[104:107], a[80:83], v[200:203]
ds_read_b64_tr_b16 a[44:45], v13 offset:32768
buffer_load_dwordx4 v2, s[4:7], s60 offen offset:2048 sc1 lds
v_mfma_f32_16x16x32_bf16 v[232:235], a[104:107], a[84:87], v[232:235]
v_mfma_f32_16x16x32_bf16 a[136:139], a[104:107], a[88:91], a[136:139]
ds_read_b64_tr_b16 a[46:47], v13 offset:36864
v_mfma_f32_16x16x32_bf16 a[168:171], a[104:107], a[92:95], a[168:171]
v_mfma_f32_16x16x32_bf16 a[172:175], a[108:111], a[92:95], a[172:175]
ds_read_b128 a[16:19], v8 offset:36864
v_mfma_f32_16x16x32_bf16 a[140:143], a[108:111], a[88:91], a[140:143]
v_mfma_f32_16x16x32_bf16 v[236:239], a[108:111], a[84:87], v[236:239]
ds_read_b64_tr_b16 a[48:49], v10 offset:40960
v_mfma_f32_16x16x32_bf16 v[204:207], a[108:111], a[80:83], v[204:207]
v_mfma_f32_16x16x32_bf16 v[172:175], a[108:111], a[76:79], v[172:175]
ds_read_b64_tr_b16 a[50:51], v10 offset:45056
buffer_load_dwordx4 v2, s[4:7], s60 offen offset:3072 sc1 lds
s_add_u32 s60, s60, 4096
v_mfma_f32_16x16x32_bf16 v[140:143], a[108:111], a[72:75], v[140:143]
v_mfma_f32_16x16x32_bf16 v[108:111], a[108:111], a[68:71], v[108:111]
ds_read_b128 a[20:23], v8 offset:37888
v_mfma_f32_16x16x32_bf16 v[76:79], a[108:111], a[64:67], v[76:79]
v_mfma_f32_16x16x32_bf16 v[80:83], a[112:115], a[64:67], v[80:83]
ds_read_b64_tr_b16 a[52:53], v11 offset:40960
v_mfma_f32_16x16x32_bf16 v[112:115], a[112:115], a[68:71], v[112:115]
v_mfma_f32_16x16x32_bf16 v[144:147], a[112:115], a[72:75], v[144:147]
ds_read_b64_tr_b16 a[54:55], v11 offset:45056
v_mfma_f32_16x16x32_bf16 v[176:179], a[112:115], a[76:79], v[176:179]
v_mfma_f32_16x16x32_bf16 v[208:211], a[112:115], a[80:83], v[208:211]
ds_read_b128 a[24:27], v8 offset:38912
s_add_u32 m0, s64, 16384
s_nop 0
buffer_load_dwordx4 v4, s[8:11], s61 offen offset:0 lds
v_mfma_f32_16x16x32_bf16 v[240:243], a[112:115], a[84:87], v[240:243]
v_mfma_f32_16x16x32_bf16 a[144:147], a[112:115], a[88:91], a[144:147]
ds_read_b64_tr_b16 a[56:57], v12 offset:40960
v_mfma_f32_16x16x32_bf16 a[176:179], a[112:115], a[92:95], a[176:179]
v_mfma_f32_16x16x32_bf16 a[180:183], a[116:119], a[92:95], a[180:183]
ds_read_b64_tr_b16 a[58:59], v12 offset:45056
v_mfma_f32_16x16x32_bf16 a[148:151], a[116:119], a[88:91], a[148:151]
v_mfma_f32_16x16x32_bf16 v[244:247], a[116:119], a[84:87], v[244:247]
ds_read_b128 a[28:31], v8 offset:39936
v_mfma_f32_16x16x32_bf16 v[212:215], a[116:119], a[80:83], v[212:215]
v_mfma_f32_16x16x32_bf16 v[180:183], a[116:119], a[76:79], v[180:183]
ds_read_b64_tr_b16 a[60:61], v13 offset:40960
buffer_load_dwordx4 v5, s[8:11], s61 offen offset:1024 lds
v_mfma_f32_16x16x32_bf16 v[148:151], a[116:119], a[72:75], v[148:151]
v_mfma_f32_16x16x32_bf16 v[116:119], a[116:119], a[68:71], v[116:119]
ds_read_b64_tr_b16 a[62:63], v13 offset:45056
v_mfma_f32_16x16x32_bf16 v[84:87], a[116:119], a[64:67], v[84:87]
v_mfma_f32_16x16x32_bf16 v[88:91], a[120:123], a[64:67], v[88:91]
v_mfma_f32_16x16x32_bf16 v[120:123], a[120:123], a[68:71], v[120:123]
v_mfma_f32_16x16x32_bf16 v[152:155], a[120:123], a[72:75], v[152:155]
v_mfma_f32_16x16x32_bf16 v[184:187], a[120:123], a[76:79], v[184:187]
v_mfma_f32_16x16x32_bf16 v[216:219], a[120:123], a[80:83], v[216:219]
buffer_load_dwordx4 v6, s[8:11], s61 offen offset:2048 lds
v_mfma_f32_16x16x32_bf16 v[248:251], a[120:123], a[84:87], v[248:251]
v_mfma_f32_16x16x32_bf16 a[152:155], a[120:123], a[88:91], a[152:155]
v_mfma_f32_16x16x32_bf16 a[184:187], a[120:123], a[92:95], a[184:187]
v_mfma_f32_16x16x32_bf16 a[188:191], a[124:127], a[92:95], a[188:191]
v_mfma_f32_16x16x32_bf16 a[156:159], a[124:127], a[88:91], a[156:159]
v_mfma_f32_16x16x32_bf16 v[252:255], a[124:127], a[84:87], v[252:255]
v_mfma_f32_16x16x32_bf16 v[220:223], a[124:127], a[80:83], v[220:223]
v_mfma_f32_16x16x32_bf16 v[188:191], a[124:127], a[76:79], v[188:191]
buffer_load_dwordx4 v7, s[8:11], s61 offen offset:3072 lds
s_add_u32 s61, s61, s65
v_mfma_f32_16x16x32_bf16 v[156:159], a[124:127], a[72:75], v[156:159]
v_mfma_f32_16x16x32_bf16 v[124:127], a[124:127], a[68:71], v[124:127]
v_mfma_f32_16x16x32_bf16 v[92:95], a[124:127], a[64:67], v[92:95]
s_waitcnt vmcnt(16) lgkmcnt(0)
s_barrier
v_mfma_f32_16x16x32_bf16 v[64:67], a[32:35], a[0:3], v[64:67]
ds_read_b128 a[64:67], v8 offset:49152
v_mfma_f32_16x16x32_bf16 v[96:99], a[32:35], a[4:7], v[96:99]
v_mfma_f32_16x16x32_bf16 v[128:131], a[32:35], a[8:11], v[128:131]
ds_read_b64_tr_b16 a[96:97], v10 offset:49152
v_mfma_f32_16x16x32_bf16 v[160:163], a[32:35], a[12:15], v[160:163]
v_mfma_f32_16x16x32_bf16 v[192:195], a[32:35], a[16:19], v[192:195]
ds_read_b64_tr_b16 a[98:99], v10 offset:53248
s_add_u32 m0, s63, 32768
s_nop 0
buffer_load_dwordx4 v2, s[4:7], s60 offen offset:0 sc1 lds
v_mfma_f32_16x16x32_bf16 v[224:227], a[32:35], a[20:23], v[224:227]
v_mfma_f32_16x16x32_bf16 a[128:131], a[32:35], a[24:27], a[128:131]
ds_read_b128 a[68:71], v8 offset:50176
v_mfma_f32_16x16x32_bf16 a[160:163], a[32:35], a[28:31], a[160:163]
v_mfma_f32_16x16x32_bf16 a[164:167], a[36:39], a[28:31], a[164:167]
ds_read_b64_tr_b16 a[100:101], v11 offset:49152
v_mfma_f32_16x16x32_bf16 a[132:135], a[36:39], a[24:27], a[132:135]
v_mfma_f32_16x16x32_bf16 v[228:231], a[36:39], a[20:23], v[228:231]
ds_read_b64_tr_b16 a[102:103], v11 offset:53248
v_mfma_f32_16x16x32_bf16 v[196:199], a[36:39], a[16:19], v[196:199]
v_mfma_f32_16x16x32_bf16 v[164:167], a[36:39], a[12:15], v[164:167]
ds_read_b128 a[72:75], v8 offset:51200
buffer_load_dwordx4 v2, s[4:7], s60 offen offset:1024 sc1 lds
v_mfma_f32_16x16x32_bf16 v[132:135], a[36:39], a[8:11], v[132:135]
v_mfma_f32_16x16x32_bf16 v[100:103], a[36:39], a[4:7], v[100:103]
ds_read_b64_tr_b16 a[104:105], v12 offset:49152
v_mfma_f32_16x16x32_bf16 v[68:71], a[36:39], a[0:3], v[68:71]
v_mfma_f32_16x16x32_bf16 v[72:75], a[40:43], a[0:3], v[72:75]
ds_read_b64_tr_b16 a[106:107], v12 offset:53248
v_mfma_f32_16x16x32_bf16 v[104:107], a[40:43], a[4:7], v[104:107]
v_mfma_f32_16x16x32_bf16 v[136:139], a[40:43], a[8:11], v[136:139]
ds_read_b128 a[76:79], v8 offset:52224
v_mfma_f32_16x16x32_bf16 v[168:171], a[40:43], a[12:15], v[168:171]
v_mfma_f32_16x16x32_bf16 v[200:203], a[40:43], a[16:19], v[200:203]
ds_read_b64_tr_b16 a[108:109], v13 offset:49152
buffer_load_dwordx4 v2, s[4:7], s60 offen offset:2048 sc1 lds
v_mfma_f32_16x16x32_bf16 v[232:235], a[40:43], a[20:23], v[232:235]
v_mfma_f32_16x16x32_bf16 a[136:139], a[40:43], a[24:27], a[136:139]
ds_read_b64_tr_b16 a[110:111], v13 offset:53248
v_mfma_f32_16x16x32_bf16 a[168:171], a[40:43], a[28:31], a[168:171]
v_mfma_f32_16x16x32_bf16 a[172:175], a[44:47], a[28:31], a[172:175]
ds_read_b128 a[80:83], v8 offset:53248
v_mfma_f32_16x16x32_bf16 a[140:143], a[44:47], a[24:27], a[140:143]
v_mfma_f32_16x16x32_bf16 v[236:239], a[44:47], a[20:23], v[236:239]
ds_read_b64_tr_b16 a[112:113], v10 offset:57344
v_mfma_f32_16x16x32_bf16 v[204:207], a[44:47], a[16:19], v[204:207]
v_mfma_f32_16x16x32_bf16 v[172:175], a[44:47], a[12:15], v[172:175]
ds_read_b64_tr_b16 a[114:115], v10 offset:61440
buffer_load_dwordx4 v2, s[4:7], s60 offen offset:3072 sc1 lds
s_add_u32 s60, s60, 4096
v_mfma_f32_16x16x32_bf16 v[140:143], a[44:47], a[8:11], v[140:143]
v_mfma_f32_16x16x32_bf16 v[108:111], a[44:47], a[4:7], v[108:111]
ds_read_b128 a[84:87], v8 offset:54272
v_mfma_f32_16x16x32_bf16 v[76:79], a[44:47], a[0:3], v[76:79]
v_mfma_f32_16x16x32_bf16 v[80:83], a[48:51], a[0:3], v[80:83]
ds_read_b64_tr_b16 a[116:117], v11 offset:57344
v_mfma_f32_16x16x32_bf16 v[112:115], a[48:51], a[4:7], v[112:115]
v_mfma_f32_16x16x32_bf16 v[144:147], a[48:51], a[8:11], v[144:147]
ds_read_b64_tr_b16 a[118:119], v11 offset:61440
v_mfma_f32_16x16x32_bf16 v[176:179], a[48:51], a[12:15], v[176:179]
v_mfma_f32_16x16x32_bf16 v[208:211], a[48:51], a[16:19], v[208:211]
ds_read_b128 a[88:91], v8 offset:55296
s_add_u32 m0, s64, 32768
s_nop 0
buffer_load_dwordx4 v4, s[8:11], s61 offen offset:0 lds
v_mfma_f32_16x16x32_bf16 v[240:243], a[48:51], a[20:23], v[240:243]
v_mfma_f32_16x16x32_bf16 a[144:147], a[48:51], a[24:27], a[144:147]
ds_read_b64_tr_b16 a[120:121], v12 offset:57344
v_mfma_f32_16x16x32_bf16 a[176:179], a[48:51], a[28:31], a[176:179]
v_mfma_f32_16x16x32_bf16 a[180:183], a[52:55], a[28:31], a[180:183]
ds_read_b64_tr_b16 a[122:123], v12 offset:61440
v_mfma_f32_16x16x32_bf16 a[148:151], a[52:55], a[24:27], a[148:151]
v_mfma_f32_16x16x32_bf16 v[244:247], a[52:55], a[20:23], v[244:247]
ds_read_b128 a[92:95], v8 offset:56320
v_mfma_f32_16x16x32_bf16 v[212:215], a[52:55], a[16:19], v[212:215]
v_mfma_f32_16x16x32_bf16 v[180:183], a[52:55], a[12:15], v[180:183]
ds_read_b64_tr_b16 a[124:125], v13 offset:57344
buffer_load_dwordx4 v5, s[8:11], s61 offen offset:1024 lds
v_mfma_f32_16x16x32_bf16 v[148:151], a[52:55], a[8:11], v[148:151]
v_mfma_f32_16x16x32_bf16 v[116:119], a[52:55], a[4:7], v[116:119]
ds_read_b64_tr_b16 a[126:127], v13 offset:61440
v_mfma_f32_16x16x32_bf16 v[84:87], a[52:55], a[0:3], v[84:87]
v_mfma_f32_16x16x32_bf16 v[88:91], a[56:59], a[0:3], v[88:91]
v_mfma_f32_16x16x32_bf16 v[120:123], a[56:59], a[4:7], v[120:123]
v_mfma_f32_16x16x32_bf16 v[152:155], a[56:59], a[8:11], v[152:155]
v_mfma_f32_16x16x32_bf16 v[184:187], a[56:59], a[12:15], v[184:187]
v_mfma_f32_16x16x32_bf16 v[216:219], a[56:59], a[16:19], v[216:219]
buffer_load_dwordx4 v6, s[8:11], s61 offen offset:2048 lds
v_mfma_f32_16x16x32_bf16 v[248:251], a[56:59], a[20:23], v[248:251]
v_mfma_f32_16x16x32_bf16 a[152:155], a[56:59], a[24:27], a[152:155]
v_mfma_f32_16x16x32_bf16 a[184:187], a[56:59], a[28:31], a[184:187]
v_mfma_f32_16x16x32_bf16 a[188:191], a[60:63], a[28:31], a[188:191]
v_mfma_f32_16x16x32_bf16 a[156:159], a[60:63], a[24:27], a[156:159]
v_mfma_f32_16x16x32_bf16 v[252:255], a[60:63], a[20:23], v[252:255]
v_mfma_f32_16x16x32_bf16 v[220:223], a[60:63], a[16:19], v[220:223]
v_mfma_f32_16x16x32_bf16 v[188:191], a[60:63], a[12:15], v[188:191]
buffer_load_dwordx4 v7, s[8:11], s61 offen offset:3072 lds
s_add_u32 s61, s61, s65
v_mfma_f32_16x16x32_bf16 v[156:159], a[60:63], a[8:11], v[156:159]
v_mfma_f32_16x16x32_bf16 v[124:127], a[60:63], a[4:7], v[124:127]
v_mfma_f32_16x16x32_bf16 v[92:95], a[60:63], a[0:3], v[92:95]
s_waitcnt vmcnt(16) lgkmcnt(0)
s_barrier
v_mfma_f32_16x16x32_bf16 v[64:67], a[96:99], a[64:67], v[64:67]
ds_read_b128 a[0:3], v8 offset:0
v_mfma_f32_16x16x32_bf16 v[96:99], a[96:99], a[68:71], v[96:99]
v_mfma_f32_16x16x32_bf16 v[128:131], a[96:99], a[72:75], v[128:131]
ds_read_b64_tr_b16 a[32:33], v10 offset:0
v_mfma_f32_16x16x32_bf16 v[160:163], a[96:99], a[76:79], v[160:163]
v_mfma_f32_16x16x32_bf16 v[192:195], a[96:99], a[80:83], v[192:195]
ds_read_b64_tr_b16 a[34:35], v10 offset:4096
s_add_u32 m0, s63, 49152
s_nop 0
buffer_load_dwordx4 v2, s[4:7], s60 offen offset:0 sc1 lds
v_mfma_f32_16x16x32_bf16 v[224:227], a[96:99], a[84:87], v[224:227]
v_mfma_f32_16x16x32_bf16 a[128:131], a[96:99], a[88:91], a[128:131]
ds_read_b128 a[4:7], v8 offset:1024
v_mfma_f32_16x16x32_bf16 a[160:163], a[96:99], a[92:95], a[160:163]
v_mfma_f32_16x16x32_bf16 a[164:167], a[100:103], a[92:95], a[164:167]
ds_read_b64_tr_b16 a[36:37], v11 offset:0
v_mfma_f32_16x16x32_bf16 a[132:135], a[100:103], a[88:91], a[132:135]
v_mfma_f32_16x16x32_bf16 v[228:231], a[100:103], a[84:87], v[228:231]
ds_read_b64_tr_b16 a[38:39], v11 offset:4096
v_mfma_f32_16x16x32_bf16 v[196:199], a[100:103], a[80:83], v[196:199]
v_mfma_f32_16x16x32_bf16 v[164:167], a[100:103], a[76:79], v[164:167]
ds_read_b128 a[8:11], v8 offset:2048
buffer_load_dwordx4 v2, s[4:7], s60 offen offset:1024 sc1 lds
v_mfma_f32_16x16x32_bf16 v[132:135], a[100:103], a[72:75], v[132:135]
v_mfma_f32_16x16x32_bf16 v[100:103], a[100:103], a[68:71], v[100:103]
ds_read_b64_tr_b16 a[40:41], v12 offset:0
v_mfma_f32_16x16x32_bf16 v[68:71], a[100:103], a[64:67], v[68:71]
v_mfma_f32_16x16x32_bf16 v[72:75], a[104:107], a[64:67], v[72:75]
ds_read_b64_tr_b16 a[42:43], v12 offset:4096
v_mfma_f32_16x16x32_bf16 v[104:107], a[104:107], a[68:71], v[104:107]
v_mfma_f32_16x16x32_bf16 v[136:139], a[104:107], a[72:75], v[136:139]
ds_read_b128 a[12:15], v8 offset:3072
v_mfma_f32_16x16x32_bf16 v[168:171], a[104:107], a[76:79], v[168:171]
v_mfma_f32_16x16x32_bf16 v[200:203], a[104:107], a[80:83], v[200:203]
ds_read_b64_tr_b16 a[44:45], v13 offset:0
buffer_load_dwordx4 v2, s[4:7], s60 offen offset:2048 sc1 lds
v_mfma_f32_16x16x32_bf16 v[232:235], a[104:107], a[84:87], v[232:235]
v_mfma_f32_16x16x32_bf16 a[136:139], a[104:107], a[88:91], a[136:139]
ds_read_b64_tr_b16 a[46:47], v13 offset:4096
v_mfma_f32_16x16x32_bf16 a[168:171], a[104:107], a[92:95], a[168:171]
v_mfma_f32_16x16x32_bf16 a[172:175], a[108:111], a[92:95], a[172:175]
ds_read_b128 a[16:19], v8 offset:4096
v_mfma_f32_16x16x32_bf16 a[140:143], a[108:111], a[88:91], a[140:143]
v_mfma_f32_16x16x32_bf16 v[236:239], a[108:111], a[84:87], v[236:239]
ds_read_b64_tr_b16 a[48:49], v10 offset:8192
v_mfma_f32_16x16x32_bf16 v[204:207], a[108:111], a[80:83], v[204:207]
v_mfma_f32_16x16x32_bf16 v[172:175], a[108:111], a[76:79], v[172:175]
ds_read_b64_tr_b16 a[50:51], v10 offset:12288
buffer_load_dwordx4 v2, s[4:7], s60 offen offset:3072 sc1 lds
s_add_u32 s60, s60, 4096
v_mfma_f32_16x16x32_bf16 v[140:143], a[108:111], a[72:75], v[140:143]
v_mfma_f32_16x16x32_bf16 v[108:111], a[108:111], a[68:71], v[108:111]
ds_read_b128 a[20:23], v8 offset:5120
v_mfma_f32_16x16x32_bf16 v[76:79], a[108:111], a[64:67], v[76:79]
v_mfma_f32_16x16x32_bf16 v[80:83], a[112:115], a[64:67], v[80:83]
ds_read_b64_tr_b16 a[52:53], v11 offset:8192
v_mfma_f32_16x16x32_bf16 v[112:115], a[112:115], a[68:71], v[112:115]
v_mfma_f32_16x16x32_bf16 v[144:147], a[112:115], a[72:75], v[144:147]
ds_read_b64_tr_b16 a[54:55], v11 offset:12288
v_mfma_f32_16x16x32_bf16 v[176:179], a[112:115], a[76:79], v[176:179]
v_mfma_f32_16x16x32_bf16 v[208:211], a[112:115], a[80:83], v[208:211]
ds_read_b128 a[24:27], v8 offset:6144
s_add_u32 m0, s64, 49152
s_nop 0
buffer_load_dwordx4 v4, s[8:11], s61 offen offset:0 lds
v_mfma_f32_16x16x32_bf16 v[240:243], a[112:115], a[84:87], v[240:243]
v_mfma_f32_16x16x32_bf16 a[144:147], a[112:115], a[88:91], a[144:147]
ds_read_b64_tr_b16 a[56:57], v12 offset:8192
v_mfma_f32_16x16x32_bf16 a[176:179], a[112:115], a[92:95], a[176:179]
v_mfma_f32_16x16x32_bf16 a[180:183], a[116:119], a[92:95], a[180:183]
ds_read_b64_tr_b16 a[58:59], v12 offset:12288
v_mfma_f32_16x16x32_bf16 a[148:151], a[116:119], a[88:91], a[148:151]
v_mfma_f32_16x16x32_bf16 v[244:247], a[116:119], a[84:87], v[244:247]
ds_read_b128 a[28:31], v8 offset:7168
v_mfma_f32_16x16x32_bf16 v[212:215], a[116:119], a[80:83], v[212:215]
v_mfma_f32_16x16x32_bf16 v[180:183], a[116:119], a[76:79], v[180:183]
ds_read_b64_tr_b16 a[60:61], v13 offset:8192
buffer_load_dwordx4 v5, s[8:11], s61 offen offset:1024 lds
v_mfma_f32_16x16x32_bf16 v[148:151], a[116:119], a[72:75], v[148:151]
v_mfma_f32_16x16x32_bf16 v[116:119], a[116:119], a[68:71], v[116:119]
ds_read_b64_tr_b16 a[62:63], v13 offset:12288
v_mfma_f32_16x16x32_bf16 v[84:87], a[116:119], a[64:67], v[84:87]
v_mfma_f32_16x16x32_bf16 v[88:91], a[120:123], a[64:67], v[88:91]
v_mfma_f32_16x16x32_bf16 v[120:123], a[120:123], a[68:71], v[120:123]
v_mfma_f32_16x16x32_bf16 v[152:155], a[120:123], a[72:75], v[152:155]
v_mfma_f32_16x16x32_bf16 v[184:187], a[120:123], a[76:79], v[184:187]
v_mfma_f32_16x16x32_bf16 v[216:219], a[120:123], a[80:83], v[216:219]
buffer_load_dwordx4 v6, s[8:11], s61 offen offset:2048 lds
v_mfma_f32_16x16x32_bf16 v[248:251], a[120:123], a[84:87], v[248:251]
v_mfma_f32_16x16x32_bf16 a[152:155], a[120:123], a[88:91], a[152:155]
v_mfma_f32_16x16x32_bf16 a[184:187], a[120:123], a[92:95], a[184:187]
v_mfma_f32_16x16x32_bf16 a[188:191], a[124:127], a[92:95], a[188:191]
v_mfma_f32_16x16x32_bf16 a[156:159], a[124:127], a[88:91], a[156:159]
v_mfma_f32_16x16x32_bf16 v[252:255], a[124:127], a[84:87], v[252:255]
v_mfma_f32_16x16x32_bf16 v[220:223], a[124:127], a[80:83], v[220:223]
v_mfma_f32_16x16x32_bf16 v[188:191], a[124:127], a[76:79], v[188:191]
buffer_load_dwordx4 v7, s[8:11], s61 offen offset:3072 lds
s_add_u32 s61, s61, s65
v_mfma_f32_16x16x32_bf16 v[156:159], a[124:127], a[72:75], v[156:159]
v_mfma_f32_16x16x32_bf16 v[124:127], a[124:127], a[68:71], v[124:127]
v_mfma_f32_16x16x32_bf16 v[92:95], a[124:127], a[64:67], v[92:95]
s_sub_u32 s62, s62, 1
s_cmp_lg_u32 s62, 0
s_cbranch_scc1 Lgl_563
s_waitcnt vmcnt(16) lgkmcnt(0)
s_barrier
v_mfma_f32_16x16x32_bf16 v[64:67], a[32:35], a[0:3], v[64:67]
ds_read_b128 a[64:67], v8 offset:16384
v_mfma_f32_16x16x32_bf16 v[96:99], a[32:35], a[4:7], v[96:99]
v_mfma_f32_16x16x32_bf16 v[128:131], a[32:35], a[8:11], v[128:131]
ds_read_b64_tr_b16 a[96:97], v10 offset:16384
v_mfma_f32_16x16x32_bf16 v[160:163], a[32:35], a[12:15], v[160:163]
v_mfma_f32_16x16x32_bf16 v[192:195], a[32:35], a[16:19], v[192:195]
ds_read_b64_tr_b16 a[98:99], v10 offset:20480
v_mfma_f32_16x16x32_bf16 v[224:227], a[32:35], a[20:23], v[224:227]
v_mfma_f32_16x16x32_bf16 a[128:131], a[32:35], a[24:27], a[128:131]
ds_read_b128 a[68:71], v8 offset:17408
v_mfma_f32_16x16x32_bf16 a[160:163], a[32:35], a[28:31], a[160:163]
v_mfma_f32_16x16x32_bf16 a[164:167], a[36:39], a[28:31], a[164:167]
ds_read_b64_tr_b16 a[100:101], v11 offset:16384
v_mfma_f32_16x16x32_bf16 a[132:135], a[36:39], a[24:27], a[132:135]
v_mfma_f32_16x16x32_bf16 v[228:231], a[36:39], a[20:23], v[228:231]
ds_read_b64_tr_b16 a[102:103], v11 offset:20480
v_mfma_f32_16x16x32_bf16 v[196:199], a[36:39], a[16:19], v[196:199]
v_mfma_f32_16x16x32_bf16 v[164:167], a[36:39], a[12:15], v[164:167]
ds_read_b128 a[72:75], v8 offset:18432
v_mfma_f32_16x16x32_bf16 v[132:135], a[36:39], a[8:11], v[132:135]
v_mfma_f32_16x16x32_bf16 v[100:103], a[36:39], a[4:7], v[100:103]
ds_read_b64_tr_b16 a[104:105], v12 offset:16384
v_mfma_f32_16x16x32_bf16 v[68:71], a[36:39], a[0:3], v[68:71]
v_mfma_f32_16x16x32_bf16 v[72:75], a[40:43], a[0:3], v[72:75]
ds_read_b64_tr_b16 a[106:107], v12 offset:20480
v_mfma_f32_16x16x32_bf16 v[104:107], a[40:43], a[4:7], v[104:107]
v_mfma_f32_16x16x32_bf16 v[136:139], a[40:43], a[8:11], v[136:139]
ds_read_b128 a[76:79], v8 offset:19456
v_mfma_f32_16x16x32_bf16 v[168:171], a[40:43], a[12:15], v[168:171]
v_mfma_f32_16x16x32_bf16 v[200:203], a[40:43], a[16:19], v[200:203]
ds_read_b64_tr_b16 a[108:109], v13 offset:16384
v_mfma_f32_16x16x32_bf16 v[232:235], a[40:43], a[20:23], v[232:235]
v_mfma_f32_16x16x32_bf16 a[136:139], a[40:43], a[24:27], a[136:139]
ds_read_b64_tr_b16 a[110:111], v13 offset:20480
v_mfma_f32_16x16x32_bf16 a[168:171], a[40:43], a[28:31], a[168:171]
v_mfma_f32_16x16x32_bf16 a[172:175], a[44:47], a[28:31], a[172:175]
ds_read_b128 a[80:83], v8 offset:20480
v_mfma_f32_16x16x32_bf16 a[140:143], a[44:47], a[24:27], a[140:143]
v_mfma_f32_16x16x32_bf16 v[236:239], a[44:47], a[20:23], v[236:239]
ds_read_b64_tr_b16 a[112:113], v10 offset:24576
v_mfma_f32_16x16x32_bf16 v[204:207], a[44:47], a[16:19], v[204:207]
v_mfma_f32_16x16x32_bf16 v[172:175], a[44:47], a[12:15], v[172:175]
ds_read_b64_tr_b16 a[114:115], v10 offset:28672
v_mfma_f32_16x16x32_bf16 v[140:143], a[44:47], a[8:11], v[140:143]
v_mfma_f32_16x16x32_bf16 v[108:111], a[44:47], a[4:7], v[108:111]
ds_read_b128 a[84:87], v8 offset:21504
v_mfma_f32_16x16x32_bf16 v[76:79], a[44:47], a[0:3], v[76:79]
v_mfma_f32_16x16x32_bf16 v[80:83], a[48:51], a[0:3], v[80:83]
ds_read_b64_tr_b16 a[116:117], v11 offset:24576
v_mfma_f32_16x16x32_bf16 v[112:115], a[48:51], a[4:7], v[112:115]
v_mfma_f32_16x16x32_bf16 v[144:147], a[48:51], a[8:11], v[144:147]
ds_read_b64_tr_b16 a[118:119], v11 offset:28672
v_mfma_f32_16x16x32_bf16 v[176:179], a[48:51], a[12:15], v[176:179]
v_mfma_f32_16x16x32_bf16 v[208:211], a[48:51], a[16:19], v[208:211]
ds_read_b128 a[88:91], v8 offset:22528
v_mfma_f32_16x16x32_bf16 v[240:243], a[48:51], a[20:23], v[240:243]
v_mfma_f32_16x16x32_bf16 a[144:147], a[48:51], a[24:27], a[144:147]
ds_read_b64_tr_b16 a[120:121], v12 offset:24576
v_mfma_f32_16x16x32_bf16 a[176:179], a[48:51], a[28:31], a[176:179]
v_mfma_f32_16x16x32_bf16 a[180:183], a[52:55], a[28:31], a[180:183]
ds_read_b64_tr_b16 a[122:123], v12 offset:28672
v_mfma_f32_16x16x32_bf16 a[148:151], a[52:55], a[24:27], a[148:151]
v_mfma_f32_16x16x32_bf16 v[244:247], a[52:55], a[20:23], v[244:247]
ds_read_b128 a[92:95], v8 offset:23552
v_mfma_f32_16x16x32_bf16 v[212:215], a[52:55], a[16:19], v[212:215]
v_mfma_f32_16x16x32_bf16 v[180:183], a[52:55], a[12:15], v[180:183]
ds_read_b64_tr_b16 a[124:125], v13 offset:24576
v_mfma_f32_16x16x32_bf16 v[148:151], a[52:55], a[8:11], v[148:151]
v_mfma_f32_16x16x32_bf16 v[116:119], a[52:55], a[4:7], v[116:119]
ds_read_b64_tr_b16 a[126:127], v13 offset:28672
v_mfma_f32_16x16x32_bf16 v[84:87], a[52:55], a[0:3], v[84:87]
v_mfma_f32_16x16x32_bf16 v[88:91], a[56:59], a[0:3], v[88:91]
v_mfma_f32_16x16x32_bf16 v[120:123], a[56:59], a[4:7], v[120:123]
v_mfma_f32_16x16x32_bf16 v[152:155], a[56:59], a[8:11], v[152:155]
v_mfma_f32_16x16x32_bf16 v[184:187], a[56:59], a[12:15], v[184:187]
v_mfma_f32_16x16x32_bf16 v[216:219], a[56:59], a[16:19], v[216:219]
v_mfma_f32_16x16x32_bf16 v[248:251], a[56:59], a[20:23], v[248:251]
v_mfma_f32_16x16x32_bf16 a[152:155], a[56:59], a[24:27], a[152:155]
v_mfma_f32_16x16x32_bf16 a[184:187], a[56:59], a[28:31], a[184:187]
v_mfma_f32_16x16x32_bf16 a[188:191], a[60:63], a[28:31], a[188:191]
v_mfma_f32_16x16x32_bf16 a[156:159], a[60:63], a[24:27], a[156:159]
v_mfma_f32_16x16x32_bf16 v[252:255], a[60:63], a[20:23], v[252:255]
v_mfma_f32_16x16x32_bf16 v[220:223], a[60:63], a[16:19], v[220:223]
v_mfma_f32_16x16x32_bf16 v[188:191], a[60:63], a[12:15], v[188:191]
v_mfma_f32_16x16x32_bf16 v[156:159], a[60:63], a[8:11], v[156:159]
v_mfma_f32_16x16x32_bf16 v[124:127], a[60:63], a[4:7], v[124:127]
v_mfma_f32_16x16x32_bf16 v[92:95], a[60:63], a[0:3], v[92:95]
s_waitcnt vmcnt(8) lgkmcnt(0)
s_barrier
v_mfma_f32_16x16x32_bf16 v[64:67], a[96:99], a[64:67], v[64:67]
ds_read_b128 a[0:3], v8 offset:32768
v_mfma_f32_16x16x32_bf16 v[96:99], a[96:99], a[68:71], v[96:99]
v_mfma_f32_16x16x32_bf16 v[128:131], a[96:99], a[72:75], v[128:131]
ds_read_b64_tr_b16 a[32:33], v10 offset:32768
v_mfma_f32_16x16x32_bf16 v[160:163], a[96:99], a[76:79], v[160:163]
v_mfma_f32_16x16x32_bf16 v[192:195], a[96:99], a[80:83], v[192:195]
ds_read_b64_tr_b16 a[34:35], v10 offset:36864
v_mfma_f32_16x16x32_bf16 v[224:227], a[96:99], a[84:87], v[224:227]
v_mfma_f32_16x16x32_bf16 a[128:131], a[96:99], a[88:91], a[128:131]
ds_read_b128 a[4:7], v8 offset:33792
v_mfma_f32_16x16x32_bf16 a[160:163], a[96:99], a[92:95], a[160:163]
v_mfma_f32_16x16x32_bf16 a[164:167], a[100:103], a[92:95], a[164:167]
ds_read_b64_tr_b16 a[36:37], v11 offset:32768
v_mfma_f32_16x16x32_bf16 a[132:135], a[100:103], a[88:91], a[132:135]
v_mfma_f32_16x16x32_bf16 v[228:231], a[100:103], a[84:87], v[228:231]
ds_read_b64_tr_b16 a[38:39], v11 offset:36864
v_mfma_f32_16x16x32_bf16 v[196:199], a[100:103], a[80:83], v[196:199]
v_mfma_f32_16x16x32_bf16 v[164:167], a[100:103], a[76:79], v[164:167]
ds_read_b128 a[8:11], v8 offset:34816
v_mfma_f32_16x16x32_bf16 v[132:135], a[100:103], a[72:75], v[132:135]
v_mfma_f32_16x16x32_bf16 v[100:103], a[100:103], a[68:71], v[100:103]
ds_read_b64_tr_b16 a[40:41], v12 offset:32768
v_mfma_f32_16x16x32_bf16 v[68:71], a[100:103], a[64:67], v[68:71]
v_mfma_f32_16x16x32_bf16 v[72:75], a[104:107], a[64:67], v[72:75]
ds_read_b64_tr_b16 a[42:43], v12 offset:36864
v_mfma_f32_16x16x32_bf16 v[104:107], a[104:107], a[68:71], v[104:107]
v_mfma_f32_16x16x32_bf16 v[136:139], a[104:107], a[72:75], v[136:139]
ds_read_b128 a[12:15], v8 offset:35840
v_mfma_f32_16x16x32_bf16 v[168:171], a[104:107], a[76:79], v[168:171]
v_mfma_f32_16x16x32_bf16 v[200:203], a[104:107], a[80:83], v[200:203]
ds_read_b64_tr_b16 a[44:45], v13 offset:32768
v_mfma_f32_16x16x32_bf16 v[232:235], a[104:107], a[84:87], v[232:235]
v_mfma_f32_16x16x32_bf16 a[136:139], a[104:107], a[88:91], a[136:139]
ds_read_b64_tr_b16 a[46:47], v13 offset:36864
v_mfma_f32_16x16x32_bf16 a[168:171], a[104:107], a[92:95], a[168:171]
v_mfma_f32_16x16x32_bf16 a[172:175], a[108:111], a[92:95], a[172:175]
ds_read_b128 a[16:19], v8 offset:36864
v_mfma_f32_16x16x32_bf16 a[140:143], a[108:111], a[88:91], a[140:143]
v_mfma_f32_16x16x32_bf16 v[236:239], a[108:111], a[84:87], v[236:239]
ds_read_b64_tr_b16 a[48:49], v10 offset:40960
v_mfma_f32_16x16x32_bf16 v[204:207], a[108:111], a[80:83], v[204:207]
v_mfma_f32_16x16x32_bf16 v[172:175], a[108:111], a[76:79], v[172:175]
ds_read_b64_tr_b16 a[50:51], v10 offset:45056
v_mfma_f32_16x16x32_bf16 v[140:143], a[108:111], a[72:75], v[140:143]
v_mfma_f32_16x16x32_bf16 v[108:111], a[108:111], a[68:71], v[108:111]
ds_read_b128 a[20:23], v8 offset:37888
v_mfma_f32_16x16x32_bf16 v[76:79], a[108:111], a[64:67], v[76:79]
v_mfma_f32_16x16x32_bf16 v[80:83], a[112:115], a[64:67], v[80:83]
ds_read_b64_tr_b16 a[52:53], v11 offset:40960
v_mfma_f32_16x16x32_bf16 v[112:115], a[112:115], a[68:71], v[112:115]
v_mfma_f32_16x16x32_bf16 v[144:147], a[112:115], a[72:75], v[144:147]
ds_read_b64_tr_b16 a[54:55], v11 offset:45056
v_mfma_f32_16x16x32_bf16 v[176:179], a[112:115], a[76:79], v[176:179]
v_mfma_f32_16x16x32_bf16 v[208:211], a[112:115], a[80:83], v[208:211]
ds_read_b128 a[24:27], v8 offset:38912
v_mfma_f32_16x16x32_bf16 v[240:243], a[112:115], a[84:87], v[240:243]
v_mfma_f32_16x16x32_bf16 a[144:147], a[112:115], a[88:91], a[144:147]
ds_read_b64_tr_b16 a[56:57], v12 offset:40960
v_mfma_f32_16x16x32_bf16 a[176:179], a[112:115], a[92:95], a[176:179]
v_mfma_f32_16x16x32_bf16 a[180:183], a[116:119], a[92:95], a[180:183]
ds_read_b64_tr_b16 a[58:59], v12 offset:45056
v_mfma_f32_16x16x32_bf16 a[148:151], a[116:119], a[88:91], a[148:151]
v_mfma_f32_16x16x32_bf16 v[244:247], a[116:119], a[84:87], v[244:247]
ds_read_b128 a[28:31], v8 offset:39936
v_mfma_f32_16x16x32_bf16 v[212:215], a[116:119], a[80:83], v[212:215]
v_mfma_f32_16x16x32_bf16 v[180:183], a[116:119], a[76:79], v[180:183]
ds_read_b64_tr_b16 a[60:61], v13 offset:40960
v_mfma_f32_16x16x32_bf16 v[148:151], a[116:119], a[72:75], v[148:151]
v_mfma_f32_16x16x32_bf16 v[116:119], a[116:119], a[68:71], v[116:119]
ds_read_b64_tr_b16 a[62:63], v13 offset:45056
v_mfma_f32_16x16x32_bf16 v[84:87], a[116:119], a[64:67], v[84:87]
v_mfma_f32_16x16x32_bf16 v[88:91], a[120:123], a[64:67], v[88:91]
v_mfma_f32_16x16x32_bf16 v[120:123], a[120:123], a[68:71], v[120:123]
v_mfma_f32_16x16x32_bf16 v[152:155], a[120:123], a[72:75], v[152:155]
v_mfma_f32_16x16x32_bf16 v[184:187], a[120:123], a[76:79], v[184:187]
v_mfma_f32_16x16x32_bf16 v[216:219], a[120:123], a[80:83], v[216:219]
v_mfma_f32_16x16x32_bf16 v[248:251], a[120:123], a[84:87], v[248:251]
v_mfma_f32_16x16x32_bf16 a[152:155], a[120:123], a[88:91], a[152:155]
v_mfma_f32_16x16x32_bf16 a[184:187], a[120:123], a[92:95], a[184:187]
v_mfma_f32_16x16x32_bf16 a[188:191], a[124:127], a[92:95], a[188:191]
v_mfma_f32_16x16x32_bf16 a[156:159], a[124:127], a[88:91], a[156:159]
v_mfma_f32_16x16x32_bf16 v[252:255], a[124:127], a[84:87], v[252:255]
v_mfma_f32_16x16x32_bf16 v[220:223], a[124:127], a[80:83], v[220:223]
v_mfma_f32_16x16x32_bf16 v[188:191], a[124:127], a[76:79], v[188:191]
v_mfma_f32_16x16x32_bf16 v[156:159], a[124:127], a[72:75], v[156:159]
v_mfma_f32_16x16x32_bf16 v[124:127], a[124:127], a[68:71], v[124:127]
v_mfma_f32_16x16x32_bf16 v[92:95], a[124:127], a[64:67], v[92:95]
s_waitcnt vmcnt(0) lgkmcnt(0)
s_barrier
v_mfma_f32_16x16x32_bf16 v[64:67], a[32:35], a[0:3], v[64:67]
ds_read_b128 a[64:67], v8 offset:49152
v_mfma_f32_16x16x32_bf16 v[96:99], a[32:35], a[4:7], v[96:99]
v_mfma_f32_16x16x32_bf16 v[128:131], a[32:35], a[8:11], v[128:131]
ds_read_b64_tr_b16 a[96:97], v10 offset:49152
v_mfma_f32_16x16x32_bf16 v[160:163], a[32:35], a[12:15], v[160:163]
v_mfma_f32_16x16x32_bf16 v[192:195], a[32:35], a[16:19], v[192:195]
ds_read_b64_tr_b16 a[98:99], v10 offset:53248
v_mfma_f32_16x16x32_bf16 v[224:227], a[32:35], a[20:23], v[224:227]
v_mfma_f32_16x16x32_bf16 a[128:131], a[32:35], a[24:27], a[128:131]
ds_read_b128 a[68:71], v8 offset:50176
v_mfma_f32_16x16x32_bf16 a[160:163], a[32:35], a[28:31], a[160:163]
v_mfma_f32_16x16x32_bf16 a[164:167], a[36:39], a[28:31], a[164:167]
ds_read_b64_tr_b16 a[100:101], v11 offset:49152
v_mfma_f32_16x16x32_bf16 a[132:135], a[36:39], a[24:27], a[132:135]
v_mfma_f32_16x16x32_bf16 v[228:231], a[36:39], a[20:23], v[228:231]
ds_read_b64_tr_b16 a[102:103], v11 offset:53248
v_mfma_f32_16x16x32_bf16 v[196:199], a[36:39], a[16:19], v[196:199]
v_mfma_f32_16x16x32_bf16 v[164:167], a[36:39], a[12:15], v[164:167]
ds_read_b128 a[72:75], v8 offset:51200
v_mfma_f32_16x16x32_bf16 v[132:135], a[36:39], a[8:11], v[132:135]
v_mfma_f32_16x16x32_bf16 v[100:103], a[36:39], a[4:7], v[100:103]
ds_read_b64_tr_b16 a[104:105], v12 offset:49152
v_mfma_f32_16x16x32_bf16 v[68:71], a[36:39], a[0:3], v[68:71]
v_mfma_f32_16x16x32_bf16 v[72:75], a[40:43], a[0:3], v[72:75]
ds_read_b64_tr_b16 a[106:107], v12 offset:53248
v_mfma_f32_16x16x32_bf16 v[104:107], a[40:43], a[4:7], v[104:107]
v_mfma_f32_16x16x32_bf16 v[136:139], a[40:43], a[8:11], v[136:139]
ds_read_b128 a[76:79], v8 offset:52224
v_mfma_f32_16x16x32_bf16 v[168:171], a[40:43], a[12:15], v[168:171]
v_mfma_f32_16x16x32_bf16 v[200:203], a[40:43], a[16:19], v[200:203]
ds_read_b64_tr_b16 a[108:109], v13 offset:49152
v_mfma_f32_16x16x32_bf16 v[232:235], a[40:43], a[20:23], v[232:235]
v_mfma_f32_16x16x32_bf16 a[136:139], a[40:43], a[24:27], a[136:139]
ds_read_b64_tr_b16 a[110:111], v13 offset:53248
v_mfma_f32_16x16x32_bf16 a[168:171], a[40:43], a[28:31], a[168:171]
v_mfma_f32_16x16x32_bf16 a[172:175], a[44:47], a[28:31], a[172:175]
ds_read_b128 a[80:83], v8 offset:53248
v_mfma_f32_16x16x32_bf16 a[140:143], a[44:47], a[24:27], a[140:143]
v_mfma_f32_16x16x32_bf16 v[236:239], a[44:47], a[20:23], v[236:239]
ds_read_b64_tr_b16 a[112:113], v10 offset:57344
v_mfma_f32_16x16x32_bf16 v[204:207], a[44:47], a[16:19], v[204:207]
v_mfma_f32_16x16x32_bf16 v[172:175], a[44:47], a[12:15], v[172:175]
ds_read_b64_tr_b16 a[114:115], v10 offset:61440
v_mfma_f32_16x16x32_bf16 v[140:143], a[44:47], a[8:11], v[140:143]
v_mfma_f32_16x16x32_bf16 v[108:111], a[44:47], a[4:7], v[108:111]
ds_read_b128 a[84:87], v8 offset:54272
v_mfma_f32_16x16x32_bf16 v[76:79], a[44:47], a[0:3], v[76:79]
v_mfma_f32_16x16x32_bf16 v[80:83], a[48:51], a[0:3], v[80:83]
ds_read_b64_tr_b16 a[116:117], v11 offset:57344
v_mfma_f32_16x16x32_bf16 v[112:115], a[48:51], a[4:7], v[112:115]
v_mfma_f32_16x16x32_bf16 v[144:147], a[48:51], a[8:11], v[144:147]
ds_read_b64_tr_b16 a[118:119], v11 offset:61440
v_mfma_f32_16x16x32_bf16 v[176:179], a[48:51], a[12:15], v[176:179]
v_mfma_f32_16x16x32_bf16 v[208:211], a[48:51], a[16:19], v[208:211]
ds_read_b128 a[88:91], v8 offset:55296
v_mfma_f32_16x16x32_bf16 v[240:243], a[48:51], a[20:23], v[240:243]
v_mfma_f32_16x16x32_bf16 a[144:147], a[48:51], a[24:27], a[144:147]
ds_read_b64_tr_b16 a[120:121], v12 offset:57344
v_mfma_f32_16x16x32_bf16 a[176:179], a[48:51], a[28:31], a[176:179]
v_mfma_f32_16x16x32_bf16 a[180:183], a[52:55], a[28:31], a[180:183]
ds_read_b64_tr_b16 a[122:123], v12 offset:61440
v_mfma_f32_16x16x32_bf16 a[148:151], a[52:55], a[24:27], a[148:151]
v_mfma_f32_16x16x32_bf16 v[244:247], a[52:55], a[20:23], v[244:247]
ds_read_b128 a[92:95], v8 offset:56320
v_mfma_f32_16x16x32_bf16 v[212:215], a[52:55], a[16:19], v[212:215]
v_mfma_f32_16x16x32_bf16 v[180:183], a[52:55], a[12:15], v[180:183]
ds_read_b64_tr_b16 a[124:125], v13 offset:57344
v_mfma_f32_16x16x32_bf16 v[148:151], a[52:55], a[8:11], v[148:151]
v_mfma_f32_16x16x32_bf16 v[116:119], a[52:55], a[4:7], v[116:119]
ds_read_b64_tr_b16 a[126:127], v13 offset:61440
v_mfma_f32_16x16x32_bf16 v[84:87], a[52:55], a[0:3], v[84:87]
v_mfma_f32_16x16x32_bf16 v[88:91], a[56:59], a[0:3], v[88:91]
v_mfma_f32_16x16x32_bf16 v[120:123], a[56:59], a[4:7], v[120:123]
v_mfma_f32_16x16x32_bf16 v[152:155], a[56:59], a[8:11], v[152:155]
v_mfma_f32_16x16x32_bf16 v[184:187], a[56:59], a[12:15], v[184:187]
v_mfma_f32_16x16x32_bf16 v[216:219], a[56:59], a[16:19], v[216:219]
v_mfma_f32_16x16x32_bf16 v[248:251], a[56:59], a[20:23], v[248:251]
v_mfma_f32_16x16x32_bf16 a[152:155], a[56:59], a[24:27], a[152:155]
v_mfma_f32_16x16x32_bf16 a[184:187], a[56:59], a[28:31], a[184:187]
v_mfma_f32_16x16x32_bf16 a[188:191], a[60:63], a[28:31], a[188:191]
v_mfma_f32_16x16x32_bf16 a[156:159], a[60:63], a[24:27], a[156:159]
v_mfma_f32_16x16x32_bf16 v[252:255], a[60:63], a[20:23], v[252:255]
v_mfma_f32_16x16x32_bf16 v[220:223], a[60:63], a[16:19], v[220:223]
v_mfma_f32_16x16x32_bf16 v[188:191], a[60:63], a[12:15], v[188:191]
v_mfma_f32_16x16x32_bf16 v[156:159], a[60:63], a[8:11], v[156:159]
v_mfma_f32_16x16x32_bf16 v[124:127], a[60:63], a[4:7], v[124:127]
v_mfma_f32_16x16x32_bf16 v[92:95], a[60:63], a[0:3], v[92:95]
s_waitcnt lgkmcnt(0)
v_mfma_f32_16x16x32_bf16 v[64:67], a[96:99], a[64:67], v[64:67]
v_mfma_f32_16x16x32_bf16 v[96:99], a[96:99], a[68:71], v[96:99]
v_mfma_f32_16x16x32_bf16 v[128:131], a[96:99], a[72:75], v[128:131]
v_mfma_f32_16x16x32_bf16 v[160:163], a[96:99], a[76:79], v[160:163]
v_mfma_f32_16x16x32_bf16 v[192:195], a[96:99], a[80:83], v[192:195]
v_mfma_f32_16x16x32_bf16 v[224:227], a[96:99], a[84:87], v[224:227]
v_mfma_f32_16x16x32_bf16 a[128:131], a[96:99], a[88:91], a[128:131]
v_mfma_f32_16x16x32_bf16 a[160:163], a[96:99], a[92:95], a[160:163]
v_mfma_f32_16x16x32_bf16 a[164:167], a[100:103], a[92:95], a[164:167]
v_mfma_f32_16x16x32_bf16 a[132:135], a[100:103], a[88:91], a[132:135]
v_mfma_f32_16x16x32_bf16 v[228:231], a[100:103], a[84:87], v[228:231]
v_mfma_f32_16x16x32_bf16 v[196:199], a[100:103], a[80:83], v[196:199]
v_mfma_f32_16x16x32_bf16 v[164:167], a[100:103], a[76:79], v[164:167]
v_mfma_f32_16x16x32_bf16 v[132:135], a[100:103], a[72:75], v[132:135]
v_mfma_f32_16x16x32_bf16 v[100:103], a[100:103], a[68:71], v[100:103]
v_mfma_f32_16x16x32_bf16 v[68:71], a[100:103], a[64:67], v[68:71]
v_mfma_f32_16x16x32_bf16 v[72:75], a[104:107], a[64:67], v[72:75]
v_mfma_f32_16x16x32_bf16 v[104:107], a[104:107], a[68:71], v[104:107]
v_mfma_f32_16x16x32_bf16 v[136:139], a[104:107], a[72:75], v[136:139]
v_mfma_f32_16x16x32_bf16 v[168:171], a[104:107], a[76:79], v[168:171]
v_mfma_f32_16x16x32_bf16 v[200:203], a[104:107], a[80:83], v[200:203]
v_mfma_f32_16x16x32_bf16 v[232:235], a[104:107], a[84:87], v[232:235]
v_mfma_f32_16x16x32_bf16 a[136:139], a[104:107], a[88:91], a[136:139]
v_mfma_f32_16x16x32_bf16 a[168:171], a[104:107], a[92:95], a[168:171]
v_mfma_f32_16x16x32_bf16 a[172:175], a[108:111], a[92:95], a[172:175]
v_mfma_f32_16x16x32_bf16 a[140:143], a[108:111], a[88:91], a[140:143]
v_mfma_f32_16x16x32_bf16 v[236:239], a[108:111], a[84:87], v[236:239]
v_mfma_f32_16x16x32_bf16 v[204:207], a[108:111], a[80:83], v[204:207]
v_mfma_f32_16x16x32_bf16 v[172:175], a[108:111], a[76:79], v[172:175]
v_mfma_f32_16x16x32_bf16 v[140:143], a[108:111], a[72:75], v[140:143]
v_mfma_f32_16x16x32_bf16 v[108:111], a[108:111], a[68:71], v[108:111]
v_mfma_f32_16x16x32_bf16 v[76:79], a[108:111], a[64:67], v[76:79]
v_mfma_f32_16x16x32_bf16 v[80:83], a[112:115], a[64:67], v[80:83]
v_mfma_f32_16x16x32_bf16 v[112:115], a[112:115], a[68:71], v[112:115]
v_mfma_f32_16x16x32_bf16 v[144:147], a[112:115], a[72:75], v[144:147]
v_mfma_f32_16x16x32_bf16 v[176:179], a[112:115], a[76:79], v[176:179]
v_mfma_f32_16x16x32_bf16 v[208:211], a[112:115], a[80:83], v[208:211]
v_mfma_f32_16x16x32_bf16 v[240:243], a[112:115], a[84:87], v[240:243]
v_mfma_f32_16x16x32_bf16 a[144:147], a[112:115], a[88:91], a[144:147]
v_mfma_f32_16x16x32_bf16 a[176:179], a[112:115], a[92:95], a[176:179]
v_mfma_f32_16x16x32_bf16 a[180:183], a[116:119], a[92:95], a[180:183]
v_mfma_f32_16x16x32_bf16 a[148:151], a[116:119], a[88:91], a[148:151]
v_mfma_f32_16x16x32_bf16 v[244:247], a[116:119], a[84:87], v[244:247]
v_mfma_f32_16x16x32_bf16 v[212:215], a[116:119], a[80:83], v[212:215]
v_mfma_f32_16x16x32_bf16 v[180:183], a[116:119], a[76:79], v[180:183]
v_mfma_f32_16x16x32_bf16 v[148:151], a[116:119], a[72:75], v[148:151]
v_mfma_f32_16x16x32_bf16 v[116:119], a[116:119], a[68:71], v[116:119]
v_mfma_f32_16x16x32_bf16 v[84:87], a[116:119], a[64:67], v[84:87]
v_mfma_f32_16x16x32_bf16 v[88:91], a[120:123], a[64:67], v[88:91]
v_mfma_f32_16x16x32_bf16 v[120:123], a[120:123], a[68:71], v[120:123]
v_mfma_f32_16x16x32_bf16 v[152:155], a[120:123], a[72:75], v[152:155]
v_mfma_f32_16x16x32_bf16 v[184:187], a[120:123], a[76:79], v[184:187]
v_mfma_f32_16x16x32_bf16 v[216:219], a[120:123], a[80:83], v[216:219]
v_mfma_f32_16x16x32_bf16 v[248:251], a[120:123], a[84:87], v[248:251]
v_mfma_f32_16x16x32_bf16 a[152:155], a[120:123], a[88:91], a[152:155]
v_mfma_f32_16x16x32_bf16 a[184:187], a[120:123], a[92:95], a[184:187]
v_mfma_f32_16x16x32_bf16 a[188:191], a[124:127], a[92:95], a[188:191]
v_mfma_f32_16x16x32_bf16 a[156:159], a[124:127], a[88:91], a[156:159]
v_mfma_f32_16x16x32_bf16 v[252:255], a[124:127], a[84:87], v[252:255]
v_mfma_f32_16x16x32_bf16 v[220:223], a[124:127], a[80:83], v[220:223]
v_mfma_f32_16x16x32_bf16 v[188:191], a[124:127], a[76:79], v[188:191]
v_mfma_f32_16x16x32_bf16 v[156:159], a[124:127], a[72:75], v[156:159]
v_mfma_f32_16x16x32_bf16 v[124:127], a[124:127], a[68:71], v[124:127]
v_mfma_f32_16x16x32_bf16 v[92:95], a[124:127], a[64:67], v[92:95]
v_lshlrev_b32 v24, 4, v1
s_mov_b32 s68, 0xbfb8aa3b
s_nop 7
s_add_u32 s66, s48, 0
v_pk_mul_f32 v[42:43], v[64:65], s[68:69] op_sel_hi:[1,0]
v_pk_mul_f32 v[44:45], v[66:67], s[68:69] op_sel_hi:[1,0]
v_pk_mul_f32 v[46:47], v[68:69], s[68:69] op_sel_hi:[1,0]
v_pk_mul_f32 v[48:49], v[70:71], s[68:69] op_sel_hi:[1,0]
v_exp_f32 v42, v42
v_exp_f32 v43, v43
v_exp_f32 v44, v44
v_exp_f32 v45, v45
v_exp_f32 v46, v46
v_exp_f32 v47, v47
v_exp_f32 v48, v48
v_exp_f32 v49, v49
v_pk_mul_f32 v[64:65], v[64:65], v[80:81]
v_pk_mul_f32 v[66:67], v[66:67], v[82:83]
v_pk_mul_f32 v[68:69], v[68:69], v[84:85]
v_pk_mul_f32 v[70:71], v[70:71], v[86:87]
v_pk_add_f32 v[42:43], v[42:43], 1.0 op_sel_hi:[1,0]
v_pk_add_f32 v[44:45], v[44:45], 1.0 op_sel_hi:[1,0]
v_pk_add_f32 v[46:47], v[46:47], 1.0 op_sel_hi:[1,0]
v_pk_add_f32 v[48:49], v[48:49], 1.0 op_sel_hi:[1,0]
v_rcp_f32 v42, v42
v_rcp_f32 v43, v43
v_rcp_f32 v44, v44
v_rcp_f32 v45, v45
v_rcp_f32 v46, v46
v_rcp_f32 v47, v47
v_rcp_f32 v48, v48
v_rcp_f32 v49, v49
s_nop 0
v_pk_mul_f32 v[64:65], v[64:65], v[42:43]
v_pk_mul_f32 v[66:67], v[66:67], v[44:45]
v_pk_mul_f32 v[68:69], v[68:69], v[46:47]
v_pk_mul_f32 v[70:71], v[70:71], v[48:49]
v_cvt_pk_bf16_f32 v54, v64, v65
v_cvt_pk_bf16_f32 v55, v66, v67
v_cvt_pk_bf16_f32 v56, v68, v69
v_cvt_pk_bf16_f32 v57, v70, v71
buffer_store_dwordx4 v[54:57], v24, s[4:7], s66 offen offset:0 sc1
s_add_u32 s66, s48, 4096
v_pk_mul_f32 v[42:43], v[72:73], s[68:69] op_sel_hi:[1,0]
v_pk_mul_f32 v[44:45], v[74:75], s[68:69] op_sel_hi:[1,0]
v_pk_mul_f32 v[46:47], v[76:77], s[68:69] op_sel_hi:[1,0]
v_pk_mul_f32 v[48:49], v[78:79], s[68:69] op_sel_hi:[1,0]
v_exp_f32 v42, v42
v_exp_f32 v43, v43
v_exp_f32 v44, v44
v_exp_f32 v45, v45
v_exp_f32 v46, v46
v_exp_f32 v47, v47
v_exp_f32 v48, v48
v_exp_f32 v49, v49
v_pk_mul_f32 v[72:73], v[72:73], v[88:89]
v_pk_mul_f32 v[74:75], v[74:75], v[90:91]
v_pk_mul_f32 v[76:77], v[76:77], v[92:93]
v_pk_mul_f32 v[78:79], v[78:79], v[94:95]
v_pk_add_f32 v[42:43], v[42:43], 1.0 op_sel_hi:[1,0]
v_pk_add_f32 v[44:45], v[44:45], 1.0 op_sel_hi:[1,0]
v_pk_add_f32 v[46:47], v[46:47], 1.0 op_sel_hi:[1,0]
v_pk_add_f32 v[48:49], v[48:49], 1.0 op_sel_hi:[1,0]
v_rcp_f32 v42, v42
v_rcp_f32 v43, v43
v_rcp_f32 v44, v44
v_rcp_f32 v45, v45
v_rcp_f32 v46, v46
v_rcp_f32 v47, v47
v_rcp_f32 v48, v48
v_rcp_f32 v49, v49
s_nop 0
v_pk_mul_f32 v[72:73], v[72:73], v[42:43]
v_pk_mul_f32 v[74:75], v[74:75], v[44:45]
v_pk_mul_f32 v[76:77], v[76:77], v[46:47]
v_pk_mul_f32 v[78:79], v[78:79], v[48:49]
v_cvt_pk_bf16_f32 v58, v72, v73
v_cvt_pk_bf16_f32 v59, v74, v75
v_cvt_pk_bf16_f32 v60, v76, v77
v_cvt_pk_bf16_f32 v61, v78, v79
buffer_store_dwordx4 v[58:61], v24, s[4:7], s66 offen offset:0 sc1
s_add_u32 s66, s48, 0
v_pk_mul_f32 v[42:43], v[96:97], s[68:69] op_sel_hi:[1,0]
v_pk_mul_f32 v[44:45], v[98:99], s[68:69] op_sel_hi:[1,0]
v_pk_mul_f32 v[46:47], v[100:101], s[68:69] op_sel_hi:[1,0]
v_pk_mul_f32 v[48:49], v[102:103], s[68:69] op_sel_hi:[1,0]
v_exp_f32 v42, v42
v_exp_f32 v43, v43
v_exp_f32 v44, v44
v_exp_f32 v45, v45
v_exp_f32 v46, v46
v_exp_f32 v47, v47
v_exp_f32 v48, v48
v_exp_f32 v49, v49
v_pk_mul_f32 v[96:97], v[96:97], v[112:113]
v_pk_mul_f32 v[98:99], v[98:99], v[114:115]
v_pk_mul_f32 v[100:101], v[100:101], v[116:117]
v_pk_mul_f32 v[102:103], v[102:103], v[118:119]
v_pk_add_f32 v[42:43], v[42:43], 1.0 op_sel_hi:[1,0]
v_pk_add_f32 v[44:45], v[44:45], 1.0 op_sel_hi:[1,0]
v_pk_add_f32 v[46:47], v[46:47], 1.0 op_sel_hi:[1,0]
v_pk_add_f32 v[48:49], v[48:49], 1.0 op_sel_hi:[1,0]
v_rcp_f32 v42, v42
v_rcp_f32 v43, v43
v_rcp_f32 v44, v44
v_rcp_f32 v45, v45
v_rcp_f32 v46, v46
v_rcp_f32 v47, v47
v_rcp_f32 v48, v48
v_rcp_f32 v49, v49
s_nop 0
v_pk_mul_f32 v[96:97], v[96:97], v[42:43]
v_pk_mul_f32 v[98:99], v[98:99], v[44:45]
v_pk_mul_f32 v[100:101], v[100:101], v[46:47]
v_pk_mul_f32 v[102:103], v[102:103], v[48:49]
v_cvt_pk_bf16_f32 v50, v96, v97
v_cvt_pk_bf16_f32 v51, v98, v99
v_cvt_pk_bf16_f32 v52, v100, v101
v_cvt_pk_bf16_f32 v53, v102, v103
buffer_store_dwordx4 v[50:53], v24, s[4:7], s66 offen offset:1024 sc1
s_add_u32 s66, s48, 4096
v_pk_mul_f32 v[42:43], v[104:105], s[68:69] op_sel_hi:[1,0]
v_pk_mul_f32 v[44:45], v[106:107], s[68:69] op_sel_hi:[1,0]
v_pk_mul_f32 v[46:47], v[108:109], s[68:69] op_sel_hi:[1,0]
v_pk_mul_f32 v[48:49], v[110:111], s[68:69] op_sel_hi:[1,0]
v_exp_f32 v42, v42
v_exp_f32 v43, v43
v_exp_f32 v44, v44
v_exp_f32 v45, v45
v_exp_f32 v46, v46
v_exp_f32 v47, v47
v_exp_f32 v48, v48
v_exp_f32 v49, v49
v_pk_mul_f32 v[104:105], v[104:105], v[120:121]
v_pk_mul_f32 v[106:107], v[106:107], v[122:123]
v_pk_mul_f32 v[108:109], v[108:109], v[124:125]
v_pk_mul_f32 v[110:111], v[110:111], v[126:127]
v_pk_add_f32 v[42:43], v[42:43], 1.0 op_sel_hi:[1,0]
v_pk_add_f32 v[44:45], v[44:45], 1.0 op_sel_hi:[1,0]
v_pk_add_f32 v[46:47], v[46:47], 1.0 op_sel_hi:[1,0]
v_pk_add_f32 v[48:49], v[48:49], 1.0 op_sel_hi:[1,0]
v_rcp_f32 v42, v42
v_rcp_f32 v43, v43
v_rcp_f32 v44, v44
v_rcp_f32 v45, v45
v_rcp_f32 v46, v46
v_rcp_f32 v47, v47
v_rcp_f32 v48, v48
v_rcp_f32 v49, v49
s_nop 0
v_pk_mul_f32 v[104:105], v[104:105], v[42:43]
v_pk_mul_f32 v[106:107], v[106:107], v[44:45]
v_pk_mul_f32 v[108:109], v[108:109], v[46:47]
v_pk_mul_f32 v[110:111], v[110:111], v[48:49]
v_cvt_pk_bf16_f32 v54, v104, v105
v_cvt_pk_bf16_f32 v55, v106, v107
v_cvt_pk_bf16_f32 v56, v108, v109
v_cvt_pk_bf16_f32 v57, v110, v111
buffer_store_dwordx4 v[54:57], v24, s[4:7], s66 offen offset:1024 sc1
s_add_u32 s66, s48, 0
v_pk_mul_f32 v[42:43], v[128:129], s[68:69] op_sel_hi:[1,0]
v_pk_mul_f32 v[44:45], v[130:131], s[68:69] op_sel_hi:[1,0]
v_pk_mul_f32 v[46:47], v[132:133], s[68:69] op_sel_hi:[1,0]
v_pk_mul_f32 v[48:49], v[134:135], s[68:69] op_sel_hi:[1,0]
v_exp_f32 v42, v42
v_exp_f32 v43, v43
v_exp_f32 v44, v44
v_exp_f32 v45, v45
v_exp_f32 v46, v46
v_exp_f32 v47, v47
v_exp_f32 v48, v48
v_exp_f32 v49, v49
v_pk_mul_f32 v[128:129], v[128:129], v[144:145]
v_pk_mul_f32 v[130:131], v[130:131], v[146:147]
v_pk_mul_f32 v[132:133], v[132:133], v[148:149]
v_pk_mul_f32 v[134:135], v[134:135], v[150:151]
v_pk_add_f32 v[42:43], v[42:43], 1.0 op_sel_hi:[1,0]
v_pk_add_f32 v[44:45], v[44:45], 1.0 op_sel_hi:[1,0]
v_pk_add_f32 v[46:47], v[46:47], 1.0 op_sel_hi:[1,0]
v_pk_add_f32 v[48:49], v[48:49], 1.0 op_sel_hi:[1,0]
v_rcp_f32 v42, v42
v_rcp_f32 v43, v43
v_rcp_f32 v44, v44
v_rcp_f32 v45, v45
v_rcp_f32 v46, v46
v_rcp_f32 v47, v47
v_rcp_f32 v48, v48
v_rcp_f32 v49, v49
s_nop 0
v_pk_mul_f32 v[128:129], v[128:129], v[42:43]
v_pk_mul_f32 v[130:131], v[130:131], v[44:45]
v_pk_mul_f32 v[132:133], v[132:133], v[46:47]
v_pk_mul_f32 v[134:135], v[134:135], v[48:49]
v_cvt_pk_bf16_f32 v58, v128, v129
v_cvt_pk_bf16_f32 v59, v130, v131
v_cvt_pk_bf16_f32 v60, v132, v133
v_cvt_pk_bf16_f32 v61, v134, v135
buffer_store_dwordx4 v[58:61], v24, s[4:7], s66 offen offset:2048 sc1
s_add_u32 s66, s48, 4096
v_pk_mul_f32 v[42:43], v[136:137], s[68:69] op_sel_hi:[1,0]
v_pk_mul_f32 v[44:45], v[138:139], s[68:69] op_sel_hi:[1,0]
v_pk_mul_f32 v[46:47], v[140:141], s[68:69] op_sel_hi:[1,0]
v_pk_mul_f32 v[48:49], v[142:143], s[68:69] op_sel_hi:[1,0]
v_exp_f32 v42, v42
v_exp_f32 v43, v43
v_exp_f32 v44, v44
v_exp_f32 v45, v45
v_exp_f32 v46, v46
v_exp_f32 v47, v47
v_exp_f32 v48, v48
v_exp_f32 v49, v49
v_pk_mul_f32 v[136:137], v[136:137], v[152:153]
v_pk_mul_f32 v[138:139], v[138:139], v[154:155]
v_pk_mul_f32 v[140:141], v[140:141], v[156:157]
v_pk_mul_f32 v[142:143], v[142:143], v[158:159]
v_pk_add_f32 v[42:43], v[42:43], 1.0 op_sel_hi:[1,0]
v_pk_add_f32 v[44:45], v[44:45], 1.0 op_sel_hi:[1,0]
v_pk_add_f32 v[46:47], v[46:47], 1.0 op_sel_hi:[1,0]
v_pk_add_f32 v[48:49], v[48:49], 1.0 op_sel_hi:[1,0]
v_rcp_f32 v42, v42
v_rcp_f32 v43, v43
v_rcp_f32 v44, v44
v_rcp_f32 v45, v45
v_rcp_f32 v46, v46
v_rcp_f32 v47, v47
v_rcp_f32 v48, v48
v_rcp_f32 v49, v49
s_nop 0
v_pk_mul_f32 v[136:137], v[136:137], v[42:43]
v_pk_mul_f32 v[138:139], v[138:139], v[44:45]
v_pk_mul_f32 v[140:141], v[140:141], v[46:47]
v_pk_mul_f32 v[142:143], v[142:143], v[48:49]
v_cvt_pk_bf16_f32 v50, v136, v137
v_cvt_pk_bf16_f32 v51, v138, v139
v_cvt_pk_bf16_f32 v52, v140, v141
v_cvt_pk_bf16_f32 v53, v142, v143
buffer_store_dwordx4 v[50:53], v24, s[4:7], s66 offen offset:2048 sc1
s_add_u32 s66, s48, 0
v_pk_mul_f32 v[42:43], v[160:161], s[68:69] op_sel_hi:[1,0]
v_pk_mul_f32 v[44:45], v[162:163], s[68:69] op_sel_hi:[1,0]
v_pk_mul_f32 v[46:47], v[164:165], s[68:69] op_sel_hi:[1,0]
v_pk_mul_f32 v[48:49], v[166:167], s[68:69] op_sel_hi:[1,0]
v_exp_f32 v42, v42
v_exp_f32 v43, v43
v_exp_f32 v44, v44
v_exp_f32 v45, v45
v_exp_f32 v46, v46
v_exp_f32 v47, v47
v_exp_f32 v48, v48
v_exp_f32 v49, v49
v_pk_mul_f32 v[160:161], v[160:161], v[176:177]
v_pk_mul_f32 v[162:163], v[162:163], v[178:179]
v_pk_mul_f32 v[164:165], v[164:165], v[180:181]
v_pk_mul_f32 v[166:167], v[166:167], v[182:183]
v_pk_add_f32 v[42:43], v[42:43], 1.0 op_sel_hi:[1,0]
v_pk_add_f32 v[44:45], v[44:45], 1.0 op_sel_hi:[1,0]
v_pk_add_f32 v[46:47], v[46:47], 1.0 op_sel_hi:[1,0]
v_pk_add_f32 v[48:49], v[48:49], 1.0 op_sel_hi:[1,0]
v_rcp_f32 v42, v42
v_rcp_f32 v43, v43
v_rcp_f32 v44, v44
v_rcp_f32 v45, v45
v_rcp_f32 v46, v46
v_rcp_f32 v47, v47
v_rcp_f32 v48, v48
v_rcp_f32 v49, v49
s_nop 0
v_pk_mul_f32 v[160:161], v[160:161], v[42:43]
v_pk_mul_f32 v[162:163], v[162:163], v[44:45]
v_pk_mul_f32 v[164:165], v[164:165], v[46:47]
v_pk_mul_f32 v[166:167], v[166:167], v[48:49]
v_cvt_pk_bf16_f32 v54, v160, v161
v_cvt_pk_bf16_f32 v55, v162, v163
v_cvt_pk_bf16_f32 v56, v164, v165
v_cvt_pk_bf16_f32 v57, v166, v167
buffer_store_dwordx4 v[54:57], v24, s[4:7], s66 offen offset:3072 sc1
s_add_u32 s66, s48, 4096
v_pk_mul_f32 v[42:43], v[168:169], s[68:69] op_sel_hi:[1,0]
v_pk_mul_f32 v[44:45], v[170:171], s[68:69] op_sel_hi:[1,0]
v_pk_mul_f32 v[46:47], v[172:173], s[68:69] op_sel_hi:[1,0]
v_pk_mul_f32 v[48:49], v[174:175], s[68:69] op_sel_hi:[1,0]
v_exp_f32 v42, v42
v_exp_f32 v43, v43
v_exp_f32 v44, v44
v_exp_f32 v45, v45
v_exp_f32 v46, v46
v_exp_f32 v47, v47
v_exp_f32 v48, v48
v_exp_f32 v49, v49
v_pk_mul_f32 v[168:169], v[168:169], v[184:185]
v_pk_mul_f32 v[170:171], v[170:171], v[186:187]
v_pk_mul_f32 v[172:173], v[172:173], v[188:189]
v_pk_mul_f32 v[174:175], v[174:175], v[190:191]
v_pk_add_f32 v[42:43], v[42:43], 1.0 op_sel_hi:[1,0]
v_pk_add_f32 v[44:45], v[44:45], 1.0 op_sel_hi:[1,0]
v_pk_add_f32 v[46:47], v[46:47], 1.0 op_sel_hi:[1,0]
v_pk_add_f32 v[48:49], v[48:49], 1.0 op_sel_hi:[1,0]
v_rcp_f32 v42, v42
v_rcp_f32 v43, v43
v_rcp_f32 v44, v44
v_rcp_f32 v45, v45
v_rcp_f32 v46, v46
v_rcp_f32 v47, v47
v_rcp_f32 v48, v48
v_rcp_f32 v49, v49
s_nop 0
v_pk_mul_f32 v[168:169], v[168:169], v[42:43]
v_pk_mul_f32 v[170:171], v[170:171], v[44:45]
v_pk_mul_f32 v[172:173], v[172:173], v[46:47]
v_pk_mul_f32 v[174:175], v[174:175], v[48:49]
v_cvt_pk_bf16_f32 v58, v168, v169
v_cvt_pk_bf16_f32 v59, v170, v171
v_cvt_pk_bf16_f32 v60, v172, v173
v_cvt_pk_bf16_f32 v61, v174, v175
buffer_store_dwordx4 v[58:61], v24, s[4:7], s66 offen offset:3072 sc1
s_add_u32 s66, s48, 458752
v_pk_mul_f32 v[42:43], v[192:193], s[68:69] op_sel_hi:[1,0]
v_pk_mul_f32 v[44:45], v[194:195], s[68:69] op_sel_hi:[1,0]
v_pk_mul_f32 v[46:47], v[196:197], s[68:69] op_sel_hi:[1,0]
v_pk_mul_f32 v[48:49], v[198:199], s[68:69] op_sel_hi:[1,0]
v_exp_f32 v42, v42
v_exp_f32 v43, v43
v_exp_f32 v44, v44
v_exp_f32 v45, v45
v_exp_f32 v46, v46
v_exp_f32 v47, v47
v_exp_f32 v48, v48
v_exp_f32 v49, v49
v_pk_mul_f32 v[192:193], v[192:193], v[208:209]
v_pk_mul_f32 v[194:195], v[194:195], v[210:211]
v_pk_mul_f32 v[196:197], v[196:197], v[212:213]
v_pk_mul_f32 v[198:199], v[198:199], v[214:215]
v_pk_add_f32 v[42:43], v[42:43], 1.0 op_sel_hi:[1,0]
v_pk_add_f32 v[44:45], v[44:45], 1.0 op_sel_hi:[1,0]
v_pk_add_f32 v[46:47], v[46:47], 1.0 op_sel_hi:[1,0]
v_pk_add_f32 v[48:49], v[48:49], 1.0 op_sel_hi:[1,0]
v_rcp_f32 v42, v42
v_rcp_f32 v43, v43
v_rcp_f32 v44, v44
v_rcp_f32 v45, v45
v_rcp_f32 v46, v46
v_rcp_f32 v47, v47
v_rcp_f32 v48, v48
v_rcp_f32 v49, v49
s_nop 0
v_pk_mul_f32 v[192:193], v[192:193], v[42:43]
v_pk_mul_f32 v[194:195], v[194:195], v[44:45]
v_pk_mul_f32 v[196:197], v[196:197], v[46:47]
v_pk_mul_f32 v[198:199], v[198:199], v[48:49]
v_cvt_pk_bf16_f32 v50, v192, v193
v_cvt_pk_bf16_f32 v51, v194, v195
v_cvt_pk_bf16_f32 v52, v196, v197
v_cvt_pk_bf16_f32 v53, v198, v199
buffer_store_dwordx4 v[50:53], v24, s[4:7], s66 offen offset:0 sc1
s_add_u32 s66, s48, 462848
v_pk_mul_f32 v[42:43], v[200:201], s[68:69] op_sel_hi:[1,0]
v_pk_mul_f32 v[44:45], v[202:203], s[68:69] op_sel_hi:[1,0]
v_pk_mul_f32 v[46:47], v[204:205], s[68:69] op_sel_hi:[1,0]
v_pk_mul_f32 v[48:49], v[206:207], s[68:69] op_sel_hi:[1,0]
v_exp_f32 v42, v42
v_exp_f32 v43, v43
v_exp_f32 v44, v44
v_exp_f32 v45, v45
v_exp_f32 v46, v46
v_exp_f32 v47, v47
v_exp_f32 v48, v48
v_exp_f32 v49, v49
v_pk_mul_f32 v[200:201], v[200:201], v[216:217]
v_pk_mul_f32 v[202:203], v[202:203], v[218:219]
v_pk_mul_f32 v[204:205], v[204:205], v[220:221]
v_pk_mul_f32 v[206:207], v[206:207], v[222:223]
v_pk_add_f32 v[42:43], v[42:43], 1.0 op_sel_hi:[1,0]
v_pk_add_f32 v[44:45], v[44:45], 1.0 op_sel_hi:[1,0]
v_pk_add_f32 v[46:47], v[46:47], 1.0 op_sel_hi:[1,0]
v_pk_add_f32 v[48:49], v[48:49], 1.0 op_sel_hi:[1,0]
v_rcp_f32 v42, v42
v_rcp_f32 v43, v43
v_rcp_f32 v44, v44
v_rcp_f32 v45, v45
v_rcp_f32 v46, v46
v_rcp_f32 v47, v47
v_rcp_f32 v48, v48
v_rcp_f32 v49, v49
s_nop 0
v_pk_mul_f32 v[200:201], v[200:201], v[42:43]
v_pk_mul_f32 v[202:203], v[202:203], v[44:45]
v_pk_mul_f32 v[204:205], v[204:205], v[46:47]
v_pk_mul_f32 v[206:207], v[206:207], v[48:49]
v_cvt_pk_bf16_f32 v54, v200, v201
v_cvt_pk_bf16_f32 v55, v202, v203
v_cvt_pk_bf16_f32 v56, v204, v205
v_cvt_pk_bf16_f32 v57, v206, v207
buffer_store_dwordx4 v[54:57], v24, s[4:7], s66 offen offset:0 sc1
s_add_u32 s66, s48, 458752
v_pk_mul_f32 v[42:43], v[224:225], s[68:69] op_sel_hi:[1,0]
v_pk_mul_f32 v[44:45], v[226:227], s[68:69] op_sel_hi:[1,0]
v_pk_mul_f32 v[46:47], v[228:229], s[68:69] op_sel_hi:[1,0]
v_pk_mul_f32 v[48:49], v[230:231], s[68:69] op_sel_hi:[1,0]
v_exp_f32 v42, v42
v_exp_f32 v43, v43
v_exp_f32 v44, v44
v_exp_f32 v45, v45
v_exp_f32 v46, v46
v_exp_f32 v47, v47
v_exp_f32 v48, v48
v_exp_f32 v49, v49
v_pk_mul_f32 v[224:225], v[224:225], v[240:241]
v_pk_mul_f32 v[226:227], v[226:227], v[242:243]
v_pk_mul_f32 v[228:229], v[228:229], v[244:245]
v_pk_mul_f32 v[230:231], v[230:231], v[246:247]
v_pk_add_f32 v[42:43], v[42:43], 1.0 op_sel_hi:[1,0]
v_pk_add_f32 v[44:45], v[44:45], 1.0 op_sel_hi:[1,0]
v_pk_add_f32 v[46:47], v[46:47], 1.0 op_sel_hi:[1,0]
v_pk_add_f32 v[48:49], v[48:49], 1.0 op_sel_hi:[1,0]
v_rcp_f32 v42, v42
v_rcp_f32 v43, v43
v_rcp_f32 v44, v44
v_rcp_f32 v45, v45
v_rcp_f32 v46, v46
v_rcp_f32 v47, v47
v_rcp_f32 v48, v48
v_rcp_f32 v49, v49
s_nop 0
v_pk_mul_f32 v[224:225], v[224:225], v[42:43]
v_pk_mul_f32 v[226:227], v[226:227], v[44:45]
v_pk_mul_f32 v[228:229], v[228:229], v[46:47]
v_pk_mul_f32 v[230:231], v[230:231], v[48:49]
v_cvt_pk_bf16_f32 v58, v224, v225
v_cvt_pk_bf16_f32 v59, v226, v227
v_cvt_pk_bf16_f32 v60, v228, v229
v_cvt_pk_bf16_f32 v61, v230, v231
buffer_store_dwordx4 v[58:61], v24, s[4:7], s66 offen offset:1024 sc1
s_add_u32 s66, s48, 462848
v_pk_mul_f32 v[42:43], v[232:233], s[68:69] op_sel_hi:[1,0]
v_pk_mul_f32 v[44:45], v[234:235], s[68:69] op_sel_hi:[1,0]
v_pk_mul_f32 v[46:47], v[236:237], s[68:69] op_sel_hi:[1,0]
v_pk_mul_f32 v[48:49], v[238:239], s[68:69] op_sel_hi:[1,0]
v_exp_f32 v42, v42
v_exp_f32 v43, v43
v_exp_f32 v44, v44
v_exp_f32 v45, v45
v_exp_f32 v46, v46
v_exp_f32 v47, v47
v_exp_f32 v48, v48
v_exp_f32 v49, v49
v_pk_mul_f32 v[232:233], v[232:233], v[248:249]
v_pk_mul_f32 v[234:235], v[234:235], v[250:251]
v_pk_mul_f32 v[236:237], v[236:237], v[252:253]
v_pk_mul_f32 v[238:239], v[238:239], v[254:255]
v_pk_add_f32 v[42:43], v[42:43], 1.0 op_sel_hi:[1,0]
v_pk_add_f32 v[44:45], v[44:45], 1.0 op_sel_hi:[1,0]
v_pk_add_f32 v[46:47], v[46:47], 1.0 op_sel_hi:[1,0]
v_pk_add_f32 v[48:49], v[48:49], 1.0 op_sel_hi:[1,0]
v_rcp_f32 v42, v42
v_rcp_f32 v43, v43
v_rcp_f32 v44, v44
v_rcp_f32 v45, v45
v_rcp_f32 v46, v46
v_rcp_f32 v47, v47
v_rcp_f32 v48, v48
v_rcp_f32 v49, v49
s_nop 0
v_pk_mul_f32 v[232:233], v[232:233], v[42:43]
v_pk_mul_f32 v[234:235], v[234:235], v[44:45]
v_pk_mul_f32 v[236:237], v[236:237], v[46:47]
v_pk_mul_f32 v[238:239], v[238:239], v[48:49]
v_cvt_pk_bf16_f32 v50, v232, v233
v_cvt_pk_bf16_f32 v51, v234, v235
v_cvt_pk_bf16_f32 v52, v236, v237
v_cvt_pk_bf16_f32 v53, v238, v239
buffer_store_dwordx4 v[50:53], v24, s[4:7], s66 offen offset:1024 sc1
s_add_u32 s66, s48, 458752
v_accvgpr_read_b32 v26, a128
v_accvgpr_read_b32 v27, a129
v_accvgpr_read_b32 v28, a130
v_accvgpr_read_b32 v29, a131
v_accvgpr_read_b32 v30, a132
v_accvgpr_read_b32 v31, a133
v_accvgpr_read_b32 v32, a134
v_accvgpr_read_b32 v33, a135
v_accvgpr_read_b32 v34, a144
v_accvgpr_read_b32 v35, a145
v_accvgpr_read_b32 v36, a146
v_accvgpr_read_b32 v37, a147
v_accvgpr_read_b32 v38, a148
v_accvgpr_read_b32 v39, a149
v_accvgpr_read_b32 v40, a150
v_accvgpr_read_b32 v41, a151
v_pk_mul_f32 v[42:43], v[26:27], s[68:69] op_sel_hi:[1,0]
v_pk_mul_f32 v[44:45], v[28:29], s[68:69] op_sel_hi:[1,0]
v_pk_mul_f32 v[46:47], v[30:31], s[68:69] op_sel_hi:[1,0]
v_pk_mul_f32 v[48:49], v[32:33], s[68:69] op_sel_hi:[1,0]
v_exp_f32 v42, v42
v_exp_f32 v43, v43
v_exp_f32 v44, v44
v_exp_f32 v45, v45
v_exp_f32 v46, v46
v_exp_f32 v47, v47
v_exp_f32 v48, v48
v_exp_f32 v49, v49
v_pk_mul_f32 v[26:27], v[26:27], v[34:35]
v_pk_mul_f32 v[28:29], v[28:29], v[36:37]
v_pk_mul_f32 v[30:31], v[30:31], v[38:39]
v_pk_mul_f32 v[32:33], v[32:33], v[40:41]
v_pk_add_f32 v[42:43], v[42:43], 1.0 op_sel_hi:[1,0]
v_pk_add_f32 v[44:45], v[44:45], 1.0 op_sel_hi:[1,0]
v_pk_add_f32 v[46:47], v[46:47], 1.0 op_sel_hi:[1,0]
v_pk_add_f32 v[48:49], v[48:49], 1.0 op_sel_hi:[1,0]
v_rcp_f32 v42, v42
v_rcp_f32 v43, v43
v_rcp_f32 v44, v44
v_rcp_f32 v45, v45
v_rcp_f32 v46, v46
v_rcp_f32 v47, v47
v_rcp_f32 v48, v48
v_rcp_f32 v49, v49
s_nop 0
v_pk_mul_f32 v[26:27], v[26:27], v[42:43]
v_pk_mul_f32 v[28:29], v[28:29], v[44:45]
v_pk_mul_f32 v[30:31], v[30:31], v[46:47]
v_pk_mul_f32 v[32:33], v[32:33], v[48:49]
v_cvt_pk_bf16_f32 v54, v26, v27
v_cvt_pk_bf16_f32 v55, v28, v29
v_cvt_pk_bf16_f32 v56, v30, v31
v_cvt_pk_bf16_f32 v57, v32, v33
buffer_store_dwordx4 v[54:57], v24, s[4:7], s66 offen offset:2048 sc1
s_add_u32 s66, s48, 462848
v_accvgpr_read_b32 v26, a136
v_accvgpr_read_b32 v27, a137
v_accvgpr_read_b32 v28, a138
v_accvgpr_read_b32 v29, a139
v_accvgpr_read_b32 v30, a140
v_accvgpr_read_b32 v31, a141
v_accvgpr_read_b32 v32, a142
v_accvgpr_read_b32 v33, a143
v_accvgpr_read_b32 v34, a152
v_accvgpr_read_b32 v35, a153
v_accvgpr_read_b32 v36, a154
v_accvgpr_read_b32 v37, a155
v_accvgpr_read_b32 v38, a156
v_accvgpr_read_b32 v39, a157
v_accvgpr_read_b32 v40, a158
v_accvgpr_read_b32 v41, a159
v_pk_mul_f32 v[42:43], v[26:27], s[68:69] op_sel_hi:[1,0]
v_pk_mul_f32 v[44:45], v[28:29], s[68:69] op_sel_hi:[1,0]
v_pk_mul_f32 v[46:47], v[30:31], s[68:69] op_sel_hi:[1,0]
v_pk_mul_f32 v[48:49], v[32:33], s[68:69] op_sel_hi:[1,0]
v_exp_f32 v42, v42
v_exp_f32 v43, v43
v_exp_f32 v44, v44
v_exp_f32 v45, v45
v_exp_f32 v46, v46
v_exp_f32 v47, v47
v_exp_f32 v48, v48
v_exp_f32 v49, v49
v_pk_mul_f32 v[26:27], v[26:27], v[34:35]
v_pk_mul_f32 v[28:29], v[28:29], v[36:37]
v_pk_mul_f32 v[30:31], v[30:31], v[38:39]
v_pk_mul_f32 v[32:33], v[32:33], v[40:41]
v_pk_add_f32 v[42:43], v[42:43], 1.0 op_sel_hi:[1,0]
v_pk_add_f32 v[44:45], v[44:45], 1.0 op_sel_hi:[1,0]
v_pk_add_f32 v[46:47], v[46:47], 1.0 op_sel_hi:[1,0]
v_pk_add_f32 v[48:49], v[48:49], 1.0 op_sel_hi:[1,0]
v_rcp_f32 v42, v42
v_rcp_f32 v43, v43
v_rcp_f32 v44, v44
v_rcp_f32 v45, v45
v_rcp_f32 v46, v46
v_rcp_f32 v47, v47
v_rcp_f32 v48, v48
v_rcp_f32 v49, v49
s_nop 0
v_pk_mul_f32 v[26:27], v[26:27], v[42:43]
v_pk_mul_f32 v[28:29], v[28:29], v[44:45]
v_pk_mul_f32 v[30:31], v[30:31], v[46:47]
v_pk_mul_f32 v[32:33], v[32:33], v[48:49]
v_cvt_pk_bf16_f32 v58, v26, v27
v_cvt_pk_bf16_f32 v59, v28, v29
v_cvt_pk_bf16_f32 v60, v30, v31
v_cvt_pk_bf16_f32 v61, v32, v33
buffer_store_dwordx4 v[58:61], v24, s[4:7], s66 offen offset:2048 sc1
s_add_u32 s66, s48, 458752
v_accvgpr_read_b32 v26, a160
v_accvgpr_read_b32 v27, a161
v_accvgpr_read_b32 v28, a162
v_accvgpr_read_b32 v29, a163
v_accvgpr_read_b32 v30, a164
v_accvgpr_read_b32 v31, a165
v_accvgpr_read_b32 v32, a166
v_accvgpr_read_b32 v33, a167
v_accvgpr_read_b32 v34, a176
v_accvgpr_read_b32 v35, a177
v_accvgpr_read_b32 v36, a178
v_accvgpr_read_b32 v37, a179
v_accvgpr_read_b32 v38, a180
v_accvgpr_read_b32 v39, a181
v_accvgpr_read_b32 v40, a182
v_accvgpr_read_b32 v41, a183
v_pk_mul_f32 v[42:43], v[26:27], s[68:69] op_sel_hi:[1,0]
v_pk_mul_f32 v[44:45], v[28:29], s[68:69] op_sel_hi:[1,0]
v_pk_mul_f32 v[46:47], v[30:31], s[68:69] op_sel_hi:[1,0]
v_pk_mul_f32 v[48:49], v[32:33], s[68:69] op_sel_hi:[1,0]
v_exp_f32 v42, v42
v_exp_f32 v43, v43
v_exp_f32 v44, v44
v_exp_f32 v45, v45
v_exp_f32 v46, v46
v_exp_f32 v47, v47
v_exp_f32 v48, v48
v_exp_f32 v49, v49
v_pk_mul_f32 v[26:27], v[26:27], v[34:35]
v_pk_mul_f32 v[28:29], v[28:29], v[36:37]
v_pk_mul_f32 v[30:31], v[30:31], v[38:39]
v_pk_mul_f32 v[32:33], v[32:33], v[40:41]
v_pk_add_f32 v[42:43], v[42:43], 1.0 op_sel_hi:[1,0]
v_pk_add_f32 v[44:45], v[44:45], 1.0 op_sel_hi:[1,0]
v_pk_add_f32 v[46:47], v[46:47], 1.0 op_sel_hi:[1,0]
v_pk_add_f32 v[48:49], v[48:49], 1.0 op_sel_hi:[1,0]
v_rcp_f32 v42, v42
v_rcp_f32 v43, v43
v_rcp_f32 v44, v44
v_rcp_f32 v45, v45
v_rcp_f32 v46, v46
v_rcp_f32 v47, v47
v_rcp_f32 v48, v48
v_rcp_f32 v49, v49
s_nop 0
v_pk_mul_f32 v[26:27], v[26:27], v[42:43]
v_pk_mul_f32 v[28:29], v[28:29], v[44:45]
v_pk_mul_f32 v[30:31], v[30:31], v[46:47]
v_pk_mul_f32 v[32:33], v[32:33], v[48:49]
v_cvt_pk_bf16_f32 v50, v26, v27
v_cvt_pk_bf16_f32 v51, v28, v29
v_cvt_pk_bf16_f32 v52, v30, v31
v_cvt_pk_bf16_f32 v53, v32, v33
buffer_store_dwordx4 v[50:53], v24, s[4:7], s66 offen offset:3072 sc1
s_add_u32 s66, s48, 462848
v_accvgpr_read_b32 v26, a168
v_accvgpr_read_b32 v27, a169
v_accvgpr_read_b32 v28, a170
v_accvgpr_read_b32 v29, a171
v_accvgpr_read_b32 v30, a172
v_accvgpr_read_b32 v31, a173
v_accvgpr_read_b32 v32, a174
v_accvgpr_read_b32 v33, a175
v_accvgpr_read_b32 v34, a184
v_accvgpr_read_b32 v35, a185
v_accvgpr_read_b32 v36, a186
v_accvgpr_read_b32 v37, a187
v_accvgpr_read_b32 v38, a188
v_accvgpr_read_b32 v39, a189
v_accvgpr_read_b32 v40, a190
v_accvgpr_read_b32 v41, a191
v_pk_mul_f32 v[42:43], v[26:27], s[68:69] op_sel_hi:[1,0]
v_pk_mul_f32 v[44:45], v[28:29], s[68:69] op_sel_hi:[1,0]
v_pk_mul_f32 v[46:47], v[30:31], s[68:69] op_sel_hi:[1,0]
v_pk_mul_f32 v[48:49], v[32:33], s[68:69] op_sel_hi:[1,0]
v_exp_f32 v42, v42
v_exp_f32 v43, v43
v_exp_f32 v44, v44
v_exp_f32 v45, v45
v_exp_f32 v46, v46
v_exp_f32 v47, v47
v_exp_f32 v48, v48
v_exp_f32 v49, v49
v_pk_mul_f32 v[26:27], v[26:27], v[34:35]
v_pk_mul_f32 v[28:29], v[28:29], v[36:37]
v_pk_mul_f32 v[30:31], v[30:31], v[38:39]
v_pk_mul_f32 v[32:33], v[32:33], v[40:41]
v_pk_add_f32 v[42:43], v[42:43], 1.0 op_sel_hi:[1,0]
v_pk_add_f32 v[44:45], v[44:45], 1.0 op_sel_hi:[1,0]
v_pk_add_f32 v[46:47], v[46:47], 1.0 op_sel_hi:[1,0]
v_pk_add_f32 v[48:49], v[48:49], 1.0 op_sel_hi:[1,0]
v_rcp_f32 v42, v42
v_rcp_f32 v43, v43
v_rcp_f32 v44, v44
v_rcp_f32 v45, v45
v_rcp_f32 v46, v46
v_rcp_f32 v47, v47
v_rcp_f32 v48, v48
v_rcp_f32 v49, v49
s_nop 0
v_pk_mul_f32 v[26:27], v[26:27], v[42:43]
v_pk_mul_f32 v[28:29], v[28:29], v[44:45]
v_pk_mul_f32 v[30:31], v[30:31], v[46:47]
v_pk_mul_f32 v[32:33], v[32:33], v[48:49]
v_cvt_pk_bf16_f32 v54, v26, v27
v_cvt_pk_bf16_f32 v55, v28, v29
v_cvt_pk_bf16_f32 v56, v30, v31
v_cvt_pk_bf16_f32 v57, v32, v33
buffer_store_dwordx4 v[54:57], v24, s[4:7], s66 offen offset:3072 sc1
Lend_562:
s_endpgm
.globl down_kernel
.p2align 8
.type down_kernel,@function
down_kernel:
s_cmp_ge_u32 s2, 128
s_cbranch_scc1 Lend_564
s_load_dwordx2 s[16:17], s[0:1], 80
s_load_dwordx2 s[18:19], s[0:1], 104
s_load_dwordx2 s[30:31], s[0:1], 120
v_lshrrev_b32 v1, 6, v0
s_nop 0
v_readfirstlane_b32 s32, v1
v_and_b32 v1, 63, v0
s_waitcnt lgkmcnt(0)
s_mov_b32 s4, s30
s_and_b32 s5, s31, 0xffff
s_mov_b32 s6, 0x10000000
s_mov_b32 s7, 0x20000
s_mov_b32 s12, s18
s_and_b32 s13, s19, 0xffff
s_mov_b32 s14, 0x400000
s_mov_b32 s15, 0x20000
s_and_b32 s40, s2, 7
s_lshr_b32 s41, s2, 3
s_lshr_b32 s42, s40, 1
s_lshl_b32 s42, s42, 2
s_and_b32 s43, s41, 3
s_add_u32 s42, s42, s43
s_and_b32 s40, s40, 1
s_lshl_b32 s40, s40, 2
s_lshr_b32 s41, s41, 2
s_add_u32 s41, s41, s40
s_mov_b32 s8, s16
s_and_b32 s9, s17, 0xffff
s_mov_b32 s10, 0x700000
s_mov_b32 s11, 0x20000
v_lshlrev_b32 v2, 4, v1
v_lshrrev_b32 v20, 4, v1
v_and_b32 v21, 15, v1
s_mov_b32 s66, 2048
v_lshlrev_b32 v22, 2, v20
v_or_b32 v22, 0, v22
v_xor_b32 v22, v22, v21
v_lshlrev_b32 v22, 4, v22
v_mad_u32_u24 v22, v20, s66, v22
v_add_u32 v4, 0, v22
v_lshlrev_b32 v22, 2, v20
v_or_b32 v22, 2, v22
v_xor_b32 v22, v22, v21
v_lshlrev_b32 v22, 4, v22
v_mad_u32_u24 v22, v20, s66, v22
v_add_u32 v5, 7168, v22
v_lshlrev_b32 v22, 2, v20
v_or_b32 v22, 0, v22
v_xor_b32 v22, v22, v21
v_lshlrev_b32 v22, 4, v22
v_mad_u32_u24 v22, v20, s66, v22
v_add_u32 v6, 14336, v22
v_lshlrev_b32 v22, 2, v20
v_or_b32 v22, 2, v22
v_xor_b32 v22, v22, v21
v_lshlrev_b32 v22, 4, v22
v_mad_u32_u24 v22, v20, s66, v22
v_add_u32 v7, 21504, v22
s_mul_i32 s63, s32, 4096
s_add_u32 s63, s63, 65536
s_mul_i32 s64, s32, 4096
s_mov_b32 s65, 131072
s_lshr_b32 s66, s32, 1
s_mul_i32 s66, s66, 8192
s_add_u32 s66, s66, 65536
v_add_u32 v8, s66, v2
v_bfe_u32 v20, v1, 2, 2
v_lshrrev_b32 v21, 4, v1
v_lshl_add_u32 v22, v21, 2, v20
v_lshlrev_b32 v22, 8, v22
v_and_b32 v23, 3, v1
v_lshl_add_u32 v22, v23, 3, v22
v_and_b32 v21, 1, v21
v_lshl_add_u32 v20, v20, 1, v21
s_and_b32 s66, s32, 1
s_lshl_b32 s66, s66, 2
v_xor_b32 v20, s66, v20
v_xor_b32 v21, 0, v20
v_lshl_add_u32 v10, v21, 5, v22
v_xor_b32 v21, 1, v20
v_lshl_add_u32 v11, v21, 5, v22
v_xor_b32 v21, 2, v20
v_lshl_add_u32 v12, v21, 5, v22
v_xor_b32 v21, 3, v20
v_lshl_add_u32 v13, v21, 5, v22
s_mul_i32 s60, s42, 917504
s_add_u32 s60, s60, 100663296
s_lshl_b32 s61, s41, 8
s_lshr_b32 s66, s32, 0
s_and_b32 s67, s66, 1
s_lshl_b32 s67, s67, 12
s_add_u32 s60, s60, s67
s_lshr_b32 s66, s66, 1
s_mul_i32 s66, s66, 458752
s_add_u32 s60, s60, s66
s_and_b32 s66, s32, 3
s_mul_i32 s66, s66, 32768
s_add_u32 s61, s61, s66
s_add_u32 m0, s63, 0
s_nop 0
buffer_load_dwordx4 v2, s[4:7], s60 offen offset:0 sc1 lds
buffer_load_dwordx4 v2, s[4:7], s60 offen offset:1024 sc1 lds
buffer_load_dwordx4 v2, s[4:7], s60 offen offset:2048 sc1 lds
buffer_load_dwordx4 v2, s[4:7], s60 offen offset:3072 sc1 lds
s_add_u32 s60, s60, 8192
s_add_u32 m0, s64, 0
s_nop 0
buffer_load_dwordx4 v4, s[8:11], s61 offen offset:0 lds
buffer_load_dwordx4 v5, s[8:11], s61 offen offset:1024 lds
buffer_load_dwordx4 v6, s[8:11], s61 offen offset:2048 lds
buffer_load_dwordx4 v7, s[8:11], s61 offen offset:3072 lds
s_add_u32 s61, s61, s65
s_add_u32 m0, s63, 16384
s_nop 0
buffer_load_dwordx4 v2, s[4:7], s60 offen offset:0 sc1 lds
buffer_load_dwordx4 v2, s[4:7], s60 offen offset:1024 sc1 lds
buffer_load_dwordx4 v2, s[4:7], s60 offen offset:2048 sc1 lds
buffer_load_dwordx4 v2, s[4:7], s60 offen offset:3072 sc1 lds
s_add_u32 s60, s60, 8192
s_add_u32 m0, s64, 16384
s_nop 0
buffer_load_dwordx4 v4, s[8:11], s61 offen offset:0 lds
buffer_load_dwordx4 v5, s[8:11], s61 offen offset:1024 lds
buffer_load_dwordx4 v6, s[8:11], s61 offen offset:2048 lds
buffer_load_dwordx4 v7, s[8:11], s61 offen offset:3072 lds
s_add_u32 s61, s61, s65
s_add_u32 m0, s63, 32768
s_nop 0
buffer_load_dwordx4 v2, s[4:7], s60 offen offset:0 sc1 lds
buffer_load_dwordx4 v2, s[4:7], s60 offen offset:1024 sc1 lds
buffer_load_dwordx4 v2, s[4:7], s60 offen offset:2048 sc1 lds
buffer_load_dwordx4 v2, s[4:7], s60 offen offset:3072 sc1 lds
s_add_u32 s60, s60, 8192
s_add_u32 m0, s64, 32768
s_nop 0
buffer_load_dwordx4 v4, s[8:11], s61 offen offset:0 lds
buffer_load_dwordx4 v5, s[8:11], s61 offen offset:1024 lds
buffer_load_dwordx4 v6, s[8:11], s61 offen offset:2048 lds
buffer_load_dwordx4 v7, s[8:11], s61 offen offset:3072 lds
s_add_u32 s61, s61, s65
s_add_u32 m0, s63, 49152
s_nop 0
buffer_load_dwordx4 v2, s[4:7], s60 offen offset:0 sc1 lds
buffer_load_dwordx4 v2, s[4:7], s60 offen offset:1024 sc1 lds
buffer_load_dwordx4 v2, s[4:7], s60 offen offset:2048 sc1 lds
buffer_load_dwordx4 v2, s[4:7], s60 offen offset:3072 sc1 lds
s_add_u32 s60, s60, 8192
s_add_u32 m0, s64, 49152
s_nop 0
buffer_load_dwordx4 v4, s[8:11], s61 offen offset:0 lds
buffer_load_dwordx4 v5, s[8:11], s61 offen offset:1024 lds
buffer_load_dwordx4 v6, s[8:11], s61 offen offset:2048 lds
buffer_load_dwordx4 v7, s[8:11], s61 offen offset:3072 lds
s_add_u32 s61, s61, s65
s_lshr_b32 s46, s32, 1
s_lshl_b32 s47, s42, 1
s_add_u32 s46, s46, s47
s_and_b32 s47, s32, 1
s_lshl_b32 s48, s41, 1
s_add_u32 s47, s47, s48
s_lshl_b32 s48, s46, 17
s_lshl_b32 s49, s47, 13
s_add_u32 s49, s49, s48
s_lshl_b32 s50, s47, 7
s_add_u32 s50, s50, s48
s_add_u32 s49, s49, 12582912
s_lshl_b32 s51, s47, 8
s_add_u32 s51, s51, 3166208
s_waitcnt vmcnt(24)
s_barrier
ds_read_b128 a[0:3], v8 offset:0
ds_read_b64_tr_b16 a[32:33], v10 offset:0
ds_read_b64_tr_b16 a[34:35], v10 offset:4096
ds_read_b128 a[4:7], v8 offset:1024
ds_read_b64_tr_b16 a[36:37], v11 offset:0
ds_read_b64_tr_b16 a[38:39], v11 offset:4096
ds_read_b128 a[8:11], v8 offset:2048
ds_read_b64_tr_b16 a[40:41], v12 offset:0
ds_read_b64_tr_b16 a[42:43], v12 offset:4096
ds_read_b128 a[12:15], v8 offset:3072
ds_read_b64_tr_b16 a[44:45], v13 offset:0
ds_read_b64_tr_b16 a[46:47], v13 offset:4096
ds_read_b128 a[16:19], v8 offset:4096
ds_read_b64_tr_b16 a[48:49], v10 offset:8192
ds_read_b64_tr_b16 a[50:51], v10 offset:12288
ds_read_b128 a[20:23], v8 offset:5120
ds_read_b64_tr_b16 a[52:53], v11 offset:8192
ds_read_b64_tr_b16 a[54:55], v11 offset:12288
ds_read_b128 a[24:27], v8 offset:6144
ds_read_b64_tr_b16 a[56:57], v12 offset:8192
ds_read_b64_tr_b16 a[58:59], v12 offset:12288
ds_read_b128 a[28:31], v8 offset:7168
ds_read_b64_tr_b16 a[60:61], v13 offset:8192
ds_read_b64_tr_b16 a[62:63], v13 offset:12288
s_waitcnt vmcnt(16) lgkmcnt(0)
s_barrier
v_mfma_f32_16x16x32_bf16 v[64:67], a[32:35], a[0:3], 0
ds_read_b128 a[64:67], v8 offset:16384
v_mfma_f32_16x16x32_bf16 v[80:83], a[32:35], a[4:7], 0
ds_read_b64_tr_b16 a[96:97], v10 offset:16384
v_mfma_f32_16x16x32_bf16 v[96:99], a[32:35], a[8:11], 0
ds_read_b64_tr_b16 a[98:99], v10 offset:20480
s_add_u32 m0, s63, 0
s_nop 0
buffer_load_dwordx4 v2, s[4:7], s60 offen offset:0 sc1 lds
v_mfma_f32_16x16x32_bf16 v[112:115], a[32:35], a[12:15], 0
ds_read_b128 a[68:71], v8 offset:17408
v_mfma_f32_16x16x32_bf16 v[116:119], a[36:39], a[12:15], 0
ds_read_b64_tr_b16 a[100:101], v11 offset:16384
v_mfma_f32_16x16x32_bf16 v[100:103], a[36:39], a[8:11], 0
ds_read_b64_tr_b16 a[102:103], v11 offset:20480
v_mfma_f32_16x16x32_bf16 v[84:87], a[36:39], a[4:7], 0
ds_read_b128 a[72:75], v8 offset:18432
buffer_load_dwordx4 v2, s[4:7], s60 offen offset:1024 sc1 lds
v_mfma_f32_16x16x32_bf16 v[68:71], a[36:39], a[0:3], 0
ds_read_b64_tr_b16 a[104:105], v12 offset:16384
v_mfma_f32_16x16x32_bf16 v[72:75], a[40:43], a[0:3], 0
ds_read_b64_tr_b16 a[106:107], v12 offset:20480
v_mfma_f32_16x16x32_bf16 v[88:91], a[40:43], a[4:7], 0
ds_read_b128 a[76:79], v8 offset:19456
v_mfma_f32_16x16x32_bf16 v[104:107], a[40:43], a[8:11], 0
ds_read_b64_tr_b16 a[108:109], v13 offset:16384
buffer_load_dwordx4 v2, s[4:7], s60 offen offset:2048 sc1 lds
v_mfma_f32_16x16x32_bf16 v[120:123], a[40:43], a[12:15], 0
ds_read_b64_tr_b16 a[110:111], v13 offset:20480
v_mfma_f32_16x16x32_bf16 v[124:127], a[44:47], a[12:15], 0
ds_read_b128 a[80:83], v8 offset:20480
v_mfma_f32_16x16x32_bf16 v[108:111], a[44:47], a[8:11], 0
ds_read_b64_tr_b16 a[112:113], v10 offset:24576
v_mfma_f32_16x16x32_bf16 v[92:95], a[44:47], a[4:7], 0
ds_read_b64_tr_b16 a[114:115], v10 offset:28672
buffer_load_dwordx4 v2, s[4:7], s60 offen offset:3072 sc1 lds
s_add_u32 s60, s60, 8192
v_mfma_f32_16x16x32_bf16 v[76:79], a[44:47], a[0:3], 0
ds_read_b128 a[84:87], v8 offset:21504
v_mfma_f32_16x16x32_bf16 v[64:67], a[48:51], a[16:19], v[64:67]
ds_read_b64_tr_b16 a[116:117], v11 offset:24576
v_mfma_f32_16x16x32_bf16 v[80:83], a[48:51], a[20:23], v[80:83]
ds_read_b64_tr_b16 a[118:119], v11 offset:28672
v_mfma_f32_16x16x32_bf16 v[96:99], a[48:51], a[24:27], v[96:99]
ds_read_b128 a[88:91], v8 offset:22528
s_add_u32 m0, s64, 0
s_nop 0
buffer_load_dwordx4 v4, s[8:11], s61 offen offset:0 lds
v_mfma_f32_16x16x32_bf16 v[112:115], a[48:51], a[28:31], v[112:115]
ds_read_b64_tr_b16 a[120:121], v12 offset:24576
v_mfma_f32_16x16x32_bf16 v[116:119], a[52:55], a[28:31], v[116:119]
ds_read_b64_tr_b16 a[122:123], v12 offset:28672
v_mfma_f32_16x16x32_bf16 v[100:103], a[52:55], a[24:27], v[100:103]
ds_read_b128 a[92:95], v8 offset:23552
v_mfma_f32_16x16x32_bf16 v[84:87], a[52:55], a[20:23], v[84:87]
ds_read_b64_tr_b16 a[124:125], v13 offset:24576
buffer_load_dwordx4 v5, s[8:11], s61 offen offset:1024 lds
v_mfma_f32_16x16x32_bf16 v[68:71], a[52:55], a[16:19], v[68:71]
ds_read_b64_tr_b16 a[126:127], v13 offset:28672
v_mfma_f32_16x16x32_bf16 v[72:75], a[56:59], a[16:19], v[72:75]
v_mfma_f32_16x16x32_bf16 v[88:91], a[56:59], a[20:23], v[88:91]
v_mfma_f32_16x16x32_bf16 v[104:107], a[56:59], a[24:27], v[104:107]
buffer_load_dwordx4 v6, s[8:11], s61 offen offset:2048 lds
v_mfma_f32_16x16x32_bf16 v[120:123], a[56:59], a[28:31], v[120:123]
v_mfma_f32_16x16x32_bf16 v[124:127], a[60:63], a[28:31], v[124:127]
v_mfma_f32_16x16x32_bf16 v[108:111], a[60:63], a[24:27], v[108:111]
v_mfma_f32_16x16x32_bf16 v[92:95], a[60:63], a[20:23], v[92:95]
buffer_load_dwordx4 v7, s[8:11], s61 offen offset:3072 lds
s_add_u32 s61, s61, s65
v_mfma_f32_16x16x32_bf16 v[76:79], a[60:63], a[16:19], v[76:79]
s_waitcnt vmcnt(16) lgkmcnt(0)
s_barrier
v_mfma_f32_16x16x32_bf16 v[64:67], a[96:99], a[64:67], v[64:67]
ds_read_b128 a[0:3], v8 offset:32768
v_mfma_f32_16x16x32_bf16 v[80:83], a[96:99], a[68:71], v[80:83]
ds_read_b64_tr_b16 a[32:33], v10 offset:32768
v_mfma_f32_16x16x32_bf16 v[96:99], a[96:99], a[72:75], v[96:99]
ds_read_b64_tr_b16 a[34:35], v10 offset:36864
s_add_u32 m0, s63, 16384
s_nop 0
buffer_load_dwordx4 v2, s[4:7], s60 offen offset:0 sc1 lds
v_mfma_f32_16x16x32_bf16 v[112:115], a[96:99], a[76:79], v[112:115]
ds_read_b128 a[4:7], v8 offset:33792
v_mfma_f32_16x16x32_bf16 v[116:119], a[100:103], a[76:79], v[116:119]
ds_read_b64_tr_b16 a[36:37], v11 offset:32768
v_mfma_f32_16x16x32_bf16 v[100:103], a[100:103], a[72:75], v[100:103]
ds_read_b64_tr_b16 a[38:39], v11 offset:36864
v_mfma_f32_16x16x32_bf16 v[84:87], a[100:103], a[68:71], v[84:87]
ds_read_b128 a[8:11], v8 offset:34816
buffer_load_dwordx4 v2, s[4:7], s60 offen offset:1024 sc1 lds
v_mfma_f32_16x16x32_bf16 v[68:71], a[100:103], a[64:67], v[68:71]
ds_read_b64_tr_b16 a[40:41], v12 offset:32768
v_mfma_f32_16x16x32_bf16 v[72:75], a[104:107], a[64:67], v[72:75]
ds_read_b64_tr_b16 a[42:43], v12 offset:36864
v_mfma_f32_16x16x32_bf16 v[88:91], a[104:107], a[68:71], v[88:91]
ds_read_b128 a[12:15], v8 offset:35840
v_mfma_f32_16x16x32_bf16 v[104:107], a[104:107], a[72:75], v[104:107]
ds_read_b64_tr_b16 a[44:45], v13 offset:32768
buffer_load_dwordx4 v2, s[4:7], s60 offen offset:2048 sc1 lds
v_mfma_f32_16x16x32_bf16 v[120:123], a[104:107], a[76:79], v[120:123]
ds_read_b64_tr_b16 a[46:47], v13 offset:36864
v_mfma_f32_16x16x32_bf16 v[124:127], a[108:111], a[76:79], v[124:127]
ds_read_b128 a[16:19], v8 offset:36864
v_mfma_f32_16x16x32_bf16 v[108:111], a[108:111], a[72:75], v[108:111]
ds_read_b64_tr_b16 a[48:49], v10 offset:40960
v_mfma_f32_16x16x32_bf16 v[92:95], a[108:111], a[68:71], v[92:95]
ds_read_b64_tr_b16 a[50:51], v10 offset:45056
buffer_load_dwordx4 v2, s[4:7], s60 offen offset:3072 sc1 lds
s_add_u32 s60, s60, 8192
v_mfma_f32_16x16x32_bf16 v[76:79], a[108:111], a[64:67], v[76:79]
ds_read_b128 a[20:23], v8 offset:37888
v_mfma_f32_16x16x32_bf16 v[64:67], a[112:115], a[80:83], v[64:67]
ds_read_b64_tr_b16 a[52:53], v11 offset:40960
v_mfma_f32_16x16x32_bf16 v[80:83], a[112:115], a[84:87], v[80:83]
ds_read_b64_tr_b16 a[54:55], v11 offset:45056
v_mfma_f32_16x16x32_bf16 v[96:99], a[112:115], a[88:91], v[96:99]
ds_read_b128 a[24:27], v8 offset:38912
s_add_u32 m0, s64, 16384
s_nop 0
buffer_load_dwordx4 v4, s[8:11], s61 offen offset:0 lds
v_mfma_f32_16x16x32_bf16 v[112:115], a[112:115], a[92:95], v[112:115]
ds_read_b64_tr_b16 a[56:57], v12 offset:40960
v_mfma_f32_16x16x32_bf16 v[116:119], a[116:119], a[92:95], v[116:119]
ds_read_b64_tr_b16 a[58:59], v12 offset:45056
v_mfma_f32_16x16x32_bf16 v[100:103], a[116:119], a[88:91], v[100:103]
ds_read_b128 a[28:31], v8 offset:39936
v_mfma_f32_16x16x32_bf16 v[84:87], a[116:119], a[84:87], v[84:87]
ds_read_b64_tr_b16 a[60:61], v13 offset:40960
buffer_load_dwordx4 v5, s[8:11], s61 offen offset:1024 lds
v_mfma_f32_16x16x32_bf16 v[68:71], a[116:119], a[80:83], v[68:71]
ds_read_b64_tr_b16 a[62:63], v13 offset:45056
v_mfma_f32_16x16x32_bf16 v[72:75], a[120:123], a[80:83], v[72:75]
v_mfma_f32_16x16x32_bf16 v[88:91], a[120:123], a[84:87], v[88:91]
v_mfma_f32_16x16x32_bf16 v[104:107], a[120:123], a[88:91], v[104:107]
buffer_load_dwordx4 v6, s[8:11], s61 offen offset:2048 lds
v_mfma_f32_16x16x32_bf16 v[120:123], a[120:123], a[92:95], v[120:123]
v_mfma_f32_16x16x32_bf16 v[124:127], a[124:127], a[92:95], v[124:127]
v_mfma_f32_16x16x32_bf16 v[108:111], a[124:127], a[88:91], v[108:111]
v_mfma_f32_16x16x32_bf16 v[92:95], a[124:127], a[84:87], v[92:95]
buffer_load_dwordx4 v7, s[8:11], s61 offen offset:3072 lds
s_add_u32 s61, s61, s65
v_mfma_f32_16x16x32_bf16 v[76:79], a[124:127], a[80:83], v[76:79]
s_waitcnt vmcnt(16) lgkmcnt(0)
s_barrier
v_mfma_f32_16x16x32_bf16 v[64:67], a[32:35], a[0:3], v[64:67]
ds_read_b128 a[64:67], v8 offset:49152
v_mfma_f32_16x16x32_bf16 v[80:83], a[32:35], a[4:7], v[80:83]
ds_read_b64_tr_b16 a[96:97], v10 offset:49152
v_mfma_f32_16x16x32_bf16 v[96:99], a[32:35], a[8:11], v[96:99]
ds_read_b64_tr_b16 a[98:99], v10 offset:53248
s_add_u32 m0, s63, 32768
s_nop 0
buffer_load_dwordx4 v2, s[4:7], s60 offen offset:0 sc1 lds
v_mfma_f32_16x16x32_bf16 v[112:115], a[32:35], a[12:15], v[112:115]
ds_read_b128 a[68:71], v8 offset:50176
v_mfma_f32_16x16x32_bf16 v[116:119], a[36:39], a[12:15], v[116:119]
ds_read_b64_tr_b16 a[100:101], v11 offset:49152
v_mfma_f32_16x16x32_bf16 v[100:103], a[36:39], a[8:11], v[100:103]
ds_read_b64_tr_b16 a[102:103], v11 offset:53248
v_mfma_f32_16x16x32_bf16 v[84:87], a[36:39], a[4:7], v[84:87]
ds_read_b128 a[72:75], v8 offset:51200
buffer_load_dwordx4 v2, s[4:7], s60 offen offset:1024 sc1 lds
v_mfma_f32_16x16x32_bf16 v[68:71], a[36:39], a[0:3], v[68:71]
ds_read_b64_tr_b16 a[104:105], v12 offset:49152
v_mfma_f32_16x16x32_bf16 v[72:75], a[40:43], a[0:3], v[72:75]
ds_read_b64_tr_b16 a[106:107], v12 offset:53248
v_mfma_f32_16x16x32_bf16 v[88:91], a[40:43], a[4:7], v[88:91]
ds_read_b128 a[76:79], v8 offset:52224
v_mfma_f32_16x16x32_bf16 v[104:107], a[40:43], a[8:11], v[104:107]
ds_read_b64_tr_b16 a[108:109], v13 offset:49152
buffer_load_dwordx4 v2, s[4:7], s60 offen offset:2048 sc1 lds
v_mfma_f32_16x16x32_bf16 v[120:123], a[40:43], a[12:15], v[120:123]
ds_read_b64_tr_b16 a[110:111], v13 offset:53248
v_mfma_f32_16x16x32_bf16 v[124:127], a[44:47], a[12:15], v[124:127]
ds_read_b128 a[80:83], v8 offset:53248
v_mfma_f32_16x16x32_bf16 v[108:111], a[44:47], a[8:11], v[108:111]
ds_read_b64_tr_b16 a[112:113], v10 offset:57344
v_mfma_f32_16x16x32_bf16 v[92:95], a[44:47], a[4:7], v[92:95]
ds_read_b64_tr_b16 a[114:115], v10 offset:61440
buffer_load_dwordx4 v2, s[4:7], s60 offen offset:3072 sc1 lds
s_add_u32 s60, s60, 8192
v_mfma_f32_16x16x32_bf16 v[76:79], a[44:47], a[0:3], v[76:79]
ds_read_b128 a[84:87], v8 offset:54272
v_mfma_f32_16x16x32_bf16 v[64:67], a[48:51], a[16:19], v[64:67]
ds_read_b64_tr_b16 a[116:117], v11 offset:57344
v_mfma_f32_16x16x32_bf16 v[80:83], a[48:51], a[20:23], v[80:83]
ds_read_b64_tr_b16 a[118:119], v11 offset:61440
v_mfma_f32_16x16x32_bf16 v[96:99], a[48:51], a[24:27], v[96:99]
ds_read_b128 a[88:91], v8 offset:55296
s_add_u32 m0, s64, 32768
s_nop 0
buffer_load_dwordx4 v4, s[8:11], s61 offen offset:0 lds
v_mfma_f32_16x16x32_bf16 v[112:115], a[48:51], a[28:31], v[112:115]
ds_read_b64_tr_b16 a[120:121], v12 offset:57344
v_mfma_f32_16x16x32_bf16 v[116:119], a[52:55], a[28:31], v[116:119]
ds_read_b64_tr_b16 a[122:123], v12 offset:61440
v_mfma_f32_16x16x32_bf16 v[100:103], a[52:55], a[24:27], v[100:103]
ds_read_b128 a[92:95], v8 offset:56320
v_mfma_f32_16x16x32_bf16 v[84:87], a[52:55], a[20:23], v[84:87]
ds_read_b64_tr_b16 a[124:125], v13 offset:57344
buffer_load_dwordx4 v5, s[8:11], s61 offen offset:1024 lds
v_mfma_f32_16x16x32_bf16 v[68:71], a[52:55], a[16:19], v[68:71]
ds_read_b64_tr_b16 a[126:127], v13 offset:61440
v_mfma_f32_16x16x32_bf16 v[72:75], a[56:59], a[16:19], v[72:75]
v_mfma_f32_16x16x32_bf16 v[88:91], a[56:59], a[20:23], v[88:91]
v_mfma_f32_16x16x32_bf16 v[104:107], a[56:59], a[24:27], v[104:107]
buffer_load_dwordx4 v6, s[8:11], s61 offen offset:2048 lds
v_mfma_f32_16x16x32_bf16 v[120:123], a[56:59], a[28:31], v[120:123]
v_mfma_f32_16x16x32_bf16 v[124:127], a[60:63], a[28:31], v[124:127]
v_mfma_f32_16x16x32_bf16 v[108:111], a[60:63], a[24:27], v[108:111]
v_mfma_f32_16x16x32_bf16 v[92:95], a[60:63], a[20:23], v[92:95]
buffer_load_dwordx4 v7, s[8:11], s61 offen offset:3072 lds
s_add_u32 s61, s61, s65
v_mfma_f32_16x16x32_bf16 v[76:79], a[60:63], a[16:19], v[76:79]
s_waitcnt vmcnt(16) lgkmcnt(0)
s_barrier
v_mfma_f32_16x16x32_bf16 v[64:67], a[96:99], a[64:67], v[64:67]
ds_read_b128 a[0:3], v8 offset:0
v_mfma_f32_16x16x32_bf16 v[80:83], a[96:99], a[68:71], v[80:83]
ds_read_b64_tr_b16 a[32:33], v10 offset:0
v_mfma_f32_16x16x32_bf16 v[96:99], a[96:99], a[72:75], v[96:99]
ds_read_b64_tr_b16 a[34:35], v10 offset:4096
s_add_u32 m0, s63, 49152
s_nop 0
buffer_load_dwordx4 v2, s[4:7], s60 offen offset:0 sc1 lds
v_mfma_f32_16x16x32_bf16 v[112:115], a[96:99], a[76:79], v[112:115]
ds_read_b128 a[4:7], v8 offset:1024
v_mfma_f32_16x16x32_bf16 v[116:119], a[100:103], a[76:79], v[116:119]
ds_read_b64_tr_b16 a[36:37], v11 offset:0
v_mfma_f32_16x16x32_bf16 v[100:103], a[100:103], a[72:75], v[100:103]
ds_read_b64_tr_b16 a[38:39], v11 offset:4096
v_mfma_f32_16x16x32_bf16 v[84:87], a[100:103], a[68:71], v[84:87]
ds_read_b128 a[8:11], v8 offset:2048
buffer_load_dwordx4 v2, s[4:7], s60 offen offset:1024 sc1 lds
v_mfma_f32_16x16x32_bf16 v[68:71], a[100:103], a[64:67], v[68:71]
ds_read_b64_tr_b16 a[40:41], v12 offset:0
v_mfma_f32_16x16x32_bf16 v[72:75], a[104:107], a[64:67], v[72:75]
ds_read_b64_tr_b16 a[42:43], v12 offset:4096
v_mfma_f32_16x16x32_bf16 v[88:91], a[104:107], a[68:71], v[88:91]
ds_read_b128 a[12:15], v8 offset:3072
v_mfma_f32_16x16x32_bf16 v[104:107], a[104:107], a[72:75], v[104:107]
ds_read_b64_tr_b16 a[44:45], v13 offset:0
buffer_load_dwordx4 v2, s[4:7], s60 offen offset:2048 sc1 lds
v_mfma_f32_16x16x32_bf16 v[120:123], a[104:107], a[76:79], v[120:123]
ds_read_b64_tr_b16 a[46:47], v13 offset:4096
v_mfma_f32_16x16x32_bf16 v[124:127], a[108:111], a[76:79], v[124:127]
ds_read_b128 a[16:19], v8 offset:4096
v_mfma_f32_16x16x32_bf16 v[108:111], a[108:111], a[72:75], v[108:111]
ds_read_b64_tr_b16 a[48:49], v10 offset:8192
v_mfma_f32_16x16x32_bf16 v[92:95], a[108:111], a[68:71], v[92:95]
ds_read_b64_tr_b16 a[50:51], v10 offset:12288
buffer_load_dwordx4 v2, s[4:7], s60 offen offset:3072 sc1 lds
s_add_u32 s60, s60, 8192
v_mfma_f32_16x16x32_bf16 v[76:79], a[108:111], a[64:67], v[76:79]
ds_read_b128 a[20:23], v8 offset:5120
v_mfma_f32_16x16x32_bf16 v[64:67], a[112:115], a[80:83], v[64:67]
ds_read_b64_tr_b16 a[52:53], v11 offset:8192
v_mfma_f32_16x16x32_bf16 v[80:83], a[112:115], a[84:87], v[80:83]
ds_read_b64_tr_b16 a[54:55], v11 offset:12288
v_mfma_f32_16x16x32_bf16 v[96:99], a[112:115], a[88:91], v[96:99]
ds_read_b128 a[24:27], v8 offset:6144
s_add_u32 m0, s64, 49152
s_nop 0
buffer_load_dwordx4 v4, s[8:11], s61 offen offset:0 lds
v_mfma_f32_16x16x32_bf16 v[112:115], a[112:115], a[92:95], v[112:115]
ds_read_b64_tr_b16 a[56:57], v12 offset:8192
v_mfma_f32_16x16x32_bf16 v[116:119], a[116:119], a[92:95], v[116:119]
ds_read_b64_tr_b16 a[58:59], v12 offset:12288
v_mfma_f32_16x16x32_bf16 v[100:103], a[116:119], a[88:91], v[100:103]
ds_read_b128 a[28:31], v8 offset:7168
v_mfma_f32_16x16x32_bf16 v[84:87], a[116:119], a[84:87], v[84:87]
ds_read_b64_tr_b16 a[60:61], v13 offset:8192
buffer_load_dwordx4 v5, s[8:11], s61 offen offset:1024 lds
v_mfma_f32_16x16x32_bf16 v[68:71], a[116:119], a[80:83], v[68:71]
ds_read_b64_tr_b16 a[62:63], v13 offset:12288
v_mfma_f32_16x16x32_bf16 v[72:75], a[120:123], a[80:83], v[72:75]
v_mfma_f32_16x16x32_bf16 v[88:91], a[120:123], a[84:87], v[88:91]
v_mfma_f32_16x16x32_bf16 v[104:107], a[120:123], a[88:91], v[104:107]
buffer_load_dwordx4 v6, s[8:11], s61 offen offset:2048 lds
v_mfma_f32_16x16x32_bf16 v[120:123], a[120:123], a[92:95], v[120:123]
v_mfma_f32_16x16x32_bf16 v[124:127], a[124:127], a[92:95], v[124:127]
v_mfma_f32_16x16x32_bf16 v[108:111], a[124:127], a[88:91], v[108:111]
v_mfma_f32_16x16x32_bf16 v[92:95], a[124:127], a[84:87], v[92:95]
buffer_load_dwordx4 v7, s[8:11], s61 offen offset:3072 lds
s_add_u32 s61, s61, s65
v_mfma_f32_16x16x32_bf16 v[76:79], a[124:127], a[80:83], v[76:79]
s_mov_b32 s62, 12
Lgl_565:
s_waitcnt vmcnt(16) lgkmcnt(0)
s_barrier
v_mfma_f32_16x16x32_bf16 v[64:67], a[32:35], a[0:3], v[64:67]
ds_read_b128 a[64:67], v8 offset:16384
v_mfma_f32_16x16x32_bf16 v[80:83], a[32:35], a[4:7], v[80:83]
ds_read_b64_tr_b16 a[96:97], v10 offset:16384
v_mfma_f32_16x16x32_bf16 v[96:99], a[32:35], a[8:11], v[96:99]
ds_read_b64_tr_b16 a[98:99], v10 offset:20480
s_add_u32 m0, s63, 0
s_nop 0
buffer_load_dwordx4 v2, s[4:7], s60 offen offset:0 sc1 lds
v_mfma_f32_16x16x32_bf16 v[112:115], a[32:35], a[12:15], v[112:115]
ds_read_b128 a[68:71], v8 offset:17408
v_mfma_f32_16x16x32_bf16 v[116:119], a[36:39], a[12:15], v[116:119]
ds_read_b64_tr_b16 a[100:101], v11 offset:16384
v_mfma_f32_16x16x32_bf16 v[100:103], a[36:39], a[8:11], v[100:103]
ds_read_b64_tr_b16 a[102:103], v11 offset:20480
v_mfma_f32_16x16x32_bf16 v[84:87], a[36:39], a[4:7], v[84:87]
ds_read_b128 a[72:75], v8 offset:18432
buffer_load_dwordx4 v2, s[4:7], s60 offen offset:1024 sc1 lds
v_mfma_f32_16x16x32_bf16 v[68:71], a[36:39], a[0:3], v[68:71]
ds_read_b64_tr_b16 a[104:105], v12 offset:16384
v_mfma_f32_16x16x32_bf16 v[72:75], a[40:43], a[0:3], v[72:75]
ds_read_b64_tr_b16 a[106:107], v12 offset:20480
v_mfma_f32_16x16x32_bf16 v[88:91], a[40:43], a[4:7], v[88:91]
ds_read_b128 a[76:79], v8 offset:19456
v_mfma_f32_16x16x32_bf16 v[104:107], a[40:43], a[8:11], v[104:107]
ds_read_b64_tr_b16 a[108:109], v13 offset:16384
buffer_load_dwordx4 v2, s[4:7], s60 offen offset:2048 sc1 lds
v_mfma_f32_16x16x32_bf16 v[120:123], a[40:43], a[12:15], v[120:123]
ds_read_b64_tr_b16 a[110:111], v13 offset:20480
v_mfma_f32_16x16x32_bf16 v[124:127], a[44:47], a[12:15], v[124:127]
ds_read_b128 a[80:83], v8 offset:20480
v_mfma_f32_16x16x32_bf16 v[108:111], a[44:47], a[8:11], v[108:111]
ds_read_b64_tr_b16 a[112:113], v10 offset:24576
v_mfma_f32_16x16x32_bf16 v[92:95], a[44:47], a[4:7], v[92:95]
ds_read_b64_tr_b16 a[114:115], v10 offset:28672
buffer_load_dwordx4 v2, s[4:7], s60 offen offset:3072 sc1 lds
s_add_u32 s60, s60, 8192
v_mfma_f32_16x16x32_bf16 v[76:79], a[44:47], a[0:3], v[76:79]
ds_read_b128 a[84:87], v8 offset:21504
v_mfma_f32_16x16x32_bf16 v[64:67], a[48:51], a[16:19], v[64:67]
ds_read_b64_tr_b16 a[116:117], v11 offset:24576
v_mfma_f32_16x16x32_bf16 v[80:83], a[48:51], a[20:23], v[80:83]
ds_read_b64_tr_b16 a[118:119], v11 offset:28672
v_mfma_f32_16x16x32_bf16 v[96:99], a[48:51], a[24:27], v[96:99]
ds_read_b128 a[88:91], v8 offset:22528
s_add_u32 m0, s64, 0
s_nop 0
buffer_load_dwordx4 v4, s[8:11], s61 offen offset:0 lds
v_mfma_f32_16x16x32_bf16 v[112:115], a[48:51], a[28:31], v[112:115]
ds_read_b64_tr_b16 a[120:121], v12 offset:24576
v_mfma_f32_16x16x32_bf16 v[116:119], a[52:55], a[28:31], v[116:119]
ds_read_b64_tr_b16 a[122:123], v12 offset:28672
v_mfma_f32_16x16x32_bf16 v[100:103], a[52:55], a[24:27], v[100:103]
ds_read_b128 a[92:95], v8 offset:23552
v_mfma_f32_16x16x32_bf16 v[84:87], a[52:55], a[20:23], v[84:87]
ds_read_b64_tr_b16 a[124:125], v13 offset:24576
buffer_load_dwordx4 v5, s[8:11], s61 offen offset:1024 lds
v_mfma_f32_16x16x32_bf16 v[68:71], a[52:55], a[16:19], v[68:71]
ds_read_b64_tr_b16 a[126:127], v13 offset:28672
v_mfma_f32_16x16x32_bf16 v[72:75], a[56:59], a[16:19], v[72:75]
v_mfma_f32_16x16x32_bf16 v[88:91], a[56:59], a[20:23], v[88:91]
v_mfma_f32_16x16x32_bf16 v[104:107], a[56:59], a[24:27], v[104:107]
buffer_load_dwordx4 v6, s[8:11], s61 offen offset:2048 lds
v_mfma_f32_16x16x32_bf16 v[120:123], a[56:59], a[28:31], v[120:123]
v_mfma_f32_16x16x32_bf16 v[124:127], a[60:63], a[28:31], v[124:127]
v_mfma_f32_16x16x32_bf16 v[108:111], a[60:63], a[24:27], v[108:111]
v_mfma_f32_16x16x32_bf16 v[92:95], a[60:63], a[20:23], v[92:95]
buffer_load_dwordx4 v7, s[8:11], s61 offen offset:3072 lds
s_add_u32 s61, s61, s65
v_mfma_f32_16x16x32_bf16 v[76:79], a[60:63], a[16:19], v[76:79]
s_waitcnt vmcnt(16) lgkmcnt(0)
s_barrier
v_mfma_f32_16x16x32_bf16 v[64:67], a[96:99], a[64:67], v[64:67]
ds_read_b128 a[0:3], v8 offset:32768
v_mfma_f32_16x16x32_bf16 v[80:83], a[96:99], a[68:71], v[80:83]
ds_read_b64_tr_b16 a[32:33], v10 offset:32768
v_mfma_f32_16x16x32_bf16 v[96:99], a[96:99], a[72:75], v[96:99]
ds_read_b64_tr_b16 a[34:35], v10 offset:36864
s_add_u32 m0, s63, 16384
s_nop 0
buffer_load_dwordx4 v2, s[4:7], s60 offen offset:0 sc1 lds
v_mfma_f32_16x16x32_bf16 v[112:115], a[96:99], a[76:79], v[112:115]
ds_read_b128 a[4:7], v8 offset:33792
v_mfma_f32_16x16x32_bf16 v[116:119], a[100:103], a[76:79], v[116:119]
ds_read_b64_tr_b16 a[36:37], v11 offset:32768
v_mfma_f32_16x16x32_bf16 v[100:103], a[100:103], a[72:75], v[100:103]
ds_read_b64_tr_b16 a[38:39], v11 offset:36864
v_mfma_f32_16x16x32_bf16 v[84:87], a[100:103], a[68:71], v[84:87]
ds_read_b128 a[8:11], v8 offset:34816
buffer_load_dwordx4 v2, s[4:7], s60 offen offset:1024 sc1 lds
v_mfma_f32_16x16x32_bf16 v[68:71], a[100:103], a[64:67], v[68:71]
ds_read_b64_tr_b16 a[40:41], v12 offset:32768
v_mfma_f32_16x16x32_bf16 v[72:75], a[104:107], a[64:67], v[72:75]
ds_read_b64_tr_b16 a[42:43], v12 offset:36864
v_mfma_f32_16x16x32_bf16 v[88:91], a[104:107], a[68:71], v[88:91]
ds_read_b128 a[12:15], v8 offset:35840
v_mfma_f32_16x16x32_bf16 v[104:107], a[104:107], a[72:75], v[104:107]
ds_read_b64_tr_b16 a[44:45], v13 offset:32768
buffer_load_dwordx4 v2, s[4:7], s60 offen offset:2048 sc1 lds
v_mfma_f32_16x16x32_bf16 v[120:123], a[104:107], a[76:79], v[120:123]
ds_read_b64_tr_b16 a[46:47], v13 offset:36864
v_mfma_f32_16x16x32_bf16 v[124:127], a[108:111], a[76:79], v[124:127]
ds_read_b128 a[16:19], v8 offset:36864
v_mfma_f32_16x16x32_bf16 v[108:111], a[108:111], a[72:75], v[108:111]
ds_read_b64_tr_b16 a[48:49], v10 offset:40960
v_mfma_f32_16x16x32_bf16 v[92:95], a[108:111], a[68:71], v[92:95]
ds_read_b64_tr_b16 a[50:51], v10 offset:45056
buffer_load_dwordx4 v2, s[4:7], s60 offen offset:3072 sc1 lds
s_add_u32 s60, s60, 8192
v_mfma_f32_16x16x32_bf16 v[76:79], a[108:111], a[64:67], v[76:79]
ds_read_b128 a[20:23], v8 offset:37888
v_mfma_f32_16x16x32_bf16 v[64:67], a[112:115], a[80:83], v[64:67]
ds_read_b64_tr_b16 a[52:53], v11 offset:40960
v_mfma_f32_16x16x32_bf16 v[80:83], a[112:115], a[84:87], v[80:83]
ds_read_b64_tr_b16 a[54:55], v11 offset:45056
v_mfma_f32_16x16x32_bf16 v[96:99], a[112:115], a[88:91], v[96:99]
ds_read_b128 a[24:27], v8 offset:38912
s_add_u32 m0, s64, 16384
s_nop 0
buffer_load_dwordx4 v4, s[8:11], s61 offen offset:0 lds
v_mfma_f32_16x16x32_bf16 v[112:115], a[112:115], a[92:95], v[112:115]
ds_read_b64_tr_b16 a[56:57], v12 offset:40960
v_mfma_f32_16x16x32_bf16 v[116:119], a[116:119], a[92:95], v[116:119]
ds_read_b64_tr_b16 a[58:59], v12 offset:45056
v_mfma_f32_16x16x32_bf16 v[100:103], a[116:119], a[88:91], v[100:103]
ds_read_b128 a[28:31], v8 offset:39936
v_mfma_f32_16x16x32_bf16 v[84:87], a[116:119], a[84:87], v[84:87]
ds_read_b64_tr_b16 a[60:61], v13 offset:40960
buffer_load_dwordx4 v5, s[8:11], s61 offen offset:1024 lds
v_mfma_f32_16x16x32_bf16 v[68:71], a[116:119], a[80:83], v[68:71]
ds_read_b64_tr_b16 a[62:63], v13 offset:45056
v_mfma_f32_16x16x32_bf16 v[72:75], a[120:123], a[80:83], v[72:75]
v_mfma_f32_16x16x32_bf16 v[88:91], a[120:123], a[84:87], v[88:91]
v_mfma_f32_16x16x32_bf16 v[104:107], a[120:123], a[88:91], v[104:107]
buffer_load_dwordx4 v6, s[8:11], s61 offen offset:2048 lds
v_mfma_f32_16x16x32_bf16 v[120:123], a[120:123], a[92:95], v[120:123]
v_mfma_f32_16x16x32_bf16 v[124:127], a[124:127], a[92:95], v[124:127]
v_mfma_f32_16x16x32_bf16 v[108:111], a[124:127], a[88:91], v[108:111]
v_mfma_f32_16x16x32_bf16 v[92:95], a[124:127], a[84:87], v[92:95]
buffer_load_dwordx4 v7, s[8:11], s61 offen offset:3072 lds
s_add_u32 s61, s61, s65
v_mfma_f32_16x16x32_bf16 v[76:79], a[124:127], a[80:83], v[76:79]
s_waitcnt vmcnt(16) lgkmcnt(0)
s_barrier
v_mfma_f32_16x16x32_bf16 v[64:67], a[32:35], a[0:3], v[64:67]
ds_read_b128 a[64:67], v8 offset:49152
v_mfma_f32_16x16x32_bf16 v[80:83], a[32:35], a[4:7], v[80:83]
ds_read_b64_tr_b16 a[96:97], v10 offset:49152
v_mfma_f32_16x16x32_bf16 v[96:99], a[32:35], a[8:11], v[96:99]
ds_read_b64_tr_b16 a[98:99], v10 offset:53248
s_add_u32 m0, s63, 32768
s_nop 0
buffer_load_dwordx4 v2, s[4:7], s60 offen offset:0 sc1 lds
v_mfma_f32_16x16x32_bf16 v[112:115], a[32:35], a[12:15], v[112:115]
ds_read_b128 a[68:71], v8 offset:50176
v_mfma_f32_16x16x32_bf16 v[116:119], a[36:39], a[12:15], v[116:119]
ds_read_b64_tr_b16 a[100:101], v11 offset:49152
v_mfma_f32_16x16x32_bf16 v[100:103], a[36:39], a[8:11], v[100:103]
ds_read_b64_tr_b16 a[102:103], v11 offset:53248
v_mfma_f32_16x16x32_bf16 v[84:87], a[36:39], a[4:7], v[84:87]
ds_read_b128 a[72:75], v8 offset:51200
buffer_load_dwordx4 v2, s[4:7], s60 offen offset:1024 sc1 lds
v_mfma_f32_16x16x32_bf16 v[68:71], a[36:39], a[0:3], v[68:71]
ds_read_b64_tr_b16 a[104:105], v12 offset:49152
v_mfma_f32_16x16x32_bf16 v[72:75], a[40:43], a[0:3], v[72:75]
ds_read_b64_tr_b16 a[106:107], v12 offset:53248
v_mfma_f32_16x16x32_bf16 v[88:91], a[40:43], a[4:7], v[88:91]
ds_read_b128 a[76:79], v8 offset:52224
v_mfma_f32_16x16x32_bf16 v[104:107], a[40:43], a[8:11], v[104:107]
ds_read_b64_tr_b16 a[108:109], v13 offset:49152
buffer_load_dwordx4 v2, s[4:7], s60 offen offset:2048 sc1 lds
v_mfma_f32_16x16x32_bf16 v[120:123], a[40:43], a[12:15], v[120:123]
ds_read_b64_tr_b16 a[110:111], v13 offset:53248
v_mfma_f32_16x16x32_bf16 v[124:127], a[44:47], a[12:15], v[124:127]
ds_read_b128 a[80:83], v8 offset:53248
v_mfma_f32_16x16x32_bf16 v[108:111], a[44:47], a[8:11], v[108:111]
ds_read_b64_tr_b16 a[112:113], v10 offset:57344
v_mfma_f32_16x16x32_bf16 v[92:95], a[44:47], a[4:7], v[92:95]
ds_read_b64_tr_b16 a[114:115], v10 offset:61440
buffer_load_dwordx4 v2, s[4:7], s60 offen offset:3072 sc1 lds
s_add_u32 s60, s60, 8192
v_mfma_f32_16x16x32_bf16 v[76:79], a[44:47], a[0:3], v[76:79]
ds_read_b128 a[84:87], v8 offset:54272
v_mfma_f32_16x16x32_bf16 v[64:67], a[48:51], a[16:19], v[64:67]
ds_read_b64_tr_b16 a[116:117], v11 offset:57344
v_mfma_f32_16x16x32_bf16 v[80:83], a[48:51], a[20:23], v[80:83]
ds_read_b64_tr_b16 a[118:119], v11 offset:61440
v_mfma_f32_16x16x32_bf16 v[96:99], a[48:51], a[24:27], v[96:99]
ds_read_b128 a[88:91], v8 offset:55296
s_add_u32 m0, s64, 32768
s_nop 0
buffer_load_dwordx4 v4, s[8:11], s61 offen offset:0 lds
v_mfma_f32_16x16x32_bf16 v[112:115], a[48:51], a[28:31], v[112:115]
ds_read_b64_tr_b16 a[120:121], v12 offset:57344
v_mfma_f32_16x16x32_bf16 v[116:119], a[52:55], a[28:31], v[116:119]
ds_read_b64_tr_b16 a[122:123], v12 offset:61440
v_mfma_f32_16x16x32_bf16 v[100:103], a[52:55], a[24:27], v[100:103]
ds_read_b128 a[92:95], v8 offset:56320
v_mfma_f32_16x16x32_bf16 v[84:87], a[52:55], a[20:23], v[84:87]
ds_read_b64_tr_b16 a[124:125], v13 offset:57344
buffer_load_dwordx4 v5, s[8:11], s61 offen offset:1024 lds
v_mfma_f32_16x16x32_bf16 v[68:71], a[52:55], a[16:19], v[68:71]
ds_read_b64_tr_b16 a[126:127], v13 offset:61440
v_mfma_f32_16x16x32_bf16 v[72:75], a[56:59], a[16:19], v[72:75]
v_mfma_f32_16x16x32_bf16 v[88:91], a[56:59], a[20:23], v[88:91]
v_mfma_f32_16x16x32_bf16 v[104:107], a[56:59], a[24:27], v[104:107]
buffer_load_dwordx4 v6, s[8:11], s61 offen offset:2048 lds
v_mfma_f32_16x16x32_bf16 v[120:123], a[56:59], a[28:31], v[120:123]
v_mfma_f32_16x16x32_bf16 v[124:127], a[60:63], a[28:31], v[124:127]
v_mfma_f32_16x16x32_bf16 v[108:111], a[60:63], a[24:27], v[108:111]
v_mfma_f32_16x16x32_bf16 v[92:95], a[60:63], a[20:23], v[92:95]
buffer_load_dwordx4 v7, s[8:11], s61 offen offset:3072 lds
s_add_u32 s61, s61, s65
v_mfma_f32_16x16x32_bf16 v[76:79], a[60:63], a[16:19], v[76:79]
s_waitcnt vmcnt(16) lgkmcnt(0)
s_barrier
v_mfma_f32_16x16x32_bf16 v[64:67], a[96:99], a[64:67], v[64:67]
ds_read_b128 a[0:3], v8 offset:0
v_mfma_f32_16x16x32_bf16 v[80:83], a[96:99], a[68:71], v[80:83]
ds_read_b64_tr_b16 a[32:33], v10 offset:0
v_mfma_f32_16x16x32_bf16 v[96:99], a[96:99], a[72:75], v[96:99]
ds_read_b64_tr_b16 a[34:35], v10 offset:4096
s_add_u32 m0, s63, 49152
s_nop 0
buffer_load_dwordx4 v2, s[4:7], s60 offen offset:0 sc1 lds
v_mfma_f32_16x16x32_bf16 v[112:115], a[96:99], a[76:79], v[112:115]
ds_read_b128 a[4:7], v8 offset:1024
v_mfma_f32_16x16x32_bf16 v[116:119], a[100:103], a[76:79], v[116:119]
ds_read_b64_tr_b16 a[36:37], v11 offset:0
v_mfma_f32_16x16x32_bf16 v[100:103], a[100:103], a[72:75], v[100:103]
ds_read_b64_tr_b16 a[38:39], v11 offset:4096
v_mfma_f32_16x16x32_bf16 v[84:87], a[100:103], a[68:71], v[84:87]
ds_read_b128 a[8:11], v8 offset:2048
buffer_load_dwordx4 v2, s[4:7], s60 offen offset:1024 sc1 lds
v_mfma_f32_16x16x32_bf16 v[68:71], a[100:103], a[64:67], v[68:71]
ds_read_b64_tr_b16 a[40:41], v12 offset:0
v_mfma_f32_16x16x32_bf16 v[72:75], a[104:107], a[64:67], v[72:75]
ds_read_b64_tr_b16 a[42:43], v12 offset:4096
v_mfma_f32_16x16x32_bf16 v[88:91], a[104:107], a[68:71], v[88:91]
ds_read_b128 a[12:15], v8 offset:3072
v_mfma_f32_16x16x32_bf16 v[104:107], a[104:107], a[72:75], v[104:107]
ds_read_b64_tr_b16 a[44:45], v13 offset:0
buffer_load_dwordx4 v2, s[4:7], s60 offen offset:2048 sc1 lds
v_mfma_f32_16x16x32_bf16 v[120:123], a[104:107], a[76:79], v[120:123]
ds_read_b64_tr_b16 a[46:47], v13 offset:4096
v_mfma_f32_16x16x32_bf16 v[124:127], a[108:111], a[76:79], v[124:127]
ds_read_b128 a[16:19], v8 offset:4096
v_mfma_f32_16x16x32_bf16 v[108:111], a[108:111], a[72:75], v[108:111]
ds_read_b64_tr_b16 a[48:49], v10 offset:8192
v_mfma_f32_16x16x32_bf16 v[92:95], a[108:111], a[68:71], v[92:95]
ds_read_b64_tr_b16 a[50:51], v10 offset:12288
buffer_load_dwordx4 v2, s[4:7], s60 offen offset:3072 sc1 lds
s_add_u32 s60, s60, 8192
v_mfma_f32_16x16x32_bf16 v[76:79], a[108:111], a[64:67], v[76:79]
ds_read_b128 a[20:23], v8 offset:5120
v_mfma_f32_16x16x32_bf16 v[64:67], a[112:115], a[80:83], v[64:67]
ds_read_b64_tr_b16 a[52:53], v11 offset:8192
v_mfma_f32_16x16x32_bf16 v[80:83], a[112:115], a[84:87], v[80:83]
ds_read_b64_tr_b16 a[54:55], v11 offset:12288
v_mfma_f32_16x16x32_bf16 v[96:99], a[112:115], a[88:91], v[96:99]
ds_read_b128 a[24:27], v8 offset:6144
s_add_u32 m0, s64, 49152
s_nop 0
buffer_load_dwordx4 v4, s[8:11], s61 offen offset:0 lds
v_mfma_f32_16x16x32_bf16 v[112:115], a[112:115], a[92:95], v[112:115]
ds_read_b64_tr_b16 a[56:57], v12 offset:8192
v_mfma_f32_16x16x32_bf16 v[116:119], a[116:119], a[92:95], v[116:119]
ds_read_b64_tr_b16 a[58:59], v12 offset:12288
v_mfma_f32_16x16x32_bf16 v[100:103], a[116:119], a[88:91], v[100:103]
ds_read_b128 a[28:31], v8 offset:7168
v_mfma_f32_16x16x32_bf16 v[84:87], a[116:119], a[84:87], v[84:87]
ds_read_b64_tr_b16 a[60:61], v13 offset:8192
buffer_load_dwordx4 v5, s[8:11], s61 offen offset:1024 lds
v_mfma_f32_16x16x32_bf16 v[68:71], a[116:119], a[80:83], v[68:71]
ds_read_b64_tr_b16 a[62:63], v13 offset:12288
v_mfma_f32_16x16x32_bf16 v[72:75], a[120:123], a[80:83], v[72:75]
v_mfma_f32_16x16x32_bf16 v[88:91], a[120:123], a[84:87], v[88:91]
v_mfma_f32_16x16x32_bf16 v[104:107], a[120:123], a[88:91], v[104:107]
buffer_load_dwordx4 v6, s[8:11], s61 offen offset:2048 lds
v_mfma_f32_16x16x32_bf16 v[120:123], a[120:123], a[92:95], v[120:123]
v_mfma_f32_16x16x32_bf16 v[124:127], a[124:127], a[92:95], v[124:127]
v_mfma_f32_16x16x32_bf16 v[108:111], a[124:127], a[88:91], v[108:111]
v_mfma_f32_16x16x32_bf16 v[92:95], a[124:127], a[84:87], v[92:95]
buffer_load_dwordx4 v7, s[8:11], s61 offen offset:3072 lds
s_add_u32 s61, s61, s65
v_mfma_f32_16x16x32_bf16 v[76:79], a[124:127], a[80:83], v[76:79]
s_sub_u32 s62, s62, 1
s_cmp_lg_u32 s62, 0
s_cbranch_scc1 Lgl_565
s_waitcnt vmcnt(16) lgkmcnt(0)
s_barrier
v_mfma_f32_16x16x32_bf16 v[64:67], a[32:35], a[0:3], v[64:67]
ds_read_b128 a[64:67], v8 offset:16384
v_mfma_f32_16x16x32_bf16 v[80:83], a[32:35], a[4:7], v[80:83]
ds_read_b64_tr_b16 a[96:97], v10 offset:16384
v_mfma_f32_16x16x32_bf16 v[96:99], a[32:35], a[8:11], v[96:99]
ds_read_b64_tr_b16 a[98:99], v10 offset:20480
v_mfma_f32_16x16x32_bf16 v[112:115], a[32:35], a[12:15], v[112:115]
ds_read_b128 a[68:71], v8 offset:17408
v_mfma_f32_16x16x32_bf16 v[116:119], a[36:39], a[12:15], v[116:119]
ds_read_b64_tr_b16 a[100:101], v11 offset:16384
v_mfma_f32_16x16x32_bf16 v[100:103], a[36:39], a[8:11], v[100:103]
ds_read_b64_tr_b16 a[102:103], v11 offset:20480
v_mfma_f32_16x16x32_bf16 v[84:87], a[36:39], a[4:7], v[84:87]
ds_read_b128 a[72:75], v8 offset:18432
v_mfma_f32_16x16x32_bf16 v[68:71], a[36:39], a[0:3], v[68:71]
ds_read_b64_tr_b16 a[104:105], v12 offset:16384
v_mfma_f32_16x16x32_bf16 v[72:75], a[40:43], a[0:3], v[72:75]
ds_read_b64_tr_b16 a[106:107], v12 offset:20480
v_mfma_f32_16x16x32_bf16 v[88:91], a[40:43], a[4:7], v[88:91]
ds_read_b128 a[76:79], v8 offset:19456
v_mfma_f32_16x16x32_bf16 v[104:107], a[40:43], a[8:11], v[104:107]
ds_read_b64_tr_b16 a[108:109], v13 offset:16384
v_mfma_f32_16x16x32_bf16 v[120:123], a[40:43], a[12:15], v[120:123]
ds_read_b64_tr_b16 a[110:111], v13 offset:20480
v_mfma_f32_16x16x32_bf16 v[124:127], a[44:47], a[12:15], v[124:127]
ds_read_b128 a[80:83], v8 offset:20480
v_mfma_f32_16x16x32_bf16 v[108:111], a[44:47], a[8:11], v[108:111]
ds_read_b64_tr_b16 a[112:113], v10 offset:24576
v_mfma_f32_16x16x32_bf16 v[92:95], a[44:47], a[4:7], v[92:95]
ds_read_b64_tr_b16 a[114:115], v10 offset:28672
v_mfma_f32_16x16x32_bf16 v[76:79], a[44:47], a[0:3], v[76:79]
ds_read_b128 a[84:87], v8 offset:21504
v_mfma_f32_16x16x32_bf16 v[64:67], a[48:51], a[16:19], v[64:67]
ds_read_b64_tr_b16 a[116:117], v11 offset:24576
v_mfma_f32_16x16x32_bf16 v[80:83], a[48:51], a[20:23], v[80:83]
ds_read_b64_tr_b16 a[118:119], v11 offset:28672
v_mfma_f32_16x16x32_bf16 v[96:99], a[48:51], a[24:27], v[96:99]
ds_read_b128 a[88:91], v8 offset:22528
v_mfma_f32_16x16x32_bf16 v[112:115], a[48:51], a[28:31], v[112:115]
ds_read_b64_tr_b16 a[120:121], v12 offset:24576
v_mfma_f32_16x16x32_bf16 v[116:119], a[52:55], a[28:31], v[116:119]
ds_read_b64_tr_b16 a[122:123], v12 offset:28672
v_mfma_f32_16x16x32_bf16 v[100:103], a[52:55], a[24:27], v[100:103]
ds_read_b128 a[92:95], v8 offset:23552
v_mfma_f32_16x16x32_bf16 v[84:87], a[52:55], a[20:23], v[84:87]
ds_read_b64_tr_b16 a[124:125], v13 offset:24576
v_mfma_f32_16x16x32_bf16 v[68:71], a[52:55], a[16:19], v[68:71]
ds_read_b64_tr_b16 a[126:127], v13 offset:28672
v_mfma_f32_16x16x32_bf16 v[72:75], a[56:59], a[16:19], v[72:75]
v_mfma_f32_16x16x32_bf16 v[88:91], a[56:59], a[20:23], v[88:91]
v_mfma_f32_16x16x32_bf16 v[104:107], a[56:59], a[24:27], v[104:107]
v_mfma_f32_16x16x32_bf16 v[120:123], a[56:59], a[28:31], v[120:123]
v_mfma_f32_16x16x32_bf16 v[124:127], a[60:63], a[28:31], v[124:127]
v_mfma_f32_16x16x32_bf16 v[108:111], a[60:63], a[24:27], v[108:111]
v_mfma_f32_16x16x32_bf16 v[92:95], a[60:63], a[20:23], v[92:95]
v_mfma_f32_16x16x32_bf16 v[76:79], a[60:63], a[16:19], v[76:79]
s_waitcnt vmcnt(8) lgkmcnt(0)
s_barrier
v_mfma_f32_16x16x32_bf16 v[64:67], a[96:99], a[64:67], v[64:67]
ds_read_b128 a[0:3], v8 offset:32768
v_mfma_f32_16x16x32_bf16 v[80:83], a[96:99], a[68:71], v[80:83]
ds_read_b64_tr_b16 a[32:33], v10 offset:32768
v_mfma_f32_16x16x32_bf16 v[96:99], a[96:99], a[72:75], v[96:99]
ds_read_b64_tr_b16 a[34:35], v10 offset:36864
v_mfma_f32_16x16x32_bf16 v[112:115], a[96:99], a[76:79], v[112:115]
ds_read_b128 a[4:7], v8 offset:33792
v_mfma_f32_16x16x32_bf16 v[116:119], a[100:103], a[76:79], v[116:119]
ds_read_b64_tr_b16 a[36:37], v11 offset:32768
v_mfma_f32_16x16x32_bf16 v[100:103], a[100:103], a[72:75], v[100:103]
ds_read_b64_tr_b16 a[38:39], v11 offset:36864
v_mfma_f32_16x16x32_bf16 v[84:87], a[100:103], a[68:71], v[84:87]
ds_read_b128 a[8:11], v8 offset:34816
v_mfma_f32_16x16x32_bf16 v[68:71], a[100:103], a[64:67], v[68:71]
ds_read_b64_tr_b16 a[40:41], v12 offset:32768
v_mfma_f32_16x16x32_bf16 v[72:75], a[104:107], a[64:67], v[72:75]
ds_read_b64_tr_b16 a[42:43], v12 offset:36864
v_mfma_f32_16x16x32_bf16 v[88:91], a[104:107], a[68:71], v[88:91]
ds_read_b128 a[12:15], v8 offset:35840
v_mfma_f32_16x16x32_bf16 v[104:107], a[104:107], a[72:75], v[104:107]
ds_read_b64_tr_b16 a[44:45], v13 offset:32768
v_mfma_f32_16x16x32_bf16 v[120:123], a[104:107], a[76:79], v[120:123]
ds_read_b64_tr_b16 a[46:47], v13 offset:36864
v_mfma_f32_16x16x32_bf16 v[124:127], a[108:111], a[76:79], v[124:127]
ds_read_b128 a[16:19], v8 offset:36864
v_mfma_f32_16x16x32_bf16 v[108:111], a[108:111], a[72:75], v[108:111]
ds_read_b64_tr_b16 a[48:49], v10 offset:40960
v_mfma_f32_16x16x32_bf16 v[92:95], a[108:111], a[68:71], v[92:95]
ds_read_b64_tr_b16 a[50:51], v10 offset:45056
v_mfma_f32_16x16x32_bf16 v[76:79], a[108:111], a[64:67], v[76:79]
ds_read_b128 a[20:23], v8 offset:37888
v_mfma_f32_16x16x32_bf16 v[64:67], a[112:115], a[80:83], v[64:67]
ds_read_b64_tr_b16 a[52:53], v11 offset:40960
v_mfma_f32_16x16x32_bf16 v[80:83], a[112:115], a[84:87], v[80:83]
ds_read_b64_tr_b16 a[54:55], v11 offset:45056
v_mfma_f32_16x16x32_bf16 v[96:99], a[112:115], a[88:91], v[96:99]
ds_read_b128 a[24:27], v8 offset:38912
v_mfma_f32_16x16x32_bf16 v[112:115], a[112:115], a[92:95], v[112:115]
ds_read_b64_tr_b16 a[56:57], v12 offset:40960
v_mfma_f32_16x16x32_bf16 v[116:119], a[116:119], a[92:95], v[116:119]
ds_read_b64_tr_b16 a[58:59], v12 offset:45056
v_mfma_f32_16x16x32_bf16 v[100:103], a[116:119], a[88:91], v[100:103]
ds_read_b128 a[28:31], v8 offset:39936
v_mfma_f32_16x16x32_bf16 v[84:87], a[116:119], a[84:87], v[84:87]
ds_read_b64_tr_b16 a[60:61], v13 offset:40960
v_mfma_f32_16x16x32_bf16 v[68:71], a[116:119], a[80:83], v[68:71]
ds_read_b64_tr_b16 a[62:63], v13 offset:45056
v_mfma_f32_16x16x32_bf16 v[72:75], a[120:123], a[80:83], v[72:75]
v_mfma_f32_16x16x32_bf16 v[88:91], a[120:123], a[84:87], v[88:91]
v_mfma_f32_16x16x32_bf16 v[104:107], a[120:123], a[88:91], v[104:107]
v_mfma_f32_16x16x32_bf16 v[120:123], a[120:123], a[92:95], v[120:123]
v_mfma_f32_16x16x32_bf16 v[124:127], a[124:127], a[92:95], v[124:127]
v_mfma_f32_16x16x32_bf16 v[108:111], a[124:127], a[88:91], v[108:111]
v_mfma_f32_16x16x32_bf16 v[92:95], a[124:127], a[84:87], v[92:95]
v_mfma_f32_16x16x32_bf16 v[76:79], a[124:127], a[80:83], v[76:79]
s_waitcnt vmcnt(0) lgkmcnt(0)
s_barrier
v_mfma_f32_16x16x32_bf16 v[64:67], a[32:35], a[0:3], v[64:67]
ds_read_b128 a[64:67], v8 offset:49152
v_mfma_f32_16x16x32_bf16 v[80:83], a[32:35], a[4:7], v[80:83]
ds_read_b64_tr_b16 a[96:97], v10 offset:49152
v_mfma_f32_16x16x32_bf16 v[96:99], a[32:35], a[8:11], v[96:99]
ds_read_b64_tr_b16 a[98:99], v10 offset:53248
v_mfma_f32_16x16x32_bf16 v[112:115], a[32:35], a[12:15], v[112:115]
ds_read_b128 a[68:71], v8 offset:50176
v_mfma_f32_16x16x32_bf16 v[116:119], a[36:39], a[12:15], v[116:119]
ds_read_b64_tr_b16 a[100:101], v11 offset:49152
v_mfma_f32_16x16x32_bf16 v[100:103], a[36:39], a[8:11], v[100:103]
ds_read_b64_tr_b16 a[102:103], v11 offset:53248
v_mfma_f32_16x16x32_bf16 v[84:87], a[36:39], a[4:7], v[84:87]
ds_read_b128 a[72:75], v8 offset:51200
v_mfma_f32_16x16x32_bf16 v[68:71], a[36:39], a[0:3], v[68:71]
ds_read_b64_tr_b16 a[104:105], v12 offset:49152
v_mfma_f32_16x16x32_bf16 v[72:75], a[40:43], a[0:3], v[72:75]
ds_read_b64_tr_b16 a[106:107], v12 offset:53248
v_mfma_f32_16x16x32_bf16 v[88:91], a[40:43], a[4:7], v[88:91]
ds_read_b128 a[76:79], v8 offset:52224
v_mfma_f32_16x16x32_bf16 v[104:107], a[40:43], a[8:11], v[104:107]
ds_read_b64_tr_b16 a[108:109], v13 offset:49152
v_mfma_f32_16x16x32_bf16 v[120:123], a[40:43], a[12:15], v[120:123]
ds_read_b64_tr_b16 a[110:111], v13 offset:53248
v_mfma_f32_16x16x32_bf16 v[124:127], a[44:47], a[12:15], v[124:127]
ds_read_b128 a[80:83], v8 offset:53248
v_mfma_f32_16x16x32_bf16 v[108:111], a[44:47], a[8:11], v[108:111]
ds_read_b64_tr_b16 a[112:113], v10 offset:57344
v_mfma_f32_16x16x32_bf16 v[92:95], a[44:47], a[4:7], v[92:95]
ds_read_b64_tr_b16 a[114:115], v10 offset:61440
v_mfma_f32_16x16x32_bf16 v[76:79], a[44:47], a[0:3], v[76:79]
ds_read_b128 a[84:87], v8 offset:54272
v_mfma_f32_16x16x32_bf16 v[64:67], a[48:51], a[16:19], v[64:67]
ds_read_b64_tr_b16 a[116:117], v11 offset:57344
v_mfma_f32_16x16x32_bf16 v[80:83], a[48:51], a[20:23], v[80:83]
ds_read_b64_tr_b16 a[118:119], v11 offset:61440
v_mfma_f32_16x16x32_bf16 v[96:99], a[48:51], a[24:27], v[96:99]
ds_read_b128 a[88:91], v8 offset:55296
v_mfma_f32_16x16x32_bf16 v[112:115], a[48:51], a[28:31], v[112:115]
ds_read_b64_tr_b16 a[120:121], v12 offset:57344
v_mfma_f32_16x16x32_bf16 v[116:119], a[52:55], a[28:31], v[116:119]
ds_read_b64_tr_b16 a[122:123], v12 offset:61440
v_mfma_f32_16x16x32_bf16 v[100:103], a[52:55], a[24:27], v[100:103]
ds_read_b128 a[92:95], v8 offset:56320
v_mfma_f32_16x16x32_bf16 v[84:87], a[52:55], a[20:23], v[84:87]
ds_read_b64_tr_b16 a[124:125], v13 offset:57344
v_mfma_f32_16x16x32_bf16 v[68:71], a[52:55], a[16:19], v[68:71]
ds_read_b64_tr_b16 a[126:127], v13 offset:61440
v_mfma_f32_16x16x32_bf16 v[72:75], a[56:59], a[16:19], v[72:75]
v_mfma_f32_16x16x32_bf16 v[88:91], a[56:59], a[20:23], v[88:91]
v_mfma_f32_16x16x32_bf16 v[104:107], a[56:59], a[24:27], v[104:107]
v_mfma_f32_16x16x32_bf16 v[120:123], a[56:59], a[28:31], v[120:123]
v_mfma_f32_16x16x32_bf16 v[124:127], a[60:63], a[28:31], v[124:127]
v_mfma_f32_16x16x32_bf16 v[108:111], a[60:63], a[24:27], v[108:111]
v_mfma_f32_16x16x32_bf16 v[92:95], a[60:63], a[20:23], v[92:95]
v_mfma_f32_16x16x32_bf16 v[76:79], a[60:63], a[16:19], v[76:79]
s_waitcnt lgkmcnt(0)
v_mfma_f32_16x16x32_bf16 v[64:67], a[96:99], a[64:67], v[64:67]
v_mfma_f32_16x16x32_bf16 v[80:83], a[96:99], a[68:71], v[80:83]
v_mfma_f32_16x16x32_bf16 v[96:99], a[96:99], a[72:75], v[96:99]
v_mfma_f32_16x16x32_bf16 v[112:115], a[96:99], a[76:79], v[112:115]
v_mfma_f32_16x16x32_bf16 v[116:119], a[100:103], a[76:79], v[116:119]
v_mfma_f32_16x16x32_bf16 v[100:103], a[100:103], a[72:75], v[100:103]
v_mfma_f32_16x16x32_bf16 v[84:87], a[100:103], a[68:71], v[84:87]
v_mfma_f32_16x16x32_bf16 v[68:71], a[100:103], a[64:67], v[68:71]
v_mfma_f32_16x16x32_bf16 v[72:75], a[104:107], a[64:67], v[72:75]
v_mfma_f32_16x16x32_bf16 v[88:91], a[104:107], a[68:71], v[88:91]
v_mfma_f32_16x16x32_bf16 v[104:107], a[104:107], a[72:75], v[104:107]
v_mfma_f32_16x16x32_bf16 v[120:123], a[104:107], a[76:79], v[120:123]
v_mfma_f32_16x16x32_bf16 v[124:127], a[108:111], a[76:79], v[124:127]
v_mfma_f32_16x16x32_bf16 v[108:111], a[108:111], a[72:75], v[108:111]
v_mfma_f32_16x16x32_bf16 v[92:95], a[108:111], a[68:71], v[92:95]
v_mfma_f32_16x16x32_bf16 v[76:79], a[108:111], a[64:67], v[76:79]
v_mfma_f32_16x16x32_bf16 v[64:67], a[112:115], a[80:83], v[64:67]
v_mfma_f32_16x16x32_bf16 v[80:83], a[112:115], a[84:87], v[80:83]
v_mfma_f32_16x16x32_bf16 v[96:99], a[112:115], a[88:91], v[96:99]
v_mfma_f32_16x16x32_bf16 v[112:115], a[112:115], a[92:95], v[112:115]
v_mfma_f32_16x16x32_bf16 v[116:119], a[116:119], a[92:95], v[116:119]
v_mfma_f32_16x16x32_bf16 v[100:103], a[116:119], a[88:91], v[100:103]
v_mfma_f32_16x16x32_bf16 v[84:87], a[116:119], a[84:87], v[84:87]
v_mfma_f32_16x16x32_bf16 v[68:71], a[116:119], a[80:83], v[68:71]
v_mfma_f32_16x16x32_bf16 v[72:75], a[120:123], a[80:83], v[72:75]
v_mfma_f32_16x16x32_bf16 v[88:91], a[120:123], a[84:87], v[88:91]
v_mfma_f32_16x16x32_bf16 v[104:107], a[120:123], a[88:91], v[104:107]
v_mfma_f32_16x16x32_bf16 v[120:123], a[120:123], a[92:95], v[120:123]
v_mfma_f32_16x16x32_bf16 v[124:127], a[124:127], a[92:95], v[124:127]
v_mfma_f32_16x16x32_bf16 v[108:111], a[124:127], a[88:91], v[108:111]
v_mfma_f32_16x16x32_bf16 v[92:95], a[124:127], a[84:87], v[92:95]
v_mfma_f32_16x16x32_bf16 v[76:79], a[124:127], a[80:83], v[76:79]
v_lshlrev_b32 v24, 4, v1
v_lshrrev_b32 v25, 4, v1
v_and_b32 v26, 15, v1
v_lshlrev_b32 v26, 11, v26
v_and_b32 v20, 1, v25
v_lshl_add_u32 v26, v20, 5, v26
v_lshrrev_b32 v20, 1, v25
v_lshl_add_u32 v26, v20, 4, v26
v_lshlrev_b32 v25, 4, v25
buffer_load_dwordx4 a[0:3], v25, s[4:7], s51 offen offset:0
buffer_load_dwordx4 a[4:7], v25, s[4:7], s51 offen offset:64
buffer_load_dwordx4 a[8:11], v25, s[4:7], s51 offen offset:128
buffer_load_dwordx4 a[12:15], v25, s[4:7], s51 offen offset:192
s_add_u32 s66, s49, 0
buffer_load_dwordx4 a[16:19], v24, s[4:7], s66 offen offset:0 sc1
buffer_load_dwordx4 a[20:23], v24, s[4:7], s66 offen offset:1024 sc1
buffer_load_dwordx4 a[24:27], v24, s[4:7], s66 offen offset:2048 sc1
buffer_load_dwordx4 a[28:31], v24, s[4:7], s66 offen offset:3072 sc1
s_add_u32 s66, s49, 4096
buffer_load_dwordx4 a[32:35], v24, s[4:7], s66 offen offset:0 sc1
buffer_load_dwordx4 a[36:39], v24, s[4:7], s66 offen offset:1024 sc1
buffer_load_dwordx4 a[40:43], v24, s[4:7], s66 offen offset:2048 sc1
buffer_load_dwordx4 a[44:47], v24, s[4:7], s66 offen offset:3072 sc1
s_waitcnt vmcnt(7)
v_accvgpr_read_b32 v28, a0
v_accvgpr_read_b32 v29, a1
v_accvgpr_read_b32 v30, a2
v_accvgpr_read_b32 v31, a3
v_accvgpr_read_b32 v32, a4
v_accvgpr_read_b32 v33, a5
v_accvgpr_read_b32 v34, a6
v_accvgpr_read_b32 v35, a7
v_accvgpr_read_b32 v36, a16
v_accvgpr_read_b32 v37, a17
v_accvgpr_read_b32 v38, a18
v_accvgpr_read_b32 v39, a19
v_lshlrev_b32 v40, 16, v36
v_and_b32 v41, 0xffff0000, v36
v_lshlrev_b32 v42, 16, v37
v_and_b32 v43, 0xffff0000, v37
v_lshlrev_b32 v44, 16, v38
v_and_b32 v45, 0xffff0000, v38
v_lshlrev_b32 v46, 16, v39
v_and_b32 v47, 0xffff0000, v39
v_pk_fma_f32 v[40:41], v[64:65], v[28:29], v[40:41]
v_pk_fma_f32 v[42:43], v[66:67], v[30:31], v[42:43]
v_pk_fma_f32 v[44:45], v[68:69], v[32:33], v[44:45]
v_pk_fma_f32 v[46:47], v[70:71], v[34:35], v[46:47]
v_cvt_pk_bf16_f32 v56, v40, v41
v_cvt_pk_bf16_f32 v57, v42, v43
v_cvt_pk_bf16_f32 v58, v44, v45
v_cvt_pk_bf16_f32 v59, v46, v47
s_add_u32 s66, s50, 0
s_nop 0
v_permlane16_swap_b32 v56, v58
v_permlane16_swap_b32 v57, v59
buffer_store_dwordx4 v[56:59], v26, s[12:15], s66 offen offset:0
s_waitcnt vmcnt(7)
v_accvgpr_read_b32 v36, a20
v_accvgpr_read_b32 v37, a21
v_accvgpr_read_b32 v38, a22
v_accvgpr_read_b32 v39, a23
v_lshlrev_b32 v40, 16, v36
v_and_b32 v41, 0xffff0000, v36
v_lshlrev_b32 v42, 16, v37
v_and_b32 v43, 0xffff0000, v37
v_lshlrev_b32 v44, 16, v38
v_and_b32 v45, 0xffff0000, v38
v_lshlrev_b32 v46, 16, v39
v_and_b32 v47, 0xffff0000, v39
v_pk_fma_f32 v[40:41], v[80:81], v[28:29], v[40:41]
v_pk_fma_f32 v[42:43], v[82:83], v[30:31], v[42:43]
v_pk_fma_f32 v[44:45], v[84:85], v[32:33], v[44:45]
v_pk_fma_f32 v[46:47], v[86:87], v[34:35], v[46:47]
v_cvt_pk_bf16_f32 v60, v40, v41
v_cvt_pk_bf16_f32 v61, v42, v43
v_cvt_pk_bf16_f32 v62, v44, v45
v_cvt_pk_bf16_f32 v63, v46, v47
s_add_u32 s66, s50, 32768
s_nop 0
v_permlane16_swap_b32 v60, v62
v_permlane16_swap_b32 v61, v63
buffer_store_dwordx4 v[60:63], v26, s[12:15], s66 offen offset:0
s_waitcnt vmcnt(7)
v_accvgpr_read_b32 v36, a24
v_accvgpr_read_b32 v37, a25
v_accvgpr_read_b32 v38, a26
v_accvgpr_read_b32 v39, a27
v_lshlrev_b32 v40, 16, v36
v_and_b32 v41, 0xffff0000, v36
v_lshlrev_b32 v42, 16, v37
v_and_b32 v43, 0xffff0000, v37
v_lshlrev_b32 v44, 16, v38
v_and_b32 v45, 0xffff0000, v38
v_lshlrev_b32 v46, 16, v39
v_and_b32 v47, 0xffff0000, v39
v_pk_fma_f32 v[40:41], v[96:97], v[28:29], v[40:41]
v_pk_fma_f32 v[42:43], v[98:99], v[30:31], v[42:43]
v_pk_fma_f32 v[44:45], v[100:101], v[32:33], v[44:45]
v_pk_fma_f32 v[46:47], v[102:103], v[34:35], v[46:47]
v_cvt_pk_bf16_f32 v52, v40, v41
v_cvt_pk_bf16_f32 v53, v42, v43
v_cvt_pk_bf16_f32 v54, v44, v45
v_cvt_pk_bf16_f32 v55, v46, v47
s_add_u32 s66, s50, 65536
s_nop 0
v_permlane16_swap_b32 v52, v54
v_permlane16_swap_b32 v53, v55
buffer_store_dwordx4 v[52:55], v26, s[12:15], s66 offen offset:0
s_waitcnt vmcnt(7)
v_accvgpr_read_b32 v36, a28
v_accvgpr_read_b32 v37, a29
v_accvgpr_read_b32 v38, a30
v_accvgpr_read_b32 v39, a31
v_lshlrev_b32 v40, 16, v36
v_and_b32 v41, 0xffff0000, v36
v_lshlrev_b32 v42, 16, v37
v_and_b32 v43, 0xffff0000, v37
v_lshlrev_b32 v44, 16, v38
v_and_b32 v45, 0xffff0000, v38
v_lshlrev_b32 v46, 16, v39
v_and_b32 v47, 0xffff0000, v39
v_pk_fma_f32 v[40:41], v[112:113], v[28:29], v[40:41]
v_pk_fma_f32 v[42:43], v[114:115], v[30:31], v[42:43]
v_pk_fma_f32 v[44:45], v[116:117], v[32:33], v[44:45]
v_pk_fma_f32 v[46:47], v[118:119], v[34:35], v[46:47]
v_cvt_pk_bf16_f32 v56, v40, v41
v_cvt_pk_bf16_f32 v57, v42, v43
v_cvt_pk_bf16_f32 v58, v44, v45
v_cvt_pk_bf16_f32 v59, v46, v47
s_add_u32 s66, s50, 98304
s_nop 0
v_permlane16_swap_b32 v56, v58
v_permlane16_swap_b32 v57, v59
buffer_store_dwordx4 v[56:59], v26, s[12:15], s66 offen offset:0
s_waitcnt vmcnt(7)
v_accvgpr_read_b32 v28, a8
v_accvgpr_read_b32 v29, a9
v_accvgpr_read_b32 v30, a10
v_accvgpr_read_b32 v31, a11
v_accvgpr_read_b32 v32, a12
v_accvgpr_read_b32 v33, a13
v_accvgpr_read_b32 v34, a14
v_accvgpr_read_b32 v35, a15
v_accvgpr_read_b32 v36, a32
v_accvgpr_read_b32 v37, a33
v_accvgpr_read_b32 v38, a34
v_accvgpr_read_b32 v39, a35
v_lshlrev_b32 v40, 16, v36
v_and_b32 v41, 0xffff0000, v36
v_lshlrev_b32 v42, 16, v37
v_and_b32 v43, 0xffff0000, v37
v_lshlrev_b32 v44, 16, v38
v_and_b32 v45, 0xffff0000, v38
v_lshlrev_b32 v46, 16, v39
v_and_b32 v47, 0xffff0000, v39
v_pk_fma_f32 v[40:41], v[72:73], v[28:29], v[40:41]
v_pk_fma_f32 v[42:43], v[74:75], v[30:31], v[42:43]
v_pk_fma_f32 v[44:45], v[76:77], v[32:33], v[44:45]
v_pk_fma_f32 v[46:47], v[78:79], v[34:35], v[46:47]
v_cvt_pk_bf16_f32 v60, v40, v41
v_cvt_pk_bf16_f32 v61, v42, v43
v_cvt_pk_bf16_f32 v62, v44, v45
v_cvt_pk_bf16_f32 v63, v46, v47
s_add_u32 s66, s50, 0
s_nop 0
v_permlane16_swap_b32 v60, v62
v_permlane16_swap_b32 v61, v63
buffer_store_dwordx4 v[60:63], v26, s[12:15], s66 offen offset:64
s_waitcnt vmcnt(7)
v_accvgpr_read_b32 v36, a36
v_accvgpr_read_b32 v37, a37
v_accvgpr_read_b32 v38, a38
v_accvgpr_read_b32 v39, a39
v_lshlrev_b32 v40, 16, v36
v_and_b32 v41, 0xffff0000, v36
v_lshlrev_b32 v42, 16, v37
v_and_b32 v43, 0xffff0000, v37
v_lshlrev_b32 v44, 16, v38
v_and_b32 v45, 0xffff0000, v38
v_lshlrev_b32 v46, 16, v39
v_and_b32 v47, 0xffff0000, v39
v_pk_fma_f32 v[40:41], v[88:89], v[28:29], v[40:41]
v_pk_fma_f32 v[42:43], v[90:91], v[30:31], v[42:43]
v_pk_fma_f32 v[44:45], v[92:93], v[32:33], v[44:45]
v_pk_fma_f32 v[46:47], v[94:95], v[34:35], v[46:47]
v_cvt_pk_bf16_f32 v52, v40, v41
v_cvt_pk_bf16_f32 v53, v42, v43
v_cvt_pk_bf16_f32 v54, v44, v45
v_cvt_pk_bf16_f32 v55, v46, v47
s_add_u32 s66, s50, 32768
s_nop 0
v_permlane16_swap_b32 v52, v54
v_permlane16_swap_b32 v53, v55
buffer_store_dwordx4 v[52:55], v26, s[12:15], s66 offen offset:64
s_waitcnt vmcnt(7)
v_accvgpr_read_b32 v36, a40
v_accvgpr_read_b32 v37, a41
v_accvgpr_read_b32 v38, a42
v_accvgpr_read_b32 v39, a43
v_lshlrev_b32 v40, 16, v36
v_and_b32 v41, 0xffff0000, v36
v_lshlrev_b32 v42, 16, v37
v_and_b32 v43, 0xffff0000, v37
v_lshlrev_b32 v44, 16, v38
v_and_b32 v45, 0xffff0000, v38
v_lshlrev_b32 v46, 16, v39
v_and_b32 v47, 0xffff0000, v39
v_pk_fma_f32 v[40:41], v[104:105], v[28:29], v[40:41]
v_pk_fma_f32 v[42:43], v[106:107], v[30:31], v[42:43]
v_pk_fma_f32 v[44:45], v[108:109], v[32:33], v[44:45]
v_pk_fma_f32 v[46:47], v[110:111], v[34:35], v[46:47]
v_cvt_pk_bf16_f32 v56, v40, v41
v_cvt_pk_bf16_f32 v57, v42, v43
v_cvt_pk_bf16_f32 v58, v44, v45
v_cvt_pk_bf16_f32 v59, v46, v47
s_add_u32 s66, s50, 65536
s_nop 0
v_permlane16_swap_b32 v56, v58
v_permlane16_swap_b32 v57, v59
buffer_store_dwordx4 v[56:59], v26, s[12:15], s66 offen offset:64
s_waitcnt vmcnt(7)
v_accvgpr_read_b32 v36, a44
v_accvgpr_read_b32 v37, a45
v_accvgpr_read_b32 v38, a46
v_accvgpr_read_b32 v39, a47
v_lshlrev_b32 v40, 16, v36
v_and_b32 v41, 0xffff0000, v36
v_lshlrev_b32 v42, 16, v37
v_and_b32 v43, 0xffff0000, v37
v_lshlrev_b32 v44, 16, v38
v_and_b32 v45, 0xffff0000, v38
v_lshlrev_b32 v46, 16, v39
v_and_b32 v47, 0xffff0000, v39
v_pk_fma_f32 v[40:41], v[120:121], v[28:29], v[40:41]
v_pk_fma_f32 v[42:43], v[122:123], v[30:31], v[42:43]
v_pk_fma_f32 v[44:45], v[124:125], v[32:33], v[44:45]
v_pk_fma_f32 v[46:47], v[126:127], v[34:35], v[46:47]
v_cvt_pk_bf16_f32 v60, v40, v41
v_cvt_pk_bf16_f32 v61, v42, v43
v_cvt_pk_bf16_f32 v62, v44, v45
v_cvt_pk_bf16_f32 v63, v46, v47
s_add_u32 s66, s50, 98304
s_nop 0
v_permlane16_swap_b32 v60, v62
v_permlane16_swap_b32 v61, v63
buffer_store_dwordx4 v[60:63], v26, s[12:15], s66 offen offset:64
Lend_564:
s_endpgm

.section .rodata,"a"
.p2align 6
.amdhsa_kernel mod_kernel
  .amdhsa_next_free_vgpr 128
  .amdhsa_next_free_sgpr 102
  .amdhsa_accum_offset 128
  .amdhsa_group_segment_fixed_size 0
  .amdhsa_kernarg_size 128
  .amdhsa_user_sgpr_count 2
  .amdhsa_user_sgpr_kernarg_segment_ptr 1
  .amdhsa_system_sgpr_workgroup_id_x 1
  .amdhsa_float_denorm_mode_32 3
.end_amdhsa_kernel

.p2align 6
.amdhsa_kernel ln1_kernel
  .amdhsa_next_free_vgpr 256
  .amdhsa_next_free_sgpr 102
  .amdhsa_accum_offset 256
  .amdhsa_group_segment_fixed_size 0
  .amdhsa_kernarg_size 128
  .amdhsa_user_sgpr_count 2
  .amdhsa_user_sgpr_kernarg_segment_ptr 1
  .amdhsa_system_sgpr_workgroup_id_x 1
  .amdhsa_float_denorm_mode_32 3
.end_amdhsa_kernel

.p2align 6
.amdhsa_kernel qkv_kernel
  .amdhsa_next_free_vgpr 512
  .amdhsa_next_free_sgpr 102
  .amdhsa_accum_offset 256
  .amdhsa_group_segment_fixed_size 0
  .amdhsa_kernarg_size 128
  .amdhsa_user_sgpr_count 2
  .amdhsa_user_sgpr_kernarg_segment_ptr 1
  .amdhsa_system_sgpr_workgroup_id_x 1
  .amdhsa_float_denorm_mode_32 3
.end_amdhsa_kernel

.p2align 6
.amdhsa_kernel chain_kernel
  .amdhsa_next_free_vgpr 512
  .amdhsa_next_free_sgpr 102
  .amdhsa_accum_offset 256
  .amdhsa_group_segment_fixed_size 0
  .amdhsa_kernarg_size 128
  .amdhsa_user_sgpr_count 2
  .amdhsa_user_sgpr_kernarg_segment_ptr 1
  .amdhsa_system_sgpr_workgroup_id_x 1
  .amdhsa_float_denorm_mode_32 3
.end_amdhsa_kernel

.p2align 6
.amdhsa_kernel wo_kernel
  .amdhsa_next_free_vgpr 512
  .amdhsa_next_free_sgpr 102
  .amdhsa_accum_offset 256
  .amdhsa_group_segment_fixed_size 0
  .amdhsa_kernarg_size 128
  .amdhsa_user_sgpr_count 2
  .amdhsa_user_sgpr_kernarg_segment_ptr 1
  .amdhsa_system_sgpr_workgroup_id_x 1
  .amdhsa_float_denorm_mode_32 3
.end_amdhsa_kernel

.p2align 6
.amdhsa_kernel ln2_kernel
  .amdhsa_next_free_vgpr 256
  .amdhsa_next_free_sgpr 102
  .amdhsa_accum_offset 256
  .amdhsa_group_segment_fixed_size 0
  .amdhsa_kernarg_size 128
  .amdhsa_user_sgpr_count 2
  .amdhsa_user_sgpr_kernarg_segment_ptr 1
  .amdhsa_system_sgpr_workgroup_id_x 1
  .amdhsa_float_denorm_mode_32 3
.end_amdhsa_kernel

.p2align 6
.amdhsa_kernel up_kernel
  .amdhsa_next_free_vgpr 512
  .amdhsa_next_free_sgpr 102
  .amdhsa_accum_offset 256
  .amdhsa_group_segment_fixed_size 0
  .amdhsa_kernarg_size 128
  .amdhsa_user_sgpr_count 2
  .amdhsa_user_sgpr_kernarg_segment_ptr 1
  .amdhsa_system_sgpr_workgroup_id_x 1
  .amdhsa_float_denorm_mode_32 3
.end_amdhsa_kernel

.p2align 6
.amdhsa_kernel down_kernel
  .amdhsa_next_free_vgpr 512
  .amdhsa_next_free_sgpr 102
  .amdhsa_accum_offset 256
  .amdhsa_group_segment_fixed_size 0
  .amdhsa_kernarg_size 128
  .amdhsa_user_sgpr_count 2
  .amdhsa_user_sgpr_kernarg_segment_ptr 1
  .amdhsa_system_sgpr_workgroup_id_x 1
  .amdhsa_float_denorm_mode_32 3
.end_amdhsa_kernel
```

```asm
; @launch grid=(256,1,1) block=(256,1,1) lds=163840
.amdgcn_target "amdgcn-amd-amdhsa--gfx950"
.text
.globl adaLN_cond__memory_aug_recurrent_mem_tr__glu_gated_swiglu__prompt_kernel
.p2align 8
.type adaLN_cond__memory_aug_recurrent_mem_tr__glu_gated_swiglu__prompt_kernel,@function
adaLN_cond__memory_aug_recurrent_mem_tr__glu_gated_swiglu__prompt_kernel:
s_cmp_ge_u32 s2, 256
s_cbranch_scc1 Lend_1
s_load_dwordx8 s[16:23], s[0:1], 8
s_load_dwordx2 s[24:25], s[0:1], 40
s_load_dwordx4 s[28:31], s[0:1], 112
s_getreg_b32 s51, hwreg(HW_REG_XCC_ID, 0, 4)
s_and_b32 s51, s51, 7
v_lshrrev_b32 v1, 6, v0
s_nop 0
v_readfirstlane_b32 s32, v1
v_and_b32 v1, 63, v0
s_waitcnt lgkmcnt(0)
s_mov_b32 s4, s30
s_and_b32 s5, s31, 0xffff
s_mov_b32 s6, 0x10000000
s_mov_b32 s7, 0x20000
s_mov_b32 s12, s28
s_and_b32 s13, s29, 0xffff
s_mov_b32 s14, 0x100
s_mov_b32 s15, 0x20000
s_mov_b32 s37, 200000
s_mov_b32 s80, 0
s_mov_b32 s81, 0
s_mov_b32 s82, 0
s_mov_b32 s83, 0
s_cmp_lg_u32 s32, 0
s_cbranch_scc1 Lrs_10
s_mov_b32 s33, s51
s_mov_b32 s35, 0
s_mov_b64 exec, 1
Lrl_9:
v_lshlrev_b32 v2, 2, s33
v_mov_b32 v3, 1
buffer_atomic_add v3, v2, s[12:15], 0 offen sc0 sc1
s_waitcnt vmcnt(0)
v_readfirstlane_b32 s34, v3
s_nop 3
s_cmp_lt_u32 s34, 32
s_cbranch_scc1 Lrg_8
s_add_u32 s33, s33, 1
s_and_b32 s33, s33, 7
s_add_u32 s35, s35, 1
s_cmp_lt_u32 s35, 8
s_cbranch_scc1 Lrl_9
Lrg_8:
s_lshl_b32 s38, s33, 8
s_min_u32 s34, s34, 255
s_or_b32 s38, s38, s34
s_lshl_b32 s39, s35, 16
s_or_b32 s38, s38, s39
v_mov_b32 v3, s38
v_mov_b32 v2, 0
ds_write_b32 v2, v3
s_mov_b64 exec, -1
Lrs_10:
s_waitcnt lgkmcnt(0)
s_barrier
v_mov_b32 v2, 0
ds_read_b32 v3, v2
s_waitcnt lgkmcnt(0)
v_readfirstlane_b32 s38, v3
s_barrier
s_and_b32 s34, s38, 255
s_bfe_u32 s33, s38, 0x80008
s_lshr_b32 s35, s38, 16
s_min_u32 s35, s35, 1
s_cmp_ge_u32 s34, 32
s_cbranch_scc1 Lend_1
s_cmp_ge_u32 s33, 4
s_cbranch_scc1 Lhi_4
s_cmp_ge_u32 s34, 24
s_cbranch_scc1 Lg3_3
s_cmp_ge_u32 s34, 8
s_cbranch_scc1 Lkvo_2
v_mov_b32 v48, v0
v_mov_b32 v50, v1
s_lshl_b32 s54, s33, 3
s_add_u32 s54, s54, s34
s_and_b32 s55, s32, 1
s_lshr_b32 s56, s32, 1
s_lshl_b32 s45, s33, 18
s_add_u32 s45, s45, 2097152
s_lshl_b32 s38, s32, 12
v_lshl_add_u32 v10, v50, 4, s38
s_lshl_b32 s38, s34, 11
s_add_u32 s39, s38, 16384
v_lshl_add_u32 v11, v50, 4, s39
s_lshl_b32 s39, s56, 10
s_add_u32 s38, s38, s39
s_lshl_b32 s39, s55, 3
s_add_u32 s39, s39, s38
s_add_u32 s39, s39, 32768
v_lshl_add_u32 v12, v50, 4, s39
v_xor_b32 v13, 8, v12
s_lshl_b32 s39, s55, 9
s_add_u32 s39, s39, s38
s_add_u32 s39, s39, 49152
v_bfe_u32 v51, v50, 5, 1
v_lshl_add_u32 v14, v51, 8, s39
v_and_b32 v51, 7, v50
v_lshl_add_u32 v14, v51, 5, v14
v_and_b32 v51, 16, v50
v_add_u32 v14, v14, v51
v_bfe_u32 v51, v50, 3, 1
v_lshl_add_u32 v14, v51, 30, v14
v_and_b32 v51, 1, v50
v_mul_u32_u24 v51, 0xaaaa, v51
v_add_u32 v15, 0x4444, v51
v_mov_b32 v200, 0
v_mov_b32 v201, 0
v_mov_b32 v202, 0
v_mov_b32 v203, 0
v_mov_b32 v204, 0
v_mov_b32 v205, 0
v_mov_b32 v206, 0
v_mov_b32 v207, 0
v_bfe_u32 v51, v50, 1, 2
v_lshlrev_b32 v51, 4, v51
v_bfe_u32 v52, v50, 3, 2
v_lshl_add_u32 v51, v52, 2, v51
v_and_b32 v53, 1, v50
v_lshlrev_b32 v51, 2, v51
v_mul_u32_u24 v53, 384, v53
v_lshrrev_b32 v54, 5, v50
v_mul_u32_u24 v52, 640, v54
v_add3_u32 v51, v51, v52, v53
s_mul_i32 s38, s32, 1280
v_add_u32 v18, s38, v51
v_and_b32 v51, 31, v50
v_lshlrev_b32 v51, 4, v51
v_lshl_add_u32 v51, v54, 3, v51
s_lshl_b32 s38, s32, 9
v_add_u32 v19, s38, v51
v_lshrrev_b32 v51, 4, v50
v_and_b32 v52, 7, v50
v_lshlrev_b32 v52, 4, v52
v_lshl_add_u32 v20, v51, 7, v52
v_lshlrev_b32 v51, 4, v50
s_mul_i32 s38, s32, 6144
v_add_u32 v21, s38, v51
s_add_u32 s57, s38, 32768
v_add_u32 v22, 40960, v51
s_lshl_b32 s38, s55, 12
s_add_u32 s38, s38, 32768
v_add_u32 v23, s38, v51
s_lshl_b32 s38, s32, 11
s_add_u32 s38, s38, 49152
v_add_u32 v24, s38, v51
v_xor_b32 v25, 2048, v24
s_lshl_b32 s59, s33, 12
s_add_u32 s59, s59, 3276800
s_lshl_b32 s38, s32, 8
v_lshl_add_u32 v192, v50, 2, s38
s_lshr_b32 s38, s34, 1
s_lshl_b32 s38, s38, 8
s_and_b32 s39, s34, 1
s_lshl_b32 s39, s39, 2
s_add_u32 s38, s38, s39
s_add_u32 s38, s38, 2048
v_min_u32 v52, 1, v48
v_lshl_add_u32 v193, v52, 30, s38
v_mov_b32 v197, 0
buffer_store_dword v197, v193, s[4:7], s59 offen sc1
s_lshr_b32 s38, s34, 2
s_lshl_b32 s38, s38, 14
s_and_b32 s39, s34, 3
s_lshl_b32 s39, s39, 11
s_add_u32 s38, s38, s39
s_lshl_b32 s39, s33, 16
s_add_u32 s38, s38, s39
v_lshl_add_u32 v198, v48, 3, s38
s_lshl_b32 s38, s54, 2
s_add_u32 s38, s38, s32
s_lshl_b32 s38, s38, 11
s_lshl_b32 s39, s55, 10
s_add_u32 s38, s38, s39
v_add_u32 v26, s38, v51
v_xor_b32 v27, 2048, v26
s_lshl_b32 s38, s54, 5
s_add_u32 s38, s38, s32
s_lshl_b32 s38, s38, 2
s_add_u32 s38, s38, 3432448
v_min_u32 v52, 1, v50
v_lshl_add_u32 v199, v52, 30, s38
buffer_store_dword v197, v199, s[4:7], 0 offen sc1
v_min_u32 v53, 9, v50
v_lshlrev_b32 v53, 7, v53
s_lshl_b32 s38, s54, 8
s_add_u32 s38, s38, 3407872
v_add_u32 v208, s38, v53
s_lshl_b32 s38, s33, 10
s_add_u32 s38, s38, 3436288
v_add_u32 v53, s38, v53
v_cmp_lt_u32 vcc, 1, v50
s_nop 1
v_cndmask_b32 v208, v208, v53, vcc
v_cndmask_b32 v210, 0, 8, vcc
v_mov_b32 v28, -1
v_mov_b32 v32, 0x3f803f80
v_mov_b32 v29, -1
v_mov_b32 v33, 0x3f803f80
v_mov_b32 v30, -1
v_mov_b32 v34, 0x3f803f80
v_mov_b32 v31, -1
v_mov_b32 v35, 0x3f803f80
v_and_b32 v51, 15, v50
s_lshl_b32 s38, s55, 4
v_add_u32 v51, s38, v51
v_lshrrev_b32 v52, 4, v50
v_lshlrev_b32 v52, 2, v52
v_mov_b32 v54, 0xf149f2ca
v_add_u32 v53, 0, v52
v_cmp_gt_u32 vcc, v53, v51
s_nop 1
v_cndmask_b32 v36, 0, v54, vcc
v_add_u32 v53, 1, v52
v_cmp_gt_u32 vcc, v53, v51
s_nop 1
v_cndmask_b32 v37, 0, v54, vcc
v_add_u32 v53, 2, v52
v_cmp_gt_u32 vcc, v53, v51
s_nop 1
v_cndmask_b32 v38, 0, v54, vcc
v_add_u32 v53, 3, v52
v_cmp_gt_u32 vcc, v53, v51
s_nop 1
v_cndmask_b32 v39, 0, v54, vcc
v_add_u32 v53, 16, v52
v_cmp_gt_u32 vcc, v53, v51
s_nop 1
v_cndmask_b32 v40, 0, v54, vcc
v_add_u32 v53, 17, v52
v_cmp_gt_u32 vcc, v53, v51
s_nop 1
v_cndmask_b32 v41, 0, v54, vcc
v_add_u32 v53, 18, v52
v_cmp_gt_u32 vcc, v53, v51
s_nop 1
v_cndmask_b32 v42, 0, v54, vcc
v_add_u32 v53, 19, v52
v_cmp_gt_u32 vcc, v53, v51
s_nop 1
v_cndmask_b32 v43, 0, v54, vcc
v_mov_b32 v0, 0
v_mov_b32 v1, 0
v_mov_b32 v2, 0
v_mov_b32 v3, 0
v_mov_b32 v4, 0
v_mov_b32 v5, 0
v_mov_b32 v6, 0
v_mov_b32 v7, 0
v_mov_b32 v8, 0
v_mov_b32 v9, 0
s_mov_b32 s48, 0x3e0293ee
s_mov_b32 s49, 0xbe0293ee
s_add_u32 s38, s45, 0
buffer_store_dwordx4 v[28:31], v14, s[4:7], s38 offen sc1
s_add_u32 s38, s45, 65536
buffer_store_dwordx4 v[28:31], v14, s[4:7], s38 offen sc1
s_add_u32 s38, s45, 131072
buffer_store_dwordx4 v[28:31], v14, s[4:7], s38 offen sc1
s_add_u32 s38, s45, 196608
buffer_store_dwordx4 v[28:31], v14, s[4:7], s38 offen sc1
s_lshl_b32 s52, s35, 16
s_or_b32 s52, s52, 1
s_waitcnt vmcnt(0)
s_barrier
s_cmp_lg_u32 s32, 0
s_cbranch_scc1 Lar_11
s_mov_b64 exec, 1
v_mov_b32 v48, 32
v_mov_b32 v49, s52
buffer_atomic_add v49, v48, s[12:15], 0 offen sc1
s_mov_b64 exec, -1
Lar_11:
v_lshrrev_b32 v55, 3, v50
v_and_b32 v56, 7, v50
v_lshlrev_b32 v56, 4, v56
v_lshl_add_u32 v51, v55, 13, v56
v_lshl_add_u32 v52, v55, 11, v56
s_mul_i32 s38, s32, 40960
v_and_b32 v56, 3, v50
v_lshl_add_u32 v56, v56, 3, s38
v_lshrrev_b32 v55, 2, v50
v_lshl_add_u32 v53, v55, 7, v56
v_and_b32 v54, 16, v50
v_bfe_u32 v55, v50, 5, 1
v_lshl_add_u32 v54, v55, 3, v54
v_bfe_u32 v55, v50, 3, 1
v_lshl_add_u32 v54, v55, 2, v54
v_bfe_u32 v55, v50, 2, 1
v_add_u32 v54, v54, v55
v_lshl_add_u32 v54, v54, 7, v56
s_mov_b32 s8, s18
s_and_b32 s9, s19, 0xffff
s_mov_b32 s10, 0x800000
s_mov_b32 s11, 0x20000
s_lshl_b32 s39, s32, 21
s_lshl_b32 s38, s54, 8
s_add_u32 s39, s39, s38
s_add_u32 s39, s39, 0
s_mul_i32 s38, s32, 40960
s_add_u32 m0, s38, 0
s_nop 0
buffer_load_dwordx4 v51, s[8:11], s39 offen lds
s_add_u32 m0, m0, 1024
s_add_u32 s39, s39, 65536
buffer_load_dwordx4 v51, s[8:11], s39 offen lds
s_add_u32 m0, m0, 1024
s_add_u32 s39, s39, 65536
buffer_load_dwordx4 v51, s[8:11], s39 offen lds
s_add_u32 m0, m0, 1024
s_add_u32 s39, s39, 65536
buffer_load_dwordx4 v51, s[8:11], s39 offen lds
s_add_u32 m0, m0, 1024
s_add_u32 s39, s39, 65536
buffer_load_dwordx4 v51, s[8:11], s39 offen lds
s_add_u32 m0, m0, 1024
s_add_u32 s39, s39, 65536
buffer_load_dwordx4 v51, s[8:11], s39 offen lds
s_add_u32 m0, m0, 1024
s_add_u32 s39, s39, 65536
buffer_load_dwordx4 v51, s[8:11], s39 offen lds
s_add_u32 m0, m0, 1024
s_add_u32 s39, s39, 65536
buffer_load_dwordx4 v51, s[8:11], s39 offen lds
s_lshl_b32 s39, s32, 21
s_lshl_b32 s38, s54, 8
s_add_u32 s39, s39, s38
s_add_u32 s39, s39, 128
s_mul_i32 s38, s32, 40960
s_add_u32 m0, s38, 8192
s_nop 0
buffer_load_dwordx4 v51, s[8:11], s39 offen lds
s_add_u32 m0, m0, 1024
s_add_u32 s39, s39, 65536
buffer_load_dwordx4 v51, s[8:11], s39 offen lds
s_add_u32 m0, m0, 1024
s_add_u32 s39, s39, 65536
buffer_load_dwordx4 v51, s[8:11], s39 offen lds
s_add_u32 m0, m0, 1024
s_add_u32 s39, s39, 65536
buffer_load_dwordx4 v51, s[8:11], s39 offen lds
s_add_u32 m0, m0, 1024
s_add_u32 s39, s39, 65536
buffer_load_dwordx4 v51, s[8:11], s39 offen lds
s_add_u32 m0, m0, 1024
s_add_u32 s39, s39, 65536
buffer_load_dwordx4 v51, s[8:11], s39 offen lds
s_add_u32 m0, m0, 1024
s_add_u32 s39, s39, 65536
buffer_load_dwordx4 v51, s[8:11], s39 offen lds
s_add_u32 m0, m0, 1024
s_add_u32 s39, s39, 65536
buffer_load_dwordx4 v51, s[8:11], s39 offen lds
s_lshl_b32 s39, s32, 21
s_lshl_b32 s38, s54, 8
s_add_u32 s39, s39, s38
s_add_u32 s39, s39, 524288
s_mul_i32 s38, s32, 40960
s_add_u32 m0, s38, 16384
s_nop 0
buffer_load_dwordx4 v51, s[8:11], s39 offen lds
s_add_u32 m0, m0, 1024
s_add_u32 s39, s39, 65536
buffer_load_dwordx4 v51, s[8:11], s39 offen lds
s_add_u32 m0, m0, 1024
s_add_u32 s39, s39, 65536
buffer_load_dwordx4 v51, s[8:11], s39 offen lds
s_add_u32 m0, m0, 1024
s_add_u32 s39, s39, 65536
buffer_load_dwordx4 v51, s[8:11], s39 offen lds
s_add_u32 m0, m0, 1024
s_add_u32 s39, s39, 65536
buffer_load_dwordx4 v51, s[8:11], s39 offen lds
s_add_u32 m0, m0, 1024
s_add_u32 s39, s39, 65536
buffer_load_dwordx4 v51, s[8:11], s39 offen lds
s_add_u32 m0, m0, 1024
s_add_u32 s39, s39, 65536
buffer_load_dwordx4 v51, s[8:11], s39 offen lds
s_add_u32 m0, m0, 1024
s_add_u32 s39, s39, 65536
buffer_load_dwordx4 v51, s[8:11], s39 offen lds
s_lshl_b32 s39, s32, 21
s_lshl_b32 s38, s54, 8
s_add_u32 s39, s39, s38
s_add_u32 s39, s39, 524416
s_mul_i32 s38, s32, 40960
s_add_u32 m0, s38, 24576
s_nop 0
buffer_load_dwordx4 v51, s[8:11], s39 offen lds
s_add_u32 m0, m0, 1024
s_add_u32 s39, s39, 65536
buffer_load_dwordx4 v51, s[8:11], s39 offen lds
s_add_u32 m0, m0, 1024
s_add_u32 s39, s39, 65536
buffer_load_dwordx4 v51, s[8:11], s39 offen lds
s_add_u32 m0, m0, 1024
s_add_u32 s39, s39, 65536
buffer_load_dwordx4 v51, s[8:11], s39 offen lds
s_add_u32 m0, m0, 1024
s_add_u32 s39, s39, 65536
buffer_load_dwordx4 v51, s[8:11], s39 offen lds
s_add_u32 m0, m0, 1024
s_add_u32 s39, s39, 65536
buffer_load_dwordx4 v51, s[8:11], s39 offen lds
s_add_u32 m0, m0, 1024
s_add_u32 s39, s39, 65536
buffer_load_dwordx4 v51, s[8:11], s39 offen lds
s_add_u32 m0, m0, 1024
s_add_u32 s39, s39, 65536
buffer_load_dwordx4 v51, s[8:11], s39 offen lds
s_lshl_b32 s39, s32, 21
s_lshl_b32 s38, s54, 8
s_add_u32 s39, s39, s38
s_add_u32 s39, s39, 1048576
s_mul_i32 s38, s32, 40960
s_add_u32 m0, s38, 32768
s_nop 0
buffer_load_dwordx4 v51, s[8:11], s39 offen lds
s_add_u32 m0, m0, 1024
s_add_u32 s39, s39, 65536
buffer_load_dwordx4 v51, s[8:11], s39 offen lds
s_add_u32 m0, m0, 1024
s_add_u32 s39, s39, 65536
buffer_load_dwordx4 v51, s[8:11], s39 offen lds
s_add_u32 m0, m0, 1024
s_add_u32 s39, s39, 65536
buffer_load_dwordx4 v51, s[8:11], s39 offen lds
s_add_u32 m0, m0, 1024
s_add_u32 s39, s39, 65536
buffer_load_dwordx4 v51, s[8:11], s39 offen lds
s_add_u32 m0, m0, 1024
s_add_u32 s39, s39, 65536
buffer_load_dwordx4 v51, s[8:11], s39 offen lds
s_add_u32 m0, m0, 1024
s_add_u32 s39, s39, 65536
buffer_load_dwordx4 v51, s[8:11], s39 offen lds
s_add_u32 m0, m0, 1024
s_add_u32 s39, s39, 65536
buffer_load_dwordx4 v51, s[8:11], s39 offen lds
s_waitcnt vmcnt(32)
ds_read_b64_tr_b16 a[0:1], v53 offset:0
ds_read_b64_tr_b16 a[2:3], v53 offset:2048
ds_read_b64_tr_b16 a[4:5], v53 offset:4096
ds_read_b64_tr_b16 a[6:7], v53 offset:6144
ds_read_b64_tr_b16 a[8:9], v53 offset:32
ds_read_b64_tr_b16 a[10:11], v53 offset:2080
ds_read_b64_tr_b16 a[12:13], v53 offset:4128
ds_read_b64_tr_b16 a[14:15], v53 offset:6176
ds_read_b64_tr_b16 a[16:17], v53 offset:64
ds_read_b64_tr_b16 a[18:19], v53 offset:2112
ds_read_b64_tr_b16 a[20:21], v53 offset:4160
ds_read_b64_tr_b16 a[22:23], v53 offset:6208
ds_read_b64_tr_b16 a[24:25], v53 offset:96
ds_read_b64_tr_b16 a[26:27], v53 offset:2144
ds_read_b64_tr_b16 a[28:29], v53 offset:4192
ds_read_b64_tr_b16 a[30:31], v53 offset:6240
s_waitcnt lgkmcnt(0)
s_lshl_b32 s39, s32, 21
s_lshl_b32 s38, s54, 8
s_add_u32 s39, s39, s38
s_add_u32 s39, s39, 1048704
s_mul_i32 s38, s32, 40960
s_add_u32 m0, s38, 0
s_nop 0
buffer_load_dwordx4 v51, s[8:11], s39 offen lds
s_add_u32 m0, m0, 1024
s_add_u32 s39, s39, 65536
buffer_load_dwordx4 v51, s[8:11], s39 offen lds
s_add_u32 m0, m0, 1024
s_add_u32 s39, s39, 65536
buffer_load_dwordx4 v51, s[8:11], s39 offen lds
s_add_u32 m0, m0, 1024
s_add_u32 s39, s39, 65536
buffer_load_dwordx4 v51, s[8:11], s39 offen lds
s_add_u32 m0, m0, 1024
s_add_u32 s39, s39, 65536
buffer_load_dwordx4 v51, s[8:11], s39 offen lds
s_add_u32 m0, m0, 1024
s_add_u32 s39, s39, 65536
buffer_load_dwordx4 v51, s[8:11], s39 offen lds
s_add_u32 m0, m0, 1024
s_add_u32 s39, s39, 65536
buffer_load_dwordx4 v51, s[8:11], s39 offen lds
s_add_u32 m0, m0, 1024
s_add_u32 s39, s39, 65536
buffer_load_dwordx4 v51, s[8:11], s39 offen lds
s_waitcnt vmcnt(32)
ds_read_b64_tr_b16 a[32:33], v53 offset:8192
ds_read_b64_tr_b16 a[34:35], v53 offset:10240
ds_read_b64_tr_b16 a[36:37], v53 offset:12288
ds_read_b64_tr_b16 a[38:39], v53 offset:14336
ds_read_b64_tr_b16 a[40:41], v53 offset:8224
ds_read_b64_tr_b16 a[42:43], v53 offset:10272
ds_read_b64_tr_b16 a[44:45], v53 offset:12320
ds_read_b64_tr_b16 a[46:47], v53 offset:14368
ds_read_b64_tr_b16 a[48:49], v53 offset:8256
ds_read_b64_tr_b16 a[50:51], v53 offset:10304
ds_read_b64_tr_b16 a[52:53], v53 offset:12352
ds_read_b64_tr_b16 a[54:55], v53 offset:14400
ds_read_b64_tr_b16 a[56:57], v53 offset:8288
ds_read_b64_tr_b16 a[58:59], v53 offset:10336
ds_read_b64_tr_b16 a[60:61], v53 offset:12384
ds_read_b64_tr_b16 a[62:63], v53 offset:14432
s_waitcnt lgkmcnt(0)
s_lshl_b32 s39, s32, 21
s_lshl_b32 s38, s54, 8
s_add_u32 s39, s39, s38
s_add_u32 s39, s39, 1572864
s_mul_i32 s38, s32, 40960
s_add_u32 m0, s38, 8192
s_nop 0
buffer_load_dwordx4 v51, s[8:11], s39 offen lds
s_add_u32 m0, m0, 1024
s_add_u32 s39, s39, 65536
buffer_load_dwordx4 v51, s[8:11], s39 offen lds
s_add_u32 m0, m0, 1024
s_add_u32 s39, s39, 65536
buffer_load_dwordx4 v51, s[8:11], s39 offen lds
s_add_u32 m0, m0, 1024
s_add_u32 s39, s39, 65536
buffer_load_dwordx4 v51, s[8:11], s39 offen lds
s_add_u32 m0, m0, 1024
s_add_u32 s39, s39, 65536
buffer_load_dwordx4 v51, s[8:11], s39 offen lds
s_add_u32 m0, m0, 1024
s_add_u32 s39, s39, 65536
buffer_load_dwordx4 v51, s[8:11], s39 offen lds
s_add_u32 m0, m0, 1024
s_add_u32 s39, s39, 65536
buffer_load_dwordx4 v51, s[8:11], s39 offen lds
s_add_u32 m0, m0, 1024
s_add_u32 s39, s39, 65536
buffer_load_dwordx4 v51, s[8:11], s39 offen lds
s_waitcnt vmcnt(32)
ds_read_b64_tr_b16 a[64:65], v53 offset:16384
ds_read_b64_tr_b16 a[66:67], v53 offset:18432
ds_read_b64_tr_b16 a[68:69], v53 offset:20480
ds_read_b64_tr_b16 a[70:71], v53 offset:22528
ds_read_b64_tr_b16 a[72:73], v53 offset:16416
ds_read_b64_tr_b16 a[74:75], v53 offset:18464
ds_read_b64_tr_b16 a[76:77], v53 offset:20512
ds_read_b64_tr_b16 a[78:79], v53 offset:22560
ds_read_b64_tr_b16 a[80:81], v53 offset:16448
ds_read_b64_tr_b16 a[82:83], v53 offset:18496
ds_read_b64_tr_b16 a[84:85], v53 offset:20544
ds_read_b64_tr_b16 a[86:87], v53 offset:22592
ds_read_b64_tr_b16 a[88:89], v53 offset:16480
ds_read_b64_tr_b16 a[90:91], v53 offset:18528
ds_read_b64_tr_b16 a[92:93], v53 offset:20576
ds_read_b64_tr_b16 a[94:95], v53 offset:22624
s_waitcnt lgkmcnt(0)
s_lshl_b32 s39, s32, 21
s_lshl_b32 s38, s54, 8
s_add_u32 s39, s39, s38
s_add_u32 s39, s39, 1572992
s_mul_i32 s38, s32, 40960
s_add_u32 m0, s38, 16384
s_nop 0
buffer_load_dwordx4 v51, s[8:11], s39 offen lds
s_add_u32 m0, m0, 1024
s_add_u32 s39, s39, 65536
buffer_load_dwordx4 v51, s[8:11], s39 offen lds
s_add_u32 m0, m0, 1024
s_add_u32 s39, s39, 65536
buffer_load_dwordx4 v51, s[8:11], s39 offen lds
s_add_u32 m0, m0, 1024
s_add_u32 s39, s39, 65536
buffer_load_dwordx4 v51, s[8:11], s39 offen lds
s_add_u32 m0, m0, 1024
s_add_u32 s39, s39, 65536
buffer_load_dwordx4 v51, s[8:11], s39 offen lds
s_add_u32 m0, m0, 1024
s_add_u32 s39, s39, 65536
buffer_load_dwordx4 v51, s[8:11], s39 offen lds
s_add_u32 m0, m0, 1024
s_add_u32 s39, s39, 65536
buffer_load_dwordx4 v51, s[8:11], s39 offen lds
s_add_u32 m0, m0, 1024
s_add_u32 s39, s39, 65536
buffer_load_dwordx4 v51, s[8:11], s39 offen lds
s_waitcnt vmcnt(32)
ds_read_b64_tr_b16 a[96:97], v53 offset:24576
ds_read_b64_tr_b16 a[98:99], v53 offset:26624
ds_read_b64_tr_b16 a[100:101], v53 offset:28672
ds_read_b64_tr_b16 a[102:103], v53 offset:30720
ds_read_b64_tr_b16 a[104:105], v53 offset:24608
ds_read_b64_tr_b16 a[106:107], v53 offset:26656
ds_read_b64_tr_b16 a[108:109], v53 offset:28704
ds_read_b64_tr_b16 a[110:111], v53 offset:30752
ds_read_b64_tr_b16 a[112:113], v53 offset:24640
ds_read_b64_tr_b16 a[114:115], v53 offset:26688
ds_read_b64_tr_b16 a[116:117], v53 offset:28736
ds_read_b64_tr_b16 a[118:119], v53 offset:30784
ds_read_b64_tr_b16 a[120:121], v53 offset:24672
ds_read_b64_tr_b16 a[122:123], v53 offset:26720
ds_read_b64_tr_b16 a[124:125], v53 offset:28768
ds_read_b64_tr_b16 a[126:127], v53 offset:30816
s_waitcnt lgkmcnt(0)
s_waitcnt vmcnt(24)
ds_read_b64_tr_b16 a[128:129], v53 offset:32768
ds_read_b64_tr_b16 a[130:131], v53 offset:34816
ds_read_b64_tr_b16 a[132:133], v53 offset:36864
ds_read_b64_tr_b16 a[134:135], v53 offset:38912
ds_read_b64_tr_b16 a[136:137], v53 offset:32800
ds_read_b64_tr_b16 a[138:139], v53 offset:34848
ds_read_b64_tr_b16 a[140:141], v53 offset:36896
ds_read_b64_tr_b16 a[142:143], v53 offset:38944
ds_read_b64_tr_b16 a[144:145], v53 offset:32832
ds_read_b64_tr_b16 a[146:147], v53 offset:34880
ds_read_b64_tr_b16 a[148:149], v53 offset:36928
ds_read_b64_tr_b16 a[150:151], v53 offset:38976
ds_read_b64_tr_b16 a[152:153], v53 offset:32864
ds_read_b64_tr_b16 a[154:155], v53 offset:34912
ds_read_b64_tr_b16 a[156:157], v53 offset:36960
ds_read_b64_tr_b16 a[158:159], v53 offset:39008
s_waitcnt lgkmcnt(0)
s_waitcnt vmcnt(16)
ds_read_b64_tr_b16 a[160:161], v53 offset:0
ds_read_b64_tr_b16 a[162:163], v53 offset:2048
ds_read_b64_tr_b16 a[164:165], v53 offset:4096
ds_read_b64_tr_b16 a[166:167], v53 offset:6144
ds_read_b64_tr_b16 a[168:169], v53 offset:32
ds_read_b64_tr_b16 a[170:171], v53 offset:2080
ds_read_b64_tr_b16 a[172:173], v53 offset:4128
ds_read_b64_tr_b16 a[174:175], v53 offset:6176
ds_read_b64_tr_b16 a[176:177], v53 offset:64
ds_read_b64_tr_b16 a[178:179], v53 offset:2112
ds_read_b64_tr_b16 a[180:181], v53 offset:4160
ds_read_b64_tr_b16 a[182:183], v53 offset:6208
ds_read_b64_tr_b16 a[184:185], v53 offset:96
ds_read_b64_tr_b16 a[186:187], v53 offset:2144
ds_read_b64_tr_b16 a[188:189], v53 offset:4192
ds_read_b64_tr_b16 a[190:191], v53 offset:6240
s_waitcnt lgkmcnt(0)
s_waitcnt vmcnt(8)
ds_read_b64_tr_b16 a[192:193], v53 offset:8192
ds_read_b64_tr_b16 a[194:195], v53 offset:10240
ds_read_b64_tr_b16 a[196:197], v53 offset:12288
ds_read_b64_tr_b16 a[198:199], v53 offset:14336
ds_read_b64_tr_b16 a[200:201], v53 offset:8224
ds_read_b64_tr_b16 a[202:203], v53 offset:10272
ds_read_b64_tr_b16 a[204:205], v53 offset:12320
ds_read_b64_tr_b16 a[206:207], v53 offset:14368
ds_read_b64_tr_b16 a[208:209], v53 offset:8256
ds_read_b64_tr_b16 a[210:211], v53 offset:10304
ds_read_b64_tr_b16 a[212:213], v53 offset:12352
ds_read_b64_tr_b16 a[214:215], v53 offset:14400
ds_read_b64_tr_b16 a[216:217], v53 offset:8288
ds_read_b64_tr_b16 a[218:219], v53 offset:10336
ds_read_b64_tr_b16 a[220:221], v53 offset:12384
ds_read_b64_tr_b16 a[222:223], v53 offset:14432
s_waitcnt lgkmcnt(0)
s_waitcnt vmcnt(0)
ds_read_b64_tr_b16 a[224:225], v53 offset:16384
ds_read_b64_tr_b16 a[226:227], v53 offset:18432
ds_read_b64_tr_b16 a[228:229], v53 offset:20480
ds_read_b64_tr_b16 a[230:231], v53 offset:22528
ds_read_b64_tr_b16 a[232:233], v53 offset:16416
ds_read_b64_tr_b16 a[234:235], v53 offset:18464
ds_read_b64_tr_b16 a[236:237], v53 offset:20512
ds_read_b64_tr_b16 a[238:239], v53 offset:22560
ds_read_b64_tr_b16 a[240:241], v53 offset:16448
ds_read_b64_tr_b16 a[242:243], v53 offset:18496
ds_read_b64_tr_b16 a[244:245], v53 offset:20544
ds_read_b64_tr_b16 a[246:247], v53 offset:22592
ds_read_b64_tr_b16 a[248:249], v53 offset:16480
ds_read_b64_tr_b16 a[250:251], v53 offset:18528
ds_read_b64_tr_b16 a[252:253], v53 offset:20576
ds_read_b64_tr_b16 a[254:255], v53 offset:22624
s_waitcnt lgkmcnt(0)
v_mov_b32 v48, 32
Lst_12:
s_sub_u32 s37, s37, 1
s_cbranch_scc1 Lend_1
s_sleep 4
buffer_load_dword v49, v48, s[12:15], 0 offen sc1
s_waitcnt vmcnt(0)
v_readfirstlane_b32 s38, v49
s_nop 3
s_and_b32 s39, s38, 0xffff
s_cmp_lg_u32 s39, 256
s_cbranch_scc1 Lst_12
s_bfe_u32 s35, s38, 0x80010
s_bfe_u32 s46, s38, 0x10018
s_lshl_b32 s46, s46, 13
s_barrier
s_mul_i32 s47, s54, 24576
s_add_u32 s47, s47, 33554432
s_mov_b32 s36, 0
s_mov_b32 s27, 1
Lbw_13:
buffer_load_dword v209, v208, s[4:7], 0 offen sc1
s_waitcnt vmcnt(0)
v_add_u32 v209, v209, v210
v_cmp_gt_u32 vcc, s27, v209
s_cbranch_vccz Lbo_14
s_sub_u32 s37, s37, 1
s_cbranch_scc1 Lend_1
s_sleep 2
s_branch Lbw_13
Lbo_14:
s_mov_b32 m0, s57
s_add_u32 s38, s47, 3072
buffer_load_dwordx4 v21, s[4:7], s47 offen offset:0 sc1 lds
buffer_load_dwordx4 v21, s[4:7], s47 offen offset:1024 sc1 lds
buffer_load_dwordx4 v21, s[4:7], s47 offen offset:2048 sc1 lds
s_add_u32 m0, s57, 3072
s_xor_b32 s57, s57, 98304
buffer_load_dwordx4 v21, s[4:7], s38 offen offset:0 sc1 lds
buffer_load_dwordx4 v21, s[4:7], s38 offen offset:1024 sc1 lds
buffer_load_dwordx4 v21, s[4:7], s38 offen offset:2048 sc1 lds
s_add_u32 s47, s47, 786432
s_mov_b32 s27, 2
Lbw_15:
buffer_load_dword v209, v208, s[4:7], 0 offen sc1
s_waitcnt vmcnt(0)
v_add_u32 v209, v209, v210
v_cmp_gt_u32 vcc, s27, v209
s_cbranch_vccz Lbo_16
s_sub_u32 s37, s37, 1
s_cbranch_scc1 Lend_1
s_sleep 2
s_branch Lbw_15
Lbo_16:
s_mov_b32 m0, s57
s_add_u32 s38, s47, 3072
buffer_load_dwordx4 v21, s[4:7], s47 offen offset:0 sc1 lds
buffer_load_dwordx4 v21, s[4:7], s47 offen offset:1024 sc1 lds
buffer_load_dwordx4 v21, s[4:7], s47 offen offset:2048 sc1 lds
s_add_u32 m0, s57, 3072
s_xor_b32 s57, s57, 98304
buffer_load_dwordx4 v21, s[4:7], s38 offen offset:0 sc1 lds
buffer_load_dwordx4 v21, s[4:7], s38 offen offset:1024 sc1 lds
buffer_load_dwordx4 v21, s[4:7], s38 offen offset:2048 sc1 lds
s_add_u32 s47, s47, 786432
buffer_load_dword v209, v208, s[4:7], 0 offen sc1
s_waitcnt vmcnt(7)
s_barrier
s_cmp_lg_u32 s35, 0
s_cbranch_scc1 Lq_sc1_17
Lq_18:
ds_read_b128 v[128:131], v22 offset:0
ds_read_b128 v[132:135], v22 offset:1024
ds_read_b128 v[136:139], v22 offset:2048
ds_read_b128 v[140:143], v22 offset:3072
ds_read_b128 v[144:147], v22 offset:4096
ds_read_b128 v[148:151], v22 offset:5120
ds_read_b128 v[152:155], v22 offset:6144
ds_read_b128 v[156:159], v22 offset:7168
ds_read_b128 v[160:163], v24 offset:0
ds_read_b128 v[164:167], v24 offset:1024
ds_read_b128 v[168:171], v25 offset:0
ds_read_b128 v[172:175], v25 offset:1024
ds_read_b128 v[176:179], v23 offset:0
ds_read_b128 v[180:183], v23 offset:1024
ds_read_b128 v[184:187], v23 offset:2048
ds_read_b128 v[188:191], v23 offset:3072
v_xor_b32 v22, 98304, v22
v_xor_b32 v24, 98304, v24
v_xor_b32 v25, 98304, v25
v_xor_b32 v23, 98304, v23
s_mul_i32 m0, s32, 5120
s_and_b32 s38, s36, 3
s_lshl_b32 s39, s38, 16
s_add_u32 s40, s39, s45
s_xor_b32 s42, s40, 0x20000
s_add_u32 s26, s36, 1
v_pk_mul_f32 v[64:65], 0, 0
v_pk_mul_f32 v[66:67], 0, 0
v_pk_mul_f32 v[68:69], 0, 0
v_pk_mul_f32 v[70:71], 0, 0
v_pk_mul_f32 v[72:73], 0, 0
v_pk_mul_f32 v[74:75], 0, 0
v_pk_mul_f32 v[76:77], 0, 0
v_pk_mul_f32 v[78:79], 0, 0
v_pk_mul_f32 v[80:81], 0, 0
v_pk_mul_f32 v[82:83], 0, 0
v_pk_mul_f32 v[84:85], 0, 0
v_pk_mul_f32 v[86:87], 0, 0
v_pk_mul_f32 v[88:89], 0, 0
v_pk_mul_f32 v[90:91], 0, 0
v_pk_mul_f32 v[92:93], 0, 0
v_pk_mul_f32 v[94:95], 0, 0
s_waitcnt vmcnt(0)
buffer_store_dword v197, v199, s[4:7], 0 offen
v_add_u32 v197, 1, v197
s_mov_b64 exec, 15
buffer_load_dword v194, v192, s[4:7], s59 offen sc1
s_nop 11
buffer_load_dword v195, v192, s[4:7], s59 offen sc1
s_nop 11
buffer_load_dword v196, v192, s[4:7], s59 offen sc1
Lft_20:
s_waitcnt vmcnt(2)
v_cmp_gt_u32 vcc, s26, v194
s_cbranch_vccz Lfg_19
buffer_load_dword v194, v192, s[4:7], s59 offen sc1
s_waitcnt vmcnt(2)
v_cmp_gt_u32 vcc, s26, v195
s_cbranch_vccz Lfg_19
buffer_load_dword v195, v192, s[4:7], s59 offen sc1
s_waitcnt vmcnt(2)
v_cmp_gt_u32 vcc, s26, v196
s_cbranch_vccz Lfg_19
buffer_load_dword v196, v192, s[4:7], s59 offen sc1
s_sub_u32 s37, s37, 1
s_cbranch_scc1 Lend_1
s_branch Lft_20
Lfg_19:
s_mov_b64 exec, -1
buffer_load_dwordx4 v[48:51], v10, s[4:7], s40 offen offset:0 sc1
v_mfma_f32_16x16x32_bf16 v[200:203], v[204:207], v[204:207], 0
v_mfma_f32_16x16x32_bf16 v[200:203], v[204:207], v[204:207], 0
v_mfma_f32_16x16x32_bf16 v[200:203], v[204:207], v[204:207], 0
v_mfma_f32_16x16x32_bf16 v[200:203], v[204:207], v[204:207], 0
buffer_load_dwordx4 v[52:55], v10, s[4:7], s40 offen offset:1024 sc1
v_mfma_f32_16x16x32_bf16 v[200:203], v[204:207], v[204:207], 0
v_mfma_f32_16x16x32_bf16 v[200:203], v[204:207], v[204:207], 0
v_mfma_f32_16x16x32_bf16 v[200:203], v[204:207], v[204:207], 0
v_mfma_f32_16x16x32_bf16 v[200:203], v[204:207], v[204:207], 0
buffer_load_dwordx4 v[56:59], v10, s[4:7], s40 offen offset:2048 sc1
v_mfma_f32_16x16x32_bf16 v[200:203], v[204:207], v[204:207], 0
v_mfma_f32_16x16x32_bf16 v[200:203], v[204:207], v[204:207], 0
v_mfma_f32_16x16x32_bf16 v[200:203], v[204:207], v[204:207], 0
v_mfma_f32_16x16x32_bf16 v[200:203], v[204:207], v[204:207], 0
buffer_load_dwordx4 v[60:63], v10, s[4:7], s40 offen offset:3072 sc1
v_mfma_f32_16x16x32_bf16 v[200:203], v[204:207], v[204:207], 0
s_waitcnt vmcnt(3)
v_max3_u32 v44, v48, v49, v50
v_max_u32 v44, v44, v51
v_cmp_eq_u32 vcc, -1, v44
s_cbranch_vccnz Lpf_23
v_smfmac_f32_16x16x64_bf16 v[64:67], v[48:51], a[0:7], v15
v_smfmac_f32_16x16x64_bf16 v[68:71], v[48:51], a[8:15], v15
v_smfmac_f32_16x16x64_bf16 v[72:75], v[48:51], a[16:23], v15
v_smfmac_f32_16x16x64_bf16 v[76:79], v[48:51], a[24:31], v15
v_smfmac_f32_16x16x64_bf16 v[80:83], v[48:51], a[32:39], v15
s_waitcnt vmcnt(2)
v_max3_u32 v44, v52, v53, v54
v_max_u32 v44, v44, v55
v_cmp_eq_u32 vcc, -1, v44
v_smfmac_f32_16x16x64_bf16 v[84:87], v[48:51], a[40:47], v15
v_smfmac_f32_16x16x64_bf16 v[88:91], v[48:51], a[48:55], v15
v_smfmac_f32_16x16x64_bf16 v[92:95], v[48:51], a[56:63], v15
s_cbranch_vccnz Lpf_24
v_smfmac_f32_16x16x64_bf16 v[64:67], v[52:55], a[64:71], v15
v_smfmac_f32_16x16x64_bf16 v[68:71], v[52:55], a[72:79], v15
v_smfmac_f32_16x16x64_bf16 v[72:75], v[52:55], a[80:87], v15
v_smfmac_f32_16x16x64_bf16 v[76:79], v[52:55], a[88:95], v15
v_smfmac_f32_16x16x64_bf16 v[80:83], v[52:55], a[96:103], v15
s_waitcnt vmcnt(1)
v_max3_u32 v44, v56, v57, v58
v_max_u32 v44, v44, v59
v_cmp_eq_u32 vcc, -1, v44
v_smfmac_f32_16x16x64_bf16 v[84:87], v[52:55], a[104:111], v15
v_smfmac_f32_16x16x64_bf16 v[88:91], v[52:55], a[112:119], v15
v_smfmac_f32_16x16x64_bf16 v[92:95], v[52:55], a[120:127], v15
s_cbranch_vccnz Lpf_25
v_smfmac_f32_16x16x64_bf16 v[64:67], v[56:59], a[128:135], v15
v_smfmac_f32_16x16x64_bf16 v[68:71], v[56:59], a[136:143], v15
v_smfmac_f32_16x16x64_bf16 v[72:75], v[56:59], a[144:151], v15
v_smfmac_f32_16x16x64_bf16 v[76:79], v[56:59], a[152:159], v15
v_smfmac_f32_16x16x64_bf16 v[80:83], v[56:59], a[160:167], v15
s_waitcnt vmcnt(0)
v_max3_u32 v44, v60, v61, v62
v_max_u32 v44, v44, v63
v_cmp_eq_u32 vcc, -1, v44
v_smfmac_f32_16x16x64_bf16 v[84:87], v[56:59], a[168:175], v15
v_smfmac_f32_16x16x64_bf16 v[88:91], v[56:59], a[176:183], v15
v_smfmac_f32_16x16x64_bf16 v[92:95], v[56:59], a[184:191], v15
s_cbranch_vccnz Lpf_26
v_smfmac_f32_16x16x64_bf16 v[64:67], v[60:63], a[192:199], v15
v_smfmac_f32_16x16x64_bf16 v[68:71], v[60:63], a[200:207], v15
v_smfmac_f32_16x16x64_bf16 v[72:75], v[60:63], a[208:215], v15
v_smfmac_f32_16x16x64_bf16 v[76:79], v[60:63], a[216:223], v15
v_smfmac_f32_16x16x64_bf16 v[80:83], v[60:63], a[224:231], v15
v_smfmac_f32_16x16x64_bf16 v[84:87], v[60:63], a[232:239], v15
v_smfmac_f32_16x16x64_bf16 v[88:91], v[60:63], a[240:247], v15
v_smfmac_f32_16x16x64_bf16 v[92:95], v[60:63], a[248:255], v15
Lpd_22:
s_nop 0
v_add_f32 v64, v64, v65
v_add_f32 v66, v66, v67
v_add_f32 v68, v68, v69
v_add_f32 v70, v70, v71
v_add_f32 v72, v72, v73
ds_write_addtid_b32 v64 offset:0
v_add_f32 v74, v74, v75
ds_write_addtid_b32 v66 offset:384
v_add_f32 v76, v76, v77
ds_write_addtid_b32 v68 offset:640
v_add_f32 v78, v78, v79
ds_write_addtid_b32 v70 offset:1024
v_add_f32 v80, v80, v81
ds_write_addtid_b32 v72 offset:1280
v_add_f32 v82, v82, v83
ds_write_addtid_b32 v74 offset:1664
v_add_f32 v84, v84, v85
ds_write_addtid_b32 v76 offset:1920
v_add_f32 v86, v86, v87
ds_write_addtid_b32 v78 offset:2304
v_add_f32 v88, v88, v89
ds_write_addtid_b32 v80 offset:2560
v_add_f32 v90, v90, v91
ds_write_addtid_b32 v82 offset:2944
v_add_f32 v92, v92, v93
ds_write_addtid_b32 v84 offset:3200
v_add_f32 v94, v94, v95
ds_write_addtid_b32 v86 offset:3584
ds_write_addtid_b32 v88 offset:3840
ds_write_addtid_b32 v90 offset:4224
ds_write_addtid_b32 v92 offset:4480
ds_write_addtid_b32 v94 offset:4864
Lqj_21:
v_mfma_f32_16x16x32_bf16 v[200:203], v[204:207], v[204:207], 0
v_mfma_f32_16x16x32_bf16 v[200:203], v[204:207], v[204:207], 0
s_waitcnt lgkmcnt(0)
s_barrier
ds_read_b128 v[76:79], v18 offset:0
ds_read_b128 v[80:83], v18 offset:5120
ds_read_b128 v[84:87], v18 offset:10240
ds_read_b128 v[88:91], v18 offset:15360
v_mov_b32 v72, 0
v_mov_b32 v73, 0
v_mov_b32 v74, 0
v_mov_b32 v75, 0
v_mfma_f32_16x16x32_bf16 v[200:203], v[204:207], v[204:207], 0
v_mfma_f32_16x16x32_bf16 v[200:203], v[204:207], v[204:207], 0
s_waitcnt lgkmcnt(0)
v_pk_add_f32 v[76:77], v[76:77], v[80:81]
v_pk_add_f32 v[84:85], v[84:85], v[88:89]
v_pk_add_f32 v[78:79], v[78:79], v[82:83]
v_pk_add_f32 v[86:87], v[86:87], v[90:91]
v_pk_add_f32 v[76:77], v[76:77], v[84:85]
v_pk_add_f32 v[78:79], v[78:79], v[86:87]
v_cvt_pk_bf16_f32 v76, v76, v77
v_cvt_pk_bf16_f32 v77, v78, v79
ds_write_b64 v19, v[76:77] offset:20480
buffer_load_dwordx4 v[112:115], v11, s[4:7], s40 offen offset:0 sc1
buffer_load_dwordx4 v[116:119], v11, s[4:7], s40 offen offset:1024 sc1
v_mfma_f32_16x16x32_bf16 v[200:203], v[204:207], v[204:207], 0
v_mfma_f32_16x16x32_bf16 v[200:203], v[204:207], v[204:207], 0
s_waitcnt lgkmcnt(0)
s_barrier
ds_read_b128 v[96:99], v20 offset:20480
ds_read_b128 v[100:103], v20 offset:20992
ds_read_b128 v[104:107], v20 offset:21504
ds_read_b128 v[108:111], v20 offset:22016
v_mfma_f32_16x16x32_bf16 v[200:203], v[204:207], v[204:207], 0
v_mfma_f32_16x16x32_bf16 v[200:203], v[204:207], v[204:207], 0
s_waitcnt lgkmcnt(3)
v_mfma_f32_16x16x32_bf16 v[64:67], v[128:131], v[96:99], 0
v_mfma_f32_16x16x32_bf16 v[68:71], v[144:147], v[96:99], 0
s_waitcnt lgkmcnt(2)
buffer_load_dwordx4 v[48:51], v11, s[4:7], s40 offen offset:0 sc1
v_mfma_f32_16x16x32_bf16 v[64:67], v[132:135], v[100:103], v[64:67]
v_mfma_f32_16x16x32_bf16 v[68:71], v[148:151], v[100:103], v[68:71]
s_waitcnt lgkmcnt(1)
buffer_load_dwordx4 v[52:55], v11, s[4:7], s40 offen offset:1024 sc1
v_mfma_f32_16x16x32_bf16 v[64:67], v[136:139], v[104:107], v[64:67]
v_mfma_f32_16x16x32_bf16 v[68:71], v[152:155], v[104:107], v[68:71]
s_waitcnt lgkmcnt(0)
s_waitcnt vmcnt(2)
v_max3_u32 v44, v112, v113, v114
v_max3_u32 v44, v44, v115, v116
v_max3_u32 v44, v44, v117, v118
v_max_u32 v44, v44, v119
v_cmp_eq_u32 vcc, -1, v44
v_mfma_f32_16x16x32_bf16 v[64:67], v[140:143], v[108:111], v[64:67]
v_mfma_f32_16x16x32_bf16 v[68:71], v[156:159], v[108:111], v[68:71]
s_cbranch_vccnz Lkr_27
v_smfmac_f32_16x16x64_bf16 v[72:75], v[112:115], v[96:103], v15
v_smfmac_f32_16x16x64_bf16 v[72:75], v[116:119], v[104:111], v15
Lko_28:
s_nop 3
v_max3_f32 v45, v64, v65, v66
v_max3_f32 v45, v45, v67, v68
v_max3_f32 v45, v45, v69, v70
v_max_f32 v45, v45, v71
v_add_f32 v72, v72, v73
v_add_f32 v73, v74, v75
v_max3_f32 v46, v45, v72, v73
v_max3_f32 v47, v45, v72, v73
buffer_load_dwordx2 v[120:121], v12, s[4:7], s40 offen sc1
buffer_load_dwordx2 v[122:123], v13, s[4:7], s40 offen sc1
s_nop 1
v_permlane32_swap_b32 v46, v47
s_nop 0
v_max_f32 v45, v46, v47
v_max_f32 v46, v46, v47
s_nop 1
v_permlane16_swap_b32 v45, v46
s_nop 0
v_max_f32 v45, v45, v46
v_mul_f32 v46, s49, v45
v_pk_fma_f32 v[64:65], v[64:65], s[48:49], v[46:47] op_sel_hi:[1,0,0]
v_pk_fma_f32 v[66:67], v[66:67], s[48:49], v[46:47] op_sel_hi:[1,0,0]
v_pk_fma_f32 v[68:69], v[68:69], s[48:49], v[46:47] op_sel_hi:[1,0,0]
v_pk_fma_f32 v[70:71], v[70:71], s[48:49], v[46:47] op_sel_hi:[1,0,0]
v_pk_fma_f32 v[72:73], v[72:73], s[48:49], v[46:47] op_sel_hi:[1,0,0]
v_exp_f32 v64, v64
v_exp_f32 v65, v65
v_exp_f32 v66, v66
v_exp_f32 v67, v67
v_exp_f32 v68, v68
v_exp_f32 v69, v69
v_exp_f32 v70, v70
v_exp_f32 v71, v71
v_exp_f32 v72, v72
v_exp_f32 v73, v73
buffer_store_dword v197, v193, s[4:7], s59 offen
v_cvt_pk_bf16_f32 v76, v64, v65
v_cvt_pk_bf16_f32 v77, v66, v67
v_cvt_pk_bf16_f32 v78, v68, v69
v_cvt_pk_bf16_f32 v79, v70, v71
v_cvt_pk_bf16_f32 v2, v72, v73
v_cvt_pk_bf16_f32 v7, v72, v73
v_mfma_f32_16x16x32_bf16 v[84:87], v[32:35], v[76:79], 0
v_mfma_f32_16x16x32_bf16 v[96:99], v[160:163], v[76:79], 0
s_waitcnt vmcnt(1)
v_max3_u32 v44, v120, v121, v122
v_max_u32 v44, v44, v123
v_cmp_eq_u32 vcc, -1, v44
v_mfma_f32_16x16x32_bf16 v[100:103], v[164:167], v[76:79], 0
v_mfma_f32_16x16x32_bf16 v[84:87], v[32:35], v[2:5], v[84:87]
s_cbranch_vccnz Lvr_29
Lvo_30:
v_mfma_f32_16x16x32_bf16 v[96:99], v[120:123], v[2:5], v[96:99]
v_mfma_f32_16x16x32_bf16 v[100:103], v[120:123], v[6:9], v[100:103]
v_mfma_f32_16x16x32_bf16 v[200:203], v[204:207], v[204:207], 0
s_nop 4
v_rcp_f32 v46, v84
s_nop 0
v_pk_mul_f32 v[96:97], v[96:97], v[46:47] op_sel_hi:[1,0]
v_pk_mul_f32 v[98:99], v[98:99], v[46:47] op_sel_hi:[1,0]
v_pk_mul_f32 v[100:101], v[100:101], v[46:47] op_sel_hi:[1,0]
v_pk_mul_f32 v[102:103], v[102:103], v[46:47] op_sel_hi:[1,0]
v_cvt_pk_bf16_f32 v124, v96, v97
v_cvt_pk_bf16_f32 v125, v98, v99
v_cvt_pk_bf16_f32 v126, v100, v101
v_cvt_pk_bf16_f32 v127, v102, v103
v_min_u32 v124, -2, v124
v_min_u32 v125, -2, v125
v_min_u32 v126, -2, v126
v_min_u32 v127, -2, v127
buffer_store_dwordx4 v[124:127], v14, s[4:7], s40 offen
s_barrier
buffer_store_dwordx4 v[28:31], v14, s[4:7], s42 offen
s_cmp_ge_u32 s36, 62
s_cbranch_scc1 Lnp_31
s_add_u32 s27, s36, 3
v_add_u32 v209, v209, v210
v_cmp_gt_u32 vcc, s27, v209
s_cbranch_vccnz Lpw_32
Lpk_33:
s_mov_b32 m0, s57
s_add_u32 s38, s47, 3072
buffer_load_dwordx4 v21, s[4:7], s47 offen offset:0 sc1 lds
buffer_load_dwordx4 v21, s[4:7], s47 offen offset:1024 sc1 lds
buffer_load_dwordx4 v21, s[4:7], s47 offen offset:2048 sc1 lds
s_add_u32 m0, s57, 3072
s_xor_b32 s57, s57, 98304
buffer_load_dwordx4 v21, s[4:7], s38 offen offset:0 sc1 lds
buffer_load_dwordx4 v21, s[4:7], s38 offen offset:1024 sc1 lds
buffer_load_dwordx4 v21, s[4:7], s38 offen offset:2048 sc1 lds
s_add_u32 s47, s47, 786432
buffer_load_dword v209, v208, s[4:7], 0 offen sc1
s_add_u32 s38, s36, 2
s_and_b32 s38, s38, 3
s_lshl_b32 s88, s38, 18
s_add_u32 s88, s88, s46
s_add_u32 s89, s88, 0x100000
buffer_store_dwordx2 v[28:29], v198, s[4:7], s88 offen sc1
buffer_store_dwordx2 v[28:29], v198, s[4:7], s89 offen sc1
Lnp_31:
v_mov_b32 v72, 0
v_mov_b32 v73, 0
v_mov_b32 v74, 0
v_mov_b32 v75, 0
v_mfma_f32_16x16x32_bf16 v[64:67], v[128:131], v[176:179], v[36:39]
v_mfma_f32_16x16x32_bf16 v[68:71], v[144:147], v[176:179], v[40:43]
v_mfma_f32_16x16x32_bf16 v[64:67], v[132:135], v[180:183], v[64:67]
v_mfma_f32_16x16x32_bf16 v[68:71], v[148:151], v[180:183], v[68:71]
v_mfma_f32_16x16x32_bf16 v[64:67], v[136:139], v[184:187], v[64:67]
v_mfma_f32_16x16x32_bf16 v[68:71], v[152:155], v[184:187], v[68:71]
v_mfma_f32_16x16x32_bf16 v[64:67], v[140:143], v[188:191], v[64:67]
v_mfma_f32_16x16x32_bf16 v[68:71], v[156:159], v[188:191], v[68:71]
v_smfmac_f32_16x16x64_bf16 v[72:75], v[112:115], v[176:183], v15
v_smfmac_f32_16x16x64_bf16 v[72:75], v[116:119], v[184:191], v15
s_and_b32 s38, s36, 7
s_lshl_b32 s38, s38, 18
s_add_u32 s50, s38, 83886080
s_nop 2
v_max3_f32 v45, v64, v65, v66
v_max3_f32 v45, v45, v67, v68
v_max3_f32 v45, v45, v69, v70
v_max_f32 v45, v45, v71
v_add_f32 v72, v72, v73
v_add_f32 v73, v74, v75
v_max3_f32 v46, v45, v72, v73
v_max3_f32 v47, v45, v72, v73
s_nop 1
v_permlane32_swap_b32 v46, v47
s_nop 0
v_max_f32 v45, v46, v47
v_max_f32 v46, v46, v47
s_nop 1
v_permlane16_swap_b32 v45, v46
s_nop 0
v_max_f32 v45, v45, v46
v_mul_f32 v46, s49, v45
v_pk_fma_f32 v[64:65], v[64:65], s[48:49], v[46:47] op_sel_hi:[1,0,0]
v_pk_fma_f32 v[66:67], v[66:67], s[48:49], v[46:47] op_sel_hi:[1,0,0]
v_pk_fma_f32 v[68:69], v[68:69], s[48:49], v[46:47] op_sel_hi:[1,0,0]
v_pk_fma_f32 v[70:71], v[70:71], s[48:49], v[46:47] op_sel_hi:[1,0,0]
v_pk_fma_f32 v[72:73], v[72:73], s[48:49], v[46:47] op_sel_hi:[1,0,0]
v_exp_f32 v64, v64
v_exp_f32 v65, v65
v_exp_f32 v66, v66
v_exp_f32 v67, v67
v_exp_f32 v68, v68
v_exp_f32 v69, v69
v_exp_f32 v70, v70
v_exp_f32 v71, v71
v_exp_f32 v72, v72
v_exp_f32 v73, v73
v_cvt_pk_bf16_f32 v76, v64, v65
v_cvt_pk_bf16_f32 v77, v66, v67
v_cvt_pk_bf16_f32 v78, v68, v69
v_cvt_pk_bf16_f32 v79, v70, v71
v_cvt_pk_bf16_f32 v2, v72, v73
v_cvt_pk_bf16_f32 v7, v72, v73
v_mfma_f32_16x16x32_bf16 v[84:87], v[32:35], v[76:79], 0
v_mfma_f32_16x16x32_bf16 v[96:99], v[160:163], v[76:79], 0
v_mfma_f32_16x16x32_bf16 v[100:103], v[164:167], v[76:79], 0
v_mfma_f32_16x16x32_bf16 v[104:107], v[168:171], v[76:79], 0
v_mfma_f32_16x16x32_bf16 v[108:111], v[172:175], v[76:79], 0
v_mfma_f32_16x16x32_bf16 v[84:87], v[32:35], v[2:5], v[84:87]
v_mfma_f32_16x16x32_bf16 v[96:99], v[120:123], v[2:5], v[96:99]
v_mfma_f32_16x16x32_bf16 v[100:103], v[120:123], v[6:9], v[100:103]
v_mfma_f32_16x16x32_bf16 v[104:107], v[120:123], v[0:3], v[104:107]
v_mfma_f32_16x16x32_bf16 v[108:111], v[120:123], v[4:7], v[108:111]
v_mfma_f32_16x16x32_bf16 v[200:203], v[204:207], v[204:207], 0
s_nop 2
v_rcp_f32 v46, v84
s_nop 0
v_pk_mul_f32 v[96:97], v[96:97], v[46:47] op_sel_hi:[1,0]
v_pk_mul_f32 v[98:99], v[98:99], v[46:47] op_sel_hi:[1,0]
v_pk_mul_f32 v[100:101], v[100:101], v[46:47] op_sel_hi:[1,0]
v_pk_mul_f32 v[102:103], v[102:103], v[46:47] op_sel_hi:[1,0]
v_pk_mul_f32 v[104:105], v[104:105], v[46:47] op_sel_hi:[1,0]
v_pk_mul_f32 v[106:107], v[106:107], v[46:47] op_sel_hi:[1,0]
v_pk_mul_f32 v[108:109], v[108:109], v[46:47] op_sel_hi:[1,0]
v_pk_mul_f32 v[110:111], v[110:111], v[46:47] op_sel_hi:[1,0]
v_cvt_pk_bf16_f32 v96, v96, v97
v_cvt_pk_bf16_f32 v97, v98, v99
v_cvt_pk_bf16_f32 v98, v100, v101
v_cvt_pk_bf16_f32 v99, v102, v103
v_cvt_pk_bf16_f32 v100, v104, v105
v_cvt_pk_bf16_f32 v101, v106, v107
v_cvt_pk_bf16_f32 v102, v108, v109
v_cvt_pk_bf16_f32 v103, v110, v111
buffer_store_dwordx4 v[96:99], v26, s[4:7], s50 offen
buffer_store_dwordx4 v[100:103], v27, s[4:7], s50 offen
s_add_u32 s36, s36, 1
s_cmp_lt_u32 s36, 64
s_cbranch_scc1 Lq_18
s_waitcnt vmcnt(0)
buffer_store_dword v197, v199, s[4:7], 0 offen
s_branch Lend_1
Lpw_32:
Lbw_34:
buffer_load_dword v209, v208, s[4:7], 0 offen sc1
s_waitcnt vmcnt(0)
v_add_u32 v209, v209, v210
v_cmp_gt_u32 vcc, s27, v209
s_cbranch_vccz Lbo_35
s_sub_u32 s37, s37, 1
s_cbranch_scc1 Lend_1
s_sleep 2
s_branch Lbw_34
Lbo_35:
s_branch Lpk_33
Lpf_23:
buffer_load_dwordx4 v[48:51], v10, s[4:7], s40 offen offset:0 sc1
v_mfma_f32_16x16x32_bf16 v[200:203], v[204:207], v[204:207], 0
s_sub_u32 s37, s37, 1
s_cbranch_scc1 Lend_1
Lps_36:
s_waitcnt vmcnt(3)
v_max3_u32 v44, v52, v53, v54
v_max_u32 v44, v44, v55
v_cmp_eq_u32 vcc, -1, v44
s_cbranch_vccnz Lpf_37
v_smfmac_f32_16x16x64_bf16 v[64:67], v[52:55], a[64:71], v15
v_smfmac_f32_16x16x64_bf16 v[68:71], v[52:55], a[72:79], v15
v_smfmac_f32_16x16x64_bf16 v[72:75], v[52:55], a[80:87], v15
v_smfmac_f32_16x16x64_bf16 v[76:79], v[52:55], a[88:95], v15
v_smfmac_f32_16x16x64_bf16 v[80:83], v[52:55], a[96:103], v15
v_smfmac_f32_16x16x64_bf16 v[84:87], v[52:55], a[104:111], v15
v_smfmac_f32_16x16x64_bf16 v[88:91], v[52:55], a[112:119], v15
v_smfmac_f32_16x16x64_bf16 v[92:95], v[52:55], a[120:127], v15
Lps_38:
s_waitcnt vmcnt(2)
v_max3_u32 v44, v56, v57, v58
v_max_u32 v44, v44, v59
v_cmp_eq_u32 vcc, -1, v44
s_cbranch_vccnz Lpf_39
v_smfmac_f32_16x16x64_bf16 v[64:67], v[56:59], a[128:135], v15
v_smfmac_f32_16x16x64_bf16 v[68:71], v[56:59], a[136:143], v15
v_smfmac_f32_16x16x64_bf16 v[72:75], v[56:59], a[144:151], v15
v_smfmac_f32_16x16x64_bf16 v[76:79], v[56:59], a[152:159], v15
v_smfmac_f32_16x16x64_bf16 v[80:83], v[56:59], a[160:167], v15
v_smfmac_f32_16x16x64_bf16 v[84:87], v[56:59], a[168:175], v15
v_smfmac_f32_16x16x64_bf16 v[88:91], v[56:59], a[176:183], v15
v_smfmac_f32_16x16x64_bf16 v[92:95], v[56:59], a[184:191], v15
Lps_40:
s_waitcnt vmcnt(1)
v_max3_u32 v44, v60, v61, v62
v_max_u32 v44, v44, v63
v_cmp_eq_u32 vcc, -1, v44
s_cbranch_vccnz Lpf_41
v_smfmac_f32_16x16x64_bf16 v[64:67], v[60:63], a[192:199], v15
v_smfmac_f32_16x16x64_bf16 v[68:71], v[60:63], a[200:207], v15
v_smfmac_f32_16x16x64_bf16 v[72:75], v[60:63], a[208:215], v15
v_smfmac_f32_16x16x64_bf16 v[76:79], v[60:63], a[216:223], v15
v_smfmac_f32_16x16x64_bf16 v[80:83], v[60:63], a[224:231], v15
v_smfmac_f32_16x16x64_bf16 v[84:87], v[60:63], a[232:239], v15
v_smfmac_f32_16x16x64_bf16 v[88:91], v[60:63], a[240:247], v15
v_smfmac_f32_16x16x64_bf16 v[92:95], v[60:63], a[248:255], v15
Lps_42:
s_waitcnt vmcnt(0)
v_max3_u32 v44, v48, v49, v50
v_max_u32 v44, v44, v51
v_cmp_eq_u32 vcc, -1, v44
s_cbranch_vccnz Lpf_43
v_smfmac_f32_16x16x64_bf16 v[64:67], v[48:51], a[0:7], v15
v_smfmac_f32_16x16x64_bf16 v[68:71], v[48:51], a[8:15], v15
v_smfmac_f32_16x16x64_bf16 v[72:75], v[48:51], a[16:23], v15
v_smfmac_f32_16x16x64_bf16 v[76:79], v[48:51], a[24:31], v15
v_smfmac_f32_16x16x64_bf16 v[80:83], v[48:51], a[32:39], v15
v_smfmac_f32_16x16x64_bf16 v[84:87], v[48:51], a[40:47], v15
v_smfmac_f32_16x16x64_bf16 v[88:91], v[48:51], a[48:55], v15
v_smfmac_f32_16x16x64_bf16 v[92:95], v[48:51], a[56:63], v15
s_branch Lpd_22
Lpf_24:
buffer_load_dwordx4 v[52:55], v10, s[4:7], s40 offen offset:1024 sc1
v_mfma_f32_16x16x32_bf16 v[200:203], v[204:207], v[204:207], 0
s_sub_u32 s37, s37, 1
s_cbranch_scc1 Lend_1
Lps_44:
s_waitcnt vmcnt(2)
v_max3_u32 v44, v56, v57, v58
v_max_u32 v44, v44, v59
v_cmp_eq_u32 vcc, -1, v44
s_cbranch_vccnz Lpf_45
v_smfmac_f32_16x16x64_bf16 v[64:67], v[56:59], a[128:135], v15
v_smfmac_f32_16x16x64_bf16 v[68:71], v[56:59], a[136:143], v15
v_smfmac_f32_16x16x64_bf16 v[72:75], v[56:59], a[144:151], v15
v_smfmac_f32_16x16x64_bf16 v[76:79], v[56:59], a[152:159], v15
v_smfmac_f32_16x16x64_bf16 v[80:83], v[56:59], a[160:167], v15
v_smfmac_f32_16x16x64_bf16 v[84:87], v[56:59], a[168:175], v15
v_smfmac_f32_16x16x64_bf16 v[88:91], v[56:59], a[176:183], v15
v_smfmac_f32_16x16x64_bf16 v[92:95], v[56:59], a[184:191], v15
Lps_46:
s_waitcnt vmcnt(1)
v_max3_u32 v44, v60, v61, v62
v_max_u32 v44, v44, v63
v_cmp_eq_u32 vcc, -1, v44
s_cbranch_vccnz Lpf_47
v_smfmac_f32_16x16x64_bf16 v[64:67], v[60:63], a[192:199], v15
v_smfmac_f32_16x16x64_bf16 v[68:71], v[60:63], a[200:207], v15
v_smfmac_f32_16x16x64_bf16 v[72:75], v[60:63], a[208:215], v15
v_smfmac_f32_16x16x64_bf16 v[76:79], v[60:63], a[216:223], v15
v_smfmac_f32_16x16x64_bf16 v[80:83], v[60:63], a[224:231], v15
v_smfmac_f32_16x16x64_bf16 v[84:87], v[60:63], a[232:239], v15
v_smfmac_f32_16x16x64_bf16 v[88:91], v[60:63], a[240:247], v15
v_smfmac_f32_16x16x64_bf16 v[92:95], v[60:63], a[248:255], v15
Lps_48:
s_waitcnt vmcnt(0)
v_max3_u32 v44, v52, v53, v54
v_max_u32 v44, v44, v55
v_cmp_eq_u32 vcc, -1, v44
s_cbranch_vccnz Lpf_49
v_smfmac_f32_16x16x64_bf16 v[64:67], v[52:55], a[64:71], v15
v_smfmac_f32_16x16x64_bf16 v[68:71], v[52:55], a[72:79], v15
v_smfmac_f32_16x16x64_bf16 v[72:75], v[52:55], a[80:87], v15
v_smfmac_f32_16x16x64_bf16 v[76:79], v[52:55], a[88:95], v15
v_smfmac_f32_16x16x64_bf16 v[80:83], v[52:55], a[96:103], v15
v_smfmac_f32_16x16x64_bf16 v[84:87], v[52:55], a[104:111], v15
v_smfmac_f32_16x16x64_bf16 v[88:91], v[52:55], a[112:119], v15
v_smfmac_f32_16x16x64_bf16 v[92:95], v[52:55], a[120:127], v15
s_branch Lpd_22
Lpf_25:
buffer_load_dwordx4 v[56:59], v10, s[4:7], s40 offen offset:2048 sc1
v_mfma_f32_16x16x32_bf16 v[200:203], v[204:207], v[204:207], 0
s_sub_u32 s37, s37, 1
s_cbranch_scc1 Lend_1
Lps_50:
s_waitcnt vmcnt(1)
v_max3_u32 v44, v60, v61, v62
v_max_u32 v44, v44, v63
v_cmp_eq_u32 vcc, -1, v44
s_cbranch_vccnz Lpf_51
v_smfmac_f32_16x16x64_bf16 v[64:67], v[60:63], a[192:199], v15
v_smfmac_f32_16x16x64_bf16 v[68:71], v[60:63], a[200:207], v15
v_smfmac_f32_16x16x64_bf16 v[72:75], v[60:63], a[208:215], v15
v_smfmac_f32_16x16x64_bf16 v[76:79], v[60:63], a[216:223], v15
v_smfmac_f32_16x16x64_bf16 v[80:83], v[60:63], a[224:231], v15
v_smfmac_f32_16x16x64_bf16 v[84:87], v[60:63], a[232:239], v15
v_smfmac_f32_16x16x64_bf16 v[88:91], v[60:63], a[240:247], v15
v_smfmac_f32_16x16x64_bf16 v[92:95], v[60:63], a[248:255], v15
Lps_52:
s_waitcnt vmcnt(0)
v_max3_u32 v44, v56, v57, v58
v_max_u32 v44, v44, v59
v_cmp_eq_u32 vcc, -1, v44
s_cbranch_vccnz Lpf_53
v_smfmac_f32_16x16x64_bf16 v[64:67], v[56:59], a[128:135], v15
v_smfmac_f32_16x16x64_bf16 v[68:71], v[56:59], a[136:143], v15
v_smfmac_f32_16x16x64_bf16 v[72:75], v[56:59], a[144:151], v15
v_smfmac_f32_16x16x64_bf16 v[76:79], v[56:59], a[152:159], v15
v_smfmac_f32_16x16x64_bf16 v[80:83], v[56:59], a[160:167], v15
v_smfmac_f32_16x16x64_bf16 v[84:87], v[56:59], a[168:175], v15
v_smfmac_f32_16x16x64_bf16 v[88:91], v[56:59], a[176:183], v15
v_smfmac_f32_16x16x64_bf16 v[92:95], v[56:59], a[184:191], v15
s_branch Lpd_22
Lpf_26:
buffer_load_dwordx4 v[60:63], v10, s[4:7], s40 offen offset:3072 sc1
v_mfma_f32_16x16x32_bf16 v[200:203], v[204:207], v[204:207], 0
s_sub_u32 s37, s37, 1
s_cbranch_scc1 Lend_1
Lps_54:
s_waitcnt vmcnt(0)
v_max3_u32 v44, v60, v61, v62
v_max_u32 v44, v44, v63
v_cmp_eq_u32 vcc, -1, v44
s_cbranch_vccnz Lpf_55
v_smfmac_f32_16x16x64_bf16 v[64:67], v[60:63], a[192:199], v15
v_smfmac_f32_16x16x64_bf16 v[68:71], v[60:63], a[200:207], v15
v_smfmac_f32_16x16x64_bf16 v[72:75], v[60:63], a[208:215], v15
v_smfmac_f32_16x16x64_bf16 v[76:79], v[60:63], a[216:223], v15
v_smfmac_f32_16x16x64_bf16 v[80:83], v[60:63], a[224:231], v15
v_smfmac_f32_16x16x64_bf16 v[84:87], v[60:63], a[232:239], v15
v_smfmac_f32_16x16x64_bf16 v[88:91], v[60:63], a[240:247], v15
v_smfmac_f32_16x16x64_bf16 v[92:95], v[60:63], a[248:255], v15
s_branch Lpd_22
Lpf_37:
buffer_load_dwordx4 v[52:55], v10, s[4:7], s40 offen offset:1024 sc1
v_mfma_f32_16x16x32_bf16 v[200:203], v[204:207], v[204:207], 0
Lps_56:
s_waitcnt vmcnt(3)
v_max3_u32 v44, v56, v57, v58
v_max_u32 v44, v44, v59
v_cmp_eq_u32 vcc, -1, v44
s_cbranch_vccnz Lpf_57
v_smfmac_f32_16x16x64_bf16 v[64:67], v[56:59], a[128:135], v15
v_smfmac_f32_16x16x64_bf16 v[68:71], v[56:59], a[136:143], v15
v_smfmac_f32_16x16x64_bf16 v[72:75], v[56:59], a[144:151], v15
v_smfmac_f32_16x16x64_bf16 v[76:79], v[56:59], a[152:159], v15
v_smfmac_f32_16x16x64_bf16 v[80:83], v[56:59], a[160:167], v15
v_smfmac_f32_16x16x64_bf16 v[84:87], v[56:59], a[168:175], v15
v_smfmac_f32_16x16x64_bf16 v[88:91], v[56:59], a[176:183], v15
v_smfmac_f32_16x16x64_bf16 v[92:95], v[56:59], a[184:191], v15
Lps_58:
s_waitcnt vmcnt(2)
v_max3_u32 v44, v60, v61, v62
v_max_u32 v44, v44, v63
v_cmp_eq_u32 vcc, -1, v44
s_cbranch_vccnz Lpf_59
v_smfmac_f32_16x16x64_bf16 v[64:67], v[60:63], a[192:199], v15
v_smfmac_f32_16x16x64_bf16 v[68:71], v[60:63], a[200:207], v15
v_smfmac_f32_16x16x64_bf16 v[72:75], v[60:63], a[208:215], v15
v_smfmac_f32_16x16x64_bf16 v[76:79], v[60:63], a[216:223], v15
v_smfmac_f32_16x16x64_bf16 v[80:83], v[60:63], a[224:231], v15
v_smfmac_f32_16x16x64_bf16 v[84:87], v[60:63], a[232:239], v15
v_smfmac_f32_16x16x64_bf16 v[88:91], v[60:63], a[240:247], v15
v_smfmac_f32_16x16x64_bf16 v[92:95], v[60:63], a[248:255], v15
Lps_60:
s_waitcnt vmcnt(1)
v_max3_u32 v44, v48, v49, v50
v_max_u32 v44, v44, v51
v_cmp_eq_u32 vcc, -1, v44
s_cbranch_vccnz Lpf_61
v_smfmac_f32_16x16x64_bf16 v[64:67], v[48:51], a[0:7], v15
v_smfmac_f32_16x16x64_bf16 v[68:71], v[48:51], a[8:15], v15
v_smfmac_f32_16x16x64_bf16 v[72:75], v[48:51], a[16:23], v15
v_smfmac_f32_16x16x64_bf16 v[76:79], v[48:51], a[24:31], v15
v_smfmac_f32_16x16x64_bf16 v[80:83], v[48:51], a[32:39], v15
v_smfmac_f32_16x16x64_bf16 v[84:87], v[48:51], a[40:47], v15
v_smfmac_f32_16x16x64_bf16 v[88:91], v[48:51], a[48:55], v15
v_smfmac_f32_16x16x64_bf16 v[92:95], v[48:51], a[56:63], v15
s_branch Lps_48
Lpf_39:
buffer_load_dwordx4 v[56:59], v10, s[4:7], s40 offen offset:2048 sc1
v_mfma_f32_16x16x32_bf16 v[200:203], v[204:207], v[204:207], 0
Lps_62:
s_waitcnt vmcnt(2)
v_max3_u32 v44, v60, v61, v62
v_max_u32 v44, v44, v63
v_cmp_eq_u32 vcc, -1, v44
s_cbranch_vccnz Lpf_63
v_smfmac_f32_16x16x64_bf16 v[64:67], v[60:63], a[192:199], v15
v_smfmac_f32_16x16x64_bf16 v[68:71], v[60:63], a[200:207], v15
v_smfmac_f32_16x16x64_bf16 v[72:75], v[60:63], a[208:215], v15
v_smfmac_f32_16x16x64_bf16 v[76:79], v[60:63], a[216:223], v15
v_smfmac_f32_16x16x64_bf16 v[80:83], v[60:63], a[224:231], v15
v_smfmac_f32_16x16x64_bf16 v[84:87], v[60:63], a[232:239], v15
v_smfmac_f32_16x16x64_bf16 v[88:91], v[60:63], a[240:247], v15
v_smfmac_f32_16x16x64_bf16 v[92:95], v[60:63], a[248:255], v15
Lps_64:
s_waitcnt vmcnt(1)
v_max3_u32 v44, v48, v49, v50
v_max_u32 v44, v44, v51
v_cmp_eq_u32 vcc, -1, v44
s_cbranch_vccnz Lpf_65
v_smfmac_f32_16x16x64_bf16 v[64:67], v[48:51], a[0:7], v15
v_smfmac_f32_16x16x64_bf16 v[68:71], v[48:51], a[8:15], v15
v_smfmac_f32_16x16x64_bf16 v[72:75], v[48:51], a[16:23], v15
v_smfmac_f32_16x16x64_bf16 v[76:79], v[48:51], a[24:31], v15
v_smfmac_f32_16x16x64_bf16 v[80:83], v[48:51], a[32:39], v15
v_smfmac_f32_16x16x64_bf16 v[84:87], v[48:51], a[40:47], v15
v_smfmac_f32_16x16x64_bf16 v[88:91], v[48:51], a[48:55], v15
v_smfmac_f32_16x16x64_bf16 v[92:95], v[48:51], a[56:63], v15
s_branch Lps_52
Lpf_41:
buffer_load_dwordx4 v[60:63], v10, s[4:7], s40 offen offset:3072 sc1
v_mfma_f32_16x16x32_bf16 v[200:203], v[204:207], v[204:207], 0
Lps_66:
s_waitcnt vmcnt(1)
v_max3_u32 v44, v48, v49, v50
v_max_u32 v44, v44, v51
v_cmp_eq_u32 vcc, -1, v44
s_cbranch_vccnz Lpf_67
v_smfmac_f32_16x16x64_bf16 v[64:67], v[48:51], a[0:7], v15
v_smfmac_f32_16x16x64_bf16 v[68:71], v[48:51], a[8:15], v15
v_smfmac_f32_16x16x64_bf16 v[72:75], v[48:51], a[16:23], v15
v_smfmac_f32_16x16x64_bf16 v[76:79], v[48:51], a[24:31], v15
v_smfmac_f32_16x16x64_bf16 v[80:83], v[48:51], a[32:39], v15
v_smfmac_f32_16x16x64_bf16 v[84:87], v[48:51], a[40:47], v15
v_smfmac_f32_16x16x64_bf16 v[88:91], v[48:51], a[48:55], v15
v_smfmac_f32_16x16x64_bf16 v[92:95], v[48:51], a[56:63], v15
s_branch Lps_54
Lpf_43:
buffer_load_dwordx4 v[48:51], v10, s[4:7], s40 offen offset:0 sc1
v_mfma_f32_16x16x32_bf16 v[200:203], v[204:207], v[204:207], 0
s_sub_u32 s37, s37, 1
s_cbranch_scc1 Lend_1
s_branch Lps_42
Lpf_45:
buffer_load_dwordx4 v[56:59], v10, s[4:7], s40 offen offset:2048 sc1
v_mfma_f32_16x16x32_bf16 v[200:203], v[204:207], v[204:207], 0
Lps_68:
s_waitcnt vmcnt(2)
v_max3_u32 v44, v60, v61, v62
v_max_u32 v44, v44, v63
v_cmp_eq_u32 vcc, -1, v44
s_cbranch_vccnz Lpf_69
v_smfmac_f32_16x16x64_bf16 v[64:67], v[60:63], a[192:199], v15
v_smfmac_f32_16x16x64_bf16 v[68:71], v[60:63], a[200:207], v15
v_smfmac_f32_16x16x64_bf16 v[72:75], v[60:63], a[208:215], v15
v_smfmac_f32_16x16x64_bf16 v[76:79], v[60:63], a[216:223], v15
v_smfmac_f32_16x16x64_bf16 v[80:83], v[60:63], a[224:231], v15
v_smfmac_f32_16x16x64_bf16 v[84:87], v[60:63], a[232:239], v15
v_smfmac_f32_16x16x64_bf16 v[88:91], v[60:63], a[240:247], v15
v_smfmac_f32_16x16x64_bf16 v[92:95], v[60:63], a[248:255], v15
Lps_70:
s_waitcnt vmcnt(1)
v_max3_u32 v44, v52, v53, v54
v_max_u32 v44, v44, v55
v_cmp_eq_u32 vcc, -1, v44
s_cbranch_vccnz Lpf_71
v_smfmac_f32_16x16x64_bf16 v[64:67], v[52:55], a[64:71], v15
v_smfmac_f32_16x16x64_bf16 v[68:71], v[52:55], a[72:79], v15
v_smfmac_f32_16x16x64_bf16 v[72:75], v[52:55], a[80:87], v15
v_smfmac_f32_16x16x64_bf16 v[76:79], v[52:55], a[88:95], v15
v_smfmac_f32_16x16x64_bf16 v[80:83], v[52:55], a[96:103], v15
v_smfmac_f32_16x16x64_bf16 v[84:87], v[52:55], a[104:111], v15
v_smfmac_f32_16x16x64_bf16 v[88:91], v[52:55], a[112:119], v15
v_smfmac_f32_16x16x64_bf16 v[92:95], v[52:55], a[120:127], v15
s_branch Lps_52
Lpf_47:
buffer_load_dwordx4 v[60:63], v10, s[4:7], s40 offen offset:3072 sc1
v_mfma_f32_16x16x32_bf16 v[200:203], v[204:207], v[204:207], 0
Lps_72:
s_waitcnt vmcnt(1)
v_max3_u32 v44, v52, v53, v54
v_max_u32 v44, v44, v55
v_cmp_eq_u32 vcc, -1, v44
s_cbranch_vccnz Lpf_73
v_smfmac_f32_16x16x64_bf16 v[64:67], v[52:55], a[64:71], v15
v_smfmac_f32_16x16x64_bf16 v[68:71], v[52:55], a[72:79], v15
v_smfmac_f32_16x16x64_bf16 v[72:75], v[52:55], a[80:87], v15
v_smfmac_f32_16x16x64_bf16 v[76:79], v[52:55], a[88:95], v15
v_smfmac_f32_16x16x64_bf16 v[80:83], v[52:55], a[96:103], v15
v_smfmac_f32_16x16x64_bf16 v[84:87], v[52:55], a[104:111], v15
v_smfmac_f32_16x16x64_bf16 v[88:91], v[52:55], a[112:119], v15
v_smfmac_f32_16x16x64_bf16 v[92:95], v[52:55], a[120:127], v15
s_branch Lps_54
Lpf_49:
buffer_load_dwordx4 v[52:55], v10, s[4:7], s40 offen offset:1024 sc1
v_mfma_f32_16x16x32_bf16 v[200:203], v[204:207], v[204:207], 0
s_sub_u32 s37, s37, 1
s_cbranch_scc1 Lend_1
s_branch Lps_48
Lpf_51:
buffer_load_dwordx4 v[60:63], v10, s[4:7], s40 offen offset:3072 sc1
v_mfma_f32_16x16x32_bf16 v[200:203], v[204:207], v[204:207], 0
Lps_74:
s_waitcnt vmcnt(1)
v_max3_u32 v44, v56, v57, v58
v_max_u32 v44, v44, v59
v_cmp_eq_u32 vcc, -1, v44
s_cbranch_vccnz Lpf_75
v_smfmac_f32_16x16x64_bf16 v[64:67], v[56:59], a[128:135], v15
v_smfmac_f32_16x16x64_bf16 v[68:71], v[56:59], a[136:143], v15
v_smfmac_f32_16x16x64_bf16 v[72:75], v[56:59], a[144:151], v15
v_smfmac_f32_16x16x64_bf16 v[76:79], v[56:59], a[152:159], v15
v_smfmac_f32_16x16x64_bf16 v[80:83], v[56:59], a[160:167], v15
v_smfmac_f32_16x16x64_bf16 v[84:87], v[56:59], a[168:175], v15
v_smfmac_f32_16x16x64_bf16 v[88:91], v[56:59], a[176:183], v15
v_smfmac_f32_16x16x64_bf16 v[92:95], v[56:59], a[184:191], v15
s_branch Lps_54
Lpf_53:
buffer_load_dwordx4 v[56:59], v10, s[4:7], s40 offen offset:2048 sc1
v_mfma_f32_16x16x32_bf16 v[200:203], v[204:207], v[204:207], 0
s_sub_u32 s37, s37, 1
s_cbranch_scc1 Lend_1
s_branch Lps_52
Lpf_55:
buffer_load_dwordx4 v[60:63], v10, s[4:7], s40 offen offset:3072 sc1
v_mfma_f32_16x16x32_bf16 v[200:203], v[204:207], v[204:207], 0
s_sub_u32 s37, s37, 1
s_cbranch_scc1 Lend_1
s_branch Lps_54
Lpf_57:
buffer_load_dwordx4 v[56:59], v10, s[4:7], s40 offen offset:2048 sc1
v_mfma_f32_16x16x32_bf16 v[200:203], v[204:207], v[204:207], 0
Lps_76:
s_waitcnt vmcnt(3)
v_max3_u32 v44, v60, v61, v62
v_max_u32 v44, v44, v63
v_cmp_eq_u32 vcc, -1, v44
s_cbranch_vccnz Lpf_77
v_smfmac_f32_16x16x64_bf16 v[64:67], v[60:63], a[192:199], v15
v_smfmac_f32_16x16x64_bf16 v[68:71], v[60:63], a[200:207], v15
v_smfmac_f32_16x16x64_bf16 v[72:75], v[60:63], a[208:215], v15
v_smfmac_f32_16x16x64_bf16 v[76:79], v[60:63], a[216:223], v15
v_smfmac_f32_16x16x64_bf16 v[80:83], v[60:63], a[224:231], v15
v_smfmac_f32_16x16x64_bf16 v[84:87], v[60:63], a[232:239], v15
v_smfmac_f32_16x16x64_bf16 v[88:91], v[60:63], a[240:247], v15
v_smfmac_f32_16x16x64_bf16 v[92:95], v[60:63], a[248:255], v15
Lps_78:
s_waitcnt vmcnt(2)
v_max3_u32 v44, v48, v49, v50
v_max_u32 v44, v44, v51
v_cmp_eq_u32 vcc, -1, v44
s_cbranch_vccnz Lpf_79
v_smfmac_f32_16x16x64_bf16 v[64:67], v[48:51], a[0:7], v15
v_smfmac_f32_16x16x64_bf16 v[68:71], v[48:51], a[8:15], v15
v_smfmac_f32_16x16x64_bf16 v[72:75], v[48:51], a[16:23], v15
v_smfmac_f32_16x16x64_bf16 v[76:79], v[48:51], a[24:31], v15
v_smfmac_f32_16x16x64_bf16 v[80:83], v[48:51], a[32:39], v15
v_smfmac_f32_16x16x64_bf16 v[84:87], v[48:51], a[40:47], v15
v_smfmac_f32_16x16x64_bf16 v[88:91], v[48:51], a[48:55], v15
v_smfmac_f32_16x16x64_bf16 v[92:95], v[48:51], a[56:63], v15
s_branch Lps_70
Lpf_59:
buffer_load_dwordx4 v[60:63], v10, s[4:7], s40 offen offset:3072 sc1
v_mfma_f32_16x16x32_bf16 v[200:203], v[204:207], v[204:207], 0
Lps_80:
s_waitcnt vmcnt(2)
v_max3_u32 v44, v48, v49, v50
v_max_u32 v44, v44, v51
v_cmp_eq_u32 vcc, -1, v44
s_cbranch_vccnz Lpf_81
v_smfmac_f32_16x16x64_bf16 v[64:67], v[48:51], a[0:7], v15
v_smfmac_f32_16x16x64_bf16 v[68:71], v[48:51], a[8:15], v15
v_smfmac_f32_16x16x64_bf16 v[72:75], v[48:51], a[16:23], v15
v_smfmac_f32_16x16x64_bf16 v[76:79], v[48:51], a[24:31], v15
v_smfmac_f32_16x16x64_bf16 v[80:83], v[48:51], a[32:39], v15
v_smfmac_f32_16x16x64_bf16 v[84:87], v[48:51], a[40:47], v15
v_smfmac_f32_16x16x64_bf16 v[88:91], v[48:51], a[48:55], v15
v_smfmac_f32_16x16x64_bf16 v[92:95], v[48:51], a[56:63], v15
s_branch Lps_72
Lpf_61:
buffer_load_dwordx4 v[48:51], v10, s[4:7], s40 offen offset:0 sc1
v_mfma_f32_16x16x32_bf16 v[200:203], v[204:207], v[204:207], 0
s_sub_u32 s37, s37, 1
s_cbranch_scc1 Lend_1
Lps_82:
s_waitcnt vmcnt(1)
v_max3_u32 v44, v52, v53, v54
v_max_u32 v44, v44, v55
v_cmp_eq_u32 vcc, -1, v44
s_cbranch_vccnz Lpf_83
v_smfmac_f32_16x16x64_bf16 v[64:67], v[52:55], a[64:71], v15
v_smfmac_f32_16x16x64_bf16 v[68:71], v[52:55], a[72:79], v15
v_smfmac_f32_16x16x64_bf16 v[72:75], v[52:55], a[80:87], v15
v_smfmac_f32_16x16x64_bf16 v[76:79], v[52:55], a[88:95], v15
v_smfmac_f32_16x16x64_bf16 v[80:83], v[52:55], a[96:103], v15
v_smfmac_f32_16x16x64_bf16 v[84:87], v[52:55], a[104:111], v15
v_smfmac_f32_16x16x64_bf16 v[88:91], v[52:55], a[112:119], v15
v_smfmac_f32_16x16x64_bf16 v[92:95], v[52:55], a[120:127], v15
s_branch Lps_42
Lpf_63:
buffer_load_dwordx4 v[60:63], v10, s[4:7], s40 offen offset:3072 sc1
v_mfma_f32_16x16x32_bf16 v[200:203], v[204:207], v[204:207], 0
Lps_84:
s_waitcnt vmcnt(2)
v_max3_u32 v44, v48, v49, v50
v_max_u32 v44, v44, v51
v_cmp_eq_u32 vcc, -1, v44
s_cbranch_vccnz Lpf_85
v_smfmac_f32_16x16x64_bf16 v[64:67], v[48:51], a[0:7], v15
v_smfmac_f32_16x16x64_bf16 v[68:71], v[48:51], a[8:15], v15
v_smfmac_f32_16x16x64_bf16 v[72:75], v[48:51], a[16:23], v15
v_smfmac_f32_16x16x64_bf16 v[76:79], v[48:51], a[24:31], v15
v_smfmac_f32_16x16x64_bf16 v[80:83], v[48:51], a[32:39], v15
v_smfmac_f32_16x16x64_bf16 v[84:87], v[48:51], a[40:47], v15
v_smfmac_f32_16x16x64_bf16 v[88:91], v[48:51], a[48:55], v15
v_smfmac_f32_16x16x64_bf16 v[92:95], v[48:51], a[56:63], v15
s_branch Lps_74
Lpf_65:
buffer_load_dwordx4 v[48:51], v10, s[4:7], s40 offen offset:0 sc1
v_mfma_f32_16x16x32_bf16 v[200:203], v[204:207], v[204:207], 0
s_sub_u32 s37, s37, 1
s_cbranch_scc1 Lend_1
Lps_86:
s_waitcnt vmcnt(1)
v_max3_u32 v44, v56, v57, v58
v_max_u32 v44, v44, v59
v_cmp_eq_u32 vcc, -1, v44
s_cbranch_vccnz Lpf_87
v_smfmac_f32_16x16x64_bf16 v[64:67], v[56:59], a[128:135], v15
v_smfmac_f32_16x16x64_bf16 v[68:71], v[56:59], a[136:143], v15
v_smfmac_f32_16x16x64_bf16 v[72:75], v[56:59], a[144:151], v15
v_smfmac_f32_16x16x64_bf16 v[76:79], v[56:59], a[152:159], v15
v_smfmac_f32_16x16x64_bf16 v[80:83], v[56:59], a[160:167], v15
v_smfmac_f32_16x16x64_bf16 v[84:87], v[56:59], a[168:175], v15
v_smfmac_f32_16x16x64_bf16 v[88:91], v[56:59], a[176:183], v15
v_smfmac_f32_16x16x64_bf16 v[92:95], v[56:59], a[184:191], v15
s_branch Lps_42
Lpf_67:
buffer_load_dwordx4 v[48:51], v10, s[4:7], s40 offen offset:0 sc1
v_mfma_f32_16x16x32_bf16 v[200:203], v[204:207], v[204:207], 0
s_sub_u32 s37, s37, 1
s_cbranch_scc1 Lend_1
s_branch Lps_40
Lpf_69:
buffer_load_dwordx4 v[60:63], v10, s[4:7], s40 offen offset:3072 sc1
v_mfma_f32_16x16x32_bf16 v[200:203], v[204:207], v[204:207], 0
Lps_88:
s_waitcnt vmcnt(2)
v_max3_u32 v44, v52, v53, v54
v_max_u32 v44, v44, v55
v_cmp_eq_u32 vcc, -1, v44
s_cbranch_vccnz Lpf_89
v_smfmac_f32_16x16x64_bf16 v[64:67], v[52:55], a[64:71], v15
v_smfmac_f32_16x16x64_bf16 v[68:71], v[52:55], a[72:79], v15
v_smfmac_f32_16x16x64_bf16 v[72:75], v[52:55], a[80:87], v15
v_smfmac_f32_16x16x64_bf16 v[76:79], v[52:55], a[88:95], v15
v_smfmac_f32_16x16x64_bf16 v[80:83], v[52:55], a[96:103], v15
v_smfmac_f32_16x16x64_bf16 v[84:87], v[52:55], a[104:111], v15
v_smfmac_f32_16x16x64_bf16 v[88:91], v[52:55], a[112:119], v15
v_smfmac_f32_16x16x64_bf16 v[92:95], v[52:55], a[120:127], v15
s_branch Lps_74
Lpf_71:
buffer_load_dwordx4 v[52:55], v10, s[4:7], s40 offen offset:1024 sc1
v_mfma_f32_16x16x32_bf16 v[200:203], v[204:207], v[204:207], 0
s_sub_u32 s37, s37, 1
s_cbranch_scc1 Lend_1
Lps_90:
s_waitcnt vmcnt(1)
v_max3_u32 v44, v56, v57, v58
v_max_u32 v44, v44, v59
v_cmp_eq_u32 vcc, -1, v44
s_cbranch_vccnz Lpf_91
v_smfmac_f32_16x16x64_bf16 v[64:67], v[56:59], a[128:135], v15
v_smfmac_f32_16x16x64_bf16 v[68:71], v[56:59], a[136:143], v15
v_smfmac_f32_16x16x64_bf16 v[72:75], v[56:59], a[144:151], v15
v_smfmac_f32_16x16x64_bf16 v[76:79], v[56:59], a[152:159], v15
v_smfmac_f32_16x16x64_bf16 v[80:83], v[56:59], a[160:167], v15
v_smfmac_f32_16x16x64_bf16 v[84:87], v[56:59], a[168:175], v15
v_smfmac_f32_16x16x64_bf16 v[88:91], v[56:59], a[176:183], v15
v_smfmac_f32_16x16x64_bf16 v[92:95], v[56:59], a[184:191], v15
s_branch Lps_48
Lpf_73:
buffer_load_dwordx4 v[52:55], v10, s[4:7], s40 offen offset:1024 sc1
v_mfma_f32_16x16x32_bf16 v[200:203], v[204:207], v[204:207], 0
s_sub_u32 s37, s37, 1
s_cbranch_scc1 Lend_1
s_branch Lps_46
Lpf_75:
buffer_load_dwordx4 v[56:59], v10, s[4:7], s40 offen offset:2048 sc1
v_mfma_f32_16x16x32_bf16 v[200:203], v[204:207], v[204:207], 0
s_sub_u32 s37, s37, 1
s_cbranch_scc1 Lend_1
s_branch Lps_50
Lpf_77:
buffer_load_dwordx4 v[60:63], v10, s[4:7], s40 offen offset:3072 sc1
v_mfma_f32_16x16x32_bf16 v[200:203], v[204:207], v[204:207], 0
Lps_92:
s_waitcnt vmcnt(3)
v_max3_u32 v44, v48, v49, v50
v_max_u32 v44, v44, v51
v_cmp_eq_u32 vcc, -1, v44
s_cbranch_vccnz Lpf_93
v_smfmac_f32_16x16x64_bf16 v[64:67], v[48:51], a[0:7], v15
v_smfmac_f32_16x16x64_bf16 v[68:71], v[48:51], a[8:15], v15
v_smfmac_f32_16x16x64_bf16 v[72:75], v[48:51], a[16:23], v15
v_smfmac_f32_16x16x64_bf16 v[76:79], v[48:51], a[24:31], v15
v_smfmac_f32_16x16x64_bf16 v[80:83], v[48:51], a[32:39], v15
v_smfmac_f32_16x16x64_bf16 v[84:87], v[48:51], a[40:47], v15
v_smfmac_f32_16x16x64_bf16 v[88:91], v[48:51], a[48:55], v15
v_smfmac_f32_16x16x64_bf16 v[92:95], v[48:51], a[56:63], v15
s_branch Lps_88
Lpf_79:
buffer_load_dwordx4 v[48:51], v10, s[4:7], s40 offen offset:0 sc1
v_mfma_f32_16x16x32_bf16 v[200:203], v[204:207], v[204:207], 0
s_sub_u32 s37, s37, 1
s_cbranch_scc1 Lend_1
Lps_94:
s_waitcnt vmcnt(2)
v_max3_u32 v44, v52, v53, v54
v_max_u32 v44, v44, v55
v_cmp_eq_u32 vcc, -1, v44
s_cbranch_vccnz Lpf_95
v_smfmac_f32_16x16x64_bf16 v[64:67], v[52:55], a[64:71], v15
v_smfmac_f32_16x16x64_bf16 v[68:71], v[52:55], a[72:79], v15
v_smfmac_f32_16x16x64_bf16 v[72:75], v[52:55], a[80:87], v15
v_smfmac_f32_16x16x64_bf16 v[76:79], v[52:55], a[88:95], v15
v_smfmac_f32_16x16x64_bf16 v[80:83], v[52:55], a[96:103], v15
v_smfmac_f32_16x16x64_bf16 v[84:87], v[52:55], a[104:111], v15
v_smfmac_f32_16x16x64_bf16 v[88:91], v[52:55], a[112:119], v15
v_smfmac_f32_16x16x64_bf16 v[92:95], v[52:55], a[120:127], v15
s_branch Lps_86
Lpf_81:
buffer_load_dwordx4 v[48:51], v10, s[4:7], s40 offen offset:0 sc1
v_mfma_f32_16x16x32_bf16 v[200:203], v[204:207], v[204:207], 0
s_sub_u32 s37, s37, 1
s_cbranch_scc1 Lend_1
Lps_96:
s_waitcnt vmcnt(2)
v_max3_u32 v44, v52, v53, v54
v_max_u32 v44, v44, v55
v_cmp_eq_u32 vcc, -1, v44
s_cbranch_vccnz Lpf_97
v_smfmac_f32_16x16x64_bf16 v[64:67], v[52:55], a[64:71], v15
v_smfmac_f32_16x16x64_bf16 v[68:71], v[52:55], a[72:79], v15
v_smfmac_f32_16x16x64_bf16 v[72:75], v[52:55], a[80:87], v15
v_smfmac_f32_16x16x64_bf16 v[76:79], v[52:55], a[88:95], v15
v_smfmac_f32_16x16x64_bf16 v[80:83], v[52:55], a[96:103], v15
v_smfmac_f32_16x16x64_bf16 v[84:87], v[52:55], a[104:111], v15
v_smfmac_f32_16x16x64_bf16 v[88:91], v[52:55], a[112:119], v15
v_smfmac_f32_16x16x64_bf16 v[92:95], v[52:55], a[120:127], v15
s_branch Lps_40
Lpf_83:
buffer_load_dwordx4 v[52:55], v10, s[4:7], s40 offen offset:1024 sc1
v_mfma_f32_16x16x32_bf16 v[200:203], v[204:207], v[204:207], 0
s_branch Lps_60
Lpf_85:
buffer_load_dwordx4 v[48:51], v10, s[4:7], s40 offen offset:0 sc1
v_mfma_f32_16x16x32_bf16 v[200:203], v[204:207], v[204:207], 0
s_sub_u32 s37, s37, 1
s_cbranch_scc1 Lend_1
s_branch Lps_38
Lpf_87:
buffer_load_dwordx4 v[56:59], v10, s[4:7], s40 offen offset:2048 sc1
v_mfma_f32_16x16x32_bf16 v[200:203], v[204:207], v[204:207], 0
s_branch Lps_64
Lpf_89:
buffer_load_dwordx4 v[52:55], v10, s[4:7], s40 offen offset:1024 sc1
v_mfma_f32_16x16x32_bf16 v[200:203], v[204:207], v[204:207], 0
s_sub_u32 s37, s37, 1
s_cbranch_scc1 Lend_1
s_branch Lps_44
Lpf_91:
buffer_load_dwordx4 v[56:59], v10, s[4:7], s40 offen offset:2048 sc1
v_mfma_f32_16x16x32_bf16 v[200:203], v[204:207], v[204:207], 0
s_branch Lps_70
Lpf_93:
buffer_load_dwordx4 v[48:51], v10, s[4:7], s40 offen offset:0 sc1
v_mfma_f32_16x16x32_bf16 v[200:203], v[204:207], v[204:207], 0
s_sub_u32 s37, s37, 1
s_cbranch_scc1 Lend_1
s_branch Lps_36
Lpf_95:
buffer_load_dwordx4 v[52:55], v10, s[4:7], s40 offen offset:1024 sc1
v_mfma_f32_16x16x32_bf16 v[200:203], v[204:207], v[204:207], 0
Lps_98:
s_waitcnt vmcnt(2)
v_max3_u32 v44, v56, v57, v58
v_max_u32 v44, v44, v59
v_cmp_eq_u32 vcc, -1, v44
s_cbranch_vccnz Lpf_99
v_smfmac_f32_16x16x64_bf16 v[64:67], v[56:59], a[128:135], v15
v_smfmac_f32_16x16x64_bf16 v[68:71], v[56:59], a[136:143], v15
v_smfmac_f32_16x16x64_bf16 v[72:75], v[56:59], a[144:151], v15
v_smfmac_f32_16x16x64_bf16 v[76:79], v[56:59], a[152:159], v15
v_smfmac_f32_16x16x64_bf16 v[80:83], v[56:59], a[160:167], v15
v_smfmac_f32_16x16x64_bf16 v[84:87], v[56:59], a[168:175], v15
v_smfmac_f32_16x16x64_bf16 v[88:91], v[56:59], a[176:183], v15
v_smfmac_f32_16x16x64_bf16 v[92:95], v[56:59], a[184:191], v15
s_branch Lps_60
Lpf_97:
buffer_load_dwordx4 v[52:55], v10, s[4:7], s40 offen offset:1024 sc1
v_mfma_f32_16x16x32_bf16 v[200:203], v[204:207], v[204:207], 0
s_branch Lps_58
Lpf_99:
buffer_load_dwordx4 v[56:59], v10, s[4:7], s40 offen offset:2048 sc1
v_mfma_f32_16x16x32_bf16 v[200:203], v[204:207], v[204:207], 0
s_branch Lps_78
Lkr_27:
buffer_load_dwordx4 v[56:59], v11, s[4:7], s40 offen offset:0 sc1
buffer_load_dwordx4 v[60:63], v11, s[4:7], s40 offen offset:1024 sc1
Lps_101:
s_waitcnt vmcnt(3)
v_max3_u32 v44, v48, v49, v50
v_max_u32 v44, v44, v51
v_cmp_eq_u32 vcc, -1, v44
s_cbranch_vccnz Lpf_102
v_smfmac_f32_16x16x64_bf16 v[72:75], v[48:51], v[96:103], v15
v_mov_b32 v112, v48
v_mov_b32 v113, v49
v_mov_b32 v114, v50
v_mov_b32 v115, v51
Lps_103:
s_waitcnt vmcnt(2)
v_max3_u32 v44, v52, v53, v54
v_max_u32 v44, v44, v55
v_cmp_eq_u32 vcc, -1, v44
s_cbranch_vccnz Lpf_104
v_smfmac_f32_16x16x64_bf16 v[72:75], v[52:55], v[104:111], v15
v_mov_b32 v116, v52
v_mov_b32 v117, v53
v_mov_b32 v118, v54
v_mov_b32 v119, v55
Lpd_100:
s_branch Lko_28
Lpf_102:
buffer_load_dwordx4 v[48:51], v11, s[4:7], s40 offen offset:0 sc1
s_sub_u32 s37, s37, 1
s_cbranch_scc1 Lend_1
Lps_105:
s_waitcnt vmcnt(3)
v_max3_u32 v44, v52, v53, v54
v_max_u32 v44, v44, v55
v_cmp_eq_u32 vcc, -1, v44
s_cbranch_vccnz Lpf_106
v_smfmac_f32_16x16x64_bf16 v[72:75], v[52:55], v[104:111], v15
v_mov_b32 v116, v52
v_mov_b32 v117, v53
v_mov_b32 v118, v54
v_mov_b32 v119, v55
Lps_107:
s_waitcnt vmcnt(2)
v_max3_u32 v44, v56, v57, v58
v_max_u32 v44, v44, v59
v_cmp_eq_u32 vcc, -1, v44
s_cbranch_vccnz Lpf_108
v_smfmac_f32_16x16x64_bf16 v[72:75], v[56:59], v[96:103], v15
v_mov_b32 v112, v56
v_mov_b32 v113, v57
v_mov_b32 v114, v58
v_mov_b32 v115, v59
s_branch Lpd_100
Lpf_104:
buffer_load_dwordx4 v[52:55], v11, s[4:7], s40 offen offset:1024 sc1
s_sub_u32 s37, s37, 1
s_cbranch_scc1 Lend_1
Lps_109:
s_waitcnt vmcnt(2)
v_max3_u32 v44, v56, v57, v58
v_max_u32 v44, v44, v59
v_cmp_eq_u32 vcc, -1, v44
s_cbranch_vccnz Lpf_110
Lps_111:
s_waitcnt vmcnt(1)
v_max3_u32 v44, v60, v61, v62
v_max_u32 v44, v44, v63
v_cmp_eq_u32 vcc, -1, v44
s_cbranch_vccnz Lpf_112
v_smfmac_f32_16x16x64_bf16 v[72:75], v[60:63], v[104:111], v15
v_mov_b32 v116, v60
v_mov_b32 v117, v61
v_mov_b32 v118, v62
v_mov_b32 v119, v63
s_branch Lpd_100
Lpf_106:
buffer_load_dwordx4 v[52:55], v11, s[4:7], s40 offen offset:1024 sc1
Lps_113:
s_waitcnt vmcnt(3)
v_max3_u32 v44, v56, v57, v58
v_max_u32 v44, v44, v59
v_cmp_eq_u32 vcc, -1, v44
s_cbranch_vccnz Lpf_114
v_smfmac_f32_16x16x64_bf16 v[72:75], v[56:59], v[96:103], v15
v_mov_b32 v112, v56
v_mov_b32 v113, v57
v_mov_b32 v114, v58
v_mov_b32 v115, v59
Lps_115:
s_waitcnt vmcnt(2)
v_max3_u32 v44, v60, v61, v62
v_max_u32 v44, v44, v63
v_cmp_eq_u32 vcc, -1, v44
s_cbranch_vccnz Lpf_116
v_smfmac_f32_16x16x64_bf16 v[72:75], v[60:63], v[104:111], v15
v_mov_b32 v116, v60
v_mov_b32 v117, v61
v_mov_b32 v118, v62
v_mov_b32 v119, v63
s_branch Lpd_100
Lpf_108:
buffer_load_dwordx4 v[56:59], v11, s[4:7], s40 offen offset:0 sc1
Lps_117:
s_waitcnt vmcnt(2)
v_max3_u32 v44, v60, v61, v62
v_max_u32 v44, v44, v63
v_cmp_eq_u32 vcc, -1, v44
s_cbranch_vccnz Lpf_118
Lps_119:
s_waitcnt vmcnt(1)
v_max3_u32 v44, v48, v49, v50
v_max_u32 v44, v44, v51
v_cmp_eq_u32 vcc, -1, v44
s_cbranch_vccnz Lpf_120
v_smfmac_f32_16x16x64_bf16 v[72:75], v[48:51], v[96:103], v15
v_mov_b32 v112, v48
v_mov_b32 v113, v49
v_mov_b32 v114, v50
v_mov_b32 v115, v51
s_branch Lpd_100
Lpf_110:
buffer_load_dwordx4 v[56:59], v11, s[4:7], s40 offen offset:0 sc1
Lps_121:
s_waitcnt vmcnt(2)
v_max3_u32 v44, v60, v61, v62
v_max_u32 v44, v44, v63
v_cmp_eq_u32 vcc, -1, v44
s_cbranch_vccnz Lpf_122
v_smfmac_f32_16x16x64_bf16 v[72:75], v[60:63], v[104:111], v15
v_mov_b32 v116, v60
v_mov_b32 v117, v61
v_mov_b32 v118, v62
v_mov_b32 v119, v63
s_branch Lpd_100
Lpf_112:
buffer_load_dwordx4 v[60:63], v11, s[4:7], s40 offen offset:1024 sc1
Lps_123:
s_waitcnt vmcnt(1)
v_max3_u32 v44, v52, v53, v54
v_max_u32 v44, v44, v55
v_cmp_eq_u32 vcc, -1, v44
s_cbranch_vccnz Lpf_124
v_smfmac_f32_16x16x64_bf16 v[72:75], v[52:55], v[104:111], v15
v_mov_b32 v116, v52
v_mov_b32 v117, v53
v_mov_b32 v118, v54
v_mov_b32 v119, v55
s_branch Lpd_100
Lpf_114:
buffer_load_dwordx4 v[56:59], v11, s[4:7], s40 offen offset:0 sc1
Lps_125:
s_waitcnt vmcnt(3)
v_max3_u32 v44, v60, v61, v62
v_max_u32 v44, v44, v63
v_cmp_eq_u32 vcc, -1, v44
s_cbranch_vccnz Lpf_126
v_smfmac_f32_16x16x64_bf16 v[72:75], v[60:63], v[104:111], v15
v_mov_b32 v116, v60
v_mov_b32 v117, v61
v_mov_b32 v118, v62
v_mov_b32 v119, v63
Lps_127:
s_waitcnt vmcnt(2)
v_max3_u32 v44, v48, v49, v50
v_max_u32 v44, v44, v51
v_cmp_eq_u32 vcc, -1, v44
s_cbranch_vccnz Lpf_128
v_smfmac_f32_16x16x64_bf16 v[72:75], v[48:51], v[96:103], v15
v_mov_b32 v112, v48
v_mov_b32 v113, v49
v_mov_b32 v114, v50
v_mov_b32 v115, v51
s_branch Lpd_100
Lpf_116:
buffer_load_dwordx4 v[60:63], v11, s[4:7], s40 offen offset:1024 sc1
Lps_129:
s_waitcnt vmcnt(2)
v_max3_u32 v44, v48, v49, v50
v_max_u32 v44, v44, v51
v_cmp_eq_u32 vcc, -1, v44
s_cbranch_vccnz Lpf_130
s_branch Lps_123
Lpf_118:
buffer_load_dwordx4 v[60:63], v11, s[4:7], s40 offen offset:1024 sc1
Lps_131:
s_waitcnt vmcnt(2)
v_max3_u32 v44, v48, v49, v50
v_max_u32 v44, v44, v51
v_cmp_eq_u32 vcc, -1, v44
s_cbranch_vccnz Lpf_132
v_smfmac_f32_16x16x64_bf16 v[72:75], v[48:51], v[96:103], v15
v_mov_b32 v112, v48
v_mov_b32 v113, v49
v_mov_b32 v114, v50
v_mov_b32 v115, v51
s_branch Lpd_100
Lpf_120:
buffer_load_dwordx4 v[48:51], v11, s[4:7], s40 offen offset:0 sc1
s_sub_u32 s37, s37, 1
s_cbranch_scc1 Lend_1
Lps_133:
s_waitcnt vmcnt(1)
v_max3_u32 v44, v56, v57, v58
v_max_u32 v44, v44, v59
v_cmp_eq_u32 vcc, -1, v44
s_cbranch_vccnz Lpf_134
v_smfmac_f32_16x16x64_bf16 v[72:75], v[56:59], v[96:103], v15
v_mov_b32 v112, v56
v_mov_b32 v113, v57
v_mov_b32 v114, v58
v_mov_b32 v115, v59
s_branch Lpd_100
Lpf_122:
buffer_load_dwordx4 v[60:63], v11, s[4:7], s40 offen offset:1024 sc1
s_branch Lps_103
Lpf_124:
buffer_load_dwordx4 v[52:55], v11, s[4:7], s40 offen offset:1024 sc1
s_sub_u32 s37, s37, 1
s_cbranch_scc1 Lend_1
s_branch Lps_111
Lpf_126:
buffer_load_dwordx4 v[60:63], v11, s[4:7], s40 offen offset:1024 sc1
s_branch Lps_101
Lpf_128:
buffer_load_dwordx4 v[48:51], v11, s[4:7], s40 offen offset:0 sc1
s_sub_u32 s37, s37, 1
s_cbranch_scc1 Lend_1
Lps_135:
s_waitcnt vmcnt(2)
v_max3_u32 v44, v52, v53, v54
v_max_u32 v44, v44, v55
v_cmp_eq_u32 vcc, -1, v44
s_cbranch_vccnz Lpf_136
s_branch Lps_133
Lpf_130:
buffer_load_dwordx4 v[48:51], v11, s[4:7], s40 offen offset:0 sc1
s_sub_u32 s37, s37, 1
s_cbranch_scc1 Lend_1
Lps_137:
s_waitcnt vmcnt(2)
v_max3_u32 v44, v52, v53, v54
v_max_u32 v44, v44, v55
v_cmp_eq_u32 vcc, -1, v44
s_cbranch_vccnz Lpf_138
v_smfmac_f32_16x16x64_bf16 v[72:75], v[52:55], v[104:111], v15
v_mov_b32 v116, v52
v_mov_b32 v117, v53
v_mov_b32 v118, v54
v_mov_b32 v119, v55
s_branch Lpd_100
Lpf_132:
buffer_load_dwordx4 v[48:51], v11, s[4:7], s40 offen offset:0 sc1
s_sub_u32 s37, s37, 1
s_cbranch_scc1 Lend_1
s_branch Lps_107
Lpf_134:
buffer_load_dwordx4 v[56:59], v11, s[4:7], s40 offen offset:0 sc1
s_branch Lps_119
Lpf_136:
buffer_load_dwordx4 v[52:55], v11, s[4:7], s40 offen offset:1024 sc1
Lps_139:
s_waitcnt vmcnt(2)
v_max3_u32 v44, v56, v57, v58
v_max_u32 v44, v44, v59
v_cmp_eq_u32 vcc, -1, v44
s_cbranch_vccnz Lpf_140
v_smfmac_f32_16x16x64_bf16 v[72:75], v[56:59], v[96:103], v15
v_mov_b32 v112, v56
v_mov_b32 v113, v57
v_mov_b32 v114, v58
v_mov_b32 v115, v59
s_branch Lpd_100
Lpf_138:
buffer_load_dwordx4 v[52:55], v11, s[4:7], s40 offen offset:1024 sc1
s_branch Lps_115
Lpf_140:
buffer_load_dwordx4 v[56:59], v11, s[4:7], s40 offen offset:0 sc1
s_branch Lps_127
Lvr_29:
buffer_load_dwordx2 v[120:121], v12, s[4:7], s40 offen sc1
buffer_load_dwordx2 v[122:123], v13, s[4:7], s40 offen sc1
s_sub_u32 s37, s37, 1
s_cbranch_scc1 Lend_1
s_waitcnt vmcnt(0)
v_max3_u32 v44, v120, v121, v122
v_max_u32 v44, v44, v123
v_cmp_eq_u32 vcc, -1, v44
s_cbranch_vccnz Lvr_29
s_branch Lvo_30
Lq_sc1_17:
Lq_141:
ds_read_b128 v[128:131], v22 offset:0
ds_read_b128 v[132:135], v22 offset:1024
ds_read_b128 v[136:139], v22 offset:2048
ds_read_b128 v[140:143], v22 offset:3072
ds_read_b128 v[144:147], v22 offset:4096
ds_read_b128 v[148:151], v22 offset:5120
ds_read_b128 v[152:155], v22 offset:6144
ds_read_b128 v[156:159], v22 offset:7168
ds_read_b128 v[160:163], v24 offset:0
ds_read_b128 v[164:167], v24 offset:1024
ds_read_b128 v[168:171], v25 offset:0
ds_read_b128 v[172:175], v25 offset:1024
ds_read_b128 v[176:179], v23 offset:0
ds_read_b128 v[180:183], v23 offset:1024
ds_read_b128 v[184:187], v23 offset:2048
ds_read_b128 v[188:191], v23 offset:3072
v_xor_b32 v22, 98304, v22
v_xor_b32 v24, 98304, v24
v_xor_b32 v25, 98304, v25
v_xor_b32 v23, 98304, v23
s_mul_i32 m0, s32, 5120
s_and_b32 s38, s36, 3
s_lshl_b32 s39, s38, 16
s_add_u32 s40, s39, s45
s_xor_b32 s42, s40, 0x20000
s_add_u32 s26, s36, 1
v_pk_mul_f32 v[64:65], 0, 0
v_pk_mul_f32 v[66:67], 0, 0
v_pk_mul_f32 v[68:69], 0, 0
v_pk_mul_f32 v[70:71], 0, 0
v_pk_mul_f32 v[72:73], 0, 0
v_pk_mul_f32 v[74:75], 0, 0
v_pk_mul_f32 v[76:77], 0, 0
v_pk_mul_f32 v[78:79], 0, 0
v_pk_mul_f32 v[80:81], 0, 0
v_pk_mul_f32 v[82:83], 0, 0
v_pk_mul_f32 v[84:85], 0, 0
v_pk_mul_f32 v[86:87], 0, 0
v_pk_mul_f32 v[88:89], 0, 0
v_pk_mul_f32 v[90:91], 0, 0
v_pk_mul_f32 v[92:93], 0, 0
v_pk_mul_f32 v[94:95], 0, 0
s_waitcnt vmcnt(0)
buffer_store_dword v197, v199, s[4:7], 0 offen sc1
v_add_u32 v197, 1, v197
s_mov_b64 exec, 15
buffer_load_dword v194, v192, s[4:7], s59 offen sc1
s_nop 11
buffer_load_dword v195, v192, s[4:7], s59 offen sc1
s_nop 11
buffer_load_dword v196, v192, s[4:7], s59 offen sc1
Lft_143:
s_waitcnt vmcnt(2)
v_cmp_gt_u32 vcc, s26, v194
s_cbranch_vccz Lfg_142
buffer_load_dword v194, v192, s[4:7], s59 offen sc1
s_waitcnt vmcnt(2)
v_cmp_gt_u32 vcc, s26, v195
s_cbranch_vccz Lfg_142
buffer_load_dword v195, v192, s[4:7], s59 offen sc1
s_waitcnt vmcnt(2)
v_cmp_gt_u32 vcc, s26, v196
s_cbranch_vccz Lfg_142
buffer_load_dword v196, v192, s[4:7], s59 offen sc1
s_sub_u32 s37, s37, 1
s_cbranch_scc1 Lend_1
s_branch Lft_143
Lfg_142:
s_mov_b64 exec, -1
buffer_load_dwordx4 v[48:51], v10, s[4:7], s40 offen offset:0 sc1
v_mfma_f32_16x16x32_bf16 v[200:203], v[204:207], v[204:207], 0
v_mfma_f32_16x16x32_bf16 v[200:203], v[204:207], v[204:207], 0
v_mfma_f32_16x16x32_bf16 v[200:203], v[204:207], v[204:207], 0
v_mfma_f32_16x16x32_bf16 v[200:203], v[204:207], v[204:207], 0
buffer_load_dwordx4 v[52:55], v10, s[4:7], s40 offen offset:1024 sc1
v_mfma_f32_16x16x32_bf16 v[200:203], v[204:207], v[204:207], 0
v_mfma_f32_16x16x32_bf16 v[200:203], v[204:207], v[204:207], 0
v_mfma_f32_16x16x32_bf16 v[200:203], v[204:207], v[204:207], 0
v_mfma_f32_16x16x32_bf16 v[200:203], v[204:207], v[204:207], 0
buffer_load_dwordx4 v[56:59], v10, s[4:7], s40 offen offset:2048 sc1
v_mfma_f32_16x16x32_bf16 v[200:203], v[204:207], v[204:207], 0
v_mfma_f32_16x16x32_bf16 v[200:203], v[204:207], v[204:207], 0
v_mfma_f32_16x16x32_bf16 v[200:203], v[204:207], v[204:207], 0
v_mfma_f32_16x16x32_bf16 v[200:203], v[204:207], v[204:207], 0
buffer_load_dwordx4 v[60:63], v10, s[4:7], s40 offen offset:3072 sc1
v_mfma_f32_16x16x32_bf16 v[200:203], v[204:207], v[204:207], 0
s_waitcnt vmcnt(3)
v_max3_u32 v44, v48, v49, v50
v_max_u32 v44, v44, v51
v_cmp_eq_u32 vcc, -1, v44
s_cbranch_vccnz Lpf_146
v_smfmac_f32_16x16x64_bf16 v[64:67], v[48:51], a[0:7], v15
v_smfmac_f32_16x16x64_bf16 v[68:71], v[48:51], a[8:15], v15
v_smfmac_f32_16x16x64_bf16 v[72:75], v[48:51], a[16:23], v15
v_smfmac_f32_16x16x64_bf16 v[76:79], v[48:51], a[24:31], v15
v_smfmac_f32_16x16x64_bf16 v[80:83], v[48:51], a[32:39], v15
s_waitcnt vmcnt(2)
v_max3_u32 v44, v52, v53, v54
v_max_u32 v44, v44, v55
v_cmp_eq_u32 vcc, -1, v44
v_smfmac_f32_16x16x64_bf16 v[84:87], v[48:51], a[40:47], v15
v_smfmac_f32_16x16x64_bf16 v[88:91], v[48:51], a[48:55], v15
v_smfmac_f32_16x16x64_bf16 v[92:95], v[48:51], a[56:63], v15
s_cbranch_vccnz Lpf_147
v_smfmac_f32_16x16x64_bf16 v[64:67], v[52:55], a[64:71], v15
v_smfmac_f32_16x16x64_bf16 v[68:71], v[52:55], a[72:79], v15
v_smfmac_f32_16x16x64_bf16 v[72:75], v[52:55], a[80:87], v15
v_smfmac_f32_16x16x64_bf16 v[76:79], v[52:55], a[88:95], v15
v_smfmac_f32_16x16x64_bf16 v[80:83], v[52:55], a[96:103], v15
s_waitcnt vmcnt(1)
v_max3_u32 v44, v56, v57, v58
v_max_u32 v44, v44, v59
v_cmp_eq_u32 vcc, -1, v44
v_smfmac_f32_16x16x64_bf16 v[84:87], v[52:55], a[104:111], v15
v_smfmac_f32_16x16x64_bf16 v[88:91], v[52:55], a[112:119], v15
v_smfmac_f32_16x16x64_bf16 v[92:95], v[52:55], a[120:127], v15
s_cbranch_vccnz Lpf_148
v_smfmac_f32_16x16x64_bf16 v[64:67], v[56:59], a[128:135], v15
v_smfmac_f32_16x16x64_bf16 v[68:71], v[56:59], a[136:143], v15
v_smfmac_f32_16x16x64_bf16 v[72:75], v[56:59], a[144:151], v15
v_smfmac_f32_16x16x64_bf16 v[76:79], v[56:59], a[152:159], v15
v_smfmac_f32_16x16x64_bf16 v[80:83], v[56:59], a[160:167], v15
s_waitcnt vmcnt(0)
v_max3_u32 v44, v60, v61, v62
v_max_u32 v44, v44, v63
v_cmp_eq_u32 vcc, -1, v44
v_smfmac_f32_16x16x64_bf16 v[84:87], v[56:59], a[168:175], v15
v_smfmac_f32_16x16x64_bf16 v[88:91], v[56:59], a[176:183], v15
v_smfmac_f32_16x16x64_bf16 v[92:95], v[56:59], a[184:191], v15
s_cbranch_vccnz Lpf_149
v_smfmac_f32_16x16x64_bf16 v[64:67], v[60:63], a[192:199], v15
v_smfmac_f32_16x16x64_bf16 v[68:71], v[60:63], a[200:207], v15
v_smfmac_f32_16x16x64_bf16 v[72:75], v[60:63], a[208:215], v15
v_smfmac_f32_16x16x64_bf16 v[76:79], v[60:63], a[216:223], v15
v_smfmac_f32_16x16x64_bf16 v[80:83], v[60:63], a[224:231], v15
v_smfmac_f32_16x16x64_bf16 v[84:87], v[60:63], a[232:239], v15
v_smfmac_f32_16x16x64_bf16 v[88:91], v[60:63], a[240:247], v15
v_smfmac_f32_16x16x64_bf16 v[92:95], v[60:63], a[248:255], v15
Lpd_145:
s_nop 0
v_add_f32 v64, v64, v65
v_add_f32 v66, v66, v67
v_add_f32 v68, v68, v69
v_add_f32 v70, v70, v71
v_add_f32 v72, v72, v73
ds_write_addtid_b32 v64 offset:0
v_add_f32 v74, v74, v75
ds_write_addtid_b32 v66 offset:384
v_add_f32 v76, v76, v77
ds_write_addtid_b32 v68 offset:640
v_add_f32 v78, v78, v79
ds_write_addtid_b32 v70 offset:1024
v_add_f32 v80, v80, v81
ds_write_addtid_b32 v72 offset:1280
v_add_f32 v82, v82, v83
ds_write_addtid_b32 v74 offset:1664
v_add_f32 v84, v84, v85
ds_write_addtid_b32 v76 offset:1920
v_add_f32 v86, v86, v87
ds_write_addtid_b32 v78 offset:2304
v_add_f32 v88, v88, v89
ds_write_addtid_b32 v80 offset:2560
v_add_f32 v90, v90, v91
ds_write_addtid_b32 v82 offset:2944
v_add_f32 v92, v92, v93
ds_write_addtid_b32 v84 offset:3200
v_add_f32 v94, v94, v95
ds_write_addtid_b32 v86 offset:3584
ds_write_addtid_b32 v88 offset:3840
ds_write_addtid_b32 v90 offset:4224
ds_write_addtid_b32 v92 offset:4480
ds_write_addtid_b32 v94 offset:4864
Lqj_144:
v_mfma_f32_16x16x32_bf16 v[200:203], v[204:207], v[204:207], 0
v_mfma_f32_16x16x32_bf16 v[200:203], v[204:207], v[204:207], 0
s_waitcnt lgkmcnt(0)
s_barrier
ds_read_b128 v[76:79], v18 offset:0
ds_read_b128 v[80:83], v18 offset:5120
ds_read_b128 v[84:87], v18 offset:10240
ds_read_b128 v[88:91], v18 offset:15360
v_mov_b32 v72, 0
v_mov_b32 v73, 0
v_mov_b32 v74, 0
v_mov_b32 v75, 0
v_mfma_f32_16x16x32_bf16 v[200:203], v[204:207], v[204:207], 0
v_mfma_f32_16x16x32_bf16 v[200:203], v[204:207], v[204:207], 0
s_waitcnt lgkmcnt(0)
v_pk_add_f32 v[76:77], v[76:77], v[80:81]
v_pk_add_f32 v[84:85], v[84:85], v[88:89]
v_pk_add_f32 v[78:79], v[78:79], v[82:83]
v_pk_add_f32 v[86:87], v[86:87], v[90:91]
v_pk_add_f32 v[76:77], v[76:77], v[84:85]
v_pk_add_f32 v[78:79], v[78:79], v[86:87]
v_cvt_pk_bf16_f32 v76, v76, v77
v_cvt_pk_bf16_f32 v77, v78, v79
ds_write_b64 v19, v[76:77] offset:20480
buffer_load_dwordx4 v[112:115], v11, s[4:7], s40 offen offset:0 sc1
buffer_load_dwordx4 v[116:119], v11, s[4:7], s40 offen offset:1024 sc1
v_mfma_f32_16x16x32_bf16 v[200:203], v[204:207], v[204:207], 0
v_mfma_f32_16x16x32_bf16 v[200:203], v[204:207], v[204:207], 0
s_waitcnt lgkmcnt(0)
s_barrier
ds_read_b128 v[96:99], v20 offset:20480
ds_read_b128 v[100:103], v20 offset:20992
ds_read_b128 v[104:107], v20 offset:21504
ds_read_b128 v[108:111], v20 offset:22016
v_mfma_f32_16x16x32_bf16 v[200:203], v[204:207], v[204:207], 0
v_mfma_f32_16x16x32_bf16 v[200:203], v[204:207], v[204:207], 0
s_waitcnt lgkmcnt(3)
v_mfma_f32_16x16x32_bf16 v[64:67], v[128:131], v[96:99], 0
v_mfma_f32_16x16x32_bf16 v[68:71], v[144:147], v[96:99], 0
s_waitcnt lgkmcnt(2)
buffer_load_dwordx4 v[48:51], v11, s[4:7], s40 offen offset:0 sc1
v_mfma_f32_16x16x32_bf16 v[64:67], v[132:135], v[100:103], v[64:67]
v_mfma_f32_16x16x32_bf16 v[68:71], v[148:151], v[100:103], v[68:71]
s_waitcnt lgkmcnt(1)
buffer_load_dwordx4 v[52:55], v11, s[4:7], s40 offen offset:1024 sc1
v_mfma_f32_16x16x32_bf16 v[64:67], v[136:139], v[104:107], v[64:67]
v_mfma_f32_16x16x32_bf16 v[68:71], v[152:155], v[104:107], v[68:71]
s_waitcnt lgkmcnt(0)
s_waitcnt vmcnt(2)
v_max3_u32 v44, v112, v113, v114
v_max3_u32 v44, v44, v115, v116
v_max3_u32 v44, v44, v117, v118
v_max_u32 v44, v44, v119
v_cmp_eq_u32 vcc, -1, v44
v_mfma_f32_16x16x32_bf16 v[64:67], v[140:143], v[108:111], v[64:67]
v_mfma_f32_16x16x32_bf16 v[68:71], v[156:159], v[108:111], v[68:71]
s_cbranch_vccnz Lkr_150
v_smfmac_f32_16x16x64_bf16 v[72:75], v[112:115], v[96:103], v15
v_smfmac_f32_16x16x64_bf16 v[72:75], v[116:119], v[104:111], v15
Lko_151:
s_nop 3
v_max3_f32 v45, v64, v65, v66
v_max3_f32 v45, v45, v67, v68
v_max3_f32 v45, v45, v69, v70
v_max_f32 v45, v45, v71
v_add_f32 v72, v72, v73
v_add_f32 v73, v74, v75
v_max3_f32 v46, v45, v72, v73
v_max3_f32 v47, v45, v72, v73
buffer_load_dwordx2 v[120:121], v12, s[4:7], s40 offen sc1
buffer_load_dwordx2 v[122:123], v13, s[4:7], s40 offen sc1
s_nop 1
v_permlane32_swap_b32 v46, v47
s_nop 0
v_max_f32 v45, v46, v47
v_max_f32 v46, v46, v47
s_nop 1
v_permlane16_swap_b32 v45, v46
s_nop 0
v_max_f32 v45, v45, v46
v_mul_f32 v46, s49, v45
v_pk_fma_f32 v[64:65], v[64:65], s[48:49], v[46:47] op_sel_hi:[1,0,0]
v_pk_fma_f32 v[66:67], v[66:67], s[48:49], v[46:47] op_sel_hi:[1,0,0]
v_pk_fma_f32 v[68:69], v[68:69], s[48:49], v[46:47] op_sel_hi:[1,0,0]
v_pk_fma_f32 v[70:71], v[70:71], s[48:49], v[46:47] op_sel_hi:[1,0,0]
v_pk_fma_f32 v[72:73], v[72:73], s[48:49], v[46:47] op_sel_hi:[1,0,0]
v_exp_f32 v64, v64
v_exp_f32 v65, v65
v_exp_f32 v66, v66
v_exp_f32 v67, v67
v_exp_f32 v68, v68
v_exp_f32 v69, v69
v_exp_f32 v70, v70
v_exp_f32 v71, v71
v_exp_f32 v72, v72
v_exp_f32 v73, v73
buffer_store_dword v197, v193, s[4:7], s59 offen sc1
v_cvt_pk_bf16_f32 v76, v64, v65
v_cvt_pk_bf16_f32 v77, v66, v67
v_cvt_pk_bf16_f32 v78, v68, v69
v_cvt_pk_bf16_f32 v79, v70, v71
v_cvt_pk_bf16_f32 v2, v72, v73
v_cvt_pk_bf16_f32 v7, v72, v73
v_mfma_f32_16x16x32_bf16 v[84:87], v[32:35], v[76:79], 0
v_mfma_f32_16x16x32_bf16 v[96:99], v[160:163], v[76:79], 0
s_waitcnt vmcnt(1)
v_max3_u32 v44, v120, v121, v122
v_max_u32 v44, v44, v123
v_cmp_eq_u32 vcc, -1, v44
v_mfma_f32_16x16x32_bf16 v[100:103], v[164:167], v[76:79], 0
v_mfma_f32_16x16x32_bf16 v[84:87], v[32:35], v[2:5], v[84:87]
s_cbranch_vccnz Lvr_152
Lvo_153:
v_mfma_f32_16x16x32_bf16 v[96:99], v[120:123], v[2:5], v[96:99]
v_mfma_f32_16x16x32_bf16 v[100:103], v[120:123], v[6:9], v[100:103]
v_mfma_f32_16x16x32_bf16 v[200:203], v[204:207], v[204:207], 0
s_nop 4
v_rcp_f32 v46, v84
s_nop 0
v_pk_mul_f32 v[96:97], v[96:97], v[46:47] op_sel_hi:[1,0]
v_pk_mul_f32 v[98:99], v[98:99], v[46:47] op_sel_hi:[1,0]
v_pk_mul_f32 v[100:101], v[100:101], v[46:47] op_sel_hi:[1,0]
v_pk_mul_f32 v[102:103], v[102:103], v[46:47] op_sel_hi:[1,0]
v_cvt_pk_bf16_f32 v124, v96, v97
v_cvt_pk_bf16_f32 v125, v98, v99
v_cvt_pk_bf16_f32 v126, v100, v101
v_cvt_pk_bf16_f32 v127, v102, v103
v_min_u32 v124, -2, v124
v_min_u32 v125, -2, v125
v_min_u32 v126, -2, v126
v_min_u32 v127, -2, v127
buffer_store_dwordx4 v[124:127], v14, s[4:7], s40 offen sc1
s_barrier
buffer_store_dwordx4 v[28:31], v14, s[4:7], s42 offen sc1
s_cmp_ge_u32 s36, 62
s_cbranch_scc1 Lnp_154
s_add_u32 s27, s36, 3
v_add_u32 v209, v209, v210
v_cmp_gt_u32 vcc, s27, v209
s_cbranch_vccnz Lpw_155
Lpk_156:
s_mov_b32 m0, s57
s_add_u32 s38, s47, 3072
buffer_load_dwordx4 v21, s[4:7], s47 offen offset:0 sc1 lds
buffer_load_dwordx4 v21, s[4:7], s47 offen offset:1024 sc1 lds
buffer_load_dwordx4 v21, s[4:7], s47 offen offset:2048 sc1 lds
s_add_u32 m0, s57, 3072
s_xor_b32 s57, s57, 98304
buffer_load_dwordx4 v21, s[4:7], s38 offen offset:0 sc1 lds
buffer_load_dwordx4 v21, s[4:7], s38 offen offset:1024 sc1 lds
buffer_load_dwordx4 v21, s[4:7], s38 offen offset:2048 sc1 lds
s_add_u32 s47, s47, 786432
buffer_load_dword v209, v208, s[4:7], 0 offen sc1
s_add_u32 s38, s36, 2
s_and_b32 s38, s38, 3
s_lshl_b32 s88, s38, 18
s_add_u32 s88, s88, s46
s_add_u32 s89, s88, 0x100000
buffer_store_dwordx2 v[28:29], v198, s[4:7], s88 offen sc1
buffer_store_dwordx2 v[28:29], v198, s[4:7], s89 offen sc1
Lnp_154:
v_mov_b32 v72, 0
v_mov_b32 v73, 0
v_mov_b32 v74, 0
v_mov_b32 v75, 0
v_mfma_f32_16x16x32_bf16 v[64:67], v[128:131], v[176:179], v[36:39]
v_mfma_f32_16x16x32_bf16 v[68:71], v[144:147], v[176:179], v[40:43]
v_mfma_f32_16x16x32_bf16 v[64:67], v[132:135], v[180:183], v[64:67]
v_mfma_f32_16x16x32_bf16 v[68:71], v[148:151], v[180:183], v[68:71]
v_mfma_f32_16x16x32_bf16 v[64:67], v[136:139], v[184:187], v[64:67]
v_mfma_f32_16x16x32_bf16 v[68:71], v[152:155], v[184:187], v[68:71]
v_mfma_f32_16x16x32_bf16 v[64:67], v[140:143], v[188:191], v[64:67]
v_mfma_f32_16x16x32_bf16 v[68:71], v[156:159], v[188:191], v[68:71]
v_smfmac_f32_16x16x64_bf16 v[72:75], v[112:115], v[176:183], v15
v_smfmac_f32_16x16x64_bf16 v[72:75], v[116:119], v[184:191], v15
s_and_b32 s38, s36, 7
s_lshl_b32 s38, s38, 18
s_add_u32 s50, s38, 83886080
s_nop 2
v_max3_f32 v45, v64, v65, v66
v_max3_f32 v45, v45, v67, v68
v_max3_f32 v45, v45, v69, v70
v_max_f32 v45, v45, v71
v_add_f32 v72, v72, v73
v_add_f32 v73, v74, v75
v_max3_f32 v46, v45, v72, v73
v_max3_f32 v47, v45, v72, v73
s_nop 1
v_permlane32_swap_b32 v46, v47
s_nop 0
v_max_f32 v45, v46, v47
v_max_f32 v46, v46, v47
s_nop 1
v_permlane16_swap_b32 v45, v46
s_nop 0
v_max_f32 v45, v45, v46
v_mul_f32 v46, s49, v45
v_pk_fma_f32 v[64:65], v[64:65], s[48:49], v[46:47] op_sel_hi:[1,0,0]
v_pk_fma_f32 v[66:67], v[66:67], s[48:49], v[46:47] op_sel_hi:[1,0,0]
v_pk_fma_f32 v[68:69], v[68:69], s[48:49], v[46:47] op_sel_hi:[1,0,0]
v_pk_fma_f32 v[70:71], v[70:71], s[48:49], v[46:47] op_sel_hi:[1,0,0]
v_pk_fma_f32 v[72:73], v[72:73], s[48:49], v[46:47] op_sel_hi:[1,0,0]
v_exp_f32 v64, v64
v_exp_f32 v65, v65
v_exp_f32 v66, v66
v_exp_f32 v67, v67
v_exp_f32 v68, v68
v_exp_f32 v69, v69
v_exp_f32 v70, v70
v_exp_f32 v71, v71
v_exp_f32 v72, v72
v_exp_f32 v73, v73
v_cvt_pk_bf16_f32 v76, v64, v65
v_cvt_pk_bf16_f32 v77, v66, v67
v_cvt_pk_bf16_f32 v78, v68, v69
v_cvt_pk_bf16_f32 v79, v70, v71
v_cvt_pk_bf16_f32 v2, v72, v73
v_cvt_pk_bf16_f32 v7, v72, v73
v_mfma_f32_16x16x32_bf16 v[84:87], v[32:35], v[76:79], 0
v_mfma_f32_16x16x32_bf16 v[96:99], v[160:163], v[76:79], 0
v_mfma_f32_16x16x32_bf16 v[100:103], v[164:167], v[76:79], 0
v_mfma_f32_16x16x32_bf16 v[104:107], v[168:171], v[76:79], 0
v_mfma_f32_16x16x32_bf16 v[108:111], v[172:175], v[76:79], 0
v_mfma_f32_16x16x32_bf16 v[84:87], v[32:35], v[2:5], v[84:87]
v_mfma_f32_16x16x32_bf16 v[96:99], v[120:123], v[2:5], v[96:99]
v_mfma_f32_16x16x32_bf16 v[100:103], v[120:123], v[6:9], v[100:103]
v_mfma_f32_16x16x32_bf16 v[104:107], v[120:123], v[0:3], v[104:107]
v_mfma_f32_16x16x32_bf16 v[108:111], v[120:123], v[4:7], v[108:111]
v_mfma_f32_16x16x32_bf16 v[200:203], v[204:207], v[204:207], 0
s_nop 2
v_rcp_f32 v46, v84
s_nop 0
v_pk_mul_f32 v[96:97], v[96:97], v[46:47] op_sel_hi:[1,0]
v_pk_mul_f32 v[98:99], v[98:99], v[46:47] op_sel_hi:[1,0]
v_pk_mul_f32 v[100:101], v[100:101], v[46:47] op_sel_hi:[1,0]
v_pk_mul_f32 v[102:103], v[102:103], v[46:47] op_sel_hi:[1,0]
v_pk_mul_f32 v[104:105], v[104:105], v[46:47] op_sel_hi:[1,0]
v_pk_mul_f32 v[106:107], v[106:107], v[46:47] op_sel_hi:[1,0]
v_pk_mul_f32 v[108:109], v[108:109], v[46:47] op_sel_hi:[1,0]
v_pk_mul_f32 v[110:111], v[110:111], v[46:47] op_sel_hi:[1,0]
v_cvt_pk_bf16_f32 v96, v96, v97
v_cvt_pk_bf16_f32 v97, v98, v99
v_cvt_pk_bf16_f32 v98, v100, v101
v_cvt_pk_bf16_f32 v99, v102, v103
v_cvt_pk_bf16_f32 v100, v104, v105
v_cvt_pk_bf16_f32 v101, v106, v107
v_cvt_pk_bf16_f32 v102, v108, v109
v_cvt_pk_bf16_f32 v103, v110, v111
buffer_store_dwordx4 v[96:99], v26, s[4:7], s50 offen sc1
buffer_store_dwordx4 v[100:103], v27, s[4:7], s50 offen sc1
s_add_u32 s36, s36, 1
s_cmp_lt_u32 s36, 64
s_cbranch_scc1 Lq_141
s_waitcnt vmcnt(0)
buffer_store_dword v197, v199, s[4:7], 0 offen sc1
s_branch Lend_1
Lpw_155:
Lbw_157:
buffer_load_dword v209, v208, s[4:7], 0 offen sc1
s_waitcnt vmcnt(0)
v_add_u32 v209, v209, v210
v_cmp_gt_u32 vcc, s27, v209
s_cbranch_vccz Lbo_158
s_sub_u32 s37, s37, 1
s_cbranch_scc1 Lend_1
s_sleep 2
s_branch Lbw_157
Lbo_158:
s_branch Lpk_156
Lpf_146:
buffer_load_dwordx4 v[48:51], v10, s[4:7], s40 offen offset:0 sc1
v_mfma_f32_16x16x32_bf16 v[200:203], v[204:207], v[204:207], 0
s_sub_u32 s37, s37, 1
s_cbranch_scc1 Lend_1
Lps_159:
s_waitcnt vmcnt(3)
v_max3_u32 v44, v52, v53, v54
v_max_u32 v44, v44, v55
v_cmp_eq_u32 vcc, -1, v44
s_cbranch_vccnz Lpf_160
v_smfmac_f32_16x16x64_bf16 v[64:67], v[52:55], a[64:71], v15
v_smfmac_f32_16x16x64_bf16 v[68:71], v[52:55], a[72:79], v15
v_smfmac_f32_16x16x64_bf16 v[72:75], v[52:55], a[80:87], v15
v_smfmac_f32_16x16x64_bf16 v[76:79], v[52:55], a[88:95], v15
v_smfmac_f32_16x16x64_bf16 v[80:83], v[52:55], a[96:103], v15
v_smfmac_f32_16x16x64_bf16 v[84:87], v[52:55], a[104:111], v15
v_smfmac_f32_16x16x64_bf16 v[88:91], v[52:55], a[112:119], v15
v_smfmac_f32_16x16x64_bf16 v[92:95], v[52:55], a[120:127], v15
Lps_161:
s_waitcnt vmcnt(2)
v_max3_u32 v44, v56, v57, v58
v_max_u32 v44, v44, v59
v_cmp_eq_u32 vcc, -1, v44
s_cbranch_vccnz Lpf_162
v_smfmac_f32_16x16x64_bf16 v[64:67], v[56:59], a[128:135], v15
v_smfmac_f32_16x16x64_bf16 v[68:71], v[56:59], a[136:143], v15
v_smfmac_f32_16x16x64_bf16 v[72:75], v[56:59], a[144:151], v15
v_smfmac_f32_16x16x64_bf16 v[76:79], v[56:59], a[152:159], v15
v_smfmac_f32_16x16x64_bf16 v[80:83], v[56:59], a[160:167], v15
v_smfmac_f32_16x16x64_bf16 v[84:87], v[56:59], a[168:175], v15
v_smfmac_f32_16x16x64_bf16 v[88:91], v[56:59], a[176:183], v15
v_smfmac_f32_16x16x64_bf16 v[92:95], v[56:59], a[184:191], v15
Lps_163:
s_waitcnt vmcnt(1)
v_max3_u32 v44, v60, v61, v62
v_max_u32 v44, v44, v63
v_cmp_eq_u32 vcc, -1, v44
s_cbranch_vccnz Lpf_164
v_smfmac_f32_16x16x64_bf16 v[64:67], v[60:63], a[192:199], v15
v_smfmac_f32_16x16x64_bf16 v[68:71], v[60:63], a[200:207], v15
v_smfmac_f32_16x16x64_bf16 v[72:75], v[60:63], a[208:215], v15
v_smfmac_f32_16x16x64_bf16 v[76:79], v[60:63], a[216:223], v15
v_smfmac_f32_16x16x64_bf16 v[80:83], v[60:63], a[224:231], v15
v_smfmac_f32_16x16x64_bf16 v[84:87], v[60:63], a[232:239], v15
v_smfmac_f32_16x16x64_bf16 v[88:91], v[60:63], a[240:247], v15
v_smfmac_f32_16x16x64_bf16 v[92:95], v[60:63], a[248:255], v15
Lps_165:
s_waitcnt vmcnt(0)
v_max3_u32 v44, v48, v49, v50
v_max_u32 v44, v44, v51
v_cmp_eq_u32 vcc, -1, v44
s_cbranch_vccnz Lpf_166
v_smfmac_f32_16x16x64_bf16 v[64:67], v[48:51], a[0:7], v15
v_smfmac_f32_16x16x64_bf16 v[68:71], v[48:51], a[8:15], v15
v_smfmac_f32_16x16x64_bf16 v[72:75], v[48:51], a[16:23], v15
v_smfmac_f32_16x16x64_bf16 v[76:79], v[48:51], a[24:31], v15
v_smfmac_f32_16x16x64_bf16 v[80:83], v[48:51], a[32:39], v15
v_smfmac_f32_16x16x64_bf16 v[84:87], v[48:51], a[40:47], v15
v_smfmac_f32_16x16x64_bf16 v[88:91], v[48:51], a[48:55], v15
v_smfmac_f32_16x16x64_bf16 v[92:95], v[48:51], a[56:63], v15
s_branch Lpd_145
Lpf_147:
buffer_load_dwordx4 v[52:55], v10, s[4:7], s40 offen offset:1024 sc1
v_mfma_f32_16x16x32_bf16 v[200:203], v[204:207], v[204:207], 0
s_sub_u32 s37, s37, 1
s_cbranch_scc1 Lend_1
Lps_167:
s_waitcnt vmcnt(2)
v_max3_u32 v44, v56, v57, v58
v_max_u32 v44, v44, v59
v_cmp_eq_u32 vcc, -1, v44
s_cbranch_vccnz Lpf_168
v_smfmac_f32_16x16x64_bf16 v[64:67], v[56:59], a[128:135], v15
v_smfmac_f32_16x16x64_bf16 v[68:71], v[56:59], a[136:143], v15
v_smfmac_f32_16x16x64_bf16 v[72:75], v[56:59], a[144:151], v15
v_smfmac_f32_16x16x64_bf16 v[76:79], v[56:59], a[152:159], v15
v_smfmac_f32_16x16x64_bf16 v[80:83], v[56:59], a[160:167], v15
v_smfmac_f32_16x16x64_bf16 v[84:87], v[56:59], a[168:175], v15
v_smfmac_f32_16x16x64_bf16 v[88:91], v[56:59], a[176:183], v15
v_smfmac_f32_16x16x64_bf16 v[92:95], v[56:59], a[184:191], v15
Lps_169:
s_waitcnt vmcnt(1)
v_max3_u32 v44, v60, v61, v62
v_max_u32 v44, v44, v63
v_cmp_eq_u32 vcc, -1, v44
s_cbranch_vccnz Lpf_170
v_smfmac_f32_16x16x64_bf16 v[64:67], v[60:63], a[192:199], v15
v_smfmac_f32_16x16x64_bf16 v[68:71], v[60:63], a[200:207], v15
v_smfmac_f32_16x16x64_bf16 v[72:75], v[60:63], a[208:215], v15
v_smfmac_f32_16x16x64_bf16 v[76:79], v[60:63], a[216:223], v15
v_smfmac_f32_16x16x64_bf16 v[80:83], v[60:63], a[224:231], v15
v_smfmac_f32_16x16x64_bf16 v[84:87], v[60:63], a[232:239], v15
v_smfmac_f32_16x16x64_bf16 v[88:91], v[60:63], a[240:247], v15
v_smfmac_f32_16x16x64_bf16 v[92:95], v[60:63], a[248:255], v15
Lps_171:
s_waitcnt vmcnt(0)
v_max3_u32 v44, v52, v53, v54
v_max_u32 v44, v44, v55
v_cmp_eq_u32 vcc, -1, v44
s_cbranch_vccnz Lpf_172
v_smfmac_f32_16x16x64_bf16 v[64:67], v[52:55], a[64:71], v15
v_smfmac_f32_16x16x64_bf16 v[68:71], v[52:55], a[72:79], v15
v_smfmac_f32_16x16x64_bf16 v[72:75], v[52:55], a[80:87], v15
v_smfmac_f32_16x16x64_bf16 v[76:79], v[52:55], a[88:95], v15
v_smfmac_f32_16x16x64_bf16 v[80:83], v[52:55], a[96:103], v15
v_smfmac_f32_16x16x64_bf16 v[84:87], v[52:55], a[104:111], v15
v_smfmac_f32_16x16x64_bf16 v[88:91], v[52:55], a[112:119], v15
v_smfmac_f32_16x16x64_bf16 v[92:95], v[52:55], a[120:127], v15
s_branch Lpd_145
Lpf_148:
buffer_load_dwordx4 v[56:59], v10, s[4:7], s40 offen offset:2048 sc1
v_mfma_f32_16x16x32_bf16 v[200:203], v[204:207], v[204:207], 0
s_sub_u32 s37, s37, 1
s_cbranch_scc1 Lend_1
Lps_173:
s_waitcnt vmcnt(1)
v_max3_u32 v44, v60, v61, v62
v_max_u32 v44, v44, v63
v_cmp_eq_u32 vcc, -1, v44
s_cbranch_vccnz Lpf_174
v_smfmac_f32_16x16x64_bf16 v[64:67], v[60:63], a[192:199], v15
v_smfmac_f32_16x16x64_bf16 v[68:71], v[60:63], a[200:207], v15
v_smfmac_f32_16x16x64_bf16 v[72:75], v[60:63], a[208:215], v15
v_smfmac_f32_16x16x64_bf16 v[76:79], v[60:63], a[216:223], v15
v_smfmac_f32_16x16x64_bf16 v[80:83], v[60:63], a[224:231], v15
v_smfmac_f32_16x16x64_bf16 v[84:87], v[60:63], a[232:239], v15
v_smfmac_f32_16x16x64_bf16 v[88:91], v[60:63], a[240:247], v15
v_smfmac_f32_16x16x64_bf16 v[92:95], v[60:63], a[248:255], v15
Lps_175:
s_waitcnt vmcnt(0)
v_max3_u32 v44, v56, v57, v58
v_max_u32 v44, v44, v59
v_cmp_eq_u32 vcc, -1, v44
s_cbranch_vccnz Lpf_176
v_smfmac_f32_16x16x64_bf16 v[64:67], v[56:59], a[128:135], v15
v_smfmac_f32_16x16x64_bf16 v[68:71], v[56:59], a[136:143], v15
v_smfmac_f32_16x16x64_bf16 v[72:75], v[56:59], a[144:151], v15
v_smfmac_f32_16x16x64_bf16 v[76:79], v[56:59], a[152:159], v15
v_smfmac_f32_16x16x64_bf16 v[80:83], v[56:59], a[160:167], v15
v_smfmac_f32_16x16x64_bf16 v[84:87], v[56:59], a[168:175], v15
v_smfmac_f32_16x16x64_bf16 v[88:91], v[56:59], a[176:183], v15
v_smfmac_f32_16x16x64_bf16 v[92:95], v[56:59], a[184:191], v15
s_branch Lpd_145
Lpf_149:
buffer_load_dwordx4 v[60:63], v10, s[4:7], s40 offen offset:3072 sc1
v_mfma_f32_16x16x32_bf16 v[200:203], v[204:207], v[204:207], 0
s_sub_u32 s37, s37, 1
s_cbranch_scc1 Lend_1
Lps_177:
s_waitcnt vmcnt(0)
v_max3_u32 v44, v60, v61, v62
v_max_u32 v44, v44, v63
v_cmp_eq_u32 vcc, -1, v44
s_cbranch_vccnz Lpf_178
v_smfmac_f32_16x16x64_bf16 v[64:67], v[60:63], a[192:199], v15
v_smfmac_f32_16x16x64_bf16 v[68:71], v[60:63], a[200:207], v15
v_smfmac_f32_16x16x64_bf16 v[72:75], v[60:63], a[208:215], v15
v_smfmac_f32_16x16x64_bf16 v[76:79], v[60:63], a[216:223], v15
v_smfmac_f32_16x16x64_bf16 v[80:83], v[60:63], a[224:231], v15
v_smfmac_f32_16x16x64_bf16 v[84:87], v[60:63], a[232:239], v15
v_smfmac_f32_16x16x64_bf16 v[88:91], v[60:63], a[240:247], v15
v_smfmac_f32_16x16x64_bf16 v[92:95], v[60:63], a[248:255], v15
s_branch Lpd_145
Lpf_160:
buffer_load_dwordx4 v[52:55], v10, s[4:7], s40 offen offset:1024 sc1
v_mfma_f32_16x16x32_bf16 v[200:203], v[204:207], v[204:207], 0
Lps_179:
s_waitcnt vmcnt(3)
v_max3_u32 v44, v56, v57, v58
v_max_u32 v44, v44, v59
v_cmp_eq_u32 vcc, -1, v44
s_cbranch_vccnz Lpf_180
v_smfmac_f32_16x16x64_bf16 v[64:67], v[56:59], a[128:135], v15
v_smfmac_f32_16x16x64_bf16 v[68:71], v[56:59], a[136:143], v15
v_smfmac_f32_16x16x64_bf16 v[72:75], v[56:59], a[144:151], v15
v_smfmac_f32_16x16x64_bf16 v[76:79], v[56:59], a[152:159], v15
v_smfmac_f32_16x16x64_bf16 v[80:83], v[56:59], a[160:167], v15
v_smfmac_f32_16x16x64_bf16 v[84:87], v[56:59], a[168:175], v15
v_smfmac_f32_16x16x64_bf16 v[88:91], v[56:59], a[176:183], v15
v_smfmac_f32_16x16x64_bf16 v[92:95], v[56:59], a[184:191], v15
Lps_181:
s_waitcnt vmcnt(2)
v_max3_u32 v44, v60, v61, v62
v_max_u32 v44, v44, v63
v_cmp_eq_u32 vcc, -1, v44
s_cbranch_vccnz Lpf_182
v_smfmac_f32_16x16x64_bf16 v[64:67], v[60:63], a[192:199], v15
v_smfmac_f32_16x16x64_bf16 v[68:71], v[60:63], a[200:207], v15
v_smfmac_f32_16x16x64_bf16 v[72:75], v[60:63], a[208:215], v15
v_smfmac_f32_16x16x64_bf16 v[76:79], v[60:63], a[216:223], v15
v_smfmac_f32_16x16x64_bf16 v[80:83], v[60:63], a[224:231], v15
v_smfmac_f32_16x16x64_bf16 v[84:87], v[60:63], a[232:239], v15
v_smfmac_f32_16x16x64_bf16 v[88:91], v[60:63], a[240:247], v15
v_smfmac_f32_16x16x64_bf16 v[92:95], v[60:63], a[248:255], v15
Lps_183:
s_waitcnt vmcnt(1)
v_max3_u32 v44, v48, v49, v50
v_max_u32 v44, v44, v51
v_cmp_eq_u32 vcc, -1, v44
s_cbranch_vccnz Lpf_184
v_smfmac_f32_16x16x64_bf16 v[64:67], v[48:51], a[0:7], v15
v_smfmac_f32_16x16x64_bf16 v[68:71], v[48:51], a[8:15], v15
v_smfmac_f32_16x16x64_bf16 v[72:75], v[48:51], a[16:23], v15
v_smfmac_f32_16x16x64_bf16 v[76:79], v[48:51], a[24:31], v15
v_smfmac_f32_16x16x64_bf16 v[80:83], v[48:51], a[32:39], v15
v_smfmac_f32_16x16x64_bf16 v[84:87], v[48:51], a[40:47], v15
v_smfmac_f32_16x16x64_bf16 v[88:91], v[48:51], a[48:55], v15
v_smfmac_f32_16x16x64_bf16 v[92:95], v[48:51], a[56:63], v15
s_branch Lps_171
Lpf_162:
buffer_load_dwordx4 v[56:59], v10, s[4:7], s40 offen offset:2048 sc1
v_mfma_f32_16x16x32_bf16 v[200:203], v[204:207], v[204:207], 0
Lps_185:
s_waitcnt vmcnt(2)
v_max3_u32 v44, v60, v61, v62
v_max_u32 v44, v44, v63
v_cmp_eq_u32 vcc, -1, v44
s_cbranch_vccnz Lpf_186
v_smfmac_f32_16x16x64_bf16 v[64:67], v[60:63], a[192:199], v15
v_smfmac_f32_16x16x64_bf16 v[68:71], v[60:63], a[200:207], v15
v_smfmac_f32_16x16x64_bf16 v[72:75], v[60:63], a[208:215], v15
v_smfmac_f32_16x16x64_bf16 v[76:79], v[60:63], a[216:223], v15
v_smfmac_f32_16x16x64_bf16 v[80:83], v[60:63], a[224:231], v15
v_smfmac_f32_16x16x64_bf16 v[84:87], v[60:63], a[232:239], v15
v_smfmac_f32_16x16x64_bf16 v[88:91], v[60:63], a[240:247], v15
v_smfmac_f32_16x16x64_bf16 v[92:95], v[60:63], a[248:255], v15
Lps_187:
s_waitcnt vmcnt(1)
v_max3_u32 v44, v48, v49, v50
v_max_u32 v44, v44, v51
v_cmp_eq_u32 vcc, -1, v44
s_cbranch_vccnz Lpf_188
v_smfmac_f32_16x16x64_bf16 v[64:67], v[48:51], a[0:7], v15
v_smfmac_f32_16x16x64_bf16 v[68:71], v[48:51], a[8:15], v15
v_smfmac_f32_16x16x64_bf16 v[72:75], v[48:51], a[16:23], v15
v_smfmac_f32_16x16x64_bf16 v[76:79], v[48:51], a[24:31], v15
v_smfmac_f32_16x16x64_bf16 v[80:83], v[48:51], a[32:39], v15
v_smfmac_f32_16x16x64_bf16 v[84:87], v[48:51], a[40:47], v15
v_smfmac_f32_16x16x64_bf16 v[88:91], v[48:51], a[48:55], v15
v_smfmac_f32_16x16x64_bf16 v[92:95], v[48:51], a[56:63], v15
s_branch Lps_175
Lpf_164:
buffer_load_dwordx4 v[60:63], v10, s[4:7], s40 offen offset:3072 sc1
v_mfma_f32_16x16x32_bf16 v[200:203], v[204:207], v[204:207], 0
Lps_189:
s_waitcnt vmcnt(1)
v_max3_u32 v44, v48, v49, v50
v_max_u32 v44, v44, v51
v_cmp_eq_u32 vcc, -1, v44
s_cbranch_vccnz Lpf_190
v_smfmac_f32_16x16x64_bf16 v[64:67], v[48:51], a[0:7], v15
v_smfmac_f32_16x16x64_bf16 v[68:71], v[48:51], a[8:15], v15
v_smfmac_f32_16x16x64_bf16 v[72:75], v[48:51], a[16:23], v15
v_smfmac_f32_16x16x64_bf16 v[76:79], v[48:51], a[24:31], v15
v_smfmac_f32_16x16x64_bf16 v[80:83], v[48:51], a[32:39], v15
v_smfmac_f32_16x16x64_bf16 v[84:87], v[48:51], a[40:47], v15
v_smfmac_f32_16x16x64_bf16 v[88:91], v[48:51], a[48:55], v15
v_smfmac_f32_16x16x64_bf16 v[92:95], v[48:51], a[56:63], v15
s_branch Lps_177
Lpf_166:
buffer_load_dwordx4 v[48:51], v10, s[4:7], s40 offen offset:0 sc1
v_mfma_f32_16x16x32_bf16 v[200:203], v[204:207], v[204:207], 0
s_sub_u32 s37, s37, 1
s_cbranch_scc1 Lend_1
s_branch Lps_165
Lpf_168:
buffer_load_dwordx4 v[56:59], v10, s[4:7], s40 offen offset:2048 sc1
v_mfma_f32_16x16x32_bf16 v[200:203], v[204:207], v[204:207], 0
Lps_191:
s_waitcnt vmcnt(2)
v_max3_u32 v44, v60, v61, v62
v_max_u32 v44, v44, v63
v_cmp_eq_u32 vcc, -1, v44
s_cbranch_vccnz Lpf_192
v_smfmac_f32_16x16x64_bf16 v[64:67], v[60:63], a[192:199], v15
v_smfmac_f32_16x16x64_bf16 v[68:71], v[60:63], a[200:207], v15
v_smfmac_f32_16x16x64_bf16 v[72:75], v[60:63], a[208:215], v15
v_smfmac_f32_16x16x64_bf16 v[76:79], v[60:63], a[216:223], v15
v_smfmac_f32_16x16x64_bf16 v[80:83], v[60:63], a[224:231], v15
v_smfmac_f32_16x16x64_bf16 v[84:87], v[60:63], a[232:239], v15
v_smfmac_f32_16x16x64_bf16 v[88:91], v[60:63], a[240:247], v15
v_smfmac_f32_16x16x64_bf16 v[92:95], v[60:63], a[248:255], v15
Lps_193:
s_waitcnt vmcnt(1)
v_max3_u32 v44, v52, v53, v54
v_max_u32 v44, v44, v55
v_cmp_eq_u32 vcc, -1, v44
s_cbranch_vccnz Lpf_194
v_smfmac_f32_16x16x64_bf16 v[64:67], v[52:55], a[64:71], v15
v_smfmac_f32_16x16x64_bf16 v[68:71], v[52:55], a[72:79], v15
v_smfmac_f32_16x16x64_bf16 v[72:75], v[52:55], a[80:87], v15
v_smfmac_f32_16x16x64_bf16 v[76:79], v[52:55], a[88:95], v15
v_smfmac_f32_16x16x64_bf16 v[80:83], v[52:55], a[96:103], v15
v_smfmac_f32_16x16x64_bf16 v[84:87], v[52:55], a[104:111], v15
v_smfmac_f32_16x16x64_bf16 v[88:91], v[52:55], a[112:119], v15
v_smfmac_f32_16x16x64_bf16 v[92:95], v[52:55], a[120:127], v15
s_branch Lps_175
Lpf_170:
buffer_load_dwordx4 v[60:63], v10, s[4:7], s40 offen offset:3072 sc1
v_mfma_f32_16x16x32_bf16 v[200:203], v[204:207], v[204:207], 0
Lps_195:
s_waitcnt vmcnt(1)
v_max3_u32 v44, v52, v53, v54
v_max_u32 v44, v44, v55
v_cmp_eq_u32 vcc, -1, v44
s_cbranch_vccnz Lpf_196
v_smfmac_f32_16x16x64_bf16 v[64:67], v[52:55], a[64:71], v15
v_smfmac_f32_16x16x64_bf16 v[68:71], v[52:55], a[72:79], v15
v_smfmac_f32_16x16x64_bf16 v[72:75], v[52:55], a[80:87], v15
v_smfmac_f32_16x16x64_bf16 v[76:79], v[52:55], a[88:95], v15
v_smfmac_f32_16x16x64_bf16 v[80:83], v[52:55], a[96:103], v15
v_smfmac_f32_16x16x64_bf16 v[84:87], v[52:55], a[104:111], v15
v_smfmac_f32_16x16x64_bf16 v[88:91], v[52:55], a[112:119], v15
v_smfmac_f32_16x16x64_bf16 v[92:95], v[52:55], a[120:127], v15
s_branch Lps_177
Lpf_172:
buffer_load_dwordx4 v[52:55], v10, s[4:7], s40 offen offset:1024 sc1
v_mfma_f32_16x16x32_bf16 v[200:203], v[204:207], v[204:207], 0
s_sub_u32 s37, s37, 1
s_cbranch_scc1 Lend_1
s_branch Lps_171
Lpf_174:
buffer_load_dwordx4 v[60:63], v10, s[4:7], s40 offen offset:3072 sc1
v_mfma_f32_16x16x32_bf16 v[200:203], v[204:207], v[204:207], 0
Lps_197:
s_waitcnt vmcnt(1)
v_max3_u32 v44, v56, v57, v58
v_max_u32 v44, v44, v59
v_cmp_eq_u32 vcc, -1, v44
s_cbranch_vccnz Lpf_198
v_smfmac_f32_16x16x64_bf16 v[64:67], v[56:59], a[128:135], v15
v_smfmac_f32_16x16x64_bf16 v[68:71], v[56:59], a[136:143], v15
v_smfmac_f32_16x16x64_bf16 v[72:75], v[56:59], a[144:151], v15
v_smfmac_f32_16x16x64_bf16 v[76:79], v[56:59], a[152:159], v15
v_smfmac_f32_16x16x64_bf16 v[80:83], v[56:59], a[160:167], v15
v_smfmac_f32_16x16x64_bf16 v[84:87], v[56:59], a[168:175], v15
v_smfmac_f32_16x16x64_bf16 v[88:91], v[56:59], a[176:183], v15
v_smfmac_f32_16x16x64_bf16 v[92:95], v[56:59], a[184:191], v15
s_branch Lps_177
Lpf_176:
buffer_load_dwordx4 v[56:59], v10, s[4:7], s40 offen offset:2048 sc1
v_mfma_f32_16x16x32_bf16 v[200:203], v[204:207], v[204:207], 0
s_sub_u32 s37, s37, 1
s_cbranch_scc1 Lend_1
s_branch Lps_175
Lpf_178:
buffer_load_dwordx4 v[60:63], v10, s[4:7], s40 offen offset:3072 sc1
v_mfma_f32_16x16x32_bf16 v[200:203], v[204:207], v[204:207], 0
s_sub_u32 s37, s37, 1
s_cbranch_scc1 Lend_1
s_branch Lps_177
Lpf_180:
buffer_load_dwordx4 v[56:59], v10, s[4:7], s40 offen offset:2048 sc1
v_mfma_f32_16x16x32_bf16 v[200:203], v[204:207], v[204:207], 0
Lps_199:
s_waitcnt vmcnt(3)
v_max3_u32 v44, v60, v61, v62
v_max_u32 v44, v44, v63
v_cmp_eq_u32 vcc, -1, v44
s_cbranch_vccnz Lpf_200
v_smfmac_f32_16x16x64_bf16 v[64:67], v[60:63], a[192:199], v15
v_smfmac_f32_16x16x64_bf16 v[68:71], v[60:63], a[200:207], v15
v_smfmac_f32_16x16x64_bf16 v[72:75], v[60:63], a[208:215], v15
v_smfmac_f32_16x16x64_bf16 v[76:79], v[60:63], a[216:223], v15
v_smfmac_f32_16x16x64_bf16 v[80:83], v[60:63], a[224:231], v15
v_smfmac_f32_16x16x64_bf16 v[84:87], v[60:63], a[232:239], v15
v_smfmac_f32_16x16x64_bf16 v[88:91], v[60:63], a[240:247], v15
v_smfmac_f32_16x16x64_bf16 v[92:95], v[60:63], a[248:255], v15
Lps_201:
s_waitcnt vmcnt(2)
v_max3_u32 v44, v48, v49, v50
v_max_u32 v44, v44, v51
v_cmp_eq_u32 vcc, -1, v44
s_cbranch_vccnz Lpf_202
v_smfmac_f32_16x16x64_bf16 v[64:67], v[48:51], a[0:7], v15
v_smfmac_f32_16x16x64_bf16 v[68:71], v[48:51], a[8:15], v15
v_smfmac_f32_16x16x64_bf16 v[72:75], v[48:51], a[16:23], v15
v_smfmac_f32_16x16x64_bf16 v[76:79], v[48:51], a[24:31], v15
v_smfmac_f32_16x16x64_bf16 v[80:83], v[48:51], a[32:39], v15
v_smfmac_f32_16x16x64_bf16 v[84:87], v[48:51], a[40:47], v15
v_smfmac_f32_16x16x64_bf16 v[88:91], v[48:51], a[48:55], v15
v_smfmac_f32_16x16x64_bf16 v[92:95], v[48:51], a[56:63], v15
s_branch Lps_193
Lpf_182:
buffer_load_dwordx4 v[60:63], v10, s[4:7], s40 offen offset:3072 sc1
v_mfma_f32_16x16x32_bf16 v[200:203], v[204:207], v[204:207], 0
Lps_203:
s_waitcnt vmcnt(2)
v_max3_u32 v44, v48, v49, v50
v_max_u32 v44, v44, v51
v_cmp_eq_u32 vcc, -1, v44
s_cbranch_vccnz Lpf_204
v_smfmac_f32_16x16x64_bf16 v[64:67], v[48:51], a[0:7], v15
v_smfmac_f32_16x16x64_bf16 v[68:71], v[48:51], a[8:15], v15
v_smfmac_f32_16x16x64_bf16 v[72:75], v[48:51], a[16:23], v15
v_smfmac_f32_16x16x64_bf16 v[76:79], v[48:51], a[24:31], v15
v_smfmac_f32_16x16x64_bf16 v[80:83], v[48:51], a[32:39], v15
v_smfmac_f32_16x16x64_bf16 v[84:87], v[48:51], a[40:47], v15
v_smfmac_f32_16x16x64_bf16 v[88:91], v[48:51], a[48:55], v15
v_smfmac_f32_16x16x64_bf16 v[92:95], v[48:51], a[56:63], v15
s_branch Lps_195
Lpf_184:
buffer_load_dwordx4 v[48:51], v10, s[4:7], s40 offen offset:0 sc1
v_mfma_f32_16x16x32_bf16 v[200:203], v[204:207], v[204:207], 0
s_sub_u32 s37, s37, 1
s_cbranch_scc1 Lend_1
Lps_205:
s_waitcnt vmcnt(1)
v_max3_u32 v44, v52, v53, v54
v_max_u32 v44, v44, v55
v_cmp_eq_u32 vcc, -1, v44
s_cbranch_vccnz Lpf_206
v_smfmac_f32_16x16x64_bf16 v[64:67], v[52:55], a[64:71], v15
v_smfmac_f32_16x16x64_bf16 v[68:71], v[52:55], a[72:79], v15
v_smfmac_f32_16x16x64_bf16 v[72:75], v[52:55], a[80:87], v15
v_smfmac_f32_16x16x64_bf16 v[76:79], v[52:55], a[88:95], v15
v_smfmac_f32_16x16x64_bf16 v[80:83], v[52:55], a[96:103], v15
v_smfmac_f32_16x16x64_bf16 v[84:87], v[52:55], a[104:111], v15
v_smfmac_f32_16x16x64_bf16 v[88:91], v[52:55], a[112:119], v15
v_smfmac_f32_16x16x64_bf16 v[92:95], v[52:55], a[120:127], v15
s_branch Lps_165
Lpf_186:
buffer_load_dwordx4 v[60:63], v10, s[4:7], s40 offen offset:3072 sc1
v_mfma_f32_16x16x32_bf16 v[200:203], v[204:207], v[204:207], 0
Lps_207:
s_waitcnt vmcnt(2)
v_max3_u32 v44, v48, v49, v50
v_max_u32 v44, v44, v51
v_cmp_eq_u32 vcc, -1, v44
s_cbranch_vccnz Lpf_208
v_smfmac_f32_16x16x64_bf16 v[64:67], v[48:51], a[0:7], v15
v_smfmac_f32_16x16x64_bf16 v[68:71], v[48:51], a[8:15], v15
v_smfmac_f32_16x16x64_bf16 v[72:75], v[48:51], a[16:23], v15
v_smfmac_f32_16x16x64_bf16 v[76:79], v[48:51], a[24:31], v15
v_smfmac_f32_16x16x64_bf16 v[80:83], v[48:51], a[32:39], v15
v_smfmac_f32_16x16x64_bf16 v[84:87], v[48:51], a[40:47], v15
v_smfmac_f32_16x16x64_bf16 v[88:91], v[48:51], a[48:55], v15
v_smfmac_f32_16x16x64_bf16 v[92:95], v[48:51], a[56:63], v15
s_branch Lps_197
Lpf_188:
buffer_load_dwordx4 v[48:51], v10, s[4:7], s40 offen offset:0 sc1
v_mfma_f32_16x16x32_bf16 v[200:203], v[204:207], v[204:207], 0
s_sub_u32 s37, s37, 1
s_cbranch_scc1 Lend_1
Lps_209:
s_waitcnt vmcnt(1)
v_max3_u32 v44, v56, v57, v58
v_max_u32 v44, v44, v59
v_cmp_eq_u32 vcc, -1, v44
s_cbranch_vccnz Lpf_210
v_smfmac_f32_16x16x64_bf16 v[64:67], v[56:59], a[128:135], v15
v_smfmac_f32_16x16x64_bf16 v[68:71], v[56:59], a[136:143], v15
v_smfmac_f32_16x16x64_bf16 v[72:75], v[56:59], a[144:151], v15
v_smfmac_f32_16x16x64_bf16 v[76:79], v[56:59], a[152:159], v15
v_smfmac_f32_16x16x64_bf16 v[80:83], v[56:59], a[160:167], v15
v_smfmac_f32_16x16x64_bf16 v[84:87], v[56:59], a[168:175], v15
v_smfmac_f32_16x16x64_bf16 v[88:91], v[56:59], a[176:183], v15
v_smfmac_f32_16x16x64_bf16 v[92:95], v[56:59], a[184:191], v15
s_branch Lps_165
Lpf_190:
buffer_load_dwordx4 v[48:51], v10, s[4:7], s40 offen offset:0 sc1
v_mfma_f32_16x16x32_bf16 v[200:203], v[204:207], v[204:207], 0
s_sub_u32 s37, s37, 1
s_cbranch_scc1 Lend_1
s_branch Lps_163
Lpf_192:
buffer_load_dwordx4 v[60:63], v10, s[4:7], s40 offen offset:3072 sc1
v_mfma_f32_16x16x32_bf16 v[200:203], v[204:207], v[204:207], 0
Lps_211:
s_waitcnt vmcnt(2)
v_max3_u32 v44, v52, v53, v54
v_max_u32 v44, v44, v55
v_cmp_eq_u32 vcc, -1, v44
s_cbranch_vccnz Lpf_212
v_smfmac_f32_16x16x64_bf16 v[64:67], v[52:55], a[64:71], v15
v_smfmac_f32_16x16x64_bf16 v[68:71], v[52:55], a[72:79], v15
v_smfmac_f32_16x16x64_bf16 v[72:75], v[52:55], a[80:87], v15
v_smfmac_f32_16x16x64_bf16 v[76:79], v[52:55], a[88:95], v15
v_smfmac_f32_16x16x64_bf16 v[80:83], v[52:55], a[96:103], v15
v_smfmac_f32_16x16x64_bf16 v[84:87], v[52:55], a[104:111], v15
v_smfmac_f32_16x16x64_bf16 v[88:91], v[52:55], a[112:119], v15
v_smfmac_f32_16x16x64_bf16 v[92:95], v[52:55], a[120:127], v15
s_branch Lps_197
Lpf_194:
buffer_load_dwordx4 v[52:55], v10, s[4:7], s40 offen offset:1024 sc1
v_mfma_f32_16x16x32_bf16 v[200:203], v[204:207], v[204:207], 0
s_sub_u32 s37, s37, 1
s_cbranch_scc1 Lend_1
Lps_213:
s_waitcnt vmcnt(1)
v_max3_u32 v44, v56, v57, v58
v_max_u32 v44, v44, v59
v_cmp_eq_u32 vcc, -1, v44
s_cbranch_vccnz Lpf_214
v_smfmac_f32_16x16x64_bf16 v[64:67], v[56:59], a[128:135], v15
v_smfmac_f32_16x16x64_bf16 v[68:71], v[56:59], a[136:143], v15
v_smfmac_f32_16x16x64_bf16 v[72:75], v[56:59], a[144:151], v15
v_smfmac_f32_16x16x64_bf16 v[76:79], v[56:59], a[152:159], v15
v_smfmac_f32_16x16x64_bf16 v[80:83], v[56:59], a[160:167], v15
v_smfmac_f32_16x16x64_bf16 v[84:87], v[56:59], a[168:175], v15
v_smfmac_f32_16x16x64_bf16 v[88:91], v[56:59], a[176:183], v15
v_smfmac_f32_16x16x64_bf16 v[92:95], v[56:59], a[184:191], v15
s_branch Lps_171
Lpf_196:
buffer_load_dwordx4 v[52:55], v10, s[4:7], s40 offen offset:1024 sc1
v_mfma_f32_16x16x32_bf16 v[200:203], v[204:207], v[204:207], 0
s_sub_u32 s37, s37, 1
s_cbranch_scc1 Lend_1
s_branch Lps_169
Lpf_198:
buffer_load_dwordx4 v[56:59], v10, s[4:7], s40 offen offset:2048 sc1
v_mfma_f32_16x16x32_bf16 v[200:203], v[204:207], v[204:207], 0
s_sub_u32 s37, s37, 1
s_cbranch_scc1 Lend_1
s_branch Lps_173
Lpf_200:
buffer_load_dwordx4 v[60:63], v10, s[4:7], s40 offen offset:3072 sc1
v_mfma_f32_16x16x32_bf16 v[200:203], v[204:207], v[204:207], 0
Lps_215:
s_waitcnt vmcnt(3)
v_max3_u32 v44, v48, v49, v50
v_max_u32 v44, v44, v51
v_cmp_eq_u32 vcc, -1, v44
s_cbranch_vccnz Lpf_216
v_smfmac_f32_16x16x64_bf16 v[64:67], v[48:51], a[0:7], v15
v_smfmac_f32_16x16x64_bf16 v[68:71], v[48:51], a[8:15], v15
v_smfmac_f32_16x16x64_bf16 v[72:75], v[48:51], a[16:23], v15
v_smfmac_f32_16x16x64_bf16 v[76:79], v[48:51], a[24:31], v15
v_smfmac_f32_16x16x64_bf16 v[80:83], v[48:51], a[32:39], v15
v_smfmac_f32_16x16x64_bf16 v[84:87], v[48:51], a[40:47], v15
v_smfmac_f32_16x16x64_bf16 v[88:91], v[48:51], a[48:55], v15
v_smfmac_f32_16x16x64_bf16 v[92:95], v[48:51], a[56:63], v15
s_branch Lps_211
Lpf_202:
buffer_load_dwordx4 v[48:51], v10, s[4:7], s40 offen offset:0 sc1
v_mfma_f32_16x16x32_bf16 v[200:203], v[204:207], v[204:207], 0
s_sub_u32 s37, s37, 1
s_cbranch_scc1 Lend_1
Lps_217:
s_waitcnt vmcnt(2)
v_max3_u32 v44, v52, v53, v54
v_max_u32 v44, v44, v55
v_cmp_eq_u32 vcc, -1, v44
s_cbranch_vccnz Lpf_218
v_smfmac_f32_16x16x64_bf16 v[64:67], v[52:55], a[64:71], v15
v_smfmac_f32_16x16x64_bf16 v[68:71], v[52:55], a[72:79], v15
v_smfmac_f32_16x16x64_bf16 v[72:75], v[52:55], a[80:87], v15
v_smfmac_f32_16x16x64_bf16 v[76:79], v[52:55], a[88:95], v15
v_smfmac_f32_16x16x64_bf16 v[80:83], v[52:55], a[96:103], v15
v_smfmac_f32_16x16x64_bf16 v[84:87], v[52:55], a[104:111], v15
v_smfmac_f32_16x16x64_bf16 v[88:91], v[52:55], a[112:119], v15
v_smfmac_f32_16x16x64_bf16 v[92:95], v[52:55], a[120:127], v15
s_branch Lps_209
Lpf_204:
buffer_load_dwordx4 v[48:51], v10, s[4:7], s40 offen offset:0 sc1
v_mfma_f32_16x16x32_bf16 v[200:203], v[204:207], v[204:207], 0
s_sub_u32 s37, s37, 1
s_cbranch_scc1 Lend_1
Lps_219:
s_waitcnt vmcnt(2)
v_max3_u32 v44, v52, v53, v54
v_max_u32 v44, v44, v55
v_cmp_eq_u32 vcc, -1, v44
s_cbranch_vccnz Lpf_220
v_smfmac_f32_16x16x64_bf16 v[64:67], v[52:55], a[64:71], v15
v_smfmac_f32_16x16x64_bf16 v[68:71], v[52:55], a[72:79], v15
v_smfmac_f32_16x16x64_bf16 v[72:75], v[52:55], a[80:87], v15
v_smfmac_f32_16x16x64_bf16 v[76:79], v[52:55], a[88:95], v15
v_smfmac_f32_16x16x64_bf16 v[80:83], v[52:55], a[96:103], v15
v_smfmac_f32_16x16x64_bf16 v[84:87], v[52:55], a[104:111], v15
v_smfmac_f32_16x16x64_bf16 v[88:91], v[52:55], a[112:119], v15
v_smfmac_f32_16x16x64_bf16 v[92:95], v[52:55], a[120:127], v15
s_branch Lps_163
Lpf_206:
buffer_load_dwordx4 v[52:55], v10, s[4:7], s40 offen offset:1024 sc1
v_mfma_f32_16x16x32_bf16 v[200:203], v[204:207], v[204:207], 0
s_branch Lps_183
Lpf_208:
buffer_load_dwordx4 v[48:51], v10, s[4:7], s40 offen offset:0 sc1
v_mfma_f32_16x16x32_bf16 v[200:203], v[204:207], v[204:207], 0
s_sub_u32 s37, s37, 1
s_cbranch_scc1 Lend_1
s_branch Lps_161
Lpf_210:
buffer_load_dwordx4 v[56:59], v10, s[4:7], s40 offen offset:2048 sc1
v_mfma_f32_16x16x32_bf16 v[200:203], v[204:207], v[204:207], 0
s_branch Lps_187
Lpf_212:
buffer_load_dwordx4 v[52:55], v10, s[4:7], s40 offen offset:1024 sc1
v_mfma_f32_16x16x32_bf16 v[200:203], v[204:207], v[204:207], 0
s_sub_u32 s37, s37, 1
s_cbranch_scc1 Lend_1
s_branch Lps_167
Lpf_214:
buffer_load_dwordx4 v[56:59], v10, s[4:7], s40 offen offset:2048 sc1
v_mfma_f32_16x16x32_bf16 v[200:203], v[204:207], v[204:207], 0
s_branch Lps_193
Lpf_216:
buffer_load_dwordx4 v[48:51], v10, s[4:7], s40 offen offset:0 sc1
v_mfma_f32_16x16x32_bf16 v[200:203], v[204:207], v[204:207], 0
s_sub_u32 s37, s37, 1
s_cbranch_scc1 Lend_1
s_branch Lps_159
Lpf_218:
buffer_load_dwordx4 v[52:55], v10, s[4:7], s40 offen offset:1024 sc1
v_mfma_f32_16x16x32_bf16 v[200:203], v[204:207], v[204:207], 0
Lps_221:
s_waitcnt vmcnt(2)
v_max3_u32 v44, v56, v57, v58
v_max_u32 v44, v44, v59
v_cmp_eq_u32 vcc, -1, v44
s_cbranch_vccnz Lpf_222
v_smfmac_f32_16x16x64_bf16 v[64:67], v[56:59], a[128:135], v15
v_smfmac_f32_16x16x64_bf16 v[68:71], v[56:59], a[136:143], v15
v_smfmac_f32_16x16x64_bf16 v[72:75], v[56:59], a[144:151], v15
v_smfmac_f32_16x16x64_bf16 v[76:79], v[56:59], a[152:159], v15
v_smfmac_f32_16x16x64_bf16 v[80:83], v[56:59], a[160:167], v15
v_smfmac_f32_16x16x64_bf16 v[84:87], v[56:59], a[168:175], v15
v_smfmac_f32_16x16x64_bf16 v[88:91], v[56:59], a[176:183], v15
v_smfmac_f32_16x16x64_bf16 v[92:95], v[56:59], a[184:191], v15
s_branch Lps_183
Lpf_220:
buffer_load_dwordx4 v[52:55], v10, s[4:7], s40 offen offset:1024 sc1
v_mfma_f32_16x16x32_bf16 v[200:203], v[204:207], v[204:207], 0
s_branch Lps_181
Lpf_222:
buffer_load_dwordx4 v[56:59], v10, s[4:7], s40 offen offset:2048 sc1
v_mfma_f32_16x16x32_bf16 v[200:203], v[204:207], v[204:207], 0
s_branch Lps_201
Lkr_150:
buffer_load_dwordx4 v[56:59], v11, s[4:7], s40 offen offset:0 sc1
buffer_load_dwordx4 v[60:63], v11, s[4:7], s40 offen offset:1024 sc1
Lps_224:
s_waitcnt vmcnt(3)
v_max3_u32 v44, v48, v49, v50
v_max_u32 v44, v44, v51
v_cmp_eq_u32 vcc, -1, v44
s_cbranch_vccnz Lpf_225
v_smfmac_f32_16x16x64_bf16 v[72:75], v[48:51], v[96:103], v15
v_mov_b32 v112, v48
v_mov_b32 v113, v49
v_mov_b32 v114, v50
v_mov_b32 v115, v51
Lps_226:
s_waitcnt vmcnt(2)
v_max3_u32 v44, v52, v53, v54
v_max_u32 v44, v44, v55
v_cmp_eq_u32 vcc, -1, v44
s_cbranch_vccnz Lpf_227
v_smfmac_f32_16x16x64_bf16 v[72:75], v[52:55], v[104:111], v15
v_mov_b32 v116, v52
v_mov_b32 v117, v53
v_mov_b32 v118, v54
v_mov_b32 v119, v55
Lpd_223:
s_branch Lko_151
Lpf_225:
buffer_load_dwordx4 v[48:51], v11, s[4:7], s40 offen offset:0 sc1
s_sub_u32 s37, s37, 1
s_cbranch_scc1 Lend_1
Lps_228:
s_waitcnt vmcnt(3)
v_max3_u32 v44, v52, v53, v54
v_max_u32 v44, v44, v55
v_cmp_eq_u32 vcc, -1, v44
s_cbranch_vccnz Lpf_229
v_smfmac_f32_16x16x64_bf16 v[72:75], v[52:55], v[104:111], v15
v_mov_b32 v116, v52
v_mov_b32 v117, v53
v_mov_b32 v118, v54
v_mov_b32 v119, v55
Lps_230:
s_waitcnt vmcnt(2)
v_max3_u32 v44, v56, v57, v58
v_max_u32 v44, v44, v59
v_cmp_eq_u32 vcc, -1, v44
s_cbranch_vccnz Lpf_231
v_smfmac_f32_16x16x64_bf16 v[72:75], v[56:59], v[96:103], v15
v_mov_b32 v112, v56
v_mov_b32 v113, v57
v_mov_b32 v114, v58
v_mov_b32 v115, v59
s_branch Lpd_223
Lpf_227:
buffer_load_dwordx4 v[52:55], v11, s[4:7], s40 offen offset:1024 sc1
s_sub_u32 s37, s37, 1
s_cbranch_scc1 Lend_1
Lps_232:
s_waitcnt vmcnt(2)
v_max3_u32 v44, v56, v57, v58
v_max_u32 v44, v44, v59
v_cmp_eq_u32 vcc, -1, v44
s_cbranch_vccnz Lpf_233
Lps_234:
s_waitcnt vmcnt(1)
v_max3_u32 v44, v60, v61, v62
v_max_u32 v44, v44, v63
v_cmp_eq_u32 vcc, -1, v44
s_cbranch_vccnz Lpf_235
v_smfmac_f32_16x16x64_bf16 v[72:75], v[60:63], v[104:111], v15
v_mov_b32 v116, v60
v_mov_b32 v117, v61
v_mov_b32 v118, v62
v_mov_b32 v119, v63
s_branch Lpd_223
Lpf_229:
buffer_load_dwordx4 v[52:55], v11, s[4:7], s40 offen offset:1024 sc1
Lps_236:
s_waitcnt vmcnt(3)
v_max3_u32 v44, v56, v57, v58
v_max_u32 v44, v44, v59
v_cmp_eq_u32 vcc, -1, v44
s_cbranch_vccnz Lpf_237
v_smfmac_f32_16x16x64_bf16 v[72:75], v[56:59], v[96:103], v15
v_mov_b32 v112, v56
v_mov_b32 v113, v57
v_mov_b32 v114, v58
v_mov_b32 v115, v59
Lps_238:
s_waitcnt vmcnt(2)
v_max3_u32 v44, v60, v61, v62
v_max_u32 v44, v44, v63
v_cmp_eq_u32 vcc, -1, v44
s_cbranch_vccnz Lpf_239
v_smfmac_f32_16x16x64_bf16 v[72:75], v[60:63], v[104:111], v15
v_mov_b32 v116, v60
v_mov_b32 v117, v61
v_mov_b32 v118, v62
v_mov_b32 v119, v63
s_branch Lpd_223
Lpf_231:
buffer_load_dwordx4 v[56:59], v11, s[4:7], s40 offen offset:0 sc1
Lps_240:
s_waitcnt vmcnt(2)
v_max3_u32 v44, v60, v61, v62
v_max_u32 v44, v44, v63
v_cmp_eq_u32 vcc, -1, v44
s_cbranch_vccnz Lpf_241
Lps_242:
s_waitcnt vmcnt(1)
v_max3_u32 v44, v48, v49, v50
v_max_u32 v44, v44, v51
v_cmp_eq_u32 vcc, -1, v44
s_cbranch_vccnz Lpf_243
v_smfmac_f32_16x16x64_bf16 v[72:75], v[48:51], v[96:103], v15
v_mov_b32 v112, v48
v_mov_b32 v113, v49
v_mov_b32 v114, v50
v_mov_b32 v115, v51
s_branch Lpd_223
Lpf_233:
buffer_load_dwordx4 v[56:59], v11, s[4:7], s40 offen offset:0 sc1
Lps_244:
s_waitcnt vmcnt(2)
v_max3_u32 v44, v60, v61, v62
v_max_u32 v44, v44, v63
v_cmp_eq_u32 vcc, -1, v44
s_cbranch_vccnz Lpf_245
v_smfmac_f32_16x16x64_bf16 v[72:75], v[60:63], v[104:111], v15
v_mov_b32 v116, v60
v_mov_b32 v117, v61
v_mov_b32 v118, v62
v_mov_b32 v119, v63
s_branch Lpd_223
Lpf_235:
buffer_load_dwordx4 v[60:63], v11, s[4:7], s40 offen offset:1024 sc1
Lps_246:
s_waitcnt vmcnt(1)
v_max3_u32 v44, v52, v53, v54
v_max_u32 v44, v44, v55
v_cmp_eq_u32 vcc, -1, v44
s_cbranch_vccnz Lpf_247
v_smfmac_f32_16x16x64_bf16 v[72:75], v[52:55], v[104:111], v15
v_mov_b32 v116, v52
v_mov_b32 v117, v53
v_mov_b32 v118, v54
v_mov_b32 v119, v55
s_branch Lpd_223
Lpf_237:
buffer_load_dwordx4 v[56:59], v11, s[4:7], s40 offen offset:0 sc1
Lps_248:
s_waitcnt vmcnt(3)
v_max3_u32 v44, v60, v61, v62
v_max_u32 v44, v44, v63
v_cmp_eq_u32 vcc, -1, v44
s_cbranch_vccnz Lpf_249
v_smfmac_f32_16x16x64_bf16 v[72:75], v[60:63], v[104:111], v15
v_mov_b32 v116, v60
v_mov_b32 v117, v61
v_mov_b32 v118, v62
v_mov_b32 v119, v63
Lps_250:
s_waitcnt vmcnt(2)
v_max3_u32 v44, v48, v49, v50
v_max_u32 v44, v44, v51
v_cmp_eq_u32 vcc, -1, v44
s_cbranch_vccnz Lpf_251
v_smfmac_f32_16x16x64_bf16 v[72:75], v[48:51], v[96:103], v15
v_mov_b32 v112, v48
v_mov_b32 v113, v49
v_mov_b32 v114, v50
v_mov_b32 v115, v51
s_branch Lpd_223
Lpf_239:
buffer_load_dwordx4 v[60:63], v11, s[4:7], s40 offen offset:1024 sc1
Lps_252:
s_waitcnt vmcnt(2)
v_max3_u32 v44, v48, v49, v50
v_max_u32 v44, v44, v51
v_cmp_eq_u32 vcc, -1, v44
s_cbranch_vccnz Lpf_253
s_branch Lps_246
Lpf_241:
buffer_load_dwordx4 v[60:63], v11, s[4:7], s40 offen offset:1024 sc1
Lps_254:
s_waitcnt vmcnt(2)
v_max3_u32 v44, v48, v49, v50
v_max_u32 v44, v44, v51
v_cmp_eq_u32 vcc, -1, v44
s_cbranch_vccnz Lpf_255
v_smfmac_f32_16x16x64_bf16 v[72:75], v[48:51], v[96:103], v15
v_mov_b32 v112, v48
v_mov_b32 v113, v49
v_mov_b32 v114, v50
v_mov_b32 v115, v51
s_branch Lpd_223
Lpf_243:
buffer_load_dwordx4 v[48:51], v11, s[4:7], s40 offen offset:0 sc1
s_sub_u32 s37, s37, 1
s_cbranch_scc1 Lend_1
Lps_256:
s_waitcnt vmcnt(1)
v_max3_u32 v44, v56, v57, v58
v_max_u32 v44, v44, v59
v_cmp_eq_u32 vcc, -1, v44
s_cbranch_vccnz Lpf_257
v_smfmac_f32_16x16x64_bf16 v[72:75], v[56:59], v[96:103], v15
v_mov_b32 v112, v56
v_mov_b32 v113, v57
v_mov_b32 v114, v58
v_mov_b32 v115, v59
s_branch Lpd_223
Lpf_245:
buffer_load_dwordx4 v[60:63], v11, s[4:7], s40 offen offset:1024 sc1
s_branch Lps_226
Lpf_247:
buffer_load_dwordx4 v[52:55], v11, s[4:7], s40 offen offset:1024 sc1
s_sub_u32 s37, s37, 1
s_cbranch_scc1 Lend_1
s_branch Lps_234
Lpf_249:
buffer_load_dwordx4 v[60:63], v11, s[4:7], s40 offen offset:1024 sc1
s_branch Lps_224
Lpf_251:
buffer_load_dwordx4 v[48:51], v11, s[4:7], s40 offen offset:0 sc1
s_sub_u32 s37, s37, 1
s_cbranch_scc1 Lend_1
Lps_258:
s_waitcnt vmcnt(2)
v_max3_u32 v44, v52, v53, v54
v_max_u32 v44, v44, v55
v_cmp_eq_u32 vcc, -1, v44
s_cbranch_vccnz Lpf_259
s_branch Lps_256
Lpf_253:
buffer_load_dwordx4 v[48:51], v11, s[4:7], s40 offen offset:0 sc1
s_sub_u32 s37, s37, 1
s_cbranch_scc1 Lend_1
Lps_260:
s_waitcnt vmcnt(2)
v_max3_u32 v44, v52, v53, v54
v_max_u32 v44, v44, v55
v_cmp_eq_u32 vcc, -1, v44
s_cbranch_vccnz Lpf_261
v_smfmac_f32_16x16x64_bf16 v[72:75], v[52:55], v[104:111], v15
v_mov_b32 v116, v52
v_mov_b32 v117, v53
v_mov_b32 v118, v54
v_mov_b32 v119, v55
s_branch Lpd_223
Lpf_255:
buffer_load_dwordx4 v[48:51], v11, s[4:7], s40 offen offset:0 sc1
s_sub_u32 s37, s37, 1
s_cbranch_scc1 Lend_1
s_branch Lps_230
Lpf_257:
buffer_load_dwordx4 v[56:59], v11, s[4:7], s40 offen offset:0 sc1
s_branch Lps_242
Lpf_259:
buffer_load_dwordx4 v[52:55], v11, s[4:7], s40 offen offset:1024 sc1
Lps_262:
s_waitcnt vmcnt(2)
v_max3_u32 v44, v56, v57, v58
v_max_u32 v44, v44, v59
v_cmp_eq_u32 vcc, -1, v44
s_cbranch_vccnz Lpf_263
v_smfmac_f32_16x16x64_bf16 v[72:75], v[56:59], v[96:103], v15
v_mov_b32 v112, v56
v_mov_b32 v113, v57
v_mov_b32 v114, v58
v_mov_b32 v115, v59
s_branch Lpd_223
Lpf_261:
buffer_load_dwordx4 v[52:55], v11, s[4:7], s40 offen offset:1024 sc1
s_branch Lps_238
Lpf_263:
buffer_load_dwordx4 v[56:59], v11, s[4:7], s40 offen offset:0 sc1
s_branch Lps_250
Lvr_152:
buffer_load_dwordx2 v[120:121], v12, s[4:7], s40 offen sc1
buffer_load_dwordx2 v[122:123], v13, s[4:7], s40 offen sc1
s_sub_u32 s37, s37, 1
s_cbranch_scc1 Lend_1
s_waitcnt vmcnt(0)
v_max3_u32 v44, v120, v121, v122
v_max_u32 v44, v44, v123
v_cmp_eq_u32 vcc, -1, v44
s_cbranch_vccnz Lvr_152
s_branch Lvo_153
Lend_1:
s_endpgm
Lkvo_2:
v_mov_b32 v44, v0
v_mov_b32 v45, v1
v_and_b32 v46, 127, v44
s_sub_u32 s54, s34, 8
s_lshl_b32 s45, s33, 18
s_add_u32 s45, s45, 2097152
s_lshl_b32 s59, s33, 12
s_add_u32 s59, s59, 3276800
s_lshl_b32 s38, s32, 12
v_lshl_add_u32 v8, v45, 4, s38
v_add_u32 v9, 49152, v8
s_lshl_b32 s38, s54, 10
v_lshl_add_u32 v10, v46, 3, s38
v_lshl_add_u32 v50, v44, 2, s38
v_add_u32 v11, 16384, v50
v_add_u32 v27, 32768, v50
s_lshl_b32 s38, s32, 8
v_lshl_add_u32 v1, v45, 2, s38
v_add_u32 v2, 2048, v1
s_lshr_b32 s38, s54, 2
s_lshl_b32 s38, s38, 8
s_and_b32 s39, s54, 3
s_lshl_b32 s39, s39, 2
s_add_u32 s38, s38, s39
v_min_u32 v50, 1, v44
v_lshl_add_u32 v3, v50, 30, s38
s_lshr_b32 s38, s54, 3
s_lshl_b32 s38, s38, 14
s_and_b32 s39, s54, 7
s_lshl_b32 s39, s39, 10
s_add_u32 s38, s38, s39
s_lshl_b32 s39, s33, 16
s_add_u32 s38, s38, s39
v_lshl_add_u32 v12, v46, 3, s38
v_xor_b32 v13, 0x10000, v12
v_xor_b32 v14, 0x20000, v12
v_xor_b32 v15, 0x30000, v12
s_mov_b32 s55, 0x00003f80
s_mov_b32 s56, 0x3f800000
v_and_b32 v50, 1, v45
v_mul_u32_u24 v50, 0xaaaa, v50
v_add_u32 v126, 0x4444, v50
s_lshl_b32 s38, s32, 11
v_lshl_add_u32 v25, v45, 5, s38
v_lshlrev_b32 v127, 3, v44
v_bfe_u32 v50, v46, 5, 1
v_lshlrev_b32 v50, 2, v50
v_and_b32 v51, 1, v46
v_lshl_add_u32 v50, v51, 1, v50
v_bfe_u32 v51, v46, 1, 1
v_add_u32 v50, v50, v51
v_and_b32 v51, 24, v46
v_add_u32 v51, v51, v50
v_lshlrev_b32 v51, 3, v51
v_bfe_u32 v52, v46, 2, 1
v_mul_u32_u24 v52, 288, v52
v_add_u32 v51, v51, v52
v_lshrrev_b32 v52, 6, v46
v_mul_u32_u24 v53, 1152, v52
v_add_u32 v0, v51, v53
v_lshl_add_u32 v50, v52, 4, v50
v_bfe_u32 v51, v46, 2, 3
v_lshlrev_b32 v51, 11, v51
v_lshl_add_u32 v50, v50, 2, v51
s_mov_b32 s8, s16
s_and_b32 s9, s17, 0xffff
s_mov_b32 s10, 0x4000
s_mov_b32 s11, 0x20000
s_lshl_b32 s38, s54, 7
buffer_load_dword v56, v50, s[8:11], s38 offen
buffer_load_dword v57, v50, s[8:11], s38 offen offset:32
v_and_b32 v50, 1, v45
s_and_b32 s38, s32, 2
v_add_u32 v51, s38, v50
s_and_b32 s39, s32, 1
s_lshl_b32 s39, s39, 3
v_bfe_u32 v52, v45, 1, 1
v_lshl_add_u32 v52, v52, 2, s39
v_bfe_u32 v53, v45, 2, 1
v_lshl_add_u32 v52, v53, 1, v52
v_bfe_u32 v53, v45, 3, 1
v_and_b32 v54, 48, v45
v_add_u32 v54, v54, v52
v_lshlrev_b32 v54, 2, v54
v_mul_u32_u24 v53, 640, v53
v_mul_u32_u24 v55, 288, v50
v_add3_u32 v54, v54, v53, v55
s_mul_i32 s38, s38, 640
v_add_u32 v24, s38, v54
v_mov_b32 v16, 0
v_mov_b32 v17, 0
v_mov_b32 v18, 0
v_mov_b32 v19, 0
v_mov_b32 v20, 0
v_mov_b32 v21, 0
v_mov_b32 v22, 0
v_mov_b32 v23, 0
v_mov_b32 v120, -1
v_mov_b32 v121, -1
v_mov_b32 v122, -1
v_mov_b32 v123, -1
s_add_u32 s38, s45, 0
buffer_store_dword v120, v11, s[4:7], s38 offen sc1
buffer_store_dword v120, v27, s[4:7], s38 offen sc1
s_mov_b32 s38, 0
s_mov_b32 s46, 0
s_lshl_b32 s88, s38, 18
s_add_u32 s88, s88, s46
s_add_u32 s89, s88, 0x100000
s_cmp_ge_u32 s32, 2
s_cbranch_scc1 Lco_264
buffer_store_dwordx2 v[120:121], v12, s[4:7], s88 offen sc1
buffer_store_dwordx2 v[120:121], v12, s[4:7], s89 offen sc1
Lco_264:
s_mov_b32 s46, 8192
s_lshl_b32 s88, s38, 18
s_add_u32 s88, s88, s46
s_add_u32 s89, s88, 0x100000
s_cmp_ge_u32 s32, 2
s_cbranch_scc1 Lco_265
buffer_store_dwordx2 v[120:121], v12, s[4:7], s88 offen sc1
buffer_store_dwordx2 v[120:121], v12, s[4:7], s89 offen sc1
Lco_265:
s_add_u32 s38, s45, 65536
buffer_store_dwordx2 v[120:121], v10, s[4:7], s38 offen sc1
buffer_store_dword v120, v11, s[4:7], s38 offen sc1
buffer_store_dword v120, v27, s[4:7], s38 offen sc1
s_mov_b32 s38, 1
s_mov_b32 s46, 0
s_lshl_b32 s88, s38, 18
s_add_u32 s88, s88, s46
s_add_u32 s89, s88, 0x100000
s_cmp_ge_u32 s32, 2
s_cbranch_scc1 Lco_266
buffer_store_dwordx2 v[120:121], v12, s[4:7], s88 offen sc1
buffer_store_dwordx2 v[120:121], v12, s[4:7], s89 offen sc1
Lco_266:
s_mov_b32 s46, 8192
s_lshl_b32 s88, s38, 18
s_add_u32 s88, s88, s46
s_add_u32 s89, s88, 0x100000
s_cmp_ge_u32 s32, 2
s_cbranch_scc1 Lco_267
buffer_store_dwordx2 v[120:121], v12, s[4:7], s88 offen sc1
buffer_store_dwordx2 v[120:121], v12, s[4:7], s89 offen sc1
Lco_267:
s_add_u32 s38, s45, 131072
buffer_store_dwordx2 v[120:121], v10, s[4:7], s38 offen sc1
buffer_store_dword v120, v11, s[4:7], s38 offen sc1
buffer_store_dword v120, v27, s[4:7], s38 offen sc1
s_mov_b32 s38, 2
s_mov_b32 s46, 0
s_lshl_b32 s88, s38, 18
s_add_u32 s88, s88, s46
s_add_u32 s89, s88, 0x100000
s_cmp_ge_u32 s32, 2
s_cbranch_scc1 Lco_268
buffer_store_dwordx2 v[120:121], v12, s[4:7], s88 offen sc1
buffer_store_dwordx2 v[120:121], v12, s[4:7], s89 offen sc1
Lco_268:
s_mov_b32 s46, 8192
s_lshl_b32 s88, s38, 18
s_add_u32 s88, s88, s46
s_add_u32 s89, s88, 0x100000
s_cmp_ge_u32 s32, 2
s_cbranch_scc1 Lco_269
buffer_store_dwordx2 v[120:121], v12, s[4:7], s88 offen sc1
buffer_store_dwordx2 v[120:121], v12, s[4:7], s89 offen sc1
Lco_269:
s_add_u32 s38, s45, 196608
buffer_store_dwordx2 v[120:121], v10, s[4:7], s38 offen sc1
buffer_store_dword v120, v11, s[4:7], s38 offen sc1
buffer_store_dword v120, v27, s[4:7], s38 offen sc1
s_mov_b32 s38, 3
s_mov_b32 s46, 0
s_lshl_b32 s88, s38, 18
s_add_u32 s88, s88, s46
s_add_u32 s89, s88, 0x100000
s_cmp_ge_u32 s32, 2
s_cbranch_scc1 Lco_270
buffer_store_dwordx2 v[120:121], v12, s[4:7], s88 offen sc1
buffer_store_dwordx2 v[120:121], v12, s[4:7], s89 offen sc1
Lco_270:
s_mov_b32 s46, 8192
s_lshl_b32 s88, s38, 18
s_add_u32 s88, s88, s46
s_add_u32 s89, s88, 0x100000
s_cmp_ge_u32 s32, 2
s_cbranch_scc1 Lco_271
buffer_store_dwordx2 v[120:121], v12, s[4:7], s88 offen sc1
buffer_store_dwordx2 v[120:121], v12, s[4:7], s89 offen sc1
Lco_271:
v_mov_b32 v7, 1
buffer_store_dword v7, v3, s[4:7], s59 offen sc1
s_waitcnt vmcnt(0)
v_min_u32 v56, -2, v56
v_min_u32 v57, -2, v57
buffer_store_dwordx2 v[56:57], v10, s[4:7], s45 offen sc1
s_lshl_b32 s52, s35, 16
s_or_b32 s52, s52, 1
s_waitcnt vmcnt(0)
s_barrier
s_cmp_lg_u32 s32, 0
s_cbranch_scc1 Lar_272
s_mov_b64 exec, 1
v_mov_b32 v48, 32
v_mov_b32 v49, s52
buffer_atomic_add v49, v48, s[12:15], 0 offen sc1
s_mov_b64 exec, -1
Lar_272:
v_lshrrev_b32 v54, 3, v45
v_and_b32 v55, 7, v45
v_lshlrev_b32 v55, 4, v55
v_lshl_add_u32 v50, v54, 13, v55
v_lshl_add_u32 v51, v54, 11, v55
s_mul_i32 s38, s32, 40960
v_and_b32 v55, 3, v45
v_lshl_add_u32 v55, v55, 3, s38
v_lshrrev_b32 v54, 2, v45
v_lshl_add_u32 v52, v54, 7, v55
v_and_b32 v53, 16, v45
v_bfe_u32 v54, v45, 5, 1
v_lshl_add_u32 v53, v54, 3, v53
v_bfe_u32 v54, v45, 3, 1
v_lshl_add_u32 v53, v54, 2, v53
v_bfe_u32 v54, v45, 2, 1
v_add_u32 v53, v53, v54
v_lshl_add_u32 v53, v53, 7, v55
s_mov_b32 s8, s20
s_and_b32 s9, s21, 0xffff
s_mov_b32 s10, 0x800000
s_mov_b32 s11, 0x20000
s_lshl_b32 s39, s32, 21
s_lshl_b32 s38, s33, 4
s_add_u32 s38, s38, s54
s_lshl_b32 s38, s38, 7
s_add_u32 s39, s39, s38
s_add_u32 s39, s39, 0
s_mul_i32 s38, s32, 40960
s_add_u32 m0, s38, 0
s_nop 0
buffer_load_dwordx4 v50, s[8:11], s39 offen lds
s_add_u32 m0, m0, 1024
s_add_u32 s39, s39, 65536
buffer_load_dwordx4 v50, s[8:11], s39 offen lds
s_add_u32 m0, m0, 1024
s_add_u32 s39, s39, 65536
buffer_load_dwordx4 v50, s[8:11], s39 offen lds
s_add_u32 m0, m0, 1024
s_add_u32 s39, s39, 65536
buffer_load_dwordx4 v50, s[8:11], s39 offen lds
s_add_u32 m0, m0, 1024
s_add_u32 s39, s39, 65536
buffer_load_dwordx4 v50, s[8:11], s39 offen lds
s_add_u32 m0, m0, 1024
s_add_u32 s39, s39, 65536
buffer_load_dwordx4 v50, s[8:11], s39 offen lds
s_add_u32 m0, m0, 1024
s_add_u32 s39, s39, 65536
buffer_load_dwordx4 v50, s[8:11], s39 offen lds
s_add_u32 m0, m0, 1024
s_add_u32 s39, s39, 65536
buffer_load_dwordx4 v50, s[8:11], s39 offen lds
s_lshl_b32 s39, s32, 21
s_lshl_b32 s38, s33, 4
s_add_u32 s38, s38, s54
s_lshl_b32 s38, s38, 7
s_add_u32 s39, s39, s38
s_add_u32 s39, s39, 524288
s_mul_i32 s38, s32, 40960
s_add_u32 m0, s38, 8192
s_nop 0
buffer_load_dwordx4 v50, s[8:11], s39 offen lds
s_add_u32 m0, m0, 1024
s_add_u32 s39, s39, 65536
buffer_load_dwordx4 v50, s[8:11], s39 offen lds
s_add_u32 m0, m0, 1024
s_add_u32 s39, s39, 65536
buffer_load_dwordx4 v50, s[8:11], s39 offen lds
s_add_u32 m0, m0, 1024
s_add_u32 s39, s39, 65536
buffer_load_dwordx4 v50, s[8:11], s39 offen lds
s_add_u32 m0, m0, 1024
s_add_u32 s39, s39, 65536
buffer_load_dwordx4 v50, s[8:11], s39 offen lds
s_add_u32 m0, m0, 1024
s_add_u32 s39, s39, 65536
buffer_load_dwordx4 v50, s[8:11], s39 offen lds
s_add_u32 m0, m0, 1024
s_add_u32 s39, s39, 65536
buffer_load_dwordx4 v50, s[8:11], s39 offen lds
s_add_u32 m0, m0, 1024
s_add_u32 s39, s39, 65536
buffer_load_dwordx4 v50, s[8:11], s39 offen lds
s_lshl_b32 s39, s32, 21
s_lshl_b32 s38, s33, 4
s_add_u32 s38, s38, s54
s_lshl_b32 s38, s38, 7
s_add_u32 s39, s39, s38
s_add_u32 s39, s39, 1048576
s_mul_i32 s38, s32, 40960
s_add_u32 m0, s38, 16384
s_nop 0
buffer_load_dwordx4 v50, s[8:11], s39 offen lds
s_add_u32 m0, m0, 1024
s_add_u32 s39, s39, 65536
buffer_load_dwordx4 v50, s[8:11], s39 offen lds
s_add_u32 m0, m0, 1024
s_add_u32 s39, s39, 65536
buffer_load_dwordx4 v50, s[8:11], s39 offen lds
s_add_u32 m0, m0, 1024
s_add_u32 s39, s39, 65536
buffer_load_dwordx4 v50, s[8:11], s39 offen lds
s_add_u32 m0, m0, 1024
s_add_u32 s39, s39, 65536
buffer_load_dwordx4 v50, s[8:11], s39 offen lds
s_add_u32 m0, m0, 1024
s_add_u32 s39, s39, 65536
buffer_load_dwordx4 v50, s[8:11], s39 offen lds
s_add_u32 m0, m0, 1024
s_add_u32 s39, s39, 65536
buffer_load_dwordx4 v50, s[8:11], s39 offen lds
s_add_u32 m0, m0, 1024
s_add_u32 s39, s39, 65536
buffer_load_dwordx4 v50, s[8:11], s39 offen lds
s_lshl_b32 s39, s32, 21
s_lshl_b32 s38, s33, 4
s_add_u32 s38, s38, s54
s_lshl_b32 s38, s38, 7
s_add_u32 s39, s39, s38
s_add_u32 s39, s39, 1572864
s_mul_i32 s38, s32, 40960
s_add_u32 m0, s38, 24576
s_nop 0
buffer_load_dwordx4 v50, s[8:11], s39 offen lds
s_add_u32 m0, m0, 1024
s_add_u32 s39, s39, 65536
buffer_load_dwordx4 v50, s[8:11], s39 offen lds
s_add_u32 m0, m0, 1024
s_add_u32 s39, s39, 65536
buffer_load_dwordx4 v50, s[8:11], s39 offen lds
s_add_u32 m0, m0, 1024
s_add_u32 s39, s39, 65536
buffer_load_dwordx4 v50, s[8:11], s39 offen lds
s_add_u32 m0, m0, 1024
s_add_u32 s39, s39, 65536
buffer_load_dwordx4 v50, s[8:11], s39 offen lds
s_add_u32 m0, m0, 1024
s_add_u32 s39, s39, 65536
buffer_load_dwordx4 v50, s[8:11], s39 offen lds
s_add_u32 m0, m0, 1024
s_add_u32 s39, s39, 65536
buffer_load_dwordx4 v50, s[8:11], s39 offen lds
s_add_u32 m0, m0, 1024
s_add_u32 s39, s39, 65536
buffer_load_dwordx4 v50, s[8:11], s39 offen lds
s_mov_b32 s8, s22
s_and_b32 s9, s23, 0xffff
s_mov_b32 s10, 0x800000
s_mov_b32 s11, 0x20000
s_lshl_b32 s39, s32, 21
s_lshl_b32 s38, s33, 4
s_add_u32 s38, s38, s54
s_lshl_b32 s38, s38, 7
s_add_u32 s39, s39, s38
s_add_u32 s39, s39, 0
s_mul_i32 s38, s32, 40960
s_add_u32 m0, s38, 32768
s_nop 0
buffer_load_dwordx4 v50, s[8:11], s39 offen lds
s_add_u32 m0, m0, 1024
s_add_u32 s39, s39, 65536
buffer_load_dwordx4 v50, s[8:11], s39 offen lds
s_add_u32 m0, m0, 1024
s_add_u32 s39, s39, 65536
buffer_load_dwordx4 v50, s[8:11], s39 offen lds
s_add_u32 m0, m0, 1024
s_add_u32 s39, s39, 65536
buffer_load_dwordx4 v50, s[8:11], s39 offen lds
s_add_u32 m0, m0, 1024
s_add_u32 s39, s39, 65536
buffer_load_dwordx4 v50, s[8:11], s39 offen lds
s_add_u32 m0, m0, 1024
s_add_u32 s39, s39, 65536
buffer_load_dwordx4 v50, s[8:11], s39 offen lds
s_add_u32 m0, m0, 1024
s_add_u32 s39, s39, 65536
buffer_load_dwordx4 v50, s[8:11], s39 offen lds
s_add_u32 m0, m0, 1024
s_add_u32 s39, s39, 65536
buffer_load_dwordx4 v50, s[8:11], s39 offen lds
s_waitcnt vmcnt(32)
ds_read_b64_tr_b16 a[0:1], v52 offset:0
ds_read_b64_tr_b16 a[2:3], v52 offset:2048
ds_read_b64_tr_b16 a[4:5], v52 offset:4096
ds_read_b64_tr_b16 a[6:7], v52 offset:6144
ds_read_b64_tr_b16 a[8:9], v52 offset:32
ds_read_b64_tr_b16 a[10:11], v52 offset:2080
ds_read_b64_tr_b16 a[12:13], v52 offset:4128
ds_read_b64_tr_b16 a[14:15], v52 offset:6176
ds_read_b64_tr_b16 a[16:17], v52 offset:64
ds_read_b64_tr_b16 a[18:19], v52 offset:2112
ds_read_b64_tr_b16 a[20:21], v52 offset:4160
ds_read_b64_tr_b16 a[22:23], v52 offset:6208
ds_read_b64_tr_b16 a[24:25], v52 offset:96
ds_read_b64_tr_b16 a[26:27], v52 offset:2144
ds_read_b64_tr_b16 a[28:29], v52 offset:4192
ds_read_b64_tr_b16 a[30:31], v52 offset:6240
s_waitcnt lgkmcnt(0)
s_lshl_b32 s39, s32, 21
s_lshl_b32 s38, s33, 4
s_add_u32 s38, s38, s54
s_lshl_b32 s38, s38, 7
s_add_u32 s39, s39, s38
s_add_u32 s39, s39, 524288
s_mul_i32 s38, s32, 40960
s_add_u32 m0, s38, 0
s_nop 0
buffer_load_dwordx4 v50, s[8:11], s39 offen lds
s_add_u32 m0, m0, 1024
s_add_u32 s39, s39, 65536
buffer_load_dwordx4 v50, s[8:11], s39 offen lds
s_add_u32 m0, m0, 1024
s_add_u32 s39, s39, 65536
buffer_load_dwordx4 v50, s[8:11], s39 offen lds
s_add_u32 m0, m0, 1024
s_add_u32 s39, s39, 65536
buffer_load_dwordx4 v50, s[8:11], s39 offen lds
s_add_u32 m0, m0, 1024
s_add_u32 s39, s39, 65536
buffer_load_dwordx4 v50, s[8:11], s39 offen lds
s_add_u32 m0, m0, 1024
s_add_u32 s39, s39, 65536
buffer_load_dwordx4 v50, s[8:11], s39 offen lds
s_add_u32 m0, m0, 1024
s_add_u32 s39, s39, 65536
buffer_load_dwordx4 v50, s[8:11], s39 offen lds
s_add_u32 m0, m0, 1024
s_add_u32 s39, s39, 65536
buffer_load_dwordx4 v50, s[8:11], s39 offen lds
s_waitcnt vmcnt(32)
ds_read_b64_tr_b16 a[32:33], v52 offset:8192
ds_read_b64_tr_b16 a[34:35], v52 offset:10240
ds_read_b64_tr_b16 a[36:37], v52 offset:12288
ds_read_b64_tr_b16 a[38:39], v52 offset:14336
ds_read_b64_tr_b16 a[40:41], v52 offset:8224
ds_read_b64_tr_b16 a[42:43], v52 offset:10272
ds_read_b64_tr_b16 a[44:45], v52 offset:12320
ds_read_b64_tr_b16 a[46:47], v52 offset:14368
ds_read_b64_tr_b16 a[48:49], v52 offset:8256
ds_read_b64_tr_b16 a[50:51], v52 offset:10304
ds_read_b64_tr_b16 a[52:53], v52 offset:12352
ds_read_b64_tr_b16 a[54:55], v52 offset:14400
ds_read_b64_tr_b16 a[56:57], v52 offset:8288
ds_read_b64_tr_b16 a[58:59], v52 offset:10336
ds_read_b64_tr_b16 a[60:61], v52 offset:12384
ds_read_b64_tr_b16 a[62:63], v52 offset:14432
s_waitcnt lgkmcnt(0)
s_lshl_b32 s39, s32, 21
s_lshl_b32 s38, s33, 4
s_add_u32 s38, s38, s54
s_lshl_b32 s38, s38, 7
s_add_u32 s39, s39, s38
s_add_u32 s39, s39, 1048576
s_mul_i32 s38, s32, 40960
s_add_u32 m0, s38, 8192
s_nop 0
buffer_load_dwordx4 v50, s[8:11], s39 offen lds
s_add_u32 m0, m0, 1024
s_add_u32 s39, s39, 65536
buffer_load_dwordx4 v50, s[8:11], s39 offen lds
s_add_u32 m0, m0, 1024
s_add_u32 s39, s39, 65536
buffer_load_dwordx4 v50, s[8:11], s39 offen lds
s_add_u32 m0, m0, 1024
s_add_u32 s39, s39, 65536
buffer_load_dwordx4 v50, s[8:11], s39 offen lds
s_add_u32 m0, m0, 1024
s_add_u32 s39, s39, 65536
buffer_load_dwordx4 v50, s[8:11], s39 offen lds
s_add_u32 m0, m0, 1024
s_add_u32 s39, s39, 65536
buffer_load_dwordx4 v50, s[8:11], s39 offen lds
s_add_u32 m0, m0, 1024
s_add_u32 s39, s39, 65536
buffer_load_dwordx4 v50, s[8:11], s39 offen lds
s_add_u32 m0, m0, 1024
s_add_u32 s39, s39, 65536
buffer_load_dwordx4 v50, s[8:11], s39 offen lds
s_waitcnt vmcnt(32)
ds_read_b64_tr_b16 a[64:65], v52 offset:16384
ds_read_b64_tr_b16 a[66:67], v52 offset:18432
ds_read_b64_tr_b16 a[68:69], v52 offset:20480
ds_read_b64_tr_b16 a[70:71], v52 offset:22528
ds_read_b64_tr_b16 a[72:73], v52 offset:16416
ds_read_b64_tr_b16 a[74:75], v52 offset:18464
ds_read_b64_tr_b16 a[76:77], v52 offset:20512
ds_read_b64_tr_b16 a[78:79], v52 offset:22560
ds_read_b64_tr_b16 a[80:81], v52 offset:16448
ds_read_b64_tr_b16 a[82:83], v52 offset:18496
ds_read_b64_tr_b16 a[84:85], v52 offset:20544
ds_read_b64_tr_b16 a[86:87], v52 offset:22592
ds_read_b64_tr_b16 a[88:89], v52 offset:16480
ds_read_b64_tr_b16 a[90:91], v52 offset:18528
ds_read_b64_tr_b16 a[92:93], v52 offset:20576
ds_read_b64_tr_b16 a[94:95], v52 offset:22624
s_waitcnt lgkmcnt(0)
s_lshl_b32 s39, s32, 21
s_lshl_b32 s38, s33, 4
s_add_u32 s38, s38, s54
s_lshl_b32 s38, s38, 7
s_add_u32 s39, s39, s38
s_add_u32 s39, s39, 1572864
s_mul_i32 s38, s32, 40960
s_add_u32 m0, s38, 16384
s_nop 0
buffer_load_dwordx4 v50, s[8:11], s39 offen lds
s_add_u32 m0, m0, 1024
s_add_u32 s39, s39, 65536
buffer_load_dwordx4 v50, s[8:11], s39 offen lds
s_add_u32 m0, m0, 1024
s_add_u32 s39, s39, 65536
buffer_load_dwordx4 v50, s[8:11], s39 offen lds
s_add_u32 m0, m0, 1024
s_add_u32 s39, s39, 65536
buffer_load_dwordx4 v50, s[8:11], s39 offen lds
s_add_u32 m0, m0, 1024
s_add_u32 s39, s39, 65536
buffer_load_dwordx4 v50, s[8:11], s39 offen lds
s_add_u32 m0, m0, 1024
s_add_u32 s39, s39, 65536
buffer_load_dwordx4 v50, s[8:11], s39 offen lds
s_add_u32 m0, m0, 1024
s_add_u32 s39, s39, 65536
buffer_load_dwordx4 v50, s[8:11], s39 offen lds
s_add_u32 m0, m0, 1024
s_add_u32 s39, s39, 65536
buffer_load_dwordx4 v50, s[8:11], s39 offen lds
s_waitcnt vmcnt(32)
ds_read_b64_tr_b16 a[96:97], v52 offset:24576
ds_read_b64_tr_b16 a[98:99], v52 offset:26624
ds_read_b64_tr_b16 a[100:101], v52 offset:28672
ds_read_b64_tr_b16 a[102:103], v52 offset:30720
ds_read_b64_tr_b16 a[104:105], v52 offset:24608
ds_read_b64_tr_b16 a[106:107], v52 offset:26656
ds_read_b64_tr_b16 a[108:109], v52 offset:28704
ds_read_b64_tr_b16 a[110:111], v52 offset:30752
ds_read_b64_tr_b16 a[112:113], v52 offset:24640
ds_read_b64_tr_b16 a[114:115], v52 offset:26688
ds_read_b64_tr_b16 a[116:117], v52 offset:28736
ds_read_b64_tr_b16 a[118:119], v52 offset:30784
ds_read_b64_tr_b16 a[120:121], v52 offset:24672
ds_read_b64_tr_b16 a[122:123], v52 offset:26720
ds_read_b64_tr_b16 a[124:125], v52 offset:28768
ds_read_b64_tr_b16 a[126:127], v52 offset:30816
s_waitcnt lgkmcnt(0)
s_mov_b32 s8, s24
s_and_b32 s9, s25, 0xffff
s_mov_b32 s10, 0x800000
s_mov_b32 s11, 0x20000
s_lshl_b32 s39, s33, 2
s_add_u32 s39, s39, s32
s_lshl_b32 s39, s39, 19
s_lshl_b32 s38, s54, 7
s_add_u32 s39, s39, s38
s_add_u32 s39, s39, 0
s_mul_i32 s38, s32, 40960
s_add_u32 m0, s38, 24576
s_nop 0
buffer_load_dwordx4 v51, s[8:11], s39 offen lds
s_add_u32 m0, m0, 1024
s_add_u32 s39, s39, 16384
buffer_load_dwordx4 v51, s[8:11], s39 offen lds
s_add_u32 m0, m0, 1024
s_add_u32 s39, s39, 16384
buffer_load_dwordx4 v51, s[8:11], s39 offen lds
s_add_u32 m0, m0, 1024
s_add_u32 s39, s39, 16384
buffer_load_dwordx4 v51, s[8:11], s39 offen lds
s_add_u32 m0, m0, 1024
s_add_u32 s39, s39, 16384
buffer_load_dwordx4 v51, s[8:11], s39 offen lds
s_add_u32 m0, m0, 1024
s_add_u32 s39, s39, 16384
buffer_load_dwordx4 v51, s[8:11], s39 offen lds
s_add_u32 m0, m0, 1024
s_add_u32 s39, s39, 16384
buffer_load_dwordx4 v51, s[8:11], s39 offen lds
s_add_u32 m0, m0, 1024
s_add_u32 s39, s39, 16384
buffer_load_dwordx4 v51, s[8:11], s39 offen lds
s_waitcnt vmcnt(32)
ds_read_b64_tr_b16 v[128:129], v52 offset:32768
ds_read_b64_tr_b16 v[130:131], v52 offset:34816
ds_read_b64_tr_b16 v[132:133], v52 offset:36864
ds_read_b64_tr_b16 v[134:135], v52 offset:38912
ds_read_b64_tr_b16 v[136:137], v52 offset:32800
ds_read_b64_tr_b16 v[138:139], v52 offset:34848
ds_read_b64_tr_b16 v[140:141], v52 offset:36896
ds_read_b64_tr_b16 v[142:143], v52 offset:38944
ds_read_b64_tr_b16 v[144:145], v52 offset:32832
ds_read_b64_tr_b16 v[146:147], v52 offset:34880
ds_read_b64_tr_b16 v[148:149], v52 offset:36928
ds_read_b64_tr_b16 v[150:151], v52 offset:38976
ds_read_b64_tr_b16 v[152:153], v52 offset:32864
ds_read_b64_tr_b16 v[154:155], v52 offset:34912
ds_read_b64_tr_b16 v[156:157], v52 offset:36960
ds_read_b64_tr_b16 v[158:159], v52 offset:39008
s_waitcnt lgkmcnt(0)
s_lshl_b32 s39, s33, 2
s_add_u32 s39, s39, s32
s_lshl_b32 s39, s39, 19
s_lshl_b32 s38, s54, 7
s_add_u32 s39, s39, s38
s_add_u32 s39, s39, 131072
s_mul_i32 s38, s32, 40960
s_add_u32 m0, s38, 32768
s_nop 0
buffer_load_dwordx4 v51, s[8:11], s39 offen lds
s_add_u32 m0, m0, 1024
s_add_u32 s39, s39, 16384
buffer_load_dwordx4 v51, s[8:11], s39 offen lds
s_add_u32 m0, m0, 1024
s_add_u32 s39, s39, 16384
buffer_load_dwordx4 v51, s[8:11], s39 offen lds
s_add_u32 m0, m0, 1024
s_add_u32 s39, s39, 16384
buffer_load_dwordx4 v51, s[8:11], s39 offen lds
s_add_u32 m0, m0, 1024
s_add_u32 s39, s39, 16384
buffer_load_dwordx4 v51, s[8:11], s39 offen lds
s_add_u32 m0, m0, 1024
s_add_u32 s39, s39, 16384
buffer_load_dwordx4 v51, s[8:11], s39 offen lds
s_add_u32 m0, m0, 1024
s_add_u32 s39, s39, 16384
buffer_load_dwordx4 v51, s[8:11], s39 offen lds
s_add_u32 m0, m0, 1024
s_add_u32 s39, s39, 16384
buffer_load_dwordx4 v51, s[8:11], s39 offen lds
s_waitcnt vmcnt(32)
ds_read_b64_tr_b16 v[160:161], v52 offset:0
ds_read_b64_tr_b16 v[162:163], v52 offset:2048
ds_read_b64_tr_b16 v[164:165], v52 offset:4096
ds_read_b64_tr_b16 v[166:167], v52 offset:6144
ds_read_b64_tr_b16 v[168:169], v52 offset:32
ds_read_b64_tr_b16 v[170:171], v52 offset:2080
ds_read_b64_tr_b16 v[172:173], v52 offset:4128
ds_read_b64_tr_b16 v[174:175], v52 offset:6176
ds_read_b64_tr_b16 v[176:177], v52 offset:64
ds_read_b64_tr_b16 v[178:179], v52 offset:2112
ds_read_b64_tr_b16 v[180:181], v52 offset:4160
ds_read_b64_tr_b16 v[182:183], v52 offset:6208
ds_read_b64_tr_b16 v[184:185], v52 offset:96
ds_read_b64_tr_b16 v[186:187], v52 offset:2144
ds_read_b64_tr_b16 v[188:189], v52 offset:4192
ds_read_b64_tr_b16 v[190:191], v52 offset:6240
s_waitcnt lgkmcnt(0)
s_lshl_b32 s39, s33, 2
s_add_u32 s39, s39, s32
s_lshl_b32 s39, s39, 19
s_lshl_b32 s38, s54, 7
s_add_u32 s39, s39, s38
s_add_u32 s39, s39, 262144
s_mul_i32 s38, s32, 40960
s_add_u32 m0, s38, 0
s_nop 0
buffer_load_dwordx4 v51, s[8:11], s39 offen lds
s_add_u32 m0, m0, 1024
s_add_u32 s39, s39, 16384
buffer_load_dwordx4 v51, s[8:11], s39 offen lds
s_add_u32 m0, m0, 1024
s_add_u32 s39, s39, 16384
buffer_load_dwordx4 v51, s[8:11], s39 offen lds
s_add_u32 m0, m0, 1024
s_add_u32 s39, s39, 16384
buffer_load_dwordx4 v51, s[8:11], s39 offen lds
s_add_u32 m0, m0, 1024
s_add_u32 s39, s39, 16384
buffer_load_dwordx4 v51, s[8:11], s39 offen lds
s_add_u32 m0, m0, 1024
s_add_u32 s39, s39, 16384
buffer_load_dwordx4 v51, s[8:11], s39 offen lds
s_add_u32 m0, m0, 1024
s_add_u32 s39, s39, 16384
buffer_load_dwordx4 v51, s[8:11], s39 offen lds
s_add_u32 m0, m0, 1024
s_add_u32 s39, s39, 16384
buffer_load_dwordx4 v51, s[8:11], s39 offen lds
s_waitcnt vmcnt(32)
ds_read_b64_tr_b16 v[192:193], v52 offset:8192
ds_read_b64_tr_b16 v[194:195], v52 offset:10240
ds_read_b64_tr_b16 v[196:197], v52 offset:12288
ds_read_b64_tr_b16 v[198:199], v52 offset:14336
ds_read_b64_tr_b16 v[200:201], v52 offset:8224
ds_read_b64_tr_b16 v[202:203], v52 offset:10272
ds_read_b64_tr_b16 v[204:205], v52 offset:12320
ds_read_b64_tr_b16 v[206:207], v52 offset:14368
ds_read_b64_tr_b16 v[208:209], v52 offset:8256
ds_read_b64_tr_b16 v[210:211], v52 offset:10304
ds_read_b64_tr_b16 v[212:213], v52 offset:12352
ds_read_b64_tr_b16 v[214:215], v52 offset:14400
ds_read_b64_tr_b16 v[216:217], v52 offset:8288
ds_read_b64_tr_b16 v[218:219], v52 offset:10336
ds_read_b64_tr_b16 v[220:221], v52 offset:12384
ds_read_b64_tr_b16 v[222:223], v52 offset:14432
s_waitcnt lgkmcnt(0)
s_lshl_b32 s39, s33, 2
s_add_u32 s39, s39, s32
s_lshl_b32 s39, s39, 19
s_lshl_b32 s38, s54, 7
s_add_u32 s39, s39, s38
s_add_u32 s39, s39, 393216
s_mul_i32 s38, s32, 40960
s_add_u32 m0, s38, 8192
s_nop 0
buffer_load_dwordx4 v51, s[8:11], s39 offen lds
s_add_u32 m0, m0, 1024
s_add_u32 s39, s39, 16384
buffer_load_dwordx4 v51, s[8:11], s39 offen lds
s_add_u32 m0, m0, 1024
s_add_u32 s39, s39, 16384
buffer_load_dwordx4 v51, s[8:11], s39 offen lds
s_add_u32 m0, m0, 1024
s_add_u32 s39, s39, 16384
buffer_load_dwordx4 v51, s[8:11], s39 offen lds
s_add_u32 m0, m0, 1024
s_add_u32 s39, s39, 16384
buffer_load_dwordx4 v51, s[8:11], s39 offen lds
s_add_u32 m0, m0, 1024
s_add_u32 s39, s39, 16384
buffer_load_dwordx4 v51, s[8:11], s39 offen lds
s_add_u32 m0, m0, 1024
s_add_u32 s39, s39, 16384
buffer_load_dwordx4 v51, s[8:11], s39 offen lds
s_add_u32 m0, m0, 1024
s_add_u32 s39, s39, 16384
buffer_load_dwordx4 v51, s[8:11], s39 offen lds
s_waitcnt vmcnt(32)
ds_read_b64_tr_b16 v[224:225], v52 offset:16384
ds_read_b64_tr_b16 v[226:227], v52 offset:18432
ds_read_b64_tr_b16 v[228:229], v52 offset:20480
ds_read_b64_tr_b16 v[230:231], v52 offset:22528
ds_read_b64_tr_b16 v[232:233], v52 offset:16416
ds_read_b64_tr_b16 v[234:235], v52 offset:18464
ds_read_b64_tr_b16 v[236:237], v52 offset:20512
ds_read_b64_tr_b16 v[238:239], v52 offset:22560
ds_read_b64_tr_b16 v[240:241], v52 offset:16448
ds_read_b64_tr_b16 v[242:243], v52 offset:18496
ds_read_b64_tr_b16 v[244:245], v52 offset:20544
ds_read_b64_tr_b16 v[246:247], v52 offset:22592
ds_read_b64_tr_b16 v[248:249], v52 offset:16480
ds_read_b64_tr_b16 v[250:251], v52 offset:18528
ds_read_b64_tr_b16 v[252:253], v52 offset:20576
ds_read_b64_tr_b16 v[254:255], v52 offset:22624
s_waitcnt lgkmcnt(0)
s_waitcnt vmcnt(24)
ds_read_b64_tr_b16 a[128:129], v53 offset:24576
ds_read_b64_tr_b16 a[130:131], v53 offset:24832
ds_read_b64_tr_b16 a[132:133], v53 offset:28672
ds_read_b64_tr_b16 a[134:135], v53 offset:28928
ds_read_b64_tr_b16 a[136:137], v53 offset:24608
ds_read_b64_tr_b16 a[138:139], v53 offset:24864
ds_read_b64_tr_b16 a[140:141], v53 offset:28704
ds_read_b64_tr_b16 a[142:143], v53 offset:28960
ds_read_b64_tr_b16 a[144:145], v53 offset:24640
ds_read_b64_tr_b16 a[146:147], v53 offset:24896
ds_read_b64_tr_b16 a[148:149], v53 offset:28736
ds_read_b64_tr_b16 a[150:151], v53 offset:28992
ds_read_b64_tr_b16 a[152:153], v53 offset:24672
ds_read_b64_tr_b16 a[154:155], v53 offset:24928
ds_read_b64_tr_b16 a[156:157], v53 offset:28768
ds_read_b64_tr_b16 a[158:159], v53 offset:29024
s_waitcnt lgkmcnt(0)
s_waitcnt vmcnt(16)
ds_read_b64_tr_b16 a[160:161], v53 offset:32768
ds_read_b64_tr_b16 a[162:163], v53 offset:33024
ds_read_b64_tr_b16 a[164:165], v53 offset:36864
ds_read_b64_tr_b16 a[166:167], v53 offset:37120
ds_read_b64_tr_b16 a[168:169], v53 offset:32800
ds_read_b64_tr_b16 a[170:171], v53 offset:33056
ds_read_b64_tr_b16 a[172:173], v53 offset:36896
ds_read_b64_tr_b16 a[174:175], v53 offset:37152
ds_read_b64_tr_b16 a[176:177], v53 offset:32832
ds_read_b64_tr_b16 a[178:179], v53 offset:33088
ds_read_b64_tr_b16 a[180:181], v53 offset:36928
ds_read_b64_tr_b16 a[182:183], v53 offset:37184
ds_read_b64_tr_b16 a[184:185], v53 offset:32864
ds_read_b64_tr_b16 a[186:187], v53 offset:33120
ds_read_b64_tr_b16 a[188:189], v53 offset:36960
ds_read_b64_tr_b16 a[190:191], v53 offset:37216
s_waitcnt lgkmcnt(0)
s_waitcnt vmcnt(8)
ds_read_b64_tr_b16 a[192:193], v53 offset:0
ds_read_b64_tr_b16 a[194:195], v53 offset:256
ds_read_b64_tr_b16 a[196:197], v53 offset:4096
ds_read_b64_tr_b16 a[198:199], v53 offset:4352
ds_read_b64_tr_b16 a[200:201], v53 offset:32
ds_read_b64_tr_b16 a[202:203], v53 offset:288
ds_read_b64_tr_b16 a[204:205], v53 offset:4128
ds_read_b64_tr_b16 a[206:207], v53 offset:4384
ds_read_b64_tr_b16 a[208:209], v53 offset:64
ds_read_b64_tr_b16 a[210:211], v53 offset:320
ds_read_b64_tr_b16 a[212:213], v53 offset:4160
ds_read_b64_tr_b16 a[214:215], v53 offset:4416
ds_read_b64_tr_b16 a[216:217], v53 offset:96
ds_read_b64_tr_b16 a[218:219], v53 offset:352
ds_read_b64_tr_b16 a[220:221], v53 offset:4192
ds_read_b64_tr_b16 a[222:223], v53 offset:4448
s_waitcnt lgkmcnt(0)
s_waitcnt vmcnt(0)
ds_read_b64_tr_b16 a[224:225], v53 offset:8192
ds_read_b64_tr_b16 a[226:227], v53 offset:8448
ds_read_b64_tr_b16 a[228:229], v53 offset:12288
ds_read_b64_tr_b16 a[230:231], v53 offset:12544
ds_read_b64_tr_b16 a[232:233], v53 offset:8224
ds_read_b64_tr_b16 a[234:235], v53 offset:8480
ds_read_b64_tr_b16 a[236:237], v53 offset:12320
ds_read_b64_tr_b16 a[238:239], v53 offset:12576
ds_read_b64_tr_b16 a[240:241], v53 offset:8256
ds_read_b64_tr_b16 a[242:243], v53 offset:8512
ds_read_b64_tr_b16 a[244:245], v53 offset:12352
ds_read_b64_tr_b16 a[246:247], v53 offset:12608
ds_read_b64_tr_b16 a[248:249], v53 offset:8288
ds_read_b64_tr_b16 a[250:251], v53 offset:8544
ds_read_b64_tr_b16 a[252:253], v53 offset:12384
ds_read_b64_tr_b16 a[254:255], v53 offset:12640
s_waitcnt lgkmcnt(0)
v_mov_b32 v48, 32
Lst_273:
s_sub_u32 s37, s37, 1
s_cbranch_scc1 Lend_1
s_sleep 4
buffer_load_dword v49, v48, s[12:15], 0 offen sc1
s_waitcnt vmcnt(0)
v_readfirstlane_b32 s38, v49
s_nop 3
s_and_b32 s39, s38, 0xffff
s_cmp_lg_u32 s39, 256
s_cbranch_scc1 Lst_273
s_bfe_u32 s35, s38, 0x80010
s_bfe_u32 s46, s38, 0x10018
s_lshl_b32 s46, s46, 13
s_barrier
s_mul_i32 m0, s32, 2560
v_mov_b32 v44, 0
v_mov_b32 v45, 0
v_mov_b32 v46, 0
v_mov_b32 v47, 0
v_mov_b32 v48, 0
v_mov_b32 v49, 0
v_mov_b32 v50, 0
v_mov_b32 v51, 0
v_mov_b32 v52, 0
v_mov_b32 v53, 0
v_mov_b32 v54, 0
v_mov_b32 v55, 0
v_mov_b32 v56, 0
v_mov_b32 v57, 0
v_mov_b32 v58, 0
v_mov_b32 v59, 0
v_mov_b32 v60, 0
v_mov_b32 v61, 0
v_mov_b32 v62, 0
v_mov_b32 v63, 0
v_mov_b32 v64, 0
v_mov_b32 v65, 0
v_mov_b32 v66, 0
v_mov_b32 v67, 0
v_mov_b32 v68, 0
v_mov_b32 v69, 0
v_mov_b32 v70, 0
v_mov_b32 v71, 0
v_mov_b32 v72, 0
v_mov_b32 v73, 0
v_mov_b32 v74, 0
v_mov_b32 v75, 0
s_mov_b32 s36, 0
s_cmp_lg_u32 s35, 0
s_cbranch_scc1 Lkvo_sc1_274
Lkvo_275:
s_and_b32 s38, s36, 3
s_lshl_b32 s39, s38, 16
s_add_u32 s40, s39, s45
s_xor_b32 s42, s40, 0x20000
s_add_u32 s26, s36, 1
s_mov_b64 exec, 15
buffer_load_dword v4, v1, s[4:7], s59 offen sc1
s_nop 11
buffer_load_dword v5, v1, s[4:7], s59 offen sc1
s_nop 11
buffer_load_dword v6, v1, s[4:7], s59 offen sc1
Lft_279:
s_waitcnt vmcnt(2)
v_cmp_gt_u32 vcc, s26, v4
s_cbranch_vccz Lfg_278
buffer_load_dword v4, v1, s[4:7], s59 offen sc1
s_waitcnt vmcnt(2)
v_cmp_gt_u32 vcc, s26, v5
s_cbranch_vccz Lfg_278
buffer_load_dword v5, v1, s[4:7], s59 offen sc1
s_waitcnt vmcnt(2)
v_cmp_gt_u32 vcc, s26, v6
s_cbranch_vccz Lfg_278
buffer_load_dword v6, v1, s[4:7], s59 offen sc1
s_sub_u32 s37, s37, 1
s_cbranch_scc1 Lend_1
s_branch Lft_279
Lfg_278:
s_mov_b64 exec, -1
Lkvo3_277:
buffer_load_dwordx4 v[28:31], v8, s[4:7], s40 offen offset:0 sc1
v_mfma_f32_16x16x32_bf16 v[16:19], v[20:23], v[20:23], 0
v_mfma_f32_16x16x32_bf16 v[16:19], v[20:23], v[20:23], 0
v_mfma_f32_16x16x32_bf16 v[16:19], v[20:23], v[20:23], 0
v_mfma_f32_16x16x32_bf16 v[16:19], v[20:23], v[20:23], 0
buffer_load_dwordx4 v[32:35], v8, s[4:7], s40 offen offset:1024 sc1
v_mfma_f32_16x16x32_bf16 v[16:19], v[20:23], v[20:23], 0
v_mfma_f32_16x16x32_bf16 v[16:19], v[20:23], v[20:23], 0
v_mfma_f32_16x16x32_bf16 v[16:19], v[20:23], v[20:23], 0
v_mfma_f32_16x16x32_bf16 v[16:19], v[20:23], v[20:23], 0
buffer_load_dwordx4 v[36:39], v8, s[4:7], s40 offen offset:2048 sc1
v_mfma_f32_16x16x32_bf16 v[16:19], v[20:23], v[20:23], 0
v_mfma_f32_16x16x32_bf16 v[16:19], v[20:23], v[20:23], 0
v_mfma_f32_16x16x32_bf16 v[16:19], v[20:23], v[20:23], 0
v_mfma_f32_16x16x32_bf16 v[16:19], v[20:23], v[20:23], 0
buffer_load_dwordx4 v[40:43], v8, s[4:7], s40 offen offset:3072 sc1
v_mfma_f32_16x16x32_bf16 v[16:19], v[20:23], v[20:23], 0
s_waitcnt vmcnt(3)
v_max3_u32 v26, v28, v29, v30
v_max_u32 v26, v26, v31
v_cmp_eq_u32 vcc, -1, v26
s_cbranch_vccnz Lpf_281
v_smfmac_f32_16x16x64_bf16 v[44:47], v[28:31], a[0:7], v126
v_smfmac_f32_16x16x64_bf16 v[48:51], v[28:31], a[8:15], v126
v_smfmac_f32_16x16x64_bf16 v[52:55], v[28:31], a[16:23], v126
v_smfmac_f32_16x16x64_bf16 v[56:59], v[28:31], a[24:31], v126
s_waitcnt vmcnt(2)
v_max3_u32 v26, v32, v33, v34
v_max_u32 v26, v26, v35
v_cmp_eq_u32 vcc, -1, v26
v_smfmac_f32_16x16x64_bf16 v[60:63], v[28:31], v[128:135], v126
v_smfmac_f32_16x16x64_bf16 v[64:67], v[28:31], v[136:143], v126
s_cbranch_vccnz Lpf_282
v_smfmac_f32_16x16x64_bf16 v[44:47], v[32:35], a[32:39], v126
v_smfmac_f32_16x16x64_bf16 v[48:51], v[32:35], a[40:47], v126
v_smfmac_f32_16x16x64_bf16 v[52:55], v[32:35], a[48:55], v126
v_smfmac_f32_16x16x64_bf16 v[56:59], v[32:35], a[56:63], v126
s_waitcnt vmcnt(1)
v_max3_u32 v26, v36, v37, v38
v_max_u32 v26, v26, v39
v_cmp_eq_u32 vcc, -1, v26
v_smfmac_f32_16x16x64_bf16 v[60:63], v[32:35], v[160:167], v126
v_smfmac_f32_16x16x64_bf16 v[64:67], v[32:35], v[168:175], v126
s_cbranch_vccnz Lpf_283
v_smfmac_f32_16x16x64_bf16 v[44:47], v[36:39], a[64:71], v126
v_smfmac_f32_16x16x64_bf16 v[48:51], v[36:39], a[72:79], v126
v_smfmac_f32_16x16x64_bf16 v[52:55], v[36:39], a[80:87], v126
v_smfmac_f32_16x16x64_bf16 v[56:59], v[36:39], a[88:95], v126
s_waitcnt vmcnt(0)
v_max3_u32 v26, v40, v41, v42
v_max_u32 v26, v26, v43
v_cmp_eq_u32 vcc, -1, v26
v_smfmac_f32_16x16x64_bf16 v[60:63], v[36:39], v[192:199], v126
v_smfmac_f32_16x16x64_bf16 v[64:67], v[36:39], v[200:207], v126
s_cbranch_vccnz Lpf_284
v_smfmac_f32_16x16x64_bf16 v[44:47], v[40:43], a[96:103], v126
v_smfmac_f32_16x16x64_bf16 v[48:51], v[40:43], a[104:111], v126
v_smfmac_f32_16x16x64_bf16 v[52:55], v[40:43], a[112:119], v126
v_smfmac_f32_16x16x64_bf16 v[56:59], v[40:43], a[120:127], v126
v_smfmac_f32_16x16x64_bf16 v[60:63], v[40:43], v[224:231], v126
v_smfmac_f32_16x16x64_bf16 v[64:67], v[40:43], v[232:239], v126
Lpd_280:
s_nop 2
v_add_f32 v92, v44, v45
v_add_f32 v93, v46, v47
v_add_f32 v94, v48, v49
v_add_f32 v95, v50, v51
v_add_f32 v96, v52, v53
ds_write_addtid_b32 v92 offset:0
v_add_f32 v97, v54, v55
ds_write_addtid_b32 v93 offset:640
v_add_f32 v98, v56, v57
ds_write_addtid_b32 v94 offset:288
v_add_f32 v99, v58, v59
ds_write_addtid_b32 v95 offset:928
ds_write_addtid_b32 v96 offset:1280
ds_write_addtid_b32 v97 offset:1920
ds_write_addtid_b32 v98 offset:1568
v_smfmac_f32_16x16x64_bf16 v[68:71], v[28:31], v[144:151], v126
ds_write_addtid_b32 v99 offset:2208
v_smfmac_f32_16x16x64_bf16 v[72:75], v[28:31], v[152:159], v126
v_smfmac_f32_16x16x64_bf16 v[68:71], v[32:35], v[176:183], v126
v_smfmac_f32_16x16x64_bf16 v[72:75], v[32:35], v[184:191], v126
s_waitcnt lgkmcnt(0)
s_barrier
ds_read_b64 v[100:101], v24 offset:0
ds_read_b64 v[102:103], v24 offset:2560
ds_read_b64 v[104:105], v24 offset:5120
ds_read_b64 v[106:107], v24 offset:7680
v_smfmac_f32_16x16x64_bf16 v[68:71], v[36:39], v[208:215], v126
v_smfmac_f32_16x16x64_bf16 v[72:75], v[36:39], v[216:223], v126
v_smfmac_f32_16x16x64_bf16 v[68:71], v[40:43], v[240:247], v126
s_waitcnt lgkmcnt(0)
v_pk_add_f32 v[100:101], v[100:101], v[102:103]
v_pk_add_f32 v[104:105], v[104:105], v[106:107]
v_pk_add_f32 v[116:117], v[100:101], v[104:105]
v_cvt_pk_bf16_f32 v116, v116, v117
v_min_u32 v116, -2, v116
buffer_store_dword v116, v11, s[4:7], s40 offen
v_smfmac_f32_16x16x64_bf16 v[72:75], v[40:43], v[248:255], v126
s_nop 5
v_add_f32 v92, v60, v61
v_add_f32 v93, v62, v63
v_add_f32 v94, v64, v65
v_add_f32 v95, v66, v67
v_add_f32 v96, v68, v69
v_add_f32 v97, v70, v71
v_add_f32 v98, v72, v73
v_add_f32 v99, v74, v75
ds_write_b128 v25, v[92:95] offset:20480
ds_write_b128 v25, v[96:99] offset:20496
s_waitcnt lgkmcnt(0)
s_barrier
ds_read_b64 v[100:101], v127 offset:20480
ds_read_b64 v[102:103], v127 offset:22528
ds_read_b64 v[104:105], v127 offset:24576
ds_read_b64 v[106:107], v127 offset:26624
s_waitcnt lgkmcnt(0)
v_pk_add_f32 v[100:101], v[100:101], v[102:103]
v_pk_add_f32 v[104:105], v[104:105], v[106:107]
v_pk_add_f32 v[116:117], v[100:101], v[104:105]
v_cvt_pk_bf16_f32 v116, v116, v117
v_min_u32 v116, -2, v116
buffer_store_dword v116, v27, s[4:7], s40 offen
s_cmp_eq_u32 s36, 63
s_cbranch_scc1 Lend_1
buffer_store_dword v120, v11, s[4:7], s42 offen
buffer_store_dword v120, v27, s[4:7], s42 offen
s_cmp_lt_u32 s32, 2
s_cbranch_scc1 Lr1_285
buffer_store_dwordx2 v[120:121], v10, s[4:7], s42 offen
Lr1_285:
v_pk_mul_f32 v[44:45], 0, 0
v_pk_mul_f32 v[46:47], 0, 0
v_pk_mul_f32 v[48:49], 0, 0
v_pk_mul_f32 v[50:51], 0, 0
v_pk_mul_f32 v[52:53], 0, 0
v_pk_mul_f32 v[54:55], 0, 0
v_pk_mul_f32 v[56:57], 0, 0
v_pk_mul_f32 v[58:59], 0, 0
v_pk_mul_f32 v[60:61], 0, 0
v_pk_mul_f32 v[62:63], 0, 0
v_pk_mul_f32 v[64:65], 0, 0
v_pk_mul_f32 v[66:67], 0, 0
v_pk_mul_f32 v[68:69], 0, 0
v_pk_mul_f32 v[70:71], 0, 0
v_pk_mul_f32 v[72:73], 0, 0
v_pk_mul_f32 v[74:75], 0, 0
v_pk_mul_f32 v[76:77], 0, 0
v_pk_mul_f32 v[78:79], 0, 0
v_pk_mul_f32 v[80:81], 0, 0
v_pk_mul_f32 v[82:83], 0, 0
v_pk_mul_f32 v[84:85], 0, 0
v_pk_mul_f32 v[86:87], 0, 0
v_pk_mul_f32 v[88:89], 0, 0
v_pk_mul_f32 v[90:91], 0, 0
v_add_u32 v7, 1, v7
s_and_b32 s38, s36, 3
s_lshl_b32 s84, s38, 18
s_add_u32 s84, s84, s46
s_add_u32 s85, s84, 0x100000
s_and_b32 s38, s26, 3
s_lshl_b32 s38, s38, 16
s_add_u32 s41, s38, s45
s_mov_b64 exec, 3
buffer_load_dword v4, v2, s[4:7], s59 offen sc1
s_nop 11
buffer_load_dword v5, v2, s[4:7], s59 offen sc1
s_nop 11
buffer_load_dword v6, v2, s[4:7], s59 offen sc1
Lft_287:
s_waitcnt vmcnt(2)
v_cmp_gt_u32 vcc, s26, v4
s_cbranch_vccz Lfg_286
buffer_load_dword v4, v2, s[4:7], s59 offen sc1
s_waitcnt vmcnt(2)
v_cmp_gt_u32 vcc, s26, v5
s_cbranch_vccz Lfg_286
buffer_load_dword v5, v2, s[4:7], s59 offen sc1
s_waitcnt vmcnt(2)
v_cmp_gt_u32 vcc, s26, v6
s_cbranch_vccz Lfg_286
buffer_load_dword v6, v2, s[4:7], s59 offen sc1
s_sub_u32 s37, s37, 1
s_cbranch_scc1 Lend_1
s_branch Lft_287
Lfg_286:
s_mov_b64 exec, -1
buffer_load_dwordx4 v[28:31], v9, s[4:7], s40 offen offset:0 sc1
v_mfma_f32_16x16x32_bf16 v[16:19], v[20:23], v[20:23], 0
v_mfma_f32_16x16x32_bf16 v[16:19], v[20:23], v[20:23], 0
v_mfma_f32_16x16x32_bf16 v[16:19], v[20:23], v[20:23], 0
v_mfma_f32_16x16x32_bf16 v[16:19], v[20:23], v[20:23], 0
buffer_load_dwordx4 v[32:35], v9, s[4:7], s40 offen offset:1024 sc1
v_mfma_f32_16x16x32_bf16 v[16:19], v[20:23], v[20:23], 0
v_mfma_f32_16x16x32_bf16 v[16:19], v[20:23], v[20:23], 0
v_mfma_f32_16x16x32_bf16 v[16:19], v[20:23], v[20:23], 0
v_mfma_f32_16x16x32_bf16 v[16:19], v[20:23], v[20:23], 0
buffer_load_dwordx4 v[36:39], v9, s[4:7], s40 offen offset:2048 sc1
v_mfma_f32_16x16x32_bf16 v[16:19], v[20:23], v[20:23], 0
v_mfma_f32_16x16x32_bf16 v[16:19], v[20:23], v[20:23], 0
v_mfma_f32_16x16x32_bf16 v[16:19], v[20:23], v[20:23], 0
v_mfma_f32_16x16x32_bf16 v[16:19], v[20:23], v[20:23], 0
buffer_load_dwordx4 v[40:43], v9, s[4:7], s40 offen offset:3072 sc1
v_mfma_f32_16x16x32_bf16 v[16:19], v[20:23], v[20:23], 0
s_waitcnt vmcnt(3)
v_max3_u32 v26, v28, v29, v30
v_max_u32 v26, v26, v31
v_cmp_eq_u32 vcc, -1, v26
s_cbranch_vccnz Lpf_289
v_smfmac_f32_16x16x64_bf16 v[76:79], v[28:31], a[128:135], v126
v_smfmac_f32_16x16x64_bf16 v[80:83], v[28:31], a[136:143], v126
s_waitcnt vmcnt(2)
v_max3_u32 v26, v32, v33, v34
v_max_u32 v26, v26, v35
v_cmp_eq_u32 vcc, -1, v26
v_smfmac_f32_16x16x64_bf16 v[84:87], v[28:31], a[144:151], v126
v_smfmac_f32_16x16x64_bf16 v[88:91], v[28:31], a[152:159], v126
s_cbranch_vccnz Lpf_290
v_smfmac_f32_16x16x64_bf16 v[76:79], v[32:35], a[160:167], v126
v_smfmac_f32_16x16x64_bf16 v[80:83], v[32:35], a[168:175], v126
s_waitcnt vmcnt(1)
v_max3_u32 v26, v36, v37, v38
v_max_u32 v26, v26, v39
v_cmp_eq_u32 vcc, -1, v26
v_smfmac_f32_16x16x64_bf16 v[84:87], v[32:35], a[176:183], v126
v_smfmac_f32_16x16x64_bf16 v[88:91], v[32:35], a[184:191], v126
s_cbranch_vccnz Lpf_291
v_smfmac_f32_16x16x64_bf16 v[76:79], v[36:39], a[192:199], v126
v_smfmac_f32_16x16x64_bf16 v[80:83], v[36:39], a[200:207], v126
s_waitcnt vmcnt(0)
v_max3_u32 v26, v40, v41, v42
v_max_u32 v26, v26, v43
v_cmp_eq_u32 vcc, -1, v26
v_smfmac_f32_16x16x64_bf16 v[84:87], v[36:39], a[208:215], v126
v_smfmac_f32_16x16x64_bf16 v[88:91], v[36:39], a[216:223], v126
s_cbranch_vccnz Lpf_292
v_smfmac_f32_16x16x64_bf16 v[76:79], v[40:43], a[224:231], v126
v_smfmac_f32_16x16x64_bf16 v[80:83], v[40:43], a[232:239], v126
v_smfmac_f32_16x16x64_bf16 v[84:87], v[40:43], a[240:247], v126
v_smfmac_f32_16x16x64_bf16 v[88:91], v[40:43], a[248:255], v126
Lpd_288:
s_nop 4
v_add_f32 v92, v76, v77
v_add_f32 v93, v78, v79
v_add_f32 v94, v80, v81
v_add_f32 v95, v82, v83
v_add_f32 v96, v84, v85
ds_write_addtid_b32 v92 offset:10240
v_add_f32 v97, v86, v87
ds_write_addtid_b32 v93 offset:10528
v_add_f32 v98, v88, v89
ds_write_addtid_b32 v94 offset:10816
v_add_f32 v99, v90, v91
ds_write_addtid_b32 v95 offset:11104
ds_write_addtid_b32 v96 offset:11392
ds_write_addtid_b32 v97 offset:11680
ds_write_addtid_b32 v98 offset:11968
ds_write_addtid_b32 v99 offset:12256
v_mfma_f32_16x16x32_bf16 v[16:19], v[20:23], v[20:23], 0
v_mfma_f32_16x16x32_bf16 v[16:19], v[20:23], v[20:23], 0
s_cmp_ge_u32 s32, 2
s_cbranch_scc1 Lxl_293
s_waitcnt lgkmcnt(0)
s_barrier
ds_read_b64 v[100:101], v0 offset:10240
ds_read_b64 v[102:103], v0 offset:10816
ds_read_b64 v[104:105], v0 offset:12800
ds_read_b64 v[106:107], v0 offset:13376
ds_read_b64 v[108:109], v0 offset:15360
ds_read_b64 v[110:111], v0 offset:15936
ds_read_b64 v[112:113], v0 offset:17920
ds_read_b64 v[114:115], v0 offset:18496
s_waitcnt lgkmcnt(4)
v_pk_add_f32 v[100:101], v[100:101], v[104:105]
v_pk_add_f32 v[102:103], v[102:103], v[106:107]
s_waitcnt lgkmcnt(0)
v_pk_add_f32 v[108:109], v[108:109], v[112:113]
v_pk_add_f32 v[110:111], v[110:111], v[114:115]
v_pk_add_f32 v[116:117], v[100:101], v[108:109]
v_pk_add_f32 v[118:119], v[102:103], v[110:111]
v_cvt_pk_bf16_f32 v116, v116, v117
v_cvt_pk_bf16_f32 v117, v118, v119
v_min_u32 v116, -2, v116
v_min_u32 v117, -2, v117
buffer_store_dwordx2 v[116:117], v12, s[4:7], s84 offen sc1
buffer_store_dwordx2 v[116:117], v12, s[4:7], s85 offen sc1
v_mfma_f32_16x16x32_bf16 v[16:19], v[20:23], v[20:23], 0
v_mfma_f32_16x16x32_bf16 v[16:19], v[20:23], v[20:23], 0
v_mfma_f32_16x16x32_bf16 v[16:19], v[20:23], v[20:23], 0
v_mfma_f32_16x16x32_bf16 v[16:19], v[20:23], v[20:23], 0
v_mfma_f32_16x16x32_bf16 v[16:19], v[20:23], v[20:23], 0
v_mfma_f32_16x16x32_bf16 v[16:19], v[20:23], v[20:23], 0
v_mfma_f32_16x16x32_bf16 v[16:19], v[20:23], v[20:23], 0
v_mfma_f32_16x16x32_bf16 v[16:19], v[20:23], v[20:23], 0
v_mfma_f32_16x16x32_bf16 v[16:19], v[20:23], v[20:23], 0
v_mfma_f32_16x16x32_bf16 v[16:19], v[20:23], v[20:23], 0
v_mfma_f32_16x16x32_bf16 v[16:19], v[20:23], v[20:23], 0
v_mfma_f32_16x16x32_bf16 v[16:19], v[20:23], v[20:23], 0
v_mfma_f32_16x16x32_bf16 v[16:19], v[20:23], v[20:23], 0
v_mfma_f32_16x16x32_bf16 v[16:19], v[20:23], v[20:23], 0
v_mfma_f32_16x16x32_bf16 v[16:19], v[20:23], v[20:23], 0
v_mfma_f32_16x16x32_bf16 v[16:19], v[20:23], v[20:23], 0
v_mfma_f32_16x16x32_bf16 v[16:19], v[20:23], v[20:23], 0
v_mfma_f32_16x16x32_bf16 v[16:19], v[20:23], v[20:23], 0
v_mfma_f32_16x16x32_bf16 v[16:19], v[20:23], v[20:23], 0
v_mfma_f32_16x16x32_bf16 v[16:19], v[20:23], v[20:23], 0
v_mfma_f32_16x16x32_bf16 v[16:19], v[20:23], v[20:23], 0
v_mfma_f32_16x16x32_bf16 v[16:19], v[20:23], v[20:23], 0
v_mfma_f32_16x16x32_bf16 v[16:19], v[20:23], v[20:23], 0
v_mfma_f32_16x16x32_bf16 v[16:19], v[20:23], v[20:23], 0
v_mfma_f32_16x16x32_bf16 v[16:19], v[20:23], v[20:23], 0
v_mfma_f32_16x16x32_bf16 v[16:19], v[20:23], v[20:23], 0
v_mfma_f32_16x16x32_bf16 v[16:19], v[20:23], v[20:23], 0
v_mfma_f32_16x16x32_bf16 v[16:19], v[20:23], v[20:23], 0
v_mfma_f32_16x16x32_bf16 v[16:19], v[20:23], v[20:23], 0
v_mfma_f32_16x16x32_bf16 v[16:19], v[20:23], v[20:23], 0
v_mfma_f32_16x16x32_bf16 v[16:19], v[20:23], v[20:23], 0
v_mfma_f32_16x16x32_bf16 v[16:19], v[20:23], v[20:23], 0
v_mfma_f32_16x16x32_bf16 v[16:19], v[20:23], v[20:23], 0
v_mfma_f32_16x16x32_bf16 v[16:19], v[20:23], v[20:23], 0
v_mfma_f32_16x16x32_bf16 v[16:19], v[20:23], v[20:23], 0
v_mfma_f32_16x16x32_bf16 v[16:19], v[20:23], v[20:23], 0
buffer_store_dword v7, v3, s[4:7], s59 offen
s_add_u32 s36, s36, 1
s_branch Lkvo_275
Lxl_293:
s_waitcnt lgkmcnt(0)
s_barrier
v_mfma_f32_16x16x32_bf16 v[16:19], v[20:23], v[20:23], 0
v_mfma_f32_16x16x32_bf16 v[16:19], v[20:23], v[20:23], 0
v_mfma_f32_16x16x32_bf16 v[16:19], v[20:23], v[20:23], 0
v_mfma_f32_16x16x32_bf16 v[16:19], v[20:23], v[20:23], 0
v_mfma_f32_16x16x32_bf16 v[16:19], v[20:23], v[20:23], 0
v_mfma_f32_16x16x32_bf16 v[16:19], v[20:23], v[20:23], 0
v_mfma_f32_16x16x32_bf16 v[16:19], v[20:23], v[20:23], 0
v_mfma_f32_16x16x32_bf16 v[16:19], v[20:23], v[20:23], 0
v_mfma_f32_16x16x32_bf16 v[16:19], v[20:23], v[20:23], 0
v_mfma_f32_16x16x32_bf16 v[16:19], v[20:23], v[20:23], 0
v_mfma_f32_16x16x32_bf16 v[16:19], v[20:23], v[20:23], 0
v_mfma_f32_16x16x32_bf16 v[16:19], v[20:23], v[20:23], 0
v_mfma_f32_16x16x32_bf16 v[16:19], v[20:23], v[20:23], 0
v_mfma_f32_16x16x32_bf16 v[16:19], v[20:23], v[20:23], 0
v_mfma_f32_16x16x32_bf16 v[16:19], v[20:23], v[20:23], 0
v_mfma_f32_16x16x32_bf16 v[16:19], v[20:23], v[20:23], 0
v_mfma_f32_16x16x32_bf16 v[16:19], v[20:23], v[20:23], 0
v_mfma_f32_16x16x32_bf16 v[16:19], v[20:23], v[20:23], 0
v_mfma_f32_16x16x32_bf16 v[16:19], v[20:23], v[20:23], 0
v_mfma_f32_16x16x32_bf16 v[16:19], v[20:23], v[20:23], 0
v_mfma_f32_16x16x32_bf16 v[16:19], v[20:23], v[20:23], 0
v_mfma_f32_16x16x32_bf16 v[16:19], v[20:23], v[20:23], 0
v_mfma_f32_16x16x32_bf16 v[16:19], v[20:23], v[20:23], 0
v_mfma_f32_16x16x32_bf16 v[16:19], v[20:23], v[20:23], 0
v_mfma_f32_16x16x32_bf16 v[16:19], v[20:23], v[20:23], 0
v_mfma_f32_16x16x32_bf16 v[16:19], v[20:23], v[20:23], 0
v_mfma_f32_16x16x32_bf16 v[16:19], v[20:23], v[20:23], 0
v_mfma_f32_16x16x32_bf16 v[16:19], v[20:23], v[20:23], 0
buffer_load_dwordx2 v[76:77], v13, s[4:7], s84 offen sc1
buffer_load_dwordx2 v[78:79], v14, s[4:7], s84 offen sc1
buffer_load_dwordx2 v[80:81], v15, s[4:7], s84 offen sc1
v_mfma_f32_16x16x32_bf16 v[16:19], v[20:23], v[20:23], 0
v_mfma_f32_16x16x32_bf16 v[16:19], v[20:23], v[20:23], 0
v_mfma_f32_16x16x32_bf16 v[16:19], v[20:23], v[20:23], 0
v_mfma_f32_16x16x32_bf16 v[16:19], v[20:23], v[20:23], 0
v_mfma_f32_16x16x32_bf16 v[16:19], v[20:23], v[20:23], 0
v_mfma_f32_16x16x32_bf16 v[16:19], v[20:23], v[20:23], 0
v_mfma_f32_16x16x32_bf16 v[16:19], v[20:23], v[20:23], 0
v_mfma_f32_16x16x32_bf16 v[16:19], v[20:23], v[20:23], 0
v_mfma_f32_16x16x32_bf16 v[16:19], v[20:23], v[20:23], 0
v_mfma_f32_16x16x32_bf16 v[16:19], v[20:23], v[20:23], 0
v_mfma_f32_16x16x32_bf16 v[16:19], v[20:23], v[20:23], 0
v_mfma_f32_16x16x32_bf16 v[16:19], v[20:23], v[20:23], 0
buffer_load_dwordx2 v[88:89], v13, s[4:7], s85 offen sc1
buffer_load_dwordx2 v[90:91], v14, s[4:7], s85 offen sc1
buffer_load_dwordx2 v[92:93], v15, s[4:7], s85 offen sc1
ds_read_b64 v[100:101], v0 offset:10240
ds_read_b64 v[102:103], v0 offset:10816
ds_read_b64 v[104:105], v0 offset:12800
ds_read_b64 v[106:107], v0 offset:13376
ds_read_b64 v[108:109], v0 offset:15360
ds_read_b64 v[110:111], v0 offset:15936
ds_read_b64 v[112:113], v0 offset:17920
ds_read_b64 v[114:115], v0 offset:18496
s_waitcnt lgkmcnt(4)
v_pk_add_f32 v[100:101], v[100:101], v[104:105]
v_pk_add_f32 v[102:103], v[102:103], v[106:107]
s_waitcnt lgkmcnt(0)
v_pk_add_f32 v[108:109], v[108:109], v[112:113]
v_pk_add_f32 v[110:111], v[110:111], v[114:115]
v_pk_add_f32 v[116:117], v[100:101], v[108:109]
v_pk_add_f32 v[118:119], v[102:103], v[110:111]
v_cvt_pk_bf16_f32 v100, v116, v117
v_cvt_pk_bf16_f32 v101, v118, v119
v_lshlrev_b32 v116, 16, v100
v_and_b32 v117, 0xffff0000, v100
v_lshlrev_b32 v118, 16, v101
v_and_b32 v119, 0xffff0000, v101
v_mfma_f32_16x16x32_bf16 v[16:19], v[20:23], v[20:23], 0
v_mfma_f32_16x16x32_bf16 v[16:19], v[20:23], v[20:23], 0
v_mfma_f32_16x16x32_bf16 v[16:19], v[20:23], v[20:23], 0
v_mfma_f32_16x16x32_bf16 v[16:19], v[20:23], v[20:23], 0
buffer_load_dwordx2 v[28:29], v13, s[4:7], s84 offen sc1
buffer_load_dwordx2 v[30:31], v14, s[4:7], s84 offen sc1
buffer_load_dwordx2 v[32:33], v15, s[4:7], s84 offen sc1
s_waitcnt vmcnt(6)
v_max3_u32 v26, v76, v77, v78
v_max3_u32 v26, v26, v79, v80
v_max_u32 v26, v26, v81
v_cmp_eq_u32 vcc, -1, v26
v_dot2_f32_bf16 v100, v76, s55, v116
v_dot2_f32_bf16 v101, v76, s56, v117
v_dot2_f32_bf16 v102, v77, s55, v118
v_dot2_f32_bf16 v103, v77, s56, v119
v_dot2_f32_bf16 v100, v78, s55, v100
v_dot2_f32_bf16 v101, v78, s56, v101
v_dot2_f32_bf16 v102, v79, s55, v102
v_dot2_f32_bf16 v103, v79, s56, v103
v_dot2_f32_bf16 v100, v80, s55, v100
v_dot2_f32_bf16 v101, v80, s56, v101
v_dot2_f32_bf16 v102, v81, s55, v102
v_dot2_f32_bf16 v103, v81, s56, v103
s_nop 1
v_cvt_pk_bf16_f32 v100, v100, v101
v_cvt_pk_bf16_f32 v101, v102, v103
v_min_u32 v100, -2, v100
v_min_u32 v101, -2, v101
s_cbranch_vccnz Lx2_294
Lxs_295:
buffer_store_dwordx2 v[100:101], v10, s[4:7], s41 offen
s_add_u32 s36, s36, 1
s_and_b32 s38, s36, 3
s_lshl_b32 s39, s38, 16
s_add_u32 s40, s39, s45
s_xor_b32 s42, s40, 0x20000
s_add_u32 s26, s36, 1
v_mfma_f32_16x16x32_bf16 v[16:19], v[20:23], v[20:23], 0
v_mfma_f32_16x16x32_bf16 v[16:19], v[20:23], v[20:23], 0
v_mfma_f32_16x16x32_bf16 v[16:19], v[20:23], v[20:23], 0
v_mfma_f32_16x16x32_bf16 v[16:19], v[20:23], v[20:23], 0
v_mfma_f32_16x16x32_bf16 v[16:19], v[20:23], v[20:23], 0
v_mfma_f32_16x16x32_bf16 v[16:19], v[20:23], v[20:23], 0
v_mfma_f32_16x16x32_bf16 v[16:19], v[20:23], v[20:23], 0
v_mfma_f32_16x16x32_bf16 v[16:19], v[20:23], v[20:23], 0
s_branch Lkvo3_277
Lx2_294:
buffer_load_dwordx2 v[76:77], v13, s[4:7], s85 offen sc1
buffer_load_dwordx2 v[78:79], v14, s[4:7], s85 offen sc1
buffer_load_dwordx2 v[80:81], v15, s[4:7], s85 offen sc1
s_waitcnt vmcnt(6)
v_max3_u32 v26, v88, v89, v90
v_max3_u32 v26, v26, v91, v92
v_max_u32 v26, v26, v93
v_cmp_eq_u32 vcc, -1, v26
v_dot2_f32_bf16 v100, v88, s55, v116
v_dot2_f32_bf16 v101, v88, s56, v117
v_dot2_f32_bf16 v102, v89, s55, v118
v_dot2_f32_bf16 v103, v89, s56, v119
v_dot2_f32_bf16 v100, v90, s55, v100
v_dot2_f32_bf16 v101, v90, s56, v101
v_dot2_f32_bf16 v102, v91, s55, v102
v_dot2_f32_bf16 v103, v91, s56, v103
v_dot2_f32_bf16 v100, v92, s55, v100
v_dot2_f32_bf16 v101, v92, s56, v101
v_dot2_f32_bf16 v102, v93, s55, v102
v_dot2_f32_bf16 v103, v93, s56, v103
s_nop 1
v_cvt_pk_bf16_f32 v100, v100, v101
v_cvt_pk_bf16_f32 v101, v102, v103
v_min_u32 v100, -2, v100
v_min_u32 v101, -2, v101
s_cbranch_vccz Lxs_295
buffer_load_dwordx2 v[88:89], v13, s[4:7], s84 offen sc1
buffer_load_dwordx2 v[90:91], v14, s[4:7], s84 offen sc1
buffer_load_dwordx2 v[92:93], v15, s[4:7], s84 offen sc1
s_waitcnt vmcnt(6)
v_max3_u32 v26, v28, v29, v30
v_max3_u32 v26, v26, v31, v32
v_max_u32 v26, v26, v33
v_cmp_eq_u32 vcc, -1, v26
v_dot2_f32_bf16 v100, v28, s55, v116
v_dot2_f32_bf16 v101, v28, s56, v117
v_dot2_f32_bf16 v102, v29, s55, v118
v_dot2_f32_bf16 v103, v29, s56, v119
v_dot2_f32_bf16 v100, v30, s55, v100
v_dot2_f32_bf16 v101, v30, s56, v101
v_dot2_f32_bf16 v102, v31, s55, v102
v_dot2_f32_bf16 v103, v31, s56, v103
v_dot2_f32_bf16 v100, v32, s55, v100
v_dot2_f32_bf16 v101, v32, s56, v101
v_dot2_f32_bf16 v102, v33, s55, v102
v_dot2_f32_bf16 v103, v33, s56, v103
s_nop 1
v_cvt_pk_bf16_f32 v100, v100, v101
v_cvt_pk_bf16_f32 v101, v102, v103
v_min_u32 v100, -2, v100
v_min_u32 v101, -2, v101
s_cbranch_vccz Lxs_295
buffer_load_dwordx2 v[28:29], v13, s[4:7], s85 offen sc1
buffer_load_dwordx2 v[30:31], v14, s[4:7], s85 offen sc1
buffer_load_dwordx2 v[32:33], v15, s[4:7], s85 offen sc1
s_waitcnt vmcnt(6)
v_max3_u32 v26, v76, v77, v78
v_max3_u32 v26, v26, v79, v80
v_max_u32 v26, v26, v81
v_cmp_eq_u32 vcc, -1, v26
v_dot2_f32_bf16 v100, v76, s55, v116
v_dot2_f32_bf16 v101, v76, s56, v117
v_dot2_f32_bf16 v102, v77, s55, v118
v_dot2_f32_bf16 v103, v77, s56, v119
v_dot2_f32_bf16 v100, v78, s55, v100
v_dot2_f32_bf16 v101, v78, s56, v101
v_dot2_f32_bf16 v102, v79, s55, v102
v_dot2_f32_bf16 v103, v79, s56, v103
v_dot2_f32_bf16 v100, v80, s55, v100
v_dot2_f32_bf16 v101, v80, s56, v101
v_dot2_f32_bf16 v102, v81, s55, v102
v_dot2_f32_bf16 v103, v81, s56, v103
s_nop 1
v_cvt_pk_bf16_f32 v100, v100, v101
v_cvt_pk_bf16_f32 v101, v102, v103
v_min_u32 v100, -2, v100
v_min_u32 v101, -2, v101
s_cbranch_vccz Lxs_295
buffer_load_dwordx2 v[76:77], v13, s[4:7], s84 offen sc1
buffer_load_dwordx2 v[78:79], v14, s[4:7], s84 offen sc1
buffer_load_dwordx2 v[80:81], v15, s[4:7], s84 offen sc1
s_waitcnt vmcnt(6)
v_max3_u32 v26, v88, v89, v90
v_max3_u32 v26, v26, v91, v92
v_max_u32 v26, v26, v93
v_cmp_eq_u32 vcc, -1, v26
v_dot2_f32_bf16 v100, v88, s55, v116
v_dot2_f32_bf16 v101, v88, s56, v117
v_dot2_f32_bf16 v102, v89, s55, v118
v_dot2_f32_bf16 v103, v89, s56, v119
v_dot2_f32_bf16 v100, v90, s55, v100
v_dot2_f32_bf16 v101, v90, s56, v101
v_dot2_f32_bf16 v102, v91, s55, v102
v_dot2_f32_bf16 v103, v91, s56, v103
v_dot2_f32_bf16 v100, v92, s55, v100
v_dot2_f32_bf16 v101, v92, s56, v101
v_dot2_f32_bf16 v102, v93, s55, v102
v_dot2_f32_bf16 v103, v93, s56, v103
s_nop 1
v_cvt_pk_bf16_f32 v100, v100, v101
v_cvt_pk_bf16_f32 v101, v102, v103
v_min_u32 v100, -2, v100
v_min_u32 v101, -2, v101
s_cbranch_vccz Lxs_295
buffer_load_dwordx2 v[88:89], v13, s[4:7], s85 offen sc1
buffer_load_dwordx2 v[90:91], v14, s[4:7], s85 offen sc1
buffer_load_dwordx2 v[92:93], v15, s[4:7], s85 offen sc1
s_waitcnt vmcnt(6)
v_max3_u32 v26, v28, v29, v30
v_max3_u32 v26, v26, v31, v32
v_max_u32 v26, v26, v33
v_cmp_eq_u32 vcc, -1, v26
v_dot2_f32_bf16 v100, v28, s55, v116
v_dot2_f32_bf16 v101, v28, s56, v117
v_dot2_f32_bf16 v102, v29, s55, v118
v_dot2_f32_bf16 v103, v29, s56, v119
v_dot2_f32_bf16 v100, v30, s55, v100
v_dot2_f32_bf16 v101, v30, s56, v101
v_dot2_f32_bf16 v102, v31, s55, v102
v_dot2_f32_bf16 v103, v31, s56, v103
v_dot2_f32_bf16 v100, v32, s55, v100
v_dot2_f32_bf16 v101, v32, s56, v101
v_dot2_f32_bf16 v102, v33, s55, v102
v_dot2_f32_bf16 v103, v33, s56, v103
s_nop 1
v_cvt_pk_bf16_f32 v100, v100, v101
v_cvt_pk_bf16_f32 v101, v102, v103
v_min_u32 v100, -2, v100
v_min_u32 v101, -2, v101
s_cbranch_vccz Lxs_295
buffer_load_dwordx2 v[28:29], v13, s[4:7], s84 offen sc1
buffer_load_dwordx2 v[30:31], v14, s[4:7], s84 offen sc1
buffer_load_dwordx2 v[32:33], v15, s[4:7], s84 offen sc1
s_waitcnt vmcnt(6)
v_max3_u32 v26, v76, v77, v78
v_max3_u32 v26, v26, v79, v80
v_max_u32 v26, v26, v81
v_cmp_eq_u32 vcc, -1, v26
v_dot2_f32_bf16 v100, v76, s55, v116
v_dot2_f32_bf16 v101, v76, s56, v117
v_dot2_f32_bf16 v102, v77, s55, v118
v_dot2_f32_bf16 v103, v77, s56, v119
v_dot2_f32_bf16 v100, v78, s55, v100
v_dot2_f32_bf16 v101, v78, s56, v101
v_dot2_f32_bf16 v102, v79, s55, v102
v_dot2_f32_bf16 v103, v79, s56, v103
v_dot2_f32_bf16 v100, v80, s55, v100
v_dot2_f32_bf16 v101, v80, s56, v101
v_dot2_f32_bf16 v102, v81, s55, v102
v_dot2_f32_bf16 v103, v81, s56, v103
s_nop 1
v_cvt_pk_bf16_f32 v100, v100, v101
v_cvt_pk_bf16_f32 v101, v102, v103
v_min_u32 v100, -2, v100
v_min_u32 v101, -2, v101
s_cbranch_vccz Lxs_295
s_sub_u32 s37, s37, 1
s_cbranch_scc1 Lend_1
s_branch Lx2_294
Lpf_281:
buffer_load_dwordx4 v[28:31], v8, s[4:7], s40 offen offset:0 sc1
v_mfma_f32_16x16x32_bf16 v[16:19], v[20:23], v[20:23], 0
s_sub_u32 s37, s37, 1
s_cbranch_scc1 Lend_1
Lps_296:
s_waitcnt vmcnt(3)
v_max3_u32 v26, v32, v33, v34
v_max_u32 v26, v26, v35
v_cmp_eq_u32 vcc, -1, v26
s_cbranch_vccnz Lpf_297
v_smfmac_f32_16x16x64_bf16 v[44:47], v[32:35], a[32:39], v126
v_smfmac_f32_16x16x64_bf16 v[48:51], v[32:35], a[40:47], v126
v_smfmac_f32_16x16x64_bf16 v[52:55], v[32:35], a[48:55], v126
v_smfmac_f32_16x16x64_bf16 v[56:59], v[32:35], a[56:63], v126
v_smfmac_f32_16x16x64_bf16 v[60:63], v[32:35], v[160:167], v126
v_smfmac_f32_16x16x64_bf16 v[64:67], v[32:35], v[168:175], v126
Lps_298:
s_waitcnt vmcnt(2)
v_max3_u32 v26, v36, v37, v38
v_max_u32 v26, v26, v39
v_cmp_eq_u32 vcc, -1, v26
s_cbranch_vccnz Lpf_299
v_smfmac_f32_16x16x64_bf16 v[44:47], v[36:39], a[64:71], v126
v_smfmac_f32_16x16x64_bf16 v[48:51], v[36:39], a[72:79], v126
v_smfmac_f32_16x16x64_bf16 v[52:55], v[36:39], a[80:87], v126
v_smfmac_f32_16x16x64_bf16 v[56:59], v[36:39], a[88:95], v126
v_smfmac_f32_16x16x64_bf16 v[60:63], v[36:39], v[192:199], v126
v_smfmac_f32_16x16x64_bf16 v[64:67], v[36:39], v[200:207], v126
Lps_300:
s_waitcnt vmcnt(1)
v_max3_u32 v26, v40, v41, v42
v_max_u32 v26, v26, v43
v_cmp_eq_u32 vcc, -1, v26
s_cbranch_vccnz Lpf_301
v_smfmac_f32_16x16x64_bf16 v[44:47], v[40:43], a[96:103], v126
v_smfmac_f32_16x16x64_bf16 v[48:51], v[40:43], a[104:111], v126
v_smfmac_f32_16x16x64_bf16 v[52:55], v[40:43], a[112:119], v126
v_smfmac_f32_16x16x64_bf16 v[56:59], v[40:43], a[120:127], v126
v_smfmac_f32_16x16x64_bf16 v[60:63], v[40:43], v[224:231], v126
v_smfmac_f32_16x16x64_bf16 v[64:67], v[40:43], v[232:239], v126
Lps_302:
s_waitcnt vmcnt(0)
v_max3_u32 v26, v28, v29, v30
v_max_u32 v26, v26, v31
v_cmp_eq_u32 vcc, -1, v26
s_cbranch_vccnz Lpf_303
v_smfmac_f32_16x16x64_bf16 v[44:47], v[28:31], a[0:7], v126
v_smfmac_f32_16x16x64_bf16 v[48:51], v[28:31], a[8:15], v126
v_smfmac_f32_16x16x64_bf16 v[52:55], v[28:31], a[16:23], v126
v_smfmac_f32_16x16x64_bf16 v[56:59], v[28:31], a[24:31], v126
v_smfmac_f32_16x16x64_bf16 v[60:63], v[28:31], v[128:135], v126
v_smfmac_f32_16x16x64_bf16 v[64:67], v[28:31], v[136:143], v126
s_branch Lpd_280
Lpf_282:
buffer_load_dwordx4 v[32:35], v8, s[4:7], s40 offen offset:1024 sc1
v_mfma_f32_16x16x32_bf16 v[16:19], v[20:23], v[20:23], 0
s_sub_u32 s37, s37, 1
s_cbranch_scc1 Lend_1
Lps_304:
s_waitcnt vmcnt(2)
v_max3_u32 v26, v36, v37, v38
v_max_u32 v26, v26, v39
v_cmp_eq_u32 vcc, -1, v26
s_cbranch_vccnz Lpf_305
v_smfmac_f32_16x16x64_bf16 v[44:47], v[36:39], a[64:71], v126
v_smfmac_f32_16x16x64_bf16 v[48:51], v[36:39], a[72:79], v126
v_smfmac_f32_16x16x64_bf16 v[52:55], v[36:39], a[80:87], v126
v_smfmac_f32_16x16x64_bf16 v[56:59], v[36:39], a[88:95], v126
v_smfmac_f32_16x16x64_bf16 v[60:63], v[36:39], v[192:199], v126
v_smfmac_f32_16x16x64_bf16 v[64:67], v[36:39], v[200:207], v126
Lps_306:
s_waitcnt vmcnt(1)
v_max3_u32 v26, v40, v41, v42
v_max_u32 v26, v26, v43
v_cmp_eq_u32 vcc, -1, v26
s_cbranch_vccnz Lpf_307
v_smfmac_f32_16x16x64_bf16 v[44:47], v[40:43], a[96:103], v126
v_smfmac_f32_16x16x64_bf16 v[48:51], v[40:43], a[104:111], v126
v_smfmac_f32_16x16x64_bf16 v[52:55], v[40:43], a[112:119], v126
v_smfmac_f32_16x16x64_bf16 v[56:59], v[40:43], a[120:127], v126
v_smfmac_f32_16x16x64_bf16 v[60:63], v[40:43], v[224:231], v126
v_smfmac_f32_16x16x64_bf16 v[64:67], v[40:43], v[232:239], v126
Lps_308:
s_waitcnt vmcnt(0)
v_max3_u32 v26, v32, v33, v34
v_max_u32 v26, v26, v35
v_cmp_eq_u32 vcc, -1, v26
s_cbranch_vccnz Lpf_309
v_smfmac_f32_16x16x64_bf16 v[44:47], v[32:35], a[32:39], v126
v_smfmac_f32_16x16x64_bf16 v[48:51], v[32:35], a[40:47], v126
v_smfmac_f32_16x16x64_bf16 v[52:55], v[32:35], a[48:55], v126
v_smfmac_f32_16x16x64_bf16 v[56:59], v[32:35], a[56:63], v126
v_smfmac_f32_16x16x64_bf16 v[60:63], v[32:35], v[160:167], v126
v_smfmac_f32_16x16x64_bf16 v[64:67], v[32:35], v[168:175], v126
s_branch Lpd_280
Lpf_283:
buffer_load_dwordx4 v[36:39], v8, s[4:7], s40 offen offset:2048 sc1
v_mfma_f32_16x16x32_bf16 v[16:19], v[20:23], v[20:23], 0
s_sub_u32 s37, s37, 1
s_cbranch_scc1 Lend_1
Lps_310:
s_waitcnt vmcnt(1)
v_max3_u32 v26, v40, v41, v42
v_max_u32 v26, v26, v43
v_cmp_eq_u32 vcc, -1, v26
s_cbranch_vccnz Lpf_311
v_smfmac_f32_16x16x64_bf16 v[44:47], v[40:43], a[96:103], v126
v_smfmac_f32_16x16x64_bf16 v[48:51], v[40:43], a[104:111], v126
v_smfmac_f32_16x16x64_bf16 v[52:55], v[40:43], a[112:119], v126
v_smfmac_f32_16x16x64_bf16 v[56:59], v[40:43], a[120:127], v126
v_smfmac_f32_16x16x64_bf16 v[60:63], v[40:43], v[224:231], v126
v_smfmac_f32_16x16x64_bf16 v[64:67], v[40:43], v[232:239], v126
Lps_312:
s_waitcnt vmcnt(0)
v_max3_u32 v26, v36, v37, v38
v_max_u32 v26, v26, v39
v_cmp_eq_u32 vcc, -1, v26
s_cbranch_vccnz Lpf_313
v_smfmac_f32_16x16x64_bf16 v[44:47], v[36:39], a[64:71], v126
v_smfmac_f32_16x16x64_bf16 v[48:51], v[36:39], a[72:79], v126
v_smfmac_f32_16x16x64_bf16 v[52:55], v[36:39], a[80:87], v126
v_smfmac_f32_16x16x64_bf16 v[56:59], v[36:39], a[88:95], v126
v_smfmac_f32_16x16x64_bf16 v[60:63], v[36:39], v[192:199], v126
v_smfmac_f32_16x16x64_bf16 v[64:67], v[36:39], v[200:207], v126
s_branch Lpd_280
Lpf_284:
buffer_load_dwordx4 v[40:43], v8, s[4:7], s40 offen offset:3072 sc1
v_mfma_f32_16x16x32_bf16 v[16:19], v[20:23], v[20:23], 0
s_sub_u32 s37, s37, 1
s_cbranch_scc1 Lend_1
Lps_314:
s_waitcnt vmcnt(0)
v_max3_u32 v26, v40, v41, v42
v_max_u32 v26, v26, v43
v_cmp_eq_u32 vcc, -1, v26
s_cbranch_vccnz Lpf_315
v_smfmac_f32_16x16x64_bf16 v[44:47], v[40:43], a[96:103], v126
v_smfmac_f32_16x16x64_bf16 v[48:51], v[40:43], a[104:111], v126
v_smfmac_f32_16x16x64_bf16 v[52:55], v[40:43], a[112:119], v126
v_smfmac_f32_16x16x64_bf16 v[56:59], v[40:43], a[120:127], v126
v_smfmac_f32_16x16x64_bf16 v[60:63], v[40:43], v[224:231], v126
v_smfmac_f32_16x16x64_bf16 v[64:67], v[40:43], v[232:239], v126
s_branch Lpd_280
Lpf_297:
buffer_load_dwordx4 v[32:35], v8, s[4:7], s40 offen offset:1024 sc1
v_mfma_f32_16x16x32_bf16 v[16:19], v[20:23], v[20:23], 0
Lps_316:
s_waitcnt vmcnt(3)
v_max3_u32 v26, v36, v37, v38
v_max_u32 v26, v26, v39
v_cmp_eq_u32 vcc, -1, v26
s_cbranch_vccnz Lpf_317
v_smfmac_f32_16x16x64_bf16 v[44:47], v[36:39], a[64:71], v126
v_smfmac_f32_16x16x64_bf16 v[48:51], v[36:39], a[72:79], v126
v_smfmac_f32_16x16x64_bf16 v[52:55], v[36:39], a[80:87], v126
v_smfmac_f32_16x16x64_bf16 v[56:59], v[36:39], a[88:95], v126
v_smfmac_f32_16x16x64_bf16 v[60:63], v[36:39], v[192:199], v126
v_smfmac_f32_16x16x64_bf16 v[64:67], v[36:39], v[200:207], v126
Lps_318:
s_waitcnt vmcnt(2)
v_max3_u32 v26, v40, v41, v42
v_max_u32 v26, v26, v43
v_cmp_eq_u32 vcc, -1, v26
s_cbranch_vccnz Lpf_319
v_smfmac_f32_16x16x64_bf16 v[44:47], v[40:43], a[96:103], v126
v_smfmac_f32_16x16x64_bf16 v[48:51], v[40:43], a[104:111], v126
v_smfmac_f32_16x16x64_bf16 v[52:55], v[40:43], a[112:119], v126
v_smfmac_f32_16x16x64_bf16 v[56:59], v[40:43], a[120:127], v126
v_smfmac_f32_16x16x64_bf16 v[60:63], v[40:43], v[224:231], v126
v_smfmac_f32_16x16x64_bf16 v[64:67], v[40:43], v[232:239], v126
Lps_320:
s_waitcnt vmcnt(1)
v_max3_u32 v26, v28, v29, v30
v_max_u32 v26, v26, v31
v_cmp_eq_u32 vcc, -1, v26
s_cbranch_vccnz Lpf_321
v_smfmac_f32_16x16x64_bf16 v[44:47], v[28:31], a[0:7], v126
v_smfmac_f32_16x16x64_bf16 v[48:51], v[28:31], a[8:15], v126
v_smfmac_f32_16x16x64_bf16 v[52:55], v[28:31], a[16:23], v126
v_smfmac_f32_16x16x64_bf16 v[56:59], v[28:31], a[24:31], v126
v_smfmac_f32_16x16x64_bf16 v[60:63], v[28:31], v[128:135], v126
v_smfmac_f32_16x16x64_bf16 v[64:67], v[28:31], v[136:143], v126
s_branch Lps_308
Lpf_299:
buffer_load_dwordx4 v[36:39], v8, s[4:7], s40 offen offset:2048 sc1
v_mfma_f32_16x16x32_bf16 v[16:19], v[20:23], v[20:23], 0
Lps_322:
s_waitcnt vmcnt(2)
v_max3_u32 v26, v40, v41, v42
v_max_u32 v26, v26, v43
v_cmp_eq_u32 vcc, -1, v26
s_cbranch_vccnz Lpf_323
v_smfmac_f32_16x16x64_bf16 v[44:47], v[40:43], a[96:103], v126
v_smfmac_f32_16x16x64_bf16 v[48:51], v[40:43], a[104:111], v126
v_smfmac_f32_16x16x64_bf16 v[52:55], v[40:43], a[112:119], v126
v_smfmac_f32_16x16x64_bf16 v[56:59], v[40:43], a[120:127], v126
v_smfmac_f32_16x16x64_bf16 v[60:63], v[40:43], v[224:231], v126
v_smfmac_f32_16x16x64_bf16 v[64:67], v[40:43], v[232:239], v126
Lps_324:
s_waitcnt vmcnt(1)
v_max3_u32 v26, v28, v29, v30
v_max_u32 v26, v26, v31
v_cmp_eq_u32 vcc, -1, v26
s_cbranch_vccnz Lpf_325
v_smfmac_f32_16x16x64_bf16 v[44:47], v[28:31], a[0:7], v126
v_smfmac_f32_16x16x64_bf16 v[48:51], v[28:31], a[8:15], v126
v_smfmac_f32_16x16x64_bf16 v[52:55], v[28:31], a[16:23], v126
v_smfmac_f32_16x16x64_bf16 v[56:59], v[28:31], a[24:31], v126
v_smfmac_f32_16x16x64_bf16 v[60:63], v[28:31], v[128:135], v126
v_smfmac_f32_16x16x64_bf16 v[64:67], v[28:31], v[136:143], v126
s_branch Lps_312
Lpf_301:
buffer_load_dwordx4 v[40:43], v8, s[4:7], s40 offen offset:3072 sc1
v_mfma_f32_16x16x32_bf16 v[16:19], v[20:23], v[20:23], 0
Lps_326:
s_waitcnt vmcnt(1)
v_max3_u32 v26, v28, v29, v30
v_max_u32 v26, v26, v31
v_cmp_eq_u32 vcc, -1, v26
s_cbranch_vccnz Lpf_327
v_smfmac_f32_16x16x64_bf16 v[44:47], v[28:31], a[0:7], v126
v_smfmac_f32_16x16x64_bf16 v[48:51], v[28:31], a[8:15], v126
v_smfmac_f32_16x16x64_bf16 v[52:55], v[28:31], a[16:23], v126
v_smfmac_f32_16x16x64_bf16 v[56:59], v[28:31], a[24:31], v126
v_smfmac_f32_16x16x64_bf16 v[60:63], v[28:31], v[128:135], v126
v_smfmac_f32_16x16x64_bf16 v[64:67], v[28:31], v[136:143], v126
s_branch Lps_314
Lpf_303:
buffer_load_dwordx4 v[28:31], v8, s[4:7], s40 offen offset:0 sc1
v_mfma_f32_16x16x32_bf16 v[16:19], v[20:23], v[20:23], 0
s_sub_u32 s37, s37, 1
s_cbranch_scc1 Lend_1
s_branch Lps_302
Lpf_305:
buffer_load_dwordx4 v[36:39], v8, s[4:7], s40 offen offset:2048 sc1
v_mfma_f32_16x16x32_bf16 v[16:19], v[20:23], v[20:23], 0
Lps_328:
s_waitcnt vmcnt(2)
v_max3_u32 v26, v40, v41, v42
v_max_u32 v26, v26, v43
v_cmp_eq_u32 vcc, -1, v26
s_cbranch_vccnz Lpf_329
v_smfmac_f32_16x16x64_bf16 v[44:47], v[40:43], a[96:103], v126
v_smfmac_f32_16x16x64_bf16 v[48:51], v[40:43], a[104:111], v126
v_smfmac_f32_16x16x64_bf16 v[52:55], v[40:43], a[112:119], v126
v_smfmac_f32_16x16x64_bf16 v[56:59], v[40:43], a[120:127], v126
v_smfmac_f32_16x16x64_bf16 v[60:63], v[40:43], v[224:231], v126
v_smfmac_f32_16x16x64_bf16 v[64:67], v[40:43], v[232:239], v126
Lps_330:
s_waitcnt vmcnt(1)
v_max3_u32 v26, v32, v33, v34
v_max_u32 v26, v26, v35
v_cmp_eq_u32 vcc, -1, v26
s_cbranch_vccnz Lpf_331
v_smfmac_f32_16x16x64_bf16 v[44:47], v[32:35], a[32:39], v126
v_smfmac_f32_16x16x64_bf16 v[48:51], v[32:35], a[40:47], v126
v_smfmac_f32_16x16x64_bf16 v[52:55], v[32:35], a[48:55], v126
v_smfmac_f32_16x16x64_bf16 v[56:59], v[32:35], a[56:63], v126
v_smfmac_f32_16x16x64_bf16 v[60:63], v[32:35], v[160:167], v126
v_smfmac_f32_16x16x64_bf16 v[64:67], v[32:35], v[168:175], v126
s_branch Lps_312
Lpf_307:
buffer_load_dwordx4 v[40:43], v8, s[4:7], s40 offen offset:3072 sc1
v_mfma_f32_16x16x32_bf16 v[16:19], v[20:23], v[20:23], 0
Lps_332:
s_waitcnt vmcnt(1)
v_max3_u32 v26, v32, v33, v34
v_max_u32 v26, v26, v35
v_cmp_eq_u32 vcc, -1, v26
s_cbranch_vccnz Lpf_333
v_smfmac_f32_16x16x64_bf16 v[44:47], v[32:35], a[32:39], v126
v_smfmac_f32_16x16x64_bf16 v[48:51], v[32:35], a[40:47], v126
v_smfmac_f32_16x16x64_bf16 v[52:55], v[32:35], a[48:55], v126
v_smfmac_f32_16x16x64_bf16 v[56:59], v[32:35], a[56:63], v126
v_smfmac_f32_16x16x64_bf16 v[60:63], v[32:35], v[160:167], v126
v_smfmac_f32_16x16x64_bf16 v[64:67], v[32:35], v[168:175], v126
s_branch Lps_314
Lpf_309:
buffer_load_dwordx4 v[32:35], v8, s[4:7], s40 offen offset:1024 sc1
v_mfma_f32_16x16x32_bf16 v[16:19], v[20:23], v[20:23], 0
s_sub_u32 s37, s37, 1
s_cbranch_scc1 Lend_1
s_branch Lps_308
Lpf_311:
buffer_load_dwordx4 v[40:43], v8, s[4:7], s40 offen offset:3072 sc1
v_mfma_f32_16x16x32_bf16 v[16:19], v[20:23], v[20:23], 0
Lps_334:
s_waitcnt vmcnt(1)
v_max3_u32 v26, v36, v37, v38
v_max_u32 v26, v26, v39
v_cmp_eq_u32 vcc, -1, v26
s_cbranch_vccnz Lpf_335
v_smfmac_f32_16x16x64_bf16 v[44:47], v[36:39], a[64:71], v126
v_smfmac_f32_16x16x64_bf16 v[48:51], v[36:39], a[72:79], v126
v_smfmac_f32_16x16x64_bf16 v[52:55], v[36:39], a[80:87], v126
v_smfmac_f32_16x16x64_bf16 v[56:59], v[36:39], a[88:95], v126
v_smfmac_f32_16x16x64_bf16 v[60:63], v[36:39], v[192:199], v126
v_smfmac_f32_16x16x64_bf16 v[64:67], v[36:39], v[200:207], v126
s_branch Lps_314
Lpf_313:
buffer_load_dwordx4 v[36:39], v8, s[4:7], s40 offen offset:2048 sc1
v_mfma_f32_16x16x32_bf16 v[16:19], v[20:23], v[20:23], 0
s_sub_u32 s37, s37, 1
s_cbranch_scc1 Lend_1
s_branch Lps_312
Lpf_315:
buffer_load_dwordx4 v[40:43], v8, s[4:7], s40 offen offset:3072 sc1
v_mfma_f32_16x16x32_bf16 v[16:19], v[20:23], v[20:23], 0
s_sub_u32 s37, s37, 1
s_cbranch_scc1 Lend_1
s_branch Lps_314
Lpf_317:
buffer_load_dwordx4 v[36:39], v8, s[4:7], s40 offen offset:2048 sc1
v_mfma_f32_16x16x32_bf16 v[16:19], v[20:23], v[20:23], 0
Lps_336:
s_waitcnt vmcnt(3)
v_max3_u32 v26, v40, v41, v42
v_max_u32 v26, v26, v43
v_cmp_eq_u32 vcc, -1, v26
s_cbranch_vccnz Lpf_337
v_smfmac_f32_16x16x64_bf16 v[44:47], v[40:43], a[96:103], v126
v_smfmac_f32_16x16x64_bf16 v[48:51], v[40:43], a[104:111], v126
v_smfmac_f32_16x16x64_bf16 v[52:55], v[40:43], a[112:119], v126
v_smfmac_f32_16x16x64_bf16 v[56:59], v[40:43], a[120:127], v126
v_smfmac_f32_16x16x64_bf16 v[60:63], v[40:43], v[224:231], v126
v_smfmac_f32_16x16x64_bf16 v[64:67], v[40:43], v[232:239], v126
Lps_338:
s_waitcnt vmcnt(2)
v_max3_u32 v26, v28, v29, v30
v_max_u32 v26, v26, v31
v_cmp_eq_u32 vcc, -1, v26
s_cbranch_vccnz Lpf_339
v_smfmac_f32_16x16x64_bf16 v[44:47], v[28:31], a[0:7], v126
v_smfmac_f32_16x16x64_bf16 v[48:51], v[28:31], a[8:15], v126
v_smfmac_f32_16x16x64_bf16 v[52:55], v[28:31], a[16:23], v126
v_smfmac_f32_16x16x64_bf16 v[56:59], v[28:31], a[24:31], v126
v_smfmac_f32_16x16x64_bf16 v[60:63], v[28:31], v[128:135], v126
v_smfmac_f32_16x16x64_bf16 v[64:67], v[28:31], v[136:143], v126
s_branch Lps_330
Lpf_319:
buffer_load_dwordx4 v[40:43], v8, s[4:7], s40 offen offset:3072 sc1
v_mfma_f32_16x16x32_bf16 v[16:19], v[20:23], v[20:23], 0
Lps_340:
s_waitcnt vmcnt(2)
v_max3_u32 v26, v28, v29, v30
v_max_u32 v26, v26, v31
v_cmp_eq_u32 vcc, -1, v26
s_cbranch_vccnz Lpf_341
v_smfmac_f32_16x16x64_bf16 v[44:47], v[28:31], a[0:7], v126
v_smfmac_f32_16x16x64_bf16 v[48:51], v[28:31], a[8:15], v126
v_smfmac_f32_16x16x64_bf16 v[52:55], v[28:31], a[16:23], v126
v_smfmac_f32_16x16x64_bf16 v[56:59], v[28:31], a[24:31], v126
v_smfmac_f32_16x16x64_bf16 v[60:63], v[28:31], v[128:135], v126
v_smfmac_f32_16x16x64_bf16 v[64:67], v[28:31], v[136:143], v126
s_branch Lps_332
Lpf_321:
buffer_load_dwordx4 v[28:31], v8, s[4:7], s40 offen offset:0 sc1
v_mfma_f32_16x16x32_bf16 v[16:19], v[20:23], v[20:23], 0
s_sub_u32 s37, s37, 1
s_cbranch_scc1 Lend_1
Lps_342:
s_waitcnt vmcnt(1)
v_max3_u32 v26, v32, v33, v34
v_max_u32 v26, v26, v35
v_cmp_eq_u32 vcc, -1, v26
s_cbranch_vccnz Lpf_343
v_smfmac_f32_16x16x64_bf16 v[44:47], v[32:35], a[32:39], v126
v_smfmac_f32_16x16x64_bf16 v[48:51], v[32:35], a[40:47], v126
v_smfmac_f32_16x16x64_bf16 v[52:55], v[32:35], a[48:55], v126
v_smfmac_f32_16x16x64_bf16 v[56:59], v[32:35], a[56:63], v126
v_smfmac_f32_16x16x64_bf16 v[60:63], v[32:35], v[160:167], v126
v_smfmac_f32_16x16x64_bf16 v[64:67], v[32:35], v[168:175], v126
s_branch Lps_302
Lpf_323:
buffer_load_dwordx4 v[40:43], v8, s[4:7], s40 offen offset:3072 sc1
v_mfma_f32_16x16x32_bf16 v[16:19], v[20:23], v[20:23], 0
Lps_344:
s_waitcnt vmcnt(2)
v_max3_u32 v26, v28, v29, v30
v_max_u32 v26, v26, v31
v_cmp_eq_u32 vcc, -1, v26
s_cbranch_vccnz Lpf_345
v_smfmac_f32_16x16x64_bf16 v[44:47], v[28:31], a[0:7], v126
v_smfmac_f32_16x16x64_bf16 v[48:51], v[28:31], a[8:15], v126
v_smfmac_f32_16x16x64_bf16 v[52:55], v[28:31], a[16:23], v126
v_smfmac_f32_16x16x64_bf16 v[56:59], v[28:31], a[24:31], v126
v_smfmac_f32_16x16x64_bf16 v[60:63], v[28:31], v[128:135], v126
v_smfmac_f32_16x16x64_bf16 v[64:67], v[28:31], v[136:143], v126
s_branch Lps_334
Lpf_325:
buffer_load_dwordx4 v[28:31], v8, s[4:7], s40 offen offset:0 sc1
v_mfma_f32_16x16x32_bf16 v[16:19], v[20:23], v[20:23], 0
s_sub_u32 s37, s37, 1
s_cbranch_scc1 Lend_1
Lps_346:
s_waitcnt vmcnt(1)
v_max3_u32 v26, v36, v37, v38
v_max_u32 v26, v26, v39
v_cmp_eq_u32 vcc, -1, v26
s_cbranch_vccnz Lpf_347
v_smfmac_f32_16x16x64_bf16 v[44:47], v[36:39], a[64:71], v126
v_smfmac_f32_16x16x64_bf16 v[48:51], v[36:39], a[72:79], v126
v_smfmac_f32_16x16x64_bf16 v[52:55], v[36:39], a[80:87], v126
v_smfmac_f32_16x16x64_bf16 v[56:59], v[36:39], a[88:95], v126
v_smfmac_f32_16x16x64_bf16 v[60:63], v[36:39], v[192:199], v126
v_smfmac_f32_16x16x64_bf16 v[64:67], v[36:39], v[200:207], v126
s_branch Lps_302
Lpf_327:
buffer_load_dwordx4 v[28:31], v8, s[4:7], s40 offen offset:0 sc1
v_mfma_f32_16x16x32_bf16 v[16:19], v[20:23], v[20:23], 0
s_sub_u32 s37, s37, 1
s_cbranch_scc1 Lend_1
s_branch Lps_300
Lpf_329:
buffer_load_dwordx4 v[40:43], v8, s[4:7], s40 offen offset:3072 sc1
v_mfma_f32_16x16x32_bf16 v[16:19], v[20:23], v[20:23], 0
Lps_348:
s_waitcnt vmcnt(2)
v_max3_u32 v26, v32, v33, v34
v_max_u32 v26, v26, v35
v_cmp_eq_u32 vcc, -1, v26
s_cbranch_vccnz Lpf_349
v_smfmac_f32_16x16x64_bf16 v[44:47], v[32:35], a[32:39], v126
v_smfmac_f32_16x16x64_bf16 v[48:51], v[32:35], a[40:47], v126
v_smfmac_f32_16x16x64_bf16 v[52:55], v[32:35], a[48:55], v126
v_smfmac_f32_16x16x64_bf16 v[56:59], v[32:35], a[56:63], v126
v_smfmac_f32_16x16x64_bf16 v[60:63], v[32:35], v[160:167], v126
v_smfmac_f32_16x16x64_bf16 v[64:67], v[32:35], v[168:175], v126
s_branch Lps_334
Lpf_331:
buffer_load_dwordx4 v[32:35], v8, s[4:7], s40 offen offset:1024 sc1
v_mfma_f32_16x16x32_bf16 v[16:19], v[20:23], v[20:23], 0
s_sub_u32 s37, s37, 1
s_cbranch_scc1 Lend_1
Lps_350:
s_waitcnt vmcnt(1)
v_max3_u32 v26, v36, v37, v38
v_max_u32 v26, v26, v39
v_cmp_eq_u32 vcc, -1, v26
s_cbranch_vccnz Lpf_351
v_smfmac_f32_16x16x64_bf16 v[44:47], v[36:39], a[64:71], v126
v_smfmac_f32_16x16x64_bf16 v[48:51], v[36:39], a[72:79], v126
v_smfmac_f32_16x16x64_bf16 v[52:55], v[36:39], a[80:87], v126
v_smfmac_f32_16x16x64_bf16 v[56:59], v[36:39], a[88:95], v126
v_smfmac_f32_16x16x64_bf16 v[60:63], v[36:39], v[192:199], v126
v_smfmac_f32_16x16x64_bf16 v[64:67], v[36:39], v[200:207], v126
s_branch Lps_308
Lpf_333:
buffer_load_dwordx4 v[32:35], v8, s[4:7], s40 offen offset:1024 sc1
v_mfma_f32_16x16x32_bf16 v[16:19], v[20:23], v[20:23], 0
s_sub_u32 s37, s37, 1
s_cbranch_scc1 Lend_1
s_branch Lps_306
Lpf_335:
buffer_load_dwordx4 v[36:39], v8, s[4:7], s40 offen offset:2048 sc1
v_mfma_f32_16x16x32_bf16 v[16:19], v[20:23], v[20:23], 0
s_sub_u32 s37, s37, 1
s_cbranch_scc1 Lend_1
s_branch Lps_310
Lpf_337:
buffer_load_dwordx4 v[40:43], v8, s[4:7], s40 offen offset:3072 sc1
v_mfma_f32_16x16x32_bf16 v[16:19], v[20:23], v[20:23], 0
Lps_352:
s_waitcnt vmcnt(3)
v_max3_u32 v26, v28, v29, v30
v_max_u32 v26, v26, v31
v_cmp_eq_u32 vcc, -1, v26
s_cbranch_vccnz Lpf_353
v_smfmac_f32_16x16x64_bf16 v[44:47], v[28:31], a[0:7], v126
v_smfmac_f32_16x16x64_bf16 v[48:51], v[28:31], a[8:15], v126
v_smfmac_f32_16x16x64_bf16 v[52:55], v[28:31], a[16:23], v126
v_smfmac_f32_16x16x64_bf16 v[56:59], v[28:31], a[24:31], v126
v_smfmac_f32_16x16x64_bf16 v[60:63], v[28:31], v[128:135], v126
v_smfmac_f32_16x16x64_bf16 v[64:67], v[28:31], v[136:143], v126
s_branch Lps_348
Lpf_339:
buffer_load_dwordx4 v[28:31], v8, s[4:7], s40 offen offset:0 sc1
v_mfma_f32_16x16x32_bf16 v[16:19], v[20:23], v[20:23], 0
s_sub_u32 s37, s37, 1
s_cbranch_scc1 Lend_1
Lps_354:
s_waitcnt vmcnt(2)
v_max3_u32 v26, v32, v33, v34
v_max_u32 v26, v26, v35
v_cmp_eq_u32 vcc, -1, v26
s_cbranch_vccnz Lpf_355
v_smfmac_f32_16x16x64_bf16 v[44:47], v[32:35], a[32:39], v126
v_smfmac_f32_16x16x64_bf16 v[48:51], v[32:35], a[40:47], v126
v_smfmac_f32_16x16x64_bf16 v[52:55], v[32:35], a[48:55], v126
v_smfmac_f32_16x16x64_bf16 v[56:59], v[32:35], a[56:63], v126
v_smfmac_f32_16x16x64_bf16 v[60:63], v[32:35], v[160:167], v126
v_smfmac_f32_16x16x64_bf16 v[64:67], v[32:35], v[168:175], v126
s_branch Lps_346
Lpf_341:
buffer_load_dwordx4 v[28:31], v8, s[4:7], s40 offen offset:0 sc1
v_mfma_f32_16x16x32_bf16 v[16:19], v[20:23], v[20:23], 0
s_sub_u32 s37, s37, 1
s_cbranch_scc1 Lend_1
Lps_356:
s_waitcnt vmcnt(2)
v_max3_u32 v26, v32, v33, v34
v_max_u32 v26, v26, v35
v_cmp_eq_u32 vcc, -1, v26
s_cbranch_vccnz Lpf_357
v_smfmac_f32_16x16x64_bf16 v[44:47], v[32:35], a[32:39], v126
v_smfmac_f32_16x16x64_bf16 v[48:51], v[32:35], a[40:47], v126
v_smfmac_f32_16x16x64_bf16 v[52:55], v[32:35], a[48:55], v126
v_smfmac_f32_16x16x64_bf16 v[56:59], v[32:35], a[56:63], v126
v_smfmac_f32_16x16x64_bf16 v[60:63], v[32:35], v[160:167], v126
v_smfmac_f32_16x16x64_bf16 v[64:67], v[32:35], v[168:175], v126
s_branch Lps_300
Lpf_343:
buffer_load_dwordx4 v[32:35], v8, s[4:7], s40 offen offset:1024 sc1
v_mfma_f32_16x16x32_bf16 v[16:19], v[20:23], v[20:23], 0
s_branch Lps_320
Lpf_345:
buffer_load_dwordx4 v[28:31], v8, s[4:7], s40 offen offset:0 sc1
v_mfma_f32_16x16x32_bf16 v[16:19], v[20:23], v[20:23], 0
s_sub_u32 s37, s37, 1
s_cbranch_scc1 Lend_1
s_branch Lps_298
Lpf_347:
buffer_load_dwordx4 v[36:39], v8, s[4:7], s40 offen offset:2048 sc1
v_mfma_f32_16x16x32_bf16 v[16:19], v[20:23], v[20:23], 0
s_branch Lps_324
Lpf_349:
buffer_load_dwordx4 v[32:35], v8, s[4:7], s40 offen offset:1024 sc1
v_mfma_f32_16x16x32_bf16 v[16:19], v[20:23], v[20:23], 0
s_sub_u32 s37, s37, 1
s_cbranch_scc1 Lend_1
s_branch Lps_304
Lpf_351:
buffer_load_dwordx4 v[36:39], v8, s[4:7], s40 offen offset:2048 sc1
v_mfma_f32_16x16x32_bf16 v[16:19], v[20:23], v[20:23], 0
s_branch Lps_330
Lpf_353:
buffer_load_dwordx4 v[28:31], v8, s[4:7], s40 offen offset:0 sc1
v_mfma_f32_16x16x32_bf16 v[16:19], v[20:23], v[20:23], 0
s_sub_u32 s37, s37, 1
s_cbranch_scc1 Lend_1
s_branch Lps_296
Lpf_355:
buffer_load_dwordx4 v[32:35], v8, s[4:7], s40 offen offset:1024 sc1
v_mfma_f32_16x16x32_bf16 v[16:19], v[20:23], v[20:23], 0
Lps_358:
s_waitcnt vmcnt(2)
v_max3_u32 v26, v36, v37, v38
v_max_u32 v26, v26, v39
v_cmp_eq_u32 vcc, -1, v26
s_cbranch_vccnz Lpf_359
v_smfmac_f32_16x16x64_bf16 v[44:47], v[36:39], a[64:71], v126
v_smfmac_f32_16x16x64_bf16 v[48:51], v[36:39], a[72:79], v126
v_smfmac_f32_16x16x64_bf16 v[52:55], v[36:39], a[80:87], v126
v_smfmac_f32_16x16x64_bf16 v[56:59], v[36:39], a[88:95], v126
v_smfmac_f32_16x16x64_bf16 v[60:63], v[36:39], v[192:199], v126
v_smfmac_f32_16x16x64_bf16 v[64:67], v[36:39], v[200:207], v126
s_branch Lps_320
Lpf_357:
buffer_load_dwordx4 v[32:35], v8, s[4:7], s40 offen offset:1024 sc1
v_mfma_f32_16x16x32_bf16 v[16:19], v[20:23], v[20:23], 0
s_branch Lps_318
Lpf_359:
buffer_load_dwordx4 v[36:39], v8, s[4:7], s40 offen offset:2048 sc1
v_mfma_f32_16x16x32_bf16 v[16:19], v[20:23], v[20:23], 0
s_branch Lps_338
Lpf_289:
buffer_load_dwordx4 v[28:31], v9, s[4:7], s40 offen offset:0 sc1
v_mfma_f32_16x16x32_bf16 v[16:19], v[20:23], v[20:23], 0
s_sub_u32 s37, s37, 1
s_cbranch_scc1 Lend_1
Lps_360:
s_waitcnt vmcnt(3)
v_max3_u32 v26, v32, v33, v34
v_max_u32 v26, v26, v35
v_cmp_eq_u32 vcc, -1, v26
s_cbranch_vccnz Lpf_361
v_smfmac_f32_16x16x64_bf16 v[76:79], v[32:35], a[160:167], v126
v_smfmac_f32_16x16x64_bf16 v[80:83], v[32:35], a[168:175], v126
v_smfmac_f32_16x16x64_bf16 v[84:87], v[32:35], a[176:183], v126
v_smfmac_f32_16x16x64_bf16 v[88:91], v[32:35], a[184:191], v126
Lps_362:
s_waitcnt vmcnt(2)
v_max3_u32 v26, v36, v37, v38
v_max_u32 v26, v26, v39
v_cmp_eq_u32 vcc, -1, v26
s_cbranch_vccnz Lpf_363
v_smfmac_f32_16x16x64_bf16 v[76:79], v[36:39], a[192:199], v126
v_smfmac_f32_16x16x64_bf16 v[80:83], v[36:39], a[200:207], v126
v_smfmac_f32_16x16x64_bf16 v[84:87], v[36:39], a[208:215], v126
v_smfmac_f32_16x16x64_bf16 v[88:91], v[36:39], a[216:223], v126
Lps_364:
s_waitcnt vmcnt(1)
v_max3_u32 v26, v40, v41, v42
v_max_u32 v26, v26, v43
v_cmp_eq_u32 vcc, -1, v26
s_cbranch_vccnz Lpf_365
v_smfmac_f32_16x16x64_bf16 v[76:79], v[40:43], a[224:231], v126
v_smfmac_f32_16x16x64_bf16 v[80:83], v[40:43], a[232:239], v126
v_smfmac_f32_16x16x64_bf16 v[84:87], v[40:43], a[240:247], v126
v_smfmac_f32_16x16x64_bf16 v[88:91], v[40:43], a[248:255], v126
Lps_366:
s_waitcnt vmcnt(0)
v_max3_u32 v26, v28, v29, v30
v_max_u32 v26, v26, v31
v_cmp_eq_u32 vcc, -1, v26
s_cbranch_vccnz Lpf_367
v_smfmac_f32_16x16x64_bf16 v[76:79], v[28:31], a[128:135], v126
v_smfmac_f32_16x16x64_bf16 v[80:83], v[28:31], a[136:143], v126
v_smfmac_f32_16x16x64_bf16 v[84:87], v[28:31], a[144:151], v126
v_smfmac_f32_16x16x64_bf16 v[88:91], v[28:31], a[152:159], v126
s_branch Lpd_288
Lpf_290:
buffer_load_dwordx4 v[32:35], v9, s[4:7], s40 offen offset:1024 sc1
v_mfma_f32_16x16x32_bf16 v[16:19], v[20:23], v[20:23], 0
s_sub_u32 s37, s37, 1
s_cbranch_scc1 Lend_1
Lps_368:
s_waitcnt vmcnt(2)
v_max3_u32 v26, v36, v37, v38
v_max_u32 v26, v26, v39
v_cmp_eq_u32 vcc, -1, v26
s_cbranch_vccnz Lpf_369
v_smfmac_f32_16x16x64_bf16 v[76:79], v[36:39], a[192:199], v126
v_smfmac_f32_16x16x64_bf16 v[80:83], v[36:39], a[200:207], v126
v_smfmac_f32_16x16x64_bf16 v[84:87], v[36:39], a[208:215], v126
v_smfmac_f32_16x16x64_bf16 v[88:91], v[36:39], a[216:223], v126
Lps_370:
s_waitcnt vmcnt(1)
v_max3_u32 v26, v40, v41, v42
v_max_u32 v26, v26, v43
v_cmp_eq_u32 vcc, -1, v26
s_cbranch_vccnz Lpf_371
v_smfmac_f32_16x16x64_bf16 v[76:79], v[40:43], a[224:231], v126
v_smfmac_f32_16x16x64_bf16 v[80:83], v[40:43], a[232:239], v126
v_smfmac_f32_16x16x64_bf16 v[84:87], v[40:43], a[240:247], v126
v_smfmac_f32_16x16x64_bf16 v[88:91], v[40:43], a[248:255], v126
Lps_372:
s_waitcnt vmcnt(0)
v_max3_u32 v26, v32, v33, v34
v_max_u32 v26, v26, v35
v_cmp_eq_u32 vcc, -1, v26
s_cbranch_vccnz Lpf_373
v_smfmac_f32_16x16x64_bf16 v[76:79], v[32:35], a[160:167], v126
v_smfmac_f32_16x16x64_bf16 v[80:83], v[32:35], a[168:175], v126
v_smfmac_f32_16x16x64_bf16 v[84:87], v[32:35], a[176:183], v126
v_smfmac_f32_16x16x64_bf16 v[88:91], v[32:35], a[184:191], v126
s_branch Lpd_288
Lpf_291:
buffer_load_dwordx4 v[36:39], v9, s[4:7], s40 offen offset:2048 sc1
v_mfma_f32_16x16x32_bf16 v[16:19], v[20:23], v[20:23], 0
s_sub_u32 s37, s37, 1
s_cbranch_scc1 Lend_1
Lps_374:
s_waitcnt vmcnt(1)
v_max3_u32 v26, v40, v41, v42
v_max_u32 v26, v26, v43
v_cmp_eq_u32 vcc, -1, v26
s_cbranch_vccnz Lpf_375
v_smfmac_f32_16x16x64_bf16 v[76:79], v[40:43], a[224:231], v126
v_smfmac_f32_16x16x64_bf16 v[80:83], v[40:43], a[232:239], v126
v_smfmac_f32_16x16x64_bf16 v[84:87], v[40:43], a[240:247], v126
v_smfmac_f32_16x16x64_bf16 v[88:91], v[40:43], a[248:255], v126
Lps_376:
s_waitcnt vmcnt(0)
v_max3_u32 v26, v36, v37, v38
v_max_u32 v26, v26, v39
v_cmp_eq_u32 vcc, -1, v26
s_cbranch_vccnz Lpf_377
v_smfmac_f32_16x16x64_bf16 v[76:79], v[36:39], a[192:199], v126
v_smfmac_f32_16x16x64_bf16 v[80:83], v[36:39], a[200:207], v126
v_smfmac_f32_16x16x64_bf16 v[84:87], v[36:39], a[208:215], v126
v_smfmac_f32_16x16x64_bf16 v[88:91], v[36:39], a[216:223], v126
s_branch Lpd_288
Lpf_292:
buffer_load_dwordx4 v[40:43], v9, s[4:7], s40 offen offset:3072 sc1
v_mfma_f32_16x16x32_bf16 v[16:19], v[20:23], v[20:23], 0
s_sub_u32 s37, s37, 1
s_cbranch_scc1 Lend_1
Lps_378:
s_waitcnt vmcnt(0)
v_max3_u32 v26, v40, v41, v42
v_max_u32 v26, v26, v43
v_cmp_eq_u32 vcc, -1, v26
s_cbranch_vccnz Lpf_379
v_smfmac_f32_16x16x64_bf16 v[76:79], v[40:43], a[224:231], v126
v_smfmac_f32_16x16x64_bf16 v[80:83], v[40:43], a[232:239], v126
v_smfmac_f32_16x16x64_bf16 v[84:87], v[40:43], a[240:247], v126
v_smfmac_f32_16x16x64_bf16 v[88:91], v[40:43], a[248:255], v126
s_branch Lpd_288
Lpf_361:
buffer_load_dwordx4 v[32:35], v9, s[4:7], s40 offen offset:1024 sc1
v_mfma_f32_16x16x32_bf16 v[16:19], v[20:23], v[20:23], 0
Lps_380:
s_waitcnt vmcnt(3)
v_max3_u32 v26, v36, v37, v38
v_max_u32 v26, v26, v39
v_cmp_eq_u32 vcc, -1, v26
s_cbranch_vccnz Lpf_381
v_smfmac_f32_16x16x64_bf16 v[76:79], v[36:39], a[192:199], v126
v_smfmac_f32_16x16x64_bf16 v[80:83], v[36:39], a[200:207], v126
v_smfmac_f32_16x16x64_bf16 v[84:87], v[36:39], a[208:215], v126
v_smfmac_f32_16x16x64_bf16 v[88:91], v[36:39], a[216:223], v126
Lps_382:
s_waitcnt vmcnt(2)
v_max3_u32 v26, v40, v41, v42
v_max_u32 v26, v26, v43
v_cmp_eq_u32 vcc, -1, v26
s_cbranch_vccnz Lpf_383
v_smfmac_f32_16x16x64_bf16 v[76:79], v[40:43], a[224:231], v126
v_smfmac_f32_16x16x64_bf16 v[80:83], v[40:43], a[232:239], v126
v_smfmac_f32_16x16x64_bf16 v[84:87], v[40:43], a[240:247], v126
v_smfmac_f32_16x16x64_bf16 v[88:91], v[40:43], a[248:255], v126
Lps_384:
s_waitcnt vmcnt(1)
v_max3_u32 v26, v28, v29, v30
v_max_u32 v26, v26, v31
v_cmp_eq_u32 vcc, -1, v26
s_cbranch_vccnz Lpf_385
v_smfmac_f32_16x16x64_bf16 v[76:79], v[28:31], a[128:135], v126
v_smfmac_f32_16x16x64_bf16 v[80:83], v[28:31], a[136:143], v126
v_smfmac_f32_16x16x64_bf16 v[84:87], v[28:31], a[144:151], v126
v_smfmac_f32_16x16x64_bf16 v[88:91], v[28:31], a[152:159], v126
s_branch Lps_372
Lpf_363:
buffer_load_dwordx4 v[36:39], v9, s[4:7], s40 offen offset:2048 sc1
v_mfma_f32_16x16x32_bf16 v[16:19], v[20:23], v[20:23], 0
Lps_386:
s_waitcnt vmcnt(2)
v_max3_u32 v26, v40, v41, v42
v_max_u32 v26, v26, v43
v_cmp_eq_u32 vcc, -1, v26
s_cbranch_vccnz Lpf_387
v_smfmac_f32_16x16x64_bf16 v[76:79], v[40:43], a[224:231], v126
v_smfmac_f32_16x16x64_bf16 v[80:83], v[40:43], a[232:239], v126
v_smfmac_f32_16x16x64_bf16 v[84:87], v[40:43], a[240:247], v126
v_smfmac_f32_16x16x64_bf16 v[88:91], v[40:43], a[248:255], v126
Lps_388:
s_waitcnt vmcnt(1)
v_max3_u32 v26, v28, v29, v30
v_max_u32 v26, v26, v31
v_cmp_eq_u32 vcc, -1, v26
s_cbranch_vccnz Lpf_389
v_smfmac_f32_16x16x64_bf16 v[76:79], v[28:31], a[128:135], v126
v_smfmac_f32_16x16x64_bf16 v[80:83], v[28:31], a[136:143], v126
v_smfmac_f32_16x16x64_bf16 v[84:87], v[28:31], a[144:151], v126
v_smfmac_f32_16x16x64_bf16 v[88:91], v[28:31], a[152:159], v126
s_branch Lps_376
Lpf_365:
buffer_load_dwordx4 v[40:43], v9, s[4:7], s40 offen offset:3072 sc1
v_mfma_f32_16x16x32_bf16 v[16:19], v[20:23], v[20:23], 0
Lps_390:
s_waitcnt vmcnt(1)
v_max3_u32 v26, v28, v29, v30
v_max_u32 v26, v26, v31
v_cmp_eq_u32 vcc, -1, v26
s_cbranch_vccnz Lpf_391
v_smfmac_f32_16x16x64_bf16 v[76:79], v[28:31], a[128:135], v126
v_smfmac_f32_16x16x64_bf16 v[80:83], v[28:31], a[136:143], v126
v_smfmac_f32_16x16x64_bf16 v[84:87], v[28:31], a[144:151], v126
v_smfmac_f32_16x16x64_bf16 v[88:91], v[28:31], a[152:159], v126
s_branch Lps_378
Lpf_367:
buffer_load_dwordx4 v[28:31], v9, s[4:7], s40 offen offset:0 sc1
v_mfma_f32_16x16x32_bf16 v[16:19], v[20:23], v[20:23], 0
s_sub_u32 s37, s37, 1
s_cbranch_scc1 Lend_1
s_branch Lps_366
Lpf_369:
buffer_load_dwordx4 v[36:39], v9, s[4:7], s40 offen offset:2048 sc1
v_mfma_f32_16x16x32_bf16 v[16:19], v[20:23], v[20:23], 0
Lps_392:
s_waitcnt vmcnt(2)
v_max3_u32 v26, v40, v41, v42
v_max_u32 v26, v26, v43
v_cmp_eq_u32 vcc, -1, v26
s_cbranch_vccnz Lpf_393
v_smfmac_f32_16x16x64_bf16 v[76:79], v[40:43], a[224:231], v126
v_smfmac_f32_16x16x64_bf16 v[80:83], v[40:43], a[232:239], v126
v_smfmac_f32_16x16x64_bf16 v[84:87], v[40:43], a[240:247], v126
v_smfmac_f32_16x16x64_bf16 v[88:91], v[40:43], a[248:255], v126
Lps_394:
s_waitcnt vmcnt(1)
v_max3_u32 v26, v32, v33, v34
v_max_u32 v26, v26, v35
v_cmp_eq_u32 vcc, -1, v26
s_cbranch_vccnz Lpf_395
v_smfmac_f32_16x16x64_bf16 v[76:79], v[32:35], a[160:167], v126
v_smfmac_f32_16x16x64_bf16 v[80:83], v[32:35], a[168:175], v126
v_smfmac_f32_16x16x64_bf16 v[84:87], v[32:35], a[176:183], v126
v_smfmac_f32_16x16x64_bf16 v[88:91], v[32:35], a[184:191], v126
s_branch Lps_376
Lpf_371:
buffer_load_dwordx4 v[40:43], v9, s[4:7], s40 offen offset:3072 sc1
v_mfma_f32_16x16x32_bf16 v[16:19], v[20:23], v[20:23], 0
Lps_396:
s_waitcnt vmcnt(1)
v_max3_u32 v26, v32, v33, v34
v_max_u32 v26, v26, v35
v_cmp_eq_u32 vcc, -1, v26
s_cbranch_vccnz Lpf_397
v_smfmac_f32_16x16x64_bf16 v[76:79], v[32:35], a[160:167], v126
v_smfmac_f32_16x16x64_bf16 v[80:83], v[32:35], a[168:175], v126
v_smfmac_f32_16x16x64_bf16 v[84:87], v[32:35], a[176:183], v126
v_smfmac_f32_16x16x64_bf16 v[88:91], v[32:35], a[184:191], v126
s_branch Lps_378
Lpf_373:
buffer_load_dwordx4 v[32:35], v9, s[4:7], s40 offen offset:1024 sc1
v_mfma_f32_16x16x32_bf16 v[16:19], v[20:23], v[20:23], 0
s_sub_u32 s37, s37, 1
s_cbranch_scc1 Lend_1
s_branch Lps_372
Lpf_375:
buffer_load_dwordx4 v[40:43], v9, s[4:7], s40 offen offset:3072 sc1
v_mfma_f32_16x16x32_bf16 v[16:19], v[20:23], v[20:23], 0
Lps_398:
s_waitcnt vmcnt(1)
v_max3_u32 v26, v36, v37, v38
v_max_u32 v26, v26, v39
v_cmp_eq_u32 vcc, -1, v26
s_cbranch_vccnz Lpf_399
v_smfmac_f32_16x16x64_bf16 v[76:79], v[36:39], a[192:199], v126
v_smfmac_f32_16x16x64_bf16 v[80:83], v[36:39], a[200:207], v126
v_smfmac_f32_16x16x64_bf16 v[84:87], v[36:39], a[208:215], v126
v_smfmac_f32_16x16x64_bf16 v[88:91], v[36:39], a[216:223], v126
s_branch Lps_378
Lpf_377:
buffer_load_dwordx4 v[36:39], v9, s[4:7], s40 offen offset:2048 sc1
v_mfma_f32_16x16x32_bf16 v[16:19], v[20:23], v[20:23], 0
s_sub_u32 s37, s37, 1
s_cbranch_scc1 Lend_1
s_branch Lps_376
Lpf_379:
buffer_load_dwordx4 v[40:43], v9, s[4:7], s40 offen offset:3072 sc1
v_mfma_f32_16x16x32_bf16 v[16:19], v[20:23], v[20:23], 0
s_sub_u32 s37, s37, 1
s_cbranch_scc1 Lend_1
s_branch Lps_378
Lpf_381:
buffer_load_dwordx4 v[36:39], v9, s[4:7], s40 offen offset:2048 sc1
v_mfma_f32_16x16x32_bf16 v[16:19], v[20:23], v[20:23], 0
Lps_400:
s_waitcnt vmcnt(3)
v_max3_u32 v26, v40, v41, v42
v_max_u32 v26, v26, v43
v_cmp_eq_u32 vcc, -1, v26
s_cbranch_vccnz Lpf_401
v_smfmac_f32_16x16x64_bf16 v[76:79], v[40:43], a[224:231], v126
v_smfmac_f32_16x16x64_bf16 v[80:83], v[40:43], a[232:239], v126
v_smfmac_f32_16x16x64_bf16 v[84:87], v[40:43], a[240:247], v126
v_smfmac_f32_16x16x64_bf16 v[88:91], v[40:43], a[248:255], v126
Lps_402:
s_waitcnt vmcnt(2)
v_max3_u32 v26, v28, v29, v30
v_max_u32 v26, v26, v31
v_cmp_eq_u32 vcc, -1, v26
s_cbranch_vccnz Lpf_403
v_smfmac_f32_16x16x64_bf16 v[76:79], v[28:31], a[128:135], v126
v_smfmac_f32_16x16x64_bf16 v[80:83], v[28:31], a[136:143], v126
v_smfmac_f32_16x16x64_bf16 v[84:87], v[28:31], a[144:151], v126
v_smfmac_f32_16x16x64_bf16 v[88:91], v[28:31], a[152:159], v126
s_branch Lps_394
Lpf_383:
buffer_load_dwordx4 v[40:43], v9, s[4:7], s40 offen offset:3072 sc1
v_mfma_f32_16x16x32_bf16 v[16:19], v[20:23], v[20:23], 0
Lps_404:
s_waitcnt vmcnt(2)
v_max3_u32 v26, v28, v29, v30
v_max_u32 v26, v26, v31
v_cmp_eq_u32 vcc, -1, v26
s_cbranch_vccnz Lpf_405
v_smfmac_f32_16x16x64_bf16 v[76:79], v[28:31], a[128:135], v126
v_smfmac_f32_16x16x64_bf16 v[80:83], v[28:31], a[136:143], v126
v_smfmac_f32_16x16x64_bf16 v[84:87], v[28:31], a[144:151], v126
v_smfmac_f32_16x16x64_bf16 v[88:91], v[28:31], a[152:159], v126
s_branch Lps_396
Lpf_385:
buffer_load_dwordx4 v[28:31], v9, s[4:7], s40 offen offset:0 sc1
v_mfma_f32_16x16x32_bf16 v[16:19], v[20:23], v[20:23], 0
s_sub_u32 s37, s37, 1
s_cbranch_scc1 Lend_1
Lps_406:
s_waitcnt vmcnt(1)
v_max3_u32 v26, v32, v33, v34
v_max_u32 v26, v26, v35
v_cmp_eq_u32 vcc, -1, v26
s_cbranch_vccnz Lpf_407
v_smfmac_f32_16x16x64_bf16 v[76:79], v[32:35], a[160:167], v126
v_smfmac_f32_16x16x64_bf16 v[80:83], v[32:35], a[168:175], v126
v_smfmac_f32_16x16x64_bf16 v[84:87], v[32:35], a[176:183], v126
v_smfmac_f32_16x16x64_bf16 v[88:91], v[32:35], a[184:191], v126
s_branch Lps_366
Lpf_387:
buffer_load_dwordx4 v[40:43], v9, s[4:7], s40 offen offset:3072 sc1
v_mfma_f32_16x16x32_bf16 v[16:19], v[20:23], v[20:23], 0
Lps_408:
s_waitcnt vmcnt(2)
v_max3_u32 v26, v28, v29, v30
v_max_u32 v26, v26, v31
v_cmp_eq_u32 vcc, -1, v26
s_cbranch_vccnz Lpf_409
v_smfmac_f32_16x16x64_bf16 v[76:79], v[28:31], a[128:135], v126
v_smfmac_f32_16x16x64_bf16 v[80:83], v[28:31], a[136:143], v126
v_smfmac_f32_16x16x64_bf16 v[84:87], v[28:31], a[144:151], v126
v_smfmac_f32_16x16x64_bf16 v[88:91], v[28:31], a[152:159], v126
s_branch Lps_398
Lpf_389:
buffer_load_dwordx4 v[28:31], v9, s[4:7], s40 offen offset:0 sc1
v_mfma_f32_16x16x32_bf16 v[16:19], v[20:23], v[20:23], 0
s_sub_u32 s37, s37, 1
s_cbranch_scc1 Lend_1
Lps_410:
s_waitcnt vmcnt(1)
v_max3_u32 v26, v36, v37, v38
v_max_u32 v26, v26, v39
v_cmp_eq_u32 vcc, -1, v26
s_cbranch_vccnz Lpf_411
v_smfmac_f32_16x16x64_bf16 v[76:79], v[36:39], a[192:199], v126
v_smfmac_f32_16x16x64_bf16 v[80:83], v[36:39], a[200:207], v126
v_smfmac_f32_16x16x64_bf16 v[84:87], v[36:39], a[208:215], v126
v_smfmac_f32_16x16x64_bf16 v[88:91], v[36:39], a[216:223], v126
s_branch Lps_366
Lpf_391:
buffer_load_dwordx4 v[28:31], v9, s[4:7], s40 offen offset:0 sc1
v_mfma_f32_16x16x32_bf16 v[16:19], v[20:23], v[20:23], 0
s_sub_u32 s37, s37, 1
s_cbranch_scc1 Lend_1
s_branch Lps_364
Lpf_393:
buffer_load_dwordx4 v[40:43], v9, s[4:7], s40 offen offset:3072 sc1
v_mfma_f32_16x16x32_bf16 v[16:19], v[20:23], v[20:23], 0
Lps_412:
s_waitcnt vmcnt(2)
v_max3_u32 v26, v32, v33, v34
v_max_u32 v26, v26, v35
v_cmp_eq_u32 vcc, -1, v26
s_cbranch_vccnz Lpf_413
v_smfmac_f32_16x16x64_bf16 v[76:79], v[32:35], a[160:167], v126
v_smfmac_f32_16x16x64_bf16 v[80:83], v[32:35], a[168:175], v126
v_smfmac_f32_16x16x64_bf16 v[84:87], v[32:35], a[176:183], v126
v_smfmac_f32_16x16x64_bf16 v[88:91], v[32:35], a[184:191], v126
s_branch Lps_398
Lpf_395:
buffer_load_dwordx4 v[32:35], v9, s[4:7], s40 offen offset:1024 sc1
v_mfma_f32_16x16x32_bf16 v[16:19], v[20:23], v[20:23], 0
s_sub_u32 s37, s37, 1
s_cbranch_scc1 Lend_1
Lps_414:
s_waitcnt vmcnt(1)
v_max3_u32 v26, v36, v37, v38
v_max_u32 v26, v26, v39
v_cmp_eq_u32 vcc, -1, v26
s_cbranch_vccnz Lpf_415
v_smfmac_f32_16x16x64_bf16 v[76:79], v[36:39], a[192:199], v126
v_smfmac_f32_16x16x64_bf16 v[80:83], v[36:39], a[200:207], v126
v_smfmac_f32_16x16x64_bf16 v[84:87], v[36:39], a[208:215], v126
v_smfmac_f32_16x16x64_bf16 v[88:91], v[36:39], a[216:223], v126
s_branch Lps_372
Lpf_397:
buffer_load_dwordx4 v[32:35], v9, s[4:7], s40 offen offset:1024 sc1
v_mfma_f32_16x16x32_bf16 v[16:19], v[20:23], v[20:23], 0
s_sub_u32 s37, s37, 1
s_cbranch_scc1 Lend_1
s_branch Lps_370
Lpf_399:
buffer_load_dwordx4 v[36:39], v9, s[4:7], s40 offen offset:2048 sc1
v_mfma_f32_16x16x32_bf16 v[16:19], v[20:23], v[20:23], 0
s_sub_u32 s37, s37, 1
s_cbranch_scc1 Lend_1
s_branch Lps_374
Lpf_401:
buffer_load_dwordx4 v[40:43], v9, s[4:7], s40 offen offset:3072 sc1
v_mfma_f32_16x16x32_bf16 v[16:19], v[20:23], v[20:23], 0
Lps_416:
s_waitcnt vmcnt(3)
v_max3_u32 v26, v28, v29, v30
v_max_u32 v26, v26, v31
v_cmp_eq_u32 vcc, -1, v26
s_cbranch_vccnz Lpf_417
v_smfmac_f32_16x16x64_bf16 v[76:79], v[28:31], a[128:135], v126
v_smfmac_f32_16x16x64_bf16 v[80:83], v[28:31], a[136:143], v126
v_smfmac_f32_16x16x64_bf16 v[84:87], v[28:31], a[144:151], v126
v_smfmac_f32_16x16x64_bf16 v[88:91], v[28:31], a[152:159], v126
s_branch Lps_412
Lpf_403:
buffer_load_dwordx4 v[28:31], v9, s[4:7], s40 offen offset:0 sc1
v_mfma_f32_16x16x32_bf16 v[16:19], v[20:23], v[20:23], 0
s_sub_u32 s37, s37, 1
s_cbranch_scc1 Lend_1
Lps_418:
s_waitcnt vmcnt(2)
v_max3_u32 v26, v32, v33, v34
v_max_u32 v26, v26, v35
v_cmp_eq_u32 vcc, -1, v26
s_cbranch_vccnz Lpf_419
v_smfmac_f32_16x16x64_bf16 v[76:79], v[32:35], a[160:167], v126
v_smfmac_f32_16x16x64_bf16 v[80:83], v[32:35], a[168:175], v126
v_smfmac_f32_16x16x64_bf16 v[84:87], v[32:35], a[176:183], v126
v_smfmac_f32_16x16x64_bf16 v[88:91], v[32:35], a[184:191], v126
s_branch Lps_410
Lpf_405:
buffer_load_dwordx4 v[28:31], v9, s[4:7], s40 offen offset:0 sc1
v_mfma_f32_16x16x32_bf16 v[16:19], v[20:23], v[20:23], 0
s_sub_u32 s37, s37, 1
s_cbranch_scc1 Lend_1
Lps_420:
s_waitcnt vmcnt(2)
v_max3_u32 v26, v32, v33, v34
v_max_u32 v26, v26, v35
v_cmp_eq_u32 vcc, -1, v26
s_cbranch_vccnz Lpf_421
v_smfmac_f32_16x16x64_bf16 v[76:79], v[32:35], a[160:167], v126
v_smfmac_f32_16x16x64_bf16 v[80:83], v[32:35], a[168:175], v126
v_smfmac_f32_16x16x64_bf16 v[84:87], v[32:35], a[176:183], v126
v_smfmac_f32_16x16x64_bf16 v[88:91], v[32:35], a[184:191], v126
s_branch Lps_364
Lpf_407:
buffer_load_dwordx4 v[32:35], v9, s[4:7], s40 offen offset:1024 sc1
v_mfma_f32_16x16x32_bf16 v[16:19], v[20:23], v[20:23], 0
s_branch Lps_384
Lpf_409:
buffer_load_dwordx4 v[28:31], v9, s[4:7], s40 offen offset:0 sc1
v_mfma_f32_16x16x32_bf16 v[16:19], v[20:23], v[20:23], 0
s_sub_u32 s37, s37, 1
s_cbranch_scc1 Lend_1
s_branch Lps_362
Lpf_411:
buffer_load_dwordx4 v[36:39], v9, s[4:7], s40 offen offset:2048 sc1
v_mfma_f32_16x16x32_bf16 v[16:19], v[20:23], v[20:23], 0
s_branch Lps_388
Lpf_413:
buffer_load_dwordx4 v[32:35], v9, s[4:7], s40 offen offset:1024 sc1
v_mfma_f32_16x16x32_bf16 v[16:19], v[20:23], v[20:23], 0
s_sub_u32 s37, s37, 1
s_cbranch_scc1 Lend_1
s_branch Lps_368
Lpf_415:
buffer_load_dwordx4 v[36:39], v9, s[4:7], s40 offen offset:2048 sc1
v_mfma_f32_16x16x32_bf16 v[16:19], v[20:23], v[20:23], 0
s_branch Lps_394
Lpf_417:
buffer_load_dwordx4 v[28:31], v9, s[4:7], s40 offen offset:0 sc1
v_mfma_f32_16x16x32_bf16 v[16:19], v[20:23], v[20:23], 0
s_sub_u32 s37, s37, 1
s_cbranch_scc1 Lend_1
s_branch Lps_360
Lpf_419:
buffer_load_dwordx4 v[32:35], v9, s[4:7], s40 offen offset:1024 sc1
v_mfma_f32_16x16x32_bf16 v[16:19], v[20:23], v[20:23], 0
Lps_422:
s_waitcnt vmcnt(2)
v_max3_u32 v26, v36, v37, v38
v_max_u32 v26, v26, v39
v_cmp_eq_u32 vcc, -1, v26
s_cbranch_vccnz Lpf_423
v_smfmac_f32_16x16x64_bf16 v[76:79], v[36:39], a[192:199], v126
v_smfmac_f32_16x16x64_bf16 v[80:83], v[36:39], a[200:207], v126
v_smfmac_f32_16x16x64_bf16 v[84:87], v[36:39], a[208:215], v126
v_smfmac_f32_16x16x64_bf16 v[88:91], v[36:39], a[216:223], v126
s_branch Lps_384
Lpf_421:
buffer_load_dwordx4 v[32:35], v9, s[4:7], s40 offen offset:1024 sc1
v_mfma_f32_16x16x32_bf16 v[16:19], v[20:23], v[20:23], 0
s_branch Lps_382
Lpf_423:
buffer_load_dwordx4 v[36:39], v9, s[4:7], s40 offen offset:2048 sc1
v_mfma_f32_16x16x32_bf16 v[16:19], v[20:23], v[20:23], 0
s_branch Lps_402
Lkvo_sc1_274:
Lkvo_424:
s_and_b32 s38, s36, 3
s_lshl_b32 s39, s38, 16
s_add_u32 s40, s39, s45
s_xor_b32 s42, s40, 0x20000
s_add_u32 s26, s36, 1
s_mov_b64 exec, 15
buffer_load_dword v4, v1, s[4:7], s59 offen sc1
s_nop 11
buffer_load_dword v5, v1, s[4:7], s59 offen sc1
s_nop 11
buffer_load_dword v6, v1, s[4:7], s59 offen sc1
Lft_428:
s_waitcnt vmcnt(2)
v_cmp_gt_u32 vcc, s26, v4
s_cbranch_vccz Lfg_427
buffer_load_dword v4, v1, s[4:7], s59 offen sc1
s_waitcnt vmcnt(2)
v_cmp_gt_u32 vcc, s26, v5
s_cbranch_vccz Lfg_427
buffer_load_dword v5, v1, s[4:7], s59 offen sc1
s_waitcnt vmcnt(2)
v_cmp_gt_u32 vcc, s26, v6
s_cbranch_vccz Lfg_427
buffer_load_dword v6, v1, s[4:7], s59 offen sc1
s_sub_u32 s37, s37, 1
s_cbranch_scc1 Lend_1
s_branch Lft_428
Lfg_427:
s_mov_b64 exec, -1
Lkvo3_426:
buffer_load_dwordx4 v[28:31], v8, s[4:7], s40 offen offset:0 sc1
v_mfma_f32_16x16x32_bf16 v[16:19], v[20:23], v[20:23], 0
v_mfma_f32_16x16x32_bf16 v[16:19], v[20:23], v[20:23], 0
v_mfma_f32_16x16x32_bf16 v[16:19], v[20:23], v[20:23], 0
v_mfma_f32_16x16x32_bf16 v[16:19], v[20:23], v[20:23], 0
buffer_load_dwordx4 v[32:35], v8, s[4:7], s40 offen offset:1024 sc1
v_mfma_f32_16x16x32_bf16 v[16:19], v[20:23], v[20:23], 0
v_mfma_f32_16x16x32_bf16 v[16:19], v[20:23], v[20:23], 0
v_mfma_f32_16x16x32_bf16 v[16:19], v[20:23], v[20:23], 0
v_mfma_f32_16x16x32_bf16 v[16:19], v[20:23], v[20:23], 0
buffer_load_dwordx4 v[36:39], v8, s[4:7], s40 offen offset:2048 sc1
v_mfma_f32_16x16x32_bf16 v[16:19], v[20:23], v[20:23], 0
v_mfma_f32_16x16x32_bf16 v[16:19], v[20:23], v[20:23], 0
v_mfma_f32_16x16x32_bf16 v[16:19], v[20:23], v[20:23], 0
v_mfma_f32_16x16x32_bf16 v[16:19], v[20:23], v[20:23], 0
buffer_load_dwordx4 v[40:43], v8, s[4:7], s40 offen offset:3072 sc1
v_mfma_f32_16x16x32_bf16 v[16:19], v[20:23], v[20:23], 0
s_waitcnt vmcnt(3)
v_max3_u32 v26, v28, v29, v30
v_max_u32 v26, v26, v31
v_cmp_eq_u32 vcc, -1, v26
s_cbranch_vccnz Lpf_430
v_smfmac_f32_16x16x64_bf16 v[44:47], v[28:31], a[0:7], v126
v_smfmac_f32_16x16x64_bf16 v[48:51], v[28:31], a[8:15], v126
v_smfmac_f32_16x16x64_bf16 v[52:55], v[28:31], a[16:23], v126
v_smfmac_f32_16x16x64_bf16 v[56:59], v[28:31], a[24:31], v126
s_waitcnt vmcnt(2)
v_max3_u32 v26, v32, v33, v34
v_max_u32 v26, v26, v35
v_cmp_eq_u32 vcc, -1, v26
v_smfmac_f32_16x16x64_bf16 v[60:63], v[28:31], v[128:135], v126
v_smfmac_f32_16x16x64_bf16 v[64:67], v[28:31], v[136:143], v126
s_cbranch_vccnz Lpf_431
v_smfmac_f32_16x16x64_bf16 v[44:47], v[32:35], a[32:39], v126
v_smfmac_f32_16x16x64_bf16 v[48:51], v[32:35], a[40:47], v126
v_smfmac_f32_16x16x64_bf16 v[52:55], v[32:35], a[48:55], v126
v_smfmac_f32_16x16x64_bf16 v[56:59], v[32:35], a[56:63], v126
s_waitcnt vmcnt(1)
v_max3_u32 v26, v36, v37, v38
v_max_u32 v26, v26, v39
v_cmp_eq_u32 vcc, -1, v26
v_smfmac_f32_16x16x64_bf16 v[60:63], v[32:35], v[160:167], v126
v_smfmac_f32_16x16x64_bf16 v[64:67], v[32:35], v[168:175], v126
s_cbranch_vccnz Lpf_432
v_smfmac_f32_16x16x64_bf16 v[44:47], v[36:39], a[64:71], v126
v_smfmac_f32_16x16x64_bf16 v[48:51], v[36:39], a[72:79], v126
v_smfmac_f32_16x16x64_bf16 v[52:55], v[36:39], a[80:87], v126
v_smfmac_f32_16x16x64_bf16 v[56:59], v[36:39], a[88:95], v126
s_waitcnt vmcnt(0)
v_max3_u32 v26, v40, v41, v42
v_max_u32 v26, v26, v43
v_cmp_eq_u32 vcc, -1, v26
v_smfmac_f32_16x16x64_bf16 v[60:63], v[36:39], v[192:199], v126
v_smfmac_f32_16x16x64_bf16 v[64:67], v[36:39], v[200:207], v126
s_cbranch_vccnz Lpf_433
v_smfmac_f32_16x16x64_bf16 v[44:47], v[40:43], a[96:103], v126
v_smfmac_f32_16x16x64_bf16 v[48:51], v[40:43], a[104:111], v126
v_smfmac_f32_16x16x64_bf16 v[52:55], v[40:43], a[112:119], v126
v_smfmac_f32_16x16x64_bf16 v[56:59], v[40:43], a[120:127], v126
v_smfmac_f32_16x16x64_bf16 v[60:63], v[40:43], v[224:231], v126
v_smfmac_f32_16x16x64_bf16 v[64:67], v[40:43], v[232:239], v126
Lpd_429:
s_nop 2
v_add_f32 v92, v44, v45
v_add_f32 v93, v46, v47
v_add_f32 v94, v48, v49
v_add_f32 v95, v50, v51
v_add_f32 v96, v52, v53
ds_write_addtid_b32 v92 offset:0
v_add_f32 v97, v54, v55
ds_write_addtid_b32 v93 offset:640
v_add_f32 v98, v56, v57
ds_write_addtid_b32 v94 offset:288
v_add_f32 v99, v58, v59
ds_write_addtid_b32 v95 offset:928
ds_write_addtid_b32 v96 offset:1280
ds_write_addtid_b32 v97 offset:1920
ds_write_addtid_b32 v98 offset:1568
v_smfmac_f32_16x16x64_bf16 v[68:71], v[28:31], v[144:151], v126
ds_write_addtid_b32 v99 offset:2208
v_smfmac_f32_16x16x64_bf16 v[72:75], v[28:31], v[152:159], v126
v_smfmac_f32_16x16x64_bf16 v[68:71], v[32:35], v[176:183], v126
v_smfmac_f32_16x16x64_bf16 v[72:75], v[32:35], v[184:191], v126
s_waitcnt lgkmcnt(0)
s_barrier
ds_read_b64 v[100:101], v24 offset:0
ds_read_b64 v[102:103], v24 offset:2560
ds_read_b64 v[104:105], v24 offset:5120
ds_read_b64 v[106:107], v24 offset:7680
v_smfmac_f32_16x16x64_bf16 v[68:71], v[36:39], v[208:215], v126
v_smfmac_f32_16x16x64_bf16 v[72:75], v[36:39], v[216:223], v126
v_smfmac_f32_16x16x64_bf16 v[68:71], v[40:43], v[240:247], v126
s_waitcnt lgkmcnt(0)
v_pk_add_f32 v[100:101], v[100:101], v[102:103]
v_pk_add_f32 v[104:105], v[104:105], v[106:107]
v_pk_add_f32 v[116:117], v[100:101], v[104:105]
v_cvt_pk_bf16_f32 v116, v116, v117
v_min_u32 v116, -2, v116
buffer_store_dword v116, v11, s[4:7], s40 offen sc1
v_smfmac_f32_16x16x64_bf16 v[72:75], v[40:43], v[248:255], v126
s_nop 5
v_add_f32 v92, v60, v61
v_add_f32 v93, v62, v63
v_add_f32 v94, v64, v65
v_add_f32 v95, v66, v67
v_add_f32 v96, v68, v69
v_add_f32 v97, v70, v71
v_add_f32 v98, v72, v73
v_add_f32 v99, v74, v75
ds_write_b128 v25, v[92:95] offset:20480
ds_write_b128 v25, v[96:99] offset:20496
s_waitcnt lgkmcnt(0)
s_barrier
ds_read_b64 v[100:101], v127 offset:20480
ds_read_b64 v[102:103], v127 offset:22528
ds_read_b64 v[104:105], v127 offset:24576
ds_read_b64 v[106:107], v127 offset:26624
s_waitcnt lgkmcnt(0)
v_pk_add_f32 v[100:101], v[100:101], v[102:103]
v_pk_add_f32 v[104:105], v[104:105], v[106:107]
v_pk_add_f32 v[116:117], v[100:101], v[104:105]
v_cvt_pk_bf16_f32 v116, v116, v117
v_min_u32 v116, -2, v116
buffer_store_dword v116, v27, s[4:7], s40 offen sc1
s_cmp_eq_u32 s36, 63
s_cbranch_scc1 Lend_1
buffer_store_dword v120, v11, s[4:7], s42 offen sc1
buffer_store_dword v120, v27, s[4:7], s42 offen sc1
s_cmp_lt_u32 s32, 2
s_cbranch_scc1 Lr1_434
buffer_store_dwordx2 v[120:121], v10, s[4:7], s42 offen sc1
Lr1_434:
v_pk_mul_f32 v[44:45], 0, 0
v_pk_mul_f32 v[46:47], 0, 0
v_pk_mul_f32 v[48:49], 0, 0
v_pk_mul_f32 v[50:51], 0, 0
v_pk_mul_f32 v[52:53], 0, 0
v_pk_mul_f32 v[54:55], 0, 0
v_pk_mul_f32 v[56:57], 0, 0
v_pk_mul_f32 v[58:59], 0, 0
v_pk_mul_f32 v[60:61], 0, 0
v_pk_mul_f32 v[62:63], 0, 0
v_pk_mul_f32 v[64:65], 0, 0
v_pk_mul_f32 v[66:67], 0, 0
v_pk_mul_f32 v[68:69], 0, 0
v_pk_mul_f32 v[70:71], 0, 0
v_pk_mul_f32 v[72:73], 0, 0
v_pk_mul_f32 v[74:75], 0, 0
v_pk_mul_f32 v[76:77], 0, 0
v_pk_mul_f32 v[78:79], 0, 0
v_pk_mul_f32 v[80:81], 0, 0
v_pk_mul_f32 v[82:83], 0, 0
v_pk_mul_f32 v[84:85], 0, 0
v_pk_mul_f32 v[86:87], 0, 0
v_pk_mul_f32 v[88:89], 0, 0
v_pk_mul_f32 v[90:91], 0, 0
v_add_u32 v7, 1, v7
s_and_b32 s38, s36, 3
s_lshl_b32 s84, s38, 18
s_add_u32 s84, s84, s46
s_add_u32 s85, s84, 0x100000
s_and_b32 s38, s26, 3
s_lshl_b32 s38, s38, 16
s_add_u32 s41, s38, s45
s_mov_b64 exec, 3
buffer_load_dword v4, v2, s[4:7], s59 offen sc1
s_nop 11
buffer_load_dword v5, v2, s[4:7], s59 offen sc1
s_nop 11
buffer_load_dword v6, v2, s[4:7], s59 offen sc1
Lft_436:
s_waitcnt vmcnt(2)
v_cmp_gt_u32 vcc, s26, v4
s_cbranch_vccz Lfg_435
buffer_load_dword v4, v2, s[4:7], s59 offen sc1
s_waitcnt vmcnt(2)
v_cmp_gt_u32 vcc, s26, v5
s_cbranch_vccz Lfg_435
buffer_load_dword v5, v2, s[4:7], s59 offen sc1
s_waitcnt vmcnt(2)
v_cmp_gt_u32 vcc, s26, v6
s_cbranch_vccz Lfg_435
buffer_load_dword v6, v2, s[4:7], s59 offen sc1
s_sub_u32 s37, s37, 1
s_cbranch_scc1 Lend_1
s_branch Lft_436
Lfg_435:
s_mov_b64 exec, -1
buffer_load_dwordx4 v[28:31], v9, s[4:7], s40 offen offset:0 sc1
v_mfma_f32_16x16x32_bf16 v[16:19], v[20:23], v[20:23], 0
v_mfma_f32_16x16x32_bf16 v[16:19], v[20:23], v[20:23], 0
v_mfma_f32_16x16x32_bf16 v[16:19], v[20:23], v[20:23], 0
v_mfma_f32_16x16x32_bf16 v[16:19], v[20:23], v[20:23], 0
buffer_load_dwordx4 v[32:35], v9, s[4:7], s40 offen offset:1024 sc1
v_mfma_f32_16x16x32_bf16 v[16:19], v[20:23], v[20:23], 0
v_mfma_f32_16x16x32_bf16 v[16:19], v[20:23], v[20:23], 0
v_mfma_f32_16x16x32_bf16 v[16:19], v[20:23], v[20:23], 0
v_mfma_f32_16x16x32_bf16 v[16:19], v[20:23], v[20:23], 0
buffer_load_dwordx4 v[36:39], v9, s[4:7], s40 offen offset:2048 sc1
v_mfma_f32_16x16x32_bf16 v[16:19], v[20:23], v[20:23], 0
v_mfma_f32_16x16x32_bf16 v[16:19], v[20:23], v[20:23], 0
v_mfma_f32_16x16x32_bf16 v[16:19], v[20:23], v[20:23], 0
v_mfma_f32_16x16x32_bf16 v[16:19], v[20:23], v[20:23], 0
buffer_load_dwordx4 v[40:43], v9, s[4:7], s40 offen offset:3072 sc1
v_mfma_f32_16x16x32_bf16 v[16:19], v[20:23], v[20:23], 0
s_waitcnt vmcnt(3)
v_max3_u32 v26, v28, v29, v30
v_max_u32 v26, v26, v31
v_cmp_eq_u32 vcc, -1, v26
s_cbranch_vccnz Lpf_438
v_smfmac_f32_16x16x64_bf16 v[76:79], v[28:31], a[128:135], v126
v_smfmac_f32_16x16x64_bf16 v[80:83], v[28:31], a[136:143], v126
s_waitcnt vmcnt(2)
v_max3_u32 v26, v32, v33, v34
v_max_u32 v26, v26, v35
v_cmp_eq_u32 vcc, -1, v26
v_smfmac_f32_16x16x64_bf16 v[84:87], v[28:31], a[144:151], v126
v_smfmac_f32_16x16x64_bf16 v[88:91], v[28:31], a[152:159], v126
s_cbranch_vccnz Lpf_439
v_smfmac_f32_16x16x64_bf16 v[76:79], v[32:35], a[160:167], v126
v_smfmac_f32_16x16x64_bf16 v[80:83], v[32:35], a[168:175], v126
s_waitcnt vmcnt(1)
v_max3_u32 v26, v36, v37, v38
v_max_u32 v26, v26, v39
v_cmp_eq_u32 vcc, -1, v26
v_smfmac_f32_16x16x64_bf16 v[84:87], v[32:35], a[176:183], v126
v_smfmac_f32_16x16x64_bf16 v[88:91], v[32:35], a[184:191], v126
s_cbranch_vccnz Lpf_440
v_smfmac_f32_16x16x64_bf16 v[76:79], v[36:39], a[192:199], v126
v_smfmac_f32_16x16x64_bf16 v[80:83], v[36:39], a[200:207], v126
s_waitcnt vmcnt(0)
v_max3_u32 v26, v40, v41, v42
v_max_u32 v26, v26, v43
v_cmp_eq_u32 vcc, -1, v26
v_smfmac_f32_16x16x64_bf16 v[84:87], v[36:39], a[208:215], v126
v_smfmac_f32_16x16x64_bf16 v[88:91], v[36:39], a[216:223], v126
s_cbranch_vccnz Lpf_441
v_smfmac_f32_16x16x64_bf16 v[76:79], v[40:43], a[224:231], v126
v_smfmac_f32_16x16x64_bf16 v[80:83], v[40:43], a[232:239], v126
v_smfmac_f32_16x16x64_bf16 v[84:87], v[40:43], a[240:247], v126
v_smfmac_f32_16x16x64_bf16 v[88:91], v[40:43], a[248:255], v126
Lpd_437:
s_nop 4
v_add_f32 v92, v76, v77
v_add_f32 v93, v78, v79
v_add_f32 v94, v80, v81
v_add_f32 v95, v82, v83
v_add_f32 v96, v84, v85
ds_write_addtid_b32 v92 offset:10240
v_add_f32 v97, v86, v87
ds_write_addtid_b32 v93 offset:10528
v_add_f32 v98, v88, v89
ds_write_addtid_b32 v94 offset:10816
v_add_f32 v99, v90, v91
ds_write_addtid_b32 v95 offset:11104
ds_write_addtid_b32 v96 offset:11392
ds_write_addtid_b32 v97 offset:11680
ds_write_addtid_b32 v98 offset:11968
ds_write_addtid_b32 v99 offset:12256
v_mfma_f32_16x16x32_bf16 v[16:19], v[20:23], v[20:23], 0
v_mfma_f32_16x16x32_bf16 v[16:19], v[20:23], v[20:23], 0
s_cmp_ge_u32 s32, 2
s_cbranch_scc1 Lxl_442
s_waitcnt lgkmcnt(0)
s_barrier
ds_read_b64 v[100:101], v0 offset:10240
ds_read_b64 v[102:103], v0 offset:10816
ds_read_b64 v[104:105], v0 offset:12800
ds_read_b64 v[106:107], v0 offset:13376
ds_read_b64 v[108:109], v0 offset:15360
ds_read_b64 v[110:111], v0 offset:15936
ds_read_b64 v[112:113], v0 offset:17920
ds_read_b64 v[114:115], v0 offset:18496
s_waitcnt lgkmcnt(4)
v_pk_add_f32 v[100:101], v[100:101], v[104:105]
v_pk_add_f32 v[102:103], v[102:103], v[106:107]
s_waitcnt lgkmcnt(0)
v_pk_add_f32 v[108:109], v[108:109], v[112:113]
v_pk_add_f32 v[110:111], v[110:111], v[114:115]
v_pk_add_f32 v[116:117], v[100:101], v[108:109]
v_pk_add_f32 v[118:119], v[102:103], v[110:111]
v_cvt_pk_bf16_f32 v116, v116, v117
v_cvt_pk_bf16_f32 v117, v118, v119
v_min_u32 v116, -2, v116
v_min_u32 v117, -2, v117
buffer_store_dwordx2 v[116:117], v12, s[4:7], s84 offen sc1
buffer_store_dwordx2 v[116:117], v12, s[4:7], s85 offen sc1
v_mfma_f32_16x16x32_bf16 v[16:19], v[20:23], v[20:23], 0
v_mfma_f32_16x16x32_bf16 v[16:19], v[20:23], v[20:23], 0
v_mfma_f32_16x16x32_bf16 v[16:19], v[20:23], v[20:23], 0
v_mfma_f32_16x16x32_bf16 v[16:19], v[20:23], v[20:23], 0
v_mfma_f32_16x16x32_bf16 v[16:19], v[20:23], v[20:23], 0
v_mfma_f32_16x16x32_bf16 v[16:19], v[20:23], v[20:23], 0
v_mfma_f32_16x16x32_bf16 v[16:19], v[20:23], v[20:23], 0
v_mfma_f32_16x16x32_bf16 v[16:19], v[20:23], v[20:23], 0
v_mfma_f32_16x16x32_bf16 v[16:19], v[20:23], v[20:23], 0
v_mfma_f32_16x16x32_bf16 v[16:19], v[20:23], v[20:23], 0
v_mfma_f32_16x16x32_bf16 v[16:19], v[20:23], v[20:23], 0
v_mfma_f32_16x16x32_bf16 v[16:19], v[20:23], v[20:23], 0
v_mfma_f32_16x16x32_bf16 v[16:19], v[20:23], v[20:23], 0
v_mfma_f32_16x16x32_bf16 v[16:19], v[20:23], v[20:23], 0
v_mfma_f32_16x16x32_bf16 v[16:19], v[20:23], v[20:23], 0
v_mfma_f32_16x16x32_bf16 v[16:19], v[20:23], v[20:23], 0
v_mfma_f32_16x16x32_bf16 v[16:19], v[20:23], v[20:23], 0
v_mfma_f32_16x16x32_bf16 v[16:19], v[20:23], v[20:23], 0
v_mfma_f32_16x16x32_bf16 v[16:19], v[20:23], v[20:23], 0
v_mfma_f32_16x16x32_bf16 v[16:19], v[20:23], v[20:23], 0
v_mfma_f32_16x16x32_bf16 v[16:19], v[20:23], v[20:23], 0
v_mfma_f32_16x16x32_bf16 v[16:19], v[20:23], v[20:23], 0
v_mfma_f32_16x16x32_bf16 v[16:19], v[20:23], v[20:23], 0
v_mfma_f32_16x16x32_bf16 v[16:19], v[20:23], v[20:23], 0
v_mfma_f32_16x16x32_bf16 v[16:19], v[20:23], v[20:23], 0
v_mfma_f32_16x16x32_bf16 v[16:19], v[20:23], v[20:23], 0
v_mfma_f32_16x16x32_bf16 v[16:19], v[20:23], v[20:23], 0
v_mfma_f32_16x16x32_bf16 v[16:19], v[20:23], v[20:23], 0
v_mfma_f32_16x16x32_bf16 v[16:19], v[20:23], v[20:23], 0
v_mfma_f32_16x16x32_bf16 v[16:19], v[20:23], v[20:23], 0
v_mfma_f32_16x16x32_bf16 v[16:19], v[20:23], v[20:23], 0
v_mfma_f32_16x16x32_bf16 v[16:19], v[20:23], v[20:23], 0
v_mfma_f32_16x16x32_bf16 v[16:19], v[20:23], v[20:23], 0
v_mfma_f32_16x16x32_bf16 v[16:19], v[20:23], v[20:23], 0
v_mfma_f32_16x16x32_bf16 v[16:19], v[20:23], v[20:23], 0
v_mfma_f32_16x16x32_bf16 v[16:19], v[20:23], v[20:23], 0
buffer_store_dword v7, v3, s[4:7], s59 offen sc1
s_add_u32 s36, s36, 1
s_branch Lkvo_424
Lxl_442:
s_waitcnt lgkmcnt(0)
s_barrier
v_mfma_f32_16x16x32_bf16 v[16:19], v[20:23], v[20:23], 0
v_mfma_f32_16x16x32_bf16 v[16:19], v[20:23], v[20:23], 0
v_mfma_f32_16x16x32_bf16 v[16:19], v[20:23], v[20:23], 0
v_mfma_f32_16x16x32_bf16 v[16:19], v[20:23], v[20:23], 0
v_mfma_f32_16x16x32_bf16 v[16:19], v[20:23], v[20:23], 0
v_mfma_f32_16x16x32_bf16 v[16:19], v[20:23], v[20:23], 0
v_mfma_f32_16x16x32_bf16 v[16:19], v[20:23], v[20:23], 0
v_mfma_f32_16x16x32_bf16 v[16:19], v[20:23], v[20:23], 0
v_mfma_f32_16x16x32_bf16 v[16:19], v[20:23], v[20:23], 0
v_mfma_f32_16x16x32_bf16 v[16:19], v[20:23], v[20:23], 0
v_mfma_f32_16x16x32_bf16 v[16:19], v[20:23], v[20:23], 0
v_mfma_f32_16x16x32_bf16 v[16:19], v[20:23], v[20:23], 0
v_mfma_f32_16x16x32_bf16 v[16:19], v[20:23], v[20:23], 0
v_mfma_f32_16x16x32_bf16 v[16:19], v[20:23], v[20:23], 0
v_mfma_f32_16x16x32_bf16 v[16:19], v[20:23], v[20:23], 0
v_mfma_f32_16x16x32_bf16 v[16:19], v[20:23], v[20:23], 0
v_mfma_f32_16x16x32_bf16 v[16:19], v[20:23], v[20:23], 0
v_mfma_f32_16x16x32_bf16 v[16:19], v[20:23], v[20:23], 0
v_mfma_f32_16x16x32_bf16 v[16:19], v[20:23], v[20:23], 0
v_mfma_f32_16x16x32_bf16 v[16:19], v[20:23], v[20:23], 0
v_mfma_f32_16x16x32_bf16 v[16:19], v[20:23], v[20:23], 0
v_mfma_f32_16x16x32_bf16 v[16:19], v[20:23], v[20:23], 0
v_mfma_f32_16x16x32_bf16 v[16:19], v[20:23], v[20:23], 0
v_mfma_f32_16x16x32_bf16 v[16:19], v[20:23], v[20:23], 0
v_mfma_f32_16x16x32_bf16 v[16:19], v[20:23], v[20:23], 0
v_mfma_f32_16x16x32_bf16 v[16:19], v[20:23], v[20:23], 0
v_mfma_f32_16x16x32_bf16 v[16:19], v[20:23], v[20:23], 0
v_mfma_f32_16x16x32_bf16 v[16:19], v[20:23], v[20:23], 0
buffer_load_dwordx2 v[76:77], v13, s[4:7], s84 offen sc1
buffer_load_dwordx2 v[78:79], v14, s[4:7], s84 offen sc1
buffer_load_dwordx2 v[80:81], v15, s[4:7], s84 offen sc1
v_mfma_f32_16x16x32_bf16 v[16:19], v[20:23], v[20:23], 0
v_mfma_f32_16x16x32_bf16 v[16:19], v[20:23], v[20:23], 0
v_mfma_f32_16x16x32_bf16 v[16:19], v[20:23], v[20:23], 0
v_mfma_f32_16x16x32_bf16 v[16:19], v[20:23], v[20:23], 0
v_mfma_f32_16x16x32_bf16 v[16:19], v[20:23], v[20:23], 0
v_mfma_f32_16x16x32_bf16 v[16:19], v[20:23], v[20:23], 0
v_mfma_f32_16x16x32_bf16 v[16:19], v[20:23], v[20:23], 0
v_mfma_f32_16x16x32_bf16 v[16:19], v[20:23], v[20:23], 0
v_mfma_f32_16x16x32_bf16 v[16:19], v[20:23], v[20:23], 0
v_mfma_f32_16x16x32_bf16 v[16:19], v[20:23], v[20:23], 0
v_mfma_f32_16x16x32_bf16 v[16:19], v[20:23], v[20:23], 0
v_mfma_f32_16x16x32_bf16 v[16:19], v[20:23], v[20:23], 0
buffer_load_dwordx2 v[88:89], v13, s[4:7], s85 offen sc1
buffer_load_dwordx2 v[90:91], v14, s[4:7], s85 offen sc1
buffer_load_dwordx2 v[92:93], v15, s[4:7], s85 offen sc1
ds_read_b64 v[100:101], v0 offset:10240
ds_read_b64 v[102:103], v0 offset:10816
ds_read_b64 v[104:105], v0 offset:12800
ds_read_b64 v[106:107], v0 offset:13376
ds_read_b64 v[108:109], v0 offset:15360
ds_read_b64 v[110:111], v0 offset:15936
ds_read_b64 v[112:113], v0 offset:17920
ds_read_b64 v[114:115], v0 offset:18496
s_waitcnt lgkmcnt(4)
v_pk_add_f32 v[100:101], v[100:101], v[104:105]
v_pk_add_f32 v[102:103], v[102:103], v[106:107]
s_waitcnt lgkmcnt(0)
v_pk_add_f32 v[108:109], v[108:109], v[112:113]
v_pk_add_f32 v[110:111], v[110:111], v[114:115]
v_pk_add_f32 v[116:117], v[100:101], v[108:109]
v_pk_add_f32 v[118:119], v[102:103], v[110:111]
v_cvt_pk_bf16_f32 v100, v116, v117
v_cvt_pk_bf16_f32 v101, v118, v119
v_lshlrev_b32 v116, 16, v100
v_and_b32 v117, 0xffff0000, v100
v_lshlrev_b32 v118, 16, v101
v_and_b32 v119, 0xffff0000, v101
v_mfma_f32_16x16x32_bf16 v[16:19], v[20:23], v[20:23], 0
v_mfma_f32_16x16x32_bf16 v[16:19], v[20:23], v[20:23], 0
v_mfma_f32_16x16x32_bf16 v[16:19], v[20:23], v[20:23], 0
v_mfma_f32_16x16x32_bf16 v[16:19], v[20:23], v[20:23], 0
buffer_load_dwordx2 v[28:29], v13, s[4:7], s84 offen sc1
buffer_load_dwordx2 v[30:31], v14, s[4:7], s84 offen sc1
buffer_load_dwordx2 v[32:33], v15, s[4:7], s84 offen sc1
s_waitcnt vmcnt(6)
v_max3_u32 v26, v76, v77, v78
v_max3_u32 v26, v26, v79, v80
v_max_u32 v26, v26, v81
v_cmp_eq_u32 vcc, -1, v26
v_dot2_f32_bf16 v100, v76, s55, v116
v_dot2_f32_bf16 v101, v76, s56, v117
v_dot2_f32_bf16 v102, v77, s55, v118
v_dot2_f32_bf16 v103, v77, s56, v119
v_dot2_f32_bf16 v100, v78, s55, v100
v_dot2_f32_bf16 v101, v78, s56, v101
v_dot2_f32_bf16 v102, v79, s55, v102
v_dot2_f32_bf16 v103, v79, s56, v103
v_dot2_f32_bf16 v100, v80, s55, v100
v_dot2_f32_bf16 v101, v80, s56, v101
v_dot2_f32_bf16 v102, v81, s55, v102
v_dot2_f32_bf16 v103, v81, s56, v103
s_nop 1
v_cvt_pk_bf16_f32 v100, v100, v101
v_cvt_pk_bf16_f32 v101, v102, v103
v_min_u32 v100, -2, v100
v_min_u32 v101, -2, v101
s_cbranch_vccnz Lx2_443
Lxs_444:
buffer_store_dwordx2 v[100:101], v10, s[4:7], s41 offen sc1
s_add_u32 s36, s36, 1
s_and_b32 s38, s36, 3
s_lshl_b32 s39, s38, 16
s_add_u32 s40, s39, s45
s_xor_b32 s42, s40, 0x20000
s_add_u32 s26, s36, 1
v_mfma_f32_16x16x32_bf16 v[16:19], v[20:23], v[20:23], 0
v_mfma_f32_16x16x32_bf16 v[16:19], v[20:23], v[20:23], 0
v_mfma_f32_16x16x32_bf16 v[16:19], v[20:23], v[20:23], 0
v_mfma_f32_16x16x32_bf16 v[16:19], v[20:23], v[20:23], 0
v_mfma_f32_16x16x32_bf16 v[16:19], v[20:23], v[20:23], 0
v_mfma_f32_16x16x32_bf16 v[16:19], v[20:23], v[20:23], 0
v_mfma_f32_16x16x32_bf16 v[16:19], v[20:23], v[20:23], 0
v_mfma_f32_16x16x32_bf16 v[16:19], v[20:23], v[20:23], 0
s_branch Lkvo3_426
Lx2_443:
buffer_load_dwordx2 v[76:77], v13, s[4:7], s85 offen sc1
buffer_load_dwordx2 v[78:79], v14, s[4:7], s85 offen sc1
buffer_load_dwordx2 v[80:81], v15, s[4:7], s85 offen sc1
s_waitcnt vmcnt(6)
v_max3_u32 v26, v88, v89, v90
v_max3_u32 v26, v26, v91, v92
v_max_u32 v26, v26, v93
v_cmp_eq_u32 vcc, -1, v26
v_dot2_f32_bf16 v100, v88, s55, v116
v_dot2_f32_bf16 v101, v88, s56, v117
v_dot2_f32_bf16 v102, v89, s55, v118
v_dot2_f32_bf16 v103, v89, s56, v119
v_dot2_f32_bf16 v100, v90, s55, v100
v_dot2_f32_bf16 v101, v90, s56, v101
v_dot2_f32_bf16 v102, v91, s55, v102
v_dot2_f32_bf16 v103, v91, s56, v103
v_dot2_f32_bf16 v100, v92, s55, v100
v_dot2_f32_bf16 v101, v92, s56, v101
v_dot2_f32_bf16 v102, v93, s55, v102
v_dot2_f32_bf16 v103, v93, s56, v103
s_nop 1
v_cvt_pk_bf16_f32 v100, v100, v101
v_cvt_pk_bf16_f32 v101, v102, v103
v_min_u32 v100, -2, v100
v_min_u32 v101, -2, v101
s_cbranch_vccz Lxs_444
buffer_load_dwordx2 v[88:89], v13, s[4:7], s84 offen sc1
buffer_load_dwordx2 v[90:91], v14, s[4:7], s84 offen sc1
buffer_load_dwordx2 v[92:93], v15, s[4:7], s84 offen sc1
s_waitcnt vmcnt(6)
v_max3_u32 v26, v28, v29, v30
v_max3_u32 v26, v26, v31, v32
v_max_u32 v26, v26, v33
v_cmp_eq_u32 vcc, -1, v26
v_dot2_f32_bf16 v100, v28, s55, v116
v_dot2_f32_bf16 v101, v28, s56, v117
v_dot2_f32_bf16 v102, v29, s55, v118
v_dot2_f32_bf16 v103, v29, s56, v119
v_dot2_f32_bf16 v100, v30, s55, v100
v_dot2_f32_bf16 v101, v30, s56, v101
v_dot2_f32_bf16 v102, v31, s55, v102
v_dot2_f32_bf16 v103, v31, s56, v103
v_dot2_f32_bf16 v100, v32, s55, v100
v_dot2_f32_bf16 v101, v32, s56, v101
v_dot2_f32_bf16 v102, v33, s55, v102
v_dot2_f32_bf16 v103, v33, s56, v103
s_nop 1
v_cvt_pk_bf16_f32 v100, v100, v101
v_cvt_pk_bf16_f32 v101, v102, v103
v_min_u32 v100, -2, v100
v_min_u32 v101, -2, v101
s_cbranch_vccz Lxs_444
buffer_load_dwordx2 v[28:29], v13, s[4:7], s85 offen sc1
buffer_load_dwordx2 v[30:31], v14, s[4:7], s85 offen sc1
buffer_load_dwordx2 v[32:33], v15, s[4:7], s85 offen sc1
s_waitcnt vmcnt(6)
v_max3_u32 v26, v76, v77, v78
v_max3_u32 v26, v26, v79, v80
v_max_u32 v26, v26, v81
v_cmp_eq_u32 vcc, -1, v26
v_dot2_f32_bf16 v100, v76, s55, v116
v_dot2_f32_bf16 v101, v76, s56, v117
v_dot2_f32_bf16 v102, v77, s55, v118
v_dot2_f32_bf16 v103, v77, s56, v119
v_dot2_f32_bf16 v100, v78, s55, v100
v_dot2_f32_bf16 v101, v78, s56, v101
v_dot2_f32_bf16 v102, v79, s55, v102
v_dot2_f32_bf16 v103, v79, s56, v103
v_dot2_f32_bf16 v100, v80, s55, v100
v_dot2_f32_bf16 v101, v80, s56, v101
v_dot2_f32_bf16 v102, v81, s55, v102
v_dot2_f32_bf16 v103, v81, s56, v103
s_nop 1
v_cvt_pk_bf16_f32 v100, v100, v101
v_cvt_pk_bf16_f32 v101, v102, v103
v_min_u32 v100, -2, v100
v_min_u32 v101, -2, v101
s_cbranch_vccz Lxs_444
buffer_load_dwordx2 v[76:77], v13, s[4:7], s84 offen sc1
buffer_load_dwordx2 v[78:79], v14, s[4:7], s84 offen sc1
buffer_load_dwordx2 v[80:81], v15, s[4:7], s84 offen sc1
s_waitcnt vmcnt(6)
v_max3_u32 v26, v88, v89, v90
v_max3_u32 v26, v26, v91, v92
v_max_u32 v26, v26, v93
v_cmp_eq_u32 vcc, -1, v26
v_dot2_f32_bf16 v100, v88, s55, v116
v_dot2_f32_bf16 v101, v88, s56, v117
v_dot2_f32_bf16 v102, v89, s55, v118
v_dot2_f32_bf16 v103, v89, s56, v119
v_dot2_f32_bf16 v100, v90, s55, v100
v_dot2_f32_bf16 v101, v90, s56, v101
v_dot2_f32_bf16 v102, v91, s55, v102
v_dot2_f32_bf16 v103, v91, s56, v103
v_dot2_f32_bf16 v100, v92, s55, v100
v_dot2_f32_bf16 v101, v92, s56, v101
v_dot2_f32_bf16 v102, v93, s55, v102
v_dot2_f32_bf16 v103, v93, s56, v103
s_nop 1
v_cvt_pk_bf16_f32 v100, v100, v101
v_cvt_pk_bf16_f32 v101, v102, v103
v_min_u32 v100, -2, v100
v_min_u32 v101, -2, v101
s_cbranch_vccz Lxs_444
buffer_load_dwordx2 v[88:89], v13, s[4:7], s85 offen sc1
buffer_load_dwordx2 v[90:91], v14, s[4:7], s85 offen sc1
buffer_load_dwordx2 v[92:93], v15, s[4:7], s85 offen sc1
s_waitcnt vmcnt(6)
v_max3_u32 v26, v28, v29, v30
v_max3_u32 v26, v26, v31, v32
v_max_u32 v26, v26, v33
v_cmp_eq_u32 vcc, -1, v26
v_dot2_f32_bf16 v100, v28, s55, v116
v_dot2_f32_bf16 v101, v28, s56, v117
v_dot2_f32_bf16 v102, v29, s55, v118
v_dot2_f32_bf16 v103, v29, s56, v119
v_dot2_f32_bf16 v100, v30, s55, v100
v_dot2_f32_bf16 v101, v30, s56, v101
v_dot2_f32_bf16 v102, v31, s55, v102
v_dot2_f32_bf16 v103, v31, s56, v103
v_dot2_f32_bf16 v100, v32, s55, v100
v_dot2_f32_bf16 v101, v32, s56, v101
v_dot2_f32_bf16 v102, v33, s55, v102
v_dot2_f32_bf16 v103, v33, s56, v103
s_nop 1
v_cvt_pk_bf16_f32 v100, v100, v101
v_cvt_pk_bf16_f32 v101, v102, v103
v_min_u32 v100, -2, v100
v_min_u32 v101, -2, v101
s_cbranch_vccz Lxs_444
buffer_load_dwordx2 v[28:29], v13, s[4:7], s84 offen sc1
buffer_load_dwordx2 v[30:31], v14, s[4:7], s84 offen sc1
buffer_load_dwordx2 v[32:33], v15, s[4:7], s84 offen sc1
s_waitcnt vmcnt(6)
v_max3_u32 v26, v76, v77, v78
v_max3_u32 v26, v26, v79, v80
v_max_u32 v26, v26, v81
v_cmp_eq_u32 vcc, -1, v26
v_dot2_f32_bf16 v100, v76, s55, v116
v_dot2_f32_bf16 v101, v76, s56, v117
v_dot2_f32_bf16 v102, v77, s55, v118
v_dot2_f32_bf16 v103, v77, s56, v119
v_dot2_f32_bf16 v100, v78, s55, v100
v_dot2_f32_bf16 v101, v78, s56, v101
v_dot2_f32_bf16 v102, v79, s55, v102
v_dot2_f32_bf16 v103, v79, s56, v103
v_dot2_f32_bf16 v100, v80, s55, v100
v_dot2_f32_bf16 v101, v80, s56, v101
v_dot2_f32_bf16 v102, v81, s55, v102
v_dot2_f32_bf16 v103, v81, s56, v103
s_nop 1
v_cvt_pk_bf16_f32 v100, v100, v101
v_cvt_pk_bf16_f32 v101, v102, v103
v_min_u32 v100, -2, v100
v_min_u32 v101, -2, v101
s_cbranch_vccz Lxs_444
s_sub_u32 s37, s37, 1
s_cbranch_scc1 Lend_1
s_branch Lx2_443
Lpf_430:
buffer_load_dwordx4 v[28:31], v8, s[4:7], s40 offen offset:0 sc1
v_mfma_f32_16x16x32_bf16 v[16:19], v[20:23], v[20:23], 0
s_sub_u32 s37, s37, 1
s_cbranch_scc1 Lend_1
Lps_445:
s_waitcnt vmcnt(3)
v_max3_u32 v26, v32, v33, v34
v_max_u32 v26, v26, v35
v_cmp_eq_u32 vcc, -1, v26
s_cbranch_vccnz Lpf_446
v_smfmac_f32_16x16x64_bf16 v[44:47], v[32:35], a[32:39], v126
v_smfmac_f32_16x16x64_bf16 v[48:51], v[32:35], a[40:47], v126
v_smfmac_f32_16x16x64_bf16 v[52:55], v[32:35], a[48:55], v126
v_smfmac_f32_16x16x64_bf16 v[56:59], v[32:35], a[56:63], v126
v_smfmac_f32_16x16x64_bf16 v[60:63], v[32:35], v[160:167], v126
v_smfmac_f32_16x16x64_bf16 v[64:67], v[32:35], v[168:175], v126
Lps_447:
s_waitcnt vmcnt(2)
v_max3_u32 v26, v36, v37, v38
v_max_u32 v26, v26, v39
v_cmp_eq_u32 vcc, -1, v26
s_cbranch_vccnz Lpf_448
v_smfmac_f32_16x16x64_bf16 v[44:47], v[36:39], a[64:71], v126
v_smfmac_f32_16x16x64_bf16 v[48:51], v[36:39], a[72:79], v126
v_smfmac_f32_16x16x64_bf16 v[52:55], v[36:39], a[80:87], v126
v_smfmac_f32_16x16x64_bf16 v[56:59], v[36:39], a[88:95], v126
v_smfmac_f32_16x16x64_bf16 v[60:63], v[36:39], v[192:199], v126
v_smfmac_f32_16x16x64_bf16 v[64:67], v[36:39], v[200:207], v126
Lps_449:
s_waitcnt vmcnt(1)
v_max3_u32 v26, v40, v41, v42
v_max_u32 v26, v26, v43
v_cmp_eq_u32 vcc, -1, v26
s_cbranch_vccnz Lpf_450
v_smfmac_f32_16x16x64_bf16 v[44:47], v[40:43], a[96:103], v126
v_smfmac_f32_16x16x64_bf16 v[48:51], v[40:43], a[104:111], v126
v_smfmac_f32_16x16x64_bf16 v[52:55], v[40:43], a[112:119], v126
v_smfmac_f32_16x16x64_bf16 v[56:59], v[40:43], a[120:127], v126
v_smfmac_f32_16x16x64_bf16 v[60:63], v[40:43], v[224:231], v126
v_smfmac_f32_16x16x64_bf16 v[64:67], v[40:43], v[232:239], v126
Lps_451:
s_waitcnt vmcnt(0)
v_max3_u32 v26, v28, v29, v30
v_max_u32 v26, v26, v31
v_cmp_eq_u32 vcc, -1, v26
s_cbranch_vccnz Lpf_452
v_smfmac_f32_16x16x64_bf16 v[44:47], v[28:31], a[0:7], v126
v_smfmac_f32_16x16x64_bf16 v[48:51], v[28:31], a[8:15], v126
v_smfmac_f32_16x16x64_bf16 v[52:55], v[28:31], a[16:23], v126
v_smfmac_f32_16x16x64_bf16 v[56:59], v[28:31], a[24:31], v126
v_smfmac_f32_16x16x64_bf16 v[60:63], v[28:31], v[128:135], v126
v_smfmac_f32_16x16x64_bf16 v[64:67], v[28:31], v[136:143], v126
s_branch Lpd_429
Lpf_431:
buffer_load_dwordx4 v[32:35], v8, s[4:7], s40 offen offset:1024 sc1
v_mfma_f32_16x16x32_bf16 v[16:19], v[20:23], v[20:23], 0
s_sub_u32 s37, s37, 1
s_cbranch_scc1 Lend_1
Lps_453:
s_waitcnt vmcnt(2)
v_max3_u32 v26, v36, v37, v38
v_max_u32 v26, v26, v39
v_cmp_eq_u32 vcc, -1, v26
s_cbranch_vccnz Lpf_454
v_smfmac_f32_16x16x64_bf16 v[44:47], v[36:39], a[64:71], v126
v_smfmac_f32_16x16x64_bf16 v[48:51], v[36:39], a[72:79], v126
v_smfmac_f32_16x16x64_bf16 v[52:55], v[36:39], a[80:87], v126
v_smfmac_f32_16x16x64_bf16 v[56:59], v[36:39], a[88:95], v126
v_smfmac_f32_16x16x64_bf16 v[60:63], v[36:39], v[192:199], v126
v_smfmac_f32_16x16x64_bf16 v[64:67], v[36:39], v[200:207], v126
Lps_455:
s_waitcnt vmcnt(1)
v_max3_u32 v26, v40, v41, v42
v_max_u32 v26, v26, v43
v_cmp_eq_u32 vcc, -1, v26
s_cbranch_vccnz Lpf_456
v_smfmac_f32_16x16x64_bf16 v[44:47], v[40:43], a[96:103], v126
v_smfmac_f32_16x16x64_bf16 v[48:51], v[40:43], a[104:111], v126
v_smfmac_f32_16x16x64_bf16 v[52:55], v[40:43], a[112:119], v126
v_smfmac_f32_16x16x64_bf16 v[56:59], v[40:43], a[120:127], v126
v_smfmac_f32_16x16x64_bf16 v[60:63], v[40:43], v[224:231], v126
v_smfmac_f32_16x16x64_bf16 v[64:67], v[40:43], v[232:239], v126
Lps_457:
s_waitcnt vmcnt(0)
v_max3_u32 v26, v32, v33, v34
v_max_u32 v26, v26, v35
v_cmp_eq_u32 vcc, -1, v26
s_cbranch_vccnz Lpf_458
v_smfmac_f32_16x16x64_bf16 v[44:47], v[32:35], a[32:39], v126
v_smfmac_f32_16x16x64_bf16 v[48:51], v[32:35], a[40:47], v126
v_smfmac_f32_16x16x64_bf16 v[52:55], v[32:35], a[48:55], v126
v_smfmac_f32_16x16x64_bf16 v[56:59], v[32:35], a[56:63], v126
v_smfmac_f32_16x16x64_bf16 v[60:63], v[32:35], v[160:167], v126
v_smfmac_f32_16x16x64_bf16 v[64:67], v[32:35], v[168:175], v126
s_branch Lpd_429
Lpf_432:
buffer_load_dwordx4 v[36:39], v8, s[4:7], s40 offen offset:2048 sc1
v_mfma_f32_16x16x32_bf16 v[16:19], v[20:23], v[20:23], 0
s_sub_u32 s37, s37, 1
s_cbranch_scc1 Lend_1
Lps_459:
s_waitcnt vmcnt(1)
v_max3_u32 v26, v40, v41, v42
v_max_u32 v26, v26, v43
v_cmp_eq_u32 vcc, -1, v26
s_cbranch_vccnz Lpf_460
v_smfmac_f32_16x16x64_bf16 v[44:47], v[40:43], a[96:103], v126
v_smfmac_f32_16x16x64_bf16 v[48:51], v[40:43], a[104:111], v126
v_smfmac_f32_16x16x64_bf16 v[52:55], v[40:43], a[112:119], v126
v_smfmac_f32_16x16x64_bf16 v[56:59], v[40:43], a[120:127], v126
v_smfmac_f32_16x16x64_bf16 v[60:63], v[40:43], v[224:231], v126
v_smfmac_f32_16x16x64_bf16 v[64:67], v[40:43], v[232:239], v126
Lps_461:
s_waitcnt vmcnt(0)
v_max3_u32 v26, v36, v37, v38
v_max_u32 v26, v26, v39
v_cmp_eq_u32 vcc, -1, v26
s_cbranch_vccnz Lpf_462
v_smfmac_f32_16x16x64_bf16 v[44:47], v[36:39], a[64:71], v126
v_smfmac_f32_16x16x64_bf16 v[48:51], v[36:39], a[72:79], v126
v_smfmac_f32_16x16x64_bf16 v[52:55], v[36:39], a[80:87], v126
v_smfmac_f32_16x16x64_bf16 v[56:59], v[36:39], a[88:95], v126
v_smfmac_f32_16x16x64_bf16 v[60:63], v[36:39], v[192:199], v126
v_smfmac_f32_16x16x64_bf16 v[64:67], v[36:39], v[200:207], v126
s_branch Lpd_429
Lpf_433:
buffer_load_dwordx4 v[40:43], v8, s[4:7], s40 offen offset:3072 sc1
v_mfma_f32_16x16x32_bf16 v[16:19], v[20:23], v[20:23], 0
s_sub_u32 s37, s37, 1
s_cbranch_scc1 Lend_1
Lps_463:
s_waitcnt vmcnt(0)
v_max3_u32 v26, v40, v41, v42
v_max_u32 v26, v26, v43
v_cmp_eq_u32 vcc, -1, v26
s_cbranch_vccnz Lpf_464
v_smfmac_f32_16x16x64_bf16 v[44:47], v[40:43], a[96:103], v126
v_smfmac_f32_16x16x64_bf16 v[48:51], v[40:43], a[104:111], v126
v_smfmac_f32_16x16x64_bf16 v[52:55], v[40:43], a[112:119], v126
v_smfmac_f32_16x16x64_bf16 v[56:59], v[40:43], a[120:127], v126
v_smfmac_f32_16x16x64_bf16 v[60:63], v[40:43], v[224:231], v126
v_smfmac_f32_16x16x64_bf16 v[64:67], v[40:43], v[232:239], v126
s_branch Lpd_429
Lpf_446:
buffer_load_dwordx4 v[32:35], v8, s[4:7], s40 offen offset:1024 sc1
v_mfma_f32_16x16x32_bf16 v[16:19], v[20:23], v[20:23], 0
Lps_465:
s_waitcnt vmcnt(3)
v_max3_u32 v26, v36, v37, v38
v_max_u32 v26, v26, v39
v_cmp_eq_u32 vcc, -1, v26
s_cbranch_vccnz Lpf_466
v_smfmac_f32_16x16x64_bf16 v[44:47], v[36:39], a[64:71], v126
v_smfmac_f32_16x16x64_bf16 v[48:51], v[36:39], a[72:79], v126
v_smfmac_f32_16x16x64_bf16 v[52:55], v[36:39], a[80:87], v126
v_smfmac_f32_16x16x64_bf16 v[56:59], v[36:39], a[88:95], v126
v_smfmac_f32_16x16x64_bf16 v[60:63], v[36:39], v[192:199], v126
v_smfmac_f32_16x16x64_bf16 v[64:67], v[36:39], v[200:207], v126
Lps_467:
s_waitcnt vmcnt(2)
v_max3_u32 v26, v40, v41, v42
v_max_u32 v26, v26, v43
v_cmp_eq_u32 vcc, -1, v26
s_cbranch_vccnz Lpf_468
v_smfmac_f32_16x16x64_bf16 v[44:47], v[40:43], a[96:103], v126
v_smfmac_f32_16x16x64_bf16 v[48:51], v[40:43], a[104:111], v126
v_smfmac_f32_16x16x64_bf16 v[52:55], v[40:43], a[112:119], v126
v_smfmac_f32_16x16x64_bf16 v[56:59], v[40:43], a[120:127], v126
v_smfmac_f32_16x16x64_bf16 v[60:63], v[40:43], v[224:231], v126
v_smfmac_f32_16x16x64_bf16 v[64:67], v[40:43], v[232:239], v126
Lps_469:
s_waitcnt vmcnt(1)
v_max3_u32 v26, v28, v29, v30
v_max_u32 v26, v26, v31
v_cmp_eq_u32 vcc, -1, v26
s_cbranch_vccnz Lpf_470
v_smfmac_f32_16x16x64_bf16 v[44:47], v[28:31], a[0:7], v126
v_smfmac_f32_16x16x64_bf16 v[48:51], v[28:31], a[8:15], v126
v_smfmac_f32_16x16x64_bf16 v[52:55], v[28:31], a[16:23], v126
v_smfmac_f32_16x16x64_bf16 v[56:59], v[28:31], a[24:31], v126
v_smfmac_f32_16x16x64_bf16 v[60:63], v[28:31], v[128:135], v126
v_smfmac_f32_16x16x64_bf16 v[64:67], v[28:31], v[136:143], v126
s_branch Lps_457
Lpf_448:
buffer_load_dwordx4 v[36:39], v8, s[4:7], s40 offen offset:2048 sc1
v_mfma_f32_16x16x32_bf16 v[16:19], v[20:23], v[20:23], 0
Lps_471:
s_waitcnt vmcnt(2)
v_max3_u32 v26, v40, v41, v42
v_max_u32 v26, v26, v43
v_cmp_eq_u32 vcc, -1, v26
s_cbranch_vccnz Lpf_472
v_smfmac_f32_16x16x64_bf16 v[44:47], v[40:43], a[96:103], v126
v_smfmac_f32_16x16x64_bf16 v[48:51], v[40:43], a[104:111], v126
v_smfmac_f32_16x16x64_bf16 v[52:55], v[40:43], a[112:119], v126
v_smfmac_f32_16x16x64_bf16 v[56:59], v[40:43], a[120:127], v126
v_smfmac_f32_16x16x64_bf16 v[60:63], v[40:43], v[224:231], v126
v_smfmac_f32_16x16x64_bf16 v[64:67], v[40:43], v[232:239], v126
Lps_473:
s_waitcnt vmcnt(1)
v_max3_u32 v26, v28, v29, v30
v_max_u32 v26, v26, v31
v_cmp_eq_u32 vcc, -1, v26
s_cbranch_vccnz Lpf_474
v_smfmac_f32_16x16x64_bf16 v[44:47], v[28:31], a[0:7], v126
v_smfmac_f32_16x16x64_bf16 v[48:51], v[28:31], a[8:15], v126
v_smfmac_f32_16x16x64_bf16 v[52:55], v[28:31], a[16:23], v126
v_smfmac_f32_16x16x64_bf16 v[56:59], v[28:31], a[24:31], v126
v_smfmac_f32_16x16x64_bf16 v[60:63], v[28:31], v[128:135], v126
v_smfmac_f32_16x16x64_bf16 v[64:67], v[28:31], v[136:143], v126
s_branch Lps_461
Lpf_450:
buffer_load_dwordx4 v[40:43], v8, s[4:7], s40 offen offset:3072 sc1
v_mfma_f32_16x16x32_bf16 v[16:19], v[20:23], v[20:23], 0
Lps_475:
s_waitcnt vmcnt(1)
v_max3_u32 v26, v28, v29, v30
v_max_u32 v26, v26, v31
v_cmp_eq_u32 vcc, -1, v26
s_cbranch_vccnz Lpf_476
v_smfmac_f32_16x16x64_bf16 v[44:47], v[28:31], a[0:7], v126
v_smfmac_f32_16x16x64_bf16 v[48:51], v[28:31], a[8:15], v126
v_smfmac_f32_16x16x64_bf16 v[52:55], v[28:31], a[16:23], v126
v_smfmac_f32_16x16x64_bf16 v[56:59], v[28:31], a[24:31], v126
v_smfmac_f32_16x16x64_bf16 v[60:63], v[28:31], v[128:135], v126
v_smfmac_f32_16x16x64_bf16 v[64:67], v[28:31], v[136:143], v126
s_branch Lps_463
Lpf_452:
buffer_load_dwordx4 v[28:31], v8, s[4:7], s40 offen offset:0 sc1
v_mfma_f32_16x16x32_bf16 v[16:19], v[20:23], v[20:23], 0
s_sub_u32 s37, s37, 1
s_cbranch_scc1 Lend_1
s_branch Lps_451
Lpf_454:
buffer_load_dwordx4 v[36:39], v8, s[4:7], s40 offen offset:2048 sc1
v_mfma_f32_16x16x32_bf16 v[16:19], v[20:23], v[20:23], 0
Lps_477:
s_waitcnt vmcnt(2)
v_max3_u32 v26, v40, v41, v42
v_max_u32 v26, v26, v43
v_cmp_eq_u32 vcc, -1, v26
s_cbranch_vccnz Lpf_478
v_smfmac_f32_16x16x64_bf16 v[44:47], v[40:43], a[96:103], v126
v_smfmac_f32_16x16x64_bf16 v[48:51], v[40:43], a[104:111], v126
v_smfmac_f32_16x16x64_bf16 v[52:55], v[40:43], a[112:119], v126
v_smfmac_f32_16x16x64_bf16 v[56:59], v[40:43], a[120:127], v126
v_smfmac_f32_16x16x64_bf16 v[60:63], v[40:43], v[224:231], v126
v_smfmac_f32_16x16x64_bf16 v[64:67], v[40:43], v[232:239], v126
Lps_479:
s_waitcnt vmcnt(1)
v_max3_u32 v26, v32, v33, v34
v_max_u32 v26, v26, v35
v_cmp_eq_u32 vcc, -1, v26
s_cbranch_vccnz Lpf_480
v_smfmac_f32_16x16x64_bf16 v[44:47], v[32:35], a[32:39], v126
v_smfmac_f32_16x16x64_bf16 v[48:51], v[32:35], a[40:47], v126
v_smfmac_f32_16x16x64_bf16 v[52:55], v[32:35], a[48:55], v126
v_smfmac_f32_16x16x64_bf16 v[56:59], v[32:35], a[56:63], v126
v_smfmac_f32_16x16x64_bf16 v[60:63], v[32:35], v[160:167], v126
v_smfmac_f32_16x16x64_bf16 v[64:67], v[32:35], v[168:175], v126
s_branch Lps_461
Lpf_456:
buffer_load_dwordx4 v[40:43], v8, s[4:7], s40 offen offset:3072 sc1
v_mfma_f32_16x16x32_bf16 v[16:19], v[20:23], v[20:23], 0
Lps_481:
s_waitcnt vmcnt(1)
v_max3_u32 v26, v32, v33, v34
v_max_u32 v26, v26, v35
v_cmp_eq_u32 vcc, -1, v26
s_cbranch_vccnz Lpf_482
v_smfmac_f32_16x16x64_bf16 v[44:47], v[32:35], a[32:39], v126
v_smfmac_f32_16x16x64_bf16 v[48:51], v[32:35], a[40:47], v126
v_smfmac_f32_16x16x64_bf16 v[52:55], v[32:35], a[48:55], v126
v_smfmac_f32_16x16x64_bf16 v[56:59], v[32:35], a[56:63], v126
v_smfmac_f32_16x16x64_bf16 v[60:63], v[32:35], v[160:167], v126
v_smfmac_f32_16x16x64_bf16 v[64:67], v[32:35], v[168:175], v126
s_branch Lps_463
Lpf_458:
buffer_load_dwordx4 v[32:35], v8, s[4:7], s40 offen offset:1024 sc1
v_mfma_f32_16x16x32_bf16 v[16:19], v[20:23], v[20:23], 0
s_sub_u32 s37, s37, 1
s_cbranch_scc1 Lend_1
s_branch Lps_457
Lpf_460:
buffer_load_dwordx4 v[40:43], v8, s[4:7], s40 offen offset:3072 sc1
v_mfma_f32_16x16x32_bf16 v[16:19], v[20:23], v[20:23], 0
Lps_483:
s_waitcnt vmcnt(1)
v_max3_u32 v26, v36, v37, v38
v_max_u32 v26, v26, v39
v_cmp_eq_u32 vcc, -1, v26
s_cbranch_vccnz Lpf_484
v_smfmac_f32_16x16x64_bf16 v[44:47], v[36:39], a[64:71], v126
v_smfmac_f32_16x16x64_bf16 v[48:51], v[36:39], a[72:79], v126
v_smfmac_f32_16x16x64_bf16 v[52:55], v[36:39], a[80:87], v126
v_smfmac_f32_16x16x64_bf16 v[56:59], v[36:39], a[88:95], v126
v_smfmac_f32_16x16x64_bf16 v[60:63], v[36:39], v[192:199], v126
v_smfmac_f32_16x16x64_bf16 v[64:67], v[36:39], v[200:207], v126
s_branch Lps_463
Lpf_462:
buffer_load_dwordx4 v[36:39], v8, s[4:7], s40 offen offset:2048 sc1
v_mfma_f32_16x16x32_bf16 v[16:19], v[20:23], v[20:23], 0
s_sub_u32 s37, s37, 1
s_cbranch_scc1 Lend_1
s_branch Lps_461
Lpf_464:
buffer_load_dwordx4 v[40:43], v8, s[4:7], s40 offen offset:3072 sc1
v_mfma_f32_16x16x32_bf16 v[16:19], v[20:23], v[20:23], 0
s_sub_u32 s37, s37, 1
s_cbranch_scc1 Lend_1
s_branch Lps_463
Lpf_466:
buffer_load_dwordx4 v[36:39], v8, s[4:7], s40 offen offset:2048 sc1
v_mfma_f32_16x16x32_bf16 v[16:19], v[20:23], v[20:23], 0
Lps_485:
s_waitcnt vmcnt(3)
v_max3_u32 v26, v40, v41, v42
v_max_u32 v26, v26, v43
v_cmp_eq_u32 vcc, -1, v26
s_cbranch_vccnz Lpf_486
v_smfmac_f32_16x16x64_bf16 v[44:47], v[40:43], a[96:103], v126
v_smfmac_f32_16x16x64_bf16 v[48:51], v[40:43], a[104:111], v126
v_smfmac_f32_16x16x64_bf16 v[52:55], v[40:43], a[112:119], v126
v_smfmac_f32_16x16x64_bf16 v[56:59], v[40:43], a[120:127], v126
v_smfmac_f32_16x16x64_bf16 v[60:63], v[40:43], v[224:231], v126
v_smfmac_f32_16x16x64_bf16 v[64:67], v[40:43], v[232:239], v126
Lps_487:
s_waitcnt vmcnt(2)
v_max3_u32 v26, v28, v29, v30
v_max_u32 v26, v26, v31
v_cmp_eq_u32 vcc, -1, v26
s_cbranch_vccnz Lpf_488
v_smfmac_f32_16x16x64_bf16 v[44:47], v[28:31], a[0:7], v126
v_smfmac_f32_16x16x64_bf16 v[48:51], v[28:31], a[8:15], v126
v_smfmac_f32_16x16x64_bf16 v[52:55], v[28:31], a[16:23], v126
v_smfmac_f32_16x16x64_bf16 v[56:59], v[28:31], a[24:31], v126
v_smfmac_f32_16x16x64_bf16 v[60:63], v[28:31], v[128:135], v126
v_smfmac_f32_16x16x64_bf16 v[64:67], v[28:31], v[136:143], v126
s_branch Lps_479
Lpf_468:
buffer_load_dwordx4 v[40:43], v8, s[4:7], s40 offen offset:3072 sc1
v_mfma_f32_16x16x32_bf16 v[16:19], v[20:23], v[20:23], 0
Lps_489:
s_waitcnt vmcnt(2)
v_max3_u32 v26, v28, v29, v30
v_max_u32 v26, v26, v31
v_cmp_eq_u32 vcc, -1, v26
s_cbranch_vccnz Lpf_490
v_smfmac_f32_16x16x64_bf16 v[44:47], v[28:31], a[0:7], v126
v_smfmac_f32_16x16x64_bf16 v[48:51], v[28:31], a[8:15], v126
v_smfmac_f32_16x16x64_bf16 v[52:55], v[28:31], a[16:23], v126
v_smfmac_f32_16x16x64_bf16 v[56:59], v[28:31], a[24:31], v126
v_smfmac_f32_16x16x64_bf16 v[60:63], v[28:31], v[128:135], v126
v_smfmac_f32_16x16x64_bf16 v[64:67], v[28:31], v[136:143], v126
s_branch Lps_481
Lpf_470:
buffer_load_dwordx4 v[28:31], v8, s[4:7], s40 offen offset:0 sc1
v_mfma_f32_16x16x32_bf16 v[16:19], v[20:23], v[20:23], 0
s_sub_u32 s37, s37, 1
s_cbranch_scc1 Lend_1
Lps_491:
s_waitcnt vmcnt(1)
v_max3_u32 v26, v32, v33, v34
v_max_u32 v26, v26, v35
v_cmp_eq_u32 vcc, -1, v26
s_cbranch_vccnz Lpf_492
v_smfmac_f32_16x16x64_bf16 v[44:47], v[32:35], a[32:39], v126
v_smfmac_f32_16x16x64_bf16 v[48:51], v[32:35], a[40:47], v126
v_smfmac_f32_16x16x64_bf16 v[52:55], v[32:35], a[48:55], v126
v_smfmac_f32_16x16x64_bf16 v[56:59], v[32:35], a[56:63], v126
v_smfmac_f32_16x16x64_bf16 v[60:63], v[32:35], v[160:167], v126
v_smfmac_f32_16x16x64_bf16 v[64:67], v[32:35], v[168:175], v126
s_branch Lps_451
Lpf_472:
buffer_load_dwordx4 v[40:43], v8, s[4:7], s40 offen offset:3072 sc1
v_mfma_f32_16x16x32_bf16 v[16:19], v[20:23], v[20:23], 0
Lps_493:
s_waitcnt vmcnt(2)
v_max3_u32 v26, v28, v29, v30
v_max_u32 v26, v26, v31
v_cmp_eq_u32 vcc, -1, v26
s_cbranch_vccnz Lpf_494
v_smfmac_f32_16x16x64_bf16 v[44:47], v[28:31], a[0:7], v126
v_smfmac_f32_16x16x64_bf16 v[48:51], v[28:31], a[8:15], v126
v_smfmac_f32_16x16x64_bf16 v[52:55], v[28:31], a[16:23], v126
v_smfmac_f32_16x16x64_bf16 v[56:59], v[28:31], a[24:31], v126
v_smfmac_f32_16x16x64_bf16 v[60:63], v[28:31], v[128:135], v126
v_smfmac_f32_16x16x64_bf16 v[64:67], v[28:31], v[136:143], v126
s_branch Lps_483
Lpf_474:
buffer_load_dwordx4 v[28:31], v8, s[4:7], s40 offen offset:0 sc1
v_mfma_f32_16x16x32_bf16 v[16:19], v[20:23], v[20:23], 0
s_sub_u32 s37, s37, 1
s_cbranch_scc1 Lend_1
Lps_495:
s_waitcnt vmcnt(1)
v_max3_u32 v26, v36, v37, v38
v_max_u32 v26, v26, v39
v_cmp_eq_u32 vcc, -1, v26
s_cbranch_vccnz Lpf_496
v_smfmac_f32_16x16x64_bf16 v[44:47], v[36:39], a[64:71], v126
v_smfmac_f32_16x16x64_bf16 v[48:51], v[36:39], a[72:79], v126
v_smfmac_f32_16x16x64_bf16 v[52:55], v[36:39], a[80:87], v126
v_smfmac_f32_16x16x64_bf16 v[56:59], v[36:39], a[88:95], v126
v_smfmac_f32_16x16x64_bf16 v[60:63], v[36:39], v[192:199], v126
v_smfmac_f32_16x16x64_bf16 v[64:67], v[36:39], v[200:207], v126
s_branch Lps_451
Lpf_476:
buffer_load_dwordx4 v[28:31], v8, s[4:7], s40 offen offset:0 sc1
v_mfma_f32_16x16x32_bf16 v[16:19], v[20:23], v[20:23], 0
s_sub_u32 s37, s37, 1
s_cbranch_scc1 Lend_1
s_branch Lps_449
Lpf_478:
buffer_load_dwordx4 v[40:43], v8, s[4:7], s40 offen offset:3072 sc1
v_mfma_f32_16x16x32_bf16 v[16:19], v[20:23], v[20:23], 0
Lps_497:
s_waitcnt vmcnt(2)
v_max3_u32 v26, v32, v33, v34
v_max_u32 v26, v26, v35
v_cmp_eq_u32 vcc, -1, v26
s_cbranch_vccnz Lpf_498
v_smfmac_f32_16x16x64_bf16 v[44:47], v[32:35], a[32:39], v126
v_smfmac_f32_16x16x64_bf16 v[48:51], v[32:35], a[40:47], v126
v_smfmac_f32_16x16x64_bf16 v[52:55], v[32:35], a[48:55], v126
v_smfmac_f32_16x16x64_bf16 v[56:59], v[32:35], a[56:63], v126
v_smfmac_f32_16x16x64_bf16 v[60:63], v[32:35], v[160:167], v126
v_smfmac_f32_16x16x64_bf16 v[64:67], v[32:35], v[168:175], v126
s_branch Lps_483
Lpf_480:
buffer_load_dwordx4 v[32:35], v8, s[4:7], s40 offen offset:1024 sc1
v_mfma_f32_16x16x32_bf16 v[16:19], v[20:23], v[20:23], 0
s_sub_u32 s37, s37, 1
s_cbranch_scc1 Lend_1
Lps_499:
s_waitcnt vmcnt(1)
v_max3_u32 v26, v36, v37, v38
v_max_u32 v26, v26, v39
v_cmp_eq_u32 vcc, -1, v26
s_cbranch_vccnz Lpf_500
v_smfmac_f32_16x16x64_bf16 v[44:47], v[36:39], a[64:71], v126
v_smfmac_f32_16x16x64_bf16 v[48:51], v[36:39], a[72:79], v126
v_smfmac_f32_16x16x64_bf16 v[52:55], v[36:39], a[80:87], v126
v_smfmac_f32_16x16x64_bf16 v[56:59], v[36:39], a[88:95], v126
v_smfmac_f32_16x16x64_bf16 v[60:63], v[36:39], v[192:199], v126
v_smfmac_f32_16x16x64_bf16 v[64:67], v[36:39], v[200:207], v126
s_branch Lps_457
Lpf_482:
buffer_load_dwordx4 v[32:35], v8, s[4:7], s40 offen offset:1024 sc1
v_mfma_f32_16x16x32_bf16 v[16:19], v[20:23], v[20:23], 0
s_sub_u32 s37, s37, 1
s_cbranch_scc1 Lend_1
s_branch Lps_455
Lpf_484:
buffer_load_dwordx4 v[36:39], v8, s[4:7], s40 offen offset:2048 sc1
v_mfma_f32_16x16x32_bf16 v[16:19], v[20:23], v[20:23], 0
s_sub_u32 s37, s37, 1
s_cbranch_scc1 Lend_1
s_branch Lps_459
Lpf_486:
buffer_load_dwordx4 v[40:43], v8, s[4:7], s40 offen offset:3072 sc1
v_mfma_f32_16x16x32_bf16 v[16:19], v[20:23], v[20:23], 0
Lps_501:
s_waitcnt vmcnt(3)
v_max3_u32 v26, v28, v29, v30
v_max_u32 v26, v26, v31
v_cmp_eq_u32 vcc, -1, v26
s_cbranch_vccnz Lpf_502
v_smfmac_f32_16x16x64_bf16 v[44:47], v[28:31], a[0:7], v126
v_smfmac_f32_16x16x64_bf16 v[48:51], v[28:31], a[8:15], v126
v_smfmac_f32_16x16x64_bf16 v[52:55], v[28:31], a[16:23], v126
v_smfmac_f32_16x16x64_bf16 v[56:59], v[28:31], a[24:31], v126
v_smfmac_f32_16x16x64_bf16 v[60:63], v[28:31], v[128:135], v126
v_smfmac_f32_16x16x64_bf16 v[64:67], v[28:31], v[136:143], v126
s_branch Lps_497
Lpf_488:
buffer_load_dwordx4 v[28:31], v8, s[4:7], s40 offen offset:0 sc1
v_mfma_f32_16x16x32_bf16 v[16:19], v[20:23], v[20:23], 0
s_sub_u32 s37, s37, 1
s_cbranch_scc1 Lend_1
Lps_503:
s_waitcnt vmcnt(2)
v_max3_u32 v26, v32, v33, v34
v_max_u32 v26, v26, v35
v_cmp_eq_u32 vcc, -1, v26
s_cbranch_vccnz Lpf_504
v_smfmac_f32_16x16x64_bf16 v[44:47], v[32:35], a[32:39], v126
v_smfmac_f32_16x16x64_bf16 v[48:51], v[32:35], a[40:47], v126
v_smfmac_f32_16x16x64_bf16 v[52:55], v[32:35], a[48:55], v126
v_smfmac_f32_16x16x64_bf16 v[56:59], v[32:35], a[56:63], v126
v_smfmac_f32_16x16x64_bf16 v[60:63], v[32:35], v[160:167], v126
v_smfmac_f32_16x16x64_bf16 v[64:67], v[32:35], v[168:175], v126
s_branch Lps_495
Lpf_490:
buffer_load_dwordx4 v[28:31], v8, s[4:7], s40 offen offset:0 sc1
v_mfma_f32_16x16x32_bf16 v[16:19], v[20:23], v[20:23], 0
s_sub_u32 s37, s37, 1
s_cbranch_scc1 Lend_1
Lps_505:
s_waitcnt vmcnt(2)
v_max3_u32 v26, v32, v33, v34
v_max_u32 v26, v26, v35
v_cmp_eq_u32 vcc, -1, v26
s_cbranch_vccnz Lpf_506
v_smfmac_f32_16x16x64_bf16 v[44:47], v[32:35], a[32:39], v126
v_smfmac_f32_16x16x64_bf16 v[48:51], v[32:35], a[40:47], v126
v_smfmac_f32_16x16x64_bf16 v[52:55], v[32:35], a[48:55], v126
v_smfmac_f32_16x16x64_bf16 v[56:59], v[32:35], a[56:63], v126
v_smfmac_f32_16x16x64_bf16 v[60:63], v[32:35], v[160:167], v126
v_smfmac_f32_16x16x64_bf16 v[64:67], v[32:35], v[168:175], v126
s_branch Lps_449
Lpf_492:
buffer_load_dwordx4 v[32:35], v8, s[4:7], s40 offen offset:1024 sc1
v_mfma_f32_16x16x32_bf16 v[16:19], v[20:23], v[20:23], 0
s_branch Lps_469
Lpf_494:
buffer_load_dwordx4 v[28:31], v8, s[4:7], s40 offen offset:0 sc1
v_mfma_f32_16x16x32_bf16 v[16:19], v[20:23], v[20:23], 0
s_sub_u32 s37, s37, 1
s_cbranch_scc1 Lend_1
s_branch Lps_447
Lpf_496:
buffer_load_dwordx4 v[36:39], v8, s[4:7], s40 offen offset:2048 sc1
v_mfma_f32_16x16x32_bf16 v[16:19], v[20:23], v[20:23], 0
s_branch Lps_473
Lpf_498:
buffer_load_dwordx4 v[32:35], v8, s[4:7], s40 offen offset:1024 sc1
v_mfma_f32_16x16x32_bf16 v[16:19], v[20:23], v[20:23], 0
s_sub_u32 s37, s37, 1
s_cbranch_scc1 Lend_1
s_branch Lps_453
Lpf_500:
buffer_load_dwordx4 v[36:39], v8, s[4:7], s40 offen offset:2048 sc1
v_mfma_f32_16x16x32_bf16 v[16:19], v[20:23], v[20:23], 0
s_branch Lps_479
Lpf_502:
buffer_load_dwordx4 v[28:31], v8, s[4:7], s40 offen offset:0 sc1
v_mfma_f32_16x16x32_bf16 v[16:19], v[20:23], v[20:23], 0
s_sub_u32 s37, s37, 1
s_cbranch_scc1 Lend_1
s_branch Lps_445
Lpf_504:
buffer_load_dwordx4 v[32:35], v8, s[4:7], s40 offen offset:1024 sc1
v_mfma_f32_16x16x32_bf16 v[16:19], v[20:23], v[20:23], 0
Lps_507:
s_waitcnt vmcnt(2)
v_max3_u32 v26, v36, v37, v38
v_max_u32 v26, v26, v39
v_cmp_eq_u32 vcc, -1, v26
s_cbranch_vccnz Lpf_508
v_smfmac_f32_16x16x64_bf16 v[44:47], v[36:39], a[64:71], v126
v_smfmac_f32_16x16x64_bf16 v[48:51], v[36:39], a[72:79], v126
v_smfmac_f32_16x16x64_bf16 v[52:55], v[36:39], a[80:87], v126
v_smfmac_f32_16x16x64_bf16 v[56:59], v[36:39], a[88:95], v126
v_smfmac_f32_16x16x64_bf16 v[60:63], v[36:39], v[192:199], v126
v_smfmac_f32_16x16x64_bf16 v[64:67], v[36:39], v[200:207], v126
s_branch Lps_469
Lpf_506:
buffer_load_dwordx4 v[32:35], v8, s[4:7], s40 offen offset:1024 sc1
v_mfma_f32_16x16x32_bf16 v[16:19], v[20:23], v[20:23], 0
s_branch Lps_467
Lpf_508:
buffer_load_dwordx4 v[36:39], v8, s[4:7], s40 offen offset:2048 sc1
v_mfma_f32_16x16x32_bf16 v[16:19], v[20:23], v[20:23], 0
s_branch Lps_487
Lpf_438:
buffer_load_dwordx4 v[28:31], v9, s[4:7], s40 offen offset:0 sc1
v_mfma_f32_16x16x32_bf16 v[16:19], v[20:23], v[20:23], 0
s_sub_u32 s37, s37, 1
s_cbranch_scc1 Lend_1
Lps_509:
s_waitcnt vmcnt(3)
v_max3_u32 v26, v32, v33, v34
v_max_u32 v26, v26, v35
v_cmp_eq_u32 vcc, -1, v26
s_cbranch_vccnz Lpf_510
v_smfmac_f32_16x16x64_bf16 v[76:79], v[32:35], a[160:167], v126
v_smfmac_f32_16x16x64_bf16 v[80:83], v[32:35], a[168:175], v126
v_smfmac_f32_16x16x64_bf16 v[84:87], v[32:35], a[176:183], v126
v_smfmac_f32_16x16x64_bf16 v[88:91], v[32:35], a[184:191], v126
Lps_511:
s_waitcnt vmcnt(2)
v_max3_u32 v26, v36, v37, v38
v_max_u32 v26, v26, v39
v_cmp_eq_u32 vcc, -1, v26
s_cbranch_vccnz Lpf_512
v_smfmac_f32_16x16x64_bf16 v[76:79], v[36:39], a[192:199], v126
v_smfmac_f32_16x16x64_bf16 v[80:83], v[36:39], a[200:207], v126
v_smfmac_f32_16x16x64_bf16 v[84:87], v[36:39], a[208:215], v126
v_smfmac_f32_16x16x64_bf16 v[88:91], v[36:39], a[216:223], v126
Lps_513:
s_waitcnt vmcnt(1)
v_max3_u32 v26, v40, v41, v42
v_max_u32 v26, v26, v43
v_cmp_eq_u32 vcc, -1, v26
s_cbranch_vccnz Lpf_514
v_smfmac_f32_16x16x64_bf16 v[76:79], v[40:43], a[224:231], v126
v_smfmac_f32_16x16x64_bf16 v[80:83], v[40:43], a[232:239], v126
v_smfmac_f32_16x16x64_bf16 v[84:87], v[40:43], a[240:247], v126
v_smfmac_f32_16x16x64_bf16 v[88:91], v[40:43], a[248:255], v126
Lps_515:
s_waitcnt vmcnt(0)
v_max3_u32 v26, v28, v29, v30
v_max_u32 v26, v26, v31
v_cmp_eq_u32 vcc, -1, v26
s_cbranch_vccnz Lpf_516
v_smfmac_f32_16x16x64_bf16 v[76:79], v[28:31], a[128:135], v126
v_smfmac_f32_16x16x64_bf16 v[80:83], v[28:31], a[136:143], v126
v_smfmac_f32_16x16x64_bf16 v[84:87], v[28:31], a[144:151], v126
v_smfmac_f32_16x16x64_bf16 v[88:91], v[28:31], a[152:159], v126
s_branch Lpd_437
Lpf_439:
buffer_load_dwordx4 v[32:35], v9, s[4:7], s40 offen offset:1024 sc1
v_mfma_f32_16x16x32_bf16 v[16:19], v[20:23], v[20:23], 0
s_sub_u32 s37, s37, 1
s_cbranch_scc1 Lend_1
Lps_517:
s_waitcnt vmcnt(2)
v_max3_u32 v26, v36, v37, v38
v_max_u32 v26, v26, v39
v_cmp_eq_u32 vcc, -1, v26
s_cbranch_vccnz Lpf_518
v_smfmac_f32_16x16x64_bf16 v[76:79], v[36:39], a[192:199], v126
v_smfmac_f32_16x16x64_bf16 v[80:83], v[36:39], a[200:207], v126
v_smfmac_f32_16x16x64_bf16 v[84:87], v[36:39], a[208:215], v126
v_smfmac_f32_16x16x64_bf16 v[88:91], v[36:39], a[216:223], v126
Lps_519:
s_waitcnt vmcnt(1)
v_max3_u32 v26, v40, v41, v42
v_max_u32 v26, v26, v43
v_cmp_eq_u32 vcc, -1, v26
s_cbranch_vccnz Lpf_520
v_smfmac_f32_16x16x64_bf16 v[76:79], v[40:43], a[224:231], v126
v_smfmac_f32_16x16x64_bf16 v[80:83], v[40:43], a[232:239], v126
v_smfmac_f32_16x16x64_bf16 v[84:87], v[40:43], a[240:247], v126
v_smfmac_f32_16x16x64_bf16 v[88:91], v[40:43], a[248:255], v126
Lps_521:
s_waitcnt vmcnt(0)
v_max3_u32 v26, v32, v33, v34
v_max_u32 v26, v26, v35
v_cmp_eq_u32 vcc, -1, v26
s_cbranch_vccnz Lpf_522
v_smfmac_f32_16x16x64_bf16 v[76:79], v[32:35], a[160:167], v126
v_smfmac_f32_16x16x64_bf16 v[80:83], v[32:35], a[168:175], v126
v_smfmac_f32_16x16x64_bf16 v[84:87], v[32:35], a[176:183], v126
v_smfmac_f32_16x16x64_bf16 v[88:91], v[32:35], a[184:191], v126
s_branch Lpd_437
Lpf_440:
buffer_load_dwordx4 v[36:39], v9, s[4:7], s40 offen offset:2048 sc1
v_mfma_f32_16x16x32_bf16 v[16:19], v[20:23], v[20:23], 0
s_sub_u32 s37, s37, 1
s_cbranch_scc1 Lend_1
Lps_523:
s_waitcnt vmcnt(1)
v_max3_u32 v26, v40, v41, v42
v_max_u32 v26, v26, v43
v_cmp_eq_u32 vcc, -1, v26
s_cbranch_vccnz Lpf_524
v_smfmac_f32_16x16x64_bf16 v[76:79], v[40:43], a[224:231], v126
v_smfmac_f32_16x16x64_bf16 v[80:83], v[40:43], a[232:239], v126
v_smfmac_f32_16x16x64_bf16 v[84:87], v[40:43], a[240:247], v126
v_smfmac_f32_16x16x64_bf16 v[88:91], v[40:43], a[248:255], v126
Lps_525:
s_waitcnt vmcnt(0)
v_max3_u32 v26, v36, v37, v38
v_max_u32 v26, v26, v39
v_cmp_eq_u32 vcc, -1, v26
s_cbranch_vccnz Lpf_526
v_smfmac_f32_16x16x64_bf16 v[76:79], v[36:39], a[192:199], v126
v_smfmac_f32_16x16x64_bf16 v[80:83], v[36:39], a[200:207], v126
v_smfmac_f32_16x16x64_bf16 v[84:87], v[36:39], a[208:215], v126
v_smfmac_f32_16x16x64_bf16 v[88:91], v[36:39], a[216:223], v126
s_branch Lpd_437
Lpf_441:
buffer_load_dwordx4 v[40:43], v9, s[4:7], s40 offen offset:3072 sc1
v_mfma_f32_16x16x32_bf16 v[16:19], v[20:23], v[20:23], 0
s_sub_u32 s37, s37, 1
s_cbranch_scc1 Lend_1
Lps_527:
s_waitcnt vmcnt(0)
v_max3_u32 v26, v40, v41, v42
v_max_u32 v26, v26, v43
v_cmp_eq_u32 vcc, -1, v26
s_cbranch_vccnz Lpf_528
v_smfmac_f32_16x16x64_bf16 v[76:79], v[40:43], a[224:231], v126
v_smfmac_f32_16x16x64_bf16 v[80:83], v[40:43], a[232:239], v126
v_smfmac_f32_16x16x64_bf16 v[84:87], v[40:43], a[240:247], v126
v_smfmac_f32_16x16x64_bf16 v[88:91], v[40:43], a[248:255], v126
s_branch Lpd_437
Lpf_510:
buffer_load_dwordx4 v[32:35], v9, s[4:7], s40 offen offset:1024 sc1
v_mfma_f32_16x16x32_bf16 v[16:19], v[20:23], v[20:23], 0
Lps_529:
s_waitcnt vmcnt(3)
v_max3_u32 v26, v36, v37, v38
v_max_u32 v26, v26, v39
v_cmp_eq_u32 vcc, -1, v26
s_cbranch_vccnz Lpf_530
v_smfmac_f32_16x16x64_bf16 v[76:79], v[36:39], a[192:199], v126
v_smfmac_f32_16x16x64_bf16 v[80:83], v[36:39], a[200:207], v126
v_smfmac_f32_16x16x64_bf16 v[84:87], v[36:39], a[208:215], v126
v_smfmac_f32_16x16x64_bf16 v[88:91], v[36:39], a[216:223], v126
Lps_531:
s_waitcnt vmcnt(2)
v_max3_u32 v26, v40, v41, v42
v_max_u32 v26, v26, v43
v_cmp_eq_u32 vcc, -1, v26
s_cbranch_vccnz Lpf_532
v_smfmac_f32_16x16x64_bf16 v[76:79], v[40:43], a[224:231], v126
v_smfmac_f32_16x16x64_bf16 v[80:83], v[40:43], a[232:239], v126
v_smfmac_f32_16x16x64_bf16 v[84:87], v[40:43], a[240:247], v126
v_smfmac_f32_16x16x64_bf16 v[88:91], v[40:43], a[248:255], v126
Lps_533:
s_waitcnt vmcnt(1)
v_max3_u32 v26, v28, v29, v30
v_max_u32 v26, v26, v31
v_cmp_eq_u32 vcc, -1, v26
s_cbranch_vccnz Lpf_534
v_smfmac_f32_16x16x64_bf16 v[76:79], v[28:31], a[128:135], v126
v_smfmac_f32_16x16x64_bf16 v[80:83], v[28:31], a[136:143], v126
v_smfmac_f32_16x16x64_bf16 v[84:87], v[28:31], a[144:151], v126
v_smfmac_f32_16x16x64_bf16 v[88:91], v[28:31], a[152:159], v126
s_branch Lps_521
Lpf_512:
buffer_load_dwordx4 v[36:39], v9, s[4:7], s40 offen offset:2048 sc1
v_mfma_f32_16x16x32_bf16 v[16:19], v[20:23], v[20:23], 0
Lps_535:
s_waitcnt vmcnt(2)
v_max3_u32 v26, v40, v41, v42
v_max_u32 v26, v26, v43
v_cmp_eq_u32 vcc, -1, v26
s_cbranch_vccnz Lpf_536
v_smfmac_f32_16x16x64_bf16 v[76:79], v[40:43], a[224:231], v126
v_smfmac_f32_16x16x64_bf16 v[80:83], v[40:43], a[232:239], v126
v_smfmac_f32_16x16x64_bf16 v[84:87], v[40:43], a[240:247], v126
v_smfmac_f32_16x16x64_bf16 v[88:91], v[40:43], a[248:255], v126
Lps_537:
s_waitcnt vmcnt(1)
v_max3_u32 v26, v28, v29, v30
v_max_u32 v26, v26, v31
v_cmp_eq_u32 vcc, -1, v26
s_cbranch_vccnz Lpf_538
v_smfmac_f32_16x16x64_bf16 v[76:79], v[28:31], a[128:135], v126
v_smfmac_f32_16x16x64_bf16 v[80:83], v[28:31], a[136:143], v126
v_smfmac_f32_16x16x64_bf16 v[84:87], v[28:31], a[144:151], v126
v_smfmac_f32_16x16x64_bf16 v[88:91], v[28:31], a[152:159], v126
s_branch Lps_525
Lpf_514:
buffer_load_dwordx4 v[40:43], v9, s[4:7], s40 offen offset:3072 sc1
v_mfma_f32_16x16x32_bf16 v[16:19], v[20:23], v[20:23], 0
Lps_539:
s_waitcnt vmcnt(1)
v_max3_u32 v26, v28, v29, v30
v_max_u32 v26, v26, v31
v_cmp_eq_u32 vcc, -1, v26
s_cbranch_vccnz Lpf_540
v_smfmac_f32_16x16x64_bf16 v[76:79], v[28:31], a[128:135], v126
v_smfmac_f32_16x16x64_bf16 v[80:83], v[28:31], a[136:143], v126
v_smfmac_f32_16x16x64_bf16 v[84:87], v[28:31], a[144:151], v126
v_smfmac_f32_16x16x64_bf16 v[88:91], v[28:31], a[152:159], v126
s_branch Lps_527
Lpf_516:
buffer_load_dwordx4 v[28:31], v9, s[4:7], s40 offen offset:0 sc1
v_mfma_f32_16x16x32_bf16 v[16:19], v[20:23], v[20:23], 0
s_sub_u32 s37, s37, 1
s_cbranch_scc1 Lend_1
s_branch Lps_515
Lpf_518:
buffer_load_dwordx4 v[36:39], v9, s[4:7], s40 offen offset:2048 sc1
v_mfma_f32_16x16x32_bf16 v[16:19], v[20:23], v[20:23], 0
Lps_541:
s_waitcnt vmcnt(2)
v_max3_u32 v26, v40, v41, v42
v_max_u32 v26, v26, v43
v_cmp_eq_u32 vcc, -1, v26
s_cbranch_vccnz Lpf_542
v_smfmac_f32_16x16x64_bf16 v[76:79], v[40:43], a[224:231], v126
v_smfmac_f32_16x16x64_bf16 v[80:83], v[40:43], a[232:239], v126
v_smfmac_f32_16x16x64_bf16 v[84:87], v[40:43], a[240:247], v126
v_smfmac_f32_16x16x64_bf16 v[88:91], v[40:43], a[248:255], v126
Lps_543:
s_waitcnt vmcnt(1)
v_max3_u32 v26, v32, v33, v34
v_max_u32 v26, v26, v35
v_cmp_eq_u32 vcc, -1, v26
s_cbranch_vccnz Lpf_544
v_smfmac_f32_16x16x64_bf16 v[76:79], v[32:35], a[160:167], v126
v_smfmac_f32_16x16x64_bf16 v[80:83], v[32:35], a[168:175], v126
v_smfmac_f32_16x16x64_bf16 v[84:87], v[32:35], a[176:183], v126
v_smfmac_f32_16x16x64_bf16 v[88:91], v[32:35], a[184:191], v126
s_branch Lps_525
Lpf_520:
buffer_load_dwordx4 v[40:43], v9, s[4:7], s40 offen offset:3072 sc1
v_mfma_f32_16x16x32_bf16 v[16:19], v[20:23], v[20:23], 0
Lps_545:
s_waitcnt vmcnt(1)
v_max3_u32 v26, v32, v33, v34
v_max_u32 v26, v26, v35
v_cmp_eq_u32 vcc, -1, v26
s_cbranch_vccnz Lpf_546
v_smfmac_f32_16x16x64_bf16 v[76:79], v[32:35], a[160:167], v126
v_smfmac_f32_16x16x64_bf16 v[80:83], v[32:35], a[168:175], v126
v_smfmac_f32_16x16x64_bf16 v[84:87], v[32:35], a[176:183], v126
v_smfmac_f32_16x16x64_bf16 v[88:91], v[32:35], a[184:191], v126
s_branch Lps_527
Lpf_522:
buffer_load_dwordx4 v[32:35], v9, s[4:7], s40 offen offset:1024 sc1
v_mfma_f32_16x16x32_bf16 v[16:19], v[20:23], v[20:23], 0
s_sub_u32 s37, s37, 1
s_cbranch_scc1 Lend_1
s_branch Lps_521
Lpf_524:
buffer_load_dwordx4 v[40:43], v9, s[4:7], s40 offen offset:3072 sc1
v_mfma_f32_16x16x32_bf16 v[16:19], v[20:23], v[20:23], 0
Lps_547:
s_waitcnt vmcnt(1)
v_max3_u32 v26, v36, v37, v38
v_max_u32 v26, v26, v39
v_cmp_eq_u32 vcc, -1, v26
s_cbranch_vccnz Lpf_548
v_smfmac_f32_16x16x64_bf16 v[76:79], v[36:39], a[192:199], v126
v_smfmac_f32_16x16x64_bf16 v[80:83], v[36:39], a[200:207], v126
v_smfmac_f32_16x16x64_bf16 v[84:87], v[36:39], a[208:215], v126
v_smfmac_f32_16x16x64_bf16 v[88:91], v[36:39], a[216:223], v126
s_branch Lps_527
Lpf_526:
buffer_load_dwordx4 v[36:39], v9, s[4:7], s40 offen offset:2048 sc1
v_mfma_f32_16x16x32_bf16 v[16:19], v[20:23], v[20:23], 0
s_sub_u32 s37, s37, 1
s_cbranch_scc1 Lend_1
s_branch Lps_525
Lpf_528:
buffer_load_dwordx4 v[40:43], v9, s[4:7], s40 offen offset:3072 sc1
v_mfma_f32_16x16x32_bf16 v[16:19], v[20:23], v[20:23], 0
s_sub_u32 s37, s37, 1
s_cbranch_scc1 Lend_1
s_branch Lps_527
Lpf_530:
buffer_load_dwordx4 v[36:39], v9, s[4:7], s40 offen offset:2048 sc1
v_mfma_f32_16x16x32_bf16 v[16:19], v[20:23], v[20:23], 0
Lps_549:
s_waitcnt vmcnt(3)
v_max3_u32 v26, v40, v41, v42
v_max_u32 v26, v26, v43
v_cmp_eq_u32 vcc, -1, v26
s_cbranch_vccnz Lpf_550
v_smfmac_f32_16x16x64_bf16 v[76:79], v[40:43], a[224:231], v126
v_smfmac_f32_16x16x64_bf16 v[80:83], v[40:43], a[232:239], v126
v_smfmac_f32_16x16x64_bf16 v[84:87], v[40:43], a[240:247], v126
v_smfmac_f32_16x16x64_bf16 v[88:91], v[40:43], a[248:255], v126
Lps_551:
s_waitcnt vmcnt(2)
v_max3_u32 v26, v28, v29, v30
v_max_u32 v26, v26, v31
v_cmp_eq_u32 vcc, -1, v26
s_cbranch_vccnz Lpf_552
v_smfmac_f32_16x16x64_bf16 v[76:79], v[28:31], a[128:135], v126
v_smfmac_f32_16x16x64_bf16 v[80:83], v[28:31], a[136:143], v126
v_smfmac_f32_16x16x64_bf16 v[84:87], v[28:31], a[144:151], v126
v_smfmac_f32_16x16x64_bf16 v[88:91], v[28:31], a[152:159], v126
s_branch Lps_543
Lpf_532:
buffer_load_dwordx4 v[40:43], v9, s[4:7], s40 offen offset:3072 sc1
v_mfma_f32_16x16x32_bf16 v[16:19], v[20:23], v[20:23], 0
Lps_553:
s_waitcnt vmcnt(2)
v_max3_u32 v26, v28, v29, v30
v_max_u32 v26, v26, v31
v_cmp_eq_u32 vcc, -1, v26
s_cbranch_vccnz Lpf_554
v_smfmac_f32_16x16x64_bf16 v[76:79], v[28:31], a[128:135], v126
v_smfmac_f32_16x16x64_bf16 v[80:83], v[28:31], a[136:143], v126
v_smfmac_f32_16x16x64_bf16 v[84:87], v[28:31], a[144:151], v126
v_smfmac_f32_16x16x64_bf16 v[88:91], v[28:31], a[152:159], v126
s_branch Lps_545
Lpf_534:
buffer_load_dwordx4 v[28:31], v9, s[4:7], s40 offen offset:0 sc1
v_mfma_f32_16x16x32_bf16 v[16:19], v[20:23], v[20:23], 0
s_sub_u32 s37, s37, 1
s_cbranch_scc1 Lend_1
Lps_555:
s_waitcnt vmcnt(1)
v_max3_u32 v26, v32, v33, v34
v_max_u32 v26, v26, v35
v_cmp_eq_u32 vcc, -1, v26
s_cbranch_vccnz Lpf_556
v_smfmac_f32_16x16x64_bf16 v[76:79], v[32:35], a[160:167], v126
v_smfmac_f32_16x16x64_bf16 v[80:83], v[32:35], a[168:175], v126
v_smfmac_f32_16x16x64_bf16 v[84:87], v[32:35], a[176:183], v126
v_smfmac_f32_16x16x64_bf16 v[88:91], v[32:35], a[184:191], v126
s_branch Lps_515
Lpf_536:
buffer_load_dwordx4 v[40:43], v9, s[4:7], s40 offen offset:3072 sc1
v_mfma_f32_16x16x32_bf16 v[16:19], v[20:23], v[20:23], 0
Lps_557:
s_waitcnt vmcnt(2)
v_max3_u32 v26, v28, v29, v30
v_max_u32 v26, v26, v31
v_cmp_eq_u32 vcc, -1, v26
s_cbranch_vccnz Lpf_558
v_smfmac_f32_16x16x64_bf16 v[76:79], v[28:31], a[128:135], v126
v_smfmac_f32_16x16x64_bf16 v[80:83], v[28:31], a[136:143], v126
v_smfmac_f32_16x16x64_bf16 v[84:87], v[28:31], a[144:151], v126
v_smfmac_f32_16x16x64_bf16 v[88:91], v[28:31], a[152:159], v126
s_branch Lps_547
Lpf_538:
buffer_load_dwordx4 v[28:31], v9, s[4:7], s40 offen offset:0 sc1
v_mfma_f32_16x16x32_bf16 v[16:19], v[20:23], v[20:23], 0
s_sub_u32 s37, s37, 1
s_cbranch_scc1 Lend_1
Lps_559:
s_waitcnt vmcnt(1)
v_max3_u32 v26, v36, v37, v38
v_max_u32 v26, v26, v39
v_cmp_eq_u32 vcc, -1, v26
s_cbranch_vccnz Lpf_560
v_smfmac_f32_16x16x64_bf16 v[76:79], v[36:39], a[192:199], v126
v_smfmac_f32_16x16x64_bf16 v[80:83], v[36:39], a[200:207], v126
v_smfmac_f32_16x16x64_bf16 v[84:87], v[36:39], a[208:215], v126
v_smfmac_f32_16x16x64_bf16 v[88:91], v[36:39], a[216:223], v126
s_branch Lps_515
Lpf_540:
buffer_load_dwordx4 v[28:31], v9, s[4:7], s40 offen offset:0 sc1
v_mfma_f32_16x16x32_bf16 v[16:19], v[20:23], v[20:23], 0
s_sub_u32 s37, s37, 1
s_cbranch_scc1 Lend_1
s_branch Lps_513
Lpf_542:
buffer_load_dwordx4 v[40:43], v9, s[4:7], s40 offen offset:3072 sc1
v_mfma_f32_16x16x32_bf16 v[16:19], v[20:23], v[20:23], 0
Lps_561:
s_waitcnt vmcnt(2)
v_max3_u32 v26, v32, v33, v34
v_max_u32 v26, v26, v35
v_cmp_eq_u32 vcc, -1, v26
s_cbranch_vccnz Lpf_562
v_smfmac_f32_16x16x64_bf16 v[76:79], v[32:35], a[160:167], v126
v_smfmac_f32_16x16x64_bf16 v[80:83], v[32:35], a[168:175], v126
v_smfmac_f32_16x16x64_bf16 v[84:87], v[32:35], a[176:183], v126
v_smfmac_f32_16x16x64_bf16 v[88:91], v[32:35], a[184:191], v126
s_branch Lps_547
Lpf_544:
buffer_load_dwordx4 v[32:35], v9, s[4:7], s40 offen offset:1024 sc1
v_mfma_f32_16x16x32_bf16 v[16:19], v[20:23], v[20:23], 0
s_sub_u32 s37, s37, 1
s_cbranch_scc1 Lend_1
Lps_563:
s_waitcnt vmcnt(1)
v_max3_u32 v26, v36, v37, v38
v_max_u32 v26, v26, v39
v_cmp_eq_u32 vcc, -1, v26
s_cbranch_vccnz Lpf_564
v_smfmac_f32_16x16x64_bf16 v[76:79], v[36:39], a[192:199], v126
v_smfmac_f32_16x16x64_bf16 v[80:83], v[36:39], a[200:207], v126
v_smfmac_f32_16x16x64_bf16 v[84:87], v[36:39], a[208:215], v126
v_smfmac_f32_16x16x64_bf16 v[88:91], v[36:39], a[216:223], v126
s_branch Lps_521
Lpf_546:
buffer_load_dwordx4 v[32:35], v9, s[4:7], s40 offen offset:1024 sc1
v_mfma_f32_16x16x32_bf16 v[16:19], v[20:23], v[20:23], 0
s_sub_u32 s37, s37, 1
s_cbranch_scc1 Lend_1
s_branch Lps_519
Lpf_548:
buffer_load_dwordx4 v[36:39], v9, s[4:7], s40 offen offset:2048 sc1
v_mfma_f32_16x16x32_bf16 v[16:19], v[20:23], v[20:23], 0
s_sub_u32 s37, s37, 1
s_cbranch_scc1 Lend_1
s_branch Lps_523
Lpf_550:
buffer_load_dwordx4 v[40:43], v9, s[4:7], s40 offen offset:3072 sc1
v_mfma_f32_16x16x32_bf16 v[16:19], v[20:23], v[20:23], 0
Lps_565:
s_waitcnt vmcnt(3)
v_max3_u32 v26, v28, v29, v30
v_max_u32 v26, v26, v31
v_cmp_eq_u32 vcc, -1, v26
s_cbranch_vccnz Lpf_566
v_smfmac_f32_16x16x64_bf16 v[76:79], v[28:31], a[128:135], v126
v_smfmac_f32_16x16x64_bf16 v[80:83], v[28:31], a[136:143], v126
v_smfmac_f32_16x16x64_bf16 v[84:87], v[28:31], a[144:151], v126
v_smfmac_f32_16x16x64_bf16 v[88:91], v[28:31], a[152:159], v126
s_branch Lps_561
Lpf_552:
buffer_load_dwordx4 v[28:31], v9, s[4:7], s40 offen offset:0 sc1
v_mfma_f32_16x16x32_bf16 v[16:19], v[20:23], v[20:23], 0
s_sub_u32 s37, s37, 1
s_cbranch_scc1 Lend_1
Lps_567:
s_waitcnt vmcnt(2)
v_max3_u32 v26, v32, v33, v34
v_max_u32 v26, v26, v35
v_cmp_eq_u32 vcc, -1, v26
s_cbranch_vccnz Lpf_568
v_smfmac_f32_16x16x64_bf16 v[76:79], v[32:35], a[160:167], v126
v_smfmac_f32_16x16x64_bf16 v[80:83], v[32:35], a[168:175], v126
v_smfmac_f32_16x16x64_bf16 v[84:87], v[32:35], a[176:183], v126
v_smfmac_f32_16x16x64_bf16 v[88:91], v[32:35], a[184:191], v126
s_branch Lps_559
Lpf_554:
buffer_load_dwordx4 v[28:31], v9, s[4:7], s40 offen offset:0 sc1
v_mfma_f32_16x16x32_bf16 v[16:19], v[20:23], v[20:23], 0
s_sub_u32 s37, s37, 1
s_cbranch_scc1 Lend_1
Lps_569:
s_waitcnt vmcnt(2)
v_max3_u32 v26, v32, v33, v34
v_max_u32 v26, v26, v35
v_cmp_eq_u32 vcc, -1, v26
s_cbranch_vccnz Lpf_570
v_smfmac_f32_16x16x64_bf16 v[76:79], v[32:35], a[160:167], v126
v_smfmac_f32_16x16x64_bf16 v[80:83], v[32:35], a[168:175], v126
v_smfmac_f32_16x16x64_bf16 v[84:87], v[32:35], a[176:183], v126
v_smfmac_f32_16x16x64_bf16 v[88:91], v[32:35], a[184:191], v126
s_branch Lps_513
Lpf_556:
buffer_load_dwordx4 v[32:35], v9, s[4:7], s40 offen offset:1024 sc1
v_mfma_f32_16x16x32_bf16 v[16:19], v[20:23], v[20:23], 0
s_branch Lps_533
Lpf_558:
buffer_load_dwordx4 v[28:31], v9, s[4:7], s40 offen offset:0 sc1
v_mfma_f32_16x16x32_bf16 v[16:19], v[20:23], v[20:23], 0
s_sub_u32 s37, s37, 1
s_cbranch_scc1 Lend_1
s_branch Lps_511
Lpf_560:
buffer_load_dwordx4 v[36:39], v9, s[4:7], s40 offen offset:2048 sc1
v_mfma_f32_16x16x32_bf16 v[16:19], v[20:23], v[20:23], 0
s_branch Lps_537
Lpf_562:
buffer_load_dwordx4 v[32:35], v9, s[4:7], s40 offen offset:1024 sc1
v_mfma_f32_16x16x32_bf16 v[16:19], v[20:23], v[20:23], 0
s_sub_u32 s37, s37, 1
s_cbranch_scc1 Lend_1
s_branch Lps_517
Lpf_564:
buffer_load_dwordx4 v[36:39], v9, s[4:7], s40 offen offset:2048 sc1
v_mfma_f32_16x16x32_bf16 v[16:19], v[20:23], v[20:23], 0
s_branch Lps_543
Lpf_566:
buffer_load_dwordx4 v[28:31], v9, s[4:7], s40 offen offset:0 sc1
v_mfma_f32_16x16x32_bf16 v[16:19], v[20:23], v[20:23], 0
s_sub_u32 s37, s37, 1
s_cbranch_scc1 Lend_1
s_branch Lps_509
Lpf_568:
buffer_load_dwordx4 v[32:35], v9, s[4:7], s40 offen offset:1024 sc1
v_mfma_f32_16x16x32_bf16 v[16:19], v[20:23], v[20:23], 0
Lps_571:
s_waitcnt vmcnt(2)
v_max3_u32 v26, v36, v37, v38
v_max_u32 v26, v26, v39
v_cmp_eq_u32 vcc, -1, v26
s_cbranch_vccnz Lpf_572
v_smfmac_f32_16x16x64_bf16 v[76:79], v[36:39], a[192:199], v126
v_smfmac_f32_16x16x64_bf16 v[80:83], v[36:39], a[200:207], v126
v_smfmac_f32_16x16x64_bf16 v[84:87], v[36:39], a[208:215], v126
v_smfmac_f32_16x16x64_bf16 v[88:91], v[36:39], a[216:223], v126
s_branch Lps_533
Lpf_570:
buffer_load_dwordx4 v[32:35], v9, s[4:7], s40 offen offset:1024 sc1
v_mfma_f32_16x16x32_bf16 v[16:19], v[20:23], v[20:23], 0
s_branch Lps_531
Lpf_572:
buffer_load_dwordx4 v[36:39], v9, s[4:7], s40 offen offset:2048 sc1
v_mfma_f32_16x16x32_bf16 v[16:19], v[20:23], v[20:23], 0
s_branch Lps_551
Lg3_3:
v_mov_b32 v9, v1
s_sub_u32 s26, s34, 24
s_lshl_b32 s44, s33, 3
s_add_u32 s44, s44, s26
s_lshl_b32 s38, s44, 7
s_add_u32 s38, s38, 3440640
v_min_u32 v80, 1, v0
v_lshl_add_u32 v4, v80, 30, s38
v_mov_b32 v5, 0
buffer_store_dword v5, v4, s[4:7], 0 offen sc1
s_mov_b32 s52, 1
s_mov_b32 s38, 4096
buffer_store_dword v5, v4, s[4:7], s38 offen sc1
s_lshl_b32 s38, s44, 7
s_add_u32 s38, s38, 3436544
v_min_u32 v80, 1, v0
v_lshl_add_u32 v7, v80, 30, s38
buffer_store_dword v5, v7, s[4:7], 0 offen sc1
s_lshl_b32 s38, s35, 16
s_or_b32 s52, s52, s38
s_cmp_lg_u32 s44, 0
s_cbranch_scc1 Lnp_573
s_cmp_lg_u32 s32, 0
s_cbranch_scc1 Lpb_574
v_lshlrev_b32 v2, 8, v9
v_mov_b32 v3, -1
s_mov_b32 s53, 32768
buffer_store_dword v3, v2, s[4:7], s53 offen sc1
s_waitcnt vmcnt(0)
s_mov_b64 exec, 1
s_mov_b32 s54, -1
s_mov_b32 s55, -1
v_mov_b32 v2, 0
s_memtime s[56:57]
s_waitcnt lgkmcnt(0)
buffer_load_dword v3, v2, s[4:7], s53 offen sc1
s_waitcnt vmcnt(0)
s_memtime s[58:59]
s_waitcnt lgkmcnt(0)
s_sub_u32 s56, s58, s56
s_min_u32 s54, s54, s56
v_mov_b32 v2, 8192
s_memtime s[56:57]
s_waitcnt lgkmcnt(0)
buffer_load_dword v3, v2, s[4:7], s53 offen sc1
s_waitcnt vmcnt(0)
s_memtime s[58:59]
s_waitcnt lgkmcnt(0)
s_sub_u32 s56, s58, s56
s_min_u32 s55, s55, s56
v_mov_b32 v2, 1792
s_memtime s[56:57]
s_waitcnt lgkmcnt(0)
buffer_load_dword v3, v2, s[4:7], s53 offen sc1
s_waitcnt vmcnt(0)
s_memtime s[58:59]
s_waitcnt lgkmcnt(0)
s_sub_u32 s56, s58, s56
s_min_u32 s54, s54, s56
v_mov_b32 v2, 9984
s_memtime s[56:57]
s_waitcnt lgkmcnt(0)
buffer_load_dword v3, v2, s[4:7], s53 offen sc1
s_waitcnt vmcnt(0)
s_memtime s[58:59]
s_waitcnt lgkmcnt(0)
s_sub_u32 s56, s58, s56
s_min_u32 s55, s55, s56
v_mov_b32 v2, 3584
s_memtime s[56:57]
s_waitcnt lgkmcnt(0)
buffer_load_dword v3, v2, s[4:7], s53 offen sc1
s_waitcnt vmcnt(0)
s_memtime s[58:59]
s_waitcnt lgkmcnt(0)
s_sub_u32 s56, s58, s56
s_min_u32 s54, s54, s56
v_mov_b32 v2, 11776
s_memtime s[56:57]
s_waitcnt lgkmcnt(0)
buffer_load_dword v3, v2, s[4:7], s53 offen sc1
s_waitcnt vmcnt(0)
s_memtime s[58:59]
s_waitcnt lgkmcnt(0)
s_sub_u32 s56, s58, s56
s_min_u32 s55, s55, s56
v_mov_b32 v2, 5376
s_memtime s[56:57]
s_waitcnt lgkmcnt(0)
buffer_load_dword v3, v2, s[4:7], s53 offen sc1
s_waitcnt vmcnt(0)
s_memtime s[58:59]
s_waitcnt lgkmcnt(0)
s_sub_u32 s56, s58, s56
s_min_u32 s54, s54, s56
v_mov_b32 v2, 13568
s_memtime s[56:57]
s_waitcnt lgkmcnt(0)
buffer_load_dword v3, v2, s[4:7], s53 offen sc1
s_waitcnt vmcnt(0)
s_memtime s[58:59]
s_waitcnt lgkmcnt(0)
s_sub_u32 s56, s58, s56
s_min_u32 s55, s55, s56
s_mov_b64 exec, -1
s_cmp_lt_u32 s55, s54
s_cselect_b32 s56, 1, 0
s_lshr_b32 s57, s51, 2
s_xor_b32 s56, s56, s57
s_lshl_b32 s56, s56, 24
s_or_b32 s52, s52, s56
Lpb_574:
Lnp_573:
s_waitcnt vmcnt(0)
s_barrier
s_cmp_lg_u32 s32, 0
s_cbranch_scc1 Lar_575
s_mov_b64 exec, 1
v_mov_b32 v48, 32
v_mov_b32 v49, s52
buffer_atomic_add v49, v48, s[12:15], 0 offen sc1
s_mov_b64 exec, -1
Lar_575:
v_mov_b32 v48, 32
Lst_576:
s_sub_u32 s37, s37, 1
s_cbranch_scc1 Lend_7
s_sleep 4
buffer_load_dword v49, v48, s[12:15], 0 offen sc1
s_waitcnt vmcnt(0)
v_readfirstlane_b32 s38, v49
s_nop 3
s_and_b32 s39, s38, 0xffff
s_cmp_lg_u32 s39, 256
s_cbranch_scc1 Lst_576
s_bfe_u32 s35, s38, 0x80010
s_bfe_u32 s46, s38, 0x10018
s_lshl_b32 s46, s46, 13
s_barrier
s_mov_b32 s8, s24
s_and_b32 s9, s25, 0xffff
s_mov_b32 s10, 0x800000
s_mov_b32 s11, 0x20000
s_lshl_b32 s60, s33, 21
s_lshl_b32 s38, s26, 8
s_add_u32 s60, s60, s38
s_add_u32 s61, s60, 128
s_lshr_b32 s52, s32, 1
s_lshl_b32 s52, s52, 14
s_and_b32 s53, s32, 1
s_lshl_b32 s53, s53, 6
s_add_u32 s52, s52, s53
v_bfe_u32 v84, v9, 2, 2
v_lshrrev_b32 v85, 4, v9
v_lshl_add_u32 v84, v85, 2, v84
v_lshl_add_u32 v84, v84, 7, s52
v_and_b32 v85, 3, v9
v_lshl_add_u32 v84, v85, 4, v84
v_add_u32 v80, 0, v84
v_bfe_u32 v84, v9, 2, 2
v_lshrrev_b32 v85, 4, v9
v_lshl_add_u32 v84, v85, 2, v84
v_lshl_add_u32 v84, v84, 7, s52
v_and_b32 v85, 3, v9
v_lshl_add_u32 v84, v85, 4, v84
v_add_u32 v81, 8, v84
v_lshrrev_b32 v84, 3, v9
s_lshl_b32 s38, s32, 5
v_add_u32 v84, s38, v84
v_mul_u32_u24 v84, 2048, v84
v_and_b32 v85, 7, v9
v_lshl_add_u32 v84, v85, 4, v84
s_lshl_b32 s38, s32, 12
s_barrier
s_add_u32 m0, s38, 0
s_add_u32 s39, s60, 0
buffer_load_dwordx4 v84, s[8:11], s39 offen lds
s_add_u32 m0, s38, 1024
s_add_u32 s39, s60, 16384
buffer_load_dwordx4 v84, s[8:11], s39 offen lds
s_add_u32 m0, s38, 2048
s_add_u32 s39, s60, 32768
buffer_load_dwordx4 v84, s[8:11], s39 offen lds
s_add_u32 m0, s38, 3072
s_add_u32 s39, s60, 49152
buffer_load_dwordx4 v84, s[8:11], s39 offen lds
s_add_u32 m0, s38, 16384
s_add_u32 s39, s61, 0
buffer_load_dwordx4 v84, s[8:11], s39 offen lds
s_add_u32 m0, s38, 17408
s_add_u32 s39, s61, 16384
buffer_load_dwordx4 v84, s[8:11], s39 offen lds
s_add_u32 m0, s38, 18432
s_add_u32 s39, s61, 32768
buffer_load_dwordx4 v84, s[8:11], s39 offen lds
s_add_u32 m0, s38, 19456
s_add_u32 s39, s61, 49152
buffer_load_dwordx4 v84, s[8:11], s39 offen lds
s_add_u32 m0, s38, 32768
s_add_u32 s39, s60, 262144
buffer_load_dwordx4 v84, s[8:11], s39 offen lds
s_add_u32 m0, s38, 33792
s_add_u32 s39, s60, 278528
buffer_load_dwordx4 v84, s[8:11], s39 offen lds
s_add_u32 m0, s38, 34816
s_add_u32 s39, s60, 294912
buffer_load_dwordx4 v84, s[8:11], s39 offen lds
s_add_u32 m0, s38, 35840
s_add_u32 s39, s60, 311296
buffer_load_dwordx4 v84, s[8:11], s39 offen lds
s_add_u32 m0, s38, 49152
s_add_u32 s39, s61, 262144
buffer_load_dwordx4 v84, s[8:11], s39 offen lds
s_add_u32 m0, s38, 50176
s_add_u32 s39, s61, 278528
buffer_load_dwordx4 v84, s[8:11], s39 offen lds
s_add_u32 m0, s38, 51200
s_add_u32 s39, s61, 294912
buffer_load_dwordx4 v84, s[8:11], s39 offen lds
s_add_u32 m0, s38, 52224
s_add_u32 s39, s61, 311296
buffer_load_dwordx4 v84, s[8:11], s39 offen lds
s_add_u32 m0, s38, 65536
s_add_u32 s39, s60, 524288
buffer_load_dwordx4 v84, s[8:11], s39 offen lds
s_add_u32 m0, s38, 66560
s_add_u32 s39, s60, 540672
buffer_load_dwordx4 v84, s[8:11], s39 offen lds
s_add_u32 m0, s38, 67584
s_add_u32 s39, s60, 557056
buffer_load_dwordx4 v84, s[8:11], s39 offen lds
s_add_u32 m0, s38, 68608
s_add_u32 s39, s60, 573440
buffer_load_dwordx4 v84, s[8:11], s39 offen lds
s_add_u32 m0, s38, 81920
s_add_u32 s39, s61, 524288
buffer_load_dwordx4 v84, s[8:11], s39 offen lds
s_add_u32 m0, s38, 82944
s_add_u32 s39, s61, 540672
buffer_load_dwordx4 v84, s[8:11], s39 offen lds
s_add_u32 m0, s38, 83968
s_add_u32 s39, s61, 557056
buffer_load_dwordx4 v84, s[8:11], s39 offen lds
s_add_u32 m0, s38, 84992
s_add_u32 s39, s61, 573440
buffer_load_dwordx4 v84, s[8:11], s39 offen lds
s_waitcnt vmcnt(16)
s_barrier
ds_read_b64_tr_b16 a[0:1], v80 offset:0
ds_read_b64_tr_b16 a[2:3], v80 offset:2048
ds_read_b64_tr_b16 a[4:5], v80 offset:4096
ds_read_b64_tr_b16 a[6:7], v80 offset:6144
ds_read_b64_tr_b16 a[8:9], v80 offset:8192
ds_read_b64_tr_b16 a[10:11], v80 offset:10240
ds_read_b64_tr_b16 a[12:13], v80 offset:12288
ds_read_b64_tr_b16 a[14:15], v80 offset:14336
ds_read_b64_tr_b16 a[128:129], v81 offset:0
ds_read_b64_tr_b16 a[130:131], v81 offset:2048
ds_read_b64_tr_b16 a[132:133], v81 offset:4096
ds_read_b64_tr_b16 a[134:135], v81 offset:6144
ds_read_b64_tr_b16 a[136:137], v81 offset:8192
ds_read_b64_tr_b16 a[138:139], v81 offset:10240
ds_read_b64_tr_b16 a[140:141], v81 offset:12288
ds_read_b64_tr_b16 a[142:143], v81 offset:14336
v_add_u32 v80, 32768, v80
v_add_u32 v81, 32768, v81
s_waitcnt lgkmcnt(0)
s_barrier
s_add_u32 m0, s38, 0
s_add_u32 s39, s60, 786432
buffer_load_dwordx4 v84, s[8:11], s39 offen lds
s_add_u32 m0, s38, 1024
s_add_u32 s39, s60, 802816
buffer_load_dwordx4 v84, s[8:11], s39 offen lds
s_add_u32 m0, s38, 2048
s_add_u32 s39, s60, 819200
buffer_load_dwordx4 v84, s[8:11], s39 offen lds
s_add_u32 m0, s38, 3072
s_add_u32 s39, s60, 835584
buffer_load_dwordx4 v84, s[8:11], s39 offen lds
s_add_u32 m0, s38, 16384
s_add_u32 s39, s61, 786432
buffer_load_dwordx4 v84, s[8:11], s39 offen lds
s_add_u32 m0, s38, 17408
s_add_u32 s39, s61, 802816
buffer_load_dwordx4 v84, s[8:11], s39 offen lds
s_add_u32 m0, s38, 18432
s_add_u32 s39, s61, 819200
buffer_load_dwordx4 v84, s[8:11], s39 offen lds
s_add_u32 m0, s38, 19456
s_add_u32 s39, s61, 835584
buffer_load_dwordx4 v84, s[8:11], s39 offen lds
s_waitcnt vmcnt(16)
s_barrier
ds_read_b64_tr_b16 a[16:17], v80 offset:0
ds_read_b64_tr_b16 a[18:19], v80 offset:2048
ds_read_b64_tr_b16 a[20:21], v80 offset:4096
ds_read_b64_tr_b16 a[22:23], v80 offset:6144
ds_read_b64_tr_b16 a[24:25], v80 offset:8192
ds_read_b64_tr_b16 a[26:27], v80 offset:10240
ds_read_b64_tr_b16 a[28:29], v80 offset:12288
ds_read_b64_tr_b16 a[30:31], v80 offset:14336
ds_read_b64_tr_b16 a[144:145], v81 offset:0
ds_read_b64_tr_b16 a[146:147], v81 offset:2048
ds_read_b64_tr_b16 a[148:149], v81 offset:4096
ds_read_b64_tr_b16 a[150:151], v81 offset:6144
ds_read_b64_tr_b16 a[152:153], v81 offset:8192
ds_read_b64_tr_b16 a[154:155], v81 offset:10240
ds_read_b64_tr_b16 a[156:157], v81 offset:12288
ds_read_b64_tr_b16 a[158:159], v81 offset:14336
v_add_u32 v80, 32768, v80
v_add_u32 v81, 32768, v81
s_waitcnt lgkmcnt(0)
s_barrier
s_add_u32 m0, s38, 32768
s_add_u32 s39, s60, 1048576
buffer_load_dwordx4 v84, s[8:11], s39 offen lds
s_add_u32 m0, s38, 33792
s_add_u32 s39, s60, 1064960
buffer_load_dwordx4 v84, s[8:11], s39 offen lds
s_add_u32 m0, s38, 34816
s_add_u32 s39, s60, 1081344
buffer_load_dwordx4 v84, s[8:11], s39 offen lds
s_add_u32 m0, s38, 35840
s_add_u32 s39, s60, 1097728
buffer_load_dwordx4 v84, s[8:11], s39 offen lds
s_add_u32 m0, s38, 49152
s_add_u32 s39, s61, 1048576
buffer_load_dwordx4 v84, s[8:11], s39 offen lds
s_add_u32 m0, s38, 50176
s_add_u32 s39, s61, 1064960
buffer_load_dwordx4 v84, s[8:11], s39 offen lds
s_add_u32 m0, s38, 51200
s_add_u32 s39, s61, 1081344
buffer_load_dwordx4 v84, s[8:11], s39 offen lds
s_add_u32 m0, s38, 52224
s_add_u32 s39, s61, 1097728
buffer_load_dwordx4 v84, s[8:11], s39 offen lds
s_waitcnt vmcnt(16)
s_barrier
ds_read_b64_tr_b16 a[32:33], v80 offset:0
ds_read_b64_tr_b16 a[34:35], v80 offset:2048
ds_read_b64_tr_b16 a[36:37], v80 offset:4096
ds_read_b64_tr_b16 a[38:39], v80 offset:6144
ds_read_b64_tr_b16 a[40:41], v80 offset:8192
ds_read_b64_tr_b16 a[42:43], v80 offset:10240
ds_read_b64_tr_b16 a[44:45], v80 offset:12288
ds_read_b64_tr_b16 a[46:47], v80 offset:14336
ds_read_b64_tr_b16 a[160:161], v81 offset:0
ds_read_b64_tr_b16 a[162:163], v81 offset:2048
ds_read_b64_tr_b16 a[164:165], v81 offset:4096
ds_read_b64_tr_b16 a[166:167], v81 offset:6144
ds_read_b64_tr_b16 a[168:169], v81 offset:8192
ds_read_b64_tr_b16 a[170:171], v81 offset:10240
ds_read_b64_tr_b16 a[172:173], v81 offset:12288
ds_read_b64_tr_b16 a[174:175], v81 offset:14336
v_add_u32 v80, -65536, v80
v_add_u32 v81, -65536, v81
s_waitcnt lgkmcnt(0)
s_barrier
s_add_u32 m0, s38, 65536
s_add_u32 s39, s60, 1310720
buffer_load_dwordx4 v84, s[8:11], s39 offen lds
s_add_u32 m0, s38, 66560
s_add_u32 s39, s60, 1327104
buffer_load_dwordx4 v84, s[8:11], s39 offen lds
s_add_u32 m0, s38, 67584
s_add_u32 s39, s60, 1343488
buffer_load_dwordx4 v84, s[8:11], s39 offen lds
s_add_u32 m0, s38, 68608
s_add_u32 s39, s60, 1359872
buffer_load_dwordx4 v84, s[8:11], s39 offen lds
s_add_u32 m0, s38, 81920
s_add_u32 s39, s61, 1310720
buffer_load_dwordx4 v84, s[8:11], s39 offen lds
s_add_u32 m0, s38, 82944
s_add_u32 s39, s61, 1327104
buffer_load_dwordx4 v84, s[8:11], s39 offen lds
s_add_u32 m0, s38, 83968
s_add_u32 s39, s61, 1343488
buffer_load_dwordx4 v84, s[8:11], s39 offen lds
s_add_u32 m0, s38, 84992
s_add_u32 s39, s61, 1359872
buffer_load_dwordx4 v84, s[8:11], s39 offen lds
s_waitcnt vmcnt(16)
s_barrier
ds_read_b64_tr_b16 a[48:49], v80 offset:0
ds_read_b64_tr_b16 a[50:51], v80 offset:2048
ds_read_b64_tr_b16 a[52:53], v80 offset:4096
ds_read_b64_tr_b16 a[54:55], v80 offset:6144
ds_read_b64_tr_b16 a[56:57], v80 offset:8192
ds_read_b64_tr_b16 a[58:59], v80 offset:10240
ds_read_b64_tr_b16 a[60:61], v80 offset:12288
ds_read_b64_tr_b16 a[62:63], v80 offset:14336
ds_read_b64_tr_b16 a[176:177], v81 offset:0
ds_read_b64_tr_b16 a[178:179], v81 offset:2048
ds_read_b64_tr_b16 a[180:181], v81 offset:4096
ds_read_b64_tr_b16 a[182:183], v81 offset:6144
ds_read_b64_tr_b16 a[184:185], v81 offset:8192
ds_read_b64_tr_b16 a[186:187], v81 offset:10240
ds_read_b64_tr_b16 a[188:189], v81 offset:12288
ds_read_b64_tr_b16 a[190:191], v81 offset:14336
v_add_u32 v80, 32768, v80
v_add_u32 v81, 32768, v81
s_waitcnt lgkmcnt(0)
s_barrier
s_add_u32 m0, s38, 0
s_add_u32 s39, s60, 1572864
buffer_load_dwordx4 v84, s[8:11], s39 offen lds
s_add_u32 m0, s38, 1024
s_add_u32 s39, s60, 1589248
buffer_load_dwordx4 v84, s[8:11], s39 offen lds
s_add_u32 m0, s38, 2048
s_add_u32 s39, s60, 1605632
buffer_load_dwordx4 v84, s[8:11], s39 offen lds
s_add_u32 m0, s38, 3072
s_add_u32 s39, s60, 1622016
buffer_load_dwordx4 v84, s[8:11], s39 offen lds
s_add_u32 m0, s38, 16384
s_add_u32 s39, s61, 1572864
buffer_load_dwordx4 v84, s[8:11], s39 offen lds
s_add_u32 m0, s38, 17408
s_add_u32 s39, s61, 1589248
buffer_load_dwordx4 v84, s[8:11], s39 offen lds
s_add_u32 m0, s38, 18432
s_add_u32 s39, s61, 1605632
buffer_load_dwordx4 v84, s[8:11], s39 offen lds
s_add_u32 m0, s38, 19456
s_add_u32 s39, s61, 1622016
buffer_load_dwordx4 v84, s[8:11], s39 offen lds
s_waitcnt vmcnt(16)
s_barrier
ds_read_b64_tr_b16 a[64:65], v80 offset:0
ds_read_b64_tr_b16 a[66:67], v80 offset:2048
ds_read_b64_tr_b16 a[68:69], v80 offset:4096
ds_read_b64_tr_b16 a[70:71], v80 offset:6144
ds_read_b64_tr_b16 a[72:73], v80 offset:8192
ds_read_b64_tr_b16 a[74:75], v80 offset:10240
ds_read_b64_tr_b16 a[76:77], v80 offset:12288
ds_read_b64_tr_b16 a[78:79], v80 offset:14336
ds_read_b64_tr_b16 a[192:193], v81 offset:0
ds_read_b64_tr_b16 a[194:195], v81 offset:2048
ds_read_b64_tr_b16 a[196:197], v81 offset:4096
ds_read_b64_tr_b16 a[198:199], v81 offset:6144
ds_read_b64_tr_b16 a[200:201], v81 offset:8192
ds_read_b64_tr_b16 a[202:203], v81 offset:10240
ds_read_b64_tr_b16 a[204:205], v81 offset:12288
ds_read_b64_tr_b16 a[206:207], v81 offset:14336
v_add_u32 v80, 32768, v80
v_add_u32 v81, 32768, v81
s_waitcnt lgkmcnt(0)
s_barrier
s_add_u32 m0, s38, 32768
s_add_u32 s39, s60, 1835008
buffer_load_dwordx4 v84, s[8:11], s39 offen lds
s_add_u32 m0, s38, 33792
s_add_u32 s39, s60, 1851392
buffer_load_dwordx4 v84, s[8:11], s39 offen lds
s_add_u32 m0, s38, 34816
s_add_u32 s39, s60, 1867776
buffer_load_dwordx4 v84, s[8:11], s39 offen lds
s_add_u32 m0, s38, 35840
s_add_u32 s39, s60, 1884160
buffer_load_dwordx4 v84, s[8:11], s39 offen lds
s_add_u32 m0, s38, 49152
s_add_u32 s39, s61, 1835008
buffer_load_dwordx4 v84, s[8:11], s39 offen lds
s_add_u32 m0, s38, 50176
s_add_u32 s39, s61, 1851392
buffer_load_dwordx4 v84, s[8:11], s39 offen lds
s_add_u32 m0, s38, 51200
s_add_u32 s39, s61, 1867776
buffer_load_dwordx4 v84, s[8:11], s39 offen lds
s_add_u32 m0, s38, 52224
s_add_u32 s39, s61, 1884160
buffer_load_dwordx4 v84, s[8:11], s39 offen lds
s_waitcnt vmcnt(16)
s_barrier
ds_read_b64_tr_b16 a[80:81], v80 offset:0
ds_read_b64_tr_b16 a[82:83], v80 offset:2048
ds_read_b64_tr_b16 a[84:85], v80 offset:4096
ds_read_b64_tr_b16 a[86:87], v80 offset:6144
ds_read_b64_tr_b16 a[88:89], v80 offset:8192
ds_read_b64_tr_b16 a[90:91], v80 offset:10240
ds_read_b64_tr_b16 a[92:93], v80 offset:12288
ds_read_b64_tr_b16 a[94:95], v80 offset:14336
ds_read_b64_tr_b16 a[208:209], v81 offset:0
ds_read_b64_tr_b16 a[210:211], v81 offset:2048
ds_read_b64_tr_b16 a[212:213], v81 offset:4096
ds_read_b64_tr_b16 a[214:215], v81 offset:6144
ds_read_b64_tr_b16 a[216:217], v81 offset:8192
ds_read_b64_tr_b16 a[218:219], v81 offset:10240
ds_read_b64_tr_b16 a[220:221], v81 offset:12288
ds_read_b64_tr_b16 a[222:223], v81 offset:14336
v_add_u32 v80, -65536, v80
v_add_u32 v81, -65536, v81
s_waitcnt lgkmcnt(0)
s_barrier
s_waitcnt vmcnt(8)
s_barrier
ds_read_b64_tr_b16 a[96:97], v80 offset:0
ds_read_b64_tr_b16 a[98:99], v80 offset:2048
ds_read_b64_tr_b16 a[100:101], v80 offset:4096
ds_read_b64_tr_b16 a[102:103], v80 offset:6144
ds_read_b64_tr_b16 a[104:105], v80 offset:8192
ds_read_b64_tr_b16 a[106:107], v80 offset:10240
ds_read_b64_tr_b16 a[108:109], v80 offset:12288
ds_read_b64_tr_b16 a[110:111], v80 offset:14336
ds_read_b64_tr_b16 a[224:225], v81 offset:0
ds_read_b64_tr_b16 a[226:227], v81 offset:2048
ds_read_b64_tr_b16 a[228:229], v81 offset:4096
ds_read_b64_tr_b16 a[230:231], v81 offset:6144
ds_read_b64_tr_b16 a[232:233], v81 offset:8192
ds_read_b64_tr_b16 a[234:235], v81 offset:10240
ds_read_b64_tr_b16 a[236:237], v81 offset:12288
ds_read_b64_tr_b16 a[238:239], v81 offset:14336
v_add_u32 v80, 32768, v80
v_add_u32 v81, 32768, v81
s_waitcnt lgkmcnt(0)
s_barrier
s_waitcnt vmcnt(0)
s_barrier
ds_read_b64_tr_b16 a[112:113], v80 offset:0
ds_read_b64_tr_b16 a[114:115], v80 offset:2048
ds_read_b64_tr_b16 a[116:117], v80 offset:4096
ds_read_b64_tr_b16 a[118:119], v80 offset:6144
ds_read_b64_tr_b16 a[120:121], v80 offset:8192
ds_read_b64_tr_b16 a[122:123], v80 offset:10240
ds_read_b64_tr_b16 a[124:125], v80 offset:12288
ds_read_b64_tr_b16 a[126:127], v80 offset:14336
ds_read_b64_tr_b16 a[240:241], v81 offset:0
ds_read_b64_tr_b16 a[242:243], v81 offset:2048
ds_read_b64_tr_b16 a[244:245], v81 offset:4096
ds_read_b64_tr_b16 a[246:247], v81 offset:6144
ds_read_b64_tr_b16 a[248:249], v81 offset:8192
ds_read_b64_tr_b16 a[250:251], v81 offset:10240
ds_read_b64_tr_b16 a[252:253], v81 offset:12288
ds_read_b64_tr_b16 a[254:255], v81 offset:14336
v_add_u32 v80, 32768, v80
v_add_u32 v81, 32768, v81
s_waitcnt lgkmcnt(0)
s_barrier
s_mul_i32 s50, s32, 16384
v_lshlrev_b32 v1, 4, v9
v_add_u32 v0, s50, v1
v_lshrrev_b32 v80, 2, v9
v_min_u32 v80, 7, v80
v_lshlrev_b32 v80, 7, v80
v_and_b32 v2, 3, v9
v_lshl_add_u32 v2, v2, 2, v80
s_lshl_b32 s47, s33, 10
s_add_u32 s47, s47, 3432448
v_mov_b32 v6, v1
s_lshl_b32 s38, s26, 2
s_add_u32 s38, s38, s32
s_lshl_b32 s38, s38, 11
s_lshl_b32 s49, s33, 22
s_add_u32 s49, s49, s38
s_add_u32 s49, s49, 117374976
s_lshl_b32 s54, s33, 16
s_add_u32 s54, s54, 83886080
s_lshl_b32 s45, s26, 18
s_add_u32 s45, s45, s54
s_add_u32 m0, s50, 0
s_add_u32 s39, s45, 0
buffer_load_dwordx4 v0, s[4:7], s39 offen offset:0 sc1 lds
buffer_load_dwordx4 v0, s[4:7], s39 offen offset:1024 sc1 lds
buffer_load_dwordx4 v0, s[4:7], s39 offen offset:2048 sc1 lds
buffer_load_dwordx4 v0, s[4:7], s39 offen offset:3072 sc1 lds
s_add_u32 m0, s50, 4096
s_add_u32 s39, s45, 4096
buffer_load_dwordx4 v0, s[4:7], s39 offen offset:0 sc1 lds
buffer_load_dwordx4 v0, s[4:7], s39 offen offset:1024 sc1 lds
buffer_load_dwordx4 v0, s[4:7], s39 offen offset:2048 sc1 lds
buffer_load_dwordx4 v0, s[4:7], s39 offen offset:3072 sc1 lds
s_add_u32 m0, s50, 8192
s_add_u32 s39, s45, 8192
buffer_load_dwordx4 v0, s[4:7], s39 offen offset:0 sc1 lds
buffer_load_dwordx4 v0, s[4:7], s39 offen offset:1024 sc1 lds
buffer_load_dwordx4 v0, s[4:7], s39 offen offset:2048 sc1 lds
buffer_load_dwordx4 v0, s[4:7], s39 offen offset:3072 sc1 lds
s_add_u32 m0, s50, 12288
s_add_u32 s39, s45, 12288
buffer_load_dwordx4 v0, s[4:7], s39 offen offset:0 sc1 lds
buffer_load_dwordx4 v0, s[4:7], s39 offen offset:1024 sc1 lds
buffer_load_dwordx4 v0, s[4:7], s39 offen offset:2048 sc1 lds
buffer_load_dwordx4 v0, s[4:7], s39 offen offset:3072 sc1 lds
v_mov_b32 v8, 0
s_mov_b32 s36, 0
s_mov_b32 s63, 0
Lsw_579:
s_add_u32 s48, s36, 1
Lbw_582:
buffer_load_dword v3, v2, s[4:7], s47 offen sc1
s_waitcnt vmcnt(0)
v_cmp_gt_u32 vcc, s48, v3
s_cbranch_vccz Lbo_583
s_sub_u32 s37, s37, 1
s_cbranch_scc1 Lend_7
s_sleep 1
s_branch Lbw_582
Lbo_583:
s_add_u32 m0, s50, 0
s_add_u32 s39, s54, 0
buffer_load_dwordx4 v0, s[4:7], s39 offen offset:0 sc1 lds
buffer_load_dwordx4 v0, s[4:7], s39 offen offset:1024 sc1 lds
buffer_load_dwordx4 v0, s[4:7], s39 offen offset:2048 sc1 lds
buffer_load_dwordx4 v0, s[4:7], s39 offen offset:3072 sc1 lds
s_add_u32 m0, s50, 4096
s_add_u32 s39, s54, 4096
buffer_load_dwordx4 v0, s[4:7], s39 offen offset:0 sc1 lds
buffer_load_dwordx4 v0, s[4:7], s39 offen offset:1024 sc1 lds
buffer_load_dwordx4 v0, s[4:7], s39 offen offset:2048 sc1 lds
buffer_load_dwordx4 v0, s[4:7], s39 offen offset:3072 sc1 lds
s_add_u32 m0, s50, 8192
s_add_u32 s39, s54, 8192
buffer_load_dwordx4 v0, s[4:7], s39 offen offset:0 sc1 lds
buffer_load_dwordx4 v0, s[4:7], s39 offen offset:1024 sc1 lds
buffer_load_dwordx4 v0, s[4:7], s39 offen offset:2048 sc1 lds
buffer_load_dwordx4 v0, s[4:7], s39 offen offset:3072 sc1 lds
s_add_u32 m0, s50, 12288
s_add_u32 s39, s54, 12288
buffer_load_dwordx4 v0, s[4:7], s39 offen offset:0 sc1 lds
buffer_load_dwordx4 v0, s[4:7], s39 offen offset:1024 sc1 lds
buffer_load_dwordx4 v0, s[4:7], s39 offen offset:2048 sc1 lds
buffer_load_dwordx4 v0, s[4:7], s39 offen offset:3072 sc1 lds
s_add_u32 s48, s36, 2
buffer_load_dword v3, v2, s[4:7], s47 offen sc1
s_waitcnt vmcnt(0)
Lse_580:
s_barrier
ds_read_b128 v[16:19], v1 offset:0
ds_read_b128 v[20:23], v1 offset:1024
ds_read_b128 v[24:27], v1 offset:2048
ds_read_b128 v[28:31], v1 offset:3072
ds_read_b128 v[32:35], v1 offset:4096
ds_read_b128 v[36:39], v1 offset:5120
ds_read_b128 v[40:43], v1 offset:6144
Lsb_578:
v_add_u32 v8, 1, v8
s_cmp_lg_u32 s35, 0
s_cbranch_scc1 Llf_584
buffer_store_dword v8, v7, s[4:7], 0 offen
s_branch Llo_585
Llf_584:
buffer_store_dword v8, v7, s[4:7], 0 offen sc1
Llo_585:
s_add_u32 s54, s54, 262144
s_bitset0_b32 s54, 21
s_xor_b32 s50, s50, 0x10000
v_cmp_gt_u32 vcc, s48, v3
s_cmp_eq_u64 vcc, 0
s_cselect_b32 s46, 1, 0
s_cselect_b32 s45, s54, 0x70000000
s_waitcnt lgkmcnt(5)
v_mfma_f32_16x16x32_bf16 v[48:51], a[0:3], v[16:19], 0
ds_read_b128 v[44:47], v1 offset:7168
v_mfma_f32_16x16x32_bf16 v[52:55], a[128:131], v[16:19], 0
v_mfma_f32_16x16x32_bf16 v[56:59], a[0:3], v[20:23], 0
ds_read_b128 v[16:19], v1 offset:8192
s_add_u32 m0, s50, 0
v_mfma_f32_16x16x32_bf16 v[60:63], a[128:131], v[20:23], 0
s_add_u32 s39, s45, 0
s_waitcnt lgkmcnt(5)
v_mfma_f32_16x16x32_bf16 v[48:51], a[4:7], v[24:27], v[48:51]
ds_read_b128 v[20:23], v1 offset:9216
v_mfma_f32_16x16x32_bf16 v[52:55], a[132:135], v[24:27], v[52:55]
buffer_load_dwordx4 v0, s[4:7], s39 offen offset:0 sc1 lds
v_mfma_f32_16x16x32_bf16 v[56:59], a[4:7], v[28:31], v[56:59]
ds_read_b128 v[24:27], v1 offset:10240
v_mfma_f32_16x16x32_bf16 v[60:63], a[132:135], v[28:31], v[60:63]
s_waitcnt lgkmcnt(5)
v_mfma_f32_16x16x32_bf16 v[48:51], a[8:11], v[32:35], v[48:51]
ds_read_b128 v[28:31], v1 offset:11264
v_mfma_f32_16x16x32_bf16 v[52:55], a[136:139], v[32:35], v[52:55]
buffer_load_dwordx4 v0, s[4:7], s39 offen offset:1024 sc1 lds
v_mfma_f32_16x16x32_bf16 v[56:59], a[8:11], v[36:39], v[56:59]
ds_read_b128 v[32:35], v1 offset:12288
v_mfma_f32_16x16x32_bf16 v[60:63], a[136:139], v[36:39], v[60:63]
s_waitcnt lgkmcnt(5)
v_mfma_f32_16x16x32_bf16 v[48:51], a[12:15], v[40:43], v[48:51]
ds_read_b128 v[36:39], v1 offset:13312
v_mfma_f32_16x16x32_bf16 v[52:55], a[140:143], v[40:43], v[52:55]
buffer_load_dwordx4 v0, s[4:7], s39 offen offset:2048 sc1 lds
v_mfma_f32_16x16x32_bf16 v[56:59], a[12:15], v[44:47], v[56:59]
ds_read_b128 v[40:43], v1 offset:14336
v_mfma_f32_16x16x32_bf16 v[60:63], a[140:143], v[44:47], v[60:63]
s_waitcnt lgkmcnt(5)
v_mfma_f32_16x16x32_bf16 v[48:51], a[16:19], v[16:19], v[48:51]
ds_read_b128 v[44:47], v1 offset:15360
v_mfma_f32_16x16x32_bf16 v[52:55], a[144:147], v[16:19], v[52:55]
buffer_load_dwordx4 v0, s[4:7], s39 offen offset:3072 sc1 lds
v_mfma_f32_16x16x32_bf16 v[56:59], a[16:19], v[20:23], v[56:59]
ds_read_b128 v[16:19], v1 offset:16384
v_mfma_f32_16x16x32_bf16 v[60:63], a[144:147], v[20:23], v[60:63]
s_waitcnt lgkmcnt(5)
v_mfma_f32_16x16x32_bf16 v[48:51], a[20:23], v[24:27], v[48:51]
ds_read_b128 v[20:23], v1 offset:17408
v_mfma_f32_16x16x32_bf16 v[52:55], a[148:151], v[24:27], v[52:55]
s_add_u32 m0, s50, 4096
s_add_u32 s39, s45, 4096
v_mfma_f32_16x16x32_bf16 v[56:59], a[20:23], v[28:31], v[56:59]
ds_read_b128 v[24:27], v1 offset:18432
v_mfma_f32_16x16x32_bf16 v[60:63], a[148:151], v[28:31], v[60:63]
s_waitcnt lgkmcnt(5)
v_mfma_f32_16x16x32_bf16 v[48:51], a[24:27], v[32:35], v[48:51]
ds_read_b128 v[28:31], v1 offset:19456
v_mfma_f32_16x16x32_bf16 v[52:55], a[152:155], v[32:35], v[52:55]
buffer_load_dwordx4 v0, s[4:7], s39 offen offset:0 sc1 lds
v_mfma_f32_16x16x32_bf16 v[56:59], a[24:27], v[36:39], v[56:59]
ds_read_b128 v[32:35], v1 offset:20480
v_mfma_f32_16x16x32_bf16 v[60:63], a[152:155], v[36:39], v[60:63]
s_waitcnt lgkmcnt(5)
v_mfma_f32_16x16x32_bf16 v[48:51], a[28:31], v[40:43], v[48:51]
ds_read_b128 v[36:39], v1 offset:21504
v_mfma_f32_16x16x32_bf16 v[52:55], a[156:159], v[40:43], v[52:55]
buffer_load_dwordx4 v0, s[4:7], s39 offen offset:1024 sc1 lds
v_mfma_f32_16x16x32_bf16 v[56:59], a[28:31], v[44:47], v[56:59]
ds_read_b128 v[40:43], v1 offset:22528
v_mfma_f32_16x16x32_bf16 v[60:63], a[156:159], v[44:47], v[60:63]
s_waitcnt lgkmcnt(5)
v_mfma_f32_16x16x32_bf16 v[48:51], a[32:35], v[16:19], v[48:51]
ds_read_b128 v[44:47], v1 offset:23552
v_mfma_f32_16x16x32_bf16 v[52:55], a[160:163], v[16:19], v[52:55]
buffer_load_dwordx4 v0, s[4:7], s39 offen offset:2048 sc1 lds
v_mfma_f32_16x16x32_bf16 v[56:59], a[32:35], v[20:23], v[56:59]
ds_read_b128 v[16:19], v1 offset:24576
v_mfma_f32_16x16x32_bf16 v[60:63], a[160:163], v[20:23], v[60:63]
s_waitcnt lgkmcnt(5)
v_mfma_f32_16x16x32_bf16 v[48:51], a[36:39], v[24:27], v[48:51]
ds_read_b128 v[20:23], v1 offset:25600
v_mfma_f32_16x16x32_bf16 v[52:55], a[164:167], v[24:27], v[52:55]
buffer_load_dwordx4 v0, s[4:7], s39 offen offset:3072 sc1 lds
v_mfma_f32_16x16x32_bf16 v[56:59], a[36:39], v[28:31], v[56:59]
ds_read_b128 v[24:27], v1 offset:26624
v_mfma_f32_16x16x32_bf16 v[60:63], a[164:167], v[28:31], v[60:63]
s_waitcnt lgkmcnt(5)
v_mfma_f32_16x16x32_bf16 v[48:51], a[40:43], v[32:35], v[48:51]
ds_read_b128 v[28:31], v1 offset:27648
v_mfma_f32_16x16x32_bf16 v[52:55], a[168:171], v[32:35], v[52:55]
s_add_u32 m0, s50, 8192
s_add_u32 s39, s45, 8192
v_mfma_f32_16x16x32_bf16 v[56:59], a[40:43], v[36:39], v[56:59]
ds_read_b128 v[32:35], v1 offset:28672
v_mfma_f32_16x16x32_bf16 v[60:63], a[168:171], v[36:39], v[60:63]
s_waitcnt lgkmcnt(5)
v_mfma_f32_16x16x32_bf16 v[48:51], a[44:47], v[40:43], v[48:51]
ds_read_b128 v[36:39], v1 offset:29696
v_mfma_f32_16x16x32_bf16 v[52:55], a[172:175], v[40:43], v[52:55]
buffer_load_dwordx4 v0, s[4:7], s39 offen offset:0 sc1 lds
v_mfma_f32_16x16x32_bf16 v[56:59], a[44:47], v[44:47], v[56:59]
ds_read_b128 v[40:43], v1 offset:30720
v_mfma_f32_16x16x32_bf16 v[60:63], a[172:175], v[44:47], v[60:63]
s_waitcnt lgkmcnt(5)
v_mfma_f32_16x16x32_bf16 v[48:51], a[48:51], v[16:19], v[48:51]
ds_read_b128 v[44:47], v1 offset:31744
v_mfma_f32_16x16x32_bf16 v[52:55], a[176:179], v[16:19], v[52:55]
buffer_load_dwordx4 v0, s[4:7], s39 offen offset:1024 sc1 lds
v_mfma_f32_16x16x32_bf16 v[56:59], a[48:51], v[20:23], v[56:59]
ds_read_b128 v[16:19], v1 offset:32768
v_mfma_f32_16x16x32_bf16 v[60:63], a[176:179], v[20:23], v[60:63]
s_waitcnt lgkmcnt(5)
v_mfma_f32_16x16x32_bf16 v[48:51], a[52:55], v[24:27], v[48:51]
ds_read_b128 v[20:23], v1 offset:33792
v_mfma_f32_16x16x32_bf16 v[52:55], a[180:183], v[24:27], v[52:55]
buffer_load_dwordx4 v0, s[4:7], s39 offen offset:2048 sc1 lds
v_mfma_f32_16x16x32_bf16 v[56:59], a[52:55], v[28:31], v[56:59]
ds_read_b128 v[24:27], v1 offset:34816
v_mfma_f32_16x16x32_bf16 v[60:63], a[180:183], v[28:31], v[60:63]
s_waitcnt lgkmcnt(5)
v_mfma_f32_16x16x32_bf16 v[48:51], a[56:59], v[32:35], v[48:51]
ds_read_b128 v[28:31], v1 offset:35840
v_mfma_f32_16x16x32_bf16 v[52:55], a[184:187], v[32:35], v[52:55]
buffer_load_dwordx4 v0, s[4:7], s39 offen offset:3072 sc1 lds
v_mfma_f32_16x16x32_bf16 v[56:59], a[56:59], v[36:39], v[56:59]
ds_read_b128 v[32:35], v1 offset:36864
v_mfma_f32_16x16x32_bf16 v[60:63], a[184:187], v[36:39], v[60:63]
s_waitcnt lgkmcnt(5)
v_mfma_f32_16x16x32_bf16 v[48:51], a[60:63], v[40:43], v[48:51]
ds_read_b128 v[36:39], v1 offset:37888
v_mfma_f32_16x16x32_bf16 v[52:55], a[188:191], v[40:43], v[52:55]
s_add_u32 m0, s50, 12288
s_add_u32 s39, s45, 12288
v_mfma_f32_16x16x32_bf16 v[56:59], a[60:63], v[44:47], v[56:59]
ds_read_b128 v[40:43], v1 offset:38912
v_mfma_f32_16x16x32_bf16 v[60:63], a[188:191], v[44:47], v[60:63]
s_waitcnt lgkmcnt(5)
v_mfma_f32_16x16x32_bf16 v[48:51], a[64:67], v[16:19], v[48:51]
ds_read_b128 v[44:47], v1 offset:39936
v_mfma_f32_16x16x32_bf16 v[52:55], a[192:195], v[16:19], v[52:55]
buffer_load_dwordx4 v0, s[4:7], s39 offen offset:0 sc1 lds
v_mfma_f32_16x16x32_bf16 v[56:59], a[64:67], v[20:23], v[56:59]
ds_read_b128 v[16:19], v1 offset:40960
v_mfma_f32_16x16x32_bf16 v[60:63], a[192:195], v[20:23], v[60:63]
s_waitcnt lgkmcnt(5)
v_mfma_f32_16x16x32_bf16 v[48:51], a[68:71], v[24:27], v[48:51]
ds_read_b128 v[20:23], v1 offset:41984
v_mfma_f32_16x16x32_bf16 v[52:55], a[196:199], v[24:27], v[52:55]
buffer_load_dwordx4 v0, s[4:7], s39 offen offset:1024 sc1 lds
v_mfma_f32_16x16x32_bf16 v[56:59], a[68:71], v[28:31], v[56:59]
ds_read_b128 v[24:27], v1 offset:43008
v_mfma_f32_16x16x32_bf16 v[60:63], a[196:199], v[28:31], v[60:63]
s_waitcnt lgkmcnt(5)
v_mfma_f32_16x16x32_bf16 v[48:51], a[72:75], v[32:35], v[48:51]
ds_read_b128 v[28:31], v1 offset:44032
v_mfma_f32_16x16x32_bf16 v[52:55], a[200:203], v[32:35], v[52:55]
buffer_load_dwordx4 v0, s[4:7], s39 offen offset:2048 sc1 lds
v_mfma_f32_16x16x32_bf16 v[56:59], a[72:75], v[36:39], v[56:59]
ds_read_b128 v[32:35], v1 offset:45056
v_mfma_f32_16x16x32_bf16 v[60:63], a[200:203], v[36:39], v[60:63]
s_waitcnt lgkmcnt(5)
v_mfma_f32_16x16x32_bf16 v[48:51], a[76:79], v[40:43], v[48:51]
ds_read_b128 v[36:39], v1 offset:46080
v_mfma_f32_16x16x32_bf16 v[52:55], a[204:207], v[40:43], v[52:55]
buffer_load_dwordx4 v0, s[4:7], s39 offen offset:3072 sc1 lds
v_mfma_f32_16x16x32_bf16 v[56:59], a[76:79], v[44:47], v[56:59]
ds_read_b128 v[40:43], v1 offset:47104
v_mfma_f32_16x16x32_bf16 v[60:63], a[204:207], v[44:47], v[60:63]
s_waitcnt lgkmcnt(5)
v_mfma_f32_16x16x32_bf16 v[48:51], a[80:83], v[16:19], v[48:51]
ds_read_b128 v[44:47], v1 offset:48128
v_mfma_f32_16x16x32_bf16 v[52:55], a[208:211], v[16:19], v[52:55]
s_add_u32 s48, s36, 3
v_mfma_f32_16x16x32_bf16 v[56:59], a[80:83], v[20:23], v[56:59]
ds_read_b128 v[16:19], v1 offset:49152
v_mfma_f32_16x16x32_bf16 v[60:63], a[208:211], v[20:23], v[60:63]
s_waitcnt lgkmcnt(5)
v_mfma_f32_16x16x32_bf16 v[48:51], a[84:87], v[24:27], v[48:51]
ds_read_b128 v[20:23], v1 offset:50176
v_mfma_f32_16x16x32_bf16 v[52:55], a[212:215], v[24:27], v[52:55]
buffer_load_dword v3, v2, s[4:7], s47 offen sc1
v_mfma_f32_16x16x32_bf16 v[56:59], a[84:87], v[28:31], v[56:59]
ds_read_b128 v[24:27], v1 offset:51200
v_mfma_f32_16x16x32_bf16 v[60:63], a[212:215], v[28:31], v[60:63]
s_waitcnt lgkmcnt(5)
v_mfma_f32_16x16x32_bf16 v[48:51], a[88:91], v[32:35], v[48:51]
ds_read_b128 v[28:31], v1 offset:52224
v_mfma_f32_16x16x32_bf16 v[52:55], a[216:219], v[32:35], v[52:55]
v_mfma_f32_16x16x32_bf16 v[56:59], a[88:91], v[36:39], v[56:59]
ds_read_b128 v[32:35], v1 offset:53248
v_mfma_f32_16x16x32_bf16 v[60:63], a[216:219], v[36:39], v[60:63]
s_waitcnt lgkmcnt(5)
v_mfma_f32_16x16x32_bf16 v[48:51], a[92:95], v[40:43], v[48:51]
ds_read_b128 v[36:39], v1 offset:54272
v_mfma_f32_16x16x32_bf16 v[52:55], a[220:223], v[40:43], v[52:55]
v_mfma_f32_16x16x32_bf16 v[56:59], a[92:95], v[44:47], v[56:59]
ds_read_b128 v[40:43], v1 offset:55296
v_mfma_f32_16x16x32_bf16 v[60:63], a[220:223], v[44:47], v[60:63]
s_waitcnt lgkmcnt(5)
v_mfma_f32_16x16x32_bf16 v[48:51], a[96:99], v[16:19], v[48:51]
ds_read_b128 v[44:47], v1 offset:56320
v_mfma_f32_16x16x32_bf16 v[52:55], a[224:227], v[16:19], v[52:55]
v_mfma_f32_16x16x32_bf16 v[56:59], a[96:99], v[20:23], v[56:59]
ds_read_b128 v[16:19], v1 offset:57344
v_mfma_f32_16x16x32_bf16 v[60:63], a[224:227], v[20:23], v[60:63]
s_waitcnt lgkmcnt(5)
v_mfma_f32_16x16x32_bf16 v[48:51], a[100:103], v[24:27], v[48:51]
ds_read_b128 v[20:23], v1 offset:58368
v_mfma_f32_16x16x32_bf16 v[52:55], a[228:231], v[24:27], v[52:55]
v_mfma_f32_16x16x32_bf16 v[56:59], a[100:103], v[28:31], v[56:59]
ds_read_b128 v[24:27], v1 offset:59392
v_mfma_f32_16x16x32_bf16 v[60:63], a[228:231], v[28:31], v[60:63]
s_waitcnt lgkmcnt(5)
v_mfma_f32_16x16x32_bf16 v[48:51], a[104:107], v[32:35], v[48:51]
ds_read_b128 v[28:31], v1 offset:60416
v_mfma_f32_16x16x32_bf16 v[52:55], a[232:235], v[32:35], v[52:55]
v_mfma_f32_16x16x32_bf16 v[56:59], a[104:107], v[36:39], v[56:59]
ds_read_b128 v[32:35], v1 offset:61440
v_mfma_f32_16x16x32_bf16 v[60:63], a[232:235], v[36:39], v[60:63]
s_waitcnt lgkmcnt(5)
v_mfma_f32_16x16x32_bf16 v[48:51], a[108:111], v[40:43], v[48:51]
ds_read_b128 v[36:39], v1 offset:62464
v_mfma_f32_16x16x32_bf16 v[52:55], a[236:239], v[40:43], v[52:55]
v_mfma_f32_16x16x32_bf16 v[56:59], a[108:111], v[44:47], v[56:59]
ds_read_b128 v[40:43], v1 offset:63488
v_mfma_f32_16x16x32_bf16 v[60:63], a[236:239], v[44:47], v[60:63]
s_waitcnt lgkmcnt(5)
v_mfma_f32_16x16x32_bf16 v[48:51], a[112:115], v[16:19], v[48:51]
ds_read_b128 v[44:47], v1 offset:64512
v_mfma_f32_16x16x32_bf16 v[52:55], a[240:243], v[16:19], v[52:55]
v_mfma_f32_16x16x32_bf16 v[56:59], a[112:115], v[20:23], v[56:59]
v_mfma_f32_16x16x32_bf16 v[60:63], a[240:243], v[20:23], v[60:63]
s_waitcnt lgkmcnt(4)
v_mfma_f32_16x16x32_bf16 v[48:51], a[116:119], v[24:27], v[48:51]
v_mfma_f32_16x16x32_bf16 v[52:55], a[244:247], v[24:27], v[52:55]
v_mfma_f32_16x16x32_bf16 v[56:59], a[116:119], v[28:31], v[56:59]
v_mfma_f32_16x16x32_bf16 v[60:63], a[244:247], v[28:31], v[60:63]
s_waitcnt lgkmcnt(2)
v_mfma_f32_16x16x32_bf16 v[48:51], a[120:123], v[32:35], v[48:51]
v_mfma_f32_16x16x32_bf16 v[52:55], a[248:251], v[32:35], v[52:55]
v_mfma_f32_16x16x32_bf16 v[56:59], a[120:123], v[36:39], v[56:59]
v_mfma_f32_16x16x32_bf16 v[60:63], a[248:251], v[36:39], v[60:63]
s_waitcnt lgkmcnt(0)
v_mfma_f32_16x16x32_bf16 v[48:51], a[124:127], v[40:43], v[48:51]
v_mfma_f32_16x16x32_bf16 v[52:55], a[252:255], v[40:43], v[52:55]
v_mfma_f32_16x16x32_bf16 v[56:59], a[124:127], v[44:47], v[56:59]
v_mfma_f32_16x16x32_bf16 v[60:63], a[252:255], v[44:47], v[60:63]
v_xor_b32 v1, 0x10000, v1
s_add_u32 s49, s49, 65536
s_add_u32 s36, s36, 1
s_nop 4
v_cvt_pk_bf16_f32 v80, v48, v49
v_cvt_pk_bf16_f32 v81, v50, v51
v_cvt_pk_bf16_f32 v82, v52, v53
v_cvt_pk_bf16_f32 v83, v54, v55
buffer_store_dwordx4 v[80:83], v6, s[4:7], s49 offen offset:0 sc1
v_cvt_pk_bf16_f32 v84, v56, v57
v_cvt_pk_bf16_f32 v85, v58, v59
v_cvt_pk_bf16_f32 v86, v60, v61
v_cvt_pk_bf16_f32 v87, v62, v63
buffer_store_dwordx4 v[84:87], v6, s[4:7], s49 offen offset:1024 sc1
s_mov_b32 s63, s36
v_mov_b32 v5, s36
s_waitcnt vmcnt(0)
s_barrier
s_and_b32 s38, s36, 1
s_lshl_b32 s38, s38, 12
buffer_store_dword v5, v4, s[4:7], s38 offen sc1
s_cmp_lg_u32 s46, 0
s_cbranch_scc1 Lse_580
s_cmp_lt_u32 s36, 64
s_cbranch_scc1 Lsw_579
s_endpgm
Lhi_4:
s_cmp_ge_u32 s34, 16
s_cbranch_scc1 Lhelper_5
v_mov_b32 v9, v1
s_sub_u32 s44, s33, 4
s_lshl_b32 s44, s44, 4
s_add_u32 s44, s44, s34
s_lshl_b32 s38, s44, 7
s_add_u32 s38, s38, 3407872
v_min_u32 v80, 1, v0
v_lshl_add_u32 v4, v80, 30, s38
v_mov_b32 v5, 0
buffer_store_dword v5, v4, s[4:7], 0 offen sc1
s_mov_b32 s52, 1
s_waitcnt vmcnt(0)
s_barrier
s_cmp_lg_u32 s32, 0
s_cbranch_scc1 Lar_586
s_mov_b64 exec, 1
v_mov_b32 v48, 32
v_mov_b32 v49, s52
buffer_atomic_add v49, v48, s[12:15], 0 offen sc1
s_mov_b64 exec, -1
Lar_586:
s_mov_b32 s8, s18
s_and_b32 s9, s19, 0xffff
s_mov_b32 s10, 0x800000
s_mov_b32 s11, 0x20000
s_mov_b32 s84, s20
s_and_b32 s85, s21, 0xffff
s_mov_b32 s86, 0x800000
s_mov_b32 s87, 0x20000
s_mov_b32 s88, s22
s_and_b32 s89, s23, 0xffff
s_mov_b32 s90, 0x800000
s_mov_b32 s91, 0x20000
s_lshl_b32 s60, s44, 7
s_lshr_b32 s52, s32, 1
s_lshl_b32 s52, s52, 14
s_and_b32 s53, s32, 1
s_lshl_b32 s53, s53, 6
s_add_u32 s52, s52, s53
v_bfe_u32 v84, v9, 2, 2
v_lshrrev_b32 v85, 4, v9
v_lshl_add_u32 v84, v85, 3, v84
v_lshl_add_u32 v84, v84, 7, s52
v_and_b32 v85, 3, v9
v_lshl_add_u32 v84, v85, 3, v84
v_add_u32 v80, 0, v84
v_bfe_u32 v84, v9, 2, 2
v_lshrrev_b32 v85, 4, v9
v_lshl_add_u32 v84, v85, 3, v84
v_lshl_add_u32 v84, v84, 7, s52
v_and_b32 v85, 3, v9
v_lshl_add_u32 v84, v85, 3, v84
v_add_u32 v81, 32, v84
s_lshl_b32 s52, s32, 5
v_bfe_u32 v84, v9, 2, 2
v_lshrrev_b32 v85, 4, v9
v_lshl_add_u32 v84, v85, 3, v84
v_lshl_add_u32 v84, v84, 7, s52
v_and_b32 v85, 3, v9
v_lshl_add_u32 v84, v85, 3, v84
v_add_u32 v82, 32768, v84
v_lshrrev_b32 v84, 3, v9
s_lshl_b32 s38, s32, 5
v_add_u32 v84, s38, v84
v_mul_u32_u24 v84, 8192, v84
v_and_b32 v85, 7, v9
v_lshl_add_u32 v84, v85, 4, v84
s_lshl_b32 s38, s32, 12
s_barrier
s_add_u32 m0, s38, 0
s_add_u32 s39, s60, 0
buffer_load_dwordx4 v84, s[8:11], s39 offen lds
s_add_u32 m0, s38, 1024
s_add_u32 s39, s60, 65536
buffer_load_dwordx4 v84, s[8:11], s39 offen lds
s_add_u32 m0, s38, 2048
s_add_u32 s39, s60, 131072
buffer_load_dwordx4 v84, s[8:11], s39 offen lds
s_add_u32 m0, s38, 3072
s_add_u32 s39, s60, 196608
buffer_load_dwordx4 v84, s[8:11], s39 offen lds
s_add_u32 m0, s38, 16384
s_add_u32 s39, s60, 0
buffer_load_dwordx4 v84, s[84:87], s39 offen lds
s_add_u32 m0, s38, 17408
s_add_u32 s39, s60, 65536
buffer_load_dwordx4 v84, s[84:87], s39 offen lds
s_add_u32 m0, s38, 18432
s_add_u32 s39, s60, 131072
buffer_load_dwordx4 v84, s[84:87], s39 offen lds
s_add_u32 m0, s38, 19456
s_add_u32 s39, s60, 196608
buffer_load_dwordx4 v84, s[84:87], s39 offen lds
s_add_u32 m0, s38, 32768
s_add_u32 s39, s60, 0
buffer_load_dwordx4 v84, s[88:91], s39 offen lds
s_add_u32 m0, s38, 33792
s_add_u32 s39, s60, 65536
buffer_load_dwordx4 v84, s[88:91], s39 offen lds
s_add_u32 m0, s38, 34816
s_add_u32 s39, s60, 131072
buffer_load_dwordx4 v84, s[88:91], s39 offen lds
s_add_u32 m0, s38, 35840
s_add_u32 s39, s60, 196608
buffer_load_dwordx4 v84, s[88:91], s39 offen lds
s_add_u32 m0, s38, 49152
s_add_u32 s39, s60, 1048576
buffer_load_dwordx4 v84, s[8:11], s39 offen lds
s_add_u32 m0, s38, 50176
s_add_u32 s39, s60, 1114112
buffer_load_dwordx4 v84, s[8:11], s39 offen lds
s_add_u32 m0, s38, 51200
s_add_u32 s39, s60, 1179648
buffer_load_dwordx4 v84, s[8:11], s39 offen lds
s_add_u32 m0, s38, 52224
s_add_u32 s39, s60, 1245184
buffer_load_dwordx4 v84, s[8:11], s39 offen lds
s_add_u32 m0, s38, 65536
s_add_u32 s39, s60, 1048576
buffer_load_dwordx4 v84, s[84:87], s39 offen lds
s_add_u32 m0, s38, 66560
s_add_u32 s39, s60, 1114112
buffer_load_dwordx4 v84, s[84:87], s39 offen lds
s_add_u32 m0, s38, 67584
s_add_u32 s39, s60, 1179648
buffer_load_dwordx4 v84, s[84:87], s39 offen lds
s_add_u32 m0, s38, 68608
s_add_u32 s39, s60, 1245184
buffer_load_dwordx4 v84, s[84:87], s39 offen lds
s_add_u32 m0, s38, 81920
s_add_u32 s39, s60, 1048576
buffer_load_dwordx4 v84, s[88:91], s39 offen lds
s_add_u32 m0, s38, 82944
s_add_u32 s39, s60, 1114112
buffer_load_dwordx4 v84, s[88:91], s39 offen lds
s_add_u32 m0, s38, 83968
s_add_u32 s39, s60, 1179648
buffer_load_dwordx4 v84, s[88:91], s39 offen lds
s_add_u32 m0, s38, 84992
s_add_u32 s39, s60, 1245184
buffer_load_dwordx4 v84, s[88:91], s39 offen lds
s_add_u32 m0, s38, 98304
s_add_u32 s39, s60, 2097152
buffer_load_dwordx4 v84, s[8:11], s39 offen lds
s_add_u32 m0, s38, 99328
s_add_u32 s39, s60, 2162688
buffer_load_dwordx4 v84, s[8:11], s39 offen lds
s_add_u32 m0, s38, 100352
s_add_u32 s39, s60, 2228224
buffer_load_dwordx4 v84, s[8:11], s39 offen lds
s_add_u32 m0, s38, 101376
s_add_u32 s39, s60, 2293760
buffer_load_dwordx4 v84, s[8:11], s39 offen lds
s_add_u32 m0, s38, 114688
s_add_u32 s39, s60, 2097152
buffer_load_dwordx4 v84, s[84:87], s39 offen lds
s_add_u32 m0, s38, 115712
s_add_u32 s39, s60, 2162688
buffer_load_dwordx4 v84, s[84:87], s39 offen lds
s_add_u32 m0, s38, 116736
s_add_u32 s39, s60, 2228224
buffer_load_dwordx4 v84, s[84:87], s39 offen lds
s_add_u32 m0, s38, 117760
s_add_u32 s39, s60, 2293760
buffer_load_dwordx4 v84, s[84:87], s39 offen lds
s_add_u32 m0, s38, 131072
s_add_u32 s39, s60, 2097152
buffer_load_dwordx4 v84, s[88:91], s39 offen lds
s_add_u32 m0, s38, 132096
s_add_u32 s39, s60, 2162688
buffer_load_dwordx4 v84, s[88:91], s39 offen lds
s_add_u32 m0, s38, 133120
s_add_u32 s39, s60, 2228224
buffer_load_dwordx4 v84, s[88:91], s39 offen lds
s_add_u32 m0, s38, 134144
s_add_u32 s39, s60, 2293760
buffer_load_dwordx4 v84, s[88:91], s39 offen lds
s_waitcnt vmcnt(24)
s_barrier
ds_read_b64_tr_b16 a[0:1], v80 offset:0
ds_read_b64_tr_b16 a[2:3], v80 offset:512
ds_read_b64_tr_b16 a[4:5], v80 offset:4096
ds_read_b64_tr_b16 a[6:7], v80 offset:4608
ds_read_b64_tr_b16 a[8:9], v80 offset:8192
ds_read_b64_tr_b16 a[10:11], v80 offset:8704
ds_read_b64_tr_b16 a[12:13], v80 offset:12288
ds_read_b64_tr_b16 a[14:15], v80 offset:12800
ds_read_b64_tr_b16 a[128:129], v81 offset:0
ds_read_b64_tr_b16 a[130:131], v81 offset:512
ds_read_b64_tr_b16 a[132:133], v81 offset:4096
ds_read_b64_tr_b16 a[134:135], v81 offset:4608
ds_read_b64_tr_b16 a[136:137], v81 offset:8192
ds_read_b64_tr_b16 a[138:139], v81 offset:8704
ds_read_b64_tr_b16 a[140:141], v81 offset:12288
ds_read_b64_tr_b16 a[142:143], v81 offset:12800
ds_read_b64_tr_b16 v[128:129], v82 offset:0
ds_read_b64_tr_b16 v[130:131], v82 offset:512
ds_read_b64_tr_b16 v[132:133], v82 offset:4096
ds_read_b64_tr_b16 v[134:135], v82 offset:4608
ds_read_b64_tr_b16 v[136:137], v82 offset:8192
ds_read_b64_tr_b16 v[138:139], v82 offset:8704
ds_read_b64_tr_b16 v[140:141], v82 offset:12288
ds_read_b64_tr_b16 v[142:143], v82 offset:12800
v_add_u32 v80, 49152, v80
v_add_u32 v81, 49152, v81
v_add_u32 v82, 49152, v82
s_waitcnt lgkmcnt(0)
s_barrier
s_add_u32 m0, s38, 0
s_add_u32 s39, s60, 3145728
buffer_load_dwordx4 v84, s[8:11], s39 offen lds
s_add_u32 m0, s38, 1024
s_add_u32 s39, s60, 3211264
buffer_load_dwordx4 v84, s[8:11], s39 offen lds
s_add_u32 m0, s38, 2048
s_add_u32 s39, s60, 3276800
buffer_load_dwordx4 v84, s[8:11], s39 offen lds
s_add_u32 m0, s38, 3072
s_add_u32 s39, s60, 3342336
buffer_load_dwordx4 v84, s[8:11], s39 offen lds
s_add_u32 m0, s38, 16384
s_add_u32 s39, s60, 3145728
buffer_load_dwordx4 v84, s[84:87], s39 offen lds
s_add_u32 m0, s38, 17408
s_add_u32 s39, s60, 3211264
buffer_load_dwordx4 v84, s[84:87], s39 offen lds
s_add_u32 m0, s38, 18432
s_add_u32 s39, s60, 3276800
buffer_load_dwordx4 v84, s[84:87], s39 offen lds
s_add_u32 m0, s38, 19456
s_add_u32 s39, s60, 3342336
buffer_load_dwordx4 v84, s[84:87], s39 offen lds
s_add_u32 m0, s38, 32768
s_add_u32 s39, s60, 3145728
buffer_load_dwordx4 v84, s[88:91], s39 offen lds
s_add_u32 m0, s38, 33792
s_add_u32 s39, s60, 3211264
buffer_load_dwordx4 v84, s[88:91], s39 offen lds
s_add_u32 m0, s38, 34816
s_add_u32 s39, s60, 3276800
buffer_load_dwordx4 v84, s[88:91], s39 offen lds
s_add_u32 m0, s38, 35840
s_add_u32 s39, s60, 3342336
buffer_load_dwordx4 v84, s[88:91], s39 offen lds
s_waitcnt vmcnt(24)
s_barrier
ds_read_b64_tr_b16 a[16:17], v80 offset:0
ds_read_b64_tr_b16 a[18:19], v80 offset:512
ds_read_b64_tr_b16 a[20:21], v80 offset:4096
ds_read_b64_tr_b16 a[22:23], v80 offset:4608
ds_read_b64_tr_b16 a[24:25], v80 offset:8192
ds_read_b64_tr_b16 a[26:27], v80 offset:8704
ds_read_b64_tr_b16 a[28:29], v80 offset:12288
ds_read_b64_tr_b16 a[30:31], v80 offset:12800
ds_read_b64_tr_b16 a[144:145], v81 offset:0
ds_read_b64_tr_b16 a[146:147], v81 offset:512
ds_read_b64_tr_b16 a[148:149], v81 offset:4096
ds_read_b64_tr_b16 a[150:151], v81 offset:4608
ds_read_b64_tr_b16 a[152:153], v81 offset:8192
ds_read_b64_tr_b16 a[154:155], v81 offset:8704
ds_read_b64_tr_b16 a[156:157], v81 offset:12288
ds_read_b64_tr_b16 a[158:159], v81 offset:12800
ds_read_b64_tr_b16 v[144:145], v82 offset:0
ds_read_b64_tr_b16 v[146:147], v82 offset:512
ds_read_b64_tr_b16 v[148:149], v82 offset:4096
ds_read_b64_tr_b16 v[150:151], v82 offset:4608
ds_read_b64_tr_b16 v[152:153], v82 offset:8192
ds_read_b64_tr_b16 v[154:155], v82 offset:8704
ds_read_b64_tr_b16 v[156:157], v82 offset:12288
ds_read_b64_tr_b16 v[158:159], v82 offset:12800
v_add_u32 v80, 49152, v80
v_add_u32 v81, 49152, v81
v_add_u32 v82, 49152, v82
s_waitcnt lgkmcnt(0)
s_barrier
s_add_u32 m0, s38, 49152
s_add_u32 s39, s60, 4194304
buffer_load_dwordx4 v84, s[8:11], s39 offen lds
s_add_u32 m0, s38, 50176
s_add_u32 s39, s60, 4259840
buffer_load_dwordx4 v84, s[8:11], s39 offen lds
s_add_u32 m0, s38, 51200
s_add_u32 s39, s60, 4325376
buffer_load_dwordx4 v84, s[8:11], s39 offen lds
s_add_u32 m0, s38, 52224
s_add_u32 s39, s60, 4390912
buffer_load_dwordx4 v84, s[8:11], s39 offen lds
s_add_u32 m0, s38, 65536
s_add_u32 s39, s60, 4194304
buffer_load_dwordx4 v84, s[84:87], s39 offen lds
s_add_u32 m0, s38, 66560
s_add_u32 s39, s60, 4259840
buffer_load_dwordx4 v84, s[84:87], s39 offen lds
s_add_u32 m0, s38, 67584
s_add_u32 s39, s60, 4325376
buffer_load_dwordx4 v84, s[84:87], s39 offen lds
s_add_u32 m0, s38, 68608
s_add_u32 s39, s60, 4390912
buffer_load_dwordx4 v84, s[84:87], s39 offen lds
s_add_u32 m0, s38, 81920
s_add_u32 s39, s60, 4194304
buffer_load_dwordx4 v84, s[88:91], s39 offen lds
s_add_u32 m0, s38, 82944
s_add_u32 s39, s60, 4259840
buffer_load_dwordx4 v84, s[88:91], s39 offen lds
s_add_u32 m0, s38, 83968
s_add_u32 s39, s60, 4325376
buffer_load_dwordx4 v84, s[88:91], s39 offen lds
s_add_u32 m0, s38, 84992
s_add_u32 s39, s60, 4390912
buffer_load_dwordx4 v84, s[88:91], s39 offen lds
s_waitcnt vmcnt(24)
s_barrier
ds_read_b64_tr_b16 a[32:33], v80 offset:0
ds_read_b64_tr_b16 a[34:35], v80 offset:512
ds_read_b64_tr_b16 a[36:37], v80 offset:4096
ds_read_b64_tr_b16 a[38:39], v80 offset:4608
ds_read_b64_tr_b16 a[40:41], v80 offset:8192
ds_read_b64_tr_b16 a[42:43], v80 offset:8704
ds_read_b64_tr_b16 a[44:45], v80 offset:12288
ds_read_b64_tr_b16 a[46:47], v80 offset:12800
ds_read_b64_tr_b16 a[160:161], v81 offset:0
ds_read_b64_tr_b16 a[162:163], v81 offset:512
ds_read_b64_tr_b16 a[164:165], v81 offset:4096
ds_read_b64_tr_b16 a[166:167], v81 offset:4608
ds_read_b64_tr_b16 a[168:169], v81 offset:8192
ds_read_b64_tr_b16 a[170:171], v81 offset:8704
ds_read_b64_tr_b16 a[172:173], v81 offset:12288
ds_read_b64_tr_b16 a[174:175], v81 offset:12800
ds_read_b64_tr_b16 v[160:161], v82 offset:0
ds_read_b64_tr_b16 v[162:163], v82 offset:512
ds_read_b64_tr_b16 v[164:165], v82 offset:4096
ds_read_b64_tr_b16 v[166:167], v82 offset:4608
ds_read_b64_tr_b16 v[168:169], v82 offset:8192
ds_read_b64_tr_b16 v[170:171], v82 offset:8704
ds_read_b64_tr_b16 v[172:173], v82 offset:12288
ds_read_b64_tr_b16 v[174:175], v82 offset:12800
v_add_u32 v80, -98304, v80
v_add_u32 v81, -98304, v81
v_add_u32 v82, -98304, v82
s_waitcnt lgkmcnt(0)
s_barrier
s_add_u32 m0, s38, 98304
s_add_u32 s39, s60, 5242880
buffer_load_dwordx4 v84, s[8:11], s39 offen lds
s_add_u32 m0, s38, 99328
s_add_u32 s39, s60, 5308416
buffer_load_dwordx4 v84, s[8:11], s39 offen lds
s_add_u32 m0, s38, 100352
s_add_u32 s39, s60, 5373952
buffer_load_dwordx4 v84, s[8:11], s39 offen lds
s_add_u32 m0, s38, 101376
s_add_u32 s39, s60, 5439488
buffer_load_dwordx4 v84, s[8:11], s39 offen lds
s_add_u32 m0, s38, 114688
s_add_u32 s39, s60, 5242880
buffer_load_dwordx4 v84, s[84:87], s39 offen lds
s_add_u32 m0, s38, 115712
s_add_u32 s39, s60, 5308416
buffer_load_dwordx4 v84, s[84:87], s39 offen lds
s_add_u32 m0, s38, 116736
s_add_u32 s39, s60, 5373952
buffer_load_dwordx4 v84, s[84:87], s39 offen lds
s_add_u32 m0, s38, 117760
s_add_u32 s39, s60, 5439488
buffer_load_dwordx4 v84, s[84:87], s39 offen lds
s_add_u32 m0, s38, 131072
s_add_u32 s39, s60, 5242880
buffer_load_dwordx4 v84, s[88:91], s39 offen lds
s_add_u32 m0, s38, 132096
s_add_u32 s39, s60, 5308416
buffer_load_dwordx4 v84, s[88:91], s39 offen lds
s_add_u32 m0, s38, 133120
s_add_u32 s39, s60, 5373952
buffer_load_dwordx4 v84, s[88:91], s39 offen lds
s_add_u32 m0, s38, 134144
s_add_u32 s39, s60, 5439488
buffer_load_dwordx4 v84, s[88:91], s39 offen lds
s_waitcnt vmcnt(24)
s_barrier
ds_read_b64_tr_b16 a[48:49], v80 offset:0
ds_read_b64_tr_b16 a[50:51], v80 offset:512
ds_read_b64_tr_b16 a[52:53], v80 offset:4096
ds_read_b64_tr_b16 a[54:55], v80 offset:4608
ds_read_b64_tr_b16 a[56:57], v80 offset:8192
ds_read_b64_tr_b16 a[58:59], v80 offset:8704
ds_read_b64_tr_b16 a[60:61], v80 offset:12288
ds_read_b64_tr_b16 a[62:63], v80 offset:12800
ds_read_b64_tr_b16 a[176:177], v81 offset:0
ds_read_b64_tr_b16 a[178:179], v81 offset:512
ds_read_b64_tr_b16 a[180:181], v81 offset:4096
ds_read_b64_tr_b16 a[182:183], v81 offset:4608
ds_read_b64_tr_b16 a[184:185], v81 offset:8192
ds_read_b64_tr_b16 a[186:187], v81 offset:8704
ds_read_b64_tr_b16 a[188:189], v81 offset:12288
ds_read_b64_tr_b16 a[190:191], v81 offset:12800
ds_read_b64_tr_b16 v[176:177], v82 offset:0
ds_read_b64_tr_b16 v[178:179], v82 offset:512
ds_read_b64_tr_b16 v[180:181], v82 offset:4096
ds_read_b64_tr_b16 v[182:183], v82 offset:4608
ds_read_b64_tr_b16 v[184:185], v82 offset:8192
ds_read_b64_tr_b16 v[186:187], v82 offset:8704
ds_read_b64_tr_b16 v[188:189], v82 offset:12288
ds_read_b64_tr_b16 v[190:191], v82 offset:12800
v_add_u32 v80, 49152, v80
v_add_u32 v81, 49152, v81
v_add_u32 v82, 49152, v82
s_waitcnt lgkmcnt(0)
s_barrier
s_add_u32 m0, s38, 0
s_add_u32 s39, s60, 6291456
buffer_load_dwordx4 v84, s[8:11], s39 offen lds
s_add_u32 m0, s38, 1024
s_add_u32 s39, s60, 6356992
buffer_load_dwordx4 v84, s[8:11], s39 offen lds
s_add_u32 m0, s38, 2048
s_add_u32 s39, s60, 6422528
buffer_load_dwordx4 v84, s[8:11], s39 offen lds
s_add_u32 m0, s38, 3072
s_add_u32 s39, s60, 6488064
buffer_load_dwordx4 v84, s[8:11], s39 offen lds
s_add_u32 m0, s38, 16384
s_add_u32 s39, s60, 6291456
buffer_load_dwordx4 v84, s[84:87], s39 offen lds
s_add_u32 m0, s38, 17408
s_add_u32 s39, s60, 6356992
buffer_load_dwordx4 v84, s[84:87], s39 offen lds
s_add_u32 m0, s38, 18432
s_add_u32 s39, s60, 6422528
buffer_load_dwordx4 v84, s[84:87], s39 offen lds
s_add_u32 m0, s38, 19456
s_add_u32 s39, s60, 6488064
buffer_load_dwordx4 v84, s[84:87], s39 offen lds
s_add_u32 m0, s38, 32768
s_add_u32 s39, s60, 6291456
buffer_load_dwordx4 v84, s[88:91], s39 offen lds
s_add_u32 m0, s38, 33792
s_add_u32 s39, s60, 6356992
buffer_load_dwordx4 v84, s[88:91], s39 offen lds
s_add_u32 m0, s38, 34816
s_add_u32 s39, s60, 6422528
buffer_load_dwordx4 v84, s[88:91], s39 offen lds
s_add_u32 m0, s38, 35840
s_add_u32 s39, s60, 6488064
buffer_load_dwordx4 v84, s[88:91], s39 offen lds
s_waitcnt vmcnt(24)
s_barrier
ds_read_b64_tr_b16 a[64:65], v80 offset:0
ds_read_b64_tr_b16 a[66:67], v80 offset:512
ds_read_b64_tr_b16 a[68:69], v80 offset:4096
ds_read_b64_tr_b16 a[70:71], v80 offset:4608
ds_read_b64_tr_b16 a[72:73], v80 offset:8192
ds_read_b64_tr_b16 a[74:75], v80 offset:8704
ds_read_b64_tr_b16 a[76:77], v80 offset:12288
ds_read_b64_tr_b16 a[78:79], v80 offset:12800
ds_read_b64_tr_b16 a[192:193], v81 offset:0
ds_read_b64_tr_b16 a[194:195], v81 offset:512
ds_read_b64_tr_b16 a[196:197], v81 offset:4096
ds_read_b64_tr_b16 a[198:199], v81 offset:4608
ds_read_b64_tr_b16 a[200:201], v81 offset:8192
ds_read_b64_tr_b16 a[202:203], v81 offset:8704
ds_read_b64_tr_b16 a[204:205], v81 offset:12288
ds_read_b64_tr_b16 a[206:207], v81 offset:12800
ds_read_b64_tr_b16 v[192:193], v82 offset:0
ds_read_b64_tr_b16 v[194:195], v82 offset:512
ds_read_b64_tr_b16 v[196:197], v82 offset:4096
ds_read_b64_tr_b16 v[198:199], v82 offset:4608
ds_read_b64_tr_b16 v[200:201], v82 offset:8192
ds_read_b64_tr_b16 v[202:203], v82 offset:8704
ds_read_b64_tr_b16 v[204:205], v82 offset:12288
ds_read_b64_tr_b16 v[206:207], v82 offset:12800
v_add_u32 v80, 49152, v80
v_add_u32 v81, 49152, v81
v_add_u32 v82, 49152, v82
s_waitcnt lgkmcnt(0)
s_barrier
s_add_u32 m0, s38, 49152
s_add_u32 s39, s60, 7340032
buffer_load_dwordx4 v84, s[8:11], s39 offen lds
s_add_u32 m0, s38, 50176
s_add_u32 s39, s60, 7405568
buffer_load_dwordx4 v84, s[8:11], s39 offen lds
s_add_u32 m0, s38, 51200
s_add_u32 s39, s60, 7471104
buffer_load_dwordx4 v84, s[8:11], s39 offen lds
s_add_u32 m0, s38, 52224
s_add_u32 s39, s60, 7536640
buffer_load_dwordx4 v84, s[8:11], s39 offen lds
s_add_u32 m0, s38, 65536
s_add_u32 s39, s60, 7340032
buffer_load_dwordx4 v84, s[84:87], s39 offen lds
s_add_u32 m0, s38, 66560
s_add_u32 s39, s60, 7405568
buffer_load_dwordx4 v84, s[84:87], s39 offen lds
s_add_u32 m0, s38, 67584
s_add_u32 s39, s60, 7471104
buffer_load_dwordx4 v84, s[84:87], s39 offen lds
s_add_u32 m0, s38, 68608
s_add_u32 s39, s60, 7536640
buffer_load_dwordx4 v84, s[84:87], s39 offen lds
s_add_u32 m0, s38, 81920
s_add_u32 s39, s60, 7340032
buffer_load_dwordx4 v84, s[88:91], s39 offen lds
s_add_u32 m0, s38, 82944
s_add_u32 s39, s60, 7405568
buffer_load_dwordx4 v84, s[88:91], s39 offen lds
s_add_u32 m0, s38, 83968
s_add_u32 s39, s60, 7471104
buffer_load_dwordx4 v84, s[88:91], s39 offen lds
s_add_u32 m0, s38, 84992
s_add_u32 s39, s60, 7536640
buffer_load_dwordx4 v84, s[88:91], s39 offen lds
s_waitcnt vmcnt(24)
s_barrier
ds_read_b64_tr_b16 a[80:81], v80 offset:0
ds_read_b64_tr_b16 a[82:83], v80 offset:512
ds_read_b64_tr_b16 a[84:85], v80 offset:4096
ds_read_b64_tr_b16 a[86:87], v80 offset:4608
ds_read_b64_tr_b16 a[88:89], v80 offset:8192
ds_read_b64_tr_b16 a[90:91], v80 offset:8704
ds_read_b64_tr_b16 a[92:93], v80 offset:12288
ds_read_b64_tr_b16 a[94:95], v80 offset:12800
ds_read_b64_tr_b16 a[208:209], v81 offset:0
ds_read_b64_tr_b16 a[210:211], v81 offset:512
ds_read_b64_tr_b16 a[212:213], v81 offset:4096
ds_read_b64_tr_b16 a[214:215], v81 offset:4608
ds_read_b64_tr_b16 a[216:217], v81 offset:8192
ds_read_b64_tr_b16 a[218:219], v81 offset:8704
ds_read_b64_tr_b16 a[220:221], v81 offset:12288
ds_read_b64_tr_b16 a[222:223], v81 offset:12800
ds_read_b64_tr_b16 v[208:209], v82 offset:0
ds_read_b64_tr_b16 v[210:211], v82 offset:512
ds_read_b64_tr_b16 v[212:213], v82 offset:4096
ds_read_b64_tr_b16 v[214:215], v82 offset:4608
ds_read_b64_tr_b16 v[216:217], v82 offset:8192
ds_read_b64_tr_b16 v[218:219], v82 offset:8704
ds_read_b64_tr_b16 v[220:221], v82 offset:12288
ds_read_b64_tr_b16 v[222:223], v82 offset:12800
v_add_u32 v80, -98304, v80
v_add_u32 v81, -98304, v81
v_add_u32 v82, -98304, v82
s_waitcnt lgkmcnt(0)
s_barrier
s_waitcnt vmcnt(12)
s_barrier
ds_read_b64_tr_b16 a[96:97], v80 offset:0
ds_read_b64_tr_b16 a[98:99], v80 offset:512
ds_read_b64_tr_b16 a[100:101], v80 offset:4096
ds_read_b64_tr_b16 a[102:103], v80 offset:4608
ds_read_b64_tr_b16 a[104:105], v80 offset:8192
ds_read_b64_tr_b16 a[106:107], v80 offset:8704
ds_read_b64_tr_b16 a[108:109], v80 offset:12288
ds_read_b64_tr_b16 a[110:111], v80 offset:12800
ds_read_b64_tr_b16 a[224:225], v81 offset:0
ds_read_b64_tr_b16 a[226:227], v81 offset:512
ds_read_b64_tr_b16 a[228:229], v81 offset:4096
ds_read_b64_tr_b16 a[230:231], v81 offset:4608
ds_read_b64_tr_b16 a[232:233], v81 offset:8192
ds_read_b64_tr_b16 a[234:235], v81 offset:8704
ds_read_b64_tr_b16 a[236:237], v81 offset:12288
ds_read_b64_tr_b16 a[238:239], v81 offset:12800
ds_read_b64_tr_b16 v[224:225], v82 offset:0
ds_read_b64_tr_b16 v[226:227], v82 offset:512
ds_read_b64_tr_b16 v[228:229], v82 offset:4096
ds_read_b64_tr_b16 v[230:231], v82 offset:4608
ds_read_b64_tr_b16 v[232:233], v82 offset:8192
ds_read_b64_tr_b16 v[234:235], v82 offset:8704
ds_read_b64_tr_b16 v[236:237], v82 offset:12288
ds_read_b64_tr_b16 v[238:239], v82 offset:12800
v_add_u32 v80, 49152, v80
v_add_u32 v81, 49152, v81
v_add_u32 v82, 49152, v82
s_waitcnt lgkmcnt(0)
s_barrier
s_waitcnt vmcnt(0)
s_barrier
ds_read_b64_tr_b16 a[112:113], v80 offset:0
ds_read_b64_tr_b16 a[114:115], v80 offset:512
ds_read_b64_tr_b16 a[116:117], v80 offset:4096
ds_read_b64_tr_b16 a[118:119], v80 offset:4608
ds_read_b64_tr_b16 a[120:121], v80 offset:8192
ds_read_b64_tr_b16 a[122:123], v80 offset:8704
ds_read_b64_tr_b16 a[124:125], v80 offset:12288
ds_read_b64_tr_b16 a[126:127], v80 offset:12800
ds_read_b64_tr_b16 a[240:241], v81 offset:0
ds_read_b64_tr_b16 a[242:243], v81 offset:512
ds_read_b64_tr_b16 a[244:245], v81 offset:4096
ds_read_b64_tr_b16 a[246:247], v81 offset:4608
ds_read_b64_tr_b16 a[248:249], v81 offset:8192
ds_read_b64_tr_b16 a[250:251], v81 offset:8704
ds_read_b64_tr_b16 a[252:253], v81 offset:12288
ds_read_b64_tr_b16 a[254:255], v81 offset:12800
ds_read_b64_tr_b16 v[240:241], v82 offset:0
ds_read_b64_tr_b16 v[242:243], v82 offset:512
ds_read_b64_tr_b16 v[244:245], v82 offset:4096
ds_read_b64_tr_b16 v[246:247], v82 offset:4608
ds_read_b64_tr_b16 v[248:249], v82 offset:8192
ds_read_b64_tr_b16 v[250:251], v82 offset:8704
ds_read_b64_tr_b16 v[252:253], v82 offset:12288
ds_read_b64_tr_b16 v[254:255], v82 offset:12800
v_add_u32 v80, 49152, v80
v_add_u32 v81, 49152, v81
v_add_u32 v82, 49152, v82
s_waitcnt lgkmcnt(0)
s_barrier
v_mov_b32 v48, 32
Lst_587:
s_sub_u32 s37, s37, 1
s_cbranch_scc1 Lend_7
s_sleep 4
buffer_load_dword v49, v48, s[12:15], 0 offen sc1
s_waitcnt vmcnt(0)
v_readfirstlane_b32 s38, v49
s_nop 3
s_and_b32 s39, s38, 0xffff
s_cmp_lg_u32 s39, 256
s_cbranch_scc1 Lst_587
s_bfe_u32 s35, s38, 0x80010
s_bfe_u32 s46, s38, 0x10018
s_lshl_b32 s46, s46, 13
s_barrier
s_mul_i32 s50, s32, 16384
v_lshlrev_b32 v1, 4, v9
v_add_u32 v0, s50, v1
v_min_u32 v2, 1, v9
v_lshlrev_b32 v2, 7, v2
s_and_b32 s52, s44, 1
s_lshr_b32 s38, s32, 1
s_lshl_b32 s38, s38, 3
s_and_b32 s39, s32, 1
s_add_u32 s38, s38, s39
s_lshl_b32 s39, s52, 1
s_add_u32 s38, s38, s39
s_lshl_b32 s38, s38, 10
v_add_u32 v6, s38, v1
v_add_u32 v7, 4096, v6
s_lshl_b32 s38, s52, 2
s_add_u32 s38, s38, s32
s_add_u32 s38, s38, 16
s_lshl_b32 s38, s38, 10
v_add_u32 v8, s38, v1
s_lshr_b32 s49, s44, 1
s_mul_i32 s49, s49, 24576
s_add_u32 s49, s49, 32768000
s_mov_b32 s54, 8388608
s_mov_b32 s36, 0
s_mov_b32 s63, 0
Lsw_590:
s_add_u32 s48, s36, 0
s_and_b32 s47, s48, 31
s_lshl_b32 s47, s47, 8
s_add_u32 s47, s47, 3424256
s_lshr_b32 s48, s48, 5
s_lshl_b32 s48, 1, s48
s_add_u32 s48, s48, 1
Lbw_593:
buffer_load_dword v3, v2, s[4:7], s47 offen sc1
s_waitcnt vmcnt(0)
v_cmp_gt_u32 vcc, s48, v3
s_cbranch_vccz Lbo_594
s_sub_u32 s37, s37, 1
s_cbranch_scc1 Lend_7
s_sleep 1
s_branch Lbw_593
Lbo_594:
s_add_u32 m0, s50, 0
s_add_u32 s39, s54, 0
buffer_load_dwordx4 v0, s[4:7], s39 offen offset:0 sc1 lds
buffer_load_dwordx4 v0, s[4:7], s39 offen offset:1024 sc1 lds
buffer_load_dwordx4 v0, s[4:7], s39 offen offset:2048 sc1 lds
buffer_load_dwordx4 v0, s[4:7], s39 offen offset:3072 sc1 lds
s_add_u32 m0, s50, 4096
s_add_u32 s39, s54, 4096
buffer_load_dwordx4 v0, s[4:7], s39 offen offset:0 sc1 lds
buffer_load_dwordx4 v0, s[4:7], s39 offen offset:1024 sc1 lds
buffer_load_dwordx4 v0, s[4:7], s39 offen offset:2048 sc1 lds
buffer_load_dwordx4 v0, s[4:7], s39 offen offset:3072 sc1 lds
s_add_u32 m0, s50, 8192
s_add_u32 s39, s54, 8192
buffer_load_dwordx4 v0, s[4:7], s39 offen offset:0 sc1 lds
buffer_load_dwordx4 v0, s[4:7], s39 offen offset:1024 sc1 lds
buffer_load_dwordx4 v0, s[4:7], s39 offen offset:2048 sc1 lds
buffer_load_dwordx4 v0, s[4:7], s39 offen offset:3072 sc1 lds
s_add_u32 m0, s50, 12288
s_add_u32 s39, s54, 12288
buffer_load_dwordx4 v0, s[4:7], s39 offen offset:0 sc1 lds
buffer_load_dwordx4 v0, s[4:7], s39 offen offset:1024 sc1 lds
buffer_load_dwordx4 v0, s[4:7], s39 offen offset:2048 sc1 lds
buffer_load_dwordx4 v0, s[4:7], s39 offen offset:3072 sc1 lds
s_add_u32 s48, s36, 1
s_and_b32 s47, s48, 31
s_lshl_b32 s47, s47, 8
s_add_u32 s47, s47, 3424256
s_lshr_b32 s48, s48, 5
s_lshl_b32 s48, 1, s48
s_add_u32 s48, s48, 1
buffer_load_dword v3, v2, s[4:7], s47 offen sc1
s_waitcnt vmcnt(0)
Lse_591:
s_barrier
ds_read_b128 v[16:19], v1 offset:0
ds_read_b128 v[20:23], v1 offset:1024
ds_read_b128 v[24:27], v1 offset:2048
ds_read_b128 v[28:31], v1 offset:3072
ds_read_b128 v[32:35], v1 offset:4096
ds_read_b128 v[36:39], v1 offset:5120
ds_read_b128 v[40:43], v1 offset:6144
s_cmp_lt_u32 s36, 4
s_cbranch_scc1 Lsb_589
s_sub_u32 s38, s36, 1
s_max_i32 s63, s63, s38
v_mov_b32 v5, s63
buffer_store_dword v5, v4, s[4:7], 0 offen sc1
s_branch Lsb_589
Lst_588:
s_waitcnt vmcnt(0)
s_barrier
ds_read_b128 v[16:19], v1 offset:0
ds_read_b128 v[20:23], v1 offset:1024
ds_read_b128 v[24:27], v1 offset:2048
ds_read_b128 v[28:31], v1 offset:3072
ds_read_b128 v[32:35], v1 offset:4096
ds_read_b128 v[36:39], v1 offset:5120
ds_read_b128 v[40:43], v1 offset:6144
s_sub_u32 s38, s36, 1
s_max_i32 s63, s63, s38
v_mov_b32 v5, s63
buffer_store_dword v5, v4, s[4:7], 0 offen sc1
v_cvt_pk_bf16_f32 v80, v48, v49
v_cvt_pk_bf16_f32 v81, v50, v51
v_cvt_pk_bf16_f32 v82, v52, v53
v_cvt_pk_bf16_f32 v83, v54, v55
buffer_store_dwordx4 v[80:83], v6, s[4:7], s49 offen sc1
v_cvt_pk_bf16_f32 v84, v56, v57
v_cvt_pk_bf16_f32 v85, v58, v59
v_cvt_pk_bf16_f32 v86, v60, v61
v_cvt_pk_bf16_f32 v87, v62, v63
buffer_store_dwordx4 v[84:87], v7, s[4:7], s49 offen sc1
v_cvt_pk_bf16_f32 v88, v64, v65
v_cvt_pk_bf16_f32 v89, v66, v67
v_cvt_pk_bf16_f32 v90, v68, v69
v_cvt_pk_bf16_f32 v91, v70, v71
buffer_store_dwordx4 v[88:91], v8, s[4:7], s49 offen sc1
Lsb_589:
s_add_u32 s54, s54, 65536
s_xor_b32 s50, s50, 0x10000
v_cmp_gt_u32 vcc, s48, v3
s_cmp_eq_u64 vcc, 0
s_cselect_b32 s46, 1, 0
s_cselect_b32 s45, s54, 0x70000000
s_waitcnt lgkmcnt(5)
v_mfma_f32_16x16x32_bf16 v[48:51], a[0:3], v[16:19], 0
ds_read_b128 v[44:47], v1 offset:7168
v_mfma_f32_16x16x32_bf16 v[52:55], a[128:131], v[16:19], 0
v_mfma_f32_16x16x32_bf16 v[64:67], v[16:19], v[128:131], 0
s_add_u32 m0, s50, 0
s_add_u32 s39, s45, 0
v_mfma_f32_16x16x32_bf16 v[56:59], a[0:3], v[20:23], 0
ds_read_b128 v[16:19], v1 offset:8192
v_mfma_f32_16x16x32_bf16 v[60:63], a[128:131], v[20:23], 0
buffer_load_dwordx4 v0, s[4:7], s39 offen offset:0 sc1 lds
v_mfma_f32_16x16x32_bf16 v[68:71], v[20:23], v[128:131], 0
s_waitcnt lgkmcnt(5)
v_mfma_f32_16x16x32_bf16 v[48:51], a[4:7], v[24:27], v[48:51]
ds_read_b128 v[20:23], v1 offset:9216
v_mfma_f32_16x16x32_bf16 v[52:55], a[132:135], v[24:27], v[52:55]
v_mfma_f32_16x16x32_bf16 v[64:67], v[24:27], v[132:135], v[64:67]
v_mfma_f32_16x16x32_bf16 v[56:59], a[4:7], v[28:31], v[56:59]
ds_read_b128 v[24:27], v1 offset:10240
v_mfma_f32_16x16x32_bf16 v[60:63], a[132:135], v[28:31], v[60:63]
buffer_load_dwordx4 v0, s[4:7], s39 offen offset:1024 sc1 lds
v_mfma_f32_16x16x32_bf16 v[68:71], v[28:31], v[132:135], v[68:71]
s_waitcnt lgkmcnt(5)
v_mfma_f32_16x16x32_bf16 v[48:51], a[8:11], v[32:35], v[48:51]
ds_read_b128 v[28:31], v1 offset:11264
v_mfma_f32_16x16x32_bf16 v[52:55], a[136:139], v[32:35], v[52:55]
v_mfma_f32_16x16x32_bf16 v[64:67], v[32:35], v[136:139], v[64:67]
v_mfma_f32_16x16x32_bf16 v[56:59], a[8:11], v[36:39], v[56:59]
ds_read_b128 v[32:35], v1 offset:12288
v_mfma_f32_16x16x32_bf16 v[60:63], a[136:139], v[36:39], v[60:63]
buffer_load_dwordx4 v0, s[4:7], s39 offen offset:2048 sc1 lds
v_mfma_f32_16x16x32_bf16 v[68:71], v[36:39], v[136:139], v[68:71]
s_waitcnt lgkmcnt(5)
v_mfma_f32_16x16x32_bf16 v[48:51], a[12:15], v[40:43], v[48:51]
ds_read_b128 v[36:39], v1 offset:13312
v_mfma_f32_16x16x32_bf16 v[52:55], a[140:143], v[40:43], v[52:55]
v_mfma_f32_16x16x32_bf16 v[64:67], v[40:43], v[140:143], v[64:67]
v_mfma_f32_16x16x32_bf16 v[56:59], a[12:15], v[44:47], v[56:59]
ds_read_b128 v[40:43], v1 offset:14336
v_mfma_f32_16x16x32_bf16 v[60:63], a[140:143], v[44:47], v[60:63]
buffer_load_dwordx4 v0, s[4:7], s39 offen offset:3072 sc1 lds
v_mfma_f32_16x16x32_bf16 v[68:71], v[44:47], v[140:143], v[68:71]
s_waitcnt lgkmcnt(5)
v_mfma_f32_16x16x32_bf16 v[48:51], a[16:19], v[16:19], v[48:51]
ds_read_b128 v[44:47], v1 offset:15360
v_mfma_f32_16x16x32_bf16 v[52:55], a[144:147], v[16:19], v[52:55]
v_mfma_f32_16x16x32_bf16 v[64:67], v[16:19], v[144:147], v[64:67]
v_mfma_f32_16x16x32_bf16 v[56:59], a[16:19], v[20:23], v[56:59]
ds_read_b128 v[16:19], v1 offset:16384
v_mfma_f32_16x16x32_bf16 v[60:63], a[144:147], v[20:23], v[60:63]
s_add_u32 m0, s50, 4096
s_add_u32 s39, s45, 4096
v_mfma_f32_16x16x32_bf16 v[68:71], v[20:23], v[144:147], v[68:71]
s_waitcnt lgkmcnt(5)
v_mfma_f32_16x16x32_bf16 v[48:51], a[20:23], v[24:27], v[48:51]
ds_read_b128 v[20:23], v1 offset:17408
v_mfma_f32_16x16x32_bf16 v[52:55], a[148:151], v[24:27], v[52:55]
buffer_load_dwordx4 v0, s[4:7], s39 offen offset:0 sc1 lds
v_mfma_f32_16x16x32_bf16 v[64:67], v[24:27], v[148:151], v[64:67]
v_mfma_f32_16x16x32_bf16 v[56:59], a[20:23], v[28:31], v[56:59]
ds_read_b128 v[24:27], v1 offset:18432
v_mfma_f32_16x16x32_bf16 v[60:63], a[148:151], v[28:31], v[60:63]
v_mfma_f32_16x16x32_bf16 v[68:71], v[28:31], v[148:151], v[68:71]
s_waitcnt lgkmcnt(5)
v_mfma_f32_16x16x32_bf16 v[48:51], a[24:27], v[32:35], v[48:51]
ds_read_b128 v[28:31], v1 offset:19456
v_mfma_f32_16x16x32_bf16 v[52:55], a[152:155], v[32:35], v[52:55]
buffer_load_dwordx4 v0, s[4:7], s39 offen offset:1024 sc1 lds
v_mfma_f32_16x16x32_bf16 v[64:67], v[32:35], v[152:155], v[64:67]
v_mfma_f32_16x16x32_bf16 v[56:59], a[24:27], v[36:39], v[56:59]
ds_read_b128 v[32:35], v1 offset:20480
v_mfma_f32_16x16x32_bf16 v[60:63], a[152:155], v[36:39], v[60:63]
v_mfma_f32_16x16x32_bf16 v[68:71], v[36:39], v[152:155], v[68:71]
s_waitcnt lgkmcnt(5)
v_mfma_f32_16x16x32_bf16 v[48:51], a[28:31], v[40:43], v[48:51]
ds_read_b128 v[36:39], v1 offset:21504
v_mfma_f32_16x16x32_bf16 v[52:55], a[156:159], v[40:43], v[52:55]
buffer_load_dwordx4 v0, s[4:7], s39 offen offset:2048 sc1 lds
v_mfma_f32_16x16x32_bf16 v[64:67], v[40:43], v[156:159], v[64:67]
v_mfma_f32_16x16x32_bf16 v[56:59], a[28:31], v[44:47], v[56:59]
ds_read_b128 v[40:43], v1 offset:22528
v_mfma_f32_16x16x32_bf16 v[60:63], a[156:159], v[44:47], v[60:63]
v_mfma_f32_16x16x32_bf16 v[68:71], v[44:47], v[156:159], v[68:71]
s_waitcnt lgkmcnt(5)
v_mfma_f32_16x16x32_bf16 v[48:51], a[32:35], v[16:19], v[48:51]
ds_read_b128 v[44:47], v1 offset:23552
v_mfma_f32_16x16x32_bf16 v[52:55], a[160:163], v[16:19], v[52:55]
buffer_load_dwordx4 v0, s[4:7], s39 offen offset:3072 sc1 lds
v_mfma_f32_16x16x32_bf16 v[64:67], v[16:19], v[160:163], v[64:67]
v_mfma_f32_16x16x32_bf16 v[56:59], a[32:35], v[20:23], v[56:59]
ds_read_b128 v[16:19], v1 offset:24576
v_mfma_f32_16x16x32_bf16 v[60:63], a[160:163], v[20:23], v[60:63]
v_mfma_f32_16x16x32_bf16 v[68:71], v[20:23], v[160:163], v[68:71]
s_waitcnt lgkmcnt(5)
v_mfma_f32_16x16x32_bf16 v[48:51], a[36:39], v[24:27], v[48:51]
ds_read_b128 v[20:23], v1 offset:25600
v_mfma_f32_16x16x32_bf16 v[52:55], a[164:167], v[24:27], v[52:55]
s_add_u32 m0, s50, 8192
s_add_u32 s39, s45, 8192
v_mfma_f32_16x16x32_bf16 v[64:67], v[24:27], v[164:167], v[64:67]
buffer_load_dwordx4 v0, s[4:7], s39 offen offset:0 sc1 lds
v_mfma_f32_16x16x32_bf16 v[56:59], a[36:39], v[28:31], v[56:59]
ds_read_b128 v[24:27], v1 offset:26624
v_mfma_f32_16x16x32_bf16 v[60:63], a[164:167], v[28:31], v[60:63]
v_mfma_f32_16x16x32_bf16 v[68:71], v[28:31], v[164:167], v[68:71]
s_waitcnt lgkmcnt(5)
v_mfma_f32_16x16x32_bf16 v[48:51], a[40:43], v[32:35], v[48:51]
ds_read_b128 v[28:31], v1 offset:27648
v_mfma_f32_16x16x32_bf16 v[52:55], a[168:171], v[32:35], v[52:55]
v_mfma_f32_16x16x32_bf16 v[64:67], v[32:35], v[168:171], v[64:67]
buffer_load_dwordx4 v0, s[4:7], s39 offen offset:1024 sc1 lds
v_mfma_f32_16x16x32_bf16 v[56:59], a[40:43], v[36:39], v[56:59]
ds_read_b128 v[32:35], v1 offset:28672
v_mfma_f32_16x16x32_bf16 v[60:63], a[168:171], v[36:39], v[60:63]
v_mfma_f32_16x16x32_bf16 v[68:71], v[36:39], v[168:171], v[68:71]
s_waitcnt lgkmcnt(5)
v_mfma_f32_16x16x32_bf16 v[48:51], a[44:47], v[40:43], v[48:51]
ds_read_b128 v[36:39], v1 offset:29696
v_mfma_f32_16x16x32_bf16 v[52:55], a[172:175], v[40:43], v[52:55]
v_mfma_f32_16x16x32_bf16 v[64:67], v[40:43], v[172:175], v[64:67]
buffer_load_dwordx4 v0, s[4:7], s39 offen offset:2048 sc1 lds
v_mfma_f32_16x16x32_bf16 v[56:59], a[44:47], v[44:47], v[56:59]
ds_read_b128 v[40:43], v1 offset:30720
v_mfma_f32_16x16x32_bf16 v[60:63], a[172:175], v[44:47], v[60:63]
v_mfma_f32_16x16x32_bf16 v[68:71], v[44:47], v[172:175], v[68:71]
s_waitcnt lgkmcnt(5)
v_mfma_f32_16x16x32_bf16 v[48:51], a[48:51], v[16:19], v[48:51]
ds_read_b128 v[44:47], v1 offset:31744
v_mfma_f32_16x16x32_bf16 v[52:55], a[176:179], v[16:19], v[52:55]
v_mfma_f32_16x16x32_bf16 v[64:67], v[16:19], v[176:179], v[64:67]
buffer_load_dwordx4 v0, s[4:7], s39 offen offset:3072 sc1 lds
v_mfma_f32_16x16x32_bf16 v[56:59], a[48:51], v[20:23], v[56:59]
ds_read_b128 v[16:19], v1 offset:32768
v_mfma_f32_16x16x32_bf16 v[60:63], a[176:179], v[20:23], v[60:63]
v_mfma_f32_16x16x32_bf16 v[68:71], v[20:23], v[176:179], v[68:71]
s_waitcnt lgkmcnt(5)
v_mfma_f32_16x16x32_bf16 v[48:51], a[52:55], v[24:27], v[48:51]
ds_read_b128 v[20:23], v1 offset:33792
v_mfma_f32_16x16x32_bf16 v[52:55], a[180:183], v[24:27], v[52:55]
v_mfma_f32_16x16x32_bf16 v[64:67], v[24:27], v[180:183], v[64:67]
s_add_u32 m0, s50, 12288
s_add_u32 s39, s45, 12288
v_mfma_f32_16x16x32_bf16 v[56:59], a[52:55], v[28:31], v[56:59]
ds_read_b128 v[24:27], v1 offset:34816
v_mfma_f32_16x16x32_bf16 v[60:63], a[180:183], v[28:31], v[60:63]
buffer_load_dwordx4 v0, s[4:7], s39 offen offset:0 sc1 lds
v_mfma_f32_16x16x32_bf16 v[68:71], v[28:31], v[180:183], v[68:71]
s_waitcnt lgkmcnt(5)
v_mfma_f32_16x16x32_bf16 v[48:51], a[56:59], v[32:35], v[48:51]
ds_read_b128 v[28:31], v1 offset:35840
v_mfma_f32_16x16x32_bf16 v[52:55], a[184:187], v[32:35], v[52:55]
v_mfma_f32_16x16x32_bf16 v[64:67], v[32:35], v[184:187], v[64:67]
v_mfma_f32_16x16x32_bf16 v[56:59], a[56:59], v[36:39], v[56:59]
ds_read_b128 v[32:35], v1 offset:36864
v_mfma_f32_16x16x32_bf16 v[60:63], a[184:187], v[36:39], v[60:63]
buffer_load_dwordx4 v0, s[4:7], s39 offen offset:1024 sc1 lds
v_mfma_f32_16x16x32_bf16 v[68:71], v[36:39], v[184:187], v[68:71]
s_waitcnt lgkmcnt(5)
v_mfma_f32_16x16x32_bf16 v[48:51], a[60:63], v[40:43], v[48:51]
ds_read_b128 v[36:39], v1 offset:37888
v_mfma_f32_16x16x32_bf16 v[52:55], a[188:191], v[40:43], v[52:55]
v_mfma_f32_16x16x32_bf16 v[64:67], v[40:43], v[188:191], v[64:67]
v_mfma_f32_16x16x32_bf16 v[56:59], a[60:63], v[44:47], v[56:59]
ds_read_b128 v[40:43], v1 offset:38912
v_mfma_f32_16x16x32_bf16 v[60:63], a[188:191], v[44:47], v[60:63]
buffer_load_dwordx4 v0, s[4:7], s39 offen offset:2048 sc1 lds
v_mfma_f32_16x16x32_bf16 v[68:71], v[44:47], v[188:191], v[68:71]
s_waitcnt lgkmcnt(5)
v_mfma_f32_16x16x32_bf16 v[48:51], a[64:67], v[16:19], v[48:51]
ds_read_b128 v[44:47], v1 offset:39936
v_mfma_f32_16x16x32_bf16 v[52:55], a[192:195], v[16:19], v[52:55]
v_mfma_f32_16x16x32_bf16 v[64:67], v[16:19], v[192:195], v[64:67]
v_mfma_f32_16x16x32_bf16 v[56:59], a[64:67], v[20:23], v[56:59]
ds_read_b128 v[16:19], v1 offset:40960
v_mfma_f32_16x16x32_bf16 v[60:63], a[192:195], v[20:23], v[60:63]
buffer_load_dwordx4 v0, s[4:7], s39 offen offset:3072 sc1 lds
v_mfma_f32_16x16x32_bf16 v[68:71], v[20:23], v[192:195], v[68:71]
s_waitcnt lgkmcnt(5)
v_mfma_f32_16x16x32_bf16 v[48:51], a[68:71], v[24:27], v[48:51]
ds_read_b128 v[20:23], v1 offset:41984
v_mfma_f32_16x16x32_bf16 v[52:55], a[196:199], v[24:27], v[52:55]
v_mfma_f32_16x16x32_bf16 v[64:67], v[24:27], v[196:199], v[64:67]
v_mfma_f32_16x16x32_bf16 v[56:59], a[68:71], v[28:31], v[56:59]
ds_read_b128 v[24:27], v1 offset:43008
v_mfma_f32_16x16x32_bf16 v[60:63], a[196:199], v[28:31], v[60:63]
v_mfma_f32_16x16x32_bf16 v[68:71], v[28:31], v[196:199], v[68:71]
s_waitcnt lgkmcnt(5)
v_mfma_f32_16x16x32_bf16 v[48:51], a[72:75], v[32:35], v[48:51]
ds_read_b128 v[28:31], v1 offset:44032
v_mfma_f32_16x16x32_bf16 v[52:55], a[200:203], v[32:35], v[52:55]
v_mfma_f32_16x16x32_bf16 v[64:67], v[32:35], v[200:203], v[64:67]
v_mfma_f32_16x16x32_bf16 v[56:59], a[72:75], v[36:39], v[56:59]
ds_read_b128 v[32:35], v1 offset:45056
v_mfma_f32_16x16x32_bf16 v[60:63], a[200:203], v[36:39], v[60:63]
v_mfma_f32_16x16x32_bf16 v[68:71], v[36:39], v[200:203], v[68:71]
s_waitcnt lgkmcnt(5)
v_mfma_f32_16x16x32_bf16 v[48:51], a[76:79], v[40:43], v[48:51]
ds_read_b128 v[36:39], v1 offset:46080
v_mfma_f32_16x16x32_bf16 v[52:55], a[204:207], v[40:43], v[52:55]
v_mfma_f32_16x16x32_bf16 v[64:67], v[40:43], v[204:207], v[64:67]
v_mfma_f32_16x16x32_bf16 v[56:59], a[76:79], v[44:47], v[56:59]
ds_read_b128 v[40:43], v1 offset:47104
v_mfma_f32_16x16x32_bf16 v[60:63], a[204:207], v[44:47], v[60:63]
v_mfma_f32_16x16x32_bf16 v[68:71], v[44:47], v[204:207], v[68:71]
s_waitcnt lgkmcnt(5)
v_mfma_f32_16x16x32_bf16 v[48:51], a[80:83], v[16:19], v[48:51]
ds_read_b128 v[44:47], v1 offset:48128
s_add_u32 s48, s36, 2
v_mfma_f32_16x16x32_bf16 v[52:55], a[208:211], v[16:19], v[52:55]
s_and_b32 s47, s48, 31
s_lshl_b32 s47, s47, 8
v_mfma_f32_16x16x32_bf16 v[64:67], v[16:19], v[208:211], v[64:67]
s_add_u32 s47, s47, 3424256
s_lshr_b32 s48, s48, 5
v_mfma_f32_16x16x32_bf16 v[56:59], a[80:83], v[20:23], v[56:59]
ds_read_b128 v[16:19], v1 offset:49152
s_lshl_b32 s48, 1, s48
v_mfma_f32_16x16x32_bf16 v[60:63], a[208:211], v[20:23], v[60:63]
s_add_u32 s48, s48, 1
v_mfma_f32_16x16x32_bf16 v[68:71], v[20:23], v[208:211], v[68:71]
s_waitcnt lgkmcnt(5)
v_mfma_f32_16x16x32_bf16 v[48:51], a[84:87], v[24:27], v[48:51]
ds_read_b128 v[20:23], v1 offset:50176
v_mfma_f32_16x16x32_bf16 v[52:55], a[212:215], v[24:27], v[52:55]
buffer_load_dword v3, v2, s[4:7], s47 offen sc1
v_mfma_f32_16x16x32_bf16 v[64:67], v[24:27], v[212:215], v[64:67]
v_mfma_f32_16x16x32_bf16 v[56:59], a[84:87], v[28:31], v[56:59]
ds_read_b128 v[24:27], v1 offset:51200
v_mfma_f32_16x16x32_bf16 v[60:63], a[212:215], v[28:31], v[60:63]
v_mfma_f32_16x16x32_bf16 v[68:71], v[28:31], v[212:215], v[68:71]
s_waitcnt lgkmcnt(5)
v_mfma_f32_16x16x32_bf16 v[48:51], a[88:91], v[32:35], v[48:51]
ds_read_b128 v[28:31], v1 offset:52224
v_mfma_f32_16x16x32_bf16 v[52:55], a[216:219], v[32:35], v[52:55]
v_mfma_f32_16x16x32_bf16 v[64:67], v[32:35], v[216:219], v[64:67]
v_mfma_f32_16x16x32_bf16 v[56:59], a[88:91], v[36:39], v[56:59]
ds_read_b128 v[32:35], v1 offset:53248
v_mfma_f32_16x16x32_bf16 v[60:63], a[216:219], v[36:39], v[60:63]
v_mfma_f32_16x16x32_bf16 v[68:71], v[36:39], v[216:219], v[68:71]
s_waitcnt lgkmcnt(5)
v_mfma_f32_16x16x32_bf16 v[48:51], a[92:95], v[40:43], v[48:51]
ds_read_b128 v[36:39], v1 offset:54272
v_mfma_f32_16x16x32_bf16 v[52:55], a[220:223], v[40:43], v[52:55]
v_mfma_f32_16x16x32_bf16 v[64:67], v[40:43], v[220:223], v[64:67]
v_mfma_f32_16x16x32_bf16 v[56:59], a[92:95], v[44:47], v[56:59]
ds_read_b128 v[40:43], v1 offset:55296
v_mfma_f32_16x16x32_bf16 v[60:63], a[220:223], v[44:47], v[60:63]
v_mfma_f32_16x16x32_bf16 v[68:71], v[44:47], v[220:223], v[68:71]
s_waitcnt lgkmcnt(5)
v_mfma_f32_16x16x32_bf16 v[48:51], a[96:99], v[16:19], v[48:51]
ds_read_b128 v[44:47], v1 offset:56320
v_mfma_f32_16x16x32_bf16 v[52:55], a[224:227], v[16:19], v[52:55]
v_mfma_f32_16x16x32_bf16 v[64:67], v[16:19], v[224:227], v[64:67]
v_mfma_f32_16x16x32_bf16 v[56:59], a[96:99], v[20:23], v[56:59]
ds_read_b128 v[16:19], v1 offset:57344
v_mfma_f32_16x16x32_bf16 v[60:63], a[224:227], v[20:23], v[60:63]
v_mfma_f32_16x16x32_bf16 v[68:71], v[20:23], v[224:227], v[68:71]
s_waitcnt lgkmcnt(5)
v_mfma_f32_16x16x32_bf16 v[48:51], a[100:103], v[24:27], v[48:51]
ds_read_b128 v[20:23], v1 offset:58368
v_mfma_f32_16x16x32_bf16 v[52:55], a[228:231], v[24:27], v[52:55]
v_mfma_f32_16x16x32_bf16 v[64:67], v[24:27], v[228:231], v[64:67]
v_mfma_f32_16x16x32_bf16 v[56:59], a[100:103], v[28:31], v[56:59]
ds_read_b128 v[24:27], v1 offset:59392
v_mfma_f32_16x16x32_bf16 v[60:63], a[228:231], v[28:31], v[60:63]
v_mfma_f32_16x16x32_bf16 v[68:71], v[28:31], v[228:231], v[68:71]
s_waitcnt lgkmcnt(5)
v_mfma_f32_16x16x32_bf16 v[48:51], a[104:107], v[32:35], v[48:51]
ds_read_b128 v[28:31], v1 offset:60416
v_mfma_f32_16x16x32_bf16 v[52:55], a[232:235], v[32:35], v[52:55]
v_mfma_f32_16x16x32_bf16 v[64:67], v[32:35], v[232:235], v[64:67]
v_mfma_f32_16x16x32_bf16 v[56:59], a[104:107], v[36:39], v[56:59]
ds_read_b128 v[32:35], v1 offset:61440
v_mfma_f32_16x16x32_bf16 v[60:63], a[232:235], v[36:39], v[60:63]
v_mfma_f32_16x16x32_bf16 v[68:71], v[36:39], v[232:235], v[68:71]
s_waitcnt lgkmcnt(5)
v_mfma_f32_16x16x32_bf16 v[48:51], a[108:111], v[40:43], v[48:51]
ds_read_b128 v[36:39], v1 offset:62464
v_mfma_f32_16x16x32_bf16 v[52:55], a[236:239], v[40:43], v[52:55]
v_mfma_f32_16x16x32_bf16 v[64:67], v[40:43], v[236:239], v[64:67]
v_mfma_f32_16x16x32_bf16 v[56:59], a[108:111], v[44:47], v[56:59]
ds_read_b128 v[40:43], v1 offset:63488
v_mfma_f32_16x16x32_bf16 v[60:63], a[236:239], v[44:47], v[60:63]
v_mfma_f32_16x16x32_bf16 v[68:71], v[44:47], v[236:239], v[68:71]
s_waitcnt lgkmcnt(5)
v_mfma_f32_16x16x32_bf16 v[48:51], a[112:115], v[16:19], v[48:51]
ds_read_b128 v[44:47], v1 offset:64512
v_mfma_f32_16x16x32_bf16 v[52:55], a[240:243], v[16:19], v[52:55]
v_mfma_f32_16x16x32_bf16 v[64:67], v[16:19], v[240:243], v[64:67]
v_mfma_f32_16x16x32_bf16 v[56:59], a[112:115], v[20:23], v[56:59]
v_mfma_f32_16x16x32_bf16 v[60:63], a[240:243], v[20:23], v[60:63]
v_mfma_f32_16x16x32_bf16 v[68:71], v[20:23], v[240:243], v[68:71]
s_waitcnt lgkmcnt(4)
v_mfma_f32_16x16x32_bf16 v[48:51], a[116:119], v[24:27], v[48:51]
v_mfma_f32_16x16x32_bf16 v[52:55], a[244:247], v[24:27], v[52:55]
v_mfma_f32_16x16x32_bf16 v[64:67], v[24:27], v[244:247], v[64:67]
v_mfma_f32_16x16x32_bf16 v[56:59], a[116:119], v[28:31], v[56:59]
v_mfma_f32_16x16x32_bf16 v[60:63], a[244:247], v[28:31], v[60:63]
v_mfma_f32_16x16x32_bf16 v[68:71], v[28:31], v[244:247], v[68:71]
s_waitcnt lgkmcnt(2)
v_mfma_f32_16x16x32_bf16 v[48:51], a[120:123], v[32:35], v[48:51]
v_mfma_f32_16x16x32_bf16 v[52:55], a[248:251], v[32:35], v[52:55]
v_mfma_f32_16x16x32_bf16 v[64:67], v[32:35], v[248:251], v[64:67]
v_mfma_f32_16x16x32_bf16 v[56:59], a[120:123], v[36:39], v[56:59]
v_mfma_f32_16x16x32_bf16 v[60:63], a[248:251], v[36:39], v[60:63]
v_mfma_f32_16x16x32_bf16 v[68:71], v[36:39], v[248:251], v[68:71]
s_waitcnt lgkmcnt(0)
v_mfma_f32_16x16x32_bf16 v[48:51], a[124:127], v[40:43], v[48:51]
v_mfma_f32_16x16x32_bf16 v[52:55], a[252:255], v[40:43], v[52:55]
v_mfma_f32_16x16x32_bf16 v[64:67], v[40:43], v[252:255], v[64:67]
v_mfma_f32_16x16x32_bf16 v[56:59], a[124:127], v[44:47], v[56:59]
v_mfma_f32_16x16x32_bf16 v[60:63], a[252:255], v[44:47], v[60:63]
v_mfma_f32_16x16x32_bf16 v[68:71], v[44:47], v[252:255], v[68:71]
v_xor_b32 v1, 0x10000, v1
s_add_u32 s49, s49, 786432
s_add_u32 s36, s36, 1
s_and_b32 s38, s36, 63
s_cmp_lt_u32 s38, 4
s_cbranch_scc1 Lsn_592
s_cmp_lg_u32 s46, 0
s_cbranch_scc1 Lst_588
v_cvt_pk_bf16_f32 v80, v48, v49
v_cvt_pk_bf16_f32 v81, v50, v51
v_cvt_pk_bf16_f32 v82, v52, v53
v_cvt_pk_bf16_f32 v83, v54, v55
buffer_store_dwordx4 v[80:83], v6, s[4:7], s49 offen sc1
v_cvt_pk_bf16_f32 v84, v56, v57
v_cvt_pk_bf16_f32 v85, v58, v59
v_cvt_pk_bf16_f32 v86, v60, v61
v_cvt_pk_bf16_f32 v87, v62, v63
buffer_store_dwordx4 v[84:87], v7, s[4:7], s49 offen sc1
v_cvt_pk_bf16_f32 v88, v64, v65
v_cvt_pk_bf16_f32 v89, v66, v67
v_cvt_pk_bf16_f32 v90, v68, v69
v_cvt_pk_bf16_f32 v91, v70, v71
buffer_store_dwordx4 v[88:91], v8, s[4:7], s49 offen sc1
s_branch Lsw_590
Lsn_592:
s_nop 4
v_cvt_pk_bf16_f32 v80, v48, v49
v_cvt_pk_bf16_f32 v81, v50, v51
v_cvt_pk_bf16_f32 v82, v52, v53
v_cvt_pk_bf16_f32 v83, v54, v55
buffer_store_dwordx4 v[80:83], v6, s[4:7], s49 offen sc1
v_cvt_pk_bf16_f32 v84, v56, v57
v_cvt_pk_bf16_f32 v85, v58, v59
v_cvt_pk_bf16_f32 v86, v60, v61
v_cvt_pk_bf16_f32 v87, v62, v63
buffer_store_dwordx4 v[84:87], v7, s[4:7], s49 offen sc1
v_cvt_pk_bf16_f32 v88, v64, v65
v_cvt_pk_bf16_f32 v89, v66, v67
v_cvt_pk_bf16_f32 v90, v68, v69
v_cvt_pk_bf16_f32 v91, v70, v71
buffer_store_dwordx4 v[88:91], v8, s[4:7], s49 offen sc1
s_mov_b32 s63, s36
v_mov_b32 v5, s36
s_waitcnt vmcnt(0)
s_barrier
buffer_store_dword v5, v4, s[4:7], 0 offen sc1
s_cmp_lg_u32 s46, 0
s_cbranch_scc1 Lse_591
s_cmp_lt_u32 s36, 64
s_cbranch_scc1 Lsw_590
s_load_dwordx2 s[16:17], s[0:1], 104
s_and_b32 s52, s44, 3
s_lshr_b32 s53, s44, 2
v_lshrrev_b32 v80, 3, v9
v_and_b32 v81, 7, v9
s_lshr_b32 s38, s52, 1
s_lshl_b32 s38, s38, 10
s_and_b32 s39, s52, 1
s_lshl_b32 s39, s39, 7
s_add_u32 s38, s38, s39
s_lshl_b32 s39, s53, 12
s_add_u32 s38, s38, s39
v_lshl_add_u32 v6, v81, 4, s38
v_and_b32 v82, 3, v80
v_lshl_add_u32 v6, v82, 8, v6
v_lshrrev_b32 v82, 2, v80
v_lshl_add_u32 v6, v82, 11, v6
s_lshl_b32 s38, s52, 14
s_lshl_b32 s39, s53, 7
s_add_u32 s38, s38, s39
v_lshl_add_u32 v7, v81, 11, s38
v_lshl_add_u32 v7, v80, 4, v7
s_lshl_b32 s38, s53, 8
v_lshl_add_u32 v8, v80, 5, s38
v_min_u32 v2, 6, v9
v_lshlrev_b32 v2, 10, v2
s_lshr_b32 s47, s44, 3
s_lshl_b32 s47, s47, 7
s_add_u32 s47, s47, 3416068
s_mov_b32 s60, 0x00003f80
s_mov_b32 s61, 0x3f800000
s_waitcnt lgkmcnt(0)
s_mov_b32 s8, s16
s_and_b32 s9, s17, 0xffff
s_mov_b32 s10, 0x400000
s_mov_b32 s11, 0x20000
v_lshlrev_b32 v80, 7, v9
s_mov_b32 s38, 3424256
Lbw_595:
buffer_load_dword v81, v80, s[4:7], s38 offen sc1
s_waitcnt vmcnt(0)
v_cmp_gt_u32 vcc, 4, v81
s_cbranch_vccz Lbo_596
s_sub_u32 s37, s37, 1
s_cbranch_scc1 Lend_7
s_sleep 2
s_branch Lbw_595
Lbo_596:
s_mov_b32 s38, 3166208
buffer_load_dwordx4 v[16:19], v8, s[4:7], s38 offen offset:0 sc1
buffer_load_dwordx4 v[20:23], v8, s[4:7], s38 offen offset:16 sc1
s_mov_b32 s36, s32
Lfin_597:
s_add_u32 s48, s36, 13
Lbw_598:
buffer_load_dword v3, v2, s[4:7], s47 offen sc1
s_waitcnt vmcnt(0)
v_cmp_gt_u32 vcc, s48, v3
s_cbranch_vccz Lbo_599
s_sub_u32 s37, s37, 1
s_cbranch_scc1 Lend_7
s_sleep 32
s_branch Lbw_598
Lbo_599:
s_lshl_b32 s49, s36, 16
s_add_u32 s39, s49, 134217728
buffer_load_dwordx4 v[64:67], v6, s[4:7], s39 offen sc1
s_add_u32 s39, s49, 138412032
buffer_load_dwordx4 v[68:71], v6, s[4:7], s39 offen sc1
s_add_u32 s39, s49, 142606336
buffer_load_dwordx4 v[72:75], v6, s[4:7], s39 offen sc1
s_add_u32 s39, s49, 146800640
buffer_load_dwordx4 v[76:79], v6, s[4:7], s39 offen sc1
s_add_u32 s39, s49, 150994944
buffer_load_dwordx4 v[80:83], v6, s[4:7], s39 offen sc1
s_add_u32 s39, s49, 155189248
buffer_load_dwordx4 v[84:87], v6, s[4:7], s39 offen sc1
s_add_u32 s39, s49, 159383552
buffer_load_dwordx4 v[88:91], v6, s[4:7], s39 offen sc1
s_add_u32 s39, s49, 12582912
buffer_load_dwordx4 v[92:95], v6, s[4:7], s39 offen sc1
s_add_u32 s39, s49, 134479872
buffer_load_dwordx4 v[96:99], v6, s[4:7], s39 offen sc1
s_add_u32 s39, s49, 138674176
buffer_load_dwordx4 v[100:103], v6, s[4:7], s39 offen sc1
s_add_u32 s39, s49, 142868480
buffer_load_dwordx4 v[104:107], v6, s[4:7], s39 offen sc1
s_add_u32 s39, s49, 147062784
buffer_load_dwordx4 v[108:111], v6, s[4:7], s39 offen sc1
s_add_u32 s39, s49, 151257088
buffer_load_dwordx4 v[112:115], v6, s[4:7], s39 offen sc1
s_add_u32 s39, s49, 155451392
buffer_load_dwordx4 v[116:119], v6, s[4:7], s39 offen sc1
s_add_u32 s39, s49, 159645696
buffer_load_dwordx4 v[120:123], v6, s[4:7], s39 offen sc1
s_add_u32 s39, s49, 12845056
buffer_load_dwordx4 v[124:127], v6, s[4:7], s39 offen sc1
s_add_u32 s39, s49, 134742016
buffer_load_dwordx4 v[128:131], v6, s[4:7], s39 offen sc1
s_add_u32 s39, s49, 138936320
buffer_load_dwordx4 v[132:135], v6, s[4:7], s39 offen sc1
s_add_u32 s39, s49, 143130624
buffer_load_dwordx4 v[136:139], v6, s[4:7], s39 offen sc1
s_add_u32 s39, s49, 147324928
buffer_load_dwordx4 v[140:143], v6, s[4:7], s39 offen sc1
s_add_u32 s39, s49, 151519232
buffer_load_dwordx4 v[144:147], v6, s[4:7], s39 offen sc1
s_add_u32 s39, s49, 155713536
buffer_load_dwordx4 v[148:151], v6, s[4:7], s39 offen sc1
s_add_u32 s39, s49, 159907840
buffer_load_dwordx4 v[152:155], v6, s[4:7], s39 offen sc1
s_add_u32 s39, s49, 13107200
buffer_load_dwordx4 v[156:159], v6, s[4:7], s39 offen sc1
s_add_u32 s39, s49, 135004160
buffer_load_dwordx4 v[160:163], v6, s[4:7], s39 offen sc1
s_add_u32 s39, s49, 139198464
buffer_load_dwordx4 v[164:167], v6, s[4:7], s39 offen sc1
s_add_u32 s39, s49, 143392768
buffer_load_dwordx4 v[168:171], v6, s[4:7], s39 offen sc1
s_add_u32 s39, s49, 147587072
buffer_load_dwordx4 v[172:175], v6, s[4:7], s39 offen sc1
s_add_u32 s39, s49, 151781376
buffer_load_dwordx4 v[176:179], v6, s[4:7], s39 offen sc1
s_add_u32 s39, s49, 155975680
buffer_load_dwordx4 v[180:183], v6, s[4:7], s39 offen sc1
s_add_u32 s39, s49, 160169984
buffer_load_dwordx4 v[184:187], v6, s[4:7], s39 offen sc1
s_add_u32 s39, s49, 13369344
buffer_load_dwordx4 v[188:191], v6, s[4:7], s39 offen sc1
s_waitcnt vmcnt(24)
v_dot2_f32_bf16 v24, v64, s60, 0
v_dot2_f32_bf16 v25, v64, s61, 0
v_dot2_f32_bf16 v26, v65, s60, 0
v_dot2_f32_bf16 v27, v65, s61, 0
v_dot2_f32_bf16 v28, v66, s60, 0
v_dot2_f32_bf16 v29, v66, s61, 0
v_dot2_f32_bf16 v30, v67, s60, 0
v_dot2_f32_bf16 v31, v67, s61, 0
v_dot2_f32_bf16 v24, v68, s60, v24
v_dot2_f32_bf16 v25, v68, s61, v25
v_dot2_f32_bf16 v26, v69, s60, v26
v_dot2_f32_bf16 v27, v69, s61, v27
v_dot2_f32_bf16 v28, v70, s60, v28
v_dot2_f32_bf16 v29, v70, s61, v29
v_dot2_f32_bf16 v30, v71, s60, v30
v_dot2_f32_bf16 v31, v71, s61, v31
v_dot2_f32_bf16 v24, v72, s60, v24
v_dot2_f32_bf16 v25, v72, s61, v25
v_dot2_f32_bf16 v26, v73, s60, v26
v_dot2_f32_bf16 v27, v73, s61, v27
v_dot2_f32_bf16 v28, v74, s60, v28
v_dot2_f32_bf16 v29, v74, s61, v29
v_dot2_f32_bf16 v30, v75, s60, v30
v_dot2_f32_bf16 v31, v75, s61, v31
v_dot2_f32_bf16 v24, v76, s60, v24
v_dot2_f32_bf16 v25, v76, s61, v25
v_dot2_f32_bf16 v26, v77, s60, v26
v_dot2_f32_bf16 v27, v77, s61, v27
v_dot2_f32_bf16 v28, v78, s60, v28
v_dot2_f32_bf16 v29, v78, s61, v29
v_dot2_f32_bf16 v30, v79, s60, v30
v_dot2_f32_bf16 v31, v79, s61, v31
v_dot2_f32_bf16 v24, v80, s60, v24
v_dot2_f32_bf16 v25, v80, s61, v25
v_dot2_f32_bf16 v26, v81, s60, v26
v_dot2_f32_bf16 v27, v81, s61, v27
v_dot2_f32_bf16 v28, v82, s60, v28
v_dot2_f32_bf16 v29, v82, s61, v29
v_dot2_f32_bf16 v30, v83, s60, v30
v_dot2_f32_bf16 v31, v83, s61, v31
v_dot2_f32_bf16 v24, v84, s60, v24
v_dot2_f32_bf16 v25, v84, s61, v25
v_dot2_f32_bf16 v26, v85, s60, v26
v_dot2_f32_bf16 v27, v85, s61, v27
v_dot2_f32_bf16 v28, v86, s60, v28
v_dot2_f32_bf16 v29, v86, s61, v29
v_dot2_f32_bf16 v30, v87, s60, v30
v_dot2_f32_bf16 v31, v87, s61, v31
v_dot2_f32_bf16 v24, v88, s60, v24
v_dot2_f32_bf16 v25, v88, s61, v25
v_dot2_f32_bf16 v26, v89, s60, v26
v_dot2_f32_bf16 v27, v89, s61, v27
v_dot2_f32_bf16 v28, v90, s60, v28
v_dot2_f32_bf16 v29, v90, s61, v29
v_dot2_f32_bf16 v30, v91, s60, v30
v_dot2_f32_bf16 v31, v91, s61, v31
v_lshlrev_b32 v32, 16, v92
v_and_b32 v33, 0xffff0000, v92
v_lshlrev_b32 v34, 16, v93
v_and_b32 v35, 0xffff0000, v93
v_lshlrev_b32 v36, 16, v94
v_and_b32 v37, 0xffff0000, v94
v_lshlrev_b32 v38, 16, v95
v_and_b32 v39, 0xffff0000, v95
v_pk_fma_f32 v[32:33], v[24:25], v[16:17], v[32:33]
v_pk_fma_f32 v[34:35], v[26:27], v[18:19], v[34:35]
v_pk_fma_f32 v[36:37], v[28:29], v[20:21], v[36:37]
v_pk_fma_f32 v[38:39], v[30:31], v[22:23], v[38:39]
v_cvt_pk_bf16_f32 v40, v32, v33
v_cvt_pk_bf16_f32 v41, v34, v35
v_cvt_pk_bf16_f32 v42, v36, v37
v_cvt_pk_bf16_f32 v43, v38, v39
s_add_u32 s39, s49, 0
buffer_store_dwordx4 v[40:43], v7, s[8:11], s39 offen
s_waitcnt vmcnt(17)
v_dot2_f32_bf16 v24, v96, s60, 0
v_dot2_f32_bf16 v25, v96, s61, 0
v_dot2_f32_bf16 v26, v97, s60, 0
v_dot2_f32_bf16 v27, v97, s61, 0
v_dot2_f32_bf16 v28, v98, s60, 0
v_dot2_f32_bf16 v29, v98, s61, 0
v_dot2_f32_bf16 v30, v99, s60, 0
v_dot2_f32_bf16 v31, v99, s61, 0
v_dot2_f32_bf16 v24, v100, s60, v24
v_dot2_f32_bf16 v25, v100, s61, v25
v_dot2_f32_bf16 v26, v101, s60, v26
v_dot2_f32_bf16 v27, v101, s61, v27
v_dot2_f32_bf16 v28, v102, s60, v28
v_dot2_f32_bf16 v29, v102, s61, v29
v_dot2_f32_bf16 v30, v103, s60, v30
v_dot2_f32_bf16 v31, v103, s61, v31
v_dot2_f32_bf16 v24, v104, s60, v24
v_dot2_f32_bf16 v25, v104, s61, v25
v_dot2_f32_bf16 v26, v105, s60, v26
v_dot2_f32_bf16 v27, v105, s61, v27
v_dot2_f32_bf16 v28, v106, s60, v28
v_dot2_f32_bf16 v29, v106, s61, v29
v_dot2_f32_bf16 v30, v107, s60, v30
v_dot2_f32_bf16 v31, v107, s61, v31
v_dot2_f32_bf16 v24, v108, s60, v24
v_dot2_f32_bf16 v25, v108, s61, v25
v_dot2_f32_bf16 v26, v109, s60, v26
v_dot2_f32_bf16 v27, v109, s61, v27
v_dot2_f32_bf16 v28, v110, s60, v28
v_dot2_f32_bf16 v29, v110, s61, v29
v_dot2_f32_bf16 v30, v111, s60, v30
v_dot2_f32_bf16 v31, v111, s61, v31
v_dot2_f32_bf16 v24, v112, s60, v24
v_dot2_f32_bf16 v25, v112, s61, v25
v_dot2_f32_bf16 v26, v113, s60, v26
v_dot2_f32_bf16 v27, v113, s61, v27
v_dot2_f32_bf16 v28, v114, s60, v28
v_dot2_f32_bf16 v29, v114, s61, v29
v_dot2_f32_bf16 v30, v115, s60, v30
v_dot2_f32_bf16 v31, v115, s61, v31
v_dot2_f32_bf16 v24, v116, s60, v24
v_dot2_f32_bf16 v25, v116, s61, v25
v_dot2_f32_bf16 v26, v117, s60, v26
v_dot2_f32_bf16 v27, v117, s61, v27
v_dot2_f32_bf16 v28, v118, s60, v28
v_dot2_f32_bf16 v29, v118, s61, v29
v_dot2_f32_bf16 v30, v119, s60, v30
v_dot2_f32_bf16 v31, v119, s61, v31
v_dot2_f32_bf16 v24, v120, s60, v24
v_dot2_f32_bf16 v25, v120, s61, v25
v_dot2_f32_bf16 v26, v121, s60, v26
v_dot2_f32_bf16 v27, v121, s61, v27
v_dot2_f32_bf16 v28, v122, s60, v28
v_dot2_f32_bf16 v29, v122, s61, v29
v_dot2_f32_bf16 v30, v123, s60, v30
v_dot2_f32_bf16 v31, v123, s61, v31
v_lshlrev_b32 v32, 16, v124
v_and_b32 v33, 0xffff0000, v124
v_lshlrev_b32 v34, 16, v125
v_and_b32 v35, 0xffff0000, v125
v_lshlrev_b32 v36, 16, v126
v_and_b32 v37, 0xffff0000, v126
v_lshlrev_b32 v38, 16, v127
v_and_b32 v39, 0xffff0000, v127
v_pk_fma_f32 v[32:33], v[24:25], v[16:17], v[32:33]
v_pk_fma_f32 v[34:35], v[26:27], v[18:19], v[34:35]
v_pk_fma_f32 v[36:37], v[28:29], v[20:21], v[36:37]
v_pk_fma_f32 v[38:39], v[30:31], v[22:23], v[38:39]
v_cvt_pk_bf16_f32 v44, v32, v33
v_cvt_pk_bf16_f32 v45, v34, v35
v_cvt_pk_bf16_f32 v46, v36, v37
v_cvt_pk_bf16_f32 v47, v38, v39
s_add_u32 s39, s49, 262144
buffer_store_dwordx4 v[44:47], v7, s[8:11], s39 offen
s_waitcnt vmcnt(10)
v_dot2_f32_bf16 v24, v128, s60, 0
v_dot2_f32_bf16 v25, v128, s61, 0
v_dot2_f32_bf16 v26, v129, s60, 0
v_dot2_f32_bf16 v27, v129, s61, 0
v_dot2_f32_bf16 v28, v130, s60, 0
v_dot2_f32_bf16 v29, v130, s61, 0
v_dot2_f32_bf16 v30, v131, s60, 0
v_dot2_f32_bf16 v31, v131, s61, 0
v_dot2_f32_bf16 v24, v132, s60, v24
v_dot2_f32_bf16 v25, v132, s61, v25
v_dot2_f32_bf16 v26, v133, s60, v26
v_dot2_f32_bf16 v27, v133, s61, v27
v_dot2_f32_bf16 v28, v134, s60, v28
v_dot2_f32_bf16 v29, v134, s61, v29
v_dot2_f32_bf16 v30, v135, s60, v30
v_dot2_f32_bf16 v31, v135, s61, v31
v_dot2_f32_bf16 v24, v136, s60, v24
v_dot2_f32_bf16 v25, v136, s61, v25
v_dot2_f32_bf16 v26, v137, s60, v26
v_dot2_f32_bf16 v27, v137, s61, v27
v_dot2_f32_bf16 v28, v138, s60, v28
v_dot2_f32_bf16 v29, v138, s61, v29
v_dot2_f32_bf16 v30, v139, s60, v30
v_dot2_f32_bf16 v31, v139, s61, v31
v_dot2_f32_bf16 v24, v140, s60, v24
v_dot2_f32_bf16 v25, v140, s61, v25
v_dot2_f32_bf16 v26, v141, s60, v26
v_dot2_f32_bf16 v27, v141, s61, v27
v_dot2_f32_bf16 v28, v142, s60, v28
v_dot2_f32_bf16 v29, v142, s61, v29
v_dot2_f32_bf16 v30, v143, s60, v30
v_dot2_f32_bf16 v31, v143, s61, v31
v_dot2_f32_bf16 v24, v144, s60, v24
v_dot2_f32_bf16 v25, v144, s61, v25
v_dot2_f32_bf16 v26, v145, s60, v26
v_dot2_f32_bf16 v27, v145, s61, v27
v_dot2_f32_bf16 v28, v146, s60, v28
v_dot2_f32_bf16 v29, v146, s61, v29
v_dot2_f32_bf16 v30, v147, s60, v30
v_dot2_f32_bf16 v31, v147, s61, v31
v_dot2_f32_bf16 v24, v148, s60, v24
v_dot2_f32_bf16 v25, v148, s61, v25
v_dot2_f32_bf16 v26, v149, s60, v26
v_dot2_f32_bf16 v27, v149, s61, v27
v_dot2_f32_bf16 v28, v150, s60, v28
v_dot2_f32_bf16 v29, v150, s61, v29
v_dot2_f32_bf16 v30, v151, s60, v30
v_dot2_f32_bf16 v31, v151, s61, v31
v_dot2_f32_bf16 v24, v152, s60, v24
v_dot2_f32_bf16 v25, v152, s61, v25
v_dot2_f32_bf16 v26, v153, s60, v26
v_dot2_f32_bf16 v27, v153, s61, v27
v_dot2_f32_bf16 v28, v154, s60, v28
v_dot2_f32_bf16 v29, v154, s61, v29
v_dot2_f32_bf16 v30, v155, s60, v30
v_dot2_f32_bf16 v31, v155, s61, v31
v_lshlrev_b32 v32, 16, v156
v_and_b32 v33, 0xffff0000, v156
v_lshlrev_b32 v34, 16, v157
v_and_b32 v35, 0xffff0000, v157
v_lshlrev_b32 v36, 16, v158
v_and_b32 v37, 0xffff0000, v158
v_lshlrev_b32 v38, 16, v159
v_and_b32 v39, 0xffff0000, v159
v_pk_fma_f32 v[32:33], v[24:25], v[16:17], v[32:33]
v_pk_fma_f32 v[34:35], v[26:27], v[18:19], v[34:35]
v_pk_fma_f32 v[36:37], v[28:29], v[20:21], v[36:37]
v_pk_fma_f32 v[38:39], v[30:31], v[22:23], v[38:39]
v_cvt_pk_bf16_f32 v48, v32, v33
v_cvt_pk_bf16_f32 v49, v34, v35
v_cvt_pk_bf16_f32 v50, v36, v37
v_cvt_pk_bf16_f32 v51, v38, v39
s_add_u32 s39, s49, 524288
buffer_store_dwordx4 v[48:51], v7, s[8:11], s39 offen
s_waitcnt vmcnt(3)
v_dot2_f32_bf16 v24, v160, s60, 0
v_dot2_f32_bf16 v25, v160, s61, 0
v_dot2_f32_bf16 v26, v161, s60, 0
v_dot2_f32_bf16 v27, v161, s61, 0
v_dot2_f32_bf16 v28, v162, s60, 0
v_dot2_f32_bf16 v29, v162, s61, 0
v_dot2_f32_bf16 v30, v163, s60, 0
v_dot2_f32_bf16 v31, v163, s61, 0
v_dot2_f32_bf16 v24, v164, s60, v24
v_dot2_f32_bf16 v25, v164, s61, v25
v_dot2_f32_bf16 v26, v165, s60, v26
v_dot2_f32_bf16 v27, v165, s61, v27
v_dot2_f32_bf16 v28, v166, s60, v28
v_dot2_f32_bf16 v29, v166, s61, v29
v_dot2_f32_bf16 v30, v167, s60, v30
v_dot2_f32_bf16 v31, v167, s61, v31
v_dot2_f32_bf16 v24, v168, s60, v24
v_dot2_f32_bf16 v25, v168, s61, v25
v_dot2_f32_bf16 v26, v169, s60, v26
v_dot2_f32_bf16 v27, v169, s61, v27
v_dot2_f32_bf16 v28, v170, s60, v28
v_dot2_f32_bf16 v29, v170, s61, v29
v_dot2_f32_bf16 v30, v171, s60, v30
v_dot2_f32_bf16 v31, v171, s61, v31
v_dot2_f32_bf16 v24, v172, s60, v24
v_dot2_f32_bf16 v25, v172, s61, v25
v_dot2_f32_bf16 v26, v173, s60, v26
v_dot2_f32_bf16 v27, v173, s61, v27
v_dot2_f32_bf16 v28, v174, s60, v28
v_dot2_f32_bf16 v29, v174, s61, v29
v_dot2_f32_bf16 v30, v175, s60, v30
v_dot2_f32_bf16 v31, v175, s61, v31
v_dot2_f32_bf16 v24, v176, s60, v24
v_dot2_f32_bf16 v25, v176, s61, v25
v_dot2_f32_bf16 v26, v177, s60, v26
v_dot2_f32_bf16 v27, v177, s61, v27
v_dot2_f32_bf16 v28, v178, s60, v28
v_dot2_f32_bf16 v29, v178, s61, v29
v_dot2_f32_bf16 v30, v179, s60, v30
v_dot2_f32_bf16 v31, v179, s61, v31
v_dot2_f32_bf16 v24, v180, s60, v24
v_dot2_f32_bf16 v25, v180, s61, v25
v_dot2_f32_bf16 v26, v181, s60, v26
v_dot2_f32_bf16 v27, v181, s61, v27
v_dot2_f32_bf16 v28, v182, s60, v28
v_dot2_f32_bf16 v29, v182, s61, v29
v_dot2_f32_bf16 v30, v183, s60, v30
v_dot2_f32_bf16 v31, v183, s61, v31
v_dot2_f32_bf16 v24, v184, s60, v24
v_dot2_f32_bf16 v25, v184, s61, v25
v_dot2_f32_bf16 v26, v185, s60, v26
v_dot2_f32_bf16 v27, v185, s61, v27
v_dot2_f32_bf16 v28, v186, s60, v28
v_dot2_f32_bf16 v29, v186, s61, v29
v_dot2_f32_bf16 v30, v187, s60, v30
v_dot2_f32_bf16 v31, v187, s61, v31
v_lshlrev_b32 v32, 16, v188
v_and_b32 v33, 0xffff0000, v188
v_lshlrev_b32 v34, 16, v189
v_and_b32 v35, 0xffff0000, v189
v_lshlrev_b32 v36, 16, v190
v_and_b32 v37, 0xffff0000, v190
v_lshlrev_b32 v38, 16, v191
v_and_b32 v39, 0xffff0000, v191
v_pk_fma_f32 v[32:33], v[24:25], v[16:17], v[32:33]
v_pk_fma_f32 v[34:35], v[26:27], v[18:19], v[34:35]
v_pk_fma_f32 v[36:37], v[28:29], v[20:21], v[36:37]
v_pk_fma_f32 v[38:39], v[30:31], v[22:23], v[38:39]
v_cvt_pk_bf16_f32 v52, v32, v33
v_cvt_pk_bf16_f32 v53, v34, v35
v_cvt_pk_bf16_f32 v54, v36, v37
v_cvt_pk_bf16_f32 v55, v38, v39
s_add_u32 s39, s49, 786432
buffer_store_dwordx4 v[52:55], v7, s[8:11], s39 offen
s_add_u32 s36, s36, 16
s_cmp_lt_u32 s36, 48
s_cbranch_scc1 Lfin_597
Lfin_600:
s_add_u32 s48, s36, 1
Lbw_601:
buffer_load_dword v3, v2, s[4:7], s47 offen sc1
s_waitcnt vmcnt(0)
v_cmp_gt_u32 vcc, s48, v3
s_cbranch_vccz Lbo_602
s_sub_u32 s37, s37, 1
s_cbranch_scc1 Lend_7
s_sleep 4
s_branch Lbw_601
Lbo_602:
s_lshl_b32 s49, s36, 16
s_add_u32 s39, s49, 134217728
buffer_load_dwordx4 v[64:67], v6, s[4:7], s39 offen sc1
s_add_u32 s39, s49, 138412032
buffer_load_dwordx4 v[68:71], v6, s[4:7], s39 offen sc1
s_add_u32 s39, s49, 142606336
buffer_load_dwordx4 v[72:75], v6, s[4:7], s39 offen sc1
s_add_u32 s39, s49, 146800640
buffer_load_dwordx4 v[76:79], v6, s[4:7], s39 offen sc1
s_add_u32 s39, s49, 150994944
buffer_load_dwordx4 v[80:83], v6, s[4:7], s39 offen sc1
s_add_u32 s39, s49, 155189248
buffer_load_dwordx4 v[84:87], v6, s[4:7], s39 offen sc1
s_add_u32 s39, s49, 159383552
buffer_load_dwordx4 v[88:91], v6, s[4:7], s39 offen sc1
s_add_u32 s39, s49, 12582912
buffer_load_dwordx4 v[92:95], v6, s[4:7], s39 offen sc1
s_waitcnt vmcnt(0)
v_dot2_f32_bf16 v24, v64, s60, 0
v_dot2_f32_bf16 v25, v64, s61, 0
v_dot2_f32_bf16 v26, v65, s60, 0
v_dot2_f32_bf16 v27, v65, s61, 0
v_dot2_f32_bf16 v28, v66, s60, 0
v_dot2_f32_bf16 v29, v66, s61, 0
v_dot2_f32_bf16 v30, v67, s60, 0
v_dot2_f32_bf16 v31, v67, s61, 0
v_dot2_f32_bf16 v24, v68, s60, v24
v_dot2_f32_bf16 v25, v68, s61, v25
v_dot2_f32_bf16 v26, v69, s60, v26
v_dot2_f32_bf16 v27, v69, s61, v27
v_dot2_f32_bf16 v28, v70, s60, v28
v_dot2_f32_bf16 v29, v70, s61, v29
v_dot2_f32_bf16 v30, v71, s60, v30
v_dot2_f32_bf16 v31, v71, s61, v31
v_dot2_f32_bf16 v24, v72, s60, v24
v_dot2_f32_bf16 v25, v72, s61, v25
v_dot2_f32_bf16 v26, v73, s60, v26
v_dot2_f32_bf16 v27, v73, s61, v27
v_dot2_f32_bf16 v28, v74, s60, v28
v_dot2_f32_bf16 v29, v74, s61, v29
v_dot2_f32_bf16 v30, v75, s60, v30
v_dot2_f32_bf16 v31, v75, s61, v31
v_dot2_f32_bf16 v24, v76, s60, v24
v_dot2_f32_bf16 v25, v76, s61, v25
v_dot2_f32_bf16 v26, v77, s60, v26
v_dot2_f32_bf16 v27, v77, s61, v27
v_dot2_f32_bf16 v28, v78, s60, v28
v_dot2_f32_bf16 v29, v78, s61, v29
v_dot2_f32_bf16 v30, v79, s60, v30
v_dot2_f32_bf16 v31, v79, s61, v31
v_dot2_f32_bf16 v24, v80, s60, v24
v_dot2_f32_bf16 v25, v80, s61, v25
v_dot2_f32_bf16 v26, v81, s60, v26
v_dot2_f32_bf16 v27, v81, s61, v27
v_dot2_f32_bf16 v28, v82, s60, v28
v_dot2_f32_bf16 v29, v82, s61, v29
v_dot2_f32_bf16 v30, v83, s60, v30
v_dot2_f32_bf16 v31, v83, s61, v31
v_dot2_f32_bf16 v24, v84, s60, v24
v_dot2_f32_bf16 v25, v84, s61, v25
v_dot2_f32_bf16 v26, v85, s60, v26
v_dot2_f32_bf16 v27, v85, s61, v27
v_dot2_f32_bf16 v28, v86, s60, v28
v_dot2_f32_bf16 v29, v86, s61, v29
v_dot2_f32_bf16 v30, v87, s60, v30
v_dot2_f32_bf16 v31, v87, s61, v31
v_dot2_f32_bf16 v24, v88, s60, v24
v_dot2_f32_bf16 v25, v88, s61, v25
v_dot2_f32_bf16 v26, v89, s60, v26
v_dot2_f32_bf16 v27, v89, s61, v27
v_dot2_f32_bf16 v28, v90, s60, v28
v_dot2_f32_bf16 v29, v90, s61, v29
v_dot2_f32_bf16 v30, v91, s60, v30
v_dot2_f32_bf16 v31, v91, s61, v31
v_lshlrev_b32 v32, 16, v92
v_and_b32 v33, 0xffff0000, v92
v_lshlrev_b32 v34, 16, v93
v_and_b32 v35, 0xffff0000, v93
v_lshlrev_b32 v36, 16, v94
v_and_b32 v37, 0xffff0000, v94
v_lshlrev_b32 v38, 16, v95
v_and_b32 v39, 0xffff0000, v95
v_pk_fma_f32 v[32:33], v[24:25], v[16:17], v[32:33]
v_pk_fma_f32 v[34:35], v[26:27], v[18:19], v[34:35]
v_pk_fma_f32 v[36:37], v[28:29], v[20:21], v[36:37]
v_pk_fma_f32 v[38:39], v[30:31], v[22:23], v[38:39]
v_cvt_pk_bf16_f32 v40, v32, v33
v_cvt_pk_bf16_f32 v41, v34, v35
v_cvt_pk_bf16_f32 v42, v36, v37
v_cvt_pk_bf16_f32 v43, v38, v39
s_add_u32 s39, s49, 0
buffer_store_dwordx4 v[40:43], v7, s[8:11], s39 offen
s_add_u32 s36, s36, 4
s_cmp_lt_u32 s36, 64
s_cbranch_scc1 Lfin_600
s_endpgm
Lend_7:
s_endpgm
Lhelper_5:
v_mov_b32 v9, v1
s_sub_u32 s52, s33, 4
s_lshl_b32 s26, s34, 2
s_add_u32 s26, s26, s52
s_sub_u32 s26, s26, 64
s_mul_i32 s44, s52, 14
s_add_u32 s44, s44, s34
s_sub_u32 s44, s44, 16
s_lshl_b32 s53, s52, 1
s_add_u32 s53, s53, s34
s_add_u32 s53, s53, 26
s_cmp_ge_u32 s34, 30
s_cselect_b32 s44, s53, s44
s_load_dwordx2 s[16:17], s[0:1], 96
s_load_dwordx2 s[18:19], s[0:1], 88
s_load_dwordx2 s[20:21], s[0:1], 0
s_lshl_b32 s38, s26, 7
s_add_u32 s38, s38, 3424256
v_min_u32 v80, 1, v0
v_lshl_add_u32 v10, v80, 30, s38
s_lshl_b32 s38, s44, 7
s_add_u32 s38, s38, 3416064
v_min_u32 v80, 1, v0
v_lshl_add_u32 v8, v80, 30, s38
v_mov_b32 v14, 0
v_mov_b32 v15, 0
buffer_store_dword v14, v10, s[4:7], 0 offen sc1
buffer_store_dwordx2 v[14:15], v8, s[4:7], 0 offen sc1
s_waitcnt lgkmcnt(0)
s_mov_b32 s8, s16
s_and_b32 s9, s17, 0xffff
s_mov_b32 s10, 0xc00000
s_mov_b32 s11, 0x20000
s_mov_b32 s84, s18
s_and_b32 s85, s19, 0xffff
s_mov_b32 s86, 0x800
s_mov_b32 s87, 0x20000
s_mov_b32 s88, s20
s_and_b32 s89, s21, 0xffff
s_mov_b32 s90, 0x400000
s_mov_b32 s91, 0x20000
v_lshrrev_b32 v2, 2, v0
v_and_b32 v3, 3, v0
v_mul_u32_u24 v4, 12288, v2
v_lshl_add_u32 v4, v3, 4, v4
v_lshlrev_b32 v5, 1, v2
s_lshl_b32 s40, s26, 6
buffer_load_ushort v80, v5, s[84:87], 0 offen offset:0
buffer_load_ushort v81, v5, s[84:87], 0 offen offset:128
buffer_load_ushort v82, v5, s[84:87], 0 offen offset:256
buffer_load_ushort v83, v5, s[84:87], 0 offen offset:384
buffer_load_ushort v84, v5, s[84:87], 0 offen offset:512
buffer_load_ushort v85, v5, s[84:87], 0 offen offset:640
buffer_load_ushort v86, v5, s[84:87], 0 offen offset:768
buffer_load_ushort v87, v5, s[84:87], 0 offen offset:896
buffer_load_ushort v88, v5, s[84:87], 0 offen offset:1024
buffer_load_ushort v89, v5, s[84:87], 0 offen offset:1152
buffer_load_ushort v90, v5, s[84:87], 0 offen offset:1280
buffer_load_ushort v91, v5, s[84:87], 0 offen offset:1408
buffer_load_ushort v92, v5, s[84:87], 0 offen offset:1536
buffer_load_ushort v93, v5, s[84:87], 0 offen offset:1664
buffer_load_ushort v94, v5, s[84:87], 0 offen offset:1792
buffer_load_ushort v95, v5, s[84:87], 0 offen offset:1920
buffer_load_dwordx4 v[16:19], v4, s[8:11], s40 offen
s_add_u32 s40, s40, 786432
buffer_load_dwordx4 v[20:23], v4, s[8:11], s40 offen
s_add_u32 s40, s40, 786432
buffer_load_dwordx4 v[24:27], v4, s[8:11], s40 offen
s_add_u32 s40, s40, 786432
buffer_load_dwordx4 v[28:31], v4, s[8:11], s40 offen
s_add_u32 s40, s40, 786432
buffer_load_dwordx4 v[32:35], v4, s[8:11], s40 offen
s_add_u32 s40, s40, 786432
buffer_load_dwordx4 v[36:39], v4, s[8:11], s40 offen
s_add_u32 s40, s40, 786432
buffer_load_dwordx4 v[40:43], v4, s[8:11], s40 offen
s_add_u32 s40, s40, 786432
buffer_load_dwordx4 v[44:47], v4, s[8:11], s40 offen
s_add_u32 s40, s40, 786432
buffer_load_dwordx4 v[48:51], v4, s[8:11], s40 offen
s_add_u32 s40, s40, 786432
buffer_load_dwordx4 v[52:55], v4, s[8:11], s40 offen
s_add_u32 s40, s40, 786432
buffer_load_dwordx4 v[56:59], v4, s[8:11], s40 offen
s_add_u32 s40, s40, 786432
buffer_load_dwordx4 v[60:63], v4, s[8:11], s40 offen
s_add_u32 s40, s40, 786432
buffer_load_dwordx4 v[64:67], v4, s[8:11], s40 offen
s_add_u32 s40, s40, 786432
buffer_load_dwordx4 v[68:71], v4, s[8:11], s40 offen
s_add_u32 s40, s40, 786432
buffer_load_dwordx4 v[72:75], v4, s[8:11], s40 offen
s_add_u32 s40, s40, 786432
buffer_load_dwordx4 v[76:79], v4, s[8:11], s40 offen
s_add_u32 s40, s40, 786432
v_mov_b32 v96, 0
v_mov_b32 v97, 0
v_mov_b32 v98, 0
v_mov_b32 v99, 0
v_mov_b32 v100, 0
v_mov_b32 v101, 0
v_mov_b32 v102, 0
v_mov_b32 v103, 0
s_waitcnt vmcnt(16)
v_lshlrev_b32 v80, 16, v80
v_mul_f32 v104, 0xbfb8aa3b, v80
v_exp_f32 v104, v104
s_nop 0
v_add_f32 v104, 1.0, v104
v_rcp_f32 v104, v104
s_nop 0
v_mul_f32 v104, v104, v80
v_cvt_pk_bf16_f32 v104, 0, v104
v_and_b32 v80, 0xffff0000, v104
v_lshlrev_b32 v81, 16, v81
v_mul_f32 v104, 0xbfb8aa3b, v81
v_exp_f32 v104, v104
s_nop 0
v_add_f32 v104, 1.0, v104
v_rcp_f32 v104, v104
s_nop 0
v_mul_f32 v104, v104, v81
v_cvt_pk_bf16_f32 v104, 0, v104
v_and_b32 v81, 0xffff0000, v104
v_lshlrev_b32 v82, 16, v82
v_mul_f32 v104, 0xbfb8aa3b, v82
v_exp_f32 v104, v104
s_nop 0
v_add_f32 v104, 1.0, v104
v_rcp_f32 v104, v104
s_nop 0
v_mul_f32 v104, v104, v82
v_cvt_pk_bf16_f32 v104, 0, v104
v_and_b32 v82, 0xffff0000, v104
v_lshlrev_b32 v83, 16, v83
v_mul_f32 v104, 0xbfb8aa3b, v83
v_exp_f32 v104, v104
s_nop 0
v_add_f32 v104, 1.0, v104
v_rcp_f32 v104, v104
s_nop 0
v_mul_f32 v104, v104, v83
v_cvt_pk_bf16_f32 v104, 0, v104
v_and_b32 v83, 0xffff0000, v104
v_lshlrev_b32 v84, 16, v84
v_mul_f32 v104, 0xbfb8aa3b, v84
v_exp_f32 v104, v104
s_nop 0
v_add_f32 v104, 1.0, v104
v_rcp_f32 v104, v104
s_nop 0
v_mul_f32 v104, v104, v84
v_cvt_pk_bf16_f32 v104, 0, v104
v_and_b32 v84, 0xffff0000, v104
v_lshlrev_b32 v85, 16, v85
v_mul_f32 v104, 0xbfb8aa3b, v85
v_exp_f32 v104, v104
s_nop 0
v_add_f32 v104, 1.0, v104
v_rcp_f32 v104, v104
s_nop 0
v_mul_f32 v104, v104, v85
v_cvt_pk_bf16_f32 v104, 0, v104
v_and_b32 v85, 0xffff0000, v104
v_lshlrev_b32 v86, 16, v86
v_mul_f32 v104, 0xbfb8aa3b, v86
v_exp_f32 v104, v104
s_nop 0
v_add_f32 v104, 1.0, v104
v_rcp_f32 v104, v104
s_nop 0
v_mul_f32 v104, v104, v86
v_cvt_pk_bf16_f32 v104, 0, v104
v_and_b32 v86, 0xffff0000, v104
v_lshlrev_b32 v87, 16, v87
v_mul_f32 v104, 0xbfb8aa3b, v87
v_exp_f32 v104, v104
s_nop 0
v_add_f32 v104, 1.0, v104
v_rcp_f32 v104, v104
s_nop 0
v_mul_f32 v104, v104, v87
v_cvt_pk_bf16_f32 v104, 0, v104
v_and_b32 v87, 0xffff0000, v104
v_lshlrev_b32 v88, 16, v88
v_mul_f32 v104, 0xbfb8aa3b, v88
v_exp_f32 v104, v104
s_nop 0
v_add_f32 v104, 1.0, v104
v_rcp_f32 v104, v104
s_nop 0
v_mul_f32 v104, v104, v88
v_cvt_pk_bf16_f32 v104, 0, v104
v_and_b32 v88, 0xffff0000, v104
v_lshlrev_b32 v89, 16, v89
v_mul_f32 v104, 0xbfb8aa3b, v89
v_exp_f32 v104, v104
s_nop 0
v_add_f32 v104, 1.0, v104
v_rcp_f32 v104, v104
s_nop 0
v_mul_f32 v104, v104, v89
v_cvt_pk_bf16_f32 v104, 0, v104
v_and_b32 v89, 0xffff0000, v104
v_lshlrev_b32 v90, 16, v90
v_mul_f32 v104, 0xbfb8aa3b, v90
v_exp_f32 v104, v104
s_nop 0
v_add_f32 v104, 1.0, v104
v_rcp_f32 v104, v104
s_nop 0
v_mul_f32 v104, v104, v90
v_cvt_pk_bf16_f32 v104, 0, v104
v_and_b32 v90, 0xffff0000, v104
v_lshlrev_b32 v91, 16, v91
v_mul_f32 v104, 0xbfb8aa3b, v91
v_exp_f32 v104, v104
s_nop 0
v_add_f32 v104, 1.0, v104
v_rcp_f32 v104, v104
s_nop 0
v_mul_f32 v104, v104, v91
v_cvt_pk_bf16_f32 v104, 0, v104
v_and_b32 v91, 0xffff0000, v104
v_lshlrev_b32 v92, 16, v92
v_mul_f32 v104, 0xbfb8aa3b, v92
v_exp_f32 v104, v104
s_nop 0
v_add_f32 v104, 1.0, v104
v_rcp_f32 v104, v104
s_nop 0
v_mul_f32 v104, v104, v92
v_cvt_pk_bf16_f32 v104, 0, v104
v_and_b32 v92, 0xffff0000, v104
v_lshlrev_b32 v93, 16, v93
v_mul_f32 v104, 0xbfb8aa3b, v93
v_exp_f32 v104, v104
s_nop 0
v_add_f32 v104, 1.0, v104
v_rcp_f32 v104, v104
s_nop 0
v_mul_f32 v104, v104, v93
v_cvt_pk_bf16_f32 v104, 0, v104
v_and_b32 v93, 0xffff0000, v104
v_lshlrev_b32 v94, 16, v94
v_mul_f32 v104, 0xbfb8aa3b, v94
v_exp_f32 v104, v104
s_nop 0
v_add_f32 v104, 1.0, v104
v_rcp_f32 v104, v104
s_nop 0
v_mul_f32 v104, v104, v94
v_cvt_pk_bf16_f32 v104, 0, v104
v_and_b32 v94, 0xffff0000, v104
v_lshlrev_b32 v95, 16, v95
v_mul_f32 v104, 0xbfb8aa3b, v95
v_exp_f32 v104, v104
s_nop 0
v_add_f32 v104, 1.0, v104
v_rcp_f32 v104, v104
s_nop 0
v_mul_f32 v104, v104, v95
v_cvt_pk_bf16_f32 v104, 0, v104
v_and_b32 v95, 0xffff0000, v104
s_cmp_lg_u32 s32, 0
s_cbranch_scc1 Lea_603
s_mov_b64 exec, 1
v_mov_b32 v14, 32
v_mov_b32 v15, 1
buffer_atomic_add v15, v14, s[12:15], 0 offen sc1
s_mov_b64 exec, -1
s_waitcnt vmcnt(1)
Lea_603:
s_waitcnt vmcnt(15)
v_lshlrev_b32 v104, 16, v16
v_and_b32 v105, 0xffff0000, v16
v_fmac_f32 v96, v104, v80
v_fmac_f32 v97, v105, v80
v_lshlrev_b32 v104, 16, v17
v_and_b32 v105, 0xffff0000, v17
v_fmac_f32 v98, v104, v80
v_fmac_f32 v99, v105, v80
v_lshlrev_b32 v104, 16, v18
v_and_b32 v105, 0xffff0000, v18
v_fmac_f32 v100, v104, v80
v_fmac_f32 v101, v105, v80
v_lshlrev_b32 v104, 16, v19
v_and_b32 v105, 0xffff0000, v19
v_fmac_f32 v102, v104, v80
v_fmac_f32 v103, v105, v80
s_waitcnt vmcnt(14)
v_lshlrev_b32 v104, 16, v20
v_and_b32 v105, 0xffff0000, v20
v_fmac_f32 v96, v104, v81
v_fmac_f32 v97, v105, v81
v_lshlrev_b32 v104, 16, v21
v_and_b32 v105, 0xffff0000, v21
v_fmac_f32 v98, v104, v81
v_fmac_f32 v99, v105, v81
v_lshlrev_b32 v104, 16, v22
v_and_b32 v105, 0xffff0000, v22
v_fmac_f32 v100, v104, v81
v_fmac_f32 v101, v105, v81
v_lshlrev_b32 v104, 16, v23
v_and_b32 v105, 0xffff0000, v23
v_fmac_f32 v102, v104, v81
v_fmac_f32 v103, v105, v81
s_waitcnt vmcnt(13)
v_lshlrev_b32 v104, 16, v24
v_and_b32 v105, 0xffff0000, v24
v_fmac_f32 v96, v104, v82
v_fmac_f32 v97, v105, v82
v_lshlrev_b32 v104, 16, v25
v_and_b32 v105, 0xffff0000, v25
v_fmac_f32 v98, v104, v82
v_fmac_f32 v99, v105, v82
v_lshlrev_b32 v104, 16, v26
v_and_b32 v105, 0xffff0000, v26
v_fmac_f32 v100, v104, v82
v_fmac_f32 v101, v105, v82
v_lshlrev_b32 v104, 16, v27
v_and_b32 v105, 0xffff0000, v27
v_fmac_f32 v102, v104, v82
v_fmac_f32 v103, v105, v82
s_waitcnt vmcnt(12)
v_lshlrev_b32 v104, 16, v28
v_and_b32 v105, 0xffff0000, v28
v_fmac_f32 v96, v104, v83
v_fmac_f32 v97, v105, v83
v_lshlrev_b32 v104, 16, v29
v_and_b32 v105, 0xffff0000, v29
v_fmac_f32 v98, v104, v83
v_fmac_f32 v99, v105, v83
v_lshlrev_b32 v104, 16, v30
v_and_b32 v105, 0xffff0000, v30
v_fmac_f32 v100, v104, v83
v_fmac_f32 v101, v105, v83
v_lshlrev_b32 v104, 16, v31
v_and_b32 v105, 0xffff0000, v31
v_fmac_f32 v102, v104, v83
v_fmac_f32 v103, v105, v83
s_waitcnt vmcnt(11)
v_lshlrev_b32 v104, 16, v32
v_and_b32 v105, 0xffff0000, v32
v_fmac_f32 v96, v104, v84
v_fmac_f32 v97, v105, v84
v_lshlrev_b32 v104, 16, v33
v_and_b32 v105, 0xffff0000, v33
v_fmac_f32 v98, v104, v84
v_fmac_f32 v99, v105, v84
v_lshlrev_b32 v104, 16, v34
v_and_b32 v105, 0xffff0000, v34
v_fmac_f32 v100, v104, v84
v_fmac_f32 v101, v105, v84
v_lshlrev_b32 v104, 16, v35
v_and_b32 v105, 0xffff0000, v35
v_fmac_f32 v102, v104, v84
v_fmac_f32 v103, v105, v84
s_waitcnt vmcnt(10)
v_lshlrev_b32 v104, 16, v36
v_and_b32 v105, 0xffff0000, v36
v_fmac_f32 v96, v104, v85
v_fmac_f32 v97, v105, v85
v_lshlrev_b32 v104, 16, v37
v_and_b32 v105, 0xffff0000, v37
v_fmac_f32 v98, v104, v85
v_fmac_f32 v99, v105, v85
v_lshlrev_b32 v104, 16, v38
v_and_b32 v105, 0xffff0000, v38
v_fmac_f32 v100, v104, v85
v_fmac_f32 v101, v105, v85
v_lshlrev_b32 v104, 16, v39
v_and_b32 v105, 0xffff0000, v39
v_fmac_f32 v102, v104, v85
v_fmac_f32 v103, v105, v85
s_waitcnt vmcnt(9)
v_lshlrev_b32 v104, 16, v40
v_and_b32 v105, 0xffff0000, v40
v_fmac_f32 v96, v104, v86
v_fmac_f32 v97, v105, v86
v_lshlrev_b32 v104, 16, v41
v_and_b32 v105, 0xffff0000, v41
v_fmac_f32 v98, v104, v86
v_fmac_f32 v99, v105, v86
v_lshlrev_b32 v104, 16, v42
v_and_b32 v105, 0xffff0000, v42
v_fmac_f32 v100, v104, v86
v_fmac_f32 v101, v105, v86
v_lshlrev_b32 v104, 16, v43
v_and_b32 v105, 0xffff0000, v43
v_fmac_f32 v102, v104, v86
v_fmac_f32 v103, v105, v86
s_waitcnt vmcnt(8)
v_lshlrev_b32 v104, 16, v44
v_and_b32 v105, 0xffff0000, v44
v_fmac_f32 v96, v104, v87
v_fmac_f32 v97, v105, v87
v_lshlrev_b32 v104, 16, v45
v_and_b32 v105, 0xffff0000, v45
v_fmac_f32 v98, v104, v87
v_fmac_f32 v99, v105, v87
v_lshlrev_b32 v104, 16, v46
v_and_b32 v105, 0xffff0000, v46
v_fmac_f32 v100, v104, v87
v_fmac_f32 v101, v105, v87
v_lshlrev_b32 v104, 16, v47
v_and_b32 v105, 0xffff0000, v47
v_fmac_f32 v102, v104, v87
v_fmac_f32 v103, v105, v87
s_waitcnt vmcnt(7)
v_lshlrev_b32 v104, 16, v48
v_and_b32 v105, 0xffff0000, v48
v_fmac_f32 v96, v104, v88
v_fmac_f32 v97, v105, v88
v_lshlrev_b32 v104, 16, v49
v_and_b32 v105, 0xffff0000, v49
v_fmac_f32 v98, v104, v88
v_fmac_f32 v99, v105, v88
v_lshlrev_b32 v104, 16, v50
v_and_b32 v105, 0xffff0000, v50
v_fmac_f32 v100, v104, v88
v_fmac_f32 v101, v105, v88
v_lshlrev_b32 v104, 16, v51
v_and_b32 v105, 0xffff0000, v51
v_fmac_f32 v102, v104, v88
v_fmac_f32 v103, v105, v88
s_waitcnt vmcnt(6)
v_lshlrev_b32 v104, 16, v52
v_and_b32 v105, 0xffff0000, v52
v_fmac_f32 v96, v104, v89
v_fmac_f32 v97, v105, v89
v_lshlrev_b32 v104, 16, v53
v_and_b32 v105, 0xffff0000, v53
v_fmac_f32 v98, v104, v89
v_fmac_f32 v99, v105, v89
v_lshlrev_b32 v104, 16, v54
v_and_b32 v105, 0xffff0000, v54
v_fmac_f32 v100, v104, v89
v_fmac_f32 v101, v105, v89
v_lshlrev_b32 v104, 16, v55
v_and_b32 v105, 0xffff0000, v55
v_fmac_f32 v102, v104, v89
v_fmac_f32 v103, v105, v89
s_waitcnt vmcnt(5)
v_lshlrev_b32 v104, 16, v56
v_and_b32 v105, 0xffff0000, v56
v_fmac_f32 v96, v104, v90
v_fmac_f32 v97, v105, v90
v_lshlrev_b32 v104, 16, v57
v_and_b32 v105, 0xffff0000, v57
v_fmac_f32 v98, v104, v90
v_fmac_f32 v99, v105, v90
v_lshlrev_b32 v104, 16, v58
v_and_b32 v105, 0xffff0000, v58
v_fmac_f32 v100, v104, v90
v_fmac_f32 v101, v105, v90
v_lshlrev_b32 v104, 16, v59
v_and_b32 v105, 0xffff0000, v59
v_fmac_f32 v102, v104, v90
v_fmac_f32 v103, v105, v90
s_waitcnt vmcnt(4)
v_lshlrev_b32 v104, 16, v60
v_and_b32 v105, 0xffff0000, v60
v_fmac_f32 v96, v104, v91
v_fmac_f32 v97, v105, v91
v_lshlrev_b32 v104, 16, v61
v_and_b32 v105, 0xffff0000, v61
v_fmac_f32 v98, v104, v91
v_fmac_f32 v99, v105, v91
v_lshlrev_b32 v104, 16, v62
v_and_b32 v105, 0xffff0000, v62
v_fmac_f32 v100, v104, v91
v_fmac_f32 v101, v105, v91
v_lshlrev_b32 v104, 16, v63
v_and_b32 v105, 0xffff0000, v63
v_fmac_f32 v102, v104, v91
v_fmac_f32 v103, v105, v91
s_waitcnt vmcnt(3)
v_lshlrev_b32 v104, 16, v64
v_and_b32 v105, 0xffff0000, v64
v_fmac_f32 v96, v104, v92
v_fmac_f32 v97, v105, v92
v_lshlrev_b32 v104, 16, v65
v_and_b32 v105, 0xffff0000, v65
v_fmac_f32 v98, v104, v92
v_fmac_f32 v99, v105, v92
v_lshlrev_b32 v104, 16, v66
v_and_b32 v105, 0xffff0000, v66
v_fmac_f32 v100, v104, v92
v_fmac_f32 v101, v105, v92
v_lshlrev_b32 v104, 16, v67
v_and_b32 v105, 0xffff0000, v67
v_fmac_f32 v102, v104, v92
v_fmac_f32 v103, v105, v92
s_waitcnt vmcnt(2)
v_lshlrev_b32 v104, 16, v68
v_and_b32 v105, 0xffff0000, v68
v_fmac_f32 v96, v104, v93
v_fmac_f32 v97, v105, v93
v_lshlrev_b32 v104, 16, v69
v_and_b32 v105, 0xffff0000, v69
v_fmac_f32 v98, v104, v93
v_fmac_f32 v99, v105, v93
v_lshlrev_b32 v104, 16, v70
v_and_b32 v105, 0xffff0000, v70
v_fmac_f32 v100, v104, v93
v_fmac_f32 v101, v105, v93
v_lshlrev_b32 v104, 16, v71
v_and_b32 v105, 0xffff0000, v71
v_fmac_f32 v102, v104, v93
v_fmac_f32 v103, v105, v93
s_waitcnt vmcnt(1)
v_lshlrev_b32 v104, 16, v72
v_and_b32 v105, 0xffff0000, v72
v_fmac_f32 v96, v104, v94
v_fmac_f32 v97, v105, v94
v_lshlrev_b32 v104, 16, v73
v_and_b32 v105, 0xffff0000, v73
v_fmac_f32 v98, v104, v94
v_fmac_f32 v99, v105, v94
v_lshlrev_b32 v104, 16, v74
v_and_b32 v105, 0xffff0000, v74
v_fmac_f32 v100, v104, v94
v_fmac_f32 v101, v105, v94
v_lshlrev_b32 v104, 16, v75
v_and_b32 v105, 0xffff0000, v75
v_fmac_f32 v102, v104, v94
v_fmac_f32 v103, v105, v94
s_waitcnt vmcnt(0)
v_lshlrev_b32 v104, 16, v76
v_and_b32 v105, 0xffff0000, v76
v_fmac_f32 v96, v104, v95
v_fmac_f32 v97, v105, v95
v_lshlrev_b32 v104, 16, v77
v_and_b32 v105, 0xffff0000, v77
v_fmac_f32 v98, v104, v95
v_fmac_f32 v99, v105, v95
v_lshlrev_b32 v104, 16, v78
v_and_b32 v105, 0xffff0000, v78
v_fmac_f32 v100, v104, v95
v_fmac_f32 v101, v105, v95
v_lshlrev_b32 v104, 16, v79
v_and_b32 v105, 0xffff0000, v79
v_fmac_f32 v102, v104, v95
v_fmac_f32 v103, v105, v95
s_nop 1
v_add_f32_dpp v96, v96, v96 row_ror:4 row_mask:0xf bank_mask:0xf
s_nop 1
v_add_f32_dpp v96, v96, v96 row_ror:8 row_mask:0xf bank_mask:0xf
v_mov_b32 v104, v96
s_nop 1
v_permlane16_swap_b32 v96, v104
s_nop 0
v_add_f32 v96, v96, v104
v_mov_b32 v104, v96
s_nop 1
v_permlane32_swap_b32 v96, v104
s_nop 0
v_add_f32 v96, v96, v104
s_nop 1
v_add_f32_dpp v97, v97, v97 row_ror:4 row_mask:0xf bank_mask:0xf
s_nop 1
v_add_f32_dpp v97, v97, v97 row_ror:8 row_mask:0xf bank_mask:0xf
v_mov_b32 v104, v97
s_nop 1
v_permlane16_swap_b32 v97, v104
s_nop 0
v_add_f32 v97, v97, v104
v_mov_b32 v104, v97
s_nop 1
v_permlane32_swap_b32 v97, v104
s_nop 0
v_add_f32 v97, v97, v104
s_nop 1
v_add_f32_dpp v98, v98, v98 row_ror:4 row_mask:0xf bank_mask:0xf
s_nop 1
v_add_f32_dpp v98, v98, v98 row_ror:8 row_mask:0xf bank_mask:0xf
v_mov_b32 v104, v98
s_nop 1
v_permlane16_swap_b32 v98, v104
s_nop 0
v_add_f32 v98, v98, v104
v_mov_b32 v104, v98
s_nop 1
v_permlane32_swap_b32 v98, v104
s_nop 0
v_add_f32 v98, v98, v104
s_nop 1
v_add_f32_dpp v99, v99, v99 row_ror:4 row_mask:0xf bank_mask:0xf
s_nop 1
v_add_f32_dpp v99, v99, v99 row_ror:8 row_mask:0xf bank_mask:0xf
v_mov_b32 v104, v99
s_nop 1
v_permlane16_swap_b32 v99, v104
s_nop 0
v_add_f32 v99, v99, v104
v_mov_b32 v104, v99
s_nop 1
v_permlane32_swap_b32 v99, v104
s_nop 0
v_add_f32 v99, v99, v104
s_nop 1
v_add_f32_dpp v100, v100, v100 row_ror:4 row_mask:0xf bank_mask:0xf
s_nop 1
v_add_f32_dpp v100, v100, v100 row_ror:8 row_mask:0xf bank_mask:0xf
v_mov_b32 v104, v100
s_nop 1
v_permlane16_swap_b32 v100, v104
s_nop 0
v_add_f32 v100, v100, v104
v_mov_b32 v104, v100
s_nop 1
v_permlane32_swap_b32 v100, v104
s_nop 0
v_add_f32 v100, v100, v104
s_nop 1
v_add_f32_dpp v101, v101, v101 row_ror:4 row_mask:0xf bank_mask:0xf
s_nop 1
v_add_f32_dpp v101, v101, v101 row_ror:8 row_mask:0xf bank_mask:0xf
v_mov_b32 v104, v101
s_nop 1
v_permlane16_swap_b32 v101, v104
s_nop 0
v_add_f32 v101, v101, v104
v_mov_b32 v104, v101
s_nop 1
v_permlane32_swap_b32 v101, v104
s_nop 0
v_add_f32 v101, v101, v104
s_nop 1
v_add_f32_dpp v102, v102, v102 row_ror:4 row_mask:0xf bank_mask:0xf
s_nop 1
v_add_f32_dpp v102, v102, v102 row_ror:8 row_mask:0xf bank_mask:0xf
v_mov_b32 v104, v102
s_nop 1
v_permlane16_swap_b32 v102, v104
s_nop 0
v_add_f32 v102, v102, v104
v_mov_b32 v104, v102
s_nop 1
v_permlane32_swap_b32 v102, v104
s_nop 0
v_add_f32 v102, v102, v104
s_nop 1
v_add_f32_dpp v103, v103, v103 row_ror:4 row_mask:0xf bank_mask:0xf
s_nop 1
v_add_f32_dpp v103, v103, v103 row_ror:8 row_mask:0xf bank_mask:0xf
v_mov_b32 v104, v103
s_nop 1
v_permlane16_swap_b32 v103, v104
s_nop 0
v_add_f32 v103, v103, v104
v_mov_b32 v104, v103
s_nop 1
v_permlane32_swap_b32 v103, v104
s_nop 0
v_add_f32 v103, v103, v104
s_lshl_b32 s40, s32, 7
v_lshl_add_u32 v4, v3, 5, s40
ds_write_b128 v4, v[96:99]
ds_write_b128 v4, v[100:103] offset:16
s_waitcnt lgkmcnt(0)
s_barrier
v_and_b32 v4, 31, v0
v_lshlrev_b32 v4, 2, v4
ds_read_b32 v96, v4 offset:0
ds_read_b32 v97, v4 offset:128
ds_read_b32 v98, v4 offset:256
ds_read_b32 v99, v4 offset:384
v_lshrrev_b32 v5, 5, v0
v_min_u32 v5, 1, v5
v_lshl_add_u32 v4, v5, 30, v4
s_lshl_b32 s40, s26, 7
s_add_u32 s40, s40, 3145728
s_waitcnt lgkmcnt(0)
v_add_f32 v96, v96, v97
v_add_f32 v98, v98, v99
v_add_f32 v96, v96, v98
v_cvt_pk_bf16_f32 v96, 0, v96
v_and_b32 v96, 0xffff0000, v96
buffer_store_dword v96, v4, s[4:7], s40 offen sc1
v_mov_b32 v14, 1
s_waitcnt vmcnt(0)
buffer_store_dword v14, v10, s[4:7], 0 offen sc1
v_and_b32 v12, 15, v9
v_lshlrev_b32 v12, 4, v12
s_lshl_b32 s38, s32, 2
v_add_u32 v11, s38, v12
v_lshlrev_b32 v13, 4, v9
v_lshrrev_b32 v7, 4, v9
v_lshlrev_b32 v6, 7, v12
v_lshl_add_u32 v6, v7, 4, v6
v_lshlrev_b32 v7, 5, v7
s_add_u32 s52, s26, 0
s_lshl_b32 s41, s52, 15
s_lshl_b32 s42, s32, 9
s_add_u32 s41, s41, s42
buffer_load_dwordx4 v[16:19], v6, s[88:91], s41 offen offset:0
buffer_load_dwordx4 v[20:23], v6, s[88:91], s41 offen offset:64
buffer_load_dwordx4 v[24:27], v6, s[88:91], s41 offen offset:128
buffer_load_dwordx4 v[28:31], v6, s[88:91], s41 offen offset:192
buffer_load_dwordx4 v[32:35], v6, s[88:91], s41 offen offset:256
buffer_load_dwordx4 v[36:39], v6, s[88:91], s41 offen offset:320
buffer_load_dwordx4 v[40:43], v6, s[88:91], s41 offen offset:384
buffer_load_dwordx4 v[44:47], v6, s[88:91], s41 offen offset:448
s_lshr_b32 s40, s52, 1
s_lshl_b32 s40, s40, 2
s_add_u32 s40, s40, s32
s_lshl_b32 s40, s40, 14
s_and_b32 s41, s52, 1
s_lshl_b32 s41, s41, 10
s_add_u32 s40, s40, s41
s_waitcnt vmcnt(0)
v_lshlrev_b32 v48, 16, v16
v_and_b32 v49, 0xffff0000, v16
v_lshlrev_b32 v50, 16, v17
v_and_b32 v51, 0xffff0000, v17
v_lshlrev_b32 v52, 16, v18
v_and_b32 v53, 0xffff0000, v18
v_lshlrev_b32 v54, 16, v19
v_and_b32 v55, 0xffff0000, v19
v_lshlrev_b32 v56, 16, v20
v_and_b32 v57, 0xffff0000, v20
v_lshlrev_b32 v58, 16, v21
v_and_b32 v59, 0xffff0000, v21
v_lshlrev_b32 v60, 16, v22
v_and_b32 v61, 0xffff0000, v22
v_lshlrev_b32 v62, 16, v23
v_and_b32 v63, 0xffff0000, v23
v_lshlrev_b32 v64, 16, v24
v_and_b32 v65, 0xffff0000, v24
v_lshlrev_b32 v66, 16, v25
v_and_b32 v67, 0xffff0000, v25
v_lshlrev_b32 v68, 16, v26
v_and_b32 v69, 0xffff0000, v26
v_lshlrev_b32 v70, 16, v27
v_and_b32 v71, 0xffff0000, v27
v_lshlrev_b32 v72, 16, v28
v_and_b32 v73, 0xffff0000, v28
v_lshlrev_b32 v74, 16, v29
v_and_b32 v75, 0xffff0000, v29
v_lshlrev_b32 v76, 16, v30
v_and_b32 v77, 0xffff0000, v30
v_lshlrev_b32 v78, 16, v31
v_and_b32 v79, 0xffff0000, v31
v_lshlrev_b32 v80, 16, v32
v_and_b32 v81, 0xffff0000, v32
v_lshlrev_b32 v82, 16, v33
v_and_b32 v83, 0xffff0000, v33
v_lshlrev_b32 v84, 16, v34
v_and_b32 v85, 0xffff0000, v34
v_lshlrev_b32 v86, 16, v35
v_and_b32 v87, 0xffff0000, v35
v_lshlrev_b32 v88, 16, v36
v_and_b32 v89, 0xffff0000, v36
v_lshlrev_b32 v90, 16, v37
v_and_b32 v91, 0xffff0000, v37
v_lshlrev_b32 v92, 16, v38
v_and_b32 v93, 0xffff0000, v38
v_lshlrev_b32 v94, 16, v39
v_and_b32 v95, 0xffff0000, v39
v_lshlrev_b32 v96, 16, v40
v_and_b32 v97, 0xffff0000, v40
v_lshlrev_b32 v98, 16, v41
v_and_b32 v99, 0xffff0000, v41
v_lshlrev_b32 v100, 16, v42
v_and_b32 v101, 0xffff0000, v42
v_lshlrev_b32 v102, 16, v43
v_and_b32 v103, 0xffff0000, v43
v_lshlrev_b32 v104, 16, v44
v_and_b32 v105, 0xffff0000, v44
v_lshlrev_b32 v106, 16, v45
v_and_b32 v107, 0xffff0000, v45
v_lshlrev_b32 v108, 16, v46
v_and_b32 v109, 0xffff0000, v46
v_lshlrev_b32 v110, 16, v47
v_and_b32 v111, 0xffff0000, v47
v_pk_add_f32 v[240:241], v[48:49], v[50:51]
v_pk_add_f32 v[240:241], v[240:241], v[52:53]
v_pk_add_f32 v[240:241], v[240:241], v[54:55]
v_pk_add_f32 v[240:241], v[240:241], v[56:57]
v_pk_add_f32 v[240:241], v[240:241], v[58:59]
v_pk_add_f32 v[240:241], v[240:241], v[60:61]
v_pk_add_f32 v[240:241], v[240:241], v[62:63]
v_pk_add_f32 v[240:241], v[240:241], v[64:65]
v_pk_add_f32 v[240:241], v[240:241], v[66:67]
v_pk_add_f32 v[240:241], v[240:241], v[68:69]
v_pk_add_f32 v[240:241], v[240:241], v[70:71]
v_pk_add_f32 v[240:241], v[240:241], v[72:73]
v_pk_add_f32 v[240:241], v[240:241], v[74:75]
v_pk_add_f32 v[240:241], v[240:241], v[76:77]
v_pk_add_f32 v[240:241], v[240:241], v[78:79]
v_pk_add_f32 v[240:241], v[240:241], v[80:81]
v_pk_add_f32 v[240:241], v[240:241], v[82:83]
v_pk_add_f32 v[240:241], v[240:241], v[84:85]
v_pk_add_f32 v[240:241], v[240:241], v[86:87]
v_pk_add_f32 v[240:241], v[240:241], v[88:89]
v_pk_add_f32 v[240:241], v[240:241], v[90:91]
v_pk_add_f32 v[240:241], v[240:241], v[92:93]
v_pk_add_f32 v[240:241], v[240:241], v[94:95]
v_pk_add_f32 v[240:241], v[240:241], v[96:97]
v_pk_add_f32 v[240:241], v[240:241], v[98:99]
v_pk_add_f32 v[240:241], v[240:241], v[100:101]
v_pk_add_f32 v[240:241], v[240:241], v[102:103]
v_pk_add_f32 v[240:241], v[240:241], v[104:105]
v_pk_add_f32 v[240:241], v[240:241], v[106:107]
v_pk_add_f32 v[240:241], v[240:241], v[108:109]
v_pk_add_f32 v[240:241], v[240:241], v[110:111]
v_add_f32 v240, v240, v241
v_mov_b32 v241, v240
s_nop 1
v_permlane16_swap_b32 v240, v241
s_nop 0
v_add_f32 v240, v240, v241
v_mov_b32 v241, v240
s_nop 1
v_permlane32_swap_b32 v240, v241
s_nop 0
v_add_f32 v240, v240, v241
ds_write_b32 v11, v240 offset:512
s_waitcnt lgkmcnt(0)
s_barrier
ds_read_b128 v[240:243], v12 offset:512
s_waitcnt lgkmcnt(0)
v_pk_add_f32 v[240:241], v[240:241], v[242:243]
v_add_f32 v240, v240, v241
v_mul_f32 v240, 0x3a800000, v240
v_pk_add_f32 v[48:49], v[48:49], v[240:241] op_sel_hi:[1,0] neg_lo:[0,1] neg_hi:[0,1]
v_pk_add_f32 v[50:51], v[50:51], v[240:241] op_sel_hi:[1,0] neg_lo:[0,1] neg_hi:[0,1]
v_pk_add_f32 v[52:53], v[52:53], v[240:241] op_sel_hi:[1,0] neg_lo:[0,1] neg_hi:[0,1]
v_pk_add_f32 v[54:55], v[54:55], v[240:241] op_sel_hi:[1,0] neg_lo:[0,1] neg_hi:[0,1]
v_pk_add_f32 v[56:57], v[56:57], v[240:241] op_sel_hi:[1,0] neg_lo:[0,1] neg_hi:[0,1]
v_pk_add_f32 v[58:59], v[58:59], v[240:241] op_sel_hi:[1,0] neg_lo:[0,1] neg_hi:[0,1]
v_pk_add_f32 v[60:61], v[60:61], v[240:241] op_sel_hi:[1,0] neg_lo:[0,1] neg_hi:[0,1]
v_pk_add_f32 v[62:63], v[62:63], v[240:241] op_sel_hi:[1,0] neg_lo:[0,1] neg_hi:[0,1]
v_pk_add_f32 v[64:65], v[64:65], v[240:241] op_sel_hi:[1,0] neg_lo:[0,1] neg_hi:[0,1]
v_pk_add_f32 v[66:67], v[66:67], v[240:241] op_sel_hi:[1,0] neg_lo:[0,1] neg_hi:[0,1]
v_pk_add_f32 v[68:69], v[68:69], v[240:241] op_sel_hi:[1,0] neg_lo:[0,1] neg_hi:[0,1]
v_pk_add_f32 v[70:71], v[70:71], v[240:241] op_sel_hi:[1,0] neg_lo:[0,1] neg_hi:[0,1]
v_pk_add_f32 v[72:73], v[72:73], v[240:241] op_sel_hi:[1,0] neg_lo:[0,1] neg_hi:[0,1]
v_pk_add_f32 v[74:75], v[74:75], v[240:241] op_sel_hi:[1,0] neg_lo:[0,1] neg_hi:[0,1]
v_pk_add_f32 v[76:77], v[76:77], v[240:241] op_sel_hi:[1,0] neg_lo:[0,1] neg_hi:[0,1]
v_pk_add_f32 v[78:79], v[78:79], v[240:241] op_sel_hi:[1,0] neg_lo:[0,1] neg_hi:[0,1]
v_pk_add_f32 v[80:81], v[80:81], v[240:241] op_sel_hi:[1,0] neg_lo:[0,1] neg_hi:[0,1]
v_pk_add_f32 v[82:83], v[82:83], v[240:241] op_sel_hi:[1,0] neg_lo:[0,1] neg_hi:[0,1]
v_pk_add_f32 v[84:85], v[84:85], v[240:241] op_sel_hi:[1,0] neg_lo:[0,1] neg_hi:[0,1]
v_pk_add_f32 v[86:87], v[86:87], v[240:241] op_sel_hi:[1,0] neg_lo:[0,1] neg_hi:[0,1]
v_pk_add_f32 v[88:89], v[88:89], v[240:241] op_sel_hi:[1,0] neg_lo:[0,1] neg_hi:[0,1]
v_pk_add_f32 v[90:91], v[90:91], v[240:241] op_sel_hi:[1,0] neg_lo:[0,1] neg_hi:[0,1]
v_pk_add_f32 v[92:93], v[92:93], v[240:241] op_sel_hi:[1,0] neg_lo:[0,1] neg_hi:[0,1]
v_pk_add_f32 v[94:95], v[94:95], v[240:241] op_sel_hi:[1,0] neg_lo:[0,1] neg_hi:[0,1]
v_pk_add_f32 v[96:97], v[96:97], v[240:241] op_sel_hi:[1,0] neg_lo:[0,1] neg_hi:[0,1]
v_pk_add_f32 v[98:99], v[98:99], v[240:241] op_sel_hi:[1,0] neg_lo:[0,1] neg_hi:[0,1]
v_pk_add_f32 v[100:101], v[100:101], v[240:241] op_sel_hi:[1,0] neg_lo:[0,1] neg_hi:[0,1]
v_pk_add_f32 v[102:103], v[102:103], v[240:241] op_sel_hi:[1,0] neg_lo:[0,1] neg_hi:[0,1]
v_pk_add_f32 v[104:105], v[104:105], v[240:241] op_sel_hi:[1,0] neg_lo:[0,1] neg_hi:[0,1]
v_pk_add_f32 v[106:107], v[106:107], v[240:241] op_sel_hi:[1,0] neg_lo:[0,1] neg_hi:[0,1]
v_pk_add_f32 v[108:109], v[108:109], v[240:241] op_sel_hi:[1,0] neg_lo:[0,1] neg_hi:[0,1]
v_pk_add_f32 v[110:111], v[110:111], v[240:241] op_sel_hi:[1,0] neg_lo:[0,1] neg_hi:[0,1]
v_pk_mul_f32 v[240:241], v[48:49], v[48:49]
v_pk_fma_f32 v[240:241], v[50:51], v[50:51], v[240:241]
v_pk_fma_f32 v[240:241], v[52:53], v[52:53], v[240:241]
v_pk_fma_f32 v[240:241], v[54:55], v[54:55], v[240:241]
v_pk_fma_f32 v[240:241], v[56:57], v[56:57], v[240:241]
v_pk_fma_f32 v[240:241], v[58:59], v[58:59], v[240:241]
v_pk_fma_f32 v[240:241], v[60:61], v[60:61], v[240:241]
v_pk_fma_f32 v[240:241], v[62:63], v[62:63], v[240:241]
v_pk_fma_f32 v[240:241], v[64:65], v[64:65], v[240:241]
v_pk_fma_f32 v[240:241], v[66:67], v[66:67], v[240:241]
v_pk_fma_f32 v[240:241], v[68:69], v[68:69], v[240:241]
v_pk_fma_f32 v[240:241], v[70:71], v[70:71], v[240:241]
v_pk_fma_f32 v[240:241], v[72:73], v[72:73], v[240:241]
v_pk_fma_f32 v[240:241], v[74:75], v[74:75], v[240:241]
v_pk_fma_f32 v[240:241], v[76:77], v[76:77], v[240:241]
v_pk_fma_f32 v[240:241], v[78:79], v[78:79], v[240:241]
v_pk_fma_f32 v[240:241], v[80:81], v[80:81], v[240:241]
v_pk_fma_f32 v[240:241], v[82:83], v[82:83], v[240:241]
v_pk_fma_f32 v[240:241], v[84:85], v[84:85], v[240:241]
v_pk_fma_f32 v[240:241], v[86:87], v[86:87], v[240:241]
v_pk_fma_f32 v[240:241], v[88:89], v[88:89], v[240:241]
v_pk_fma_f32 v[240:241], v[90:91], v[90:91], v[240:241]
v_pk_fma_f32 v[240:241], v[92:93], v[92:93], v[240:241]
v_pk_fma_f32 v[240:241], v[94:95], v[94:95], v[240:241]
v_pk_fma_f32 v[240:241], v[96:97], v[96:97], v[240:241]
v_pk_fma_f32 v[240:241], v[98:99], v[98:99], v[240:241]
v_pk_fma_f32 v[240:241], v[100:101], v[100:101], v[240:241]
v_pk_fma_f32 v[240:241], v[102:103], v[102:103], v[240:241]
v_pk_fma_f32 v[240:241], v[104:105], v[104:105], v[240:241]
v_pk_fma_f32 v[240:241], v[106:107], v[106:107], v[240:241]
v_pk_fma_f32 v[240:241], v[108:109], v[108:109], v[240:241]
v_pk_fma_f32 v[240:241], v[110:111], v[110:111], v[240:241]
v_add_f32 v240, v240, v241
v_mov_b32 v241, v240
s_nop 1
v_permlane16_swap_b32 v240, v241
s_nop 0
v_add_f32 v240, v240, v241
v_mov_b32 v241, v240
s_nop 1
v_permlane32_swap_b32 v240, v241
s_nop 0
v_add_f32 v240, v240, v241
ds_write_b32 v11, v240 offset:768
s_waitcnt lgkmcnt(0)
s_barrier
ds_read_b128 v[240:243], v12 offset:768
s_waitcnt lgkmcnt(0)
v_pk_add_f32 v[240:241], v[240:241], v[242:243]
v_add_f32 v240, v240, v241
v_mul_f32 v240, 0x3a800000, v240
v_add_f32 v240, 0x3727c5ac, v240
v_rsq_f32 v240, v240
s_nop 0
v_pk_mul_f32 v[48:49], v[48:49], v[240:241] op_sel_hi:[1,0]
v_pk_mul_f32 v[50:51], v[50:51], v[240:241] op_sel_hi:[1,0]
v_pk_mul_f32 v[52:53], v[52:53], v[240:241] op_sel_hi:[1,0]
v_pk_mul_f32 v[54:55], v[54:55], v[240:241] op_sel_hi:[1,0]
v_pk_mul_f32 v[56:57], v[56:57], v[240:241] op_sel_hi:[1,0]
v_pk_mul_f32 v[58:59], v[58:59], v[240:241] op_sel_hi:[1,0]
v_pk_mul_f32 v[60:61], v[60:61], v[240:241] op_sel_hi:[1,0]
v_pk_mul_f32 v[62:63], v[62:63], v[240:241] op_sel_hi:[1,0]
v_pk_mul_f32 v[64:65], v[64:65], v[240:241] op_sel_hi:[1,0]
v_pk_mul_f32 v[66:67], v[66:67], v[240:241] op_sel_hi:[1,0]
v_pk_mul_f32 v[68:69], v[68:69], v[240:241] op_sel_hi:[1,0]
v_pk_mul_f32 v[70:71], v[70:71], v[240:241] op_sel_hi:[1,0]
v_pk_mul_f32 v[72:73], v[72:73], v[240:241] op_sel_hi:[1,0]
v_pk_mul_f32 v[74:75], v[74:75], v[240:241] op_sel_hi:[1,0]
v_pk_mul_f32 v[76:77], v[76:77], v[240:241] op_sel_hi:[1,0]
v_pk_mul_f32 v[78:79], v[78:79], v[240:241] op_sel_hi:[1,0]
v_pk_mul_f32 v[80:81], v[80:81], v[240:241] op_sel_hi:[1,0]
v_pk_mul_f32 v[82:83], v[82:83], v[240:241] op_sel_hi:[1,0]
v_pk_mul_f32 v[84:85], v[84:85], v[240:241] op_sel_hi:[1,0]
v_pk_mul_f32 v[86:87], v[86:87], v[240:241] op_sel_hi:[1,0]
v_pk_mul_f32 v[88:89], v[88:89], v[240:241] op_sel_hi:[1,0]
v_pk_mul_f32 v[90:91], v[90:91], v[240:241] op_sel_hi:[1,0]
v_pk_mul_f32 v[92:93], v[92:93], v[240:241] op_sel_hi:[1,0]
v_pk_mul_f32 v[94:95], v[94:95], v[240:241] op_sel_hi:[1,0]
v_pk_mul_f32 v[96:97], v[96:97], v[240:241] op_sel_hi:[1,0]
v_pk_mul_f32 v[98:99], v[98:99], v[240:241] op_sel_hi:[1,0]
v_pk_mul_f32 v[100:101], v[100:101], v[240:241] op_sel_hi:[1,0]
v_pk_mul_f32 v[102:103], v[102:103], v[240:241] op_sel_hi:[1,0]
v_pk_mul_f32 v[104:105], v[104:105], v[240:241] op_sel_hi:[1,0]
v_pk_mul_f32 v[106:107], v[106:107], v[240:241] op_sel_hi:[1,0]
v_pk_mul_f32 v[108:109], v[108:109], v[240:241] op_sel_hi:[1,0]
v_pk_mul_f32 v[110:111], v[110:111], v[240:241] op_sel_hi:[1,0]
v_mov_b32 v14, 32
Lst_604:
s_sub_u32 s37, s37, 1
s_cbranch_scc1 Lend_7
s_sleep 4
buffer_load_dword v15, v14, s[12:15], 0 offen sc1
s_waitcnt vmcnt(0)
v_readfirstlane_b32 s38, v15
s_nop 3
s_and_b32 s39, s38, 0xffff
s_cmp_lg_u32 s39, 256
s_cbranch_scc1 Lst_604
s_bfe_u32 s35, s38, 0x80010
s_bfe_u32 s46, s38, 0x10018
s_lshl_b32 s46, s46, 13
s_barrier
v_lshlrev_b32 v14, 7, v9
s_mov_b32 s38, 3424256
Lbw_605:
buffer_load_dword v15, v14, s[4:7], s38 offen sc1
s_waitcnt vmcnt(0)
v_cmp_gt_u32 vcc, 1, v15
s_cbranch_vccz Lbo_606
s_sub_u32 s37, s37, 1
s_cbranch_scc1 Lend_7
s_sleep 2
s_branch Lbw_605
Lbo_606:
s_lshl_b32 s42, s32, 10
s_add_u32 s43, s42, 3149824
s_add_u32 s42, s42, 3145728
buffer_load_dwordx4 v[176:179], v7, s[4:7], s43 offen offset:0 sc1
buffer_load_dwordx4 v[112:115], v7, s[4:7], s42 offen offset:0 sc1
buffer_load_dwordx4 v[180:183], v7, s[4:7], s43 offen offset:16 sc1
buffer_load_dwordx4 v[116:119], v7, s[4:7], s42 offen offset:16 sc1
buffer_load_dwordx4 v[184:187], v7, s[4:7], s43 offen offset:128 sc1
buffer_load_dwordx4 v[120:123], v7, s[4:7], s42 offen offset:128 sc1
buffer_load_dwordx4 v[188:191], v7, s[4:7], s43 offen offset:144 sc1
buffer_load_dwordx4 v[124:127], v7, s[4:7], s42 offen offset:144 sc1
buffer_load_dwordx4 v[192:195], v7, s[4:7], s43 offen offset:256 sc1
buffer_load_dwordx4 v[128:131], v7, s[4:7], s42 offen offset:256 sc1
buffer_load_dwordx4 v[196:199], v7, s[4:7], s43 offen offset:272 sc1
buffer_load_dwordx4 v[132:135], v7, s[4:7], s42 offen offset:272 sc1
buffer_load_dwordx4 v[200:203], v7, s[4:7], s43 offen offset:384 sc1
buffer_load_dwordx4 v[136:139], v7, s[4:7], s42 offen offset:384 sc1
buffer_load_dwordx4 v[204:207], v7, s[4:7], s43 offen offset:400 sc1
buffer_load_dwordx4 v[140:143], v7, s[4:7], s42 offen offset:400 sc1
buffer_load_dwordx4 v[208:211], v7, s[4:7], s43 offen offset:512 sc1
buffer_load_dwordx4 v[144:147], v7, s[4:7], s42 offen offset:512 sc1
buffer_load_dwordx4 v[212:215], v7, s[4:7], s43 offen offset:528 sc1
buffer_load_dwordx4 v[148:151], v7, s[4:7], s42 offen offset:528 sc1
buffer_load_dwordx4 v[216:219], v7, s[4:7], s43 offen offset:640 sc1
buffer_load_dwordx4 v[152:155], v7, s[4:7], s42 offen offset:640 sc1
buffer_load_dwordx4 v[220:223], v7, s[4:7], s43 offen offset:656 sc1
buffer_load_dwordx4 v[156:159], v7, s[4:7], s42 offen offset:656 sc1
buffer_load_dwordx4 v[224:227], v7, s[4:7], s43 offen offset:768 sc1
buffer_load_dwordx4 v[160:163], v7, s[4:7], s42 offen offset:768 sc1
buffer_load_dwordx4 v[228:231], v7, s[4:7], s43 offen offset:784 sc1
buffer_load_dwordx4 v[164:167], v7, s[4:7], s42 offen offset:784 sc1
buffer_load_dwordx4 v[232:235], v7, s[4:7], s43 offen offset:896 sc1
buffer_load_dwordx4 v[168:171], v7, s[4:7], s42 offen offset:896 sc1
buffer_load_dwordx4 v[236:239], v7, s[4:7], s43 offen offset:912 sc1
buffer_load_dwordx4 v[172:175], v7, s[4:7], s42 offen offset:912 sc1
s_waitcnt vmcnt(28)
v_pk_add_f32 v[176:177], v[176:177], 1.0 op_sel_hi:[1,0]
v_pk_add_f32 v[178:179], v[178:179], 1.0 op_sel_hi:[1,0]
v_pk_add_f32 v[180:181], v[180:181], 1.0 op_sel_hi:[1,0]
v_pk_add_f32 v[182:183], v[182:183], 1.0 op_sel_hi:[1,0]
v_pk_fma_f32 v[48:49], v[48:49], v[176:177], v[112:113]
v_pk_fma_f32 v[50:51], v[50:51], v[178:179], v[114:115]
v_pk_fma_f32 v[52:53], v[52:53], v[180:181], v[116:117]
v_pk_fma_f32 v[54:55], v[54:55], v[182:183], v[118:119]
v_cvt_pk_bf16_f32 v16, v48, v49
v_cvt_pk_bf16_f32 v17, v50, v51
v_cvt_pk_bf16_f32 v18, v52, v53
v_cvt_pk_bf16_f32 v19, v54, v55
s_add_u32 s41, s40, 8388608
buffer_store_dwordx4 v[16:19], v13, s[4:7], s41 offen sc1
s_waitcnt vmcnt(25)
v_pk_add_f32 v[184:185], v[184:185], 1.0 op_sel_hi:[1,0]
v_pk_add_f32 v[186:187], v[186:187], 1.0 op_sel_hi:[1,0]
v_pk_add_f32 v[188:189], v[188:189], 1.0 op_sel_hi:[1,0]
v_pk_add_f32 v[190:191], v[190:191], 1.0 op_sel_hi:[1,0]
v_pk_fma_f32 v[56:57], v[56:57], v[184:185], v[120:121]
v_pk_fma_f32 v[58:59], v[58:59], v[186:187], v[122:123]
v_pk_fma_f32 v[60:61], v[60:61], v[188:189], v[124:125]
v_pk_fma_f32 v[62:63], v[62:63], v[190:191], v[126:127]
v_cvt_pk_bf16_f32 v20, v56, v57
v_cvt_pk_bf16_f32 v21, v58, v59
v_cvt_pk_bf16_f32 v22, v60, v61
v_cvt_pk_bf16_f32 v23, v62, v63
s_add_u32 s41, s40, 8390656
buffer_store_dwordx4 v[20:23], v13, s[4:7], s41 offen sc1
s_waitcnt vmcnt(22)
v_pk_add_f32 v[192:193], v[192:193], 1.0 op_sel_hi:[1,0]
v_pk_add_f32 v[194:195], v[194:195], 1.0 op_sel_hi:[1,0]
v_pk_add_f32 v[196:197], v[196:197], 1.0 op_sel_hi:[1,0]
v_pk_add_f32 v[198:199], v[198:199], 1.0 op_sel_hi:[1,0]
v_pk_fma_f32 v[64:65], v[64:65], v[192:193], v[128:129]
v_pk_fma_f32 v[66:67], v[66:67], v[194:195], v[130:131]
v_pk_fma_f32 v[68:69], v[68:69], v[196:197], v[132:133]
v_pk_fma_f32 v[70:71], v[70:71], v[198:199], v[134:135]
v_cvt_pk_bf16_f32 v24, v64, v65
v_cvt_pk_bf16_f32 v25, v66, v67
v_cvt_pk_bf16_f32 v26, v68, v69
v_cvt_pk_bf16_f32 v27, v70, v71
s_add_u32 s41, s40, 8392704
buffer_store_dwordx4 v[24:27], v13, s[4:7], s41 offen sc1
s_waitcnt vmcnt(19)
v_pk_add_f32 v[200:201], v[200:201], 1.0 op_sel_hi:[1,0]
v_pk_add_f32 v[202:203], v[202:203], 1.0 op_sel_hi:[1,0]
v_pk_add_f32 v[204:205], v[204:205], 1.0 op_sel_hi:[1,0]
v_pk_add_f32 v[206:207], v[206:207], 1.0 op_sel_hi:[1,0]
v_pk_fma_f32 v[72:73], v[72:73], v[200:201], v[136:137]
v_pk_fma_f32 v[74:75], v[74:75], v[202:203], v[138:139]
v_pk_fma_f32 v[76:77], v[76:77], v[204:205], v[140:141]
v_pk_fma_f32 v[78:79], v[78:79], v[206:207], v[142:143]
v_cvt_pk_bf16_f32 v28, v72, v73
v_cvt_pk_bf16_f32 v29, v74, v75
v_cvt_pk_bf16_f32 v30, v76, v77
v_cvt_pk_bf16_f32 v31, v78, v79
s_add_u32 s41, s40, 8394752
buffer_store_dwordx4 v[28:31], v13, s[4:7], s41 offen sc1
s_waitcnt vmcnt(16)
v_pk_add_f32 v[208:209], v[208:209], 1.0 op_sel_hi:[1,0]
v_pk_add_f32 v[210:211], v[210:211], 1.0 op_sel_hi:[1,0]
v_pk_add_f32 v[212:213], v[212:213], 1.0 op_sel_hi:[1,0]
v_pk_add_f32 v[214:215], v[214:215], 1.0 op_sel_hi:[1,0]
v_pk_fma_f32 v[80:81], v[80:81], v[208:209], v[144:145]
v_pk_fma_f32 v[82:83], v[82:83], v[210:211], v[146:147]
v_pk_fma_f32 v[84:85], v[84:85], v[212:213], v[148:149]
v_pk_fma_f32 v[86:87], v[86:87], v[214:215], v[150:151]
v_cvt_pk_bf16_f32 v32, v80, v81
v_cvt_pk_bf16_f32 v33, v82, v83
v_cvt_pk_bf16_f32 v34, v84, v85
v_cvt_pk_bf16_f32 v35, v86, v87
s_add_u32 s41, s40, 8396800
buffer_store_dwordx4 v[32:35], v13, s[4:7], s41 offen sc1
s_waitcnt vmcnt(13)
v_pk_add_f32 v[216:217], v[216:217], 1.0 op_sel_hi:[1,0]
v_pk_add_f32 v[218:219], v[218:219], 1.0 op_sel_hi:[1,0]
v_pk_add_f32 v[220:221], v[220:221], 1.0 op_sel_hi:[1,0]
v_pk_add_f32 v[222:223], v[222:223], 1.0 op_sel_hi:[1,0]
v_pk_fma_f32 v[88:89], v[88:89], v[216:217], v[152:153]
v_pk_fma_f32 v[90:91], v[90:91], v[218:219], v[154:155]
v_pk_fma_f32 v[92:93], v[92:93], v[220:221], v[156:157]
v_pk_fma_f32 v[94:95], v[94:95], v[222:223], v[158:159]
v_cvt_pk_bf16_f32 v36, v88, v89
v_cvt_pk_bf16_f32 v37, v90, v91
v_cvt_pk_bf16_f32 v38, v92, v93
v_cvt_pk_bf16_f32 v39, v94, v95
s_add_u32 s41, s40, 8398848
buffer_store_dwordx4 v[36:39], v13, s[4:7], s41 offen sc1
s_waitcnt vmcnt(10)
v_pk_add_f32 v[224:225], v[224:225], 1.0 op_sel_hi:[1,0]
v_pk_add_f32 v[226:227], v[226:227], 1.0 op_sel_hi:[1,0]
v_pk_add_f32 v[228:229], v[228:229], 1.0 op_sel_hi:[1,0]
v_pk_add_f32 v[230:231], v[230:231], 1.0 op_sel_hi:[1,0]
v_pk_fma_f32 v[96:97], v[96:97], v[224:225], v[160:161]
v_pk_fma_f32 v[98:99], v[98:99], v[226:227], v[162:163]
v_pk_fma_f32 v[100:101], v[100:101], v[228:229], v[164:165]
v_pk_fma_f32 v[102:103], v[102:103], v[230:231], v[166:167]
v_cvt_pk_bf16_f32 v40, v96, v97
v_cvt_pk_bf16_f32 v41, v98, v99
v_cvt_pk_bf16_f32 v42, v100, v101
v_cvt_pk_bf16_f32 v43, v102, v103
s_add_u32 s41, s40, 8400896
buffer_store_dwordx4 v[40:43], v13, s[4:7], s41 offen sc1
s_waitcnt vmcnt(7)
v_pk_add_f32 v[232:233], v[232:233], 1.0 op_sel_hi:[1,0]
v_pk_add_f32 v[234:235], v[234:235], 1.0 op_sel_hi:[1,0]
v_pk_add_f32 v[236:237], v[236:237], 1.0 op_sel_hi:[1,0]
v_pk_add_f32 v[238:239], v[238:239], 1.0 op_sel_hi:[1,0]
v_pk_fma_f32 v[104:105], v[104:105], v[232:233], v[168:169]
v_pk_fma_f32 v[106:107], v[106:107], v[234:235], v[170:171]
v_pk_fma_f32 v[108:109], v[108:109], v[236:237], v[172:173]
v_pk_fma_f32 v[110:111], v[110:111], v[238:239], v[174:175]
v_cvt_pk_bf16_f32 v44, v104, v105
v_cvt_pk_bf16_f32 v45, v106, v107
v_cvt_pk_bf16_f32 v46, v108, v109
v_cvt_pk_bf16_f32 v47, v110, v111
s_add_u32 s41, s40, 8402944
buffer_store_dwordx4 v[44:47], v13, s[4:7], s41 offen sc1
v_mov_b32 v14, 2
s_waitcnt vmcnt(0)
s_barrier
buffer_store_dword v14, v10, s[4:7], 0 offen sc1
s_add_u32 s52, s26, 64
s_lshl_b32 s41, s52, 15
s_lshl_b32 s42, s32, 9
s_add_u32 s41, s41, s42
buffer_load_dwordx4 v[16:19], v6, s[88:91], s41 offen offset:0
buffer_load_dwordx4 v[20:23], v6, s[88:91], s41 offen offset:64
buffer_load_dwordx4 v[24:27], v6, s[88:91], s41 offen offset:128
buffer_load_dwordx4 v[28:31], v6, s[88:91], s41 offen offset:192
buffer_load_dwordx4 v[32:35], v6, s[88:91], s41 offen offset:256
buffer_load_dwordx4 v[36:39], v6, s[88:91], s41 offen offset:320
buffer_load_dwordx4 v[40:43], v6, s[88:91], s41 offen offset:384
buffer_load_dwordx4 v[44:47], v6, s[88:91], s41 offen offset:448
s_lshr_b32 s40, s52, 1
s_lshl_b32 s40, s40, 2
s_add_u32 s40, s40, s32
s_lshl_b32 s40, s40, 14
s_and_b32 s41, s52, 1
s_lshl_b32 s41, s41, 10
s_add_u32 s40, s40, s41
s_waitcnt vmcnt(0)
v_lshlrev_b32 v48, 16, v16
v_and_b32 v49, 0xffff0000, v16
v_lshlrev_b32 v50, 16, v17
v_and_b32 v51, 0xffff0000, v17
v_lshlrev_b32 v52, 16, v18
v_and_b32 v53, 0xffff0000, v18
v_lshlrev_b32 v54, 16, v19
v_and_b32 v55, 0xffff0000, v19
v_lshlrev_b32 v56, 16, v20
v_and_b32 v57, 0xffff0000, v20
v_lshlrev_b32 v58, 16, v21
v_and_b32 v59, 0xffff0000, v21
v_lshlrev_b32 v60, 16, v22
v_and_b32 v61, 0xffff0000, v22
v_lshlrev_b32 v62, 16, v23
v_and_b32 v63, 0xffff0000, v23
v_lshlrev_b32 v64, 16, v24
v_and_b32 v65, 0xffff0000, v24
v_lshlrev_b32 v66, 16, v25
v_and_b32 v67, 0xffff0000, v25
v_lshlrev_b32 v68, 16, v26
v_and_b32 v69, 0xffff0000, v26
v_lshlrev_b32 v70, 16, v27
v_and_b32 v71, 0xffff0000, v27
v_lshlrev_b32 v72, 16, v28
v_and_b32 v73, 0xffff0000, v28
v_lshlrev_b32 v74, 16, v29
v_and_b32 v75, 0xffff0000, v29
v_lshlrev_b32 v76, 16, v30
v_and_b32 v77, 0xffff0000, v30
v_lshlrev_b32 v78, 16, v31
v_and_b32 v79, 0xffff0000, v31
v_lshlrev_b32 v80, 16, v32
v_and_b32 v81, 0xffff0000, v32
v_lshlrev_b32 v82, 16, v33
v_and_b32 v83, 0xffff0000, v33
v_lshlrev_b32 v84, 16, v34
v_and_b32 v85, 0xffff0000, v34
v_lshlrev_b32 v86, 16, v35
v_and_b32 v87, 0xffff0000, v35
v_lshlrev_b32 v88, 16, v36
v_and_b32 v89, 0xffff0000, v36
v_lshlrev_b32 v90, 16, v37
v_and_b32 v91, 0xffff0000, v37
v_lshlrev_b32 v92, 16, v38
v_and_b32 v93, 0xffff0000, v38
v_lshlrev_b32 v94, 16, v39
v_and_b32 v95, 0xffff0000, v39
v_lshlrev_b32 v96, 16, v40
v_and_b32 v97, 0xffff0000, v40
v_lshlrev_b32 v98, 16, v41
v_and_b32 v99, 0xffff0000, v41
v_lshlrev_b32 v100, 16, v42
v_and_b32 v101, 0xffff0000, v42
v_lshlrev_b32 v102, 16, v43
v_and_b32 v103, 0xffff0000, v43
v_lshlrev_b32 v104, 16, v44
v_and_b32 v105, 0xffff0000, v44
v_lshlrev_b32 v106, 16, v45
v_and_b32 v107, 0xffff0000, v45
v_lshlrev_b32 v108, 16, v46
v_and_b32 v109, 0xffff0000, v46
v_lshlrev_b32 v110, 16, v47
v_and_b32 v111, 0xffff0000, v47
v_pk_add_f32 v[240:241], v[48:49], v[50:51]
v_pk_add_f32 v[240:241], v[240:241], v[52:53]
v_pk_add_f32 v[240:241], v[240:241], v[54:55]
v_pk_add_f32 v[240:241], v[240:241], v[56:57]
v_pk_add_f32 v[240:241], v[240:241], v[58:59]
v_pk_add_f32 v[240:241], v[240:241], v[60:61]
v_pk_add_f32 v[240:241], v[240:241], v[62:63]
v_pk_add_f32 v[240:241], v[240:241], v[64:65]
v_pk_add_f32 v[240:241], v[240:241], v[66:67]
v_pk_add_f32 v[240:241], v[240:241], v[68:69]
v_pk_add_f32 v[240:241], v[240:241], v[70:71]
v_pk_add_f32 v[240:241], v[240:241], v[72:73]
v_pk_add_f32 v[240:241], v[240:241], v[74:75]
v_pk_add_f32 v[240:241], v[240:241], v[76:77]
v_pk_add_f32 v[240:241], v[240:241], v[78:79]
v_pk_add_f32 v[240:241], v[240:241], v[80:81]
v_pk_add_f32 v[240:241], v[240:241], v[82:83]
v_pk_add_f32 v[240:241], v[240:241], v[84:85]
v_pk_add_f32 v[240:241], v[240:241], v[86:87]
v_pk_add_f32 v[240:241], v[240:241], v[88:89]
v_pk_add_f32 v[240:241], v[240:241], v[90:91]
v_pk_add_f32 v[240:241], v[240:241], v[92:93]
v_pk_add_f32 v[240:241], v[240:241], v[94:95]
v_pk_add_f32 v[240:241], v[240:241], v[96:97]
v_pk_add_f32 v[240:241], v[240:241], v[98:99]
v_pk_add_f32 v[240:241], v[240:241], v[100:101]
v_pk_add_f32 v[240:241], v[240:241], v[102:103]
v_pk_add_f32 v[240:241], v[240:241], v[104:105]
v_pk_add_f32 v[240:241], v[240:241], v[106:107]
v_pk_add_f32 v[240:241], v[240:241], v[108:109]
v_pk_add_f32 v[240:241], v[240:241], v[110:111]
v_add_f32 v240, v240, v241
v_mov_b32 v241, v240
s_nop 1
v_permlane16_swap_b32 v240, v241
s_nop 0
v_add_f32 v240, v240, v241
v_mov_b32 v241, v240
s_nop 1
v_permlane32_swap_b32 v240, v241
s_nop 0
v_add_f32 v240, v240, v241
ds_write_b32 v11, v240 offset:512
s_waitcnt lgkmcnt(0)
s_barrier
ds_read_b128 v[240:243], v12 offset:512
s_waitcnt lgkmcnt(0)
v_pk_add_f32 v[240:241], v[240:241], v[242:243]
v_add_f32 v240, v240, v241
v_mul_f32 v240, 0x3a800000, v240
v_pk_add_f32 v[48:49], v[48:49], v[240:241] op_sel_hi:[1,0] neg_lo:[0,1] neg_hi:[0,1]
v_pk_add_f32 v[50:51], v[50:51], v[240:241] op_sel_hi:[1,0] neg_lo:[0,1] neg_hi:[0,1]
v_pk_add_f32 v[52:53], v[52:53], v[240:241] op_sel_hi:[1,0] neg_lo:[0,1] neg_hi:[0,1]
v_pk_add_f32 v[54:55], v[54:55], v[240:241] op_sel_hi:[1,0] neg_lo:[0,1] neg_hi:[0,1]
v_pk_add_f32 v[56:57], v[56:57], v[240:241] op_sel_hi:[1,0] neg_lo:[0,1] neg_hi:[0,1]
v_pk_add_f32 v[58:59], v[58:59], v[240:241] op_sel_hi:[1,0] neg_lo:[0,1] neg_hi:[0,1]
v_pk_add_f32 v[60:61], v[60:61], v[240:241] op_sel_hi:[1,0] neg_lo:[0,1] neg_hi:[0,1]
v_pk_add_f32 v[62:63], v[62:63], v[240:241] op_sel_hi:[1,0] neg_lo:[0,1] neg_hi:[0,1]
v_pk_add_f32 v[64:65], v[64:65], v[240:241] op_sel_hi:[1,0] neg_lo:[0,1] neg_hi:[0,1]
v_pk_add_f32 v[66:67], v[66:67], v[240:241] op_sel_hi:[1,0] neg_lo:[0,1] neg_hi:[0,1]
v_pk_add_f32 v[68:69], v[68:69], v[240:241] op_sel_hi:[1,0] neg_lo:[0,1] neg_hi:[0,1]
v_pk_add_f32 v[70:71], v[70:71], v[240:241] op_sel_hi:[1,0] neg_lo:[0,1] neg_hi:[0,1]
v_pk_add_f32 v[72:73], v[72:73], v[240:241] op_sel_hi:[1,0] neg_lo:[0,1] neg_hi:[0,1]
v_pk_add_f32 v[74:75], v[74:75], v[240:241] op_sel_hi:[1,0] neg_lo:[0,1] neg_hi:[0,1]
v_pk_add_f32 v[76:77], v[76:77], v[240:241] op_sel_hi:[1,0] neg_lo:[0,1] neg_hi:[0,1]
v_pk_add_f32 v[78:79], v[78:79], v[240:241] op_sel_hi:[1,0] neg_lo:[0,1] neg_hi:[0,1]
v_pk_add_f32 v[80:81], v[80:81], v[240:241] op_sel_hi:[1,0] neg_lo:[0,1] neg_hi:[0,1]
v_pk_add_f32 v[82:83], v[82:83], v[240:241] op_sel_hi:[1,0] neg_lo:[0,1] neg_hi:[0,1]
v_pk_add_f32 v[84:85], v[84:85], v[240:241] op_sel_hi:[1,0] neg_lo:[0,1] neg_hi:[0,1]
v_pk_add_f32 v[86:87], v[86:87], v[240:241] op_sel_hi:[1,0] neg_lo:[0,1] neg_hi:[0,1]
v_pk_add_f32 v[88:89], v[88:89], v[240:241] op_sel_hi:[1,0] neg_lo:[0,1] neg_hi:[0,1]
v_pk_add_f32 v[90:91], v[90:91], v[240:241] op_sel_hi:[1,0] neg_lo:[0,1] neg_hi:[0,1]
v_pk_add_f32 v[92:93], v[92:93], v[240:241] op_sel_hi:[1,0] neg_lo:[0,1] neg_hi:[0,1]
v_pk_add_f32 v[94:95], v[94:95], v[240:241] op_sel_hi:[1,0] neg_lo:[0,1] neg_hi:[0,1]
v_pk_add_f32 v[96:97], v[96:97], v[240:241] op_sel_hi:[1,0] neg_lo:[0,1] neg_hi:[0,1]
v_pk_add_f32 v[98:99], v[98:99], v[240:241] op_sel_hi:[1,0] neg_lo:[0,1] neg_hi:[0,1]
v_pk_add_f32 v[100:101], v[100:101], v[240:241] op_sel_hi:[1,0] neg_lo:[0,1] neg_hi:[0,1]
v_pk_add_f32 v[102:103], v[102:103], v[240:241] op_sel_hi:[1,0] neg_lo:[0,1] neg_hi:[0,1]
v_pk_add_f32 v[104:105], v[104:105], v[240:241] op_sel_hi:[1,0] neg_lo:[0,1] neg_hi:[0,1]
v_pk_add_f32 v[106:107], v[106:107], v[240:241] op_sel_hi:[1,0] neg_lo:[0,1] neg_hi:[0,1]
v_pk_add_f32 v[108:109], v[108:109], v[240:241] op_sel_hi:[1,0] neg_lo:[0,1] neg_hi:[0,1]
v_pk_add_f32 v[110:111], v[110:111], v[240:241] op_sel_hi:[1,0] neg_lo:[0,1] neg_hi:[0,1]
v_pk_mul_f32 v[240:241], v[48:49], v[48:49]
v_pk_fma_f32 v[240:241], v[50:51], v[50:51], v[240:241]
v_pk_fma_f32 v[240:241], v[52:53], v[52:53], v[240:241]
v_pk_fma_f32 v[240:241], v[54:55], v[54:55], v[240:241]
v_pk_fma_f32 v[240:241], v[56:57], v[56:57], v[240:241]
v_pk_fma_f32 v[240:241], v[58:59], v[58:59], v[240:241]
v_pk_fma_f32 v[240:241], v[60:61], v[60:61], v[240:241]
v_pk_fma_f32 v[240:241], v[62:63], v[62:63], v[240:241]
v_pk_fma_f32 v[240:241], v[64:65], v[64:65], v[240:241]
v_pk_fma_f32 v[240:241], v[66:67], v[66:67], v[240:241]
v_pk_fma_f32 v[240:241], v[68:69], v[68:69], v[240:241]
v_pk_fma_f32 v[240:241], v[70:71], v[70:71], v[240:241]
v_pk_fma_f32 v[240:241], v[72:73], v[72:73], v[240:241]
v_pk_fma_f32 v[240:241], v[74:75], v[74:75], v[240:241]
v_pk_fma_f32 v[240:241], v[76:77], v[76:77], v[240:241]
v_pk_fma_f32 v[240:241], v[78:79], v[78:79], v[240:241]
v_pk_fma_f32 v[240:241], v[80:81], v[80:81], v[240:241]
v_pk_fma_f32 v[240:241], v[82:83], v[82:83], v[240:241]
v_pk_fma_f32 v[240:241], v[84:85], v[84:85], v[240:241]
v_pk_fma_f32 v[240:241], v[86:87], v[86:87], v[240:241]
v_pk_fma_f32 v[240:241], v[88:89], v[88:89], v[240:241]
v_pk_fma_f32 v[240:241], v[90:91], v[90:91], v[240:241]
v_pk_fma_f32 v[240:241], v[92:93], v[92:93], v[240:241]
v_pk_fma_f32 v[240:241], v[94:95], v[94:95], v[240:241]
v_pk_fma_f32 v[240:241], v[96:97], v[96:97], v[240:241]
v_pk_fma_f32 v[240:241], v[98:99], v[98:99], v[240:241]
v_pk_fma_f32 v[240:241], v[100:101], v[100:101], v[240:241]
v_pk_fma_f32 v[240:241], v[102:103], v[102:103], v[240:241]
v_pk_fma_f32 v[240:241], v[104:105], v[104:105], v[240:241]
v_pk_fma_f32 v[240:241], v[106:107], v[106:107], v[240:241]
v_pk_fma_f32 v[240:241], v[108:109], v[108:109], v[240:241]
v_pk_fma_f32 v[240:241], v[110:111], v[110:111], v[240:241]
v_add_f32 v240, v240, v241
v_mov_b32 v241, v240
s_nop 1
v_permlane16_swap_b32 v240, v241
s_nop 0
v_add_f32 v240, v240, v241
v_mov_b32 v241, v240
s_nop 1
v_permlane32_swap_b32 v240, v241
s_nop 0
v_add_f32 v240, v240, v241
ds_write_b32 v11, v240 offset:768
s_waitcnt lgkmcnt(0)
s_barrier
ds_read_b128 v[240:243], v12 offset:768
s_waitcnt lgkmcnt(0)
v_pk_add_f32 v[240:241], v[240:241], v[242:243]
v_add_f32 v240, v240, v241
v_mul_f32 v240, 0x3a800000, v240
v_add_f32 v240, 0x3727c5ac, v240
v_rsq_f32 v240, v240
s_nop 0
v_pk_mul_f32 v[48:49], v[48:49], v[240:241] op_sel_hi:[1,0]
v_pk_mul_f32 v[50:51], v[50:51], v[240:241] op_sel_hi:[1,0]
v_pk_mul_f32 v[52:53], v[52:53], v[240:241] op_sel_hi:[1,0]
v_pk_mul_f32 v[54:55], v[54:55], v[240:241] op_sel_hi:[1,0]
v_pk_mul_f32 v[56:57], v[56:57], v[240:241] op_sel_hi:[1,0]
v_pk_mul_f32 v[58:59], v[58:59], v[240:241] op_sel_hi:[1,0]
v_pk_mul_f32 v[60:61], v[60:61], v[240:241] op_sel_hi:[1,0]
v_pk_mul_f32 v[62:63], v[62:63], v[240:241] op_sel_hi:[1,0]
v_pk_mul_f32 v[64:65], v[64:65], v[240:241] op_sel_hi:[1,0]
v_pk_mul_f32 v[66:67], v[66:67], v[240:241] op_sel_hi:[1,0]
v_pk_mul_f32 v[68:69], v[68:69], v[240:241] op_sel_hi:[1,0]
v_pk_mul_f32 v[70:71], v[70:71], v[240:241] op_sel_hi:[1,0]
v_pk_mul_f32 v[72:73], v[72:73], v[240:241] op_sel_hi:[1,0]
v_pk_mul_f32 v[74:75], v[74:75], v[240:241] op_sel_hi:[1,0]
v_pk_mul_f32 v[76:77], v[76:77], v[240:241] op_sel_hi:[1,0]
v_pk_mul_f32 v[78:79], v[78:79], v[240:241] op_sel_hi:[1,0]
v_pk_mul_f32 v[80:81], v[80:81], v[240:241] op_sel_hi:[1,0]
v_pk_mul_f32 v[82:83], v[82:83], v[240:241] op_sel_hi:[1,0]
v_pk_mul_f32 v[84:85], v[84:85], v[240:241] op_sel_hi:[1,0]
v_pk_mul_f32 v[86:87], v[86:87], v[240:241] op_sel_hi:[1,0]
v_pk_mul_f32 v[88:89], v[88:89], v[240:241] op_sel_hi:[1,0]
v_pk_mul_f32 v[90:91], v[90:91], v[240:241] op_sel_hi:[1,0]
v_pk_mul_f32 v[92:93], v[92:93], v[240:241] op_sel_hi:[1,0]
v_pk_mul_f32 v[94:95], v[94:95], v[240:241] op_sel_hi:[1,0]
v_pk_mul_f32 v[96:97], v[96:97], v[240:241] op_sel_hi:[1,0]
v_pk_mul_f32 v[98:99], v[98:99], v[240:241] op_sel_hi:[1,0]
v_pk_mul_f32 v[100:101], v[100:101], v[240:241] op_sel_hi:[1,0]
v_pk_mul_f32 v[102:103], v[102:103], v[240:241] op_sel_hi:[1,0]
v_pk_mul_f32 v[104:105], v[104:105], v[240:241] op_sel_hi:[1,0]
v_pk_mul_f32 v[106:107], v[106:107], v[240:241] op_sel_hi:[1,0]
v_pk_mul_f32 v[108:109], v[108:109], v[240:241] op_sel_hi:[1,0]
v_pk_mul_f32 v[110:111], v[110:111], v[240:241] op_sel_hi:[1,0]
v_pk_fma_f32 v[48:49], v[48:49], v[176:177], v[112:113]
v_pk_fma_f32 v[50:51], v[50:51], v[178:179], v[114:115]
v_pk_fma_f32 v[52:53], v[52:53], v[180:181], v[116:117]
v_pk_fma_f32 v[54:55], v[54:55], v[182:183], v[118:119]
v_cvt_pk_bf16_f32 v16, v48, v49
v_cvt_pk_bf16_f32 v17, v50, v51
v_cvt_pk_bf16_f32 v18, v52, v53
v_cvt_pk_bf16_f32 v19, v54, v55
s_add_u32 s41, s40, 8388608
buffer_store_dwordx4 v[16:19], v13, s[4:7], s41 offen sc1
v_pk_fma_f32 v[56:57], v[56:57], v[184:185], v[120:121]
v_pk_fma_f32 v[58:59], v[58:59], v[186:187], v[122:123]
v_pk_fma_f32 v[60:61], v[60:61], v[188:189], v[124:125]
v_pk_fma_f32 v[62:63], v[62:63], v[190:191], v[126:127]
v_cvt_pk_bf16_f32 v20, v56, v57
v_cvt_pk_bf16_f32 v21, v58, v59
v_cvt_pk_bf16_f32 v22, v60, v61
v_cvt_pk_bf16_f32 v23, v62, v63
s_add_u32 s41, s40, 8390656
buffer_store_dwordx4 v[20:23], v13, s[4:7], s41 offen sc1
v_pk_fma_f32 v[64:65], v[64:65], v[192:193], v[128:129]
v_pk_fma_f32 v[66:67], v[66:67], v[194:195], v[130:131]
v_pk_fma_f32 v[68:69], v[68:69], v[196:197], v[132:133]
v_pk_fma_f32 v[70:71], v[70:71], v[198:199], v[134:135]
v_cvt_pk_bf16_f32 v24, v64, v65
v_cvt_pk_bf16_f32 v25, v66, v67
v_cvt_pk_bf16_f32 v26, v68, v69
v_cvt_pk_bf16_f32 v27, v70, v71
s_add_u32 s41, s40, 8392704
buffer_store_dwordx4 v[24:27], v13, s[4:7], s41 offen sc1
v_pk_fma_f32 v[72:73], v[72:73], v[200:201], v[136:137]
v_pk_fma_f32 v[74:75], v[74:75], v[202:203], v[138:139]
v_pk_fma_f32 v[76:77], v[76:77], v[204:205], v[140:141]
v_pk_fma_f32 v[78:79], v[78:79], v[206:207], v[142:143]
v_cvt_pk_bf16_f32 v28, v72, v73
v_cvt_pk_bf16_f32 v29, v74, v75
v_cvt_pk_bf16_f32 v30, v76, v77
v_cvt_pk_bf16_f32 v31, v78, v79
s_add_u32 s41, s40, 8394752
buffer_store_dwordx4 v[28:31], v13, s[4:7], s41 offen sc1
v_pk_fma_f32 v[80:81], v[80:81], v[208:209], v[144:145]
v_pk_fma_f32 v[82:83], v[82:83], v[210:211], v[146:147]
v_pk_fma_f32 v[84:85], v[84:85], v[212:213], v[148:149]
v_pk_fma_f32 v[86:87], v[86:87], v[214:215], v[150:151]
v_cvt_pk_bf16_f32 v32, v80, v81
v_cvt_pk_bf16_f32 v33, v82, v83
v_cvt_pk_bf16_f32 v34, v84, v85
v_cvt_pk_bf16_f32 v35, v86, v87
s_add_u32 s41, s40, 8396800
buffer_store_dwordx4 v[32:35], v13, s[4:7], s41 offen sc1
v_pk_fma_f32 v[88:89], v[88:89], v[216:217], v[152:153]
v_pk_fma_f32 v[90:91], v[90:91], v[218:219], v[154:155]
v_pk_fma_f32 v[92:93], v[92:93], v[220:221], v[156:157]
v_pk_fma_f32 v[94:95], v[94:95], v[222:223], v[158:159]
v_cvt_pk_bf16_f32 v36, v88, v89
v_cvt_pk_bf16_f32 v37, v90, v91
v_cvt_pk_bf16_f32 v38, v92, v93
v_cvt_pk_bf16_f32 v39, v94, v95
s_add_u32 s41, s40, 8398848
buffer_store_dwordx4 v[36:39], v13, s[4:7], s41 offen sc1
v_pk_fma_f32 v[96:97], v[96:97], v[224:225], v[160:161]
v_pk_fma_f32 v[98:99], v[98:99], v[226:227], v[162:163]
v_pk_fma_f32 v[100:101], v[100:101], v[228:229], v[164:165]
v_pk_fma_f32 v[102:103], v[102:103], v[230:231], v[166:167]
v_cvt_pk_bf16_f32 v40, v96, v97
v_cvt_pk_bf16_f32 v41, v98, v99
v_cvt_pk_bf16_f32 v42, v100, v101
v_cvt_pk_bf16_f32 v43, v102, v103
s_add_u32 s41, s40, 8400896
buffer_store_dwordx4 v[40:43], v13, s[4:7], s41 offen sc1
v_pk_fma_f32 v[104:105], v[104:105], v[232:233], v[168:169]
v_pk_fma_f32 v[106:107], v[106:107], v[234:235], v[170:171]
v_pk_fma_f32 v[108:109], v[108:109], v[236:237], v[172:173]
v_pk_fma_f32 v[110:111], v[110:111], v[238:239], v[174:175]
v_cvt_pk_bf16_f32 v44, v104, v105
v_cvt_pk_bf16_f32 v45, v106, v107
v_cvt_pk_bf16_f32 v46, v108, v109
v_cvt_pk_bf16_f32 v47, v110, v111
s_add_u32 s41, s40, 8402944
buffer_store_dwordx4 v[44:47], v13, s[4:7], s41 offen sc1
v_mov_b32 v14, 3
s_waitcnt vmcnt(0)
s_barrier
buffer_store_dword v14, v10, s[4:7], 0 offen sc1
Lmd_607:
s_add_u32 s26, s26, 64
s_barrier
v_lshrrev_b32 v2, 2, v0
v_and_b32 v3, 3, v0
v_mul_u32_u24 v4, 12288, v2
v_lshl_add_u32 v4, v3, 4, v4
v_lshlrev_b32 v5, 1, v2
s_lshl_b32 s40, s26, 6
buffer_load_ushort v80, v5, s[84:87], 0 offen offset:0
buffer_load_ushort v81, v5, s[84:87], 0 offen offset:128
buffer_load_ushort v82, v5, s[84:87], 0 offen offset:256
buffer_load_ushort v83, v5, s[84:87], 0 offen offset:384
buffer_load_ushort v84, v5, s[84:87], 0 offen offset:512
buffer_load_ushort v85, v5, s[84:87], 0 offen offset:640
buffer_load_ushort v86, v5, s[84:87], 0 offen offset:768
buffer_load_ushort v87, v5, s[84:87], 0 offen offset:896
buffer_load_ushort v88, v5, s[84:87], 0 offen offset:1024
buffer_load_ushort v89, v5, s[84:87], 0 offen offset:1152
buffer_load_ushort v90, v5, s[84:87], 0 offen offset:1280
buffer_load_ushort v91, v5, s[84:87], 0 offen offset:1408
buffer_load_ushort v92, v5, s[84:87], 0 offen offset:1536
buffer_load_ushort v93, v5, s[84:87], 0 offen offset:1664
buffer_load_ushort v94, v5, s[84:87], 0 offen offset:1792
buffer_load_ushort v95, v5, s[84:87], 0 offen offset:1920
buffer_load_dwordx4 v[16:19], v4, s[8:11], s40 offen
s_add_u32 s40, s40, 786432
buffer_load_dwordx4 v[20:23], v4, s[8:11], s40 offen
s_add_u32 s40, s40, 786432
buffer_load_dwordx4 v[24:27], v4, s[8:11], s40 offen
s_add_u32 s40, s40, 786432
buffer_load_dwordx4 v[28:31], v4, s[8:11], s40 offen
s_add_u32 s40, s40, 786432
buffer_load_dwordx4 v[32:35], v4, s[8:11], s40 offen
s_add_u32 s40, s40, 786432
buffer_load_dwordx4 v[36:39], v4, s[8:11], s40 offen
s_add_u32 s40, s40, 786432
buffer_load_dwordx4 v[40:43], v4, s[8:11], s40 offen
s_add_u32 s40, s40, 786432
buffer_load_dwordx4 v[44:47], v4, s[8:11], s40 offen
s_add_u32 s40, s40, 786432
buffer_load_dwordx4 v[48:51], v4, s[8:11], s40 offen
s_add_u32 s40, s40, 786432
buffer_load_dwordx4 v[52:55], v4, s[8:11], s40 offen
s_add_u32 s40, s40, 786432
buffer_load_dwordx4 v[56:59], v4, s[8:11], s40 offen
s_add_u32 s40, s40, 786432
buffer_load_dwordx4 v[60:63], v4, s[8:11], s40 offen
s_add_u32 s40, s40, 786432
buffer_load_dwordx4 v[64:67], v4, s[8:11], s40 offen
s_add_u32 s40, s40, 786432
buffer_load_dwordx4 v[68:71], v4, s[8:11], s40 offen
s_add_u32 s40, s40, 786432
buffer_load_dwordx4 v[72:75], v4, s[8:11], s40 offen
s_add_u32 s40, s40, 786432
buffer_load_dwordx4 v[76:79], v4, s[8:11], s40 offen
s_add_u32 s40, s40, 786432
v_mov_b32 v96, 0
v_mov_b32 v97, 0
v_mov_b32 v98, 0
v_mov_b32 v99, 0
v_mov_b32 v100, 0
v_mov_b32 v101, 0
v_mov_b32 v102, 0
v_mov_b32 v103, 0
s_waitcnt vmcnt(16)
v_lshlrev_b32 v80, 16, v80
v_mul_f32 v104, 0xbfb8aa3b, v80
v_exp_f32 v104, v104
s_nop 0
v_add_f32 v104, 1.0, v104
v_rcp_f32 v104, v104
s_nop 0
v_mul_f32 v104, v104, v80
v_cvt_pk_bf16_f32 v104, 0, v104
v_and_b32 v80, 0xffff0000, v104
v_lshlrev_b32 v81, 16, v81
v_mul_f32 v104, 0xbfb8aa3b, v81
v_exp_f32 v104, v104
s_nop 0
v_add_f32 v104, 1.0, v104
v_rcp_f32 v104, v104
s_nop 0
v_mul_f32 v104, v104, v81
v_cvt_pk_bf16_f32 v104, 0, v104
v_and_b32 v81, 0xffff0000, v104
v_lshlrev_b32 v82, 16, v82
v_mul_f32 v104, 0xbfb8aa3b, v82
v_exp_f32 v104, v104
s_nop 0
v_add_f32 v104, 1.0, v104
v_rcp_f32 v104, v104
s_nop 0
v_mul_f32 v104, v104, v82
v_cvt_pk_bf16_f32 v104, 0, v104
v_and_b32 v82, 0xffff0000, v104
v_lshlrev_b32 v83, 16, v83
v_mul_f32 v104, 0xbfb8aa3b, v83
v_exp_f32 v104, v104
s_nop 0
v_add_f32 v104, 1.0, v104
v_rcp_f32 v104, v104
s_nop 0
v_mul_f32 v104, v104, v83
v_cvt_pk_bf16_f32 v104, 0, v104
v_and_b32 v83, 0xffff0000, v104
v_lshlrev_b32 v84, 16, v84
v_mul_f32 v104, 0xbfb8aa3b, v84
v_exp_f32 v104, v104
s_nop 0
v_add_f32 v104, 1.0, v104
v_rcp_f32 v104, v104
s_nop 0
v_mul_f32 v104, v104, v84
v_cvt_pk_bf16_f32 v104, 0, v104
v_and_b32 v84, 0xffff0000, v104
v_lshlrev_b32 v85, 16, v85
v_mul_f32 v104, 0xbfb8aa3b, v85
v_exp_f32 v104, v104
s_nop 0
v_add_f32 v104, 1.0, v104
v_rcp_f32 v104, v104
s_nop 0
v_mul_f32 v104, v104, v85
v_cvt_pk_bf16_f32 v104, 0, v104
v_and_b32 v85, 0xffff0000, v104
v_lshlrev_b32 v86, 16, v86
v_mul_f32 v104, 0xbfb8aa3b, v86
v_exp_f32 v104, v104
s_nop 0
v_add_f32 v104, 1.0, v104
v_rcp_f32 v104, v104
s_nop 0
v_mul_f32 v104, v104, v86
v_cvt_pk_bf16_f32 v104, 0, v104
v_and_b32 v86, 0xffff0000, v104
v_lshlrev_b32 v87, 16, v87
v_mul_f32 v104, 0xbfb8aa3b, v87
v_exp_f32 v104, v104
s_nop 0
v_add_f32 v104, 1.0, v104
v_rcp_f32 v104, v104
s_nop 0
v_mul_f32 v104, v104, v87
v_cvt_pk_bf16_f32 v104, 0, v104
v_and_b32 v87, 0xffff0000, v104
v_lshlrev_b32 v88, 16, v88
v_mul_f32 v104, 0xbfb8aa3b, v88
v_exp_f32 v104, v104
s_nop 0
v_add_f32 v104, 1.0, v104
v_rcp_f32 v104, v104
s_nop 0
v_mul_f32 v104, v104, v88
v_cvt_pk_bf16_f32 v104, 0, v104
v_and_b32 v88, 0xffff0000, v104
v_lshlrev_b32 v89, 16, v89
v_mul_f32 v104, 0xbfb8aa3b, v89
v_exp_f32 v104, v104
s_nop 0
v_add_f32 v104, 1.0, v104
v_rcp_f32 v104, v104
s_nop 0
v_mul_f32 v104, v104, v89
v_cvt_pk_bf16_f32 v104, 0, v104
v_and_b32 v89, 0xffff0000, v104
v_lshlrev_b32 v90, 16, v90
v_mul_f32 v104, 0xbfb8aa3b, v90
v_exp_f32 v104, v104
s_nop 0
v_add_f32 v104, 1.0, v104
v_rcp_f32 v104, v104
s_nop 0
v_mul_f32 v104, v104, v90
v_cvt_pk_bf16_f32 v104, 0, v104
v_and_b32 v90, 0xffff0000, v104
v_lshlrev_b32 v91, 16, v91
v_mul_f32 v104, 0xbfb8aa3b, v91
v_exp_f32 v104, v104
s_nop 0
v_add_f32 v104, 1.0, v104
v_rcp_f32 v104, v104
s_nop 0
v_mul_f32 v104, v104, v91
v_cvt_pk_bf16_f32 v104, 0, v104
v_and_b32 v91, 0xffff0000, v104
v_lshlrev_b32 v92, 16, v92
v_mul_f32 v104, 0xbfb8aa3b, v92
v_exp_f32 v104, v104
s_nop 0
v_add_f32 v104, 1.0, v104
v_rcp_f32 v104, v104
s_nop 0
v_mul_f32 v104, v104, v92
v_cvt_pk_bf16_f32 v104, 0, v104
v_and_b32 v92, 0xffff0000, v104
v_lshlrev_b32 v93, 16, v93
v_mul_f32 v104, 0xbfb8aa3b, v93
v_exp_f32 v104, v104
s_nop 0
v_add_f32 v104, 1.0, v104
v_rcp_f32 v104, v104
s_nop 0
v_mul_f32 v104, v104, v93
v_cvt_pk_bf16_f32 v104, 0, v104
v_and_b32 v93, 0xffff0000, v104
v_lshlrev_b32 v94, 16, v94
v_mul_f32 v104, 0xbfb8aa3b, v94
v_exp_f32 v104, v104
s_nop 0
v_add_f32 v104, 1.0, v104
v_rcp_f32 v104, v104
s_nop 0
v_mul_f32 v104, v104, v94
v_cvt_pk_bf16_f32 v104, 0, v104
v_and_b32 v94, 0xffff0000, v104
v_lshlrev_b32 v95, 16, v95
v_mul_f32 v104, 0xbfb8aa3b, v95
v_exp_f32 v104, v104
s_nop 0
v_add_f32 v104, 1.0, v104
v_rcp_f32 v104, v104
s_nop 0
v_mul_f32 v104, v104, v95
v_cvt_pk_bf16_f32 v104, 0, v104
v_and_b32 v95, 0xffff0000, v104
s_waitcnt vmcnt(15)
v_lshlrev_b32 v104, 16, v16
v_and_b32 v105, 0xffff0000, v16
v_fmac_f32 v96, v104, v80
v_fmac_f32 v97, v105, v80
v_lshlrev_b32 v104, 16, v17
v_and_b32 v105, 0xffff0000, v17
v_fmac_f32 v98, v104, v80
v_fmac_f32 v99, v105, v80
v_lshlrev_b32 v104, 16, v18
v_and_b32 v105, 0xffff0000, v18
v_fmac_f32 v100, v104, v80
v_fmac_f32 v101, v105, v80
v_lshlrev_b32 v104, 16, v19
v_and_b32 v105, 0xffff0000, v19
v_fmac_f32 v102, v104, v80
v_fmac_f32 v103, v105, v80
s_waitcnt vmcnt(14)
v_lshlrev_b32 v104, 16, v20
v_and_b32 v105, 0xffff0000, v20
v_fmac_f32 v96, v104, v81
v_fmac_f32 v97, v105, v81
v_lshlrev_b32 v104, 16, v21
v_and_b32 v105, 0xffff0000, v21
v_fmac_f32 v98, v104, v81
v_fmac_f32 v99, v105, v81
v_lshlrev_b32 v104, 16, v22
v_and_b32 v105, 0xffff0000, v22
v_fmac_f32 v100, v104, v81
v_fmac_f32 v101, v105, v81
v_lshlrev_b32 v104, 16, v23
v_and_b32 v105, 0xffff0000, v23
v_fmac_f32 v102, v104, v81
v_fmac_f32 v103, v105, v81
s_waitcnt vmcnt(13)
v_lshlrev_b32 v104, 16, v24
v_and_b32 v105, 0xffff0000, v24
v_fmac_f32 v96, v104, v82
v_fmac_f32 v97, v105, v82
v_lshlrev_b32 v104, 16, v25
v_and_b32 v105, 0xffff0000, v25
v_fmac_f32 v98, v104, v82
v_fmac_f32 v99, v105, v82
v_lshlrev_b32 v104, 16, v26
v_and_b32 v105, 0xffff0000, v26
v_fmac_f32 v100, v104, v82
v_fmac_f32 v101, v105, v82
v_lshlrev_b32 v104, 16, v27
v_and_b32 v105, 0xffff0000, v27
v_fmac_f32 v102, v104, v82
v_fmac_f32 v103, v105, v82
s_waitcnt vmcnt(12)
v_lshlrev_b32 v104, 16, v28
v_and_b32 v105, 0xffff0000, v28
v_fmac_f32 v96, v104, v83
v_fmac_f32 v97, v105, v83
v_lshlrev_b32 v104, 16, v29
v_and_b32 v105, 0xffff0000, v29
v_fmac_f32 v98, v104, v83
v_fmac_f32 v99, v105, v83
v_lshlrev_b32 v104, 16, v30
v_and_b32 v105, 0xffff0000, v30
v_fmac_f32 v100, v104, v83
v_fmac_f32 v101, v105, v83
v_lshlrev_b32 v104, 16, v31
v_and_b32 v105, 0xffff0000, v31
v_fmac_f32 v102, v104, v83
v_fmac_f32 v103, v105, v83
s_waitcnt vmcnt(11)
v_lshlrev_b32 v104, 16, v32
v_and_b32 v105, 0xffff0000, v32
v_fmac_f32 v96, v104, v84
v_fmac_f32 v97, v105, v84
v_lshlrev_b32 v104, 16, v33
v_and_b32 v105, 0xffff0000, v33
v_fmac_f32 v98, v104, v84
v_fmac_f32 v99, v105, v84
v_lshlrev_b32 v104, 16, v34
v_and_b32 v105, 0xffff0000, v34
v_fmac_f32 v100, v104, v84
v_fmac_f32 v101, v105, v84
v_lshlrev_b32 v104, 16, v35
v_and_b32 v105, 0xffff0000, v35
v_fmac_f32 v102, v104, v84
v_fmac_f32 v103, v105, v84
s_waitcnt vmcnt(10)
v_lshlrev_b32 v104, 16, v36
v_and_b32 v105, 0xffff0000, v36
v_fmac_f32 v96, v104, v85
v_fmac_f32 v97, v105, v85
v_lshlrev_b32 v104, 16, v37
v_and_b32 v105, 0xffff0000, v37
v_fmac_f32 v98, v104, v85
v_fmac_f32 v99, v105, v85
v_lshlrev_b32 v104, 16, v38
v_and_b32 v105, 0xffff0000, v38
v_fmac_f32 v100, v104, v85
v_fmac_f32 v101, v105, v85
v_lshlrev_b32 v104, 16, v39
v_and_b32 v105, 0xffff0000, v39
v_fmac_f32 v102, v104, v85
v_fmac_f32 v103, v105, v85
s_waitcnt vmcnt(9)
v_lshlrev_b32 v104, 16, v40
v_and_b32 v105, 0xffff0000, v40
v_fmac_f32 v96, v104, v86
v_fmac_f32 v97, v105, v86
v_lshlrev_b32 v104, 16, v41
v_and_b32 v105, 0xffff0000, v41
v_fmac_f32 v98, v104, v86
v_fmac_f32 v99, v105, v86
v_lshlrev_b32 v104, 16, v42
v_and_b32 v105, 0xffff0000, v42
v_fmac_f32 v100, v104, v86
v_fmac_f32 v101, v105, v86
v_lshlrev_b32 v104, 16, v43
v_and_b32 v105, 0xffff0000, v43
v_fmac_f32 v102, v104, v86
v_fmac_f32 v103, v105, v86
s_waitcnt vmcnt(8)
v_lshlrev_b32 v104, 16, v44
v_and_b32 v105, 0xffff0000, v44
v_fmac_f32 v96, v104, v87
v_fmac_f32 v97, v105, v87
v_lshlrev_b32 v104, 16, v45
v_and_b32 v105, 0xffff0000, v45
v_fmac_f32 v98, v104, v87
v_fmac_f32 v99, v105, v87
v_lshlrev_b32 v104, 16, v46
v_and_b32 v105, 0xffff0000, v46
v_fmac_f32 v100, v104, v87
v_fmac_f32 v101, v105, v87
v_lshlrev_b32 v104, 16, v47
v_and_b32 v105, 0xffff0000, v47
v_fmac_f32 v102, v104, v87
v_fmac_f32 v103, v105, v87
s_waitcnt vmcnt(7)
v_lshlrev_b32 v104, 16, v48
v_and_b32 v105, 0xffff0000, v48
v_fmac_f32 v96, v104, v88
v_fmac_f32 v97, v105, v88
v_lshlrev_b32 v104, 16, v49
v_and_b32 v105, 0xffff0000, v49
v_fmac_f32 v98, v104, v88
v_fmac_f32 v99, v105, v88
v_lshlrev_b32 v104, 16, v50
v_and_b32 v105, 0xffff0000, v50
v_fmac_f32 v100, v104, v88
v_fmac_f32 v101, v105, v88
v_lshlrev_b32 v104, 16, v51
v_and_b32 v105, 0xffff0000, v51
v_fmac_f32 v102, v104, v88
v_fmac_f32 v103, v105, v88
s_waitcnt vmcnt(6)
v_lshlrev_b32 v104, 16, v52
v_and_b32 v105, 0xffff0000, v52
v_fmac_f32 v96, v104, v89
v_fmac_f32 v97, v105, v89
v_lshlrev_b32 v104, 16, v53
v_and_b32 v105, 0xffff0000, v53
v_fmac_f32 v98, v104, v89
v_fmac_f32 v99, v105, v89
v_lshlrev_b32 v104, 16, v54
v_and_b32 v105, 0xffff0000, v54
v_fmac_f32 v100, v104, v89
v_fmac_f32 v101, v105, v89
v_lshlrev_b32 v104, 16, v55
v_and_b32 v105, 0xffff0000, v55
v_fmac_f32 v102, v104, v89
v_fmac_f32 v103, v105, v89
s_waitcnt vmcnt(5)
v_lshlrev_b32 v104, 16, v56
v_and_b32 v105, 0xffff0000, v56
v_fmac_f32 v96, v104, v90
v_fmac_f32 v97, v105, v90
v_lshlrev_b32 v104, 16, v57
v_and_b32 v105, 0xffff0000, v57
v_fmac_f32 v98, v104, v90
v_fmac_f32 v99, v105, v90
v_lshlrev_b32 v104, 16, v58
v_and_b32 v105, 0xffff0000, v58
v_fmac_f32 v100, v104, v90
v_fmac_f32 v101, v105, v90
v_lshlrev_b32 v104, 16, v59
v_and_b32 v105, 0xffff0000, v59
v_fmac_f32 v102, v104, v90
v_fmac_f32 v103, v105, v90
s_waitcnt vmcnt(4)
v_lshlrev_b32 v104, 16, v60
v_and_b32 v105, 0xffff0000, v60
v_fmac_f32 v96, v104, v91
v_fmac_f32 v97, v105, v91
v_lshlrev_b32 v104, 16, v61
v_and_b32 v105, 0xffff0000, v61
v_fmac_f32 v98, v104, v91
v_fmac_f32 v99, v105, v91
v_lshlrev_b32 v104, 16, v62
v_and_b32 v105, 0xffff0000, v62
v_fmac_f32 v100, v104, v91
v_fmac_f32 v101, v105, v91
v_lshlrev_b32 v104, 16, v63
v_and_b32 v105, 0xffff0000, v63
v_fmac_f32 v102, v104, v91
v_fmac_f32 v103, v105, v91
s_waitcnt vmcnt(3)
v_lshlrev_b32 v104, 16, v64
v_and_b32 v105, 0xffff0000, v64
v_fmac_f32 v96, v104, v92
v_fmac_f32 v97, v105, v92
v_lshlrev_b32 v104, 16, v65
v_and_b32 v105, 0xffff0000, v65
v_fmac_f32 v98, v104, v92
v_fmac_f32 v99, v105, v92
v_lshlrev_b32 v104, 16, v66
v_and_b32 v105, 0xffff0000, v66
v_fmac_f32 v100, v104, v92
v_fmac_f32 v101, v105, v92
v_lshlrev_b32 v104, 16, v67
v_and_b32 v105, 0xffff0000, v67
v_fmac_f32 v102, v104, v92
v_fmac_f32 v103, v105, v92
s_waitcnt vmcnt(2)
v_lshlrev_b32 v104, 16, v68
v_and_b32 v105, 0xffff0000, v68
v_fmac_f32 v96, v104, v93
v_fmac_f32 v97, v105, v93
v_lshlrev_b32 v104, 16, v69
v_and_b32 v105, 0xffff0000, v69
v_fmac_f32 v98, v104, v93
v_fmac_f32 v99, v105, v93
v_lshlrev_b32 v104, 16, v70
v_and_b32 v105, 0xffff0000, v70
v_fmac_f32 v100, v104, v93
v_fmac_f32 v101, v105, v93
v_lshlrev_b32 v104, 16, v71
v_and_b32 v105, 0xffff0000, v71
v_fmac_f32 v102, v104, v93
v_fmac_f32 v103, v105, v93
s_waitcnt vmcnt(1)
v_lshlrev_b32 v104, 16, v72
v_and_b32 v105, 0xffff0000, v72
v_fmac_f32 v96, v104, v94
v_fmac_f32 v97, v105, v94
v_lshlrev_b32 v104, 16, v73
v_and_b32 v105, 0xffff0000, v73
v_fmac_f32 v98, v104, v94
v_fmac_f32 v99, v105, v94
v_lshlrev_b32 v104, 16, v74
v_and_b32 v105, 0xffff0000, v74
v_fmac_f32 v100, v104, v94
v_fmac_f32 v101, v105, v94
v_lshlrev_b32 v104, 16, v75
v_and_b32 v105, 0xffff0000, v75
v_fmac_f32 v102, v104, v94
v_fmac_f32 v103, v105, v94
s_waitcnt vmcnt(0)
v_lshlrev_b32 v104, 16, v76
v_and_b32 v105, 0xffff0000, v76
v_fmac_f32 v96, v104, v95
v_fmac_f32 v97, v105, v95
v_lshlrev_b32 v104, 16, v77
v_and_b32 v105, 0xffff0000, v77
v_fmac_f32 v98, v104, v95
v_fmac_f32 v99, v105, v95
v_lshlrev_b32 v104, 16, v78
v_and_b32 v105, 0xffff0000, v78
v_fmac_f32 v100, v104, v95
v_fmac_f32 v101, v105, v95
v_lshlrev_b32 v104, 16, v79
v_and_b32 v105, 0xffff0000, v79
v_fmac_f32 v102, v104, v95
v_fmac_f32 v103, v105, v95
s_nop 1
v_add_f32_dpp v96, v96, v96 row_ror:4 row_mask:0xf bank_mask:0xf
s_nop 1
v_add_f32_dpp v96, v96, v96 row_ror:8 row_mask:0xf bank_mask:0xf
v_mov_b32 v104, v96
s_nop 1
v_permlane16_swap_b32 v96, v104
s_nop 0
v_add_f32 v96, v96, v104
v_mov_b32 v104, v96
s_nop 1
v_permlane32_swap_b32 v96, v104
s_nop 0
v_add_f32 v96, v96, v104
s_nop 1
v_add_f32_dpp v97, v97, v97 row_ror:4 row_mask:0xf bank_mask:0xf
s_nop 1
v_add_f32_dpp v97, v97, v97 row_ror:8 row_mask:0xf bank_mask:0xf
v_mov_b32 v104, v97
s_nop 1
v_permlane16_swap_b32 v97, v104
s_nop 0
v_add_f32 v97, v97, v104
v_mov_b32 v104, v97
s_nop 1
v_permlane32_swap_b32 v97, v104
s_nop 0
v_add_f32 v97, v97, v104
s_nop 1
v_add_f32_dpp v98, v98, v98 row_ror:4 row_mask:0xf bank_mask:0xf
s_nop 1
v_add_f32_dpp v98, v98, v98 row_ror:8 row_mask:0xf bank_mask:0xf
v_mov_b32 v104, v98
s_nop 1
v_permlane16_swap_b32 v98, v104
s_nop 0
v_add_f32 v98, v98, v104
v_mov_b32 v104, v98
s_nop 1
v_permlane32_swap_b32 v98, v104
s_nop 0
v_add_f32 v98, v98, v104
s_nop 1
v_add_f32_dpp v99, v99, v99 row_ror:4 row_mask:0xf bank_mask:0xf
s_nop 1
v_add_f32_dpp v99, v99, v99 row_ror:8 row_mask:0xf bank_mask:0xf
v_mov_b32 v104, v99
s_nop 1
v_permlane16_swap_b32 v99, v104
s_nop 0
v_add_f32 v99, v99, v104
v_mov_b32 v104, v99
s_nop 1
v_permlane32_swap_b32 v99, v104
s_nop 0
v_add_f32 v99, v99, v104
s_nop 1
v_add_f32_dpp v100, v100, v100 row_ror:4 row_mask:0xf bank_mask:0xf
s_nop 1
v_add_f32_dpp v100, v100, v100 row_ror:8 row_mask:0xf bank_mask:0xf
v_mov_b32 v104, v100
s_nop 1
v_permlane16_swap_b32 v100, v104
s_nop 0
v_add_f32 v100, v100, v104
v_mov_b32 v104, v100
s_nop 1
v_permlane32_swap_b32 v100, v104
s_nop 0
v_add_f32 v100, v100, v104
s_nop 1
v_add_f32_dpp v101, v101, v101 row_ror:4 row_mask:0xf bank_mask:0xf
s_nop 1
v_add_f32_dpp v101, v101, v101 row_ror:8 row_mask:0xf bank_mask:0xf
v_mov_b32 v104, v101
s_nop 1
v_permlane16_swap_b32 v101, v104
s_nop 0
v_add_f32 v101, v101, v104
v_mov_b32 v104, v101
s_nop 1
v_permlane32_swap_b32 v101, v104
s_nop 0
v_add_f32 v101, v101, v104
s_nop 1
v_add_f32_dpp v102, v102, v102 row_ror:4 row_mask:0xf bank_mask:0xf
s_nop 1
v_add_f32_dpp v102, v102, v102 row_ror:8 row_mask:0xf bank_mask:0xf
v_mov_b32 v104, v102
s_nop 1
v_permlane16_swap_b32 v102, v104
s_nop 0
v_add_f32 v102, v102, v104
v_mov_b32 v104, v102
s_nop 1
v_permlane32_swap_b32 v102, v104
s_nop 0
v_add_f32 v102, v102, v104
s_nop 1
v_add_f32_dpp v103, v103, v103 row_ror:4 row_mask:0xf bank_mask:0xf
s_nop 1
v_add_f32_dpp v103, v103, v103 row_ror:8 row_mask:0xf bank_mask:0xf
v_mov_b32 v104, v103
s_nop 1
v_permlane16_swap_b32 v103, v104
s_nop 0
v_add_f32 v103, v103, v104
v_mov_b32 v104, v103
s_nop 1
v_permlane32_swap_b32 v103, v104
s_nop 0
v_add_f32 v103, v103, v104
s_lshl_b32 s40, s32, 7
v_lshl_add_u32 v4, v3, 5, s40
ds_write_b128 v4, v[96:99]
ds_write_b128 v4, v[100:103] offset:16
s_waitcnt lgkmcnt(0)
s_barrier
v_and_b32 v4, 31, v0
v_lshlrev_b32 v4, 2, v4
ds_read_b32 v96, v4 offset:0
ds_read_b32 v97, v4 offset:128
ds_read_b32 v98, v4 offset:256
ds_read_b32 v99, v4 offset:384
v_lshrrev_b32 v5, 5, v0
v_min_u32 v5, 1, v5
v_lshl_add_u32 v4, v5, 30, v4
s_lshl_b32 s40, s26, 7
s_add_u32 s40, s40, 3145728
s_waitcnt lgkmcnt(0)
v_add_f32 v96, v96, v97
v_add_f32 v98, v98, v99
v_add_f32 v96, v96, v98
v_cvt_pk_bf16_f32 v96, 0, v96
v_and_b32 v96, 0xffff0000, v96
buffer_store_dword v96, v4, s[4:7], s40 offen sc1
s_cmp_lt_u32 s26, 128
s_cbranch_scc1 Lmd_607
v_mov_b32 v14, 4
s_waitcnt vmcnt(0)
buffer_store_dword v14, v10, s[4:7], 0 offen sc1
v_mov_b32 v4, v8
v_mov_b32 v5, 0
s_cmp_ge_u32 s34, 30
s_cbranch_scc1 Lln_6
s_load_dwordx2 s[16:17], s[0:1], 64
s_load_dwordx2 s[18:19], s[0:1], 72
s_load_dwordx2 s[20:21], s[0:1], 80
s_waitcnt lgkmcnt(0)
s_mov_b32 s8, s16
s_and_b32 s9, s17, 0xffff
s_mov_b32 s10, 0x700000
s_mov_b32 s11, 0x20000
s_mov_b32 s84, s18
s_and_b32 s85, s19, 0xffff
s_mov_b32 s86, 0x700000
s_mov_b32 s87, 0x20000
s_mov_b32 s88, s20
s_and_b32 s89, s21, 0xffff
s_mov_b32 s90, 0x700000
s_mov_b32 s91, 0x20000
s_lshl_b32 s60, s44, 7
s_lshl_b32 s52, s32, 5
v_bfe_u32 v84, v9, 2, 2
v_lshrrev_b32 v85, 4, v9
v_lshl_add_u32 v84, v85, 3, v84
v_lshl_add_u32 v84, v84, 7, s52
v_and_b32 v85, 3, v9
v_lshl_add_u32 v84, v85, 3, v84
v_add_u32 v80, 0, v84
v_bfe_u32 v84, v9, 2, 2
v_lshrrev_b32 v85, 4, v9
v_lshl_add_u32 v84, v85, 3, v84
v_lshl_add_u32 v84, v84, 7, s52
v_and_b32 v85, 3, v9
v_lshl_add_u32 v84, v85, 3, v84
v_add_u32 v81, 16384, v84
v_lshrrev_b32 v84, 3, v9
s_lshl_b32 s38, s32, 5
v_add_u32 v84, s38, v84
v_mul_u32_u24 v84, 7168, v84
v_and_b32 v85, 7, v9
v_lshl_add_u32 v84, v85, 4, v84
s_lshl_b32 s38, s32, 12
s_barrier
s_add_u32 m0, s38, 0
s_add_u32 s39, s60, 0
buffer_load_dwordx4 v84, s[8:11], s39 offen lds
s_add_u32 m0, s38, 1024
s_add_u32 s39, s60, 57344
buffer_load_dwordx4 v84, s[8:11], s39 offen lds
s_add_u32 m0, s38, 2048
s_add_u32 s39, s60, 114688
buffer_load_dwordx4 v84, s[8:11], s39 offen lds
s_add_u32 m0, s38, 3072
s_add_u32 s39, s60, 172032
buffer_load_dwordx4 v84, s[8:11], s39 offen lds
s_add_u32 m0, s38, 16384
s_add_u32 s39, s60, 0
buffer_load_dwordx4 v84, s[84:87], s39 offen lds
s_add_u32 m0, s38, 17408
s_add_u32 s39, s60, 57344
buffer_load_dwordx4 v84, s[84:87], s39 offen lds
s_add_u32 m0, s38, 18432
s_add_u32 s39, s60, 114688
buffer_load_dwordx4 v84, s[84:87], s39 offen lds
s_add_u32 m0, s38, 19456
s_add_u32 s39, s60, 172032
buffer_load_dwordx4 v84, s[84:87], s39 offen lds
s_add_u32 m0, s38, 32768
s_add_u32 s39, s60, 917504
buffer_load_dwordx4 v84, s[8:11], s39 offen lds
s_add_u32 m0, s38, 33792
s_add_u32 s39, s60, 974848
buffer_load_dwordx4 v84, s[8:11], s39 offen lds
s_add_u32 m0, s38, 34816
s_add_u32 s39, s60, 1032192
buffer_load_dwordx4 v84, s[8:11], s39 offen lds
s_add_u32 m0, s38, 35840
s_add_u32 s39, s60, 1089536
buffer_load_dwordx4 v84, s[8:11], s39 offen lds
s_add_u32 m0, s38, 49152
s_add_u32 s39, s60, 917504
buffer_load_dwordx4 v84, s[84:87], s39 offen lds
s_add_u32 m0, s38, 50176
s_add_u32 s39, s60, 974848
buffer_load_dwordx4 v84, s[84:87], s39 offen lds
s_add_u32 m0, s38, 51200
s_add_u32 s39, s60, 1032192
buffer_load_dwordx4 v84, s[84:87], s39 offen lds
s_add_u32 m0, s38, 52224
s_add_u32 s39, s60, 1089536
buffer_load_dwordx4 v84, s[84:87], s39 offen lds
s_add_u32 m0, s38, 65536
s_add_u32 s39, s60, 1835008
buffer_load_dwordx4 v84, s[8:11], s39 offen lds
s_add_u32 m0, s38, 66560
s_add_u32 s39, s60, 1892352
buffer_load_dwordx4 v84, s[8:11], s39 offen lds
s_add_u32 m0, s38, 67584
s_add_u32 s39, s60, 1949696
buffer_load_dwordx4 v84, s[8:11], s39 offen lds
s_add_u32 m0, s38, 68608
s_add_u32 s39, s60, 2007040
buffer_load_dwordx4 v84, s[8:11], s39 offen lds
s_add_u32 m0, s38, 81920
s_add_u32 s39, s60, 1835008
buffer_load_dwordx4 v84, s[84:87], s39 offen lds
s_add_u32 m0, s38, 82944
s_add_u32 s39, s60, 1892352
buffer_load_dwordx4 v84, s[84:87], s39 offen lds
s_add_u32 m0, s38, 83968
s_add_u32 s39, s60, 1949696
buffer_load_dwordx4 v84, s[84:87], s39 offen lds
s_add_u32 m0, s38, 84992
s_add_u32 s39, s60, 2007040
buffer_load_dwordx4 v84, s[84:87], s39 offen lds
s_waitcnt vmcnt(16)
s_barrier
ds_read_b64_tr_b16 a[0:1], v80 offset:0
ds_read_b64_tr_b16 a[2:3], v80 offset:512
ds_read_b64_tr_b16 a[4:5], v80 offset:4096
ds_read_b64_tr_b16 a[6:7], v80 offset:4608
ds_read_b64_tr_b16 a[8:9], v80 offset:8192
ds_read_b64_tr_b16 a[10:11], v80 offset:8704
ds_read_b64_tr_b16 a[12:13], v80 offset:12288
ds_read_b64_tr_b16 a[14:15], v80 offset:12800
ds_read_b64_tr_b16 a[128:129], v81 offset:0
ds_read_b64_tr_b16 a[130:131], v81 offset:512
ds_read_b64_tr_b16 a[132:133], v81 offset:4096
ds_read_b64_tr_b16 a[134:135], v81 offset:4608
ds_read_b64_tr_b16 a[136:137], v81 offset:8192
ds_read_b64_tr_b16 a[138:139], v81 offset:8704
ds_read_b64_tr_b16 a[140:141], v81 offset:12288
ds_read_b64_tr_b16 a[142:143], v81 offset:12800
v_add_u32 v80, 32768, v80
v_add_u32 v81, 32768, v81
s_waitcnt lgkmcnt(0)
s_barrier
s_add_u32 m0, s38, 0
s_add_u32 s39, s60, 2752512
buffer_load_dwordx4 v84, s[8:11], s39 offen lds
s_add_u32 m0, s38, 1024
s_add_u32 s39, s60, 2809856
buffer_load_dwordx4 v84, s[8:11], s39 offen lds
s_add_u32 m0, s38, 2048
s_add_u32 s39, s60, 2867200
buffer_load_dwordx4 v84, s[8:11], s39 offen lds
s_add_u32 m0, s38, 3072
s_add_u32 s39, s60, 2924544
buffer_load_dwordx4 v84, s[8:11], s39 offen lds
s_add_u32 m0, s38, 16384
s_add_u32 s39, s60, 2752512
buffer_load_dwordx4 v84, s[84:87], s39 offen lds
s_add_u32 m0, s38, 17408
s_add_u32 s39, s60, 2809856
buffer_load_dwordx4 v84, s[84:87], s39 offen lds
s_add_u32 m0, s38, 18432
s_add_u32 s39, s60, 2867200
buffer_load_dwordx4 v84, s[84:87], s39 offen lds
s_add_u32 m0, s38, 19456
s_add_u32 s39, s60, 2924544
buffer_load_dwordx4 v84, s[84:87], s39 offen lds
s_waitcnt vmcnt(16)
s_barrier
ds_read_b64_tr_b16 a[16:17], v80 offset:0
ds_read_b64_tr_b16 a[18:19], v80 offset:512
ds_read_b64_tr_b16 a[20:21], v80 offset:4096
ds_read_b64_tr_b16 a[22:23], v80 offset:4608
ds_read_b64_tr_b16 a[24:25], v80 offset:8192
ds_read_b64_tr_b16 a[26:27], v80 offset:8704
ds_read_b64_tr_b16 a[28:29], v80 offset:12288
ds_read_b64_tr_b16 a[30:31], v80 offset:12800
ds_read_b64_tr_b16 a[144:145], v81 offset:0
ds_read_b64_tr_b16 a[146:147], v81 offset:512
ds_read_b64_tr_b16 a[148:149], v81 offset:4096
ds_read_b64_tr_b16 a[150:151], v81 offset:4608
ds_read_b64_tr_b16 a[152:153], v81 offset:8192
ds_read_b64_tr_b16 a[154:155], v81 offset:8704
ds_read_b64_tr_b16 a[156:157], v81 offset:12288
ds_read_b64_tr_b16 a[158:159], v81 offset:12800
v_add_u32 v80, 32768, v80
v_add_u32 v81, 32768, v81
s_waitcnt lgkmcnt(0)
s_barrier
s_add_u32 m0, s38, 32768
s_add_u32 s39, s60, 3670016
buffer_load_dwordx4 v84, s[8:11], s39 offen lds
s_add_u32 m0, s38, 33792
s_add_u32 s39, s60, 3727360
buffer_load_dwordx4 v84, s[8:11], s39 offen lds
s_add_u32 m0, s38, 34816
s_add_u32 s39, s60, 3784704
buffer_load_dwordx4 v84, s[8:11], s39 offen lds
s_add_u32 m0, s38, 35840
s_add_u32 s39, s60, 3842048
buffer_load_dwordx4 v84, s[8:11], s39 offen lds
s_add_u32 m0, s38, 49152
s_add_u32 s39, s60, 3670016
buffer_load_dwordx4 v84, s[84:87], s39 offen lds
s_add_u32 m0, s38, 50176
s_add_u32 s39, s60, 3727360
buffer_load_dwordx4 v84, s[84:87], s39 offen lds
s_add_u32 m0, s38, 51200
s_add_u32 s39, s60, 3784704
buffer_load_dwordx4 v84, s[84:87], s39 offen lds
s_add_u32 m0, s38, 52224
s_add_u32 s39, s60, 3842048
buffer_load_dwordx4 v84, s[84:87], s39 offen lds
s_waitcnt vmcnt(16)
s_barrier
ds_read_b64_tr_b16 a[32:33], v80 offset:0
ds_read_b64_tr_b16 a[34:35], v80 offset:512
ds_read_b64_tr_b16 a[36:37], v80 offset:4096
ds_read_b64_tr_b16 a[38:39], v80 offset:4608
ds_read_b64_tr_b16 a[40:41], v80 offset:8192
ds_read_b64_tr_b16 a[42:43], v80 offset:8704
ds_read_b64_tr_b16 a[44:45], v80 offset:12288
ds_read_b64_tr_b16 a[46:47], v80 offset:12800
ds_read_b64_tr_b16 a[160:161], v81 offset:0
ds_read_b64_tr_b16 a[162:163], v81 offset:512
ds_read_b64_tr_b16 a[164:165], v81 offset:4096
ds_read_b64_tr_b16 a[166:167], v81 offset:4608
ds_read_b64_tr_b16 a[168:169], v81 offset:8192
ds_read_b64_tr_b16 a[170:171], v81 offset:8704
ds_read_b64_tr_b16 a[172:173], v81 offset:12288
ds_read_b64_tr_b16 a[174:175], v81 offset:12800
v_add_u32 v80, -65536, v80
v_add_u32 v81, -65536, v81
s_waitcnt lgkmcnt(0)
s_barrier
s_add_u32 m0, s38, 65536
s_add_u32 s39, s60, 4587520
buffer_load_dwordx4 v84, s[8:11], s39 offen lds
s_add_u32 m0, s38, 66560
s_add_u32 s39, s60, 4644864
buffer_load_dwordx4 v84, s[8:11], s39 offen lds
s_add_u32 m0, s38, 67584
s_add_u32 s39, s60, 4702208
buffer_load_dwordx4 v84, s[8:11], s39 offen lds
s_add_u32 m0, s38, 68608
s_add_u32 s39, s60, 4759552
buffer_load_dwordx4 v84, s[8:11], s39 offen lds
s_add_u32 m0, s38, 81920
s_add_u32 s39, s60, 4587520
buffer_load_dwordx4 v84, s[84:87], s39 offen lds
s_add_u32 m0, s38, 82944
s_add_u32 s39, s60, 4644864
buffer_load_dwordx4 v84, s[84:87], s39 offen lds
s_add_u32 m0, s38, 83968
s_add_u32 s39, s60, 4702208
buffer_load_dwordx4 v84, s[84:87], s39 offen lds
s_add_u32 m0, s38, 84992
s_add_u32 s39, s60, 4759552
buffer_load_dwordx4 v84, s[84:87], s39 offen lds
s_waitcnt vmcnt(16)
s_barrier
ds_read_b64_tr_b16 a[48:49], v80 offset:0
ds_read_b64_tr_b16 a[50:51], v80 offset:512
ds_read_b64_tr_b16 a[52:53], v80 offset:4096
ds_read_b64_tr_b16 a[54:55], v80 offset:4608
ds_read_b64_tr_b16 a[56:57], v80 offset:8192
ds_read_b64_tr_b16 a[58:59], v80 offset:8704
ds_read_b64_tr_b16 a[60:61], v80 offset:12288
ds_read_b64_tr_b16 a[62:63], v80 offset:12800
ds_read_b64_tr_b16 a[176:177], v81 offset:0
ds_read_b64_tr_b16 a[178:179], v81 offset:512
ds_read_b64_tr_b16 a[180:181], v81 offset:4096
ds_read_b64_tr_b16 a[182:183], v81 offset:4608
ds_read_b64_tr_b16 a[184:185], v81 offset:8192
ds_read_b64_tr_b16 a[186:187], v81 offset:8704
ds_read_b64_tr_b16 a[188:189], v81 offset:12288
ds_read_b64_tr_b16 a[190:191], v81 offset:12800
v_add_u32 v80, 32768, v80
v_add_u32 v81, 32768, v81
s_waitcnt lgkmcnt(0)
s_barrier
s_add_u32 m0, s38, 0
s_add_u32 s39, s60, 5505024
buffer_load_dwordx4 v84, s[8:11], s39 offen lds
s_add_u32 m0, s38, 1024
s_add_u32 s39, s60, 5562368
buffer_load_dwordx4 v84, s[8:11], s39 offen lds
s_add_u32 m0, s38, 2048
s_add_u32 s39, s60, 5619712
buffer_load_dwordx4 v84, s[8:11], s39 offen lds
s_add_u32 m0, s38, 3072
s_add_u32 s39, s60, 5677056
buffer_load_dwordx4 v84, s[8:11], s39 offen lds
s_add_u32 m0, s38, 16384
s_add_u32 s39, s60, 5505024
buffer_load_dwordx4 v84, s[84:87], s39 offen lds
s_add_u32 m0, s38, 17408
s_add_u32 s39, s60, 5562368
buffer_load_dwordx4 v84, s[84:87], s39 offen lds
s_add_u32 m0, s38, 18432
s_add_u32 s39, s60, 5619712
buffer_load_dwordx4 v84, s[84:87], s39 offen lds
s_add_u32 m0, s38, 19456
s_add_u32 s39, s60, 5677056
buffer_load_dwordx4 v84, s[84:87], s39 offen lds
s_waitcnt vmcnt(16)
s_barrier
ds_read_b64_tr_b16 a[64:65], v80 offset:0
ds_read_b64_tr_b16 a[66:67], v80 offset:512
ds_read_b64_tr_b16 a[68:69], v80 offset:4096
ds_read_b64_tr_b16 a[70:71], v80 offset:4608
ds_read_b64_tr_b16 a[72:73], v80 offset:8192
ds_read_b64_tr_b16 a[74:75], v80 offset:8704
ds_read_b64_tr_b16 a[76:77], v80 offset:12288
ds_read_b64_tr_b16 a[78:79], v80 offset:12800
ds_read_b64_tr_b16 a[192:193], v81 offset:0
ds_read_b64_tr_b16 a[194:195], v81 offset:512
ds_read_b64_tr_b16 a[196:197], v81 offset:4096
ds_read_b64_tr_b16 a[198:199], v81 offset:4608
ds_read_b64_tr_b16 a[200:201], v81 offset:8192
ds_read_b64_tr_b16 a[202:203], v81 offset:8704
ds_read_b64_tr_b16 a[204:205], v81 offset:12288
ds_read_b64_tr_b16 a[206:207], v81 offset:12800
v_add_u32 v80, 32768, v80
v_add_u32 v81, 32768, v81
s_waitcnt lgkmcnt(0)
s_barrier
s_add_u32 m0, s38, 32768
s_add_u32 s39, s60, 6422528
buffer_load_dwordx4 v84, s[8:11], s39 offen lds
s_add_u32 m0, s38, 33792
s_add_u32 s39, s60, 6479872
buffer_load_dwordx4 v84, s[8:11], s39 offen lds
s_add_u32 m0, s38, 34816
s_add_u32 s39, s60, 6537216
buffer_load_dwordx4 v84, s[8:11], s39 offen lds
s_add_u32 m0, s38, 35840
s_add_u32 s39, s60, 6594560
buffer_load_dwordx4 v84, s[8:11], s39 offen lds
s_add_u32 m0, s38, 49152
s_add_u32 s39, s60, 6422528
buffer_load_dwordx4 v84, s[84:87], s39 offen lds
s_add_u32 m0, s38, 50176
s_add_u32 s39, s60, 6479872
buffer_load_dwordx4 v84, s[84:87], s39 offen lds
s_add_u32 m0, s38, 51200
s_add_u32 s39, s60, 6537216
buffer_load_dwordx4 v84, s[84:87], s39 offen lds
s_add_u32 m0, s38, 52224
s_add_u32 s39, s60, 6594560
buffer_load_dwordx4 v84, s[84:87], s39 offen lds
s_waitcnt vmcnt(16)
s_barrier
ds_read_b64_tr_b16 a[80:81], v80 offset:0
ds_read_b64_tr_b16 a[82:83], v80 offset:512
ds_read_b64_tr_b16 a[84:85], v80 offset:4096
ds_read_b64_tr_b16 a[86:87], v80 offset:4608
ds_read_b64_tr_b16 a[88:89], v80 offset:8192
ds_read_b64_tr_b16 a[90:91], v80 offset:8704
ds_read_b64_tr_b16 a[92:93], v80 offset:12288
ds_read_b64_tr_b16 a[94:95], v80 offset:12800
ds_read_b64_tr_b16 a[208:209], v81 offset:0
ds_read_b64_tr_b16 a[210:211], v81 offset:512
ds_read_b64_tr_b16 a[212:213], v81 offset:4096
ds_read_b64_tr_b16 a[214:215], v81 offset:4608
ds_read_b64_tr_b16 a[216:217], v81 offset:8192
ds_read_b64_tr_b16 a[218:219], v81 offset:8704
ds_read_b64_tr_b16 a[220:221], v81 offset:12288
ds_read_b64_tr_b16 a[222:223], v81 offset:12800
v_add_u32 v80, -65536, v80
v_add_u32 v81, -65536, v81
s_waitcnt lgkmcnt(0)
s_barrier
s_waitcnt vmcnt(8)
s_barrier
ds_read_b64_tr_b16 a[96:97], v80 offset:0
ds_read_b64_tr_b16 a[98:99], v80 offset:512
ds_read_b64_tr_b16 a[100:101], v80 offset:4096
ds_read_b64_tr_b16 a[102:103], v80 offset:4608
ds_read_b64_tr_b16 a[104:105], v80 offset:8192
ds_read_b64_tr_b16 a[106:107], v80 offset:8704
ds_read_b64_tr_b16 a[108:109], v80 offset:12288
ds_read_b64_tr_b16 a[110:111], v80 offset:12800
ds_read_b64_tr_b16 a[224:225], v81 offset:0
ds_read_b64_tr_b16 a[226:227], v81 offset:512
ds_read_b64_tr_b16 a[228:229], v81 offset:4096
ds_read_b64_tr_b16 a[230:231], v81 offset:4608
ds_read_b64_tr_b16 a[232:233], v81 offset:8192
ds_read_b64_tr_b16 a[234:235], v81 offset:8704
ds_read_b64_tr_b16 a[236:237], v81 offset:12288
ds_read_b64_tr_b16 a[238:239], v81 offset:12800
v_add_u32 v80, 32768, v80
v_add_u32 v81, 32768, v81
s_waitcnt lgkmcnt(0)
s_barrier
s_waitcnt vmcnt(0)
s_barrier
ds_read_b64_tr_b16 a[112:113], v80 offset:0
ds_read_b64_tr_b16 a[114:115], v80 offset:512
ds_read_b64_tr_b16 a[116:117], v80 offset:4096
ds_read_b64_tr_b16 a[118:119], v80 offset:4608
ds_read_b64_tr_b16 a[120:121], v80 offset:8192
ds_read_b64_tr_b16 a[122:123], v80 offset:8704
ds_read_b64_tr_b16 a[124:125], v80 offset:12288
ds_read_b64_tr_b16 a[126:127], v80 offset:12800
ds_read_b64_tr_b16 a[240:241], v81 offset:0
ds_read_b64_tr_b16 a[242:243], v81 offset:512
ds_read_b64_tr_b16 a[244:245], v81 offset:4096
ds_read_b64_tr_b16 a[246:247], v81 offset:4608
ds_read_b64_tr_b16 a[248:249], v81 offset:8192
ds_read_b64_tr_b16 a[250:251], v81 offset:8704
ds_read_b64_tr_b16 a[252:253], v81 offset:12288
ds_read_b64_tr_b16 a[254:255], v81 offset:12800
v_add_u32 v80, 32768, v80
v_add_u32 v81, 32768, v81
s_waitcnt lgkmcnt(0)
s_barrier
s_lshr_b32 s26, s44, 3
s_and_b32 s62, s44, 7
s_lshl_b32 s60, s26, 20
s_lshl_b32 s38, s62, 8
s_add_u32 s60, s60, s38
s_add_u32 s61, s60, 128
s_lshr_b32 s52, s32, 1
s_lshl_b32 s52, s52, 14
s_and_b32 s53, s32, 1
s_lshl_b32 s53, s53, 6
s_add_u32 s52, s52, s53
v_bfe_u32 v84, v9, 2, 2
v_lshrrev_b32 v85, 4, v9
v_lshl_add_u32 v84, v85, 3, v84
v_lshl_add_u32 v84, v84, 7, s52
v_and_b32 v85, 3, v9
v_lshl_add_u32 v84, v85, 4, v84
v_add_u32 v80, 0, v84
v_bfe_u32 v84, v9, 2, 2
v_lshrrev_b32 v85, 4, v9
v_lshl_add_u32 v84, v85, 3, v84
v_lshl_add_u32 v84, v84, 7, s52
v_and_b32 v85, 3, v9
v_lshl_add_u32 v84, v85, 4, v84
v_add_u32 v81, 8, v84
v_lshrrev_b32 v84, 3, v9
s_lshl_b32 s38, s32, 5
v_add_u32 v84, s38, v84
v_mul_u32_u24 v84, 2048, v84
v_and_b32 v85, 7, v9
v_lshl_add_u32 v84, v85, 4, v84
s_lshl_b32 s38, s32, 12
s_barrier
s_add_u32 m0, s38, 0
s_add_u32 s39, s60, 0
buffer_load_dwordx4 v84, s[88:91], s39 offen lds
s_add_u32 m0, s38, 1024
s_add_u32 s39, s60, 16384
buffer_load_dwordx4 v84, s[88:91], s39 offen lds
s_add_u32 m0, s38, 2048
s_add_u32 s39, s60, 32768
buffer_load_dwordx4 v84, s[88:91], s39 offen lds
s_add_u32 m0, s38, 3072
s_add_u32 s39, s60, 49152
buffer_load_dwordx4 v84, s[88:91], s39 offen lds
s_add_u32 m0, s38, 16384
s_add_u32 s39, s61, 0
buffer_load_dwordx4 v84, s[88:91], s39 offen lds
s_add_u32 m0, s38, 17408
s_add_u32 s39, s61, 16384
buffer_load_dwordx4 v84, s[88:91], s39 offen lds
s_add_u32 m0, s38, 18432
s_add_u32 s39, s61, 32768
buffer_load_dwordx4 v84, s[88:91], s39 offen lds
s_add_u32 m0, s38, 19456
s_add_u32 s39, s61, 49152
buffer_load_dwordx4 v84, s[88:91], s39 offen lds
s_add_u32 m0, s38, 32768
s_add_u32 s39, s60, 262144
buffer_load_dwordx4 v84, s[88:91], s39 offen lds
s_add_u32 m0, s38, 33792
s_add_u32 s39, s60, 278528
buffer_load_dwordx4 v84, s[88:91], s39 offen lds
s_add_u32 m0, s38, 34816
s_add_u32 s39, s60, 294912
buffer_load_dwordx4 v84, s[88:91], s39 offen lds
s_add_u32 m0, s38, 35840
s_add_u32 s39, s60, 311296
buffer_load_dwordx4 v84, s[88:91], s39 offen lds
s_add_u32 m0, s38, 49152
s_add_u32 s39, s61, 262144
buffer_load_dwordx4 v84, s[88:91], s39 offen lds
s_add_u32 m0, s38, 50176
s_add_u32 s39, s61, 278528
buffer_load_dwordx4 v84, s[88:91], s39 offen lds
s_add_u32 m0, s38, 51200
s_add_u32 s39, s61, 294912
buffer_load_dwordx4 v84, s[88:91], s39 offen lds
s_add_u32 m0, s38, 52224
s_add_u32 s39, s61, 311296
buffer_load_dwordx4 v84, s[88:91], s39 offen lds
s_add_u32 m0, s38, 65536
s_add_u32 s39, s60, 524288
buffer_load_dwordx4 v84, s[88:91], s39 offen lds
s_add_u32 m0, s38, 66560
s_add_u32 s39, s60, 540672
buffer_load_dwordx4 v84, s[88:91], s39 offen lds
s_add_u32 m0, s38, 67584
s_add_u32 s39, s60, 557056
buffer_load_dwordx4 v84, s[88:91], s39 offen lds
s_add_u32 m0, s38, 68608
s_add_u32 s39, s60, 573440
buffer_load_dwordx4 v84, s[88:91], s39 offen lds
s_add_u32 m0, s38, 81920
s_add_u32 s39, s61, 524288
buffer_load_dwordx4 v84, s[88:91], s39 offen lds
s_add_u32 m0, s38, 82944
s_add_u32 s39, s61, 540672
buffer_load_dwordx4 v84, s[88:91], s39 offen lds
s_add_u32 m0, s38, 83968
s_add_u32 s39, s61, 557056
buffer_load_dwordx4 v84, s[88:91], s39 offen lds
s_add_u32 m0, s38, 84992
s_add_u32 s39, s61, 573440
buffer_load_dwordx4 v84, s[88:91], s39 offen lds
s_waitcnt vmcnt(16)
s_barrier
ds_read_b64_tr_b16 v[128:129], v80 offset:0
ds_read_b64_tr_b16 v[130:131], v80 offset:512
ds_read_b64_tr_b16 v[132:133], v80 offset:4096
ds_read_b64_tr_b16 v[134:135], v80 offset:4608
ds_read_b64_tr_b16 v[136:137], v80 offset:8192
ds_read_b64_tr_b16 v[138:139], v80 offset:8704
ds_read_b64_tr_b16 v[140:141], v80 offset:12288
ds_read_b64_tr_b16 v[142:143], v80 offset:12800
ds_read_b64_tr_b16 v[192:193], v81 offset:0
ds_read_b64_tr_b16 v[194:195], v81 offset:512
ds_read_b64_tr_b16 v[196:197], v81 offset:4096
ds_read_b64_tr_b16 v[198:199], v81 offset:4608
ds_read_b64_tr_b16 v[200:201], v81 offset:8192
ds_read_b64_tr_b16 v[202:203], v81 offset:8704
ds_read_b64_tr_b16 v[204:205], v81 offset:12288
ds_read_b64_tr_b16 v[206:207], v81 offset:12800
v_add_u32 v80, 32768, v80
v_add_u32 v81, 32768, v81
s_waitcnt lgkmcnt(0)
s_barrier
s_add_u32 m0, s38, 0
s_add_u32 s39, s60, 786432
buffer_load_dwordx4 v84, s[88:91], s39 offen lds
s_add_u32 m0, s38, 1024
s_add_u32 s39, s60, 802816
buffer_load_dwordx4 v84, s[88:91], s39 offen lds
s_add_u32 m0, s38, 2048
s_add_u32 s39, s60, 819200
buffer_load_dwordx4 v84, s[88:91], s39 offen lds
s_add_u32 m0, s38, 3072
s_add_u32 s39, s60, 835584
buffer_load_dwordx4 v84, s[88:91], s39 offen lds
s_add_u32 m0, s38, 16384
s_add_u32 s39, s61, 786432
buffer_load_dwordx4 v84, s[88:91], s39 offen lds
s_add_u32 m0, s38, 17408
s_add_u32 s39, s61, 802816
buffer_load_dwordx4 v84, s[88:91], s39 offen lds
s_add_u32 m0, s38, 18432
s_add_u32 s39, s61, 819200
buffer_load_dwordx4 v84, s[88:91], s39 offen lds
s_add_u32 m0, s38, 19456
s_add_u32 s39, s61, 835584
buffer_load_dwordx4 v84, s[88:91], s39 offen lds
s_waitcnt vmcnt(16)
s_barrier
ds_read_b64_tr_b16 v[144:145], v80 offset:0
ds_read_b64_tr_b16 v[146:147], v80 offset:512
ds_read_b64_tr_b16 v[148:149], v80 offset:4096
ds_read_b64_tr_b16 v[150:151], v80 offset:4608
ds_read_b64_tr_b16 v[152:153], v80 offset:8192
ds_read_b64_tr_b16 v[154:155], v80 offset:8704
ds_read_b64_tr_b16 v[156:157], v80 offset:12288
ds_read_b64_tr_b16 v[158:159], v80 offset:12800
ds_read_b64_tr_b16 v[208:209], v81 offset:0
ds_read_b64_tr_b16 v[210:211], v81 offset:512
ds_read_b64_tr_b16 v[212:213], v81 offset:4096
ds_read_b64_tr_b16 v[214:215], v81 offset:4608
ds_read_b64_tr_b16 v[216:217], v81 offset:8192
ds_read_b64_tr_b16 v[218:219], v81 offset:8704
ds_read_b64_tr_b16 v[220:221], v81 offset:12288
ds_read_b64_tr_b16 v[222:223], v81 offset:12800
v_add_u32 v80, 32768, v80
v_add_u32 v81, 32768, v81
s_waitcnt lgkmcnt(0)
s_barrier
s_waitcnt vmcnt(8)
s_barrier
ds_read_b64_tr_b16 v[160:161], v80 offset:0
ds_read_b64_tr_b16 v[162:163], v80 offset:512
ds_read_b64_tr_b16 v[164:165], v80 offset:4096
ds_read_b64_tr_b16 v[166:167], v80 offset:4608
ds_read_b64_tr_b16 v[168:169], v80 offset:8192
ds_read_b64_tr_b16 v[170:171], v80 offset:8704
ds_read_b64_tr_b16 v[172:173], v80 offset:12288
ds_read_b64_tr_b16 v[174:175], v80 offset:12800
ds_read_b64_tr_b16 v[224:225], v81 offset:0
ds_read_b64_tr_b16 v[226:227], v81 offset:512
ds_read_b64_tr_b16 v[228:229], v81 offset:4096
ds_read_b64_tr_b16 v[230:231], v81 offset:4608
ds_read_b64_tr_b16 v[232:233], v81 offset:8192
ds_read_b64_tr_b16 v[234:235], v81 offset:8704
ds_read_b64_tr_b16 v[236:237], v81 offset:12288
ds_read_b64_tr_b16 v[238:239], v81 offset:12800
v_add_u32 v80, -65536, v80
v_add_u32 v81, -65536, v81
s_waitcnt lgkmcnt(0)
s_barrier
s_waitcnt vmcnt(0)
s_barrier
ds_read_b64_tr_b16 v[176:177], v80 offset:0
ds_read_b64_tr_b16 v[178:179], v80 offset:512
ds_read_b64_tr_b16 v[180:181], v80 offset:4096
ds_read_b64_tr_b16 v[182:183], v80 offset:4608
ds_read_b64_tr_b16 v[184:185], v80 offset:8192
ds_read_b64_tr_b16 v[186:187], v80 offset:8704
ds_read_b64_tr_b16 v[188:189], v80 offset:12288
ds_read_b64_tr_b16 v[190:191], v80 offset:12800
ds_read_b64_tr_b16 v[240:241], v81 offset:0
ds_read_b64_tr_b16 v[242:243], v81 offset:512
ds_read_b64_tr_b16 v[244:245], v81 offset:4096
ds_read_b64_tr_b16 v[246:247], v81 offset:4608
ds_read_b64_tr_b16 v[248:249], v81 offset:8192
ds_read_b64_tr_b16 v[250:251], v81 offset:8704
ds_read_b64_tr_b16 v[252:253], v81 offset:12288
ds_read_b64_tr_b16 v[254:255], v81 offset:12800
v_add_u32 v80, 32768, v80
v_add_u32 v81, 32768, v81
s_waitcnt lgkmcnt(0)
s_barrier
s_mul_i32 s50, s32, 16384
v_lshlrev_b32 v1, 4, v9
v_add_u32 v0, s50, v1
s_lshl_b32 s60, s32, 13
v_add_u32 v10, s60, v1
v_add_u32 v11, 0x20000, v1
v_mov_b32 v7, v1
v_min_u32 v2, 3, v9
v_lshlrev_b32 v2, 7, v2
v_min_u32 v12, 7, v9
v_lshlrev_b32 v12, 7, v12
s_lshl_b32 s61, s26, 10
s_add_u32 s61, s61, 3416064
s_lshl_b32 s38, s44, 1
s_lshr_b32 s39, s32, 1
s_add_u32 s38, s38, s39
s_lshl_b32 s38, s38, 11
s_and_b32 s39, s32, 1
s_lshl_b32 s39, s39, 9
s_add_u32 s38, s38, s39
v_and_b32 v80, 15, v9
v_lshl_add_u32 v6, v80, 4, s38
v_bfe_u32 v80, v9, 4, 1
v_lshl_add_u32 v6, v80, 10, v6
v_lshrrev_b32 v80, 5, v9
v_lshl_add_u32 v6, v80, 8, v6
s_mov_b32 s49, 100433920
s_mov_b32 s54, 16777216
s_lshl_b32 s59, s26, 15
s_add_u32 s59, s59, 99745792
s_lshl_b32 s38, s62, 2
s_add_u32 s38, s38, s32
s_lshl_b32 s38, s38, 11
s_lshl_b32 s62, s26, 22
s_add_u32 s62, s62, s38
s_add_u32 s62, s62, 133955584
s_mov_b32 s64, 0xbfb8aa3b
v_mov_b32 v100, 0
v_mov_b32 v101, 0
s_mov_b32 s36, 0
Lfw_610:
s_add_u32 s48, s36, 0
s_and_b32 s47, s48, 1
s_lshl_b32 s47, s47, 9
s_add_u32 s47, s47, 3423232
s_add_u32 s48, s48, 1
Lbw_614:
buffer_load_dword v3, v2, s[4:7], s47 offen sc1
s_waitcnt vmcnt(0)
v_cmp_gt_u32 vcc, s48, v3
s_cbranch_vccz Lbo_615
s_sub_u32 s37, s37, 1
s_cbranch_scc1 Lend_7
s_sleep 4
s_branch Lbw_614
Lbo_615:
s_add_u32 m0, s50, 0
s_add_u32 s39, s54, 0
buffer_load_dwordx4 v0, s[4:7], s39 offen offset:0 sc1 lds
buffer_load_dwordx4 v0, s[4:7], s39 offen offset:1024 sc1 lds
buffer_load_dwordx4 v0, s[4:7], s39 offen offset:2048 sc1 lds
buffer_load_dwordx4 v0, s[4:7], s39 offen offset:3072 sc1 lds
s_add_u32 m0, s50, 4096
s_add_u32 s39, s54, 4096
buffer_load_dwordx4 v0, s[4:7], s39 offen offset:0 sc1 lds
buffer_load_dwordx4 v0, s[4:7], s39 offen offset:1024 sc1 lds
buffer_load_dwordx4 v0, s[4:7], s39 offen offset:2048 sc1 lds
buffer_load_dwordx4 v0, s[4:7], s39 offen offset:3072 sc1 lds
s_add_u32 m0, s50, 8192
s_add_u32 s39, s54, 8192
buffer_load_dwordx4 v0, s[4:7], s39 offen offset:0 sc1 lds
buffer_load_dwordx4 v0, s[4:7], s39 offen offset:1024 sc1 lds
buffer_load_dwordx4 v0, s[4:7], s39 offen offset:2048 sc1 lds
buffer_load_dwordx4 v0, s[4:7], s39 offen offset:3072 sc1 lds
s_add_u32 m0, s50, 12288
s_add_u32 s39, s54, 12288
buffer_load_dwordx4 v0, s[4:7], s39 offen offset:0 sc1 lds
buffer_load_dwordx4 v0, s[4:7], s39 offen offset:1024 sc1 lds
buffer_load_dwordx4 v0, s[4:7], s39 offen offset:2048 sc1 lds
buffer_load_dwordx4 v0, s[4:7], s39 offen offset:3072 sc1 lds
s_add_u32 s48, s36, 1
s_and_b32 s47, s48, 1
s_lshl_b32 s47, s47, 9
s_add_u32 s47, s47, 3423232
s_add_u32 s48, s48, 1
buffer_load_dword v3, v2, s[4:7], s47 offen sc1
buffer_load_dword v13, v12, s[4:7], s61 offen sc1
s_waitcnt vmcnt(0)
s_barrier
ds_read_b128 v[16:19], v1 offset:0
ds_read_b128 v[20:23], v1 offset:1024
ds_read_b128 v[24:27], v1 offset:2048
ds_read_b128 v[28:31], v1 offset:3072
ds_read_b128 v[32:35], v1 offset:4096
ds_read_b128 v[36:39], v1 offset:5120
ds_read_b128 v[40:43], v1 offset:6144
s_sub_u32 s38, s36, 1
v_med3_i32 v100, s38, 0, 64
s_sub_u32 s38, s38, 4
v_max_i32 v101, s38, 0
buffer_store_dwordx2 v[100:101], v4, s[4:7], 0 offen sc1
s_branch Lfb_609
Lft_608:
s_waitcnt vmcnt(0)
s_barrier
ds_read_b128 v[16:19], v1 offset:0
ds_read_b128 v[20:23], v1 offset:1024
ds_read_b128 v[24:27], v1 offset:2048
ds_read_b128 v[28:31], v1 offset:3072
ds_read_b128 v[32:35], v1 offset:4096
ds_read_b128 v[36:39], v1 offset:5120
ds_read_b128 v[40:43], v1 offset:6144
s_sub_u32 s38, s36, 1
v_med3_i32 v100, s38, 0, 64
s_sub_u32 s38, s38, 4
v_max_i32 v101, s38, 0
buffer_store_dwordx2 v[100:101], v4, s[4:7], 0 offen sc1
buffer_store_dwordx4 v[96:99], v6, s[4:7], s49 offen sc1
v_cvt_pk_bf16_f32 v80, v64, v65
v_cvt_pk_bf16_f32 v81, v66, v67
v_cvt_pk_bf16_f32 v82, v68, v69
v_cvt_pk_bf16_f32 v83, v70, v71
buffer_store_dwordx4 v[80:83], v7, s[4:7], s58 offen offset:0 sc1
v_cvt_pk_bf16_f32 v84, v72, v73
v_cvt_pk_bf16_f32 v85, v74, v75
v_cvt_pk_bf16_f32 v86, v76, v77
v_cvt_pk_bf16_f32 v87, v78, v79
buffer_store_dwordx4 v[84:87], v7, s[4:7], s58 offen offset:1024 sc1
Lfb_609:
s_add_u32 s54, s54, 65536
s_xor_b32 s50, s50, 0x10000
s_sub_u32 s57, s36, 3
s_max_i32 s57, s57, 0
v_cmp_gt_u32 vcc, s48, v3
s_cmp_eq_u64 vcc, 0
s_cselect_b32 s46, 1, 0
s_cselect_b32 s45, s54, 0x70000000
v_cmp_gt_u32 vcc, s57, v13
s_cmp_eq_u64 vcc, 0
s_cselect_b32 s56, 1, 0
s_cselect_b32 s55, s59, 0x70000000
s_waitcnt lgkmcnt(5)
v_mfma_f32_16x16x32_bf16 v[48:51], a[0:3], v[16:19], 0
ds_read_b128 v[44:47], v1 offset:7168
v_mfma_f32_16x16x32_bf16 v[56:59], a[128:131], v[16:19], 0
v_mfma_f32_16x16x32_bf16 v[52:55], a[0:3], v[20:23], 0
ds_read_b128 v[16:19], v1 offset:8192
s_add_u32 m0, s60, 131072
v_mfma_f32_16x16x32_bf16 v[60:63], a[128:131], v[20:23], 0
s_add_u32 s39, s55, 0
s_waitcnt lgkmcnt(5)
v_mfma_f32_16x16x32_bf16 v[48:51], a[4:7], v[24:27], v[48:51]
ds_read_b128 v[20:23], v1 offset:9216
v_mfma_f32_16x16x32_bf16 v[56:59], a[132:135], v[24:27], v[56:59]
buffer_load_dwordx4 v10, s[4:7], s39 offen offset:0 sc1 lds
v_mfma_f32_16x16x32_bf16 v[52:55], a[4:7], v[28:31], v[52:55]
ds_read_b128 v[24:27], v1 offset:10240
v_mfma_f32_16x16x32_bf16 v[60:63], a[132:135], v[28:31], v[60:63]
s_waitcnt lgkmcnt(5)
v_mfma_f32_16x16x32_bf16 v[48:51], a[8:11], v[32:35], v[48:51]
ds_read_b128 v[28:31], v1 offset:11264
v_mfma_f32_16x16x32_bf16 v[56:59], a[136:139], v[32:35], v[56:59]
buffer_load_dwordx4 v10, s[4:7], s39 offen offset:1024 sc1 lds
v_mfma_f32_16x16x32_bf16 v[52:55], a[8:11], v[36:39], v[52:55]
ds_read_b128 v[32:35], v1 offset:12288
v_mfma_f32_16x16x32_bf16 v[60:63], a[136:139], v[36:39], v[60:63]
s_waitcnt lgkmcnt(5)
v_mfma_f32_16x16x32_bf16 v[48:51], a[12:15], v[40:43], v[48:51]
ds_read_b128 v[36:39], v1 offset:13312
v_mfma_f32_16x16x32_bf16 v[56:59], a[140:143], v[40:43], v[56:59]
buffer_load_dwordx4 v10, s[4:7], s39 offen offset:2048 sc1 lds
v_mfma_f32_16x16x32_bf16 v[52:55], a[12:15], v[44:47], v[52:55]
ds_read_b128 v[40:43], v1 offset:14336
v_mfma_f32_16x16x32_bf16 v[60:63], a[140:143], v[44:47], v[60:63]
s_waitcnt lgkmcnt(5)
v_mfma_f32_16x16x32_bf16 v[48:51], a[16:19], v[16:19], v[48:51]
ds_read_b128 v[44:47], v1 offset:15360
v_mfma_f32_16x16x32_bf16 v[56:59], a[144:147], v[16:19], v[56:59]
buffer_load_dwordx4 v10, s[4:7], s39 offen offset:3072 sc1 lds
v_mfma_f32_16x16x32_bf16 v[52:55], a[16:19], v[20:23], v[52:55]
ds_read_b128 v[16:19], v1 offset:16384
v_mfma_f32_16x16x32_bf16 v[60:63], a[144:147], v[20:23], v[60:63]
s_waitcnt lgkmcnt(5)
v_mfma_f32_16x16x32_bf16 v[48:51], a[20:23], v[24:27], v[48:51]
ds_read_b128 v[20:23], v1 offset:17408
v_mfma_f32_16x16x32_bf16 v[56:59], a[148:151], v[24:27], v[56:59]
s_add_u32 m0, s60, 135168
s_add_u32 s39, s55, 4096
v_mfma_f32_16x16x32_bf16 v[52:55], a[20:23], v[28:31], v[52:55]
ds_read_b128 v[24:27], v1 offset:18432
v_mfma_f32_16x16x32_bf16 v[60:63], a[148:151], v[28:31], v[60:63]
s_waitcnt lgkmcnt(5)
v_mfma_f32_16x16x32_bf16 v[48:51], a[24:27], v[32:35], v[48:51]
ds_read_b128 v[28:31], v1 offset:19456
v_mfma_f32_16x16x32_bf16 v[56:59], a[152:155], v[32:35], v[56:59]
buffer_load_dwordx4 v10, s[4:7], s39 offen offset:0 sc1 lds
v_mfma_f32_16x16x32_bf16 v[52:55], a[24:27], v[36:39], v[52:55]
ds_read_b128 v[32:35], v1 offset:20480
v_mfma_f32_16x16x32_bf16 v[60:63], a[152:155], v[36:39], v[60:63]
s_waitcnt lgkmcnt(5)
v_mfma_f32_16x16x32_bf16 v[48:51], a[28:31], v[40:43], v[48:51]
ds_read_b128 v[36:39], v1 offset:21504
v_mfma_f32_16x16x32_bf16 v[56:59], a[156:159], v[40:43], v[56:59]
buffer_load_dwordx4 v10, s[4:7], s39 offen offset:1024 sc1 lds
v_mfma_f32_16x16x32_bf16 v[52:55], a[28:31], v[44:47], v[52:55]
ds_read_b128 v[40:43], v1 offset:22528
v_mfma_f32_16x16x32_bf16 v[60:63], a[156:159], v[44:47], v[60:63]
s_waitcnt lgkmcnt(5)
v_mfma_f32_16x16x32_bf16 v[48:51], a[32:35], v[16:19], v[48:51]
ds_read_b128 v[44:47], v1 offset:23552
v_mfma_f32_16x16x32_bf16 v[56:59], a[160:163], v[16:19], v[56:59]
buffer_load_dwordx4 v10, s[4:7], s39 offen offset:2048 sc1 lds
v_mfma_f32_16x16x32_bf16 v[52:55], a[32:35], v[20:23], v[52:55]
ds_read_b128 v[16:19], v1 offset:24576
v_mfma_f32_16x16x32_bf16 v[60:63], a[160:163], v[20:23], v[60:63]
s_waitcnt lgkmcnt(5)
v_mfma_f32_16x16x32_bf16 v[48:51], a[36:39], v[24:27], v[48:51]
ds_read_b128 v[20:23], v1 offset:25600
v_mfma_f32_16x16x32_bf16 v[56:59], a[164:167], v[24:27], v[56:59]
buffer_load_dwordx4 v10, s[4:7], s39 offen offset:3072 sc1 lds
v_mfma_f32_16x16x32_bf16 v[52:55], a[36:39], v[28:31], v[52:55]
ds_read_b128 v[24:27], v1 offset:26624
v_mfma_f32_16x16x32_bf16 v[60:63], a[164:167], v[28:31], v[60:63]
s_waitcnt lgkmcnt(5)
v_mfma_f32_16x16x32_bf16 v[48:51], a[40:43], v[32:35], v[48:51]
ds_read_b128 v[28:31], v1 offset:27648
v_mfma_f32_16x16x32_bf16 v[56:59], a[168:171], v[32:35], v[56:59]
s_add_u32 m0, s50, 0
s_add_u32 s39, s45, 0
v_mfma_f32_16x16x32_bf16 v[52:55], a[40:43], v[36:39], v[52:55]
ds_read_b128 v[32:35], v1 offset:28672
v_mfma_f32_16x16x32_bf16 v[60:63], a[168:171], v[36:39], v[60:63]
s_waitcnt lgkmcnt(5)
v_mfma_f32_16x16x32_bf16 v[48:51], a[44:47], v[40:43], v[48:51]
ds_read_b128 v[36:39], v1 offset:29696
v_mfma_f32_16x16x32_bf16 v[56:59], a[172:175], v[40:43], v[56:59]
buffer_load_dwordx4 v0, s[4:7], s39 offen offset:0 sc1 lds
v_mfma_f32_16x16x32_bf16 v[52:55], a[44:47], v[44:47], v[52:55]
ds_read_b128 v[40:43], v1 offset:30720
v_mfma_f32_16x16x32_bf16 v[60:63], a[172:175], v[44:47], v[60:63]
s_waitcnt lgkmcnt(5)
v_mfma_f32_16x16x32_bf16 v[48:51], a[48:51], v[16:19], v[48:51]
ds_read_b128 v[44:47], v1 offset:31744
v_mfma_f32_16x16x32_bf16 v[56:59], a[176:179], v[16:19], v[56:59]
buffer_load_dwordx4 v0, s[4:7], s39 offen offset:1024 sc1 lds
v_mfma_f32_16x16x32_bf16 v[52:55], a[48:51], v[20:23], v[52:55]
ds_read_b128 v[16:19], v1 offset:32768
v_mfma_f32_16x16x32_bf16 v[60:63], a[176:179], v[20:23], v[60:63]
s_waitcnt lgkmcnt(5)
v_mfma_f32_16x16x32_bf16 v[48:51], a[52:55], v[24:27], v[48:51]
ds_read_b128 v[20:23], v1 offset:33792
v_mfma_f32_16x16x32_bf16 v[56:59], a[180:183], v[24:27], v[56:59]
buffer_load_dwordx4 v0, s[4:7], s39 offen offset:2048 sc1 lds
v_mfma_f32_16x16x32_bf16 v[52:55], a[52:55], v[28:31], v[52:55]
ds_read_b128 v[24:27], v1 offset:34816
v_mfma_f32_16x16x32_bf16 v[60:63], a[180:183], v[28:31], v[60:63]
s_waitcnt lgkmcnt(5)
v_mfma_f32_16x16x32_bf16 v[48:51], a[56:59], v[32:35], v[48:51]
ds_read_b128 v[28:31], v1 offset:35840
v_mfma_f32_16x16x32_bf16 v[56:59], a[184:187], v[32:35], v[56:59]
buffer_load_dwordx4 v0, s[4:7], s39 offen offset:3072 sc1 lds
v_mfma_f32_16x16x32_bf16 v[52:55], a[56:59], v[36:39], v[52:55]
ds_read_b128 v[32:35], v1 offset:36864
v_mfma_f32_16x16x32_bf16 v[60:63], a[184:187], v[36:39], v[60:63]
s_waitcnt lgkmcnt(5)
v_mfma_f32_16x16x32_bf16 v[48:51], a[60:63], v[40:43], v[48:51]
ds_read_b128 v[36:39], v1 offset:37888
v_mfma_f32_16x16x32_bf16 v[56:59], a[188:191], v[40:43], v[56:59]
s_add_u32 m0, s50, 4096
s_add_u32 s39, s45, 4096
v_mfma_f32_16x16x32_bf16 v[52:55], a[60:63], v[44:47], v[52:55]
ds_read_b128 v[40:43], v1 offset:38912
v_mfma_f32_16x16x32_bf16 v[60:63], a[188:191], v[44:47], v[60:63]
s_waitcnt lgkmcnt(5)
v_mfma_f32_16x16x32_bf16 v[48:51], a[64:67], v[16:19], v[48:51]
ds_read_b128 v[44:47], v1 offset:39936
v_mfma_f32_16x16x32_bf16 v[56:59], a[192:195], v[16:19], v[56:59]
buffer_load_dwordx4 v0, s[4:7], s39 offen offset:0 sc1 lds
v_mfma_f32_16x16x32_bf16 v[52:55], a[64:67], v[20:23], v[52:55]
ds_read_b128 v[16:19], v1 offset:40960
v_mfma_f32_16x16x32_bf16 v[60:63], a[192:195], v[20:23], v[60:63]
s_waitcnt lgkmcnt(5)
v_mfma_f32_16x16x32_bf16 v[48:51], a[68:71], v[24:27], v[48:51]
ds_read_b128 v[20:23], v1 offset:41984
v_mfma_f32_16x16x32_bf16 v[56:59], a[196:199], v[24:27], v[56:59]
buffer_load_dwordx4 v0, s[4:7], s39 offen offset:1024 sc1 lds
v_mfma_f32_16x16x32_bf16 v[52:55], a[68:71], v[28:31], v[52:55]
ds_read_b128 v[24:27], v1 offset:43008
v_mfma_f32_16x16x32_bf16 v[60:63], a[196:199], v[28:31], v[60:63]
s_waitcnt lgkmcnt(5)
v_mfma_f32_16x16x32_bf16 v[48:51], a[72:75], v[32:35], v[48:51]
ds_read_b128 v[28:31], v1 offset:44032
v_mfma_f32_16x16x32_bf16 v[56:59], a[200:203], v[32:35], v[56:59]
buffer_load_dwordx4 v0, s[4:7], s39 offen offset:2048 sc1 lds
v_mfma_f32_16x16x32_bf16 v[52:55], a[72:75], v[36:39], v[52:55]
ds_read_b128 v[32:35], v1 offset:45056
v_mfma_f32_16x16x32_bf16 v[60:63], a[200:203], v[36:39], v[60:63]
s_waitcnt lgkmcnt(5)
v_mfma_f32_16x16x32_bf16 v[48:51], a[76:79], v[40:43], v[48:51]
ds_read_b128 v[36:39], v1 offset:46080
v_mfma_f32_16x16x32_bf16 v[56:59], a[204:207], v[40:43], v[56:59]
buffer_load_dwordx4 v0, s[4:7], s39 offen offset:3072 sc1 lds
v_mfma_f32_16x16x32_bf16 v[52:55], a[76:79], v[44:47], v[52:55]
ds_read_b128 v[40:43], v1 offset:47104
v_mfma_f32_16x16x32_bf16 v[60:63], a[204:207], v[44:47], v[60:63]
s_waitcnt lgkmcnt(5)
v_mfma_f32_16x16x32_bf16 v[48:51], a[80:83], v[16:19], v[48:51]
ds_read_b128 v[44:47], v1 offset:48128
v_mfma_f32_16x16x32_bf16 v[56:59], a[208:211], v[16:19], v[56:59]
s_add_u32 m0, s50, 8192
s_add_u32 s39, s45, 8192
v_mfma_f32_16x16x32_bf16 v[52:55], a[80:83], v[20:23], v[52:55]
ds_read_b128 v[16:19], v1 offset:49152
v_mfma_f32_16x16x32_bf16 v[60:63], a[208:211], v[20:23], v[60:63]
s_waitcnt lgkmcnt(5)
v_mfma_f32_16x16x32_bf16 v[48:51], a[84:87], v[24:27], v[48:51]
ds_read_b128 v[20:23], v1 offset:50176
v_mfma_f32_16x16x32_bf16 v[56:59], a[212:215], v[24:27], v[56:59]
buffer_load_dwordx4 v0, s[4:7], s39 offen offset:0 sc1 lds
v_mfma_f32_16x16x32_bf16 v[52:55], a[84:87], v[28:31], v[52:55]
ds_read_b128 v[24:27], v1 offset:51200
v_mfma_f32_16x16x32_bf16 v[60:63], a[212:215], v[28:31], v[60:63]
s_waitcnt lgkmcnt(5)
v_mfma_f32_16x16x32_bf16 v[48:51], a[88:91], v[32:35], v[48:51]
ds_read_b128 v[28:31], v1 offset:52224
v_mfma_f32_16x16x32_bf16 v[56:59], a[216:219], v[32:35], v[56:59]
buffer_load_dwordx4 v0, s[4:7], s39 offen offset:1024 sc1 lds
v_mfma_f32_16x16x32_bf16 v[52:55], a[88:91], v[36:39], v[52:55]
ds_read_b128 v[32:35], v1 offset:53248
v_mfma_f32_16x16x32_bf16 v[60:63], a[216:219], v[36:39], v[60:63]
s_waitcnt lgkmcnt(5)
v_mfma_f32_16x16x32_bf16 v[48:51], a[92:95], v[40:43], v[48:51]
ds_read_b128 v[36:39], v1 offset:54272
v_mfma_f32_16x16x32_bf16 v[56:59], a[220:223], v[40:43], v[56:59]
buffer_load_dwordx4 v0, s[4:7], s39 offen offset:2048 sc1 lds
v_mfma_f32_16x16x32_bf16 v[52:55], a[92:95], v[44:47], v[52:55]
ds_read_b128 v[40:43], v1 offset:55296
v_mfma_f32_16x16x32_bf16 v[60:63], a[220:223], v[44:47], v[60:63]
s_waitcnt lgkmcnt(5)
v_mfma_f32_16x16x32_bf16 v[48:51], a[96:99], v[16:19], v[48:51]
ds_read_b128 v[44:47], v1 offset:56320
v_mfma_f32_16x16x32_bf16 v[56:59], a[224:227], v[16:19], v[56:59]
buffer_load_dwordx4 v0, s[4:7], s39 offen offset:3072 sc1 lds
v_mfma_f32_16x16x32_bf16 v[52:55], a[96:99], v[20:23], v[52:55]
ds_read_b128 v[16:19], v1 offset:57344
v_mfma_f32_16x16x32_bf16 v[60:63], a[224:227], v[20:23], v[60:63]
s_waitcnt lgkmcnt(5)
v_mfma_f32_16x16x32_bf16 v[48:51], a[100:103], v[24:27], v[48:51]
ds_read_b128 v[20:23], v1 offset:58368
v_mfma_f32_16x16x32_bf16 v[56:59], a[228:231], v[24:27], v[56:59]
s_add_u32 m0, s50, 12288
s_add_u32 s39, s45, 12288
v_mfma_f32_16x16x32_bf16 v[52:55], a[100:103], v[28:31], v[52:55]
ds_read_b128 v[24:27], v1 offset:59392
v_mfma_f32_16x16x32_bf16 v[60:63], a[228:231], v[28:31], v[60:63]
s_waitcnt lgkmcnt(5)
v_mfma_f32_16x16x32_bf16 v[48:51], a[104:107], v[32:35], v[48:51]
ds_read_b128 v[28:31], v1 offset:60416
v_mfma_f32_16x16x32_bf16 v[56:59], a[232:235], v[32:35], v[56:59]
buffer_load_dwordx4 v0, s[4:7], s39 offen offset:0 sc1 lds
v_mfma_f32_16x16x32_bf16 v[52:55], a[104:107], v[36:39], v[52:55]
ds_read_b128 v[32:35], v1 offset:61440
v_mfma_f32_16x16x32_bf16 v[60:63], a[232:235], v[36:39], v[60:63]
s_waitcnt lgkmcnt(5)
v_mfma_f32_16x16x32_bf16 v[48:51], a[108:111], v[40:43], v[48:51]
ds_read_b128 v[36:39], v1 offset:62464
v_mfma_f32_16x16x32_bf16 v[56:59], a[236:239], v[40:43], v[56:59]
buffer_load_dwordx4 v0, s[4:7], s39 offen offset:1024 sc1 lds
v_mfma_f32_16x16x32_bf16 v[52:55], a[108:111], v[44:47], v[52:55]
ds_read_b128 v[40:43], v1 offset:63488
v_mfma_f32_16x16x32_bf16 v[60:63], a[236:239], v[44:47], v[60:63]
s_waitcnt lgkmcnt(5)
v_mfma_f32_16x16x32_bf16 v[48:51], a[112:115], v[16:19], v[48:51]
ds_read_b128 v[44:47], v1 offset:64512
v_mfma_f32_16x16x32_bf16 v[56:59], a[240:243], v[16:19], v[56:59]
buffer_load_dwordx4 v0, s[4:7], s39 offen offset:2048 sc1 lds
v_mfma_f32_16x16x32_bf16 v[52:55], a[112:115], v[20:23], v[52:55]
v_mfma_f32_16x16x32_bf16 v[60:63], a[240:243], v[20:23], v[60:63]
s_waitcnt lgkmcnt(4)
v_mfma_f32_16x16x32_bf16 v[48:51], a[116:119], v[24:27], v[48:51]
v_mfma_f32_16x16x32_bf16 v[56:59], a[244:247], v[24:27], v[56:59]
buffer_load_dwordx4 v0, s[4:7], s39 offen offset:3072 sc1 lds
v_mfma_f32_16x16x32_bf16 v[52:55], a[116:119], v[28:31], v[52:55]
v_mfma_f32_16x16x32_bf16 v[60:63], a[244:247], v[28:31], v[60:63]
s_waitcnt lgkmcnt(2)
v_mfma_f32_16x16x32_bf16 v[48:51], a[120:123], v[32:35], v[48:51]
v_mfma_f32_16x16x32_bf16 v[56:59], a[248:251], v[32:35], v[56:59]
v_mfma_f32_16x16x32_bf16 v[52:55], a[120:123], v[36:39], v[52:55]
v_mfma_f32_16x16x32_bf16 v[60:63], a[248:251], v[36:39], v[60:63]
s_waitcnt lgkmcnt(0)
v_mfma_f32_16x16x32_bf16 v[48:51], a[124:127], v[40:43], v[48:51]
v_mfma_f32_16x16x32_bf16 v[56:59], a[252:255], v[40:43], v[56:59]
v_mfma_f32_16x16x32_bf16 v[52:55], a[124:127], v[44:47], v[52:55]
v_mfma_f32_16x16x32_bf16 v[60:63], a[252:255], v[44:47], v[60:63]
v_xor_b32 v1, 0x10000, v1
s_cmp_eq_u32 s56, 0
s_cbranch_scc1 Lfl_612
s_waitcnt vmcnt(16)
Lfg_613:
s_barrier
ds_read_b128 v[16:19], v11 offset:0
ds_read_b128 v[20:23], v11 offset:1024
ds_read_b128 v[24:27], v11 offset:2048
ds_read_b128 v[28:31], v11 offset:3072
ds_read_b128 v[32:35], v11 offset:4096
ds_read_b128 v[36:39], v11 offset:5120
ds_read_b128 v[40:43], v11 offset:6144
s_cmp_lg_u32 s36, 63
s_cbranch_scc1 Lfi_616
s_sub_u32 s38, s36, 0
v_med3_i32 v100, s38, 0, 64
s_sub_u32 s38, s38, 4
v_max_i32 v101, s38, 0
buffer_store_dwordx2 v[100:101], v4, s[4:7], 0 offen sc1
Lfi_616:
v_pk_mul_f32 v[88:89], v[48:49], s[64:65] op_sel_hi:[1,0]
v_pk_mul_f32 v[90:91], v[50:51], s[64:65] op_sel_hi:[1,0]
v_pk_mul_f32 v[92:93], v[52:53], s[64:65] op_sel_hi:[1,0]
v_pk_mul_f32 v[94:95], v[54:55], s[64:65] op_sel_hi:[1,0]
v_exp_f32 v88, v88
v_exp_f32 v89, v89
v_exp_f32 v90, v90
v_exp_f32 v91, v91
v_exp_f32 v92, v92
v_exp_f32 v93, v93
v_exp_f32 v94, v94
v_exp_f32 v95, v95
s_waitcnt lgkmcnt(5)
v_mfma_f32_16x16x32_bf16 v[64:67], v[128:131], v[16:19], 0
ds_read_b128 v[44:47], v11 offset:7168
s_add_u32 s48, s36, 2
v_mfma_f32_16x16x32_bf16 v[68:71], v[192:195], v[16:19], 0
s_and_b32 s47, s48, 1
s_lshl_b32 s47, s47, 9
v_mfma_f32_16x16x32_bf16 v[72:75], v[128:131], v[20:23], 0
ds_read_b128 v[16:19], v11 offset:8192
s_add_u32 s47, s47, 3423232
v_mfma_f32_16x16x32_bf16 v[76:79], v[192:195], v[20:23], 0
s_add_u32 s48, s48, 1
s_waitcnt lgkmcnt(5)
v_mfma_f32_16x16x32_bf16 v[64:67], v[132:135], v[24:27], v[64:67]
ds_read_b128 v[20:23], v11 offset:9216
v_mfma_f32_16x16x32_bf16 v[68:71], v[196:199], v[24:27], v[68:71]
buffer_load_dword v3, v2, s[4:7], s47 offen sc1
v_mfma_f32_16x16x32_bf16 v[72:75], v[132:135], v[28:31], v[72:75]
ds_read_b128 v[24:27], v11 offset:10240
v_mfma_f32_16x16x32_bf16 v[76:79], v[196:199], v[28:31], v[76:79]
s_waitcnt lgkmcnt(5)
v_mfma_f32_16x16x32_bf16 v[64:67], v[136:139], v[32:35], v[64:67]
ds_read_b128 v[28:31], v11 offset:11264
v_mfma_f32_16x16x32_bf16 v[68:71], v[200:203], v[32:35], v[68:71]
buffer_load_dword v13, v12, s[4:7], s61 offen sc1
v_mfma_f32_16x16x32_bf16 v[72:75], v[136:139], v[36:39], v[72:75]
ds_read_b128 v[32:35], v11 offset:12288
v_pk_mul_f32 v[48:49], v[48:49], v[56:57]
v_mfma_f32_16x16x32_bf16 v[76:79], v[200:203], v[36:39], v[76:79]
v_pk_mul_f32 v[50:51], v[50:51], v[58:59]
s_waitcnt lgkmcnt(5)
v_mfma_f32_16x16x32_bf16 v[64:67], v[140:143], v[40:43], v[64:67]
ds_read_b128 v[36:39], v11 offset:13312
v_pk_mul_f32 v[52:53], v[52:53], v[60:61]
v_mfma_f32_16x16x32_bf16 v[68:71], v[204:207], v[40:43], v[68:71]
v_pk_mul_f32 v[54:55], v[54:55], v[62:63]
v_pk_add_f32 v[88:89], v[88:89], 1.0 op_sel_hi:[1,0]
v_mfma_f32_16x16x32_bf16 v[72:75], v[140:143], v[44:47], v[72:75]
ds_read_b128 v[40:43], v11 offset:14336
v_pk_add_f32 v[90:91], v[90:91], 1.0 op_sel_hi:[1,0]
v_mfma_f32_16x16x32_bf16 v[76:79], v[204:207], v[44:47], v[76:79]
v_pk_add_f32 v[92:93], v[92:93], 1.0 op_sel_hi:[1,0]
s_waitcnt lgkmcnt(5)
v_mfma_f32_16x16x32_bf16 v[64:67], v[144:147], v[16:19], v[64:67]
ds_read_b128 v[44:47], v11 offset:15360
v_pk_add_f32 v[94:95], v[94:95], 1.0 op_sel_hi:[1,0]
v_mfma_f32_16x16x32_bf16 v[68:71], v[208:211], v[16:19], v[68:71]
v_rcp_f32 v88, v88
v_mfma_f32_16x16x32_bf16 v[72:75], v[144:147], v[20:23], v[72:75]
ds_read_b128 v[16:19], v11 offset:16384
v_mfma_f32_16x16x32_bf16 v[76:79], v[208:211], v[20:23], v[76:79]
s_waitcnt lgkmcnt(5)
v_mfma_f32_16x16x32_bf16 v[64:67], v[148:151], v[24:27], v[64:67]
ds_read_b128 v[20:23], v11 offset:17408
v_mfma_f32_16x16x32_bf16 v[68:71], v[212:215], v[24:27], v[68:71]
v_rcp_f32 v89, v89
v_mfma_f32_16x16x32_bf16 v[72:75], v[148:151], v[28:31], v[72:75]
ds_read_b128 v[24:27], v11 offset:18432
v_mfma_f32_16x16x32_bf16 v[76:79], v[212:215], v[28:31], v[76:79]
s_waitcnt lgkmcnt(5)
v_mfma_f32_16x16x32_bf16 v[64:67], v[152:155], v[32:35], v[64:67]
ds_read_b128 v[28:31], v11 offset:19456
v_mfma_f32_16x16x32_bf16 v[68:71], v[216:219], v[32:35], v[68:71]
v_rcp_f32 v90, v90
v_mfma_f32_16x16x32_bf16 v[72:75], v[152:155], v[36:39], v[72:75]
ds_read_b128 v[32:35], v11 offset:20480
v_mfma_f32_16x16x32_bf16 v[76:79], v[216:219], v[36:39], v[76:79]
s_waitcnt lgkmcnt(5)
v_mfma_f32_16x16x32_bf16 v[64:67], v[156:159], v[40:43], v[64:67]
ds_read_b128 v[36:39], v11 offset:21504
v_mfma_f32_16x16x32_bf16 v[68:71], v[220:223], v[40:43], v[68:71]
v_rcp_f32 v91, v91
v_mfma_f32_16x16x32_bf16 v[72:75], v[156:159], v[44:47], v[72:75]
ds_read_b128 v[40:43], v11 offset:22528
v_mfma_f32_16x16x32_bf16 v[76:79], v[220:223], v[44:47], v[76:79]
s_waitcnt lgkmcnt(5)
v_mfma_f32_16x16x32_bf16 v[64:67], v[160:163], v[16:19], v[64:67]
ds_read_b128 v[44:47], v11 offset:23552
v_mfma_f32_16x16x32_bf16 v[68:71], v[224:227], v[16:19], v[68:71]
v_rcp_f32 v92, v92
v_mfma_f32_16x16x32_bf16 v[72:75], v[160:163], v[20:23], v[72:75]
ds_read_b128 v[16:19], v11 offset:24576
v_mfma_f32_16x16x32_bf16 v[76:79], v[224:227], v[20:23], v[76:79]
s_waitcnt lgkmcnt(5)
v_mfma_f32_16x16x32_bf16 v[64:67], v[164:167], v[24:27], v[64:67]
ds_read_b128 v[20:23], v11 offset:25600
v_mfma_f32_16x16x32_bf16 v[68:71], v[228:231], v[24:27], v[68:71]
v_rcp_f32 v93, v93
v_mfma_f32_16x16x32_bf16 v[72:75], v[164:167], v[28:31], v[72:75]
ds_read_b128 v[24:27], v11 offset:26624
v_mfma_f32_16x16x32_bf16 v[76:79], v[228:231], v[28:31], v[76:79]
s_waitcnt lgkmcnt(5)
v_mfma_f32_16x16x32_bf16 v[64:67], v[168:171], v[32:35], v[64:67]
ds_read_b128 v[28:31], v11 offset:27648
v_mfma_f32_16x16x32_bf16 v[68:71], v[232:235], v[32:35], v[68:71]
v_rcp_f32 v94, v94
v_mfma_f32_16x16x32_bf16 v[72:75], v[168:171], v[36:39], v[72:75]
ds_read_b128 v[32:35], v11 offset:28672
v_mfma_f32_16x16x32_bf16 v[76:79], v[232:235], v[36:39], v[76:79]
s_waitcnt lgkmcnt(5)
v_mfma_f32_16x16x32_bf16 v[64:67], v[172:175], v[40:43], v[64:67]
ds_read_b128 v[36:39], v11 offset:29696
v_mfma_f32_16x16x32_bf16 v[68:71], v[236:239], v[40:43], v[68:71]
v_rcp_f32 v95, v95
v_mfma_f32_16x16x32_bf16 v[72:75], v[172:175], v[44:47], v[72:75]
ds_read_b128 v[40:43], v11 offset:30720
v_pk_mul_f32 v[48:49], v[48:49], v[88:89]
v_mfma_f32_16x16x32_bf16 v[76:79], v[236:239], v[44:47], v[76:79]
v_pk_mul_f32 v[50:51], v[50:51], v[90:91]
s_waitcnt lgkmcnt(5)
v_mfma_f32_16x16x32_bf16 v[64:67], v[176:179], v[16:19], v[64:67]
ds_read_b128 v[44:47], v11 offset:31744
v_pk_mul_f32 v[52:53], v[52:53], v[92:93]
v_mfma_f32_16x16x32_bf16 v[68:71], v[240:243], v[16:19], v[68:71]
v_pk_mul_f32 v[54:55], v[54:55], v[94:95]
v_cvt_pk_bf16_f32 v96, v48, v49
v_mfma_f32_16x16x32_bf16 v[72:75], v[176:179], v[20:23], v[72:75]
v_cvt_pk_bf16_f32 v97, v50, v51
v_cvt_pk_bf16_f32 v98, v52, v53
v_mfma_f32_16x16x32_bf16 v[76:79], v[240:243], v[20:23], v[76:79]
v_cvt_pk_bf16_f32 v99, v54, v55
s_waitcnt lgkmcnt(4)
v_mfma_f32_16x16x32_bf16 v[64:67], v[180:183], v[24:27], v[64:67]
s_nop 1
v_permlane16_swap_b32 v96, v98
v_mfma_f32_16x16x32_bf16 v[68:71], v[244:247], v[24:27], v[68:71]
v_permlane16_swap_b32 v97, v99
v_mfma_f32_16x16x32_bf16 v[72:75], v[180:183], v[28:31], v[72:75]
v_mfma_f32_16x16x32_bf16 v[76:79], v[244:247], v[28:31], v[76:79]
s_waitcnt lgkmcnt(2)
v_mfma_f32_16x16x32_bf16 v[64:67], v[184:187], v[32:35], v[64:67]
v_mfma_f32_16x16x32_bf16 v[68:71], v[248:251], v[32:35], v[68:71]
v_mfma_f32_16x16x32_bf16 v[72:75], v[184:187], v[36:39], v[72:75]
v_mfma_f32_16x16x32_bf16 v[76:79], v[248:251], v[36:39], v[76:79]
s_waitcnt lgkmcnt(0)
v_mfma_f32_16x16x32_bf16 v[64:67], v[188:191], v[40:43], v[64:67]
v_mfma_f32_16x16x32_bf16 v[68:71], v[252:255], v[40:43], v[68:71]
v_mfma_f32_16x16x32_bf16 v[72:75], v[188:191], v[44:47], v[72:75]
v_mfma_f32_16x16x32_bf16 v[76:79], v[252:255], v[44:47], v[76:79]
s_add_u32 s49, s49, 229376
s_cmp_ge_u32 s36, 4
s_cselect_b32 s58, s62, 0x70000000
s_add_u32 s62, s62, 65536
s_add_u32 s59, s59, 229376
s_add_u32 s36, s36, 1
s_cmp_lg_u32 s46, 0
s_cbranch_scc1 Lft_608
buffer_store_dwordx4 v[96:99], v6, s[4:7], s49 offen sc1
v_cvt_pk_bf16_f32 v80, v64, v65
v_cvt_pk_bf16_f32 v81, v66, v67
v_cvt_pk_bf16_f32 v82, v68, v69
v_cvt_pk_bf16_f32 v83, v70, v71
buffer_store_dwordx4 v[80:83], v7, s[4:7], s58 offen offset:0 sc1
v_cvt_pk_bf16_f32 v84, v72, v73
v_cvt_pk_bf16_f32 v85, v74, v75
v_cvt_pk_bf16_f32 v86, v76, v77
v_cvt_pk_bf16_f32 v87, v78, v79
buffer_store_dwordx4 v[84:87], v7, s[4:7], s58 offen offset:1024 sc1
s_cmp_lt_u32 s36, 64
s_cbranch_scc1 Lfw_610
s_mov_b32 s57, 63
s_waitcnt vmcnt(0)
s_barrier
s_sub_u32 s38, s36, 0
v_med3_i32 v100, s38, 0, 64
s_sub_u32 s38, s38, 4
v_max_i32 v101, s38, 0
buffer_store_dwordx2 v[100:101], v4, s[4:7], 0 offen sc1
Lbw_617:
buffer_load_dword v13, v12, s[4:7], s61 offen sc1
s_waitcnt vmcnt(0)
v_cmp_gt_u32 vcc, s57, v13
s_cbranch_vccz Lbo_618
s_sub_u32 s37, s37, 1
s_cbranch_scc1 Lend_7
s_sleep 1
s_branch Lbw_617
Lbo_618:
s_add_u32 s55, s59, 0
s_add_u32 m0, s60, 0
s_add_u32 s39, s55, 0
buffer_load_dwordx4 v10, s[4:7], s39 offen offset:0 sc1 lds
buffer_load_dwordx4 v10, s[4:7], s39 offen offset:1024 sc1 lds
buffer_load_dwordx4 v10, s[4:7], s39 offen offset:2048 sc1 lds
buffer_load_dwordx4 v10, s[4:7], s39 offen offset:3072 sc1 lds
s_add_u32 m0, s60, 4096
s_add_u32 s39, s55, 4096
buffer_load_dwordx4 v10, s[4:7], s39 offen offset:0 sc1 lds
buffer_load_dwordx4 v10, s[4:7], s39 offen offset:1024 sc1 lds
buffer_load_dwordx4 v10, s[4:7], s39 offen offset:2048 sc1 lds
buffer_load_dwordx4 v10, s[4:7], s39 offen offset:3072 sc1 lds
s_add_u32 s55, s59, 229376
s_add_u32 m0, s60, 32768
s_add_u32 s39, s55, 0
buffer_load_dwordx4 v10, s[4:7], s39 offen offset:0 sc1 lds
buffer_load_dwordx4 v10, s[4:7], s39 offen offset:1024 sc1 lds
buffer_load_dwordx4 v10, s[4:7], s39 offen offset:2048 sc1 lds
buffer_load_dwordx4 v10, s[4:7], s39 offen offset:3072 sc1 lds
s_add_u32 m0, s60, 36864
s_add_u32 s39, s55, 4096
buffer_load_dwordx4 v10, s[4:7], s39 offen offset:0 sc1 lds
buffer_load_dwordx4 v10, s[4:7], s39 offen offset:1024 sc1 lds
buffer_load_dwordx4 v10, s[4:7], s39 offen offset:2048 sc1 lds
buffer_load_dwordx4 v10, s[4:7], s39 offen offset:3072 sc1 lds
s_add_u32 s55, s59, 458752
s_add_u32 m0, s60, 65536
s_add_u32 s39, s55, 0
buffer_load_dwordx4 v10, s[4:7], s39 offen offset:0 sc1 lds
buffer_load_dwordx4 v10, s[4:7], s39 offen offset:1024 sc1 lds
buffer_load_dwordx4 v10, s[4:7], s39 offen offset:2048 sc1 lds
buffer_load_dwordx4 v10, s[4:7], s39 offen offset:3072 sc1 lds
s_add_u32 m0, s60, 69632
s_add_u32 s39, s55, 4096
buffer_load_dwordx4 v10, s[4:7], s39 offen offset:0 sc1 lds
buffer_load_dwordx4 v10, s[4:7], s39 offen offset:1024 sc1 lds
buffer_load_dwordx4 v10, s[4:7], s39 offen offset:2048 sc1 lds
buffer_load_dwordx4 v10, s[4:7], s39 offen offset:3072 sc1 lds
v_lshlrev_b32 v11, 4, v9
Lfz_619:
s_waitcnt vmcnt(0)
s_barrier
Lfm_620:
s_sub_u32 s57, s36, 3
s_max_i32 s57, s57, 0
ds_read_b128 v[16:19], v11 offset:0
ds_read_b128 v[20:23], v11 offset:1024
ds_read_b128 v[24:27], v11 offset:2048
ds_read_b128 v[28:31], v11 offset:3072
ds_read_b128 v[32:35], v11 offset:4096
ds_read_b128 v[36:39], v11 offset:5120
ds_read_b128 v[40:43], v11 offset:6144
s_waitcnt lgkmcnt(5)
v_mfma_f32_16x16x32_bf16 v[64:67], v[128:131], v[16:19], 0
ds_read_b128 v[44:47], v11 offset:7168
v_mfma_f32_16x16x32_bf16 v[68:71], v[192:195], v[16:19], 0
v_mfma_f32_16x16x32_bf16 v[72:75], v[128:131], v[20:23], 0
ds_read_b128 v[16:19], v11 offset:8192
v_mfma_f32_16x16x32_bf16 v[76:79], v[192:195], v[20:23], 0
s_waitcnt lgkmcnt(5)
v_mfma_f32_16x16x32_bf16 v[64:67], v[132:135], v[24:27], v[64:67]
ds_read_b128 v[20:23], v11 offset:9216
v_mfma_f32_16x16x32_bf16 v[68:71], v[196:199], v[24:27], v[68:71]
v_mfma_f32_16x16x32_bf16 v[72:75], v[132:135], v[28:31], v[72:75]
ds_read_b128 v[24:27], v11 offset:10240
v_mfma_f32_16x16x32_bf16 v[76:79], v[196:199], v[28:31], v[76:79]
s_waitcnt lgkmcnt(5)
v_mfma_f32_16x16x32_bf16 v[64:67], v[136:139], v[32:35], v[64:67]
ds_read_b128 v[28:31], v11 offset:11264
v_mfma_f32_16x16x32_bf16 v[68:71], v[200:203], v[32:35], v[68:71]
v_mfma_f32_16x16x32_bf16 v[72:75], v[136:139], v[36:39], v[72:75]
ds_read_b128 v[32:35], v11 offset:12288
v_mfma_f32_16x16x32_bf16 v[76:79], v[200:203], v[36:39], v[76:79]
s_waitcnt lgkmcnt(5)
v_mfma_f32_16x16x32_bf16 v[64:67], v[140:143], v[40:43], v[64:67]
ds_read_b128 v[36:39], v11 offset:13312
v_mfma_f32_16x16x32_bf16 v[68:71], v[204:207], v[40:43], v[68:71]
v_mfma_f32_16x16x32_bf16 v[72:75], v[140:143], v[44:47], v[72:75]
ds_read_b128 v[40:43], v11 offset:14336
v_mfma_f32_16x16x32_bf16 v[76:79], v[204:207], v[44:47], v[76:79]
s_waitcnt lgkmcnt(5)
v_mfma_f32_16x16x32_bf16 v[64:67], v[144:147], v[16:19], v[64:67]
ds_read_b128 v[44:47], v11 offset:15360
v_mfma_f32_16x16x32_bf16 v[68:71], v[208:211], v[16:19], v[68:71]
v_mfma_f32_16x16x32_bf16 v[72:75], v[144:147], v[20:23], v[72:75]
ds_read_b128 v[16:19], v11 offset:16384
v_mfma_f32_16x16x32_bf16 v[76:79], v[208:211], v[20:23], v[76:79]
s_waitcnt lgkmcnt(5)
v_mfma_f32_16x16x32_bf16 v[64:67], v[148:151], v[24:27], v[64:67]
ds_read_b128 v[20:23], v11 offset:17408
v_mfma_f32_16x16x32_bf16 v[68:71], v[212:215], v[24:27], v[68:71]
v_mfma_f32_16x16x32_bf16 v[72:75], v[148:151], v[28:31], v[72:75]
ds_read_b128 v[24:27], v11 offset:18432
v_mfma_f32_16x16x32_bf16 v[76:79], v[212:215], v[28:31], v[76:79]
s_waitcnt lgkmcnt(5)
v_mfma_f32_16x16x32_bf16 v[64:67], v[152:155], v[32:35], v[64:67]
ds_read_b128 v[28:31], v11 offset:19456
v_mfma_f32_16x16x32_bf16 v[68:71], v[216:219], v[32:35], v[68:71]
v_mfma_f32_16x16x32_bf16 v[72:75], v[152:155], v[36:39], v[72:75]
ds_read_b128 v[32:35], v11 offset:20480
v_mfma_f32_16x16x32_bf16 v[76:79], v[216:219], v[36:39], v[76:79]
s_waitcnt lgkmcnt(5)
v_mfma_f32_16x16x32_bf16 v[64:67], v[156:159], v[40:43], v[64:67]
ds_read_b128 v[36:39], v11 offset:21504
v_mfma_f32_16x16x32_bf16 v[68:71], v[220:223], v[40:43], v[68:71]
v_mfma_f32_16x16x32_bf16 v[72:75], v[156:159], v[44:47], v[72:75]
ds_read_b128 v[40:43], v11 offset:22528
v_mfma_f32_16x16x32_bf16 v[76:79], v[220:223], v[44:47], v[76:79]
s_waitcnt lgkmcnt(5)
v_mfma_f32_16x16x32_bf16 v[64:67], v[160:163], v[16:19], v[64:67]
ds_read_b128 v[44:47], v11 offset:23552
v_mfma_f32_16x16x32_bf16 v[68:71], v[224:227], v[16:19], v[68:71]
v_mfma_f32_16x16x32_bf16 v[72:75], v[160:163], v[20:23], v[72:75]
ds_read_b128 v[16:19], v11 offset:24576
v_mfma_f32_16x16x32_bf16 v[76:79], v[224:227], v[20:23], v[76:79]
s_waitcnt lgkmcnt(5)
v_mfma_f32_16x16x32_bf16 v[64:67], v[164:167], v[24:27], v[64:67]
ds_read_b128 v[20:23], v11 offset:25600
v_mfma_f32_16x16x32_bf16 v[68:71], v[228:231], v[24:27], v[68:71]
v_mfma_f32_16x16x32_bf16 v[72:75], v[164:167], v[28:31], v[72:75]
ds_read_b128 v[24:27], v11 offset:26624
v_mfma_f32_16x16x32_bf16 v[76:79], v[228:231], v[28:31], v[76:79]
s_waitcnt lgkmcnt(5)
v_mfma_f32_16x16x32_bf16 v[64:67], v[168:171], v[32:35], v[64:67]
ds_read_b128 v[28:31], v11 offset:27648
v_mfma_f32_16x16x32_bf16 v[68:71], v[232:235], v[32:35], v[68:71]
v_mfma_f32_16x16x32_bf16 v[72:75], v[168:171], v[36:39], v[72:75]
ds_read_b128 v[32:35], v11 offset:28672
v_mfma_f32_16x16x32_bf16 v[76:79], v[232:235], v[36:39], v[76:79]
s_waitcnt lgkmcnt(5)
v_mfma_f32_16x16x32_bf16 v[64:67], v[172:175], v[40:43], v[64:67]
ds_read_b128 v[36:39], v11 offset:29696
v_mfma_f32_16x16x32_bf16 v[68:71], v[236:239], v[40:43], v[68:71]
v_mfma_f32_16x16x32_bf16 v[72:75], v[172:175], v[44:47], v[72:75]
ds_read_b128 v[40:43], v11 offset:30720
v_mfma_f32_16x16x32_bf16 v[76:79], v[236:239], v[44:47], v[76:79]
s_waitcnt lgkmcnt(5)
v_mfma_f32_16x16x32_bf16 v[64:67], v[176:179], v[16:19], v[64:67]
ds_read_b128 v[44:47], v11 offset:31744
v_mfma_f32_16x16x32_bf16 v[68:71], v[240:243], v[16:19], v[68:71]
v_mfma_f32_16x16x32_bf16 v[72:75], v[176:179], v[20:23], v[72:75]
v_mfma_f32_16x16x32_bf16 v[76:79], v[240:243], v[20:23], v[76:79]
s_waitcnt lgkmcnt(4)
v_mfma_f32_16x16x32_bf16 v[64:67], v[180:183], v[24:27], v[64:67]
v_mfma_f32_16x16x32_bf16 v[68:71], v[244:247], v[24:27], v[68:71]
v_mfma_f32_16x16x32_bf16 v[72:75], v[180:183], v[28:31], v[72:75]
v_mfma_f32_16x16x32_bf16 v[76:79], v[244:247], v[28:31], v[76:79]
s_waitcnt lgkmcnt(2)
v_mfma_f32_16x16x32_bf16 v[64:67], v[184:187], v[32:35], v[64:67]
v_mfma_f32_16x16x32_bf16 v[68:71], v[248:251], v[32:35], v[68:71]
v_mfma_f32_16x16x32_bf16 v[72:75], v[184:187], v[36:39], v[72:75]
v_mfma_f32_16x16x32_bf16 v[76:79], v[248:251], v[36:39], v[76:79]
s_waitcnt lgkmcnt(0)
v_mfma_f32_16x16x32_bf16 v[64:67], v[188:191], v[40:43], v[64:67]
v_mfma_f32_16x16x32_bf16 v[68:71], v[252:255], v[40:43], v[68:71]
v_mfma_f32_16x16x32_bf16 v[72:75], v[188:191], v[44:47], v[72:75]
v_mfma_f32_16x16x32_bf16 v[76:79], v[252:255], v[44:47], v[76:79]
s_cmp_ge_u32 s36, 4
s_cselect_b32 s58, s62, 0x70000000
s_add_u32 s62, s62, 65536
s_add_u32 s59, s59, 229376
s_add_u32 s36, s36, 1
v_add_u32 v11, 0x8000, v11
s_nop 1
v_cvt_pk_bf16_f32 v80, v64, v65
v_cvt_pk_bf16_f32 v81, v66, v67
v_cvt_pk_bf16_f32 v82, v68, v69
v_cvt_pk_bf16_f32 v83, v70, v71
buffer_store_dwordx4 v[80:83], v7, s[4:7], s58 offen offset:0 sc1
v_cvt_pk_bf16_f32 v84, v72, v73
v_cvt_pk_bf16_f32 v85, v74, v75
v_cvt_pk_bf16_f32 v86, v76, v77
v_cvt_pk_bf16_f32 v87, v78, v79
buffer_store_dwordx4 v[84:87], v7, s[4:7], s58 offen offset:1024 sc1
s_cmp_lt_u32 s36, 67
s_cbranch_scc1 Lfm_620
s_waitcnt vmcnt(0)
s_barrier
s_sub_u32 s38, s36, 0
v_med3_i32 v100, s38, 0, 64
s_sub_u32 s38, s38, 4
v_max_i32 v101, s38, 0
buffer_store_dwordx2 v[100:101], v4, s[4:7], 0 offen sc1
s_cmp_eq_u32 s36, 68
s_cbranch_scc1 Lend_7
s_mov_b32 s57, 64
Lbw_621:
buffer_load_dword v13, v12, s[4:7], s61 offen sc1
s_waitcnt vmcnt(0)
v_cmp_gt_u32 vcc, s57, v13
s_cbranch_vccz Lbo_622
s_sub_u32 s37, s37, 1
s_cbranch_scc1 Lend_7
s_sleep 1
s_branch Lbw_621
Lbo_622:
s_add_u32 m0, s60, 98304
s_add_u32 s39, s59, 0
buffer_load_dwordx4 v10, s[4:7], s39 offen offset:0 sc1 lds
buffer_load_dwordx4 v10, s[4:7], s39 offen offset:1024 sc1 lds
buffer_load_dwordx4 v10, s[4:7], s39 offen offset:2048 sc1 lds
buffer_load_dwordx4 v10, s[4:7], s39 offen offset:3072 sc1 lds
s_add_u32 m0, s60, 102400
s_add_u32 s39, s59, 4096
buffer_load_dwordx4 v10, s[4:7], s39 offen offset:0 sc1 lds
buffer_load_dwordx4 v10, s[4:7], s39 offen offset:1024 sc1 lds
buffer_load_dwordx4 v10, s[4:7], s39 offen offset:2048 sc1 lds
buffer_load_dwordx4 v10, s[4:7], s39 offen offset:3072 sc1 lds
s_branch Lfz_619
Lfl_612:
Lbw_623:
buffer_load_dword v13, v12, s[4:7], s61 offen sc1
s_waitcnt vmcnt(0)
v_cmp_gt_u32 vcc, s57, v13
s_cbranch_vccz Lbo_624
s_sub_u32 s37, s37, 1
s_cbranch_scc1 Lend_7
s_sleep 2
s_branch Lbw_623
Lbo_624:
s_add_u32 m0, s60, 131072
s_add_u32 s39, s59, 0
buffer_load_dwordx4 v10, s[4:7], s39 offen offset:0 sc1 lds
buffer_load_dwordx4 v10, s[4:7], s39 offen offset:1024 sc1 lds
buffer_load_dwordx4 v10, s[4:7], s39 offen offset:2048 sc1 lds
buffer_load_dwordx4 v10, s[4:7], s39 offen offset:3072 sc1 lds
s_add_u32 m0, s60, 135168
s_add_u32 s39, s59, 4096
buffer_load_dwordx4 v10, s[4:7], s39 offen offset:0 sc1 lds
buffer_load_dwordx4 v10, s[4:7], s39 offen offset:1024 sc1 lds
buffer_load_dwordx4 v10, s[4:7], s39 offen offset:2048 sc1 lds
buffer_load_dwordx4 v10, s[4:7], s39 offen offset:3072 sc1 lds
s_waitcnt vmcnt(0)
s_branch Lfg_613
Lln_6:
s_sub_u32 s26, s44, 56
s_and_b32 s52, s26, 3
s_lshl_b32 s53, s32, 2
v_lshrrev_b32 v80, 3, v9
v_and_b32 v81, 7, v9
s_lshr_b32 s38, s52, 1
s_lshl_b32 s38, s38, 10
s_and_b32 s39, s52, 1
s_lshl_b32 s39, s39, 7
s_add_u32 s38, s38, s39
s_lshl_b32 s39, s53, 12
s_add_u32 s38, s38, s39
v_lshl_add_u32 v6, v81, 4, s38
v_and_b32 v82, 3, v80
v_lshl_add_u32 v6, v82, 8, v6
v_lshrrev_b32 v82, 2, v80
v_lshl_add_u32 v6, v82, 11, v6
s_lshl_b32 s38, s52, 14
s_lshl_b32 s39, s53, 7
s_add_u32 s38, s38, s39
v_lshl_add_u32 v7, v81, 11, s38
v_lshl_add_u32 v7, v80, 4, v7
s_lshl_b32 s38, s53, 8
v_lshl_add_u32 v8, v80, 5, s38
v_and_b32 v12, 7, v9
v_lshlrev_b32 v12, 4, v12
s_lshl_b32 s38, s32, 2
v_add_u32 v11, s38, v12
s_mov_b32 s60, 0x00003f80
s_mov_b32 s61, 0x3f800000
v_min_u32 v2, 31, v9
v_lshlrev_b32 v2, 7, v2
s_lshr_b32 s47, s26, 2
s_xor_b32 s47, s47, 1
s_lshl_b32 s47, s47, 12
s_add_u32 s47, s47, 3440640
v_lshlrev_b32 v80, 7, v9
s_mov_b32 s38, 3424256
Lbw_625:
buffer_load_dword v81, v80, s[4:7], s38 offen sc1
s_waitcnt vmcnt(0)
v_cmp_gt_u32 vcc, 4, v81
s_cbranch_vccz Lbo_626
s_sub_u32 s37, s37, 1
s_cbranch_scc1 Lend_7
s_sleep 2
s_branch Lbw_625
Lbo_626:
s_mov_b32 s38, 3153920
buffer_load_dwordx4 v[128:131], v8, s[4:7], s38 offen offset:0 sc1
buffer_load_dwordx4 v[132:135], v8, s[4:7], s38 offen offset:16 sc1
buffer_load_dwordx4 v[136:139], v8, s[4:7], s38 offen offset:256 sc1
buffer_load_dwordx4 v[140:143], v8, s[4:7], s38 offen offset:272 sc1
buffer_load_dwordx4 v[144:147], v8, s[4:7], s38 offen offset:512 sc1
buffer_load_dwordx4 v[148:151], v8, s[4:7], s38 offen offset:528 sc1
buffer_load_dwordx4 v[152:155], v8, s[4:7], s38 offen offset:768 sc1
buffer_load_dwordx4 v[156:159], v8, s[4:7], s38 offen offset:784 sc1
s_mov_b32 s38, 3158016
buffer_load_dwordx4 v[192:195], v8, s[4:7], s38 offen offset:0 sc1
buffer_load_dwordx4 v[196:199], v8, s[4:7], s38 offen offset:16 sc1
buffer_load_dwordx4 v[200:203], v8, s[4:7], s38 offen offset:256 sc1
buffer_load_dwordx4 v[204:207], v8, s[4:7], s38 offen offset:272 sc1
buffer_load_dwordx4 v[208:211], v8, s[4:7], s38 offen offset:512 sc1
buffer_load_dwordx4 v[212:215], v8, s[4:7], s38 offen offset:528 sc1
buffer_load_dwordx4 v[216:219], v8, s[4:7], s38 offen offset:768 sc1
buffer_load_dwordx4 v[220:223], v8, s[4:7], s38 offen offset:784 sc1
s_mov_b32 s38, 3162112
buffer_load_dwordx4 v[160:163], v8, s[4:7], s38 offen offset:0 sc1
buffer_load_dwordx4 v[164:167], v8, s[4:7], s38 offen offset:16 sc1
buffer_load_dwordx4 v[168:171], v8, s[4:7], s38 offen offset:256 sc1
buffer_load_dwordx4 v[172:175], v8, s[4:7], s38 offen offset:272 sc1
buffer_load_dwordx4 v[176:179], v8, s[4:7], s38 offen offset:512 sc1
buffer_load_dwordx4 v[180:183], v8, s[4:7], s38 offen offset:528 sc1
buffer_load_dwordx4 v[184:187], v8, s[4:7], s38 offen offset:768 sc1
buffer_load_dwordx4 v[188:191], v8, s[4:7], s38 offen offset:784 sc1
s_waitcnt vmcnt(0)
v_pk_add_f32 v[160:161], v[160:161], 1.0 op_sel_hi:[1,0]
v_pk_add_f32 v[162:163], v[162:163], 1.0 op_sel_hi:[1,0]
v_pk_add_f32 v[164:165], v[164:165], 1.0 op_sel_hi:[1,0]
v_pk_add_f32 v[166:167], v[166:167], 1.0 op_sel_hi:[1,0]
v_pk_add_f32 v[168:169], v[168:169], 1.0 op_sel_hi:[1,0]
v_pk_add_f32 v[170:171], v[170:171], 1.0 op_sel_hi:[1,0]
v_pk_add_f32 v[172:173], v[172:173], 1.0 op_sel_hi:[1,0]
v_pk_add_f32 v[174:175], v[174:175], 1.0 op_sel_hi:[1,0]
v_pk_add_f32 v[176:177], v[176:177], 1.0 op_sel_hi:[1,0]
v_pk_add_f32 v[178:179], v[178:179], 1.0 op_sel_hi:[1,0]
v_pk_add_f32 v[180:181], v[180:181], 1.0 op_sel_hi:[1,0]
v_pk_add_f32 v[182:183], v[182:183], 1.0 op_sel_hi:[1,0]
v_pk_add_f32 v[184:185], v[184:185], 1.0 op_sel_hi:[1,0]
v_pk_add_f32 v[186:187], v[186:187], 1.0 op_sel_hi:[1,0]
v_pk_add_f32 v[188:189], v[188:189], 1.0 op_sel_hi:[1,0]
v_pk_add_f32 v[190:191], v[190:191], 1.0 op_sel_hi:[1,0]
s_lshr_b32 s36, s26, 2
Lln_627:
s_lshl_b32 s49, s36, 16
buffer_load_dwordx4 v[80:83], v7, s[88:91], s49 offen offset:0
buffer_load_dwordx4 v[84:87], v7, s[88:91], s49 offen offset:128
buffer_load_dwordx4 v[88:91], v7, s[88:91], s49 offen offset:256
buffer_load_dwordx4 v[92:95], v7, s[88:91], s49 offen offset:384
s_add_u32 s48, s36, 1
Lbw_628:
buffer_load_dword v3, v2, s[4:7], s47 offen sc1
s_waitcnt vmcnt(0)
v_cmp_gt_u32 vcc, s48, v3
s_cbranch_vccz Lbo_629
s_sub_u32 s37, s37, 1
s_cbranch_scc1 Lend_7
s_sleep 2
s_branch Lbw_628
Lbo_629:
s_add_u32 s39, s49, 117440512
buffer_load_dwordx4 v[16:19], v6, s[4:7], s39 offen sc1
s_add_u32 s39, s49, 121634816
buffer_load_dwordx4 v[20:23], v6, s[4:7], s39 offen sc1
s_add_u32 s39, s49, 125829120
buffer_load_dwordx4 v[24:27], v6, s[4:7], s39 offen sc1
s_add_u32 s39, s49, 130023424
buffer_load_dwordx4 v[28:31], v6, s[4:7], s39 offen sc1
s_add_u32 s39, s49, 117444608
buffer_load_dwordx4 v[32:35], v6, s[4:7], s39 offen sc1
s_add_u32 s39, s49, 121638912
buffer_load_dwordx4 v[36:39], v6, s[4:7], s39 offen sc1
s_add_u32 s39, s49, 125833216
buffer_load_dwordx4 v[40:43], v6, s[4:7], s39 offen sc1
s_add_u32 s39, s49, 130027520
buffer_load_dwordx4 v[44:47], v6, s[4:7], s39 offen sc1
s_add_u32 s39, s49, 117448704
buffer_load_dwordx4 v[48:51], v6, s[4:7], s39 offen sc1
s_add_u32 s39, s49, 121643008
buffer_load_dwordx4 v[52:55], v6, s[4:7], s39 offen sc1
s_add_u32 s39, s49, 125837312
buffer_load_dwordx4 v[56:59], v6, s[4:7], s39 offen sc1
s_add_u32 s39, s49, 130031616
buffer_load_dwordx4 v[60:63], v6, s[4:7], s39 offen sc1
s_add_u32 s39, s49, 117452800
buffer_load_dwordx4 v[64:67], v6, s[4:7], s39 offen sc1
s_add_u32 s39, s49, 121647104
buffer_load_dwordx4 v[68:71], v6, s[4:7], s39 offen sc1
s_add_u32 s39, s49, 125841408
buffer_load_dwordx4 v[72:75], v6, s[4:7], s39 offen sc1
s_add_u32 s39, s49, 130035712
buffer_load_dwordx4 v[76:79], v6, s[4:7], s39 offen sc1
v_lshlrev_b32 v96, 16, v80
v_and_b32 v97, 0xffff0000, v80
v_lshlrev_b32 v98, 16, v81
v_and_b32 v99, 0xffff0000, v81
v_lshlrev_b32 v100, 16, v82
v_and_b32 v101, 0xffff0000, v82
v_lshlrev_b32 v102, 16, v83
v_and_b32 v103, 0xffff0000, v83
v_lshlrev_b32 v104, 16, v84
v_and_b32 v105, 0xffff0000, v84
v_lshlrev_b32 v106, 16, v85
v_and_b32 v107, 0xffff0000, v85
v_lshlrev_b32 v108, 16, v86
v_and_b32 v109, 0xffff0000, v86
v_lshlrev_b32 v110, 16, v87
v_and_b32 v111, 0xffff0000, v87
v_lshlrev_b32 v112, 16, v88
v_and_b32 v113, 0xffff0000, v88
v_lshlrev_b32 v114, 16, v89
v_and_b32 v115, 0xffff0000, v89
v_lshlrev_b32 v116, 16, v90
v_and_b32 v117, 0xffff0000, v90
v_lshlrev_b32 v118, 16, v91
v_and_b32 v119, 0xffff0000, v91
v_lshlrev_b32 v120, 16, v92
v_and_b32 v121, 0xffff0000, v92
v_lshlrev_b32 v122, 16, v93
v_and_b32 v123, 0xffff0000, v93
v_lshlrev_b32 v124, 16, v94
v_and_b32 v125, 0xffff0000, v94
v_lshlrev_b32 v126, 16, v95
v_and_b32 v127, 0xffff0000, v95
s_waitcnt vmcnt(12)
v_dot2_f32_bf16 v224, v16, s60, 0
v_dot2_f32_bf16 v225, v16, s61, 0
v_dot2_f32_bf16 v226, v17, s60, 0
v_dot2_f32_bf16 v227, v17, s61, 0
v_dot2_f32_bf16 v228, v18, s60, 0
v_dot2_f32_bf16 v229, v18, s61, 0
v_dot2_f32_bf16 v230, v19, s60, 0
v_dot2_f32_bf16 v231, v19, s61, 0
v_dot2_f32_bf16 v224, v20, s60, v224
v_dot2_f32_bf16 v225, v20, s61, v225
v_dot2_f32_bf16 v226, v21, s60, v226
v_dot2_f32_bf16 v227, v21, s61, v227
v_dot2_f32_bf16 v228, v22, s60, v228
v_dot2_f32_bf16 v229, v22, s61, v229
v_dot2_f32_bf16 v230, v23, s60, v230
v_dot2_f32_bf16 v231, v23, s61, v231
v_dot2_f32_bf16 v224, v24, s60, v224
v_dot2_f32_bf16 v225, v24, s61, v225
v_dot2_f32_bf16 v226, v25, s60, v226
v_dot2_f32_bf16 v227, v25, s61, v227
v_dot2_f32_bf16 v228, v26, s60, v228
v_dot2_f32_bf16 v229, v26, s61, v229
v_dot2_f32_bf16 v230, v27, s60, v230
v_dot2_f32_bf16 v231, v27, s61, v231
v_dot2_f32_bf16 v224, v28, s60, v224
v_dot2_f32_bf16 v225, v28, s61, v225
v_dot2_f32_bf16 v226, v29, s60, v226
v_dot2_f32_bf16 v227, v29, s61, v227
v_dot2_f32_bf16 v228, v30, s60, v228
v_dot2_f32_bf16 v229, v30, s61, v229
v_dot2_f32_bf16 v230, v31, s60, v230
v_dot2_f32_bf16 v231, v31, s61, v231
s_nop 1
v_pk_fma_f32 v[96:97], v[224:225], v[128:129], v[96:97]
v_pk_fma_f32 v[98:99], v[226:227], v[130:131], v[98:99]
v_pk_fma_f32 v[100:101], v[228:229], v[132:133], v[100:101]
v_pk_fma_f32 v[102:103], v[230:231], v[134:135], v[102:103]
v_cvt_pk_bf16_f32 v80, v96, v97
v_cvt_pk_bf16_f32 v81, v98, v99
v_cvt_pk_bf16_f32 v82, v100, v101
v_cvt_pk_bf16_f32 v83, v102, v103
s_add_u32 s39, s49, 12582912
buffer_store_dwordx4 v[80:83], v6, s[4:7], s39 offen sc1
v_lshlrev_b32 v96, 16, v80
v_and_b32 v97, 0xffff0000, v80
v_lshlrev_b32 v98, 16, v81
v_and_b32 v99, 0xffff0000, v81
v_lshlrev_b32 v100, 16, v82
v_and_b32 v101, 0xffff0000, v82
v_lshlrev_b32 v102, 16, v83
v_and_b32 v103, 0xffff0000, v83
s_waitcnt vmcnt(9)
v_dot2_f32_bf16 v224, v32, s60, 0
v_dot2_f32_bf16 v225, v32, s61, 0
v_dot2_f32_bf16 v226, v33, s60, 0
v_dot2_f32_bf16 v227, v33, s61, 0
v_dot2_f32_bf16 v228, v34, s60, 0
v_dot2_f32_bf16 v229, v34, s61, 0
v_dot2_f32_bf16 v230, v35, s60, 0
v_dot2_f32_bf16 v231, v35, s61, 0
v_dot2_f32_bf16 v224, v36, s60, v224
v_dot2_f32_bf16 v225, v36, s61, v225
v_dot2_f32_bf16 v226, v37, s60, v226
v_dot2_f32_bf16 v227, v37, s61, v227
v_dot2_f32_bf16 v228, v38, s60, v228
v_dot2_f32_bf16 v229, v38, s61, v229
v_dot2_f32_bf16 v230, v39, s60, v230
v_dot2_f32_bf16 v231, v39, s61, v231
v_dot2_f32_bf16 v224, v40, s60, v224
v_dot2_f32_bf16 v225, v40, s61, v225
v_dot2_f32_bf16 v226, v41, s60, v226
v_dot2_f32_bf16 v227, v41, s61, v227
v_dot2_f32_bf16 v228, v42, s60, v228
v_dot2_f32_bf16 v229, v42, s61, v229
v_dot2_f32_bf16 v230, v43, s60, v230
v_dot2_f32_bf16 v231, v43, s61, v231
v_dot2_f32_bf16 v224, v44, s60, v224
v_dot2_f32_bf16 v225, v44, s61, v225
v_dot2_f32_bf16 v226, v45, s60, v226
v_dot2_f32_bf16 v227, v45, s61, v227
v_dot2_f32_bf16 v228, v46, s60, v228
v_dot2_f32_bf16 v229, v46, s61, v229
v_dot2_f32_bf16 v230, v47, s60, v230
v_dot2_f32_bf16 v231, v47, s61, v231
s_nop 1
v_pk_fma_f32 v[104:105], v[224:225], v[136:137], v[104:105]
v_pk_fma_f32 v[106:107], v[226:227], v[138:139], v[106:107]
v_pk_fma_f32 v[108:109], v[228:229], v[140:141], v[108:109]
v_pk_fma_f32 v[110:111], v[230:231], v[142:143], v[110:111]
v_cvt_pk_bf16_f32 v84, v104, v105
v_cvt_pk_bf16_f32 v85, v106, v107
v_cvt_pk_bf16_f32 v86, v108, v109
v_cvt_pk_bf16_f32 v87, v110, v111
s_add_u32 s39, s49, 12587008
buffer_store_dwordx4 v[84:87], v6, s[4:7], s39 offen sc1
v_lshlrev_b32 v104, 16, v84
v_and_b32 v105, 0xffff0000, v84
v_lshlrev_b32 v106, 16, v85
v_and_b32 v107, 0xffff0000, v85
v_lshlrev_b32 v108, 16, v86
v_and_b32 v109, 0xffff0000, v86
v_lshlrev_b32 v110, 16, v87
v_and_b32 v111, 0xffff0000, v87
s_waitcnt vmcnt(6)
v_dot2_f32_bf16 v224, v48, s60, 0
v_dot2_f32_bf16 v225, v48, s61, 0
v_dot2_f32_bf16 v226, v49, s60, 0
v_dot2_f32_bf16 v227, v49, s61, 0
v_dot2_f32_bf16 v228, v50, s60, 0
v_dot2_f32_bf16 v229, v50, s61, 0
v_dot2_f32_bf16 v230, v51, s60, 0
v_dot2_f32_bf16 v231, v51, s61, 0
v_dot2_f32_bf16 v224, v52, s60, v224
v_dot2_f32_bf16 v225, v52, s61, v225
v_dot2_f32_bf16 v226, v53, s60, v226
v_dot2_f32_bf16 v227, v53, s61, v227
v_dot2_f32_bf16 v228, v54, s60, v228
v_dot2_f32_bf16 v229, v54, s61, v229
v_dot2_f32_bf16 v230, v55, s60, v230
v_dot2_f32_bf16 v231, v55, s61, v231
v_dot2_f32_bf16 v224, v56, s60, v224
v_dot2_f32_bf16 v225, v56, s61, v225
v_dot2_f32_bf16 v226, v57, s60, v226
v_dot2_f32_bf16 v227, v57, s61, v227
v_dot2_f32_bf16 v228, v58, s60, v228
v_dot2_f32_bf16 v229, v58, s61, v229
v_dot2_f32_bf16 v230, v59, s60, v230
v_dot2_f32_bf16 v231, v59, s61, v231
v_dot2_f32_bf16 v224, v60, s60, v224
v_dot2_f32_bf16 v225, v60, s61, v225
v_dot2_f32_bf16 v226, v61, s60, v226
v_dot2_f32_bf16 v227, v61, s61, v227
v_dot2_f32_bf16 v228, v62, s60, v228
v_dot2_f32_bf16 v229, v62, s61, v229
v_dot2_f32_bf16 v230, v63, s60, v230
v_dot2_f32_bf16 v231, v63, s61, v231
s_nop 1
v_pk_fma_f32 v[112:113], v[224:225], v[144:145], v[112:113]
v_pk_fma_f32 v[114:115], v[226:227], v[146:147], v[114:115]
v_pk_fma_f32 v[116:117], v[228:229], v[148:149], v[116:117]
v_pk_fma_f32 v[118:119], v[230:231], v[150:151], v[118:119]
v_cvt_pk_bf16_f32 v88, v112, v113
v_cvt_pk_bf16_f32 v89, v114, v115
v_cvt_pk_bf16_f32 v90, v116, v117
v_cvt_pk_bf16_f32 v91, v118, v119
s_add_u32 s39, s49, 12591104
buffer_store_dwordx4 v[88:91], v6, s[4:7], s39 offen sc1
v_lshlrev_b32 v112, 16, v88
v_and_b32 v113, 0xffff0000, v88
v_lshlrev_b32 v114, 16, v89
v_and_b32 v115, 0xffff0000, v89
v_lshlrev_b32 v116, 16, v90
v_and_b32 v117, 0xffff0000, v90
v_lshlrev_b32 v118, 16, v91
v_and_b32 v119, 0xffff0000, v91
s_waitcnt vmcnt(3)
v_dot2_f32_bf16 v224, v64, s60, 0
v_dot2_f32_bf16 v225, v64, s61, 0
v_dot2_f32_bf16 v226, v65, s60, 0
v_dot2_f32_bf16 v227, v65, s61, 0
v_dot2_f32_bf16 v228, v66, s60, 0
v_dot2_f32_bf16 v229, v66, s61, 0
v_dot2_f32_bf16 v230, v67, s60, 0
v_dot2_f32_bf16 v231, v67, s61, 0
v_dot2_f32_bf16 v224, v68, s60, v224
v_dot2_f32_bf16 v225, v68, s61, v225
v_dot2_f32_bf16 v226, v69, s60, v226
v_dot2_f32_bf16 v227, v69, s61, v227
v_dot2_f32_bf16 v228, v70, s60, v228
v_dot2_f32_bf16 v229, v70, s61, v229
v_dot2_f32_bf16 v230, v71, s60, v230
v_dot2_f32_bf16 v231, v71, s61, v231
v_dot2_f32_bf16 v224, v72, s60, v224
v_dot2_f32_bf16 v225, v72, s61, v225
v_dot2_f32_bf16 v226, v73, s60, v226
v_dot2_f32_bf16 v227, v73, s61, v227
v_dot2_f32_bf16 v228, v74, s60, v228
v_dot2_f32_bf16 v229, v74, s61, v229
v_dot2_f32_bf16 v230, v75, s60, v230
v_dot2_f32_bf16 v231, v75, s61, v231
v_dot2_f32_bf16 v224, v76, s60, v224
v_dot2_f32_bf16 v225, v76, s61, v225
v_dot2_f32_bf16 v226, v77, s60, v226
v_dot2_f32_bf16 v227, v77, s61, v227
v_dot2_f32_bf16 v228, v78, s60, v228
v_dot2_f32_bf16 v229, v78, s61, v229
v_dot2_f32_bf16 v230, v79, s60, v230
v_dot2_f32_bf16 v231, v79, s61, v231
s_nop 1
v_pk_fma_f32 v[120:121], v[224:225], v[152:153], v[120:121]
v_pk_fma_f32 v[122:123], v[226:227], v[154:155], v[122:123]
v_pk_fma_f32 v[124:125], v[228:229], v[156:157], v[124:125]
v_pk_fma_f32 v[126:127], v[230:231], v[158:159], v[126:127]
v_cvt_pk_bf16_f32 v92, v120, v121
v_cvt_pk_bf16_f32 v93, v122, v123
v_cvt_pk_bf16_f32 v94, v124, v125
v_cvt_pk_bf16_f32 v95, v126, v127
s_add_u32 s39, s49, 12595200
buffer_store_dwordx4 v[92:95], v6, s[4:7], s39 offen sc1
v_lshlrev_b32 v120, 16, v92
v_and_b32 v121, 0xffff0000, v92
v_lshlrev_b32 v122, 16, v93
v_and_b32 v123, 0xffff0000, v93
v_lshlrev_b32 v124, 16, v94
v_and_b32 v125, 0xffff0000, v94
v_lshlrev_b32 v126, 16, v95
v_and_b32 v127, 0xffff0000, v95
v_pk_add_f32 v[224:225], v[96:97], v[98:99]
v_pk_add_f32 v[224:225], v[224:225], v[100:101]
v_pk_add_f32 v[224:225], v[224:225], v[102:103]
v_pk_add_f32 v[224:225], v[224:225], v[104:105]
v_pk_add_f32 v[224:225], v[224:225], v[106:107]
v_pk_add_f32 v[224:225], v[224:225], v[108:109]
v_pk_add_f32 v[224:225], v[224:225], v[110:111]
v_pk_add_f32 v[224:225], v[224:225], v[112:113]
v_pk_add_f32 v[224:225], v[224:225], v[114:115]
v_pk_add_f32 v[224:225], v[224:225], v[116:117]
v_pk_add_f32 v[224:225], v[224:225], v[118:119]
v_pk_add_f32 v[224:225], v[224:225], v[120:121]
v_pk_add_f32 v[224:225], v[224:225], v[122:123]
v_pk_add_f32 v[224:225], v[224:225], v[124:125]
v_pk_add_f32 v[224:225], v[224:225], v[126:127]
v_add_f32 v224, v224, v225
s_nop 1
v_add_f32_dpp v224, v224, v224 row_ror:8 row_mask:0xf bank_mask:0xf
v_mov_b32 v225, v224
s_nop 1
v_permlane16_swap_b32 v224, v225
s_nop 0
v_add_f32 v224, v224, v225
v_mov_b32 v225, v224
s_nop 1
v_permlane32_swap_b32 v224, v225
s_nop 0
v_add_f32 v224, v224, v225
ds_write_b32 v11, v224 offset:512
s_waitcnt lgkmcnt(0)
s_barrier
ds_read_b128 v[224:227], v12 offset:512
s_waitcnt lgkmcnt(0)
v_pk_add_f32 v[224:225], v[224:225], v[226:227]
v_add_f32 v224, v224, v225
v_mul_f32 v224, 0x3a800000, v224
v_pk_add_f32 v[96:97], v[96:97], v[224:225] op_sel_hi:[1,0] neg_lo:[0,1] neg_hi:[0,1]
v_pk_add_f32 v[98:99], v[98:99], v[224:225] op_sel_hi:[1,0] neg_lo:[0,1] neg_hi:[0,1]
v_pk_add_f32 v[100:101], v[100:101], v[224:225] op_sel_hi:[1,0] neg_lo:[0,1] neg_hi:[0,1]
v_pk_add_f32 v[102:103], v[102:103], v[224:225] op_sel_hi:[1,0] neg_lo:[0,1] neg_hi:[0,1]
v_pk_add_f32 v[104:105], v[104:105], v[224:225] op_sel_hi:[1,0] neg_lo:[0,1] neg_hi:[0,1]
v_pk_add_f32 v[106:107], v[106:107], v[224:225] op_sel_hi:[1,0] neg_lo:[0,1] neg_hi:[0,1]
v_pk_add_f32 v[108:109], v[108:109], v[224:225] op_sel_hi:[1,0] neg_lo:[0,1] neg_hi:[0,1]
v_pk_add_f32 v[110:111], v[110:111], v[224:225] op_sel_hi:[1,0] neg_lo:[0,1] neg_hi:[0,1]
v_pk_add_f32 v[112:113], v[112:113], v[224:225] op_sel_hi:[1,0] neg_lo:[0,1] neg_hi:[0,1]
v_pk_add_f32 v[114:115], v[114:115], v[224:225] op_sel_hi:[1,0] neg_lo:[0,1] neg_hi:[0,1]
v_pk_add_f32 v[116:117], v[116:117], v[224:225] op_sel_hi:[1,0] neg_lo:[0,1] neg_hi:[0,1]
v_pk_add_f32 v[118:119], v[118:119], v[224:225] op_sel_hi:[1,0] neg_lo:[0,1] neg_hi:[0,1]
v_pk_add_f32 v[120:121], v[120:121], v[224:225] op_sel_hi:[1,0] neg_lo:[0,1] neg_hi:[0,1]
v_pk_add_f32 v[122:123], v[122:123], v[224:225] op_sel_hi:[1,0] neg_lo:[0,1] neg_hi:[0,1]
v_pk_add_f32 v[124:125], v[124:125], v[224:225] op_sel_hi:[1,0] neg_lo:[0,1] neg_hi:[0,1]
v_pk_add_f32 v[126:127], v[126:127], v[224:225] op_sel_hi:[1,0] neg_lo:[0,1] neg_hi:[0,1]
v_pk_mul_f32 v[224:225], v[96:97], v[96:97]
v_pk_fma_f32 v[224:225], v[98:99], v[98:99], v[224:225]
v_pk_fma_f32 v[224:225], v[100:101], v[100:101], v[224:225]
v_pk_fma_f32 v[224:225], v[102:103], v[102:103], v[224:225]
v_pk_fma_f32 v[224:225], v[104:105], v[104:105], v[224:225]
v_pk_fma_f32 v[224:225], v[106:107], v[106:107], v[224:225]
v_pk_fma_f32 v[224:225], v[108:109], v[108:109], v[224:225]
v_pk_fma_f32 v[224:225], v[110:111], v[110:111], v[224:225]
v_pk_fma_f32 v[224:225], v[112:113], v[112:113], v[224:225]
v_pk_fma_f32 v[224:225], v[114:115], v[114:115], v[224:225]
v_pk_fma_f32 v[224:225], v[116:117], v[116:117], v[224:225]
v_pk_fma_f32 v[224:225], v[118:119], v[118:119], v[224:225]
v_pk_fma_f32 v[224:225], v[120:121], v[120:121], v[224:225]
v_pk_fma_f32 v[224:225], v[122:123], v[122:123], v[224:225]
v_pk_fma_f32 v[224:225], v[124:125], v[124:125], v[224:225]
v_pk_fma_f32 v[224:225], v[126:127], v[126:127], v[224:225]
v_add_f32 v224, v224, v225
s_nop 1
v_add_f32_dpp v224, v224, v224 row_ror:8 row_mask:0xf bank_mask:0xf
v_mov_b32 v225, v224
s_nop 1
v_permlane16_swap_b32 v224, v225
s_nop 0
v_add_f32 v224, v224, v225
v_mov_b32 v225, v224
s_nop 1
v_permlane32_swap_b32 v224, v225
s_nop 0
v_add_f32 v224, v224, v225
ds_write_b32 v11, v224 offset:768
s_waitcnt lgkmcnt(0)
s_barrier
ds_read_b128 v[224:227], v12 offset:768
s_waitcnt lgkmcnt(0)
v_pk_add_f32 v[224:225], v[224:225], v[226:227]
v_add_f32 v224, v224, v225
v_mul_f32 v224, 0x3a800000, v224
v_add_f32 v224, 0x3727c5ac, v224
v_rsq_f32 v224, v224
s_nop 0
v_pk_mul_f32 v[96:97], v[96:97], v[224:225] op_sel_hi:[1,0]
v_pk_mul_f32 v[98:99], v[98:99], v[224:225] op_sel_hi:[1,0]
v_pk_mul_f32 v[100:101], v[100:101], v[224:225] op_sel_hi:[1,0]
v_pk_mul_f32 v[102:103], v[102:103], v[224:225] op_sel_hi:[1,0]
v_pk_mul_f32 v[104:105], v[104:105], v[224:225] op_sel_hi:[1,0]
v_pk_mul_f32 v[106:107], v[106:107], v[224:225] op_sel_hi:[1,0]
v_pk_mul_f32 v[108:109], v[108:109], v[224:225] op_sel_hi:[1,0]
v_pk_mul_f32 v[110:111], v[110:111], v[224:225] op_sel_hi:[1,0]
v_pk_mul_f32 v[112:113], v[112:113], v[224:225] op_sel_hi:[1,0]
v_pk_mul_f32 v[114:115], v[114:115], v[224:225] op_sel_hi:[1,0]
v_pk_mul_f32 v[116:117], v[116:117], v[224:225] op_sel_hi:[1,0]
v_pk_mul_f32 v[118:119], v[118:119], v[224:225] op_sel_hi:[1,0]
v_pk_mul_f32 v[120:121], v[120:121], v[224:225] op_sel_hi:[1,0]
v_pk_mul_f32 v[122:123], v[122:123], v[224:225] op_sel_hi:[1,0]
v_pk_mul_f32 v[124:125], v[124:125], v[224:225] op_sel_hi:[1,0]
v_pk_mul_f32 v[126:127], v[126:127], v[224:225] op_sel_hi:[1,0]
v_pk_fma_f32 v[96:97], v[96:97], v[160:161], v[192:193]
v_pk_fma_f32 v[98:99], v[98:99], v[162:163], v[194:195]
v_pk_fma_f32 v[100:101], v[100:101], v[164:165], v[196:197]
v_pk_fma_f32 v[102:103], v[102:103], v[166:167], v[198:199]
v_cvt_pk_bf16_f32 v16, v96, v97
v_cvt_pk_bf16_f32 v17, v98, v99
v_cvt_pk_bf16_f32 v18, v100, v101
v_cvt_pk_bf16_f32 v19, v102, v103
s_add_u32 s39, s49, 16777216
buffer_store_dwordx4 v[16:19], v6, s[4:7], s39 offen sc1
v_pk_fma_f32 v[104:105], v[104:105], v[168:169], v[200:201]
v_pk_fma_f32 v[106:107], v[106:107], v[170:171], v[202:203]
v_pk_fma_f32 v[108:109], v[108:109], v[172:173], v[204:205]
v_pk_fma_f32 v[110:111], v[110:111], v[174:175], v[206:207]
v_cvt_pk_bf16_f32 v20, v104, v105
v_cvt_pk_bf16_f32 v21, v106, v107
v_cvt_pk_bf16_f32 v22, v108, v109
v_cvt_pk_bf16_f32 v23, v110, v111
s_add_u32 s39, s49, 16781312
buffer_store_dwordx4 v[20:23], v6, s[4:7], s39 offen sc1
v_pk_fma_f32 v[112:113], v[112:113], v[176:177], v[208:209]
v_pk_fma_f32 v[114:115], v[114:115], v[178:179], v[210:211]
v_pk_fma_f32 v[116:117], v[116:117], v[180:181], v[212:213]
v_pk_fma_f32 v[118:119], v[118:119], v[182:183], v[214:215]
v_cvt_pk_bf16_f32 v24, v112, v113
v_cvt_pk_bf16_f32 v25, v114, v115
v_cvt_pk_bf16_f32 v26, v116, v117
v_cvt_pk_bf16_f32 v27, v118, v119
s_add_u32 s39, s49, 16785408
buffer_store_dwordx4 v[24:27], v6, s[4:7], s39 offen sc1
v_pk_fma_f32 v[120:121], v[120:121], v[184:185], v[216:217]
v_pk_fma_f32 v[122:123], v[122:123], v[186:187], v[218:219]
v_pk_fma_f32 v[124:125], v[124:125], v[188:189], v[220:221]
v_pk_fma_f32 v[126:127], v[126:127], v[190:191], v[222:223]
v_cvt_pk_bf16_f32 v28, v120, v121
v_cvt_pk_bf16_f32 v29, v122, v123
v_cvt_pk_bf16_f32 v30, v124, v125
v_cvt_pk_bf16_f32 v31, v126, v127
s_add_u32 s39, s49, 16789504
buffer_store_dwordx4 v[28:31], v6, s[4:7], s39 offen sc1
v_mov_b32 v5, s48
s_waitcnt vmcnt(0)
s_barrier
buffer_store_dword v5, v4, s[4:7], 0 offen sc1
s_add_u32 s36, s36, 2
s_cmp_lt_u32 s36, 64
s_cbranch_scc1 Lln_627
s_endpgm

.section .rodata,"a"
.p2align 6
.amdhsa_kernel adaLN_cond__memory_aug_recurrent_mem_tr__glu_gated_swiglu__prompt_kernel
  .amdhsa_next_free_vgpr 512
  .amdhsa_next_free_sgpr 102
  .amdhsa_accum_offset 256
  .amdhsa_group_segment_fixed_size 0
  .amdhsa_kernarg_size 128
  .amdhsa_user_sgpr_count 2
  .amdhsa_user_sgpr_kernarg_segment_ptr 1
  .amdhsa_system_sgpr_workgroup_id_x 1
  .amdhsa_float_denorm_mode_32 3
.end_amdhsa_kernel
```

```asm
; @launch grid=(256,1,1) block=(256,1,1) lds=163840
.amdgcn_target "amdgcn-amd-amdhsa--gfx950"
.text
.globl adaLN_cond__memory_aug_recurrent_mem_tr__glu_gated_swiglu__prompt_kernel
.p2align 8
.type adaLN_cond__memory_aug_recurrent_mem_tr__glu_gated_swiglu__prompt_kernel,@function
adaLN_cond__memory_aug_recurrent_mem_tr__glu_gated_swiglu__prompt_kernel:
s_cmp_ge_u32 s2, 256
s_cbranch_scc1 Lend_1
s_load_dwordx8 s[16:23], s[0:1], 8
s_load_dwordx2 s[24:25], s[0:1], 40
s_load_dwordx4 s[28:31], s[0:1], 112
s_getreg_b32 s51, hwreg(HW_REG_XCC_ID, 0, 4)
s_and_b32 s51, s51, 7
v_lshrrev_b32 v1, 6, v0
s_nop 0
v_readfirstlane_b32 s32, v1
v_and_b32 v1, 63, v0
s_waitcnt lgkmcnt(0)
s_mov_b32 s4, s30
s_and_b32 s5, s31, 0xffff
s_mov_b32 s6, 0x10000000
s_mov_b32 s7, 0x20000
s_mov_b32 s12, s28
s_and_b32 s13, s29, 0xffff
s_mov_b32 s14, 0x100
s_mov_b32 s15, 0x20000
s_mov_b32 s37, 200000
s_mov_b32 s80, 0
s_mov_b32 s81, 0
s_mov_b32 s82, 0
s_mov_b32 s83, 0
s_cmp_lg_u32 s32, 0
s_cbranch_scc1 Lrs_10
s_mov_b32 s33, s51
s_mov_b32 s35, 0
s_mov_b64 exec, 1
Lrl_9:
s_and_b32 s38, s33, 4
s_mul_i32 s38, s38, 7
s_add_u32 s38, s38, s33
v_lshlrev_b32 v2, 2, s38
v_mov_b32 v3, 1
buffer_atomic_add v3, v2, s[12:15], 0 offen sc0 sc1
s_waitcnt vmcnt(0)
v_readfirstlane_b32 s34, v3
s_nop 3
s_cmp_lt_u32 s34, 32
s_cbranch_scc1 Lrg_8
s_add_u32 s33, s33, 1
s_and_b32 s33, s33, 7
s_add_u32 s35, s35, 1
s_cmp_lt_u32 s35, 8
s_cbranch_scc1 Lrl_9
Lrg_8:
s_lshl_b32 s38, s33, 8
s_min_u32 s34, s34, 255
s_or_b32 s38, s38, s34
s_lshl_b32 s39, s35, 16
s_or_b32 s38, s38, s39
v_mov_b32 v3, s38
v_mov_b32 v2, 0
ds_write_b32 v2, v3
s_mov_b64 exec, -1
Lrs_10:
s_waitcnt lgkmcnt(0)
s_barrier
v_mov_b32 v2, 0
ds_read_b32 v3, v2
s_waitcnt lgkmcnt(0)
v_readfirstlane_b32 s38, v3
s_barrier
s_and_b32 s34, s38, 255
s_bfe_u32 s33, s38, 0x80008
s_lshr_b32 s35, s38, 16
s_min_u32 s35, s35, 1
s_cmp_ge_u32 s34, 32
s_cbranch_scc1 Lend_1
s_cmp_ge_u32 s33, 4
s_cselect_b32 s38, 16, 24
s_add_u32 s34, s34, s38
s_and_b32 s34, s34, 31
s_getpc_b64 s[40:41]
Lcode_here:
s_lshl_b32 s42, s34, 12
v_lshl_add_u32 v2, v0, 4, s42
v_min_u32 v2, Lcode_end-Lcode_here-16, v2
v_mov_b32 v3, s41
v_add_co_u32 v2, vcc, s40, v2
s_nop 1
v_addc_co_u32 v3, vcc, 0, v3, vcc
global_load_dword v255, v[2:3], off
s_cmp_ge_u32 s33, 4
s_cbranch_scc1 Lhi_4
s_cmp_ge_u32 s34, 24
s_cbranch_scc1 Lg3_3
s_cmp_ge_u32 s34, 8
s_cbranch_scc1 Lkvo_2
v_mov_b32 v48, v0
v_mov_b32 v50, v1
s_lshl_b32 s54, s33, 3
s_add_u32 s54, s54, s34
s_and_b32 s55, s32, 1
s_lshr_b32 s56, s32, 1
s_lshl_b32 s45, s33, 18
s_add_u32 s45, s45, 2097152
s_lshl_b32 s38, s32, 12
v_lshl_add_u32 v10, v50, 4, s38
s_lshl_b32 s38, s34, 11
s_add_u32 s39, s38, 16384
v_lshl_add_u32 v11, v50, 4, s39
s_lshl_b32 s39, s56, 10
s_add_u32 s38, s38, s39
s_lshl_b32 s39, s55, 3
s_add_u32 s39, s39, s38
s_add_u32 s39, s39, 32768
v_lshl_add_u32 v12, v50, 4, s39
v_xor_b32 v13, 8, v12
s_lshl_b32 s39, s55, 9
s_add_u32 s39, s39, s38
s_add_u32 s39, s39, 49152
v_bfe_u32 v51, v50, 5, 1
v_lshl_add_u32 v14, v51, 8, s39
v_and_b32 v51, 7, v50
v_lshl_add_u32 v14, v51, 5, v14
v_and_b32 v51, 16, v50
v_add_u32 v14, v14, v51
v_bfe_u32 v51, v50, 3, 1
v_lshl_add_u32 v14, v51, 30, v14
v_and_b32 v51, 1, v50
v_mul_u32_u24 v51, 0xaaaa, v51
v_add_u32 v15, 0x4444, v51
v_mov_b32 v200, 0
v_mov_b32 v201, 0
v_mov_b32 v202, 0
v_mov_b32 v203, 0
v_mov_b32 v204, 0
v_mov_b32 v205, 0
v_mov_b32 v206, 0
v_mov_b32 v207, 0
v_bfe_u32 v51, v50, 1, 2
v_lshlrev_b32 v51, 4, v51
v_bfe_u32 v52, v50, 3, 2
v_lshl_add_u32 v51, v52, 2, v51
v_and_b32 v53, 1, v50
v_lshlrev_b32 v51, 2, v51
v_mul_u32_u24 v53, 384, v53
v_lshrrev_b32 v54, 5, v50
v_mul_u32_u24 v52, 640, v54
v_add3_u32 v51, v51, v52, v53
s_mul_i32 s38, s32, 1280
v_add_u32 v18, s38, v51
v_and_b32 v51, 31, v50
v_lshlrev_b32 v51, 4, v51
v_lshl_add_u32 v51, v54, 3, v51
s_lshl_b32 s38, s32, 9
v_add_u32 v19, s38, v51
v_lshrrev_b32 v51, 4, v50
v_and_b32 v52, 7, v50
v_lshlrev_b32 v52, 4, v52
v_lshl_add_u32 v20, v51, 7, v52
v_lshlrev_b32 v51, 4, v50
s_mul_i32 s38, s32, 6144
v_add_u32 v21, s38, v51
s_add_u32 s57, s38, 32768
v_add_u32 v22, 40960, v51
s_lshl_b32 s38, s55, 12
s_add_u32 s38, s38, 32768
v_add_u32 v23, s38, v51
s_lshl_b32 s38, s32, 11
s_add_u32 s38, s38, 49152
v_add_u32 v24, s38, v51
v_xor_b32 v25, 2048, v24
s_lshl_b32 s59, s33, 12
s_add_u32 s59, s59, 3276800
s_lshl_b32 s38, s32, 8
v_lshl_add_u32 v192, v50, 2, s38
s_lshr_b32 s38, s34, 1
s_lshl_b32 s38, s38, 8
s_and_b32 s39, s34, 1
s_lshl_b32 s39, s39, 2
s_add_u32 s38, s38, s39
s_add_u32 s38, s38, 2048
v_min_u32 v52, 1, v48
v_lshl_add_u32 v193, v52, 30, s38
v_mov_b32 v197, 0
buffer_store_dword v197, v193, s[4:7], s59 offen sc1
s_lshr_b32 s38, s34, 2
s_lshl_b32 s38, s38, 14
s_and_b32 s39, s34, 3
s_lshl_b32 s39, s39, 11
s_add_u32 s38, s38, s39
s_lshl_b32 s39, s33, 16
s_add_u32 s38, s38, s39
v_lshl_add_u32 v198, v48, 3, s38
s_lshl_b32 s38, s54, 2
s_add_u32 s38, s38, s32
s_lshl_b32 s38, s38, 11
s_lshl_b32 s39, s55, 10
s_add_u32 s38, s38, s39
v_add_u32 v26, s38, v51
v_xor_b32 v27, 2048, v26
s_lshl_b32 s38, s54, 5
s_add_u32 s38, s38, s32
s_lshl_b32 s38, s38, 2
s_add_u32 s38, s38, 3432448
v_min_u32 v52, 1, v50
v_lshl_add_u32 v199, v52, 30, s38
buffer_store_dword v197, v199, s[4:7], 0 offen sc1
v_min_u32 v53, 15, v50
v_lshlrev_b32 v53, 7, v53
s_lshr_b32 s38, s54, 2
s_lshl_b32 s38, s38, 10
s_add_u32 s38, s38, 3407872
v_add_u32 v208, s38, v53
s_lshl_b32 s38, s33, 10
s_add_u32 s38, s38, 3435520
v_add_u32 v53, s38, v53
v_cmp_lt_u32 vcc, 7, v50
s_nop 1
v_cndmask_b32 v208, v208, v53, vcc
v_cndmask_b32 v210, 0, 8, vcc
v_mov_b32 v28, -1
v_mov_b32 v32, 0x3f803f80
v_mov_b32 v29, -1
v_mov_b32 v33, 0x3f803f80
v_mov_b32 v30, -1
v_mov_b32 v34, 0x3f803f80
v_mov_b32 v31, -1
v_mov_b32 v35, 0x3f803f80
v_and_b32 v51, 15, v50
s_lshl_b32 s38, s55, 4
v_add_u32 v51, s38, v51
v_lshrrev_b32 v52, 4, v50
v_lshlrev_b32 v52, 2, v52
v_mov_b32 v54, 0xf149f2ca
v_add_u32 v53, 0, v52
v_cmp_gt_u32 vcc, v53, v51
s_nop 1
v_cndmask_b32 v36, 0, v54, vcc
v_add_u32 v53, 1, v52
v_cmp_gt_u32 vcc, v53, v51
s_nop 1
v_cndmask_b32 v37, 0, v54, vcc
v_add_u32 v53, 2, v52
v_cmp_gt_u32 vcc, v53, v51
s_nop 1
v_cndmask_b32 v38, 0, v54, vcc
v_add_u32 v53, 3, v52
v_cmp_gt_u32 vcc, v53, v51
s_nop 1
v_cndmask_b32 v39, 0, v54, vcc
v_add_u32 v53, 16, v52
v_cmp_gt_u32 vcc, v53, v51
s_nop 1
v_cndmask_b32 v40, 0, v54, vcc
v_add_u32 v53, 17, v52
v_cmp_gt_u32 vcc, v53, v51
s_nop 1
v_cndmask_b32 v41, 0, v54, vcc
v_add_u32 v53, 18, v52
v_cmp_gt_u32 vcc, v53, v51
s_nop 1
v_cndmask_b32 v42, 0, v54, vcc
v_add_u32 v53, 19, v52
v_cmp_gt_u32 vcc, v53, v51
s_nop 1
v_cndmask_b32 v43, 0, v54, vcc
v_mov_b32 v0, 0
v_mov_b32 v1, 0
v_mov_b32 v2, 0
v_mov_b32 v3, 0
v_mov_b32 v4, 0
v_mov_b32 v5, 0
v_mov_b32 v6, 0
v_mov_b32 v7, 0
v_mov_b32 v8, 0
v_mov_b32 v9, 0
s_mov_b32 s48, 0x3e0293ee
s_mov_b32 s49, 0xbe0293ee
s_add_u32 s38, s45, 0
buffer_store_dwordx4 v[28:31], v14, s[4:7], s38 offen sc1
s_add_u32 s38, s45, 65536
buffer_store_dwordx4 v[28:31], v14, s[4:7], s38 offen sc1
s_add_u32 s38, s45, 131072
buffer_store_dwordx4 v[28:31], v14, s[4:7], s38 offen sc1
s_add_u32 s38, s45, 196608
buffer_store_dwordx4 v[28:31], v14, s[4:7], s38 offen sc1
s_lshl_b32 s52, s35, 16
s_or_b32 s52, s52, 1
s_waitcnt vmcnt(0)
s_barrier
s_cmp_lg_u32 s32, 0
s_cbranch_scc1 Lar_11
s_mov_b64 exec, 1
v_mov_b32 v48, 32
v_mov_b32 v49, s52
buffer_atomic_add v49, v48, s[12:15], 0 offen sc1
s_mov_b64 exec, -1
Lar_11:
v_lshrrev_b32 v55, 3, v50
v_and_b32 v56, 7, v50
v_lshlrev_b32 v56, 4, v56
v_lshl_add_u32 v51, v55, 13, v56
v_lshl_add_u32 v52, v55, 11, v56
s_mul_i32 s38, s32, 40960
v_and_b32 v56, 3, v50
v_lshl_add_u32 v56, v56, 3, s38
v_lshrrev_b32 v55, 2, v50
v_lshl_add_u32 v53, v55, 7, v56
v_and_b32 v54, 16, v50
v_bfe_u32 v55, v50, 5, 1
v_lshl_add_u32 v54, v55, 3, v54
v_bfe_u32 v55, v50, 3, 1
v_lshl_add_u32 v54, v55, 2, v54
v_bfe_u32 v55, v50, 2, 1
v_add_u32 v54, v54, v55
v_lshl_add_u32 v54, v54, 7, v56
s_mov_b32 s8, s18
s_and_b32 s9, s19, 0xffff
s_mov_b32 s10, 0x800000
s_mov_b32 s11, 0x20000
s_lshl_b32 s39, s32, 21
s_lshl_b32 s38, s54, 8
s_add_u32 s39, s39, s38
s_add_u32 s39, s39, 1572992
s_mul_i32 s38, s32, 40960
s_add_u32 m0, s38, 0
s_nop 0
buffer_load_dwordx4 v51, s[8:11], s39 offen lds
s_add_u32 m0, m0, 1024
s_add_u32 s39, s39, 65536
buffer_load_dwordx4 v51, s[8:11], s39 offen lds
s_add_u32 m0, m0, 1024
s_add_u32 s39, s39, 65536
buffer_load_dwordx4 v51, s[8:11], s39 offen lds
s_add_u32 m0, m0, 1024
s_add_u32 s39, s39, 65536
buffer_load_dwordx4 v51, s[8:11], s39 offen lds
s_add_u32 m0, m0, 1024
s_add_u32 s39, s39, 65536
buffer_load_dwordx4 v51, s[8:11], s39 offen lds
s_add_u32 m0, m0, 1024
s_add_u32 s39, s39, 65536
buffer_load_dwordx4 v51, s[8:11], s39 offen lds
s_add_u32 m0, m0, 1024
s_add_u32 s39, s39, 65536
buffer_load_dwordx4 v51, s[8:11], s39 offen lds
s_add_u32 m0, m0, 1024
s_add_u32 s39, s39, 65536
buffer_load_dwordx4 v51, s[8:11], s39 offen lds
s_lshl_b32 s39, s32, 21
s_lshl_b32 s38, s54, 8
s_add_u32 s39, s39, s38
s_add_u32 s39, s39, 1572864
s_mul_i32 s38, s32, 40960
s_add_u32 m0, s38, 8192
s_nop 0
buffer_load_dwordx4 v51, s[8:11], s39 offen lds
s_add_u32 m0, m0, 1024
s_add_u32 s39, s39, 65536
buffer_load_dwordx4 v51, s[8:11], s39 offen lds
s_add_u32 m0, m0, 1024
s_add_u32 s39, s39, 65536
buffer_load_dwordx4 v51, s[8:11], s39 offen lds
s_add_u32 m0, m0, 1024
s_add_u32 s39, s39, 65536
buffer_load_dwordx4 v51, s[8:11], s39 offen lds
s_add_u32 m0, m0, 1024
s_add_u32 s39, s39, 65536
buffer_load_dwordx4 v51, s[8:11], s39 offen lds
s_add_u32 m0, m0, 1024
s_add_u32 s39, s39, 65536
buffer_load_dwordx4 v51, s[8:11], s39 offen lds
s_add_u32 m0, m0, 1024
s_add_u32 s39, s39, 65536
buffer_load_dwordx4 v51, s[8:11], s39 offen lds
s_add_u32 m0, m0, 1024
s_add_u32 s39, s39, 65536
buffer_load_dwordx4 v51, s[8:11], s39 offen lds
s_lshl_b32 s39, s32, 21
s_lshl_b32 s38, s54, 8
s_add_u32 s39, s39, s38
s_add_u32 s39, s39, 1048704
s_mul_i32 s38, s32, 40960
s_add_u32 m0, s38, 16384
s_nop 0
buffer_load_dwordx4 v51, s[8:11], s39 offen lds
s_add_u32 m0, m0, 1024
s_add_u32 s39, s39, 65536
buffer_load_dwordx4 v51, s[8:11], s39 offen lds
s_add_u32 m0, m0, 1024
s_add_u32 s39, s39, 65536
buffer_load_dwordx4 v51, s[8:11], s39 offen lds
s_add_u32 m0, m0, 1024
s_add_u32 s39, s39, 65536
buffer_load_dwordx4 v51, s[8:11], s39 offen lds
s_add_u32 m0, m0, 1024
s_add_u32 s39, s39, 65536
buffer_load_dwordx4 v51, s[8:11], s39 offen lds
s_add_u32 m0, m0, 1024
s_add_u32 s39, s39, 65536
buffer_load_dwordx4 v51, s[8:11], s39 offen lds
s_add_u32 m0, m0, 1024
s_add_u32 s39, s39, 65536
buffer_load_dwordx4 v51, s[8:11], s39 offen lds
s_add_u32 m0, m0, 1024
s_add_u32 s39, s39, 65536
buffer_load_dwordx4 v51, s[8:11], s39 offen lds
s_lshl_b32 s39, s32, 21
s_lshl_b32 s38, s54, 8
s_add_u32 s39, s39, s38
s_add_u32 s39, s39, 1048576
s_mul_i32 s38, s32, 40960
s_add_u32 m0, s38, 24576
s_nop 0
buffer_load_dwordx4 v51, s[8:11], s39 offen lds
s_add_u32 m0, m0, 1024
s_add_u32 s39, s39, 65536
buffer_load_dwordx4 v51, s[8:11], s39 offen lds
s_add_u32 m0, m0, 1024
s_add_u32 s39, s39, 65536
buffer_load_dwordx4 v51, s[8:11], s39 offen lds
s_add_u32 m0, m0, 1024
s_add_u32 s39, s39, 65536
buffer_load_dwordx4 v51, s[8:11], s39 offen lds
s_add_u32 m0, m0, 1024
s_add_u32 s39, s39, 65536
buffer_load_dwordx4 v51, s[8:11], s39 offen lds
s_add_u32 m0, m0, 1024
s_add_u32 s39, s39, 65536
buffer_load_dwordx4 v51, s[8:11], s39 offen lds
s_add_u32 m0, m0, 1024
s_add_u32 s39, s39, 65536
buffer_load_dwordx4 v51, s[8:11], s39 offen lds
s_add_u32 m0, m0, 1024
s_add_u32 s39, s39, 65536
buffer_load_dwordx4 v51, s[8:11], s39 offen lds
s_lshl_b32 s39, s32, 21
s_lshl_b32 s38, s54, 8
s_add_u32 s39, s39, s38
s_add_u32 s39, s39, 524416
s_mul_i32 s38, s32, 40960
s_add_u32 m0, s38, 32768
s_nop 0
buffer_load_dwordx4 v51, s[8:11], s39 offen lds
s_add_u32 m0, m0, 1024
s_add_u32 s39, s39, 65536
buffer_load_dwordx4 v51, s[8:11], s39 offen lds
s_add_u32 m0, m0, 1024
s_add_u32 s39, s39, 65536
buffer_load_dwordx4 v51, s[8:11], s39 offen lds
s_add_u32 m0, m0, 1024
s_add_u32 s39, s39, 65536
buffer_load_dwordx4 v51, s[8:11], s39 offen lds
s_add_u32 m0, m0, 1024
s_add_u32 s39, s39, 65536
buffer_load_dwordx4 v51, s[8:11], s39 offen lds
s_add_u32 m0, m0, 1024
s_add_u32 s39, s39, 65536
buffer_load_dwordx4 v51, s[8:11], s39 offen lds
s_add_u32 m0, m0, 1024
s_add_u32 s39, s39, 65536
buffer_load_dwordx4 v51, s[8:11], s39 offen lds
s_add_u32 m0, m0, 1024
s_add_u32 s39, s39, 65536
buffer_load_dwordx4 v51, s[8:11], s39 offen lds
s_waitcnt vmcnt(32)
ds_read_b64_tr_b16 a[224:225], v53 offset:0
ds_read_b64_tr_b16 a[226:227], v53 offset:2048
ds_read_b64_tr_b16 a[228:229], v53 offset:4096
ds_read_b64_tr_b16 a[230:231], v53 offset:6144
ds_read_b64_tr_b16 a[232:233], v53 offset:32
ds_read_b64_tr_b16 a[234:235], v53 offset:2080
ds_read_b64_tr_b16 a[236:237], v53 offset:4128
ds_read_b64_tr_b16 a[238:239], v53 offset:6176
ds_read_b64_tr_b16 a[240:241], v53 offset:64
ds_read_b64_tr_b16 a[242:243], v53 offset:2112
ds_read_b64_tr_b16 a[244:245], v53 offset:4160
ds_read_b64_tr_b16 a[246:247], v53 offset:6208
ds_read_b64_tr_b16 a[248:249], v53 offset:96
ds_read_b64_tr_b16 a[250:251], v53 offset:2144
ds_read_b64_tr_b16 a[252:253], v53 offset:4192
ds_read_b64_tr_b16 a[254:255], v53 offset:6240
s_waitcnt lgkmcnt(0)
s_lshl_b32 s39, s32, 21
s_lshl_b32 s38, s54, 8
s_add_u32 s39, s39, s38
s_add_u32 s39, s39, 524288
s_mul_i32 s38, s32, 40960
s_add_u32 m0, s38, 0
s_nop 0
buffer_load_dwordx4 v51, s[8:11], s39 offen lds
s_add_u32 m0, m0, 1024
s_add_u32 s39, s39, 65536
buffer_load_dwordx4 v51, s[8:11], s39 offen lds
s_add_u32 m0, m0, 1024
s_add_u32 s39, s39, 65536
buffer_load_dwordx4 v51, s[8:11], s39 offen lds
s_add_u32 m0, m0, 1024
s_add_u32 s39, s39, 65536
buffer_load_dwordx4 v51, s[8:11], s39 offen lds
s_add_u32 m0, m0, 1024
s_add_u32 s39, s39, 65536
buffer_load_dwordx4 v51, s[8:11], s39 offen lds
s_add_u32 m0, m0, 1024
s_add_u32 s39, s39, 65536
buffer_load_dwordx4 v51, s[8:11], s39 offen lds
s_add_u32 m0, m0, 1024
s_add_u32 s39, s39, 65536
buffer_load_dwordx4 v51, s[8:11], s39 offen lds
s_add_u32 m0, m0, 1024
s_add_u32 s39, s39, 65536
buffer_load_dwordx4 v51, s[8:11], s39 offen lds
s_waitcnt vmcnt(32)
ds_read_b64_tr_b16 a[192:193], v53 offset:8192
ds_read_b64_tr_b16 a[194:195], v53 offset:10240
ds_read_b64_tr_b16 a[196:197], v53 offset:12288
ds_read_b64_tr_b16 a[198:199], v53 offset:14336
ds_read_b64_tr_b16 a[200:201], v53 offset:8224
ds_read_b64_tr_b16 a[202:203], v53 offset:10272
ds_read_b64_tr_b16 a[204:205], v53 offset:12320
ds_read_b64_tr_b16 a[206:207], v53 offset:14368
ds_read_b64_tr_b16 a[208:209], v53 offset:8256
ds_read_b64_tr_b16 a[210:211], v53 offset:10304
ds_read_b64_tr_b16 a[212:213], v53 offset:12352
ds_read_b64_tr_b16 a[214:215], v53 offset:14400
ds_read_b64_tr_b16 a[216:217], v53 offset:8288
ds_read_b64_tr_b16 a[218:219], v53 offset:10336
ds_read_b64_tr_b16 a[220:221], v53 offset:12384
ds_read_b64_tr_b16 a[222:223], v53 offset:14432
s_waitcnt lgkmcnt(0)
s_lshl_b32 s39, s32, 21
s_lshl_b32 s38, s54, 8
s_add_u32 s39, s39, s38
s_add_u32 s39, s39, 128
s_mul_i32 s38, s32, 40960
s_add_u32 m0, s38, 8192
s_nop 0
buffer_load_dwordx4 v51, s[8:11], s39 offen lds
s_add_u32 m0, m0, 1024
s_add_u32 s39, s39, 65536
buffer_load_dwordx4 v51, s[8:11], s39 offen lds
s_add_u32 m0, m0, 1024
s_add_u32 s39, s39, 65536
buffer_load_dwordx4 v51, s[8:11], s39 offen lds
s_add_u32 m0, m0, 1024
s_add_u32 s39, s39, 65536
buffer_load_dwordx4 v51, s[8:11], s39 offen lds
s_add_u32 m0, m0, 1024
s_add_u32 s39, s39, 65536
buffer_load_dwordx4 v51, s[8:11], s39 offen lds
s_add_u32 m0, m0, 1024
s_add_u32 s39, s39, 65536
buffer_load_dwordx4 v51, s[8:11], s39 offen lds
s_add_u32 m0, m0, 1024
s_add_u32 s39, s39, 65536
buffer_load_dwordx4 v51, s[8:11], s39 offen lds
s_add_u32 m0, m0, 1024
s_add_u32 s39, s39, 65536
buffer_load_dwordx4 v51, s[8:11], s39 offen lds
s_waitcnt vmcnt(32)
ds_read_b64_tr_b16 a[160:161], v53 offset:16384
ds_read_b64_tr_b16 a[162:163], v53 offset:18432
ds_read_b64_tr_b16 a[164:165], v53 offset:20480
ds_read_b64_tr_b16 a[166:167], v53 offset:22528
ds_read_b64_tr_b16 a[168:169], v53 offset:16416
ds_read_b64_tr_b16 a[170:171], v53 offset:18464
ds_read_b64_tr_b16 a[172:173], v53 offset:20512
ds_read_b64_tr_b16 a[174:175], v53 offset:22560
ds_read_b64_tr_b16 a[176:177], v53 offset:16448
ds_read_b64_tr_b16 a[178:179], v53 offset:18496
ds_read_b64_tr_b16 a[180:181], v53 offset:20544
ds_read_b64_tr_b16 a[182:183], v53 offset:22592
ds_read_b64_tr_b16 a[184:185], v53 offset:16480
ds_read_b64_tr_b16 a[186:187], v53 offset:18528
ds_read_b64_tr_b16 a[188:189], v53 offset:20576
ds_read_b64_tr_b16 a[190:191], v53 offset:22624
s_waitcnt lgkmcnt(0)
s_lshl_b32 s39, s32, 21
s_lshl_b32 s38, s54, 8
s_add_u32 s39, s39, s38
s_add_u32 s39, s39, 0
s_mul_i32 s38, s32, 40960
s_add_u32 m0, s38, 16384
s_nop 0
buffer_load_dwordx4 v51, s[8:11], s39 offen lds
s_add_u32 m0, m0, 1024
s_add_u32 s39, s39, 65536
buffer_load_dwordx4 v51, s[8:11], s39 offen lds
s_add_u32 m0, m0, 1024
s_add_u32 s39, s39, 65536
buffer_load_dwordx4 v51, s[8:11], s39 offen lds
s_add_u32 m0, m0, 1024
s_add_u32 s39, s39, 65536
buffer_load_dwordx4 v51, s[8:11], s39 offen lds
s_add_u32 m0, m0, 1024
s_add_u32 s39, s39, 65536
buffer_load_dwordx4 v51, s[8:11], s39 offen lds
s_add_u32 m0, m0, 1024
s_add_u32 s39, s39, 65536
buffer_load_dwordx4 v51, s[8:11], s39 offen lds
s_add_u32 m0, m0, 1024
s_add_u32 s39, s39, 65536
buffer_load_dwordx4 v51, s[8:11], s39 offen lds
s_add_u32 m0, m0, 1024
s_add_u32 s39, s39, 65536
buffer_load_dwordx4 v51, s[8:11], s39 offen lds
s_waitcnt vmcnt(32)
ds_read_b64_tr_b16 a[128:129], v53 offset:24576
ds_read_b64_tr_b16 a[130:131], v53 offset:26624
ds_read_b64_tr_b16 a[132:133], v53 offset:28672
ds_read_b64_tr_b16 a[134:135], v53 offset:30720
ds_read_b64_tr_b16 a[136:137], v53 offset:24608
ds_read_b64_tr_b16 a[138:139], v53 offset:26656
ds_read_b64_tr_b16 a[140:141], v53 offset:28704
ds_read_b64_tr_b16 a[142:143], v53 offset:30752
ds_read_b64_tr_b16 a[144:145], v53 offset:24640
ds_read_b64_tr_b16 a[146:147], v53 offset:26688
ds_read_b64_tr_b16 a[148:149], v53 offset:28736
ds_read_b64_tr_b16 a[150:151], v53 offset:30784
ds_read_b64_tr_b16 a[152:153], v53 offset:24672
ds_read_b64_tr_b16 a[154:155], v53 offset:26720
ds_read_b64_tr_b16 a[156:157], v53 offset:28768
ds_read_b64_tr_b16 a[158:159], v53 offset:30816
s_waitcnt lgkmcnt(0)
s_waitcnt vmcnt(24)
ds_read_b64_tr_b16 a[96:97], v53 offset:32768
ds_read_b64_tr_b16 a[98:99], v53 offset:34816
ds_read_b64_tr_b16 a[100:101], v53 offset:36864
ds_read_b64_tr_b16 a[102:103], v53 offset:38912
ds_read_b64_tr_b16 a[104:105], v53 offset:32800
ds_read_b64_tr_b16 a[106:107], v53 offset:34848
ds_read_b64_tr_b16 a[108:109], v53 offset:36896
ds_read_b64_tr_b16 a[110:111], v53 offset:38944
ds_read_b64_tr_b16 a[112:113], v53 offset:32832
ds_read_b64_tr_b16 a[114:115], v53 offset:34880
ds_read_b64_tr_b16 a[116:117], v53 offset:36928
ds_read_b64_tr_b16 a[118:119], v53 offset:38976
ds_read_b64_tr_b16 a[120:121], v53 offset:32864
ds_read_b64_tr_b16 a[122:123], v53 offset:34912
ds_read_b64_tr_b16 a[124:125], v53 offset:36960
ds_read_b64_tr_b16 a[126:127], v53 offset:39008
s_waitcnt lgkmcnt(0)
s_waitcnt vmcnt(16)
ds_read_b64_tr_b16 a[64:65], v53 offset:0
ds_read_b64_tr_b16 a[66:67], v53 offset:2048
ds_read_b64_tr_b16 a[68:69], v53 offset:4096
ds_read_b64_tr_b16 a[70:71], v53 offset:6144
ds_read_b64_tr_b16 a[72:73], v53 offset:32
ds_read_b64_tr_b16 a[74:75], v53 offset:2080
ds_read_b64_tr_b16 a[76:77], v53 offset:4128
ds_read_b64_tr_b16 a[78:79], v53 offset:6176
ds_read_b64_tr_b16 a[80:81], v53 offset:64
ds_read_b64_tr_b16 a[82:83], v53 offset:2112
ds_read_b64_tr_b16 a[84:85], v53 offset:4160
ds_read_b64_tr_b16 a[86:87], v53 offset:6208
ds_read_b64_tr_b16 a[88:89], v53 offset:96
ds_read_b64_tr_b16 a[90:91], v53 offset:2144
ds_read_b64_tr_b16 a[92:93], v53 offset:4192
ds_read_b64_tr_b16 a[94:95], v53 offset:6240
s_waitcnt lgkmcnt(0)
s_waitcnt vmcnt(8)
ds_read_b64_tr_b16 a[32:33], v53 offset:8192
ds_read_b64_tr_b16 a[34:35], v53 offset:10240
ds_read_b64_tr_b16 a[36:37], v53 offset:12288
ds_read_b64_tr_b16 a[38:39], v53 offset:14336
ds_read_b64_tr_b16 a[40:41], v53 offset:8224
ds_read_b64_tr_b16 a[42:43], v53 offset:10272
ds_read_b64_tr_b16 a[44:45], v53 offset:12320
ds_read_b64_tr_b16 a[46:47], v53 offset:14368
ds_read_b64_tr_b16 a[48:49], v53 offset:8256
ds_read_b64_tr_b16 a[50:51], v53 offset:10304
ds_read_b64_tr_b16 a[52:53], v53 offset:12352
ds_read_b64_tr_b16 a[54:55], v53 offset:14400
ds_read_b64_tr_b16 a[56:57], v53 offset:8288
ds_read_b64_tr_b16 a[58:59], v53 offset:10336
ds_read_b64_tr_b16 a[60:61], v53 offset:12384
ds_read_b64_tr_b16 a[62:63], v53 offset:14432
s_waitcnt lgkmcnt(0)
s_waitcnt vmcnt(0)
ds_read_b64_tr_b16 a[0:1], v53 offset:16384
ds_read_b64_tr_b16 a[2:3], v53 offset:18432
ds_read_b64_tr_b16 a[4:5], v53 offset:20480
ds_read_b64_tr_b16 a[6:7], v53 offset:22528
ds_read_b64_tr_b16 a[8:9], v53 offset:16416
ds_read_b64_tr_b16 a[10:11], v53 offset:18464
ds_read_b64_tr_b16 a[12:13], v53 offset:20512
ds_read_b64_tr_b16 a[14:15], v53 offset:22560
ds_read_b64_tr_b16 a[16:17], v53 offset:16448
ds_read_b64_tr_b16 a[18:19], v53 offset:18496
ds_read_b64_tr_b16 a[20:21], v53 offset:20544
ds_read_b64_tr_b16 a[22:23], v53 offset:22592
ds_read_b64_tr_b16 a[24:25], v53 offset:16480
ds_read_b64_tr_b16 a[26:27], v53 offset:18528
ds_read_b64_tr_b16 a[28:29], v53 offset:20576
ds_read_b64_tr_b16 a[30:31], v53 offset:22624
s_waitcnt lgkmcnt(0)
s_cmp_lg_u32 s54, 0
s_cbranch_scc1 Lnp_12
s_barrier
s_mov_b32 s52, 0x2000000
s_cmp_lg_u32 s32, 0
s_cbranch_scc1 Lpb_13
v_lshlrev_b32 v52, 8, v50
v_mov_b32 v53, -1
s_mov_b32 s53, 32768
buffer_store_dword v53, v52, s[4:7], s53 offen sc1
s_waitcnt vmcnt(0)
s_mov_b64 exec, 1
s_mov_b32 s60, -1
s_mov_b32 s61, -1
v_mov_b32 v52, 0
s_mov_b32 s66, 5
Lpl_14:
s_memtime s[62:63]
s_waitcnt lgkmcnt(0)
buffer_load_dword v53, v52, s[4:7], s53 offen sc1
s_waitcnt vmcnt(0)
s_memtime s[64:65]
s_waitcnt lgkmcnt(0)
s_sub_u32 s62, s64, s62
s_min_u32 s60, s60, s62
v_add_u32 v52, 8192, v52
s_memtime s[62:63]
s_waitcnt lgkmcnt(0)
buffer_load_dword v53, v52, s[4:7], s53 offen sc1
s_waitcnt vmcnt(0)
s_memtime s[64:65]
s_waitcnt lgkmcnt(0)
s_sub_u32 s62, s64, s62
s_min_u32 s61, s61, s62
v_add_u32 v52, -6912, v52
s_sub_u32 s66, s66, 1
s_cmp_lg_u32 s66, 0
s_cbranch_scc1 Lpl_14
s_mov_b64 exec, -1
s_cmp_lt_u32 s61, s60
s_cselect_b32 s62, 1, 0
s_lshr_b32 s63, s51, 2
s_xor_b32 s62, s62, s63
s_lshl_b32 s62, s62, 24
s_or_b32 s52, s52, s62
Lpb_13:
s_waitcnt vmcnt(0)
s_barrier
s_cmp_lg_u32 s32, 0
s_cbranch_scc1 Lar_15
s_mov_b64 exec, 1
v_mov_b32 v48, 32
v_mov_b32 v49, s52
buffer_atomic_add v49, v48, s[12:15], 0 offen sc1
s_mov_b64 exec, -1
Lar_15:
Lnp_12:
Lst_16:
buffer_load_dword v48, off, s[12:15], 0 offset:32 sc1
buffer_load_dword v49, off, s[12:15], 0 offset:160 sc1
s_waitcnt vmcnt(0)
v_add_u32 v48, v48, v49
s_nop 0
v_readfirstlane_b32 s38, v48
s_nop 3
s_and_b32 s39, s38, 0xffff
s_cmp_eq_u32 s39, 0x100
s_cbranch_scc1 Lso_17
s_sub_u32 s37, s37, 1
s_cbranch_scc1 Lend_1
s_sleep 8
s_branch Lst_16
Lso_17:
s_bfe_u32 s35, s38, 0x80010
s_bfe_u32 s46, s38, 0x10018
s_lshl_b32 s46, s46, 13
s_barrier
s_lshl_b32 s38, s34, 15
s_add_u32 s38, s38, s45
s_add_u32 s39, s38, 16384
buffer_load_dwordx4 v[64:67], v10, s[4:7], s38 offen offset:0 sc1
buffer_load_dwordx4 v[68:71], v10, s[4:7], s38 offen offset:1024 sc1
buffer_load_dwordx4 v[72:75], v10, s[4:7], s38 offen offset:2048 sc1
buffer_load_dwordx4 v[76:79], v10, s[4:7], s38 offen offset:3072 sc1
buffer_load_dwordx4 v[80:83], v10, s[4:7], s39 offen offset:0 sc1
buffer_load_dwordx4 v[84:87], v10, s[4:7], s39 offen offset:1024 sc1
buffer_load_dwordx4 v[88:91], v10, s[4:7], s39 offen offset:2048 sc1
buffer_load_dwordx4 v[92:95], v10, s[4:7], s39 offen offset:3072 sc1
Lst_18:
buffer_load_dword v48, off, s[12:15], 0 offset:32 sc1
buffer_load_dword v49, off, s[12:15], 0 offset:160 sc1
s_waitcnt vmcnt(0)
v_add_u32 v48, v48, v49
s_nop 0
v_readfirstlane_b32 s38, v48
s_nop 3
s_and_b32 s39, s38, 0x200ffff
s_cmp_eq_u32 s39, 0x2000100
s_cbranch_scc1 Lso_19
s_sub_u32 s37, s37, 1
s_cbranch_scc1 Lend_1
s_sleep 8
s_branch Lst_18
Lso_19:
s_bfe_u32 s35, s38, 0x80010
s_bfe_u32 s46, s38, 0x10018
s_lshl_b32 s46, s46, 13
s_barrier
s_mul_i32 s47, s54, 24576
s_add_u32 s47, s47, 33554432
s_mov_b32 s36, 0
s_mov_b32 s27, 1
Lbw_20:
buffer_load_dword v209, v208, s[4:7], 0 offen sc1
s_waitcnt vmcnt(0)
v_add_u32 v44, v209, v210
v_cmp_gt_u32 vcc, s27, v44
s_cbranch_vccz Lbo_21
s_sub_u32 s37, s37, 1
s_cbranch_scc1 Lend_1
s_sleep 2
s_branch Lbw_20
Lbo_21:
s_mov_b32 m0, s57
s_add_u32 s38, s47, 3072
buffer_load_dwordx4 v21, s[4:7], s47 offen offset:0 sc1 lds
buffer_load_dwordx4 v21, s[4:7], s47 offen offset:1024 sc1 lds
buffer_load_dwordx4 v21, s[4:7], s47 offen offset:2048 sc1 lds
s_add_u32 m0, s57, 3072
s_xor_b32 s57, s57, 98304
buffer_load_dwordx4 v21, s[4:7], s38 offen offset:0 sc1 lds
buffer_load_dwordx4 v21, s[4:7], s38 offen offset:1024 sc1 lds
buffer_load_dwordx4 v21, s[4:7], s38 offen offset:2048 sc1 lds
s_add_u32 s47, s47, 786432
s_cmp_lg_u32 s35, 0
s_cbranch_scc1 Lq_sc1_22
Lq_23:
s_cmp_gt_u32 s36, 7
s_cbranch_scc1 Lqf_24
s_waitcnt vmcnt(0)
s_barrier
Lqf_24:
ds_read_b128 v[128:131], v22 offset:0
ds_read_b128 v[132:135], v22 offset:1024
ds_read_b128 v[136:139], v22 offset:2048
ds_read_b128 v[140:143], v22 offset:3072
ds_read_b128 v[144:147], v22 offset:4096
ds_read_b128 v[148:151], v22 offset:5120
ds_read_b128 v[152:155], v22 offset:6144
ds_read_b128 v[156:159], v22 offset:7168
ds_read_b128 v[160:163], v24 offset:0
ds_read_b128 v[164:167], v24 offset:1024
ds_read_b128 v[168:171], v25 offset:0
ds_read_b128 v[172:175], v25 offset:1024
ds_read_b128 v[176:179], v23 offset:0
ds_read_b128 v[180:183], v23 offset:1024
ds_read_b128 v[184:187], v23 offset:2048
ds_read_b128 v[188:191], v23 offset:3072
v_xor_b32 v22, 98304, v22
v_xor_b32 v24, 98304, v24
v_xor_b32 v25, 98304, v25
v_xor_b32 v23, 98304, v23
s_mul_i32 m0, s32, 5120
s_and_b32 s38, s36, 3
s_lshl_b32 s39, s38, 16
s_add_u32 s40, s39, s45
s_xor_b32 s42, s40, 0x20000
s_add_u32 s26, s36, 1
v_pk_mul_f32 v[64:65], 0, 0
v_pk_mul_f32 v[66:67], 0, 0
v_pk_mul_f32 v[68:69], 0, 0
v_pk_mul_f32 v[70:71], 0, 0
v_pk_mul_f32 v[72:73], 0, 0
v_pk_mul_f32 v[74:75], 0, 0
v_pk_mul_f32 v[76:77], 0, 0
v_pk_mul_f32 v[78:79], 0, 0
v_pk_mul_f32 v[80:81], 0, 0
v_pk_mul_f32 v[82:83], 0, 0
v_pk_mul_f32 v[84:85], 0, 0
v_pk_mul_f32 v[86:87], 0, 0
v_pk_mul_f32 v[88:89], 0, 0
v_pk_mul_f32 v[90:91], 0, 0
v_pk_mul_f32 v[92:93], 0, 0
v_pk_mul_f32 v[94:95], 0, 0
s_waitcnt vmcnt(0)
buffer_store_dword v197, v199, s[4:7], 0 offen
v_add_u32 v197, 1, v197
s_mov_b64 exec, 15
buffer_load_dword v194, v192, s[4:7], s59 offen sc1
s_nop 11
buffer_load_dword v195, v192, s[4:7], s59 offen sc1
s_nop 11
buffer_load_dword v196, v192, s[4:7], s59 offen sc1
Lft_26:
s_waitcnt vmcnt(2)
v_cmp_gt_u32 vcc, s26, v194
s_cbranch_vccz Lfg_25
buffer_load_dword v194, v192, s[4:7], s59 offen sc1
s_waitcnt vmcnt(2)
v_cmp_gt_u32 vcc, s26, v195
s_cbranch_vccz Lfg_25
buffer_load_dword v195, v192, s[4:7], s59 offen sc1
s_waitcnt vmcnt(2)
v_cmp_gt_u32 vcc, s26, v196
s_cbranch_vccz Lfg_25
buffer_load_dword v196, v192, s[4:7], s59 offen sc1
s_sub_u32 s37, s37, 1
s_cbranch_scc1 Lend_1
s_branch Lft_26
Lfg_25:
s_mov_b64 exec, -1
buffer_load_dwordx4 v[48:51], v10, s[4:7], s40 offen offset:0 sc1
v_mfma_f32_16x16x32_bf16 v[200:203], v[204:207], v[204:207], 0
v_mfma_f32_16x16x32_bf16 v[200:203], v[204:207], v[204:207], 0
v_mfma_f32_16x16x32_bf16 v[200:203], v[204:207], v[204:207], 0
v_mfma_f32_16x16x32_bf16 v[200:203], v[204:207], v[204:207], 0
buffer_load_dwordx4 v[52:55], v10, s[4:7], s40 offen offset:1024 sc1
v_mfma_f32_16x16x32_bf16 v[200:203], v[204:207], v[204:207], 0
v_mfma_f32_16x16x32_bf16 v[200:203], v[204:207], v[204:207], 0
v_mfma_f32_16x16x32_bf16 v[200:203], v[204:207], v[204:207], 0
v_mfma_f32_16x16x32_bf16 v[200:203], v[204:207], v[204:207], 0
buffer_load_dwordx4 v[56:59], v10, s[4:7], s40 offen offset:2048 sc1
v_mfma_f32_16x16x32_bf16 v[200:203], v[204:207], v[204:207], 0
v_mfma_f32_16x16x32_bf16 v[200:203], v[204:207], v[204:207], 0
v_mfma_f32_16x16x32_bf16 v[200:203], v[204:207], v[204:207], 0
v_mfma_f32_16x16x32_bf16 v[200:203], v[204:207], v[204:207], 0
buffer_load_dwordx4 v[60:63], v10, s[4:7], s40 offen offset:3072 sc1
v_mfma_f32_16x16x32_bf16 v[200:203], v[204:207], v[204:207], 0
s_waitcnt vmcnt(3)
v_max3_u32 v44, v48, v49, v50
v_max_u32 v44, v44, v51
v_cmp_eq_u32 vcc, -1, v44
s_cbranch_vccnz Lpf_29
v_smfmac_f32_16x16x64_bf16 v[64:67], v[48:51], a[0:7], v15
v_smfmac_f32_16x16x64_bf16 v[68:71], v[48:51], a[8:15], v15
v_smfmac_f32_16x16x64_bf16 v[72:75], v[48:51], a[16:23], v15
v_smfmac_f32_16x16x64_bf16 v[76:79], v[48:51], a[24:31], v15
v_smfmac_f32_16x16x64_bf16 v[80:83], v[48:51], a[32:39], v15
s_waitcnt vmcnt(2)
v_max3_u32 v44, v52, v53, v54
v_max_u32 v44, v44, v55
v_cmp_eq_u32 vcc, -1, v44
v_smfmac_f32_16x16x64_bf16 v[84:87], v[48:51], a[40:47], v15
v_smfmac_f32_16x16x64_bf16 v[88:91], v[48:51], a[48:55], v15
v_smfmac_f32_16x16x64_bf16 v[92:95], v[48:51], a[56:63], v15
s_cbranch_vccnz Lpf_30
v_smfmac_f32_16x16x64_bf16 v[64:67], v[52:55], a[64:71], v15
v_smfmac_f32_16x16x64_bf16 v[68:71], v[52:55], a[72:79], v15
v_smfmac_f32_16x16x64_bf16 v[72:75], v[52:55], a[80:87], v15
v_smfmac_f32_16x16x64_bf16 v[76:79], v[52:55], a[88:95], v15
v_smfmac_f32_16x16x64_bf16 v[80:83], v[52:55], a[96:103], v15
s_waitcnt vmcnt(1)
v_max3_u32 v44, v56, v57, v58
v_max_u32 v44, v44, v59
v_cmp_eq_u32 vcc, -1, v44
v_smfmac_f32_16x16x64_bf16 v[84:87], v[52:55], a[104:111], v15
v_smfmac_f32_16x16x64_bf16 v[88:91], v[52:55], a[112:119], v15
v_smfmac_f32_16x16x64_bf16 v[92:95], v[52:55], a[120:127], v15
s_cbranch_vccnz Lpf_31
v_smfmac_f32_16x16x64_bf16 v[64:67], v[56:59], a[128:135], v15
v_smfmac_f32_16x16x64_bf16 v[68:71], v[56:59], a[136:143], v15
v_smfmac_f32_16x16x64_bf16 v[72:75], v[56:59], a[144:151], v15
v_smfmac_f32_16x16x64_bf16 v[76:79], v[56:59], a[152:159], v15
v_smfmac_f32_16x16x64_bf16 v[80:83], v[56:59], a[160:167], v15
s_waitcnt vmcnt(0)
v_max3_u32 v44, v60, v61, v62
v_max_u32 v44, v44, v63
v_cmp_eq_u32 vcc, -1, v44
v_smfmac_f32_16x16x64_bf16 v[84:87], v[56:59], a[168:175], v15
v_smfmac_f32_16x16x64_bf16 v[88:91], v[56:59], a[176:183], v15
v_smfmac_f32_16x16x64_bf16 v[92:95], v[56:59], a[184:191], v15
s_cbranch_vccnz Lpf_32
v_smfmac_f32_16x16x64_bf16 v[64:67], v[60:63], a[192:199], v15
v_smfmac_f32_16x16x64_bf16 v[68:71], v[60:63], a[200:207], v15
v_smfmac_f32_16x16x64_bf16 v[72:75], v[60:63], a[208:215], v15
v_smfmac_f32_16x16x64_bf16 v[76:79], v[60:63], a[216:223], v15
v_smfmac_f32_16x16x64_bf16 v[80:83], v[60:63], a[224:231], v15
v_smfmac_f32_16x16x64_bf16 v[84:87], v[60:63], a[232:239], v15
v_smfmac_f32_16x16x64_bf16 v[88:91], v[60:63], a[240:247], v15
v_smfmac_f32_16x16x64_bf16 v[92:95], v[60:63], a[248:255], v15
Lpd_28:
s_nop 0
v_add_f32 v64, v64, v65
v_add_f32 v66, v66, v67
v_add_f32 v68, v68, v69
v_add_f32 v70, v70, v71
v_add_f32 v72, v72, v73
ds_write_addtid_b32 v64 offset:0
v_add_f32 v74, v74, v75
ds_write_addtid_b32 v66 offset:384
v_add_f32 v76, v76, v77
ds_write_addtid_b32 v68 offset:640
v_add_f32 v78, v78, v79
ds_write_addtid_b32 v70 offset:1024
v_add_f32 v80, v80, v81
ds_write_addtid_b32 v72 offset:1280
v_add_f32 v82, v82, v83
ds_write_addtid_b32 v74 offset:1664
v_add_f32 v84, v84, v85
ds_write_addtid_b32 v76 offset:1920
v_add_f32 v86, v86, v87
ds_write_addtid_b32 v78 offset:2304
v_add_f32 v88, v88, v89
ds_write_addtid_b32 v80 offset:2560
v_add_f32 v90, v90, v91
ds_write_addtid_b32 v82 offset:2944
v_add_f32 v92, v92, v93
ds_write_addtid_b32 v84 offset:3200
v_add_f32 v94, v94, v95
ds_write_addtid_b32 v86 offset:3584
ds_write_addtid_b32 v88 offset:3840
ds_write_addtid_b32 v90 offset:4224
ds_write_addtid_b32 v92 offset:4480
ds_write_addtid_b32 v94 offset:4864
Lqj_27:
v_mfma_f32_16x16x32_bf16 v[200:203], v[204:207], v[204:207], 0
v_mfma_f32_16x16x32_bf16 v[200:203], v[204:207], v[204:207], 0
s_waitcnt lgkmcnt(0)
s_barrier
ds_read_b128 v[76:79], v18 offset:0
ds_read_b128 v[80:83], v18 offset:5120
ds_read_b128 v[84:87], v18 offset:10240
ds_read_b128 v[88:91], v18 offset:15360
v_mov_b32 v72, 0
v_mov_b32 v73, 0
v_mov_b32 v74, 0
v_mov_b32 v75, 0
v_mfma_f32_16x16x32_bf16 v[200:203], v[204:207], v[204:207], 0
v_mfma_f32_16x16x32_bf16 v[200:203], v[204:207], v[204:207], 0
s_waitcnt lgkmcnt(0)
v_pk_add_f32 v[76:77], v[76:77], v[80:81]
v_pk_add_f32 v[84:85], v[84:85], v[88:89]
v_pk_add_f32 v[78:79], v[78:79], v[82:83]
v_pk_add_f32 v[86:87], v[86:87], v[90:91]
v_pk_add_f32 v[76:77], v[76:77], v[84:85]
v_pk_add_f32 v[78:79], v[78:79], v[86:87]
v_cvt_pk_bf16_f32 v76, v76, v77
v_cvt_pk_bf16_f32 v77, v78, v79
ds_write_b64 v19, v[76:77] offset:20480
buffer_load_dwordx4 v[112:115], v11, s[4:7], s40 offen offset:0 sc1
buffer_load_dwordx4 v[116:119], v11, s[4:7], s40 offen offset:1024 sc1
v_mfma_f32_16x16x32_bf16 v[200:203], v[204:207], v[204:207], 0
v_mfma_f32_16x16x32_bf16 v[200:203], v[204:207], v[204:207], 0
s_waitcnt lgkmcnt(0)
s_barrier
ds_read_b128 v[96:99], v20 offset:20480
ds_read_b128 v[100:103], v20 offset:20992
ds_read_b128 v[104:107], v20 offset:21504
ds_read_b128 v[108:111], v20 offset:22016
v_mfma_f32_16x16x32_bf16 v[200:203], v[204:207], v[204:207], 0
v_mfma_f32_16x16x32_bf16 v[200:203], v[204:207], v[204:207], 0
s_waitcnt lgkmcnt(3)
v_mfma_f32_16x16x32_bf16 v[64:67], v[128:131], v[96:99], 0
v_mfma_f32_16x16x32_bf16 v[68:71], v[144:147], v[96:99], 0
s_waitcnt lgkmcnt(2)
buffer_load_dwordx4 v[48:51], v11, s[4:7], s40 offen offset:0 sc1
v_mfma_f32_16x16x32_bf16 v[64:67], v[132:135], v[100:103], v[64:67]
v_mfma_f32_16x16x32_bf16 v[68:71], v[148:151], v[100:103], v[68:71]
s_waitcnt lgkmcnt(1)
buffer_load_dwordx4 v[52:55], v11, s[4:7], s40 offen offset:1024 sc1
v_mfma_f32_16x16x32_bf16 v[64:67], v[136:139], v[104:107], v[64:67]
v_mfma_f32_16x16x32_bf16 v[68:71], v[152:155], v[104:107], v[68:71]
s_waitcnt lgkmcnt(0)
s_waitcnt vmcnt(2)
v_max3_u32 v44, v112, v113, v114
v_max3_u32 v44, v44, v115, v116
v_max3_u32 v44, v44, v117, v118
v_max_u32 v44, v44, v119
v_cmp_eq_u32 vcc, -1, v44
v_mfma_f32_16x16x32_bf16 v[64:67], v[140:143], v[108:111], v[64:67]
v_mfma_f32_16x16x32_bf16 v[68:71], v[156:159], v[108:111], v[68:71]
s_cbranch_vccnz Lkr_33
v_smfmac_f32_16x16x64_bf16 v[72:75], v[112:115], v[96:103], v15
v_smfmac_f32_16x16x64_bf16 v[72:75], v[116:119], v[104:111], v15
Lko_34:
s_nop 3
v_max3_f32 v45, v64, v65, v66
v_max3_f32 v45, v45, v67, v68
v_max3_f32 v45, v45, v69, v70
v_max_f32 v45, v45, v71
v_add_f32 v72, v72, v73
v_add_f32 v73, v74, v75
v_max3_f32 v46, v45, v72, v73
v_max3_f32 v47, v45, v72, v73
buffer_load_dwordx2 v[120:121], v12, s[4:7], s40 offen sc1
buffer_load_dwordx2 v[122:123], v13, s[4:7], s40 offen sc1
s_nop 1
v_permlane32_swap_b32 v46, v47
s_nop 0
v_max_f32 v45, v46, v47
v_max_f32 v46, v46, v47
s_nop 1
v_permlane16_swap_b32 v45, v46
s_nop 0
v_max_f32 v45, v45, v46
v_mul_f32 v46, s49, v45
v_pk_fma_f32 v[64:65], v[64:65], s[48:49], v[46:47] op_sel_hi:[1,0,0]
v_pk_fma_f32 v[66:67], v[66:67], s[48:49], v[46:47] op_sel_hi:[1,0,0]
v_pk_fma_f32 v[68:69], v[68:69], s[48:49], v[46:47] op_sel_hi:[1,0,0]
v_pk_fma_f32 v[70:71], v[70:71], s[48:49], v[46:47] op_sel_hi:[1,0,0]
v_pk_fma_f32 v[72:73], v[72:73], s[48:49], v[46:47] op_sel_hi:[1,0,0]
v_exp_f32 v64, v64
v_exp_f32 v65, v65
v_exp_f32 v66, v66
v_exp_f32 v67, v67
v_exp_f32 v68, v68
v_exp_f32 v69, v69
v_exp_f32 v70, v70
v_exp_f32 v71, v71
v_exp_f32 v72, v72
v_exp_f32 v73, v73
buffer_store_dword v197, v193, s[4:7], s59 offen
v_cvt_pk_bf16_f32 v76, v64, v65
v_cvt_pk_bf16_f32 v77, v66, v67
v_cvt_pk_bf16_f32 v78, v68, v69
v_cvt_pk_bf16_f32 v79, v70, v71
v_cvt_pk_bf16_f32 v2, v72, v73
v_cvt_pk_bf16_f32 v7, v72, v73
v_mfma_f32_16x16x32_bf16 v[84:87], v[32:35], v[76:79], 0
v_mfma_f32_16x16x32_bf16 v[96:99], v[160:163], v[76:79], 0
s_waitcnt vmcnt(1)
v_max3_u32 v44, v120, v121, v122
v_max_u32 v44, v44, v123
v_cmp_eq_u32 vcc, -1, v44
v_mfma_f32_16x16x32_bf16 v[100:103], v[164:167], v[76:79], 0
v_mfma_f32_16x16x32_bf16 v[84:87], v[32:35], v[2:5], v[84:87]
s_cbranch_vccnz Lvr_35
Lvo_36:
v_mfma_f32_16x16x32_bf16 v[96:99], v[120:123], v[2:5], v[96:99]
v_mfma_f32_16x16x32_bf16 v[100:103], v[120:123], v[6:9], v[100:103]
v_mfma_f32_16x16x32_bf16 v[200:203], v[204:207], v[204:207], 0
s_nop 4
v_rcp_f32 v46, v84
s_nop 0
v_pk_mul_f32 v[96:97], v[96:97], v[46:47] op_sel_hi:[1,0]
v_pk_mul_f32 v[98:99], v[98:99], v[46:47] op_sel_hi:[1,0]
v_pk_mul_f32 v[100:101], v[100:101], v[46:47] op_sel_hi:[1,0]
v_pk_mul_f32 v[102:103], v[102:103], v[46:47] op_sel_hi:[1,0]
v_cvt_pk_bf16_f32 v124, v96, v97
v_cvt_pk_bf16_f32 v125, v98, v99
v_cvt_pk_bf16_f32 v126, v100, v101
v_cvt_pk_bf16_f32 v127, v102, v103
v_min_u32 v124, -2, v124
v_min_u32 v125, -2, v125
v_min_u32 v126, -2, v126
v_min_u32 v127, -2, v127
buffer_store_dwordx4 v[124:127], v14, s[4:7], s40 offen
s_barrier
buffer_store_dwordx4 v[28:31], v14, s[4:7], s42 offen
s_cmp_ge_u32 s36, 62
s_cbranch_scc1 Lnp_37
Lpa_40:
s_add_u32 s27, s27, 1
v_add_u32 v44, v209, v210
v_cmp_gt_u32 vcc, s27, v44
s_cbranch_vccnz Lpw_38
Lpk_39:
s_mov_b32 m0, s57
s_add_u32 s38, s47, 3072
buffer_load_dwordx4 v21, s[4:7], s47 offen offset:0 sc1 lds
buffer_load_dwordx4 v21, s[4:7], s47 offen offset:1024 sc1 lds
buffer_load_dwordx4 v21, s[4:7], s47 offen offset:2048 sc1 lds
s_add_u32 m0, s57, 3072
s_xor_b32 s57, s57, 98304
buffer_load_dwordx4 v21, s[4:7], s38 offen offset:0 sc1 lds
buffer_load_dwordx4 v21, s[4:7], s38 offen offset:1024 sc1 lds
buffer_load_dwordx4 v21, s[4:7], s38 offen offset:2048 sc1 lds
s_add_u32 s47, s47, 786432
s_cmp_eq_u32 s27, 8
s_cbranch_scc1 Lpa_40
buffer_load_dword v209, v208, s[4:7], 0 offen sc1
s_add_u32 s38, s36, 2
s_and_b32 s38, s38, 3
s_lshl_b32 s88, s38, 18
s_add_u32 s88, s88, s46
s_add_u32 s89, s88, 0x100000
buffer_store_dwordx2 v[28:29], v198, s[4:7], s88 offen sc1
buffer_store_dwordx2 v[28:29], v198, s[4:7], s89 offen sc1
Lnp_37:
v_mov_b32 v72, 0
v_mov_b32 v73, 0
v_mov_b32 v74, 0
v_mov_b32 v75, 0
v_mfma_f32_16x16x32_bf16 v[64:67], v[128:131], v[176:179], v[36:39]
v_mfma_f32_16x16x32_bf16 v[68:71], v[144:147], v[176:179], v[40:43]
v_mfma_f32_16x16x32_bf16 v[64:67], v[132:135], v[180:183], v[64:67]
v_mfma_f32_16x16x32_bf16 v[68:71], v[148:151], v[180:183], v[68:71]
v_mfma_f32_16x16x32_bf16 v[64:67], v[136:139], v[184:187], v[64:67]
v_mfma_f32_16x16x32_bf16 v[68:71], v[152:155], v[184:187], v[68:71]
v_mfma_f32_16x16x32_bf16 v[64:67], v[140:143], v[188:191], v[64:67]
v_mfma_f32_16x16x32_bf16 v[68:71], v[156:159], v[188:191], v[68:71]
v_smfmac_f32_16x16x64_bf16 v[72:75], v[112:115], v[176:183], v15
v_smfmac_f32_16x16x64_bf16 v[72:75], v[116:119], v[184:191], v15
s_and_b32 s38, s36, 7
s_lshl_b32 s38, s38, 18
s_add_u32 s50, s38, 83886080
s_nop 2
v_max3_f32 v45, v64, v65, v66
v_max3_f32 v45, v45, v67, v68
v_max3_f32 v45, v45, v69, v70
v_max_f32 v45, v45, v71
v_add_f32 v72, v72, v73
v_add_f32 v73, v74, v75
v_max3_f32 v46, v45, v72, v73
v_max3_f32 v47, v45, v72, v73
s_nop 1
v_permlane32_swap_b32 v46, v47
s_nop 0
v_max_f32 v45, v46, v47
v_max_f32 v46, v46, v47
s_nop 1
v_permlane16_swap_b32 v45, v46
s_nop 0
v_max_f32 v45, v45, v46
v_mul_f32 v46, s49, v45
v_pk_fma_f32 v[64:65], v[64:65], s[48:49], v[46:47] op_sel_hi:[1,0,0]
v_pk_fma_f32 v[66:67], v[66:67], s[48:49], v[46:47] op_sel_hi:[1,0,0]
v_pk_fma_f32 v[68:69], v[68:69], s[48:49], v[46:47] op_sel_hi:[1,0,0]
v_pk_fma_f32 v[70:71], v[70:71], s[48:49], v[46:47] op_sel_hi:[1,0,0]
v_pk_fma_f32 v[72:73], v[72:73], s[48:49], v[46:47] op_sel_hi:[1,0,0]
v_exp_f32 v64, v64
v_exp_f32 v65, v65
v_exp_f32 v66, v66
v_exp_f32 v67, v67
v_exp_f32 v68, v68
v_exp_f32 v69, v69
v_exp_f32 v70, v70
v_exp_f32 v71, v71
v_exp_f32 v72, v72
v_exp_f32 v73, v73
v_cvt_pk_bf16_f32 v76, v64, v65
v_cvt_pk_bf16_f32 v77, v66, v67
v_cvt_pk_bf16_f32 v78, v68, v69
v_cvt_pk_bf16_f32 v79, v70, v71
v_cvt_pk_bf16_f32 v2, v72, v73
v_cvt_pk_bf16_f32 v7, v72, v73
v_mfma_f32_16x16x32_bf16 v[84:87], v[32:35], v[76:79], 0
v_mfma_f32_16x16x32_bf16 v[96:99], v[160:163], v[76:79], 0
v_mfma_f32_16x16x32_bf16 v[100:103], v[164:167], v[76:79], 0
v_mfma_f32_16x16x32_bf16 v[104:107], v[168:171], v[76:79], 0
v_mfma_f32_16x16x32_bf16 v[108:111], v[172:175], v[76:79], 0
v_mfma_f32_16x16x32_bf16 v[84:87], v[32:35], v[2:5], v[84:87]
v_mfma_f32_16x16x32_bf16 v[96:99], v[120:123], v[2:5], v[96:99]
v_mfma_f32_16x16x32_bf16 v[100:103], v[120:123], v[6:9], v[100:103]
v_mfma_f32_16x16x32_bf16 v[104:107], v[120:123], v[0:3], v[104:107]
v_mfma_f32_16x16x32_bf16 v[108:111], v[120:123], v[4:7], v[108:111]
v_mfma_f32_16x16x32_bf16 v[200:203], v[204:207], v[204:207], 0
s_nop 2
v_rcp_f32 v46, v84
s_nop 0
v_pk_mul_f32 v[96:97], v[96:97], v[46:47] op_sel_hi:[1,0]
v_pk_mul_f32 v[98:99], v[98:99], v[46:47] op_sel_hi:[1,0]
v_pk_mul_f32 v[100:101], v[100:101], v[46:47] op_sel_hi:[1,0]
v_pk_mul_f32 v[102:103], v[102:103], v[46:47] op_sel_hi:[1,0]
v_pk_mul_f32 v[104:105], v[104:105], v[46:47] op_sel_hi:[1,0]
v_pk_mul_f32 v[106:107], v[106:107], v[46:47] op_sel_hi:[1,0]
v_pk_mul_f32 v[108:109], v[108:109], v[46:47] op_sel_hi:[1,0]
v_pk_mul_f32 v[110:111], v[110:111], v[46:47] op_sel_hi:[1,0]
v_cvt_pk_bf16_f32 v96, v96, v97
v_cvt_pk_bf16_f32 v97, v98, v99
v_cvt_pk_bf16_f32 v98, v100, v101
v_cvt_pk_bf16_f32 v99, v102, v103
v_cvt_pk_bf16_f32 v100, v104, v105
v_cvt_pk_bf16_f32 v101, v106, v107
v_cvt_pk_bf16_f32 v102, v108, v109
v_cvt_pk_bf16_f32 v103, v110, v111
buffer_store_dwordx4 v[96:99], v26, s[4:7], s50 offen
buffer_store_dwordx4 v[100:103], v27, s[4:7], s50 offen
s_add_u32 s36, s36, 1
s_cmp_lt_u32 s36, 64
s_cbranch_scc1 Lq_23
s_waitcnt vmcnt(0)
buffer_store_dword v197, v199, s[4:7], 0 offen
s_branch Lend_1
Lpw_38:
Lbw_41:
buffer_load_dword v209, v208, s[4:7], 0 offen sc1
s_waitcnt vmcnt(0)
v_add_u32 v44, v209, v210
v_cmp_gt_u32 vcc, s27, v44
s_cbranch_vccz Lbo_42
s_sub_u32 s37, s37, 1
s_cbranch_scc1 Lend_1
s_sleep 2
s_branch Lbw_41
Lbo_42:
s_branch Lpk_39
Lpf_29:
buffer_load_dwordx4 v[48:51], v10, s[4:7], s40 offen offset:0 sc1
v_mfma_f32_16x16x32_bf16 v[200:203], v[204:207], v[204:207], 0
s_sub_u32 s37, s37, 1
s_cbranch_scc1 Lend_1
Lps_43:
s_waitcnt vmcnt(3)
v_max3_u32 v44, v52, v53, v54
v_max_u32 v44, v44, v55
v_cmp_eq_u32 vcc, -1, v44
s_cbranch_vccnz Lpf_44
v_smfmac_f32_16x16x64_bf16 v[64:67], v[52:55], a[64:71], v15
v_smfmac_f32_16x16x64_bf16 v[68:71], v[52:55], a[72:79], v15
v_smfmac_f32_16x16x64_bf16 v[72:75], v[52:55], a[80:87], v15
v_smfmac_f32_16x16x64_bf16 v[76:79], v[52:55], a[88:95], v15
v_smfmac_f32_16x16x64_bf16 v[80:83], v[52:55], a[96:103], v15
v_smfmac_f32_16x16x64_bf16 v[84:87], v[52:55], a[104:111], v15
v_smfmac_f32_16x16x64_bf16 v[88:91], v[52:55], a[112:119], v15
v_smfmac_f32_16x16x64_bf16 v[92:95], v[52:55], a[120:127], v15
Lps_45:
s_waitcnt vmcnt(2)
v_max3_u32 v44, v56, v57, v58
v_max_u32 v44, v44, v59
v_cmp_eq_u32 vcc, -1, v44
s_cbranch_vccnz Lpf_46
v_smfmac_f32_16x16x64_bf16 v[64:67], v[56:59], a[128:135], v15
v_smfmac_f32_16x16x64_bf16 v[68:71], v[56:59], a[136:143], v15
v_smfmac_f32_16x16x64_bf16 v[72:75], v[56:59], a[144:151], v15
v_smfmac_f32_16x16x64_bf16 v[76:79], v[56:59], a[152:159], v15
v_smfmac_f32_16x16x64_bf16 v[80:83], v[56:59], a[160:167], v15
v_smfmac_f32_16x16x64_bf16 v[84:87], v[56:59], a[168:175], v15
v_smfmac_f32_16x16x64_bf16 v[88:91], v[56:59], a[176:183], v15
v_smfmac_f32_16x16x64_bf16 v[92:95], v[56:59], a[184:191], v15
Lps_47:
s_waitcnt vmcnt(1)
v_max3_u32 v44, v60, v61, v62
v_max_u32 v44, v44, v63
v_cmp_eq_u32 vcc, -1, v44
s_cbranch_vccnz Lpf_48
v_smfmac_f32_16x16x64_bf16 v[64:67], v[60:63], a[192:199], v15
v_smfmac_f32_16x16x64_bf16 v[68:71], v[60:63], a[200:207], v15
v_smfmac_f32_16x16x64_bf16 v[72:75], v[60:63], a[208:215], v15
v_smfmac_f32_16x16x64_bf16 v[76:79], v[60:63], a[216:223], v15
v_smfmac_f32_16x16x64_bf16 v[80:83], v[60:63], a[224:231], v15
v_smfmac_f32_16x16x64_bf16 v[84:87], v[60:63], a[232:239], v15
v_smfmac_f32_16x16x64_bf16 v[88:91], v[60:63], a[240:247], v15
v_smfmac_f32_16x16x64_bf16 v[92:95], v[60:63], a[248:255], v15
Lps_49:
s_waitcnt vmcnt(0)
v_max3_u32 v44, v48, v49, v50
v_max_u32 v44, v44, v51
v_cmp_eq_u32 vcc, -1, v44
s_cbranch_vccnz Lpf_50
v_smfmac_f32_16x16x64_bf16 v[64:67], v[48:51], a[0:7], v15
v_smfmac_f32_16x16x64_bf16 v[68:71], v[48:51], a[8:15], v15
v_smfmac_f32_16x16x64_bf16 v[72:75], v[48:51], a[16:23], v15
v_smfmac_f32_16x16x64_bf16 v[76:79], v[48:51], a[24:31], v15
v_smfmac_f32_16x16x64_bf16 v[80:83], v[48:51], a[32:39], v15
v_smfmac_f32_16x16x64_bf16 v[84:87], v[48:51], a[40:47], v15
v_smfmac_f32_16x16x64_bf16 v[88:91], v[48:51], a[48:55], v15
v_smfmac_f32_16x16x64_bf16 v[92:95], v[48:51], a[56:63], v15
s_branch Lpd_28
Lpf_30:
buffer_load_dwordx4 v[52:55], v10, s[4:7], s40 offen offset:1024 sc1
v_mfma_f32_16x16x32_bf16 v[200:203], v[204:207], v[204:207], 0
s_sub_u32 s37, s37, 1
s_cbranch_scc1 Lend_1
Lps_51:
s_waitcnt vmcnt(2)
v_max3_u32 v44, v56, v57, v58
v_max_u32 v44, v44, v59
v_cmp_eq_u32 vcc, -1, v44
s_cbranch_vccnz Lpf_52
v_smfmac_f32_16x16x64_bf16 v[64:67], v[56:59], a[128:135], v15
v_smfmac_f32_16x16x64_bf16 v[68:71], v[56:59], a[136:143], v15
v_smfmac_f32_16x16x64_bf16 v[72:75], v[56:59], a[144:151], v15
v_smfmac_f32_16x16x64_bf16 v[76:79], v[56:59], a[152:159], v15
v_smfmac_f32_16x16x64_bf16 v[80:83], v[56:59], a[160:167], v15
v_smfmac_f32_16x16x64_bf16 v[84:87], v[56:59], a[168:175], v15
v_smfmac_f32_16x16x64_bf16 v[88:91], v[56:59], a[176:183], v15
v_smfmac_f32_16x16x64_bf16 v[92:95], v[56:59], a[184:191], v15
Lps_53:
s_waitcnt vmcnt(1)
v_max3_u32 v44, v60, v61, v62
v_max_u32 v44, v44, v63
v_cmp_eq_u32 vcc, -1, v44
s_cbranch_vccnz Lpf_54
v_smfmac_f32_16x16x64_bf16 v[64:67], v[60:63], a[192:199], v15
v_smfmac_f32_16x16x64_bf16 v[68:71], v[60:63], a[200:207], v15
v_smfmac_f32_16x16x64_bf16 v[72:75], v[60:63], a[208:215], v15
v_smfmac_f32_16x16x64_bf16 v[76:79], v[60:63], a[216:223], v15
v_smfmac_f32_16x16x64_bf16 v[80:83], v[60:63], a[224:231], v15
v_smfmac_f32_16x16x64_bf16 v[84:87], v[60:63], a[232:239], v15
v_smfmac_f32_16x16x64_bf16 v[88:91], v[60:63], a[240:247], v15
v_smfmac_f32_16x16x64_bf16 v[92:95], v[60:63], a[248:255], v15
Lps_55:
s_waitcnt vmcnt(0)
v_max3_u32 v44, v52, v53, v54
v_max_u32 v44, v44, v55
v_cmp_eq_u32 vcc, -1, v44
s_cbranch_vccnz Lpf_56
v_smfmac_f32_16x16x64_bf16 v[64:67], v[52:55], a[64:71], v15
v_smfmac_f32_16x16x64_bf16 v[68:71], v[52:55], a[72:79], v15
v_smfmac_f32_16x16x64_bf16 v[72:75], v[52:55], a[80:87], v15
v_smfmac_f32_16x16x64_bf16 v[76:79], v[52:55], a[88:95], v15
v_smfmac_f32_16x16x64_bf16 v[80:83], v[52:55], a[96:103], v15
v_smfmac_f32_16x16x64_bf16 v[84:87], v[52:55], a[104:111], v15
v_smfmac_f32_16x16x64_bf16 v[88:91], v[52:55], a[112:119], v15
v_smfmac_f32_16x16x64_bf16 v[92:95], v[52:55], a[120:127], v15
s_branch Lpd_28
Lpf_31:
buffer_load_dwordx4 v[56:59], v10, s[4:7], s40 offen offset:2048 sc1
v_mfma_f32_16x16x32_bf16 v[200:203], v[204:207], v[204:207], 0
s_sub_u32 s37, s37, 1
s_cbranch_scc1 Lend_1
Lps_57:
s_waitcnt vmcnt(1)
v_max3_u32 v44, v60, v61, v62
v_max_u32 v44, v44, v63
v_cmp_eq_u32 vcc, -1, v44
s_cbranch_vccnz Lpf_58
v_smfmac_f32_16x16x64_bf16 v[64:67], v[60:63], a[192:199], v15
v_smfmac_f32_16x16x64_bf16 v[68:71], v[60:63], a[200:207], v15
v_smfmac_f32_16x16x64_bf16 v[72:75], v[60:63], a[208:215], v15
v_smfmac_f32_16x16x64_bf16 v[76:79], v[60:63], a[216:223], v15
v_smfmac_f32_16x16x64_bf16 v[80:83], v[60:63], a[224:231], v15
v_smfmac_f32_16x16x64_bf16 v[84:87], v[60:63], a[232:239], v15
v_smfmac_f32_16x16x64_bf16 v[88:91], v[60:63], a[240:247], v15
v_smfmac_f32_16x16x64_bf16 v[92:95], v[60:63], a[248:255], v15
Lps_59:
s_waitcnt vmcnt(0)
v_max3_u32 v44, v56, v57, v58
v_max_u32 v44, v44, v59
v_cmp_eq_u32 vcc, -1, v44
s_cbranch_vccnz Lpf_60
v_smfmac_f32_16x16x64_bf16 v[64:67], v[56:59], a[128:135], v15
v_smfmac_f32_16x16x64_bf16 v[68:71], v[56:59], a[136:143], v15
v_smfmac_f32_16x16x64_bf16 v[72:75], v[56:59], a[144:151], v15
v_smfmac_f32_16x16x64_bf16 v[76:79], v[56:59], a[152:159], v15
v_smfmac_f32_16x16x64_bf16 v[80:83], v[56:59], a[160:167], v15
v_smfmac_f32_16x16x64_bf16 v[84:87], v[56:59], a[168:175], v15
v_smfmac_f32_16x16x64_bf16 v[88:91], v[56:59], a[176:183], v15
v_smfmac_f32_16x16x64_bf16 v[92:95], v[56:59], a[184:191], v15
s_branch Lpd_28
Lpf_32:
buffer_load_dwordx4 v[60:63], v10, s[4:7], s40 offen offset:3072 sc1
v_mfma_f32_16x16x32_bf16 v[200:203], v[204:207], v[204:207], 0
s_sub_u32 s37, s37, 1
s_cbranch_scc1 Lend_1
Lps_61:
s_waitcnt vmcnt(0)
v_max3_u32 v44, v60, v61, v62
v_max_u32 v44, v44, v63
v_cmp_eq_u32 vcc, -1, v44
s_cbranch_vccnz Lpf_62
v_smfmac_f32_16x16x64_bf16 v[64:67], v[60:63], a[192:199], v15
v_smfmac_f32_16x16x64_bf16 v[68:71], v[60:63], a[200:207], v15
v_smfmac_f32_16x16x64_bf16 v[72:75], v[60:63], a[208:215], v15
v_smfmac_f32_16x16x64_bf16 v[76:79], v[60:63], a[216:223], v15
v_smfmac_f32_16x16x64_bf16 v[80:83], v[60:63], a[224:231], v15
v_smfmac_f32_16x16x64_bf16 v[84:87], v[60:63], a[232:239], v15
v_smfmac_f32_16x16x64_bf16 v[88:91], v[60:63], a[240:247], v15
v_smfmac_f32_16x16x64_bf16 v[92:95], v[60:63], a[248:255], v15
s_branch Lpd_28
Lpf_44:
buffer_load_dwordx4 v[52:55], v10, s[4:7], s40 offen offset:1024 sc1
v_mfma_f32_16x16x32_bf16 v[200:203], v[204:207], v[204:207], 0
Lps_63:
s_waitcnt vmcnt(3)
v_max3_u32 v44, v56, v57, v58
v_max_u32 v44, v44, v59
v_cmp_eq_u32 vcc, -1, v44
s_cbranch_vccnz Lpf_64
v_smfmac_f32_16x16x64_bf16 v[64:67], v[56:59], a[128:135], v15
v_smfmac_f32_16x16x64_bf16 v[68:71], v[56:59], a[136:143], v15
v_smfmac_f32_16x16x64_bf16 v[72:75], v[56:59], a[144:151], v15
v_smfmac_f32_16x16x64_bf16 v[76:79], v[56:59], a[152:159], v15
v_smfmac_f32_16x16x64_bf16 v[80:83], v[56:59], a[160:167], v15
v_smfmac_f32_16x16x64_bf16 v[84:87], v[56:59], a[168:175], v15
v_smfmac_f32_16x16x64_bf16 v[88:91], v[56:59], a[176:183], v15
v_smfmac_f32_16x16x64_bf16 v[92:95], v[56:59], a[184:191], v15
Lps_65:
s_waitcnt vmcnt(2)
v_max3_u32 v44, v60, v61, v62
v_max_u32 v44, v44, v63
v_cmp_eq_u32 vcc, -1, v44
s_cbranch_vccnz Lpf_66
v_smfmac_f32_16x16x64_bf16 v[64:67], v[60:63], a[192:199], v15
v_smfmac_f32_16x16x64_bf16 v[68:71], v[60:63], a[200:207], v15
v_smfmac_f32_16x16x64_bf16 v[72:75], v[60:63], a[208:215], v15
v_smfmac_f32_16x16x64_bf16 v[76:79], v[60:63], a[216:223], v15
v_smfmac_f32_16x16x64_bf16 v[80:83], v[60:63], a[224:231], v15
v_smfmac_f32_16x16x64_bf16 v[84:87], v[60:63], a[232:239], v15
v_smfmac_f32_16x16x64_bf16 v[88:91], v[60:63], a[240:247], v15
v_smfmac_f32_16x16x64_bf16 v[92:95], v[60:63], a[248:255], v15
Lps_67:
s_waitcnt vmcnt(1)
v_max3_u32 v44, v48, v49, v50
v_max_u32 v44, v44, v51
v_cmp_eq_u32 vcc, -1, v44
s_cbranch_vccnz Lpf_68
v_smfmac_f32_16x16x64_bf16 v[64:67], v[48:51], a[0:7], v15
v_smfmac_f32_16x16x64_bf16 v[68:71], v[48:51], a[8:15], v15
v_smfmac_f32_16x16x64_bf16 v[72:75], v[48:51], a[16:23], v15
v_smfmac_f32_16x16x64_bf16 v[76:79], v[48:51], a[24:31], v15
v_smfmac_f32_16x16x64_bf16 v[80:83], v[48:51], a[32:39], v15
v_smfmac_f32_16x16x64_bf16 v[84:87], v[48:51], a[40:47], v15
v_smfmac_f32_16x16x64_bf16 v[88:91], v[48:51], a[48:55], v15
v_smfmac_f32_16x16x64_bf16 v[92:95], v[48:51], a[56:63], v15
s_branch Lps_55
Lpf_46:
buffer_load_dwordx4 v[56:59], v10, s[4:7], s40 offen offset:2048 sc1
v_mfma_f32_16x16x32_bf16 v[200:203], v[204:207], v[204:207], 0
Lps_69:
s_waitcnt vmcnt(2)
v_max3_u32 v44, v60, v61, v62
v_max_u32 v44, v44, v63
v_cmp_eq_u32 vcc, -1, v44
s_cbranch_vccnz Lpf_70
v_smfmac_f32_16x16x64_bf16 v[64:67], v[60:63], a[192:199], v15
v_smfmac_f32_16x16x64_bf16 v[68:71], v[60:63], a[200:207], v15
v_smfmac_f32_16x16x64_bf16 v[72:75], v[60:63], a[208:215], v15
v_smfmac_f32_16x16x64_bf16 v[76:79], v[60:63], a[216:223], v15
v_smfmac_f32_16x16x64_bf16 v[80:83], v[60:63], a[224:231], v15
v_smfmac_f32_16x16x64_bf16 v[84:87], v[60:63], a[232:239], v15
v_smfmac_f32_16x16x64_bf16 v[88:91], v[60:63], a[240:247], v15
v_smfmac_f32_16x16x64_bf16 v[92:95], v[60:63], a[248:255], v15
Lps_71:
s_waitcnt vmcnt(1)
v_max3_u32 v44, v48, v49, v50
v_max_u32 v44, v44, v51
v_cmp_eq_u32 vcc, -1, v44
s_cbranch_vccnz Lpf_72
v_smfmac_f32_16x16x64_bf16 v[64:67], v[48:51], a[0:7], v15
v_smfmac_f32_16x16x64_bf16 v[68:71], v[48:51], a[8:15], v15
v_smfmac_f32_16x16x64_bf16 v[72:75], v[48:51], a[16:23], v15
v_smfmac_f32_16x16x64_bf16 v[76:79], v[48:51], a[24:31], v15
v_smfmac_f32_16x16x64_bf16 v[80:83], v[48:51], a[32:39], v15
v_smfmac_f32_16x16x64_bf16 v[84:87], v[48:51], a[40:47], v15
v_smfmac_f32_16x16x64_bf16 v[88:91], v[48:51], a[48:55], v15
v_smfmac_f32_16x16x64_bf16 v[92:95], v[48:51], a[56:63], v15
s_branch Lps_59
Lpf_48:
buffer_load_dwordx4 v[60:63], v10, s[4:7], s40 offen offset:3072 sc1
v_mfma_f32_16x16x32_bf16 v[200:203], v[204:207], v[204:207], 0
Lps_73:
s_waitcnt vmcnt(1)
v_max3_u32 v44, v48, v49, v50
v_max_u32 v44, v44, v51
v_cmp_eq_u32 vcc, -1, v44
s_cbranch_vccnz Lpf_74
v_smfmac_f32_16x16x64_bf16 v[64:67], v[48:51], a[0:7], v15
v_smfmac_f32_16x16x64_bf16 v[68:71], v[48:51], a[8:15], v15
v_smfmac_f32_16x16x64_bf16 v[72:75], v[48:51], a[16:23], v15
v_smfmac_f32_16x16x64_bf16 v[76:79], v[48:51], a[24:31], v15
v_smfmac_f32_16x16x64_bf16 v[80:83], v[48:51], a[32:39], v15
v_smfmac_f32_16x16x64_bf16 v[84:87], v[48:51], a[40:47], v15
v_smfmac_f32_16x16x64_bf16 v[88:91], v[48:51], a[48:55], v15
v_smfmac_f32_16x16x64_bf16 v[92:95], v[48:51], a[56:63], v15
s_branch Lps_61
Lpf_50:
buffer_load_dwordx4 v[48:51], v10, s[4:7], s40 offen offset:0 sc1
v_mfma_f32_16x16x32_bf16 v[200:203], v[204:207], v[204:207], 0
s_sub_u32 s37, s37, 1
s_cbranch_scc1 Lend_1
s_branch Lps_49
Lpf_52:
buffer_load_dwordx4 v[56:59], v10, s[4:7], s40 offen offset:2048 sc1
v_mfma_f32_16x16x32_bf16 v[200:203], v[204:207], v[204:207], 0
Lps_75:
s_waitcnt vmcnt(2)
v_max3_u32 v44, v60, v61, v62
v_max_u32 v44, v44, v63
v_cmp_eq_u32 vcc, -1, v44
s_cbranch_vccnz Lpf_76
v_smfmac_f32_16x16x64_bf16 v[64:67], v[60:63], a[192:199], v15
v_smfmac_f32_16x16x64_bf16 v[68:71], v[60:63], a[200:207], v15
v_smfmac_f32_16x16x64_bf16 v[72:75], v[60:63], a[208:215], v15
v_smfmac_f32_16x16x64_bf16 v[76:79], v[60:63], a[216:223], v15
v_smfmac_f32_16x16x64_bf16 v[80:83], v[60:63], a[224:231], v15
v_smfmac_f32_16x16x64_bf16 v[84:87], v[60:63], a[232:239], v15
v_smfmac_f32_16x16x64_bf16 v[88:91], v[60:63], a[240:247], v15
v_smfmac_f32_16x16x64_bf16 v[92:95], v[60:63], a[248:255], v15
Lps_77:
s_waitcnt vmcnt(1)
v_max3_u32 v44, v52, v53, v54
v_max_u32 v44, v44, v55
v_cmp_eq_u32 vcc, -1, v44
s_cbranch_vccnz Lpf_78
v_smfmac_f32_16x16x64_bf16 v[64:67], v[52:55], a[64:71], v15
v_smfmac_f32_16x16x64_bf16 v[68:71], v[52:55], a[72:79], v15
v_smfmac_f32_16x16x64_bf16 v[72:75], v[52:55], a[80:87], v15
v_smfmac_f32_16x16x64_bf16 v[76:79], v[52:55], a[88:95], v15
v_smfmac_f32_16x16x64_bf16 v[80:83], v[52:55], a[96:103], v15
v_smfmac_f32_16x16x64_bf16 v[84:87], v[52:55], a[104:111], v15
v_smfmac_f32_16x16x64_bf16 v[88:91], v[52:55], a[112:119], v15
v_smfmac_f32_16x16x64_bf16 v[92:95], v[52:55], a[120:127], v15
s_branch Lps_59
Lpf_54:
buffer_load_dwordx4 v[60:63], v10, s[4:7], s40 offen offset:3072 sc1
v_mfma_f32_16x16x32_bf16 v[200:203], v[204:207], v[204:207], 0
Lps_79:
s_waitcnt vmcnt(1)
v_max3_u32 v44, v52, v53, v54
v_max_u32 v44, v44, v55
v_cmp_eq_u32 vcc, -1, v44
s_cbranch_vccnz Lpf_80
v_smfmac_f32_16x16x64_bf16 v[64:67], v[52:55], a[64:71], v15
v_smfmac_f32_16x16x64_bf16 v[68:71], v[52:55], a[72:79], v15
v_smfmac_f32_16x16x64_bf16 v[72:75], v[52:55], a[80:87], v15
v_smfmac_f32_16x16x64_bf16 v[76:79], v[52:55], a[88:95], v15
v_smfmac_f32_16x16x64_bf16 v[80:83], v[52:55], a[96:103], v15
v_smfmac_f32_16x16x64_bf16 v[84:87], v[52:55], a[104:111], v15
v_smfmac_f32_16x16x64_bf16 v[88:91], v[52:55], a[112:119], v15
v_smfmac_f32_16x16x64_bf16 v[92:95], v[52:55], a[120:127], v15
s_branch Lps_61
Lpf_56:
buffer_load_dwordx4 v[52:55], v10, s[4:7], s40 offen offset:1024 sc1
v_mfma_f32_16x16x32_bf16 v[200:203], v[204:207], v[204:207], 0
s_sub_u32 s37, s37, 1
s_cbranch_scc1 Lend_1
s_branch Lps_55
Lpf_58:
buffer_load_dwordx4 v[60:63], v10, s[4:7], s40 offen offset:3072 sc1
v_mfma_f32_16x16x32_bf16 v[200:203], v[204:207], v[204:207], 0
Lps_81:
s_waitcnt vmcnt(1)
v_max3_u32 v44, v56, v57, v58
v_max_u32 v44, v44, v59
v_cmp_eq_u32 vcc, -1, v44
s_cbranch_vccnz Lpf_82
v_smfmac_f32_16x16x64_bf16 v[64:67], v[56:59], a[128:135], v15
v_smfmac_f32_16x16x64_bf16 v[68:71], v[56:59], a[136:143], v15
v_smfmac_f32_16x16x64_bf16 v[72:75], v[56:59], a[144:151], v15
v_smfmac_f32_16x16x64_bf16 v[76:79], v[56:59], a[152:159], v15
v_smfmac_f32_16x16x64_bf16 v[80:83], v[56:59], a[160:167], v15
v_smfmac_f32_16x16x64_bf16 v[84:87], v[56:59], a[168:175], v15
v_smfmac_f32_16x16x64_bf16 v[88:91], v[56:59], a[176:183], v15
v_smfmac_f32_16x16x64_bf16 v[92:95], v[56:59], a[184:191], v15
s_branch Lps_61
Lpf_60:
buffer_load_dwordx4 v[56:59], v10, s[4:7], s40 offen offset:2048 sc1
v_mfma_f32_16x16x32_bf16 v[200:203], v[204:207], v[204:207], 0
s_sub_u32 s37, s37, 1
s_cbranch_scc1 Lend_1
s_branch Lps_59
Lpf_62:
buffer_load_dwordx4 v[60:63], v10, s[4:7], s40 offen offset:3072 sc1
v_mfma_f32_16x16x32_bf16 v[200:203], v[204:207], v[204:207], 0
s_sub_u32 s37, s37, 1
s_cbranch_scc1 Lend_1
s_branch Lps_61
Lpf_64:
buffer_load_dwordx4 v[56:59], v10, s[4:7], s40 offen offset:2048 sc1
v_mfma_f32_16x16x32_bf16 v[200:203], v[204:207], v[204:207], 0
Lps_83:
s_waitcnt vmcnt(3)
v_max3_u32 v44, v60, v61, v62
v_max_u32 v44, v44, v63
v_cmp_eq_u32 vcc, -1, v44
s_cbranch_vccnz Lpf_84
v_smfmac_f32_16x16x64_bf16 v[64:67], v[60:63], a[192:199], v15
v_smfmac_f32_16x16x64_bf16 v[68:71], v[60:63], a[200:207], v15
v_smfmac_f32_16x16x64_bf16 v[72:75], v[60:63], a[208:215], v15
v_smfmac_f32_16x16x64_bf16 v[76:79], v[60:63], a[216:223], v15
v_smfmac_f32_16x16x64_bf16 v[80:83], v[60:63], a[224:231], v15
v_smfmac_f32_16x16x64_bf16 v[84:87], v[60:63], a[232:239], v15
v_smfmac_f32_16x16x64_bf16 v[88:91], v[60:63], a[240:247], v15
v_smfmac_f32_16x16x64_bf16 v[92:95], v[60:63], a[248:255], v15
Lps_85:
s_waitcnt vmcnt(2)
v_max3_u32 v44, v48, v49, v50
v_max_u32 v44, v44, v51
v_cmp_eq_u32 vcc, -1, v44
s_cbranch_vccnz Lpf_86
v_smfmac_f32_16x16x64_bf16 v[64:67], v[48:51], a[0:7], v15
v_smfmac_f32_16x16x64_bf16 v[68:71], v[48:51], a[8:15], v15
v_smfmac_f32_16x16x64_bf16 v[72:75], v[48:51], a[16:23], v15
v_smfmac_f32_16x16x64_bf16 v[76:79], v[48:51], a[24:31], v15
v_smfmac_f32_16x16x64_bf16 v[80:83], v[48:51], a[32:39], v15
v_smfmac_f32_16x16x64_bf16 v[84:87], v[48:51], a[40:47], v15
v_smfmac_f32_16x16x64_bf16 v[88:91], v[48:51], a[48:55], v15
v_smfmac_f32_16x16x64_bf16 v[92:95], v[48:51], a[56:63], v15
s_branch Lps_77
Lpf_66:
buffer_load_dwordx4 v[60:63], v10, s[4:7], s40 offen offset:3072 sc1
v_mfma_f32_16x16x32_bf16 v[200:203], v[204:207], v[204:207], 0
Lps_87:
s_waitcnt vmcnt(2)
v_max3_u32 v44, v48, v49, v50
v_max_u32 v44, v44, v51
v_cmp_eq_u32 vcc, -1, v44
s_cbranch_vccnz Lpf_88
v_smfmac_f32_16x16x64_bf16 v[64:67], v[48:51], a[0:7], v15
v_smfmac_f32_16x16x64_bf16 v[68:71], v[48:51], a[8:15], v15
v_smfmac_f32_16x16x64_bf16 v[72:75], v[48:51], a[16:23], v15
v_smfmac_f32_16x16x64_bf16 v[76:79], v[48:51], a[24:31], v15
v_smfmac_f32_16x16x64_bf16 v[80:83], v[48:51], a[32:39], v15
v_smfmac_f32_16x16x64_bf16 v[84:87], v[48:51], a[40:47], v15
v_smfmac_f32_16x16x64_bf16 v[88:91], v[48:51], a[48:55], v15
v_smfmac_f32_16x16x64_bf16 v[92:95], v[48:51], a[56:63], v15
s_branch Lps_79
Lpf_68:
buffer_load_dwordx4 v[48:51], v10, s[4:7], s40 offen offset:0 sc1
v_mfma_f32_16x16x32_bf16 v[200:203], v[204:207], v[204:207], 0
s_sub_u32 s37, s37, 1
s_cbranch_scc1 Lend_1
Lps_89:
s_waitcnt vmcnt(1)
v_max3_u32 v44, v52, v53, v54
v_max_u32 v44, v44, v55
v_cmp_eq_u32 vcc, -1, v44
s_cbranch_vccnz Lpf_90
v_smfmac_f32_16x16x64_bf16 v[64:67], v[52:55], a[64:71], v15
v_smfmac_f32_16x16x64_bf16 v[68:71], v[52:55], a[72:79], v15
v_smfmac_f32_16x16x64_bf16 v[72:75], v[52:55], a[80:87], v15
v_smfmac_f32_16x16x64_bf16 v[76:79], v[52:55], a[88:95], v15
v_smfmac_f32_16x16x64_bf16 v[80:83], v[52:55], a[96:103], v15
v_smfmac_f32_16x16x64_bf16 v[84:87], v[52:55], a[104:111], v15
v_smfmac_f32_16x16x64_bf16 v[88:91], v[52:55], a[112:119], v15
v_smfmac_f32_16x16x64_bf16 v[92:95], v[52:55], a[120:127], v15
s_branch Lps_49
Lpf_70:
buffer_load_dwordx4 v[60:63], v10, s[4:7], s40 offen offset:3072 sc1
v_mfma_f32_16x16x32_bf16 v[200:203], v[204:207], v[204:207], 0
Lps_91:
s_waitcnt vmcnt(2)
v_max3_u32 v44, v48, v49, v50
v_max_u32 v44, v44, v51
v_cmp_eq_u32 vcc, -1, v44
s_cbranch_vccnz Lpf_92
v_smfmac_f32_16x16x64_bf16 v[64:67], v[48:51], a[0:7], v15
v_smfmac_f32_16x16x64_bf16 v[68:71], v[48:51], a[8:15], v15
v_smfmac_f32_16x16x64_bf16 v[72:75], v[48:51], a[16:23], v15
v_smfmac_f32_16x16x64_bf16 v[76:79], v[48:51], a[24:31], v15
v_smfmac_f32_16x16x64_bf16 v[80:83], v[48:51], a[32:39], v15
v_smfmac_f32_16x16x64_bf16 v[84:87], v[48:51], a[40:47], v15
v_smfmac_f32_16x16x64_bf16 v[88:91], v[48:51], a[48:55], v15
v_smfmac_f32_16x16x64_bf16 v[92:95], v[48:51], a[56:63], v15
s_branch Lps_81
Lpf_72:
buffer_load_dwordx4 v[48:51], v10, s[4:7], s40 offen offset:0 sc1
v_mfma_f32_16x16x32_bf16 v[200:203], v[204:207], v[204:207], 0
s_sub_u32 s37, s37, 1
s_cbranch_scc1 Lend_1
Lps_93:
s_waitcnt vmcnt(1)
v_max3_u32 v44, v56, v57, v58
v_max_u32 v44, v44, v59
v_cmp_eq_u32 vcc, -1, v44
s_cbranch_vccnz Lpf_94
v_smfmac_f32_16x16x64_bf16 v[64:67], v[56:59], a[128:135], v15
v_smfmac_f32_16x16x64_bf16 v[68:71], v[56:59], a[136:143], v15
v_smfmac_f32_16x16x64_bf16 v[72:75], v[56:59], a[144:151], v15
v_smfmac_f32_16x16x64_bf16 v[76:79], v[56:59], a[152:159], v15
v_smfmac_f32_16x16x64_bf16 v[80:83], v[56:59], a[160:167], v15
v_smfmac_f32_16x16x64_bf16 v[84:87], v[56:59], a[168:175], v15
v_smfmac_f32_16x16x64_bf16 v[88:91], v[56:59], a[176:183], v15
v_smfmac_f32_16x16x64_bf16 v[92:95], v[56:59], a[184:191], v15
s_branch Lps_49
Lpf_74:
buffer_load_dwordx4 v[48:51], v10, s[4:7], s40 offen offset:0 sc1
v_mfma_f32_16x16x32_bf16 v[200:203], v[204:207], v[204:207], 0
s_sub_u32 s37, s37, 1
s_cbranch_scc1 Lend_1
s_branch Lps_47
Lpf_76:
buffer_load_dwordx4 v[60:63], v10, s[4:7], s40 offen offset:3072 sc1
v_mfma_f32_16x16x32_bf16 v[200:203], v[204:207], v[204:207], 0
Lps_95:
s_waitcnt vmcnt(2)
v_max3_u32 v44, v52, v53, v54
v_max_u32 v44, v44, v55
v_cmp_eq_u32 vcc, -1, v44
s_cbranch_vccnz Lpf_96
v_smfmac_f32_16x16x64_bf16 v[64:67], v[52:55], a[64:71], v15
v_smfmac_f32_16x16x64_bf16 v[68:71], v[52:55], a[72:79], v15
v_smfmac_f32_16x16x64_bf16 v[72:75], v[52:55], a[80:87], v15
v_smfmac_f32_16x16x64_bf16 v[76:79], v[52:55], a[88:95], v15
v_smfmac_f32_16x16x64_bf16 v[80:83], v[52:55], a[96:103], v15
v_smfmac_f32_16x16x64_bf16 v[84:87], v[52:55], a[104:111], v15
v_smfmac_f32_16x16x64_bf16 v[88:91], v[52:55], a[112:119], v15
v_smfmac_f32_16x16x64_bf16 v[92:95], v[52:55], a[120:127], v15
s_branch Lps_81
Lpf_78:
buffer_load_dwordx4 v[52:55], v10, s[4:7], s40 offen offset:1024 sc1
v_mfma_f32_16x16x32_bf16 v[200:203], v[204:207], v[204:207], 0
s_sub_u32 s37, s37, 1
s_cbranch_scc1 Lend_1
Lps_97:
s_waitcnt vmcnt(1)
v_max3_u32 v44, v56, v57, v58
v_max_u32 v44, v44, v59
v_cmp_eq_u32 vcc, -1, v44
s_cbranch_vccnz Lpf_98
v_smfmac_f32_16x16x64_bf16 v[64:67], v[56:59], a[128:135], v15
v_smfmac_f32_16x16x64_bf16 v[68:71], v[56:59], a[136:143], v15
v_smfmac_f32_16x16x64_bf16 v[72:75], v[56:59], a[144:151], v15
v_smfmac_f32_16x16x64_bf16 v[76:79], v[56:59], a[152:159], v15
v_smfmac_f32_16x16x64_bf16 v[80:83], v[56:59], a[160:167], v15
v_smfmac_f32_16x16x64_bf16 v[84:87], v[56:59], a[168:175], v15
v_smfmac_f32_16x16x64_bf16 v[88:91], v[56:59], a[176:183], v15
v_smfmac_f32_16x16x64_bf16 v[92:95], v[56:59], a[184:191], v15
s_branch Lps_55
Lpf_80:
buffer_load_dwordx4 v[52:55], v10, s[4:7], s40 offen offset:1024 sc1
v_mfma_f32_16x16x32_bf16 v[200:203], v[204:207], v[204:207], 0
s_sub_u32 s37, s37, 1
s_cbranch_scc1 Lend_1
s_branch Lps_53
Lpf_82:
buffer_load_dwordx4 v[56:59], v10, s[4:7], s40 offen offset:2048 sc1
v_mfma_f32_16x16x32_bf16 v[200:203], v[204:207], v[204:207], 0
s_sub_u32 s37, s37, 1
s_cbranch_scc1 Lend_1
s_branch Lps_57
Lpf_84:
buffer_load_dwordx4 v[60:63], v10, s[4:7], s40 offen offset:3072 sc1
v_mfma_f32_16x16x32_bf16 v[200:203], v[204:207], v[204:207], 0
Lps_99:
s_waitcnt vmcnt(3)
v_max3_u32 v44, v48, v49, v50
v_max_u32 v44, v44, v51
v_cmp_eq_u32 vcc, -1, v44
s_cbranch_vccnz Lpf_100
v_smfmac_f32_16x16x64_bf16 v[64:67], v[48:51], a[0:7], v15
v_smfmac_f32_16x16x64_bf16 v[68:71], v[48:51], a[8:15], v15
v_smfmac_f32_16x16x64_bf16 v[72:75], v[48:51], a[16:23], v15
v_smfmac_f32_16x16x64_bf16 v[76:79], v[48:51], a[24:31], v15
v_smfmac_f32_16x16x64_bf16 v[80:83], v[48:51], a[32:39], v15
v_smfmac_f32_16x16x64_bf16 v[84:87], v[48:51], a[40:47], v15
v_smfmac_f32_16x16x64_bf16 v[88:91], v[48:51], a[48:55], v15
v_smfmac_f32_16x16x64_bf16 v[92:95], v[48:51], a[56:63], v15
s_branch Lps_95
Lpf_86:
buffer_load_dwordx4 v[48:51], v10, s[4:7], s40 offen offset:0 sc1
v_mfma_f32_16x16x32_bf16 v[200:203], v[204:207], v[204:207], 0
s_sub_u32 s37, s37, 1
s_cbranch_scc1 Lend_1
Lps_101:
s_waitcnt vmcnt(2)
v_max3_u32 v44, v52, v53, v54
v_max_u32 v44, v44, v55
v_cmp_eq_u32 vcc, -1, v44
s_cbranch_vccnz Lpf_102
v_smfmac_f32_16x16x64_bf16 v[64:67], v[52:55], a[64:71], v15
v_smfmac_f32_16x16x64_bf16 v[68:71], v[52:55], a[72:79], v15
v_smfmac_f32_16x16x64_bf16 v[72:75], v[52:55], a[80:87], v15
v_smfmac_f32_16x16x64_bf16 v[76:79], v[52:55], a[88:95], v15
v_smfmac_f32_16x16x64_bf16 v[80:83], v[52:55], a[96:103], v15
v_smfmac_f32_16x16x64_bf16 v[84:87], v[52:55], a[104:111], v15
v_smfmac_f32_16x16x64_bf16 v[88:91], v[52:55], a[112:119], v15
v_smfmac_f32_16x16x64_bf16 v[92:95], v[52:55], a[120:127], v15
s_branch Lps_93
Lpf_88:
buffer_load_dwordx4 v[48:51], v10, s[4:7], s40 offen offset:0 sc1
v_mfma_f32_16x16x32_bf16 v[200:203], v[204:207], v[204:207], 0
s_sub_u32 s37, s37, 1
s_cbranch_scc1 Lend_1
Lps_103:
s_waitcnt vmcnt(2)
v_max3_u32 v44, v52, v53, v54
v_max_u32 v44, v44, v55
v_cmp_eq_u32 vcc, -1, v44
s_cbranch_vccnz Lpf_104
v_smfmac_f32_16x16x64_bf16 v[64:67], v[52:55], a[64:71], v15
v_smfmac_f32_16x16x64_bf16 v[68:71], v[52:55], a[72:79], v15
v_smfmac_f32_16x16x64_bf16 v[72:75], v[52:55], a[80:87], v15
v_smfmac_f32_16x16x64_bf16 v[76:79], v[52:55], a[88:95], v15
v_smfmac_f32_16x16x64_bf16 v[80:83], v[52:55], a[96:103], v15
v_smfmac_f32_16x16x64_bf16 v[84:87], v[52:55], a[104:111], v15
v_smfmac_f32_16x16x64_bf16 v[88:91], v[52:55], a[112:119], v15
v_smfmac_f32_16x16x64_bf16 v[92:95], v[52:55], a[120:127], v15
s_branch Lps_47
Lpf_90:
buffer_load_dwordx4 v[52:55], v10, s[4:7], s40 offen offset:1024 sc1
v_mfma_f32_16x16x32_bf16 v[200:203], v[204:207], v[204:207], 0
s_branch Lps_67
Lpf_92:
buffer_load_dwordx4 v[48:51], v10, s[4:7], s40 offen offset:0 sc1
v_mfma_f32_16x16x32_bf16 v[200:203], v[204:207], v[204:207], 0
s_sub_u32 s37, s37, 1
s_cbranch_scc1 Lend_1
s_branch Lps_45
Lpf_94:
buffer_load_dwordx4 v[56:59], v10, s[4:7], s40 offen offset:2048 sc1
v_mfma_f32_16x16x32_bf16 v[200:203], v[204:207], v[204:207], 0
s_branch Lps_71
Lpf_96:
buffer_load_dwordx4 v[52:55], v10, s[4:7], s40 offen offset:1024 sc1
v_mfma_f32_16x16x32_bf16 v[200:203], v[204:207], v[204:207], 0
s_sub_u32 s37, s37, 1
s_cbranch_scc1 Lend_1
s_branch Lps_51
Lpf_98:
buffer_load_dwordx4 v[56:59], v10, s[4:7], s40 offen offset:2048 sc1
v_mfma_f32_16x16x32_bf16 v[200:203], v[204:207], v[204:207], 0
s_branch Lps_77
Lpf_100:
buffer_load_dwordx4 v[48:51], v10, s[4:7], s40 offen offset:0 sc1
v_mfma_f32_16x16x32_bf16 v[200:203], v[204:207], v[204:207], 0
s_sub_u32 s37, s37, 1
s_cbranch_scc1 Lend_1
s_branch Lps_43
Lpf_102:
buffer_load_dwordx4 v[52:55], v10, s[4:7], s40 offen offset:1024 sc1
v_mfma_f32_16x16x32_bf16 v[200:203], v[204:207], v[204:207], 0
Lps_105:
s_waitcnt vmcnt(2)
v_max3_u32 v44, v56, v57, v58
v_max_u32 v44, v44, v59
v_cmp_eq_u32 vcc, -1, v44
s_cbranch_vccnz Lpf_106
v_smfmac_f32_16x16x64_bf16 v[64:67], v[56:59], a[128:135], v15
v_smfmac_f32_16x16x64_bf16 v[68:71], v[56:59], a[136:143], v15
v_smfmac_f32_16x16x64_bf16 v[72:75], v[56:59], a[144:151], v15
v_smfmac_f32_16x16x64_bf16 v[76:79], v[56:59], a[152:159], v15
v_smfmac_f32_16x16x64_bf16 v[80:83], v[56:59], a[160:167], v15
v_smfmac_f32_16x16x64_bf16 v[84:87], v[56:59], a[168:175], v15
v_smfmac_f32_16x16x64_bf16 v[88:91], v[56:59], a[176:183], v15
v_smfmac_f32_16x16x64_bf16 v[92:95], v[56:59], a[184:191], v15
s_branch Lps_67
Lpf_104:
buffer_load_dwordx4 v[52:55], v10, s[4:7], s40 offen offset:1024 sc1
v_mfma_f32_16x16x32_bf16 v[200:203], v[204:207], v[204:207], 0
s_branch Lps_65
Lpf_106:
buffer_load_dwordx4 v[56:59], v10, s[4:7], s40 offen offset:2048 sc1
v_mfma_f32_16x16x32_bf16 v[200:203], v[204:207], v[204:207], 0
s_branch Lps_85
Lkr_33:
buffer_load_dwordx4 v[56:59], v11, s[4:7], s40 offen offset:0 sc1
buffer_load_dwordx4 v[60:63], v11, s[4:7], s40 offen offset:1024 sc1
Lps_108:
s_waitcnt vmcnt(3)
v_max3_u32 v44, v48, v49, v50
v_max_u32 v44, v44, v51
v_cmp_eq_u32 vcc, -1, v44
s_cbranch_vccnz Lpf_109
v_smfmac_f32_16x16x64_bf16 v[72:75], v[48:51], v[96:103], v15
v_mov_b32 v112, v48
v_mov_b32 v113, v49
v_mov_b32 v114, v50
v_mov_b32 v115, v51
Lps_110:
s_waitcnt vmcnt(2)
v_max3_u32 v44, v52, v53, v54
v_max_u32 v44, v44, v55
v_cmp_eq_u32 vcc, -1, v44
s_cbranch_vccnz Lpf_111
v_smfmac_f32_16x16x64_bf16 v[72:75], v[52:55], v[104:111], v15
v_mov_b32 v116, v52
v_mov_b32 v117, v53
v_mov_b32 v118, v54
v_mov_b32 v119, v55
Lpd_107:
s_branch Lko_34
Lpf_109:
buffer_load_dwordx4 v[48:51], v11, s[4:7], s40 offen offset:0 sc1
s_sub_u32 s37, s37, 1
s_cbranch_scc1 Lend_1
Lps_112:
s_waitcnt vmcnt(3)
v_max3_u32 v44, v52, v53, v54
v_max_u32 v44, v44, v55
v_cmp_eq_u32 vcc, -1, v44
s_cbranch_vccnz Lpf_113
v_smfmac_f32_16x16x64_bf16 v[72:75], v[52:55], v[104:111], v15
v_mov_b32 v116, v52
v_mov_b32 v117, v53
v_mov_b32 v118, v54
v_mov_b32 v119, v55
Lps_114:
s_waitcnt vmcnt(2)
v_max3_u32 v44, v56, v57, v58
v_max_u32 v44, v44, v59
v_cmp_eq_u32 vcc, -1, v44
s_cbranch_vccnz Lpf_115
v_smfmac_f32_16x16x64_bf16 v[72:75], v[56:59], v[96:103], v15
v_mov_b32 v112, v56
v_mov_b32 v113, v57
v_mov_b32 v114, v58
v_mov_b32 v115, v59
s_branch Lpd_107
Lpf_111:
buffer_load_dwordx4 v[52:55], v11, s[4:7], s40 offen offset:1024 sc1
s_sub_u32 s37, s37, 1
s_cbranch_scc1 Lend_1
Lps_116:
s_waitcnt vmcnt(2)
v_max3_u32 v44, v56, v57, v58
v_max_u32 v44, v44, v59
v_cmp_eq_u32 vcc, -1, v44
s_cbranch_vccnz Lpf_117
Lps_118:
s_waitcnt vmcnt(1)
v_max3_u32 v44, v60, v61, v62
v_max_u32 v44, v44, v63
v_cmp_eq_u32 vcc, -1, v44
s_cbranch_vccnz Lpf_119
v_smfmac_f32_16x16x64_bf16 v[72:75], v[60:63], v[104:111], v15
v_mov_b32 v116, v60
v_mov_b32 v117, v61
v_mov_b32 v118, v62
v_mov_b32 v119, v63
s_branch Lpd_107
Lpf_113:
buffer_load_dwordx4 v[52:55], v11, s[4:7], s40 offen offset:1024 sc1
Lps_120:
s_waitcnt vmcnt(3)
v_max3_u32 v44, v56, v57, v58
v_max_u32 v44, v44, v59
v_cmp_eq_u32 vcc, -1, v44
s_cbranch_vccnz Lpf_121
v_smfmac_f32_16x16x64_bf16 v[72:75], v[56:59], v[96:103], v15
v_mov_b32 v112, v56
v_mov_b32 v113, v57
v_mov_b32 v114, v58
v_mov_b32 v115, v59
Lps_122:
s_waitcnt vmcnt(2)
v_max3_u32 v44, v60, v61, v62
v_max_u32 v44, v44, v63
v_cmp_eq_u32 vcc, -1, v44
s_cbranch_vccnz Lpf_123
v_smfmac_f32_16x16x64_bf16 v[72:75], v[60:63], v[104:111], v15
v_mov_b32 v116, v60
v_mov_b32 v117, v61
v_mov_b32 v118, v62
v_mov_b32 v119, v63
s_branch Lpd_107
Lpf_115:
buffer_load_dwordx4 v[56:59], v11, s[4:7], s40 offen offset:0 sc1
Lps_124:
s_waitcnt vmcnt(2)
v_max3_u32 v44, v60, v61, v62
v_max_u32 v44, v44, v63
v_cmp_eq_u32 vcc, -1, v44
s_cbranch_vccnz Lpf_125
Lps_126:
s_waitcnt vmcnt(1)
v_max3_u32 v44, v48, v49, v50
v_max_u32 v44, v44, v51
v_cmp_eq_u32 vcc, -1, v44
s_cbranch_vccnz Lpf_127
v_smfmac_f32_16x16x64_bf16 v[72:75], v[48:51], v[96:103], v15
v_mov_b32 v112, v48
v_mov_b32 v113, v49
v_mov_b32 v114, v50
v_mov_b32 v115, v51
s_branch Lpd_107
Lpf_117:
buffer_load_dwordx4 v[56:59], v11, s[4:7], s40 offen offset:0 sc1
Lps_128:
s_waitcnt vmcnt(2)
v_max3_u32 v44, v60, v61, v62
v_max_u32 v44, v44, v63
v_cmp_eq_u32 vcc, -1, v44
s_cbranch_vccnz Lpf_129
v_smfmac_f32_16x16x64_bf16 v[72:75], v[60:63], v[104:111], v15
v_mov_b32 v116, v60
v_mov_b32 v117, v61
v_mov_b32 v118, v62
v_mov_b32 v119, v63
s_branch Lpd_107
Lpf_119:
buffer_load_dwordx4 v[60:63], v11, s[4:7], s40 offen offset:1024 sc1
Lps_130:
s_waitcnt vmcnt(1)
v_max3_u32 v44, v52, v53, v54
v_max_u32 v44, v44, v55
v_cmp_eq_u32 vcc, -1, v44
s_cbranch_vccnz Lpf_131
v_smfmac_f32_16x16x64_bf16 v[72:75], v[52:55], v[104:111], v15
v_mov_b32 v116, v52
v_mov_b32 v117, v53
v_mov_b32 v118, v54
v_mov_b32 v119, v55
s_branch Lpd_107
Lpf_121:
buffer_load_dwordx4 v[56:59], v11, s[4:7], s40 offen offset:0 sc1
Lps_132:
s_waitcnt vmcnt(3)
v_max3_u32 v44, v60, v61, v62
v_max_u32 v44, v44, v63
v_cmp_eq_u32 vcc, -1, v44
s_cbranch_vccnz Lpf_133
v_smfmac_f32_16x16x64_bf16 v[72:75], v[60:63], v[104:111], v15
v_mov_b32 v116, v60
v_mov_b32 v117, v61
v_mov_b32 v118, v62
v_mov_b32 v119, v63
Lps_134:
s_waitcnt vmcnt(2)
v_max3_u32 v44, v48, v49, v50
v_max_u32 v44, v44, v51
v_cmp_eq_u32 vcc, -1, v44
s_cbranch_vccnz Lpf_135
v_smfmac_f32_16x16x64_bf16 v[72:75], v[48:51], v[96:103], v15
v_mov_b32 v112, v48
v_mov_b32 v113, v49
v_mov_b32 v114, v50
v_mov_b32 v115, v51
s_branch Lpd_107
Lpf_123:
buffer_load_dwordx4 v[60:63], v11, s[4:7], s40 offen offset:1024 sc1
Lps_136:
s_waitcnt vmcnt(2)
v_max3_u32 v44, v48, v49, v50
v_max_u32 v44, v44, v51
v_cmp_eq_u32 vcc, -1, v44
s_cbranch_vccnz Lpf_137
s_branch Lps_130
Lpf_125:
buffer_load_dwordx4 v[60:63], v11, s[4:7], s40 offen offset:1024 sc1
Lps_138:
s_waitcnt vmcnt(2)
v_max3_u32 v44, v48, v49, v50
v_max_u32 v44, v44, v51
v_cmp_eq_u32 vcc, -1, v44
s_cbranch_vccnz Lpf_139
v_smfmac_f32_16x16x64_bf16 v[72:75], v[48:51], v[96:103], v15
v_mov_b32 v112, v48
v_mov_b32 v113, v49
v_mov_b32 v114, v50
v_mov_b32 v115, v51
s_branch Lpd_107
Lpf_127:
buffer_load_dwordx4 v[48:51], v11, s[4:7], s40 offen offset:0 sc1
s_sub_u32 s37, s37, 1
s_cbranch_scc1 Lend_1
Lps_140:
s_waitcnt vmcnt(1)
v_max3_u32 v44, v56, v57, v58
v_max_u32 v44, v44, v59
v_cmp_eq_u32 vcc, -1, v44
s_cbranch_vccnz Lpf_141
v_smfmac_f32_16x16x64_bf16 v[72:75], v[56:59], v[96:103], v15
v_mov_b32 v112, v56
v_mov_b32 v113, v57
v_mov_b32 v114, v58
v_mov_b32 v115, v59
s_branch Lpd_107
Lpf_129:
buffer_load_dwordx4 v[60:63], v11, s[4:7], s40 offen offset:1024 sc1
s_branch Lps_110
Lpf_131:
buffer_load_dwordx4 v[52:55], v11, s[4:7], s40 offen offset:1024 sc1
s_sub_u32 s37, s37, 1
s_cbranch_scc1 Lend_1
s_branch Lps_118
Lpf_133:
buffer_load_dwordx4 v[60:63], v11, s[4:7], s40 offen offset:1024 sc1
s_branch Lps_108
Lpf_135:
buffer_load_dwordx4 v[48:51], v11, s[4:7], s40 offen offset:0 sc1
s_sub_u32 s37, s37, 1
s_cbranch_scc1 Lend_1
Lps_142:
s_waitcnt vmcnt(2)
v_max3_u32 v44, v52, v53, v54
v_max_u32 v44, v44, v55
v_cmp_eq_u32 vcc, -1, v44
s_cbranch_vccnz Lpf_143
s_branch Lps_140
Lpf_137:
buffer_load_dwordx4 v[48:51], v11, s[4:7], s40 offen offset:0 sc1
s_sub_u32 s37, s37, 1
s_cbranch_scc1 Lend_1
Lps_144:
s_waitcnt vmcnt(2)
v_max3_u32 v44, v52, v53, v54
v_max_u32 v44, v44, v55
v_cmp_eq_u32 vcc, -1, v44
s_cbranch_vccnz Lpf_145
v_smfmac_f32_16x16x64_bf16 v[72:75], v[52:55], v[104:111], v15
v_mov_b32 v116, v52
v_mov_b32 v117, v53
v_mov_b32 v118, v54
v_mov_b32 v119, v55
s_branch Lpd_107
Lpf_139:
buffer_load_dwordx4 v[48:51], v11, s[4:7], s40 offen offset:0 sc1
s_sub_u32 s37, s37, 1
s_cbranch_scc1 Lend_1
s_branch Lps_114
Lpf_141:
buffer_load_dwordx4 v[56:59], v11, s[4:7], s40 offen offset:0 sc1
s_branch Lps_126
Lpf_143:
buffer_load_dwordx4 v[52:55], v11, s[4:7], s40 offen offset:1024 sc1
Lps_146:
s_waitcnt vmcnt(2)
v_max3_u32 v44, v56, v57, v58
v_max_u32 v44, v44, v59
v_cmp_eq_u32 vcc, -1, v44
s_cbranch_vccnz Lpf_147
v_smfmac_f32_16x16x64_bf16 v[72:75], v[56:59], v[96:103], v15
v_mov_b32 v112, v56
v_mov_b32 v113, v57
v_mov_b32 v114, v58
v_mov_b32 v115, v59
s_branch Lpd_107
Lpf_145:
buffer_load_dwordx4 v[52:55], v11, s[4:7], s40 offen offset:1024 sc1
s_branch Lps_122
Lpf_147:
buffer_load_dwordx4 v[56:59], v11, s[4:7], s40 offen offset:0 sc1
s_branch Lps_134
Lvr_35:
buffer_load_dwordx2 v[120:121], v12, s[4:7], s40 offen sc1
buffer_load_dwordx2 v[122:123], v13, s[4:7], s40 offen sc1
s_sub_u32 s37, s37, 1
s_cbranch_scc1 Lend_1
s_waitcnt vmcnt(0)
v_max3_u32 v44, v120, v121, v122
v_max_u32 v44, v44, v123
v_cmp_eq_u32 vcc, -1, v44
s_cbranch_vccnz Lvr_35
s_branch Lvo_36
Lq_sc1_22:
Lq_148:
s_cmp_gt_u32 s36, 7
s_cbranch_scc1 Lqf_149
s_waitcnt vmcnt(0)
s_barrier
Lqf_149:
ds_read_b128 v[128:131], v22 offset:0
ds_read_b128 v[132:135], v22 offset:1024
ds_read_b128 v[136:139], v22 offset:2048
ds_read_b128 v[140:143], v22 offset:3072
ds_read_b128 v[144:147], v22 offset:4096
ds_read_b128 v[148:151], v22 offset:5120
ds_read_b128 v[152:155], v22 offset:6144
ds_read_b128 v[156:159], v22 offset:7168
ds_read_b128 v[160:163], v24 offset:0
ds_read_b128 v[164:167], v24 offset:1024
ds_read_b128 v[168:171], v25 offset:0
ds_read_b128 v[172:175], v25 offset:1024
ds_read_b128 v[176:179], v23 offset:0
ds_read_b128 v[180:183], v23 offset:1024
ds_read_b128 v[184:187], v23 offset:2048
ds_read_b128 v[188:191], v23 offset:3072
v_xor_b32 v22, 98304, v22
v_xor_b32 v24, 98304, v24
v_xor_b32 v25, 98304, v25
v_xor_b32 v23, 98304, v23
s_mul_i32 m0, s32, 5120
s_and_b32 s38, s36, 3
s_lshl_b32 s39, s38, 16
s_add_u32 s40, s39, s45
s_xor_b32 s42, s40, 0x20000
s_add_u32 s26, s36, 1
v_pk_mul_f32 v[64:65], 0, 0
v_pk_mul_f32 v[66:67], 0, 0
v_pk_mul_f32 v[68:69], 0, 0
v_pk_mul_f32 v[70:71], 0, 0
v_pk_mul_f32 v[72:73], 0, 0
v_pk_mul_f32 v[74:75], 0, 0
v_pk_mul_f32 v[76:77], 0, 0
v_pk_mul_f32 v[78:79], 0, 0
v_pk_mul_f32 v[80:81], 0, 0
v_pk_mul_f32 v[82:83], 0, 0
v_pk_mul_f32 v[84:85], 0, 0
v_pk_mul_f32 v[86:87], 0, 0
v_pk_mul_f32 v[88:89], 0, 0
v_pk_mul_f32 v[90:91], 0, 0
v_pk_mul_f32 v[92:93], 0, 0
v_pk_mul_f32 v[94:95], 0, 0
s_waitcnt vmcnt(0)
buffer_store_dword v197, v199, s[4:7], 0 offen sc1
v_add_u32 v197, 1, v197
s_mov_b64 exec, 15
buffer_load_dword v194, v192, s[4:7], s59 offen sc1
s_nop 11
buffer_load_dword v195, v192, s[4:7], s59 offen sc1
s_nop 11
buffer_load_dword v196, v192, s[4:7], s59 offen sc1
Lft_151:
s_waitcnt vmcnt(2)
v_cmp_gt_u32 vcc, s26, v194
s_cbranch_vccz Lfg_150
buffer_load_dword v194, v192, s[4:7], s59 offen sc1
s_waitcnt vmcnt(2)
v_cmp_gt_u32 vcc, s26, v195
s_cbranch_vccz Lfg_150
buffer_load_dword v195, v192, s[4:7], s59 offen sc1
s_waitcnt vmcnt(2)
v_cmp_gt_u32 vcc, s26, v196
s_cbranch_vccz Lfg_150
buffer_load_dword v196, v192, s[4:7], s59 offen sc1
s_sub_u32 s37, s37, 1
s_cbranch_scc1 Lend_1
s_branch Lft_151
Lfg_150:
s_mov_b64 exec, -1
buffer_load_dwordx4 v[48:51], v10, s[4:7], s40 offen offset:0 sc1
v_mfma_f32_16x16x32_bf16 v[200:203], v[204:207], v[204:207], 0
v_mfma_f32_16x16x32_bf16 v[200:203], v[204:207], v[204:207], 0
v_mfma_f32_16x16x32_bf16 v[200:203], v[204:207], v[204:207], 0
v_mfma_f32_16x16x32_bf16 v[200:203], v[204:207], v[204:207], 0
buffer_load_dwordx4 v[52:55], v10, s[4:7], s40 offen offset:1024 sc1
v_mfma_f32_16x16x32_bf16 v[200:203], v[204:207], v[204:207], 0
v_mfma_f32_16x16x32_bf16 v[200:203], v[204:207], v[204:207], 0
v_mfma_f32_16x16x32_bf16 v[200:203], v[204:207], v[204:207], 0
v_mfma_f32_16x16x32_bf16 v[200:203], v[204:207], v[204:207], 0
buffer_load_dwordx4 v[56:59], v10, s[4:7], s40 offen offset:2048 sc1
v_mfma_f32_16x16x32_bf16 v[200:203], v[204:207], v[204:207], 0
v_mfma_f32_16x16x32_bf16 v[200:203], v[204:207], v[204:207], 0
v_mfma_f32_16x16x32_bf16 v[200:203], v[204:207], v[204:207], 0
v_mfma_f32_16x16x32_bf16 v[200:203], v[204:207], v[204:207], 0
buffer_load_dwordx4 v[60:63], v10, s[4:7], s40 offen offset:3072 sc1
v_mfma_f32_16x16x32_bf16 v[200:203], v[204:207], v[204:207], 0
s_waitcnt vmcnt(3)
v_max3_u32 v44, v48, v49, v50
v_max_u32 v44, v44, v51
v_cmp_eq_u32 vcc, -1, v44
s_cbranch_vccnz Lpf_154
v_smfmac_f32_16x16x64_bf16 v[64:67], v[48:51], a[0:7], v15
v_smfmac_f32_16x16x64_bf16 v[68:71], v[48:51], a[8:15], v15
v_smfmac_f32_16x16x64_bf16 v[72:75], v[48:51], a[16:23], v15
v_smfmac_f32_16x16x64_bf16 v[76:79], v[48:51], a[24:31], v15
v_smfmac_f32_16x16x64_bf16 v[80:83], v[48:51], a[32:39], v15
s_waitcnt vmcnt(2)
v_max3_u32 v44, v52, v53, v54
v_max_u32 v44, v44, v55
v_cmp_eq_u32 vcc, -1, v44
v_smfmac_f32_16x16x64_bf16 v[84:87], v[48:51], a[40:47], v15
v_smfmac_f32_16x16x64_bf16 v[88:91], v[48:51], a[48:55], v15
v_smfmac_f32_16x16x64_bf16 v[92:95], v[48:51], a[56:63], v15
s_cbranch_vccnz Lpf_155
v_smfmac_f32_16x16x64_bf16 v[64:67], v[52:55], a[64:71], v15
v_smfmac_f32_16x16x64_bf16 v[68:71], v[52:55], a[72:79], v15
v_smfmac_f32_16x16x64_bf16 v[72:75], v[52:55], a[80:87], v15
v_smfmac_f32_16x16x64_bf16 v[76:79], v[52:55], a[88:95], v15
v_smfmac_f32_16x16x64_bf16 v[80:83], v[52:55], a[96:103], v15
s_waitcnt vmcnt(1)
v_max3_u32 v44, v56, v57, v58
v_max_u32 v44, v44, v59
v_cmp_eq_u32 vcc, -1, v44
v_smfmac_f32_16x16x64_bf16 v[84:87], v[52:55], a[104:111], v15
v_smfmac_f32_16x16x64_bf16 v[88:91], v[52:55], a[112:119], v15
v_smfmac_f32_16x16x64_bf16 v[92:95], v[52:55], a[120:127], v15
s_cbranch_vccnz Lpf_156
v_smfmac_f32_16x16x64_bf16 v[64:67], v[56:59], a[128:135], v15
v_smfmac_f32_16x16x64_bf16 v[68:71], v[56:59], a[136:143], v15
v_smfmac_f32_16x16x64_bf16 v[72:75], v[56:59], a[144:151], v15
v_smfmac_f32_16x16x64_bf16 v[76:79], v[56:59], a[152:159], v15
v_smfmac_f32_16x16x64_bf16 v[80:83], v[56:59], a[160:167], v15
s_waitcnt vmcnt(0)
v_max3_u32 v44, v60, v61, v62
v_max_u32 v44, v44, v63
v_cmp_eq_u32 vcc, -1, v44
v_smfmac_f32_16x16x64_bf16 v[84:87], v[56:59], a[168:175], v15
v_smfmac_f32_16x16x64_bf16 v[88:91], v[56:59], a[176:183], v15
v_smfmac_f32_16x16x64_bf16 v[92:95], v[56:59], a[184:191], v15
s_cbranch_vccnz Lpf_157
v_smfmac_f32_16x16x64_bf16 v[64:67], v[60:63], a[192:199], v15
v_smfmac_f32_16x16x64_bf16 v[68:71], v[60:63], a[200:207], v15
v_smfmac_f32_16x16x64_bf16 v[72:75], v[60:63], a[208:215], v15
v_smfmac_f32_16x16x64_bf16 v[76:79], v[60:63], a[216:223], v15
v_smfmac_f32_16x16x64_bf16 v[80:83], v[60:63], a[224:231], v15
v_smfmac_f32_16x16x64_bf16 v[84:87], v[60:63], a[232:239], v15
v_smfmac_f32_16x16x64_bf16 v[88:91], v[60:63], a[240:247], v15
v_smfmac_f32_16x16x64_bf16 v[92:95], v[60:63], a[248:255], v15
Lpd_153:
s_nop 0
v_add_f32 v64, v64, v65
v_add_f32 v66, v66, v67
v_add_f32 v68, v68, v69
v_add_f32 v70, v70, v71
v_add_f32 v72, v72, v73
ds_write_addtid_b32 v64 offset:0
v_add_f32 v74, v74, v75
ds_write_addtid_b32 v66 offset:384
v_add_f32 v76, v76, v77
ds_write_addtid_b32 v68 offset:640
v_add_f32 v78, v78, v79
ds_write_addtid_b32 v70 offset:1024
v_add_f32 v80, v80, v81
ds_write_addtid_b32 v72 offset:1280
v_add_f32 v82, v82, v83
ds_write_addtid_b32 v74 offset:1664
v_add_f32 v84, v84, v85
ds_write_addtid_b32 v76 offset:1920
v_add_f32 v86, v86, v87
ds_write_addtid_b32 v78 offset:2304
v_add_f32 v88, v88, v89
ds_write_addtid_b32 v80 offset:2560
v_add_f32 v90, v90, v91
ds_write_addtid_b32 v82 offset:2944
v_add_f32 v92, v92, v93
ds_write_addtid_b32 v84 offset:3200
v_add_f32 v94, v94, v95
ds_write_addtid_b32 v86 offset:3584
ds_write_addtid_b32 v88 offset:3840
ds_write_addtid_b32 v90 offset:4224
ds_write_addtid_b32 v92 offset:4480
ds_write_addtid_b32 v94 offset:4864
Lqj_152:
v_mfma_f32_16x16x32_bf16 v[200:203], v[204:207], v[204:207], 0
v_mfma_f32_16x16x32_bf16 v[200:203], v[204:207], v[204:207], 0
s_waitcnt lgkmcnt(0)
s_barrier
ds_read_b128 v[76:79], v18 offset:0
ds_read_b128 v[80:83], v18 offset:5120
ds_read_b128 v[84:87], v18 offset:10240
ds_read_b128 v[88:91], v18 offset:15360
v_mov_b32 v72, 0
v_mov_b32 v73, 0
v_mov_b32 v74, 0
v_mov_b32 v75, 0
v_mfma_f32_16x16x32_bf16 v[200:203], v[204:207], v[204:207], 0
v_mfma_f32_16x16x32_bf16 v[200:203], v[204:207], v[204:207], 0
s_waitcnt lgkmcnt(0)
v_pk_add_f32 v[76:77], v[76:77], v[80:81]
v_pk_add_f32 v[84:85], v[84:85], v[88:89]
v_pk_add_f32 v[78:79], v[78:79], v[82:83]
v_pk_add_f32 v[86:87], v[86:87], v[90:91]
v_pk_add_f32 v[76:77], v[76:77], v[84:85]
v_pk_add_f32 v[78:79], v[78:79], v[86:87]
v_cvt_pk_bf16_f32 v76, v76, v77
v_cvt_pk_bf16_f32 v77, v78, v79
ds_write_b64 v19, v[76:77] offset:20480
buffer_load_dwordx4 v[112:115], v11, s[4:7], s40 offen offset:0 sc1
buffer_load_dwordx4 v[116:119], v11, s[4:7], s40 offen offset:1024 sc1
v_mfma_f32_16x16x32_bf16 v[200:203], v[204:207], v[204:207], 0
v_mfma_f32_16x16x32_bf16 v[200:203], v[204:207], v[204:207], 0
s_waitcnt lgkmcnt(0)
s_barrier
ds_read_b128 v[96:99], v20 offset:20480
ds_read_b128 v[100:103], v20 offset:20992
ds_read_b128 v[104:107], v20 offset:21504
ds_read_b128 v[108:111], v20 offset:22016
v_mfma_f32_16x16x32_bf16 v[200:203], v[204:207], v[204:207], 0
v_mfma_f32_16x16x32_bf16 v[200:203], v[204:207], v[204:207], 0
s_waitcnt lgkmcnt(3)
v_mfma_f32_16x16x32_bf16 v[64:67], v[128:131], v[96:99], 0
v_mfma_f32_16x16x32_bf16 v[68:71], v[144:147], v[96:99], 0
s_waitcnt lgkmcnt(2)
buffer_load_dwordx4 v[48:51], v11, s[4:7], s40 offen offset:0 sc1
v_mfma_f32_16x16x32_bf16 v[64:67], v[132:135], v[100:103], v[64:67]
v_mfma_f32_16x16x32_bf16 v[68:71], v[148:151], v[100:103], v[68:71]
s_waitcnt lgkmcnt(1)
buffer_load_dwordx4 v[52:55], v11, s[4:7], s40 offen offset:1024 sc1
v_mfma_f32_16x16x32_bf16 v[64:67], v[136:139], v[104:107], v[64:67]
v_mfma_f32_16x16x32_bf16 v[68:71], v[152:155], v[104:107], v[68:71]
s_waitcnt lgkmcnt(0)
s_waitcnt vmcnt(2)
v_max3_u32 v44, v112, v113, v114
v_max3_u32 v44, v44, v115, v116
v_max3_u32 v44, v44, v117, v118
v_max_u32 v44, v44, v119
v_cmp_eq_u32 vcc, -1, v44
v_mfma_f32_16x16x32_bf16 v[64:67], v[140:143], v[108:111], v[64:67]
v_mfma_f32_16x16x32_bf16 v[68:71], v[156:159], v[108:111], v[68:71]
s_cbranch_vccnz Lkr_158
v_smfmac_f32_16x16x64_bf16 v[72:75], v[112:115], v[96:103], v15
v_smfmac_f32_16x16x64_bf16 v[72:75], v[116:119], v[104:111], v15
Lko_159:
s_nop 3
v_max3_f32 v45, v64, v65, v66
v_max3_f32 v45, v45, v67, v68
v_max3_f32 v45, v45, v69, v70
v_max_f32 v45, v45, v71
v_add_f32 v72, v72, v73
v_add_f32 v73, v74, v75
v_max3_f32 v46, v45, v72, v73
v_max3_f32 v47, v45, v72, v73
buffer_load_dwordx2 v[120:121], v12, s[4:7], s40 offen sc1
buffer_load_dwordx2 v[122:123], v13, s[4:7], s40 offen sc1
s_nop 1
v_permlane32_swap_b32 v46, v47
s_nop 0
v_max_f32 v45, v46, v47
v_max_f32 v46, v46, v47
s_nop 1
v_permlane16_swap_b32 v45, v46
s_nop 0
v_max_f32 v45, v45, v46
v_mul_f32 v46, s49, v45
v_pk_fma_f32 v[64:65], v[64:65], s[48:49], v[46:47] op_sel_hi:[1,0,0]
v_pk_fma_f32 v[66:67], v[66:67], s[48:49], v[46:47] op_sel_hi:[1,0,0]
v_pk_fma_f32 v[68:69], v[68:69], s[48:49], v[46:47] op_sel_hi:[1,0,0]
v_pk_fma_f32 v[70:71], v[70:71], s[48:49], v[46:47] op_sel_hi:[1,0,0]
v_pk_fma_f32 v[72:73], v[72:73], s[48:49], v[46:47] op_sel_hi:[1,0,0]
v_exp_f32 v64, v64
v_exp_f32 v65, v65
v_exp_f32 v66, v66
v_exp_f32 v67, v67
v_exp_f32 v68, v68
v_exp_f32 v69, v69
v_exp_f32 v70, v70
v_exp_f32 v71, v71
v_exp_f32 v72, v72
v_exp_f32 v73, v73
buffer_store_dword v197, v193, s[4:7], s59 offen sc1
v_cvt_pk_bf16_f32 v76, v64, v65
v_cvt_pk_bf16_f32 v77, v66, v67
v_cvt_pk_bf16_f32 v78, v68, v69
v_cvt_pk_bf16_f32 v79, v70, v71
v_cvt_pk_bf16_f32 v2, v72, v73
v_cvt_pk_bf16_f32 v7, v72, v73
v_mfma_f32_16x16x32_bf16 v[84:87], v[32:35], v[76:79], 0
v_mfma_f32_16x16x32_bf16 v[96:99], v[160:163], v[76:79], 0
s_waitcnt vmcnt(1)
v_max3_u32 v44, v120, v121, v122
v_max_u32 v44, v44, v123
v_cmp_eq_u32 vcc, -1, v44
v_mfma_f32_16x16x32_bf16 v[100:103], v[164:167], v[76:79], 0
v_mfma_f32_16x16x32_bf16 v[84:87], v[32:35], v[2:5], v[84:87]
s_cbranch_vccnz Lvr_160
Lvo_161:
v_mfma_f32_16x16x32_bf16 v[96:99], v[120:123], v[2:5], v[96:99]
v_mfma_f32_16x16x32_bf16 v[100:103], v[120:123], v[6:9], v[100:103]
v_mfma_f32_16x16x32_bf16 v[200:203], v[204:207], v[204:207], 0
s_nop 4
v_rcp_f32 v46, v84
s_nop 0
v_pk_mul_f32 v[96:97], v[96:97], v[46:47] op_sel_hi:[1,0]
v_pk_mul_f32 v[98:99], v[98:99], v[46:47] op_sel_hi:[1,0]
v_pk_mul_f32 v[100:101], v[100:101], v[46:47] op_sel_hi:[1,0]
v_pk_mul_f32 v[102:103], v[102:103], v[46:47] op_sel_hi:[1,0]
v_cvt_pk_bf16_f32 v124, v96, v97
v_cvt_pk_bf16_f32 v125, v98, v99
v_cvt_pk_bf16_f32 v126, v100, v101
v_cvt_pk_bf16_f32 v127, v102, v103
v_min_u32 v124, -2, v124
v_min_u32 v125, -2, v125
v_min_u32 v126, -2, v126
v_min_u32 v127, -2, v127
buffer_store_dwordx4 v[124:127], v14, s[4:7], s40 offen sc1
s_barrier
buffer_store_dwordx4 v[28:31], v14, s[4:7], s42 offen sc1
s_cmp_ge_u32 s36, 62
s_cbranch_scc1 Lnp_162
Lpa_165:
s_add_u32 s27, s27, 1
v_add_u32 v44, v209, v210
v_cmp_gt_u32 vcc, s27, v44
s_cbranch_vccnz Lpw_163
Lpk_164:
s_mov_b32 m0, s57
s_add_u32 s38, s47, 3072
buffer_load_dwordx4 v21, s[4:7], s47 offen offset:0 sc1 lds
buffer_load_dwordx4 v21, s[4:7], s47 offen offset:1024 sc1 lds
buffer_load_dwordx4 v21, s[4:7], s47 offen offset:2048 sc1 lds
s_add_u32 m0, s57, 3072
s_xor_b32 s57, s57, 98304
buffer_load_dwordx4 v21, s[4:7], s38 offen offset:0 sc1 lds
buffer_load_dwordx4 v21, s[4:7], s38 offen offset:1024 sc1 lds
buffer_load_dwordx4 v21, s[4:7], s38 offen offset:2048 sc1 lds
s_add_u32 s47, s47, 786432
s_cmp_eq_u32 s27, 8
s_cbranch_scc1 Lpa_165
buffer_load_dword v209, v208, s[4:7], 0 offen sc1
s_add_u32 s38, s36, 2
s_and_b32 s38, s38, 3
s_lshl_b32 s88, s38, 18
s_add_u32 s88, s88, s46
s_add_u32 s89, s88, 0x100000
buffer_store_dwordx2 v[28:29], v198, s[4:7], s88 offen sc1
buffer_store_dwordx2 v[28:29], v198, s[4:7], s89 offen sc1
Lnp_162:
v_mov_b32 v72, 0
v_mov_b32 v73, 0
v_mov_b32 v74, 0
v_mov_b32 v75, 0
v_mfma_f32_16x16x32_bf16 v[64:67], v[128:131], v[176:179], v[36:39]
v_mfma_f32_16x16x32_bf16 v[68:71], v[144:147], v[176:179], v[40:43]
v_mfma_f32_16x16x32_bf16 v[64:67], v[132:135], v[180:183], v[64:67]
v_mfma_f32_16x16x32_bf16 v[68:71], v[148:151], v[180:183], v[68:71]
v_mfma_f32_16x16x32_bf16 v[64:67], v[136:139], v[184:187], v[64:67]
v_mfma_f32_16x16x32_bf16 v[68:71], v[152:155], v[184:187], v[68:71]
v_mfma_f32_16x16x32_bf16 v[64:67], v[140:143], v[188:191], v[64:67]
v_mfma_f32_16x16x32_bf16 v[68:71], v[156:159], v[188:191], v[68:71]
v_smfmac_f32_16x16x64_bf16 v[72:75], v[112:115], v[176:183], v15
v_smfmac_f32_16x16x64_bf16 v[72:75], v[116:119], v[184:191], v15
s_and_b32 s38, s36, 7
s_lshl_b32 s38, s38, 18
s_add_u32 s50, s38, 83886080
s_nop 2
v_max3_f32 v45, v64, v65, v66
v_max3_f32 v45, v45, v67, v68
v_max3_f32 v45, v45, v69, v70
v_max_f32 v45, v45, v71
v_add_f32 v72, v72, v73
v_add_f32 v73, v74, v75
v_max3_f32 v46, v45, v72, v73
v_max3_f32 v47, v45, v72, v73
s_nop 1
v_permlane32_swap_b32 v46, v47
s_nop 0
v_max_f32 v45, v46, v47
v_max_f32 v46, v46, v47
s_nop 1
v_permlane16_swap_b32 v45, v46
s_nop 0
v_max_f32 v45, v45, v46
v_mul_f32 v46, s49, v45
v_pk_fma_f32 v[64:65], v[64:65], s[48:49], v[46:47] op_sel_hi:[1,0,0]
v_pk_fma_f32 v[66:67], v[66:67], s[48:49], v[46:47] op_sel_hi:[1,0,0]
v_pk_fma_f32 v[68:69], v[68:69], s[48:49], v[46:47] op_sel_hi:[1,0,0]
v_pk_fma_f32 v[70:71], v[70:71], s[48:49], v[46:47] op_sel_hi:[1,0,0]
v_pk_fma_f32 v[72:73], v[72:73], s[48:49], v[46:47] op_sel_hi:[1,0,0]
v_exp_f32 v64, v64
v_exp_f32 v65, v65
v_exp_f32 v66, v66
v_exp_f32 v67, v67
v_exp_f32 v68, v68
v_exp_f32 v69, v69
v_exp_f32 v70, v70
v_exp_f32 v71, v71
v_exp_f32 v72, v72
v_exp_f32 v73, v73
v_cvt_pk_bf16_f32 v76, v64, v65
v_cvt_pk_bf16_f32 v77, v66, v67
v_cvt_pk_bf16_f32 v78, v68, v69
v_cvt_pk_bf16_f32 v79, v70, v71
v_cvt_pk_bf16_f32 v2, v72, v73
v_cvt_pk_bf16_f32 v7, v72, v73
v_mfma_f32_16x16x32_bf16 v[84:87], v[32:35], v[76:79], 0
v_mfma_f32_16x16x32_bf16 v[96:99], v[160:163], v[76:79], 0
v_mfma_f32_16x16x32_bf16 v[100:103], v[164:167], v[76:79], 0
v_mfma_f32_16x16x32_bf16 v[104:107], v[168:171], v[76:79], 0
v_mfma_f32_16x16x32_bf16 v[108:111], v[172:175], v[76:79], 0
v_mfma_f32_16x16x32_bf16 v[84:87], v[32:35], v[2:5], v[84:87]
v_mfma_f32_16x16x32_bf16 v[96:99], v[120:123], v[2:5], v[96:99]
v_mfma_f32_16x16x32_bf16 v[100:103], v[120:123], v[6:9], v[100:103]
v_mfma_f32_16x16x32_bf16 v[104:107], v[120:123], v[0:3], v[104:107]
v_mfma_f32_16x16x32_bf16 v[108:111], v[120:123], v[4:7], v[108:111]
v_mfma_f32_16x16x32_bf16 v[200:203], v[204:207], v[204:207], 0
s_nop 2
v_rcp_f32 v46, v84
s_nop 0
v_pk_mul_f32 v[96:97], v[96:97], v[46:47] op_sel_hi:[1,0]
v_pk_mul_f32 v[98:99], v[98:99], v[46:47] op_sel_hi:[1,0]
v_pk_mul_f32 v[100:101], v[100:101], v[46:47] op_sel_hi:[1,0]
v_pk_mul_f32 v[102:103], v[102:103], v[46:47] op_sel_hi:[1,0]
v_pk_mul_f32 v[104:105], v[104:105], v[46:47] op_sel_hi:[1,0]
v_pk_mul_f32 v[106:107], v[106:107], v[46:47] op_sel_hi:[1,0]
v_pk_mul_f32 v[108:109], v[108:109], v[46:47] op_sel_hi:[1,0]
v_pk_mul_f32 v[110:111], v[110:111], v[46:47] op_sel_hi:[1,0]
v_cvt_pk_bf16_f32 v96, v96, v97
v_cvt_pk_bf16_f32 v97, v98, v99
v_cvt_pk_bf16_f32 v98, v100, v101
v_cvt_pk_bf16_f32 v99, v102, v103
v_cvt_pk_bf16_f32 v100, v104, v105
v_cvt_pk_bf16_f32 v101, v106, v107
v_cvt_pk_bf16_f32 v102, v108, v109
v_cvt_pk_bf16_f32 v103, v110, v111
buffer_store_dwordx4 v[96:99], v26, s[4:7], s50 offen sc1
buffer_store_dwordx4 v[100:103], v27, s[4:7], s50 offen sc1
s_add_u32 s36, s36, 1
s_cmp_lt_u32 s36, 64
s_cbranch_scc1 Lq_148
s_waitcnt vmcnt(0)
buffer_store_dword v197, v199, s[4:7], 0 offen sc1
s_branch Lend_1
Lpw_163:
Lbw_166:
buffer_load_dword v209, v208, s[4:7], 0 offen sc1
s_waitcnt vmcnt(0)
v_add_u32 v44, v209, v210
v_cmp_gt_u32 vcc, s27, v44
s_cbranch_vccz Lbo_167
s_sub_u32 s37, s37, 1
s_cbranch_scc1 Lend_1
s_sleep 2
s_branch Lbw_166
Lbo_167:
s_branch Lpk_164
Lpf_154:
buffer_load_dwordx4 v[48:51], v10, s[4:7], s40 offen offset:0 sc1
v_mfma_f32_16x16x32_bf16 v[200:203], v[204:207], v[204:207], 0
s_sub_u32 s37, s37, 1
s_cbranch_scc1 Lend_1
Lps_168:
s_waitcnt vmcnt(3)
v_max3_u32 v44, v52, v53, v54
v_max_u32 v44, v44, v55
v_cmp_eq_u32 vcc, -1, v44
s_cbranch_vccnz Lpf_169
v_smfmac_f32_16x16x64_bf16 v[64:67], v[52:55], a[64:71], v15
v_smfmac_f32_16x16x64_bf16 v[68:71], v[52:55], a[72:79], v15
v_smfmac_f32_16x16x64_bf16 v[72:75], v[52:55], a[80:87], v15
v_smfmac_f32_16x16x64_bf16 v[76:79], v[52:55], a[88:95], v15
v_smfmac_f32_16x16x64_bf16 v[80:83], v[52:55], a[96:103], v15
v_smfmac_f32_16x16x64_bf16 v[84:87], v[52:55], a[104:111], v15
v_smfmac_f32_16x16x64_bf16 v[88:91], v[52:55], a[112:119], v15
v_smfmac_f32_16x16x64_bf16 v[92:95], v[52:55], a[120:127], v15
Lps_170:
s_waitcnt vmcnt(2)
v_max3_u32 v44, v56, v57, v58
v_max_u32 v44, v44, v59
v_cmp_eq_u32 vcc, -1, v44
s_cbranch_vccnz Lpf_171
v_smfmac_f32_16x16x64_bf16 v[64:67], v[56:59], a[128:135], v15
v_smfmac_f32_16x16x64_bf16 v[68:71], v[56:59], a[136:143], v15
v_smfmac_f32_16x16x64_bf16 v[72:75], v[56:59], a[144:151], v15
v_smfmac_f32_16x16x64_bf16 v[76:79], v[56:59], a[152:159], v15
v_smfmac_f32_16x16x64_bf16 v[80:83], v[56:59], a[160:167], v15
v_smfmac_f32_16x16x64_bf16 v[84:87], v[56:59], a[168:175], v15
v_smfmac_f32_16x16x64_bf16 v[88:91], v[56:59], a[176:183], v15
v_smfmac_f32_16x16x64_bf16 v[92:95], v[56:59], a[184:191], v15
Lps_172:
s_waitcnt vmcnt(1)
v_max3_u32 v44, v60, v61, v62
v_max_u32 v44, v44, v63
v_cmp_eq_u32 vcc, -1, v44
s_cbranch_vccnz Lpf_173
v_smfmac_f32_16x16x64_bf16 v[64:67], v[60:63], a[192:199], v15
v_smfmac_f32_16x16x64_bf16 v[68:71], v[60:63], a[200:207], v15
v_smfmac_f32_16x16x64_bf16 v[72:75], v[60:63], a[208:215], v15
v_smfmac_f32_16x16x64_bf16 v[76:79], v[60:63], a[216:223], v15
v_smfmac_f32_16x16x64_bf16 v[80:83], v[60:63], a[224:231], v15
v_smfmac_f32_16x16x64_bf16 v[84:87], v[60:63], a[232:239], v15
v_smfmac_f32_16x16x64_bf16 v[88:91], v[60:63], a[240:247], v15
v_smfmac_f32_16x16x64_bf16 v[92:95], v[60:63], a[248:255], v15
Lps_174:
s_waitcnt vmcnt(0)
v_max3_u32 v44, v48, v49, v50
v_max_u32 v44, v44, v51
v_cmp_eq_u32 vcc, -1, v44
s_cbranch_vccnz Lpf_175
v_smfmac_f32_16x16x64_bf16 v[64:67], v[48:51], a[0:7], v15
v_smfmac_f32_16x16x64_bf16 v[68:71], v[48:51], a[8:15], v15
v_smfmac_f32_16x16x64_bf16 v[72:75], v[48:51], a[16:23], v15
v_smfmac_f32_16x16x64_bf16 v[76:79], v[48:51], a[24:31], v15
v_smfmac_f32_16x16x64_bf16 v[80:83], v[48:51], a[32:39], v15
v_smfmac_f32_16x16x64_bf16 v[84:87], v[48:51], a[40:47], v15
v_smfmac_f32_16x16x64_bf16 v[88:91], v[48:51], a[48:55], v15
v_smfmac_f32_16x16x64_bf16 v[92:95], v[48:51], a[56:63], v15
s_branch Lpd_153
Lpf_155:
buffer_load_dwordx4 v[52:55], v10, s[4:7], s40 offen offset:1024 sc1
v_mfma_f32_16x16x32_bf16 v[200:203], v[204:207], v[204:207], 0
s_sub_u32 s37, s37, 1
s_cbranch_scc1 Lend_1
Lps_176:
s_waitcnt vmcnt(2)
v_max3_u32 v44, v56, v57, v58
v_max_u32 v44, v44, v59
v_cmp_eq_u32 vcc, -1, v44
s_cbranch_vccnz Lpf_177
v_smfmac_f32_16x16x64_bf16 v[64:67], v[56:59], a[128:135], v15
v_smfmac_f32_16x16x64_bf16 v[68:71], v[56:59], a[136:143], v15
v_smfmac_f32_16x16x64_bf16 v[72:75], v[56:59], a[144:151], v15
v_smfmac_f32_16x16x64_bf16 v[76:79], v[56:59], a[152:159], v15
v_smfmac_f32_16x16x64_bf16 v[80:83], v[56:59], a[160:167], v15
v_smfmac_f32_16x16x64_bf16 v[84:87], v[56:59], a[168:175], v15
v_smfmac_f32_16x16x64_bf16 v[88:91], v[56:59], a[176:183], v15
v_smfmac_f32_16x16x64_bf16 v[92:95], v[56:59], a[184:191], v15
Lps_178:
s_waitcnt vmcnt(1)
v_max3_u32 v44, v60, v61, v62
v_max_u32 v44, v44, v63
v_cmp_eq_u32 vcc, -1, v44
s_cbranch_vccnz Lpf_179
v_smfmac_f32_16x16x64_bf16 v[64:67], v[60:63], a[192:199], v15
v_smfmac_f32_16x16x64_bf16 v[68:71], v[60:63], a[200:207], v15
v_smfmac_f32_16x16x64_bf16 v[72:75], v[60:63], a[208:215], v15
v_smfmac_f32_16x16x64_bf16 v[76:79], v[60:63], a[216:223], v15
v_smfmac_f32_16x16x64_bf16 v[80:83], v[60:63], a[224:231], v15
v_smfmac_f32_16x16x64_bf16 v[84:87], v[60:63], a[232:239], v15
v_smfmac_f32_16x16x64_bf16 v[88:91], v[60:63], a[240:247], v15
v_smfmac_f32_16x16x64_bf16 v[92:95], v[60:63], a[248:255], v15
Lps_180:
s_waitcnt vmcnt(0)
v_max3_u32 v44, v52, v53, v54
v_max_u32 v44, v44, v55
v_cmp_eq_u32 vcc, -1, v44
s_cbranch_vccnz Lpf_181
v_smfmac_f32_16x16x64_bf16 v[64:67], v[52:55], a[64:71], v15
v_smfmac_f32_16x16x64_bf16 v[68:71], v[52:55], a[72:79], v15
v_smfmac_f32_16x16x64_bf16 v[72:75], v[52:55], a[80:87], v15
v_smfmac_f32_16x16x64_bf16 v[76:79], v[52:55], a[88:95], v15
v_smfmac_f32_16x16x64_bf16 v[80:83], v[52:55], a[96:103], v15
v_smfmac_f32_16x16x64_bf16 v[84:87], v[52:55], a[104:111], v15
v_smfmac_f32_16x16x64_bf16 v[88:91], v[52:55], a[112:119], v15
v_smfmac_f32_16x16x64_bf16 v[92:95], v[52:55], a[120:127], v15
s_branch Lpd_153
Lpf_156:
buffer_load_dwordx4 v[56:59], v10, s[4:7], s40 offen offset:2048 sc1
v_mfma_f32_16x16x32_bf16 v[200:203], v[204:207], v[204:207], 0
s_sub_u32 s37, s37, 1
s_cbranch_scc1 Lend_1
Lps_182:
s_waitcnt vmcnt(1)
v_max3_u32 v44, v60, v61, v62
v_max_u32 v44, v44, v63
v_cmp_eq_u32 vcc, -1, v44
s_cbranch_vccnz Lpf_183
v_smfmac_f32_16x16x64_bf16 v[64:67], v[60:63], a[192:199], v15
v_smfmac_f32_16x16x64_bf16 v[68:71], v[60:63], a[200:207], v15
v_smfmac_f32_16x16x64_bf16 v[72:75], v[60:63], a[208:215], v15
v_smfmac_f32_16x16x64_bf16 v[76:79], v[60:63], a[216:223], v15
v_smfmac_f32_16x16x64_bf16 v[80:83], v[60:63], a[224:231], v15
v_smfmac_f32_16x16x64_bf16 v[84:87], v[60:63], a[232:239], v15
v_smfmac_f32_16x16x64_bf16 v[88:91], v[60:63], a[240:247], v15
v_smfmac_f32_16x16x64_bf16 v[92:95], v[60:63], a[248:255], v15
Lps_184:
s_waitcnt vmcnt(0)
v_max3_u32 v44, v56, v57, v58
v_max_u32 v44, v44, v59
v_cmp_eq_u32 vcc, -1, v44
s_cbranch_vccnz Lpf_185
v_smfmac_f32_16x16x64_bf16 v[64:67], v[56:59], a[128:135], v15
v_smfmac_f32_16x16x64_bf16 v[68:71], v[56:59], a[136:143], v15
v_smfmac_f32_16x16x64_bf16 v[72:75], v[56:59], a[144:151], v15
v_smfmac_f32_16x16x64_bf16 v[76:79], v[56:59], a[152:159], v15
v_smfmac_f32_16x16x64_bf16 v[80:83], v[56:59], a[160:167], v15
v_smfmac_f32_16x16x64_bf16 v[84:87], v[56:59], a[168:175], v15
v_smfmac_f32_16x16x64_bf16 v[88:91], v[56:59], a[176:183], v15
v_smfmac_f32_16x16x64_bf16 v[92:95], v[56:59], a[184:191], v15
s_branch Lpd_153
Lpf_157:
buffer_load_dwordx4 v[60:63], v10, s[4:7], s40 offen offset:3072 sc1
v_mfma_f32_16x16x32_bf16 v[200:203], v[204:207], v[204:207], 0
s_sub_u32 s37, s37, 1
s_cbranch_scc1 Lend_1
Lps_186:
s_waitcnt vmcnt(0)
v_max3_u32 v44, v60, v61, v62
v_max_u32 v44, v44, v63
v_cmp_eq_u32 vcc, -1, v44
s_cbranch_vccnz Lpf_187
v_smfmac_f32_16x16x64_bf16 v[64:67], v[60:63], a[192:199], v15
v_smfmac_f32_16x16x64_bf16 v[68:71], v[60:63], a[200:207], v15
v_smfmac_f32_16x16x64_bf16 v[72:75], v[60:63], a[208:215], v15
v_smfmac_f32_16x16x64_bf16 v[76:79], v[60:63], a[216:223], v15
v_smfmac_f32_16x16x64_bf16 v[80:83], v[60:63], a[224:231], v15
v_smfmac_f32_16x16x64_bf16 v[84:87], v[60:63], a[232:239], v15
v_smfmac_f32_16x16x64_bf16 v[88:91], v[60:63], a[240:247], v15
v_smfmac_f32_16x16x64_bf16 v[92:95], v[60:63], a[248:255], v15
s_branch Lpd_153
Lpf_169:
buffer_load_dwordx4 v[52:55], v10, s[4:7], s40 offen offset:1024 sc1
v_mfma_f32_16x16x32_bf16 v[200:203], v[204:207], v[204:207], 0
Lps_188:
s_waitcnt vmcnt(3)
v_max3_u32 v44, v56, v57, v58
v_max_u32 v44, v44, v59
v_cmp_eq_u32 vcc, -1, v44
s_cbranch_vccnz Lpf_189
v_smfmac_f32_16x16x64_bf16 v[64:67], v[56:59], a[128:135], v15
v_smfmac_f32_16x16x64_bf16 v[68:71], v[56:59], a[136:143], v15
v_smfmac_f32_16x16x64_bf16 v[72:75], v[56:59], a[144:151], v15
v_smfmac_f32_16x16x64_bf16 v[76:79], v[56:59], a[152:159], v15
v_smfmac_f32_16x16x64_bf16 v[80:83], v[56:59], a[160:167], v15
v_smfmac_f32_16x16x64_bf16 v[84:87], v[56:59], a[168:175], v15
v_smfmac_f32_16x16x64_bf16 v[88:91], v[56:59], a[176:183], v15
v_smfmac_f32_16x16x64_bf16 v[92:95], v[56:59], a[184:191], v15
Lps_190:
s_waitcnt vmcnt(2)
v_max3_u32 v44, v60, v61, v62
v_max_u32 v44, v44, v63
v_cmp_eq_u32 vcc, -1, v44
s_cbranch_vccnz Lpf_191
v_smfmac_f32_16x16x64_bf16 v[64:67], v[60:63], a[192:199], v15
v_smfmac_f32_16x16x64_bf16 v[68:71], v[60:63], a[200:207], v15
v_smfmac_f32_16x16x64_bf16 v[72:75], v[60:63], a[208:215], v15
v_smfmac_f32_16x16x64_bf16 v[76:79], v[60:63], a[216:223], v15
v_smfmac_f32_16x16x64_bf16 v[80:83], v[60:63], a[224:231], v15
v_smfmac_f32_16x16x64_bf16 v[84:87], v[60:63], a[232:239], v15
v_smfmac_f32_16x16x64_bf16 v[88:91], v[60:63], a[240:247], v15
v_smfmac_f32_16x16x64_bf16 v[92:95], v[60:63], a[248:255], v15
Lps_192:
s_waitcnt vmcnt(1)
v_max3_u32 v44, v48, v49, v50
v_max_u32 v44, v44, v51
v_cmp_eq_u32 vcc, -1, v44
s_cbranch_vccnz Lpf_193
v_smfmac_f32_16x16x64_bf16 v[64:67], v[48:51], a[0:7], v15
v_smfmac_f32_16x16x64_bf16 v[68:71], v[48:51], a[8:15], v15
v_smfmac_f32_16x16x64_bf16 v[72:75], v[48:51], a[16:23], v15
v_smfmac_f32_16x16x64_bf16 v[76:79], v[48:51], a[24:31], v15
v_smfmac_f32_16x16x64_bf16 v[80:83], v[48:51], a[32:39], v15
v_smfmac_f32_16x16x64_bf16 v[84:87], v[48:51], a[40:47], v15
v_smfmac_f32_16x16x64_bf16 v[88:91], v[48:51], a[48:55], v15
v_smfmac_f32_16x16x64_bf16 v[92:95], v[48:51], a[56:63], v15
s_branch Lps_180
Lpf_171:
buffer_load_dwordx4 v[56:59], v10, s[4:7], s40 offen offset:2048 sc1
v_mfma_f32_16x16x32_bf16 v[200:203], v[204:207], v[204:207], 0
Lps_194:
s_waitcnt vmcnt(2)
v_max3_u32 v44, v60, v61, v62
v_max_u32 v44, v44, v63
v_cmp_eq_u32 vcc, -1, v44
s_cbranch_vccnz Lpf_195
v_smfmac_f32_16x16x64_bf16 v[64:67], v[60:63], a[192:199], v15
v_smfmac_f32_16x16x64_bf16 v[68:71], v[60:63], a[200:207], v15
v_smfmac_f32_16x16x64_bf16 v[72:75], v[60:63], a[208:215], v15
v_smfmac_f32_16x16x64_bf16 v[76:79], v[60:63], a[216:223], v15
v_smfmac_f32_16x16x64_bf16 v[80:83], v[60:63], a[224:231], v15
v_smfmac_f32_16x16x64_bf16 v[84:87], v[60:63], a[232:239], v15
v_smfmac_f32_16x16x64_bf16 v[88:91], v[60:63], a[240:247], v15
v_smfmac_f32_16x16x64_bf16 v[92:95], v[60:63], a[248:255], v15
Lps_196:
s_waitcnt vmcnt(1)
v_max3_u32 v44, v48, v49, v50
v_max_u32 v44, v44, v51
v_cmp_eq_u32 vcc, -1, v44
s_cbranch_vccnz Lpf_197
v_smfmac_f32_16x16x64_bf16 v[64:67], v[48:51], a[0:7], v15
v_smfmac_f32_16x16x64_bf16 v[68:71], v[48:51], a[8:15], v15
v_smfmac_f32_16x16x64_bf16 v[72:75], v[48:51], a[16:23], v15
v_smfmac_f32_16x16x64_bf16 v[76:79], v[48:51], a[24:31], v15
v_smfmac_f32_16x16x64_bf16 v[80:83], v[48:51], a[32:39], v15
v_smfmac_f32_16x16x64_bf16 v[84:87], v[48:51], a[40:47], v15
v_smfmac_f32_16x16x64_bf16 v[88:91], v[48:51], a[48:55], v15
v_smfmac_f32_16x16x64_bf16 v[92:95], v[48:51], a[56:63], v15
s_branch Lps_184
Lpf_173:
buffer_load_dwordx4 v[60:63], v10, s[4:7], s40 offen offset:3072 sc1
v_mfma_f32_16x16x32_bf16 v[200:203], v[204:207], v[204:207], 0
Lps_198:
s_waitcnt vmcnt(1)
v_max3_u32 v44, v48, v49, v50
v_max_u32 v44, v44, v51
v_cmp_eq_u32 vcc, -1, v44
s_cbranch_vccnz Lpf_199
v_smfmac_f32_16x16x64_bf16 v[64:67], v[48:51], a[0:7], v15
v_smfmac_f32_16x16x64_bf16 v[68:71], v[48:51], a[8:15], v15
v_smfmac_f32_16x16x64_bf16 v[72:75], v[48:51], a[16:23], v15
v_smfmac_f32_16x16x64_bf16 v[76:79], v[48:51], a[24:31], v15
v_smfmac_f32_16x16x64_bf16 v[80:83], v[48:51], a[32:39], v15
v_smfmac_f32_16x16x64_bf16 v[84:87], v[48:51], a[40:47], v15
v_smfmac_f32_16x16x64_bf16 v[88:91], v[48:51], a[48:55], v15
v_smfmac_f32_16x16x64_bf16 v[92:95], v[48:51], a[56:63], v15
s_branch Lps_186
Lpf_175:
buffer_load_dwordx4 v[48:51], v10, s[4:7], s40 offen offset:0 sc1
v_mfma_f32_16x16x32_bf16 v[200:203], v[204:207], v[204:207], 0
s_sub_u32 s37, s37, 1
s_cbranch_scc1 Lend_1
s_branch Lps_174
Lpf_177:
buffer_load_dwordx4 v[56:59], v10, s[4:7], s40 offen offset:2048 sc1
v_mfma_f32_16x16x32_bf16 v[200:203], v[204:207], v[204:207], 0
Lps_200:
s_waitcnt vmcnt(2)
v_max3_u32 v44, v60, v61, v62
v_max_u32 v44, v44, v63
v_cmp_eq_u32 vcc, -1, v44
s_cbranch_vccnz Lpf_201
v_smfmac_f32_16x16x64_bf16 v[64:67], v[60:63], a[192:199], v15
v_smfmac_f32_16x16x64_bf16 v[68:71], v[60:63], a[200:207], v15
v_smfmac_f32_16x16x64_bf16 v[72:75], v[60:63], a[208:215], v15
v_smfmac_f32_16x16x64_bf16 v[76:79], v[60:63], a[216:223], v15
v_smfmac_f32_16x16x64_bf16 v[80:83], v[60:63], a[224:231], v15
v_smfmac_f32_16x16x64_bf16 v[84:87], v[60:63], a[232:239], v15
v_smfmac_f32_16x16x64_bf16 v[88:91], v[60:63], a[240:247], v15
v_smfmac_f32_16x16x64_bf16 v[92:95], v[60:63], a[248:255], v15
Lps_202:
s_waitcnt vmcnt(1)
v_max3_u32 v44, v52, v53, v54
v_max_u32 v44, v44, v55
v_cmp_eq_u32 vcc, -1, v44
s_cbranch_vccnz Lpf_203
v_smfmac_f32_16x16x64_bf16 v[64:67], v[52:55], a[64:71], v15
v_smfmac_f32_16x16x64_bf16 v[68:71], v[52:55], a[72:79], v15
v_smfmac_f32_16x16x64_bf16 v[72:75], v[52:55], a[80:87], v15
v_smfmac_f32_16x16x64_bf16 v[76:79], v[52:55], a[88:95], v15
v_smfmac_f32_16x16x64_bf16 v[80:83], v[52:55], a[96:103], v15
v_smfmac_f32_16x16x64_bf16 v[84:87], v[52:55], a[104:111], v15
v_smfmac_f32_16x16x64_bf16 v[88:91], v[52:55], a[112:119], v15
v_smfmac_f32_16x16x64_bf16 v[92:95], v[52:55], a[120:127], v15
s_branch Lps_184
Lpf_179:
buffer_load_dwordx4 v[60:63], v10, s[4:7], s40 offen offset:3072 sc1
v_mfma_f32_16x16x32_bf16 v[200:203], v[204:207], v[204:207], 0
Lps_204:
s_waitcnt vmcnt(1)
v_max3_u32 v44, v52, v53, v54
v_max_u32 v44, v44, v55
v_cmp_eq_u32 vcc, -1, v44
s_cbranch_vccnz Lpf_205
v_smfmac_f32_16x16x64_bf16 v[64:67], v[52:55], a[64:71], v15
v_smfmac_f32_16x16x64_bf16 v[68:71], v[52:55], a[72:79], v15
v_smfmac_f32_16x16x64_bf16 v[72:75], v[52:55], a[80:87], v15
v_smfmac_f32_16x16x64_bf16 v[76:79], v[52:55], a[88:95], v15
v_smfmac_f32_16x16x64_bf16 v[80:83], v[52:55], a[96:103], v15
v_smfmac_f32_16x16x64_bf16 v[84:87], v[52:55], a[104:111], v15
v_smfmac_f32_16x16x64_bf16 v[88:91], v[52:55], a[112:119], v15
v_smfmac_f32_16x16x64_bf16 v[92:95], v[52:55], a[120:127], v15
s_branch Lps_186
Lpf_181:
buffer_load_dwordx4 v[52:55], v10, s[4:7], s40 offen offset:1024 sc1
v_mfma_f32_16x16x32_bf16 v[200:203], v[204:207], v[204:207], 0
s_sub_u32 s37, s37, 1
s_cbranch_scc1 Lend_1
s_branch Lps_180
Lpf_183:
buffer_load_dwordx4 v[60:63], v10, s[4:7], s40 offen offset:3072 sc1
v_mfma_f32_16x16x32_bf16 v[200:203], v[204:207], v[204:207], 0
Lps_206:
s_waitcnt vmcnt(1)
v_max3_u32 v44, v56, v57, v58
v_max_u32 v44, v44, v59
v_cmp_eq_u32 vcc, -1, v44
s_cbranch_vccnz Lpf_207
v_smfmac_f32_16x16x64_bf16 v[64:67], v[56:59], a[128:135], v15
v_smfmac_f32_16x16x64_bf16 v[68:71], v[56:59], a[136:143], v15
v_smfmac_f32_16x16x64_bf16 v[72:75], v[56:59], a[144:151], v15
v_smfmac_f32_16x16x64_bf16 v[76:79], v[56:59], a[152:159], v15
v_smfmac_f32_16x16x64_bf16 v[80:83], v[56:59], a[160:167], v15
v_smfmac_f32_16x16x64_bf16 v[84:87], v[56:59], a[168:175], v15
v_smfmac_f32_16x16x64_bf16 v[88:91], v[56:59], a[176:183], v15
v_smfmac_f32_16x16x64_bf16 v[92:95], v[56:59], a[184:191], v15
s_branch Lps_186
Lpf_185:
buffer_load_dwordx4 v[56:59], v10, s[4:7], s40 offen offset:2048 sc1
v_mfma_f32_16x16x32_bf16 v[200:203], v[204:207], v[204:207], 0
s_sub_u32 s37, s37, 1
s_cbranch_scc1 Lend_1
s_branch Lps_184
Lpf_187:
buffer_load_dwordx4 v[60:63], v10, s[4:7], s40 offen offset:3072 sc1
v_mfma_f32_16x16x32_bf16 v[200:203], v[204:207], v[204:207], 0
s_sub_u32 s37, s37, 1
s_cbranch_scc1 Lend_1
s_branch Lps_186
Lpf_189:
buffer_load_dwordx4 v[56:59], v10, s[4:7], s40 offen offset:2048 sc1
v_mfma_f32_16x16x32_bf16 v[200:203], v[204:207], v[204:207], 0
Lps_208:
s_waitcnt vmcnt(3)
v_max3_u32 v44, v60, v61, v62
v_max_u32 v44, v44, v63
v_cmp_eq_u32 vcc, -1, v44
s_cbranch_vccnz Lpf_209
v_smfmac_f32_16x16x64_bf16 v[64:67], v[60:63], a[192:199], v15
v_smfmac_f32_16x16x64_bf16 v[68:71], v[60:63], a[200:207], v15
v_smfmac_f32_16x16x64_bf16 v[72:75], v[60:63], a[208:215], v15
v_smfmac_f32_16x16x64_bf16 v[76:79], v[60:63], a[216:223], v15
v_smfmac_f32_16x16x64_bf16 v[80:83], v[60:63], a[224:231], v15
v_smfmac_f32_16x16x64_bf16 v[84:87], v[60:63], a[232:239], v15
v_smfmac_f32_16x16x64_bf16 v[88:91], v[60:63], a[240:247], v15
v_smfmac_f32_16x16x64_bf16 v[92:95], v[60:63], a[248:255], v15
Lps_210:
s_waitcnt vmcnt(2)
v_max3_u32 v44, v48, v49, v50
v_max_u32 v44, v44, v51
v_cmp_eq_u32 vcc, -1, v44
s_cbranch_vccnz Lpf_211
v_smfmac_f32_16x16x64_bf16 v[64:67], v[48:51], a[0:7], v15
v_smfmac_f32_16x16x64_bf16 v[68:71], v[48:51], a[8:15], v15
v_smfmac_f32_16x16x64_bf16 v[72:75], v[48:51], a[16:23], v15
v_smfmac_f32_16x16x64_bf16 v[76:79], v[48:51], a[24:31], v15
v_smfmac_f32_16x16x64_bf16 v[80:83], v[48:51], a[32:39], v15
v_smfmac_f32_16x16x64_bf16 v[84:87], v[48:51], a[40:47], v15
v_smfmac_f32_16x16x64_bf16 v[88:91], v[48:51], a[48:55], v15
v_smfmac_f32_16x16x64_bf16 v[92:95], v[48:51], a[56:63], v15
s_branch Lps_202
Lpf_191:
buffer_load_dwordx4 v[60:63], v10, s[4:7], s40 offen offset:3072 sc1
v_mfma_f32_16x16x32_bf16 v[200:203], v[204:207], v[204:207], 0
Lps_212:
s_waitcnt vmcnt(2)
v_max3_u32 v44, v48, v49, v50
v_max_u32 v44, v44, v51
v_cmp_eq_u32 vcc, -1, v44
s_cbranch_vccnz Lpf_213
v_smfmac_f32_16x16x64_bf16 v[64:67], v[48:51], a[0:7], v15
v_smfmac_f32_16x16x64_bf16 v[68:71], v[48:51], a[8:15], v15
v_smfmac_f32_16x16x64_bf16 v[72:75], v[48:51], a[16:23], v15
v_smfmac_f32_16x16x64_bf16 v[76:79], v[48:51], a[24:31], v15
v_smfmac_f32_16x16x64_bf16 v[80:83], v[48:51], a[32:39], v15
v_smfmac_f32_16x16x64_bf16 v[84:87], v[48:51], a[40:47], v15
v_smfmac_f32_16x16x64_bf16 v[88:91], v[48:51], a[48:55], v15
v_smfmac_f32_16x16x64_bf16 v[92:95], v[48:51], a[56:63], v15
s_branch Lps_204
Lpf_193:
buffer_load_dwordx4 v[48:51], v10, s[4:7], s40 offen offset:0 sc1
v_mfma_f32_16x16x32_bf16 v[200:203], v[204:207], v[204:207], 0
s_sub_u32 s37, s37, 1
s_cbranch_scc1 Lend_1
Lps_214:
s_waitcnt vmcnt(1)
v_max3_u32 v44, v52, v53, v54
v_max_u32 v44, v44, v55
v_cmp_eq_u32 vcc, -1, v44
s_cbranch_vccnz Lpf_215
v_smfmac_f32_16x16x64_bf16 v[64:67], v[52:55], a[64:71], v15
v_smfmac_f32_16x16x64_bf16 v[68:71], v[52:55], a[72:79], v15
v_smfmac_f32_16x16x64_bf16 v[72:75], v[52:55], a[80:87], v15
v_smfmac_f32_16x16x64_bf16 v[76:79], v[52:55], a[88:95], v15
v_smfmac_f32_16x16x64_bf16 v[80:83], v[52:55], a[96:103], v15
v_smfmac_f32_16x16x64_bf16 v[84:87], v[52:55], a[104:111], v15
v_smfmac_f32_16x16x64_bf16 v[88:91], v[52:55], a[112:119], v15
v_smfmac_f32_16x16x64_bf16 v[92:95], v[52:55], a[120:127], v15
s_branch Lps_174
Lpf_195:
buffer_load_dwordx4 v[60:63], v10, s[4:7], s40 offen offset:3072 sc1
v_mfma_f32_16x16x32_bf16 v[200:203], v[204:207], v[204:207], 0
Lps_216:
s_waitcnt vmcnt(2)
v_max3_u32 v44, v48, v49, v50
v_max_u32 v44, v44, v51
v_cmp_eq_u32 vcc, -1, v44
s_cbranch_vccnz Lpf_217
v_smfmac_f32_16x16x64_bf16 v[64:67], v[48:51], a[0:7], v15
v_smfmac_f32_16x16x64_bf16 v[68:71], v[48:51], a[8:15], v15
v_smfmac_f32_16x16x64_bf16 v[72:75], v[48:51], a[16:23], v15
v_smfmac_f32_16x16x64_bf16 v[76:79], v[48:51], a[24:31], v15
v_smfmac_f32_16x16x64_bf16 v[80:83], v[48:51], a[32:39], v15
v_smfmac_f32_16x16x64_bf16 v[84:87], v[48:51], a[40:47], v15
v_smfmac_f32_16x16x64_bf16 v[88:91], v[48:51], a[48:55], v15
v_smfmac_f32_16x16x64_bf16 v[92:95], v[48:51], a[56:63], v15
s_branch Lps_206
Lpf_197:
buffer_load_dwordx4 v[48:51], v10, s[4:7], s40 offen offset:0 sc1
v_mfma_f32_16x16x32_bf16 v[200:203], v[204:207], v[204:207], 0
s_sub_u32 s37, s37, 1
s_cbranch_scc1 Lend_1
Lps_218:
s_waitcnt vmcnt(1)
v_max3_u32 v44, v56, v57, v58
v_max_u32 v44, v44, v59
v_cmp_eq_u32 vcc, -1, v44
s_cbranch_vccnz Lpf_219
v_smfmac_f32_16x16x64_bf16 v[64:67], v[56:59], a[128:135], v15
v_smfmac_f32_16x16x64_bf16 v[68:71], v[56:59], a[136:143], v15
v_smfmac_f32_16x16x64_bf16 v[72:75], v[56:59], a[144:151], v15
v_smfmac_f32_16x16x64_bf16 v[76:79], v[56:59], a[152:159], v15
v_smfmac_f32_16x16x64_bf16 v[80:83], v[56:59], a[160:167], v15
v_smfmac_f32_16x16x64_bf16 v[84:87], v[56:59], a[168:175], v15
v_smfmac_f32_16x16x64_bf16 v[88:91], v[56:59], a[176:183], v15
v_smfmac_f32_16x16x64_bf16 v[92:95], v[56:59], a[184:191], v15
s_branch Lps_174
Lpf_199:
buffer_load_dwordx4 v[48:51], v10, s[4:7], s40 offen offset:0 sc1
v_mfma_f32_16x16x32_bf16 v[200:203], v[204:207], v[204:207], 0
s_sub_u32 s37, s37, 1
s_cbranch_scc1 Lend_1
s_branch Lps_172
Lpf_201:
buffer_load_dwordx4 v[60:63], v10, s[4:7], s40 offen offset:3072 sc1
v_mfma_f32_16x16x32_bf16 v[200:203], v[204:207], v[204:207], 0
Lps_220:
s_waitcnt vmcnt(2)
v_max3_u32 v44, v52, v53, v54
v_max_u32 v44, v44, v55
v_cmp_eq_u32 vcc, -1, v44
s_cbranch_vccnz Lpf_221
v_smfmac_f32_16x16x64_bf16 v[64:67], v[52:55], a[64:71], v15
v_smfmac_f32_16x16x64_bf16 v[68:71], v[52:55], a[72:79], v15
v_smfmac_f32_16x16x64_bf16 v[72:75], v[52:55], a[80:87], v15
v_smfmac_f32_16x16x64_bf16 v[76:79], v[52:55], a[88:95], v15
v_smfmac_f32_16x16x64_bf16 v[80:83], v[52:55], a[96:103], v15
v_smfmac_f32_16x16x64_bf16 v[84:87], v[52:55], a[104:111], v15
v_smfmac_f32_16x16x64_bf16 v[88:91], v[52:55], a[112:119], v15
v_smfmac_f32_16x16x64_bf16 v[92:95], v[52:55], a[120:127], v15
s_branch Lps_206
Lpf_203:
buffer_load_dwordx4 v[52:55], v10, s[4:7], s40 offen offset:1024 sc1
v_mfma_f32_16x16x32_bf16 v[200:203], v[204:207], v[204:207], 0
s_sub_u32 s37, s37, 1
s_cbranch_scc1 Lend_1
Lps_222:
s_waitcnt vmcnt(1)
v_max3_u32 v44, v56, v57, v58
v_max_u32 v44, v44, v59
v_cmp_eq_u32 vcc, -1, v44
s_cbranch_vccnz Lpf_223
v_smfmac_f32_16x16x64_bf16 v[64:67], v[56:59], a[128:135], v15
v_smfmac_f32_16x16x64_bf16 v[68:71], v[56:59], a[136:143], v15
v_smfmac_f32_16x16x64_bf16 v[72:75], v[56:59], a[144:151], v15
v_smfmac_f32_16x16x64_bf16 v[76:79], v[56:59], a[152:159], v15
v_smfmac_f32_16x16x64_bf16 v[80:83], v[56:59], a[160:167], v15
v_smfmac_f32_16x16x64_bf16 v[84:87], v[56:59], a[168:175], v15
v_smfmac_f32_16x16x64_bf16 v[88:91], v[56:59], a[176:183], v15
v_smfmac_f32_16x16x64_bf16 v[92:95], v[56:59], a[184:191], v15
s_branch Lps_180
Lpf_205:
buffer_load_dwordx4 v[52:55], v10, s[4:7], s40 offen offset:1024 sc1
v_mfma_f32_16x16x32_bf16 v[200:203], v[204:207], v[204:207], 0
s_sub_u32 s37, s37, 1
s_cbranch_scc1 Lend_1
s_branch Lps_178
Lpf_207:
buffer_load_dwordx4 v[56:59], v10, s[4:7], s40 offen offset:2048 sc1
v_mfma_f32_16x16x32_bf16 v[200:203], v[204:207], v[204:207], 0
s_sub_u32 s37, s37, 1
s_cbranch_scc1 Lend_1
s_branch Lps_182
Lpf_209:
buffer_load_dwordx4 v[60:63], v10, s[4:7], s40 offen offset:3072 sc1
v_mfma_f32_16x16x32_bf16 v[200:203], v[204:207], v[204:207], 0
Lps_224:
s_waitcnt vmcnt(3)
v_max3_u32 v44, v48, v49, v50
v_max_u32 v44, v44, v51
v_cmp_eq_u32 vcc, -1, v44
s_cbranch_vccnz Lpf_225
v_smfmac_f32_16x16x64_bf16 v[64:67], v[48:51], a[0:7], v15
v_smfmac_f32_16x16x64_bf16 v[68:71], v[48:51], a[8:15], v15
v_smfmac_f32_16x16x64_bf16 v[72:75], v[48:51], a[16:23], v15
v_smfmac_f32_16x16x64_bf16 v[76:79], v[48:51], a[24:31], v15
v_smfmac_f32_16x16x64_bf16 v[80:83], v[48:51], a[32:39], v15
v_smfmac_f32_16x16x64_bf16 v[84:87], v[48:51], a[40:47], v15
v_smfmac_f32_16x16x64_bf16 v[88:91], v[48:51], a[48:55], v15
v_smfmac_f32_16x16x64_bf16 v[92:95], v[48:51], a[56:63], v15
s_branch Lps_220
Lpf_211:
buffer_load_dwordx4 v[48:51], v10, s[4:7], s40 offen offset:0 sc1
v_mfma_f32_16x16x32_bf16 v[200:203], v[204:207], v[204:207], 0
s_sub_u32 s37, s37, 1
s_cbranch_scc1 Lend_1
Lps_226:
s_waitcnt vmcnt(2)
v_max3_u32 v44, v52, v53, v54
v_max_u32 v44, v44, v55
v_cmp_eq_u32 vcc, -1, v44
s_cbranch_vccnz Lpf_227
v_smfmac_f32_16x16x64_bf16 v[64:67], v[52:55], a[64:71], v15
v_smfmac_f32_16x16x64_bf16 v[68:71], v[52:55], a[72:79], v15
v_smfmac_f32_16x16x64_bf16 v[72:75], v[52:55], a[80:87], v15
v_smfmac_f32_16x16x64_bf16 v[76:79], v[52:55], a[88:95], v15
v_smfmac_f32_16x16x64_bf16 v[80:83], v[52:55], a[96:103], v15
v_smfmac_f32_16x16x64_bf16 v[84:87], v[52:55], a[104:111], v15
v_smfmac_f32_16x16x64_bf16 v[88:91], v[52:55], a[112:119], v15
v_smfmac_f32_16x16x64_bf16 v[92:95], v[52:55], a[120:127], v15
s_branch Lps_218
Lpf_213:
buffer_load_dwordx4 v[48:51], v10, s[4:7], s40 offen offset:0 sc1
v_mfma_f32_16x16x32_bf16 v[200:203], v[204:207], v[204:207], 0
s_sub_u32 s37, s37, 1
s_cbranch_scc1 Lend_1
Lps_228:
s_waitcnt vmcnt(2)
v_max3_u32 v44, v52, v53, v54
v_max_u32 v44, v44, v55
v_cmp_eq_u32 vcc, -1, v44
s_cbranch_vccnz Lpf_229
v_smfmac_f32_16x16x64_bf16 v[64:67], v[52:55], a[64:71], v15
v_smfmac_f32_16x16x64_bf16 v[68:71], v[52:55], a[72:79], v15
v_smfmac_f32_16x16x64_bf16 v[72:75], v[52:55], a[80:87], v15
v_smfmac_f32_16x16x64_bf16 v[76:79], v[52:55], a[88:95], v15
v_smfmac_f32_16x16x64_bf16 v[80:83], v[52:55], a[96:103], v15
v_smfmac_f32_16x16x64_bf16 v[84:87], v[52:55], a[104:111], v15
v_smfmac_f32_16x16x64_bf16 v[88:91], v[52:55], a[112:119], v15
v_smfmac_f32_16x16x64_bf16 v[92:95], v[52:55], a[120:127], v15
s_branch Lps_172
Lpf_215:
buffer_load_dwordx4 v[52:55], v10, s[4:7], s40 offen offset:1024 sc1
v_mfma_f32_16x16x32_bf16 v[200:203], v[204:207], v[204:207], 0
s_branch Lps_192
Lpf_217:
buffer_load_dwordx4 v[48:51], v10, s[4:7], s40 offen offset:0 sc1
v_mfma_f32_16x16x32_bf16 v[200:203], v[204:207], v[204:207], 0
s_sub_u32 s37, s37, 1
s_cbranch_scc1 Lend_1
s_branch Lps_170
Lpf_219:
buffer_load_dwordx4 v[56:59], v10, s[4:7], s40 offen offset:2048 sc1
v_mfma_f32_16x16x32_bf16 v[200:203], v[204:207], v[204:207], 0
s_branch Lps_196
Lpf_221:
buffer_load_dwordx4 v[52:55], v10, s[4:7], s40 offen offset:1024 sc1
v_mfma_f32_16x16x32_bf16 v[200:203], v[204:207], v[204:207], 0
s_sub_u32 s37, s37, 1
s_cbranch_scc1 Lend_1
s_branch Lps_176
Lpf_223:
buffer_load_dwordx4 v[56:59], v10, s[4:7], s40 offen offset:2048 sc1
v_mfma_f32_16x16x32_bf16 v[200:203], v[204:207], v[204:207], 0
s_branch Lps_202
Lpf_225:
buffer_load_dwordx4 v[48:51], v10, s[4:7], s40 offen offset:0 sc1
v_mfma_f32_16x16x32_bf16 v[200:203], v[204:207], v[204:207], 0
s_sub_u32 s37, s37, 1
s_cbranch_scc1 Lend_1
s_branch Lps_168
Lpf_227:
buffer_load_dwordx4 v[52:55], v10, s[4:7], s40 offen offset:1024 sc1
v_mfma_f32_16x16x32_bf16 v[200:203], v[204:207], v[204:207], 0
Lps_230:
s_waitcnt vmcnt(2)
v_max3_u32 v44, v56, v57, v58
v_max_u32 v44, v44, v59
v_cmp_eq_u32 vcc, -1, v44
s_cbranch_vccnz Lpf_231
v_smfmac_f32_16x16x64_bf16 v[64:67], v[56:59], a[128:135], v15
v_smfmac_f32_16x16x64_bf16 v[68:71], v[56:59], a[136:143], v15
v_smfmac_f32_16x16x64_bf16 v[72:75], v[56:59], a[144:151], v15
v_smfmac_f32_16x16x64_bf16 v[76:79], v[56:59], a[152:159], v15
v_smfmac_f32_16x16x64_bf16 v[80:83], v[56:59], a[160:167], v15
v_smfmac_f32_16x16x64_bf16 v[84:87], v[56:59], a[168:175], v15
v_smfmac_f32_16x16x64_bf16 v[88:91], v[56:59], a[176:183], v15
v_smfmac_f32_16x16x64_bf16 v[92:95], v[56:59], a[184:191], v15
s_branch Lps_192
Lpf_229:
buffer_load_dwordx4 v[52:55], v10, s[4:7], s40 offen offset:1024 sc1
v_mfma_f32_16x16x32_bf16 v[200:203], v[204:207], v[204:207], 0
s_branch Lps_190
Lpf_231:
buffer_load_dwordx4 v[56:59], v10, s[4:7], s40 offen offset:2048 sc1
v_mfma_f32_16x16x32_bf16 v[200:203], v[204:207], v[204:207], 0
s_branch Lps_210
Lkr_158:
buffer_load_dwordx4 v[56:59], v11, s[4:7], s40 offen offset:0 sc1
buffer_load_dwordx4 v[60:63], v11, s[4:7], s40 offen offset:1024 sc1
Lps_233:
s_waitcnt vmcnt(3)
v_max3_u32 v44, v48, v49, v50
v_max_u32 v44, v44, v51
v_cmp_eq_u32 vcc, -1, v44
s_cbranch_vccnz Lpf_234
v_smfmac_f32_16x16x64_bf16 v[72:75], v[48:51], v[96:103], v15
v_mov_b32 v112, v48
v_mov_b32 v113, v49
v_mov_b32 v114, v50
v_mov_b32 v115, v51
Lps_235:
s_waitcnt vmcnt(2)
v_max3_u32 v44, v52, v53, v54
v_max_u32 v44, v44, v55
v_cmp_eq_u32 vcc, -1, v44
s_cbranch_vccnz Lpf_236
v_smfmac_f32_16x16x64_bf16 v[72:75], v[52:55], v[104:111], v15
v_mov_b32 v116, v52
v_mov_b32 v117, v53
v_mov_b32 v118, v54
v_mov_b32 v119, v55
Lpd_232:
s_branch Lko_159
Lpf_234:
buffer_load_dwordx4 v[48:51], v11, s[4:7], s40 offen offset:0 sc1
s_sub_u32 s37, s37, 1
s_cbranch_scc1 Lend_1
Lps_237:
s_waitcnt vmcnt(3)
v_max3_u32 v44, v52, v53, v54
v_max_u32 v44, v44, v55
v_cmp_eq_u32 vcc, -1, v44
s_cbranch_vccnz Lpf_238
v_smfmac_f32_16x16x64_bf16 v[72:75], v[52:55], v[104:111], v15
v_mov_b32 v116, v52
v_mov_b32 v117, v53
v_mov_b32 v118, v54
v_mov_b32 v119, v55
Lps_239:
s_waitcnt vmcnt(2)
v_max3_u32 v44, v56, v57, v58
v_max_u32 v44, v44, v59
v_cmp_eq_u32 vcc, -1, v44
s_cbranch_vccnz Lpf_240
v_smfmac_f32_16x16x64_bf16 v[72:75], v[56:59], v[96:103], v15
v_mov_b32 v112, v56
v_mov_b32 v113, v57
v_mov_b32 v114, v58
v_mov_b32 v115, v59
s_branch Lpd_232
Lpf_236:
buffer_load_dwordx4 v[52:55], v11, s[4:7], s40 offen offset:1024 sc1
s_sub_u32 s37, s37, 1
s_cbranch_scc1 Lend_1
Lps_241:
s_waitcnt vmcnt(2)
v_max3_u32 v44, v56, v57, v58
v_max_u32 v44, v44, v59
v_cmp_eq_u32 vcc, -1, v44
s_cbranch_vccnz Lpf_242
Lps_243:
s_waitcnt vmcnt(1)
v_max3_u32 v44, v60, v61, v62
v_max_u32 v44, v44, v63
v_cmp_eq_u32 vcc, -1, v44
s_cbranch_vccnz Lpf_244
v_smfmac_f32_16x16x64_bf16 v[72:75], v[60:63], v[104:111], v15
v_mov_b32 v116, v60
v_mov_b32 v117, v61
v_mov_b32 v118, v62
v_mov_b32 v119, v63
s_branch Lpd_232
Lpf_238:
buffer_load_dwordx4 v[52:55], v11, s[4:7], s40 offen offset:1024 sc1
Lps_245:
s_waitcnt vmcnt(3)
v_max3_u32 v44, v56, v57, v58
v_max_u32 v44, v44, v59
v_cmp_eq_u32 vcc, -1, v44
s_cbranch_vccnz Lpf_246
v_smfmac_f32_16x16x64_bf16 v[72:75], v[56:59], v[96:103], v15
v_mov_b32 v112, v56
v_mov_b32 v113, v57
v_mov_b32 v114, v58
v_mov_b32 v115, v59
Lps_247:
s_waitcnt vmcnt(2)
v_max3_u32 v44, v60, v61, v62
v_max_u32 v44, v44, v63
v_cmp_eq_u32 vcc, -1, v44
s_cbranch_vccnz Lpf_248
v_smfmac_f32_16x16x64_bf16 v[72:75], v[60:63], v[104:111], v15
v_mov_b32 v116, v60
v_mov_b32 v117, v61
v_mov_b32 v118, v62
v_mov_b32 v119, v63
s_branch Lpd_232
Lpf_240:
buffer_load_dwordx4 v[56:59], v11, s[4:7], s40 offen offset:0 sc1
Lps_249:
s_waitcnt vmcnt(2)
v_max3_u32 v44, v60, v61, v62
v_max_u32 v44, v44, v63
v_cmp_eq_u32 vcc, -1, v44
s_cbranch_vccnz Lpf_250
Lps_251:
s_waitcnt vmcnt(1)
v_max3_u32 v44, v48, v49, v50
v_max_u32 v44, v44, v51
v_cmp_eq_u32 vcc, -1, v44
s_cbranch_vccnz Lpf_252
v_smfmac_f32_16x16x64_bf16 v[72:75], v[48:51], v[96:103], v15
v_mov_b32 v112, v48
v_mov_b32 v113, v49
v_mov_b32 v114, v50
v_mov_b32 v115, v51
s_branch Lpd_232
Lpf_242:
buffer_load_dwordx4 v[56:59], v11, s[4:7], s40 offen offset:0 sc1
Lps_253:
s_waitcnt vmcnt(2)
v_max3_u32 v44, v60, v61, v62
v_max_u32 v44, v44, v63
v_cmp_eq_u32 vcc, -1, v44
s_cbranch_vccnz Lpf_254
v_smfmac_f32_16x16x64_bf16 v[72:75], v[60:63], v[104:111], v15
v_mov_b32 v116, v60
v_mov_b32 v117, v61
v_mov_b32 v118, v62
v_mov_b32 v119, v63
s_branch Lpd_232
Lpf_244:
buffer_load_dwordx4 v[60:63], v11, s[4:7], s40 offen offset:1024 sc1
Lps_255:
s_waitcnt vmcnt(1)
v_max3_u32 v44, v52, v53, v54
v_max_u32 v44, v44, v55
v_cmp_eq_u32 vcc, -1, v44
s_cbranch_vccnz Lpf_256
v_smfmac_f32_16x16x64_bf16 v[72:75], v[52:55], v[104:111], v15
v_mov_b32 v116, v52
v_mov_b32 v117, v53
v_mov_b32 v118, v54
v_mov_b32 v119, v55
s_branch Lpd_232
Lpf_246:
buffer_load_dwordx4 v[56:59], v11, s[4:7], s40 offen offset:0 sc1
Lps_257:
s_waitcnt vmcnt(3)
v_max3_u32 v44, v60, v61, v62
v_max_u32 v44, v44, v63
v_cmp_eq_u32 vcc, -1, v44
s_cbranch_vccnz Lpf_258
v_smfmac_f32_16x16x64_bf16 v[72:75], v[60:63], v[104:111], v15
v_mov_b32 v116, v60
v_mov_b32 v117, v61
v_mov_b32 v118, v62
v_mov_b32 v119, v63
Lps_259:
s_waitcnt vmcnt(2)
v_max3_u32 v44, v48, v49, v50
v_max_u32 v44, v44, v51
v_cmp_eq_u32 vcc, -1, v44
s_cbranch_vccnz Lpf_260
v_smfmac_f32_16x16x64_bf16 v[72:75], v[48:51], v[96:103], v15
v_mov_b32 v112, v48
v_mov_b32 v113, v49
v_mov_b32 v114, v50
v_mov_b32 v115, v51
s_branch Lpd_232
Lpf_248:
buffer_load_dwordx4 v[60:63], v11, s[4:7], s40 offen offset:1024 sc1
Lps_261:
s_waitcnt vmcnt(2)
v_max3_u32 v44, v48, v49, v50
v_max_u32 v44, v44, v51
v_cmp_eq_u32 vcc, -1, v44
s_cbranch_vccnz Lpf_262
s_branch Lps_255
Lpf_250:
buffer_load_dwordx4 v[60:63], v11, s[4:7], s40 offen offset:1024 sc1
Lps_263:
s_waitcnt vmcnt(2)
v_max3_u32 v44, v48, v49, v50
v_max_u32 v44, v44, v51
v_cmp_eq_u32 vcc, -1, v44
s_cbranch_vccnz Lpf_264
v_smfmac_f32_16x16x64_bf16 v[72:75], v[48:51], v[96:103], v15
v_mov_b32 v112, v48
v_mov_b32 v113, v49
v_mov_b32 v114, v50
v_mov_b32 v115, v51
s_branch Lpd_232
Lpf_252:
buffer_load_dwordx4 v[48:51], v11, s[4:7], s40 offen offset:0 sc1
s_sub_u32 s37, s37, 1
s_cbranch_scc1 Lend_1
Lps_265:
s_waitcnt vmcnt(1)
v_max3_u32 v44, v56, v57, v58
v_max_u32 v44, v44, v59
v_cmp_eq_u32 vcc, -1, v44
s_cbranch_vccnz Lpf_266
v_smfmac_f32_16x16x64_bf16 v[72:75], v[56:59], v[96:103], v15
v_mov_b32 v112, v56
v_mov_b32 v113, v57
v_mov_b32 v114, v58
v_mov_b32 v115, v59
s_branch Lpd_232
Lpf_254:
buffer_load_dwordx4 v[60:63], v11, s[4:7], s40 offen offset:1024 sc1
s_branch Lps_235
Lpf_256:
buffer_load_dwordx4 v[52:55], v11, s[4:7], s40 offen offset:1024 sc1
s_sub_u32 s37, s37, 1
s_cbranch_scc1 Lend_1
s_branch Lps_243
Lpf_258:
buffer_load_dwordx4 v[60:63], v11, s[4:7], s40 offen offset:1024 sc1
s_branch Lps_233
Lpf_260:
buffer_load_dwordx4 v[48:51], v11, s[4:7], s40 offen offset:0 sc1
s_sub_u32 s37, s37, 1
s_cbranch_scc1 Lend_1
Lps_267:
s_waitcnt vmcnt(2)
v_max3_u32 v44, v52, v53, v54
v_max_u32 v44, v44, v55
v_cmp_eq_u32 vcc, -1, v44
s_cbranch_vccnz Lpf_268
s_branch Lps_265
Lpf_262:
buffer_load_dwordx4 v[48:51], v11, s[4:7], s40 offen offset:0 sc1
s_sub_u32 s37, s37, 1
s_cbranch_scc1 Lend_1
Lps_269:
s_waitcnt vmcnt(2)
v_max3_u32 v44, v52, v53, v54
v_max_u32 v44, v44, v55
v_cmp_eq_u32 vcc, -1, v44
s_cbranch_vccnz Lpf_270
v_smfmac_f32_16x16x64_bf16 v[72:75], v[52:55], v[104:111], v15
v_mov_b32 v116, v52
v_mov_b32 v117, v53
v_mov_b32 v118, v54
v_mov_b32 v119, v55
s_branch Lpd_232
Lpf_264:
buffer_load_dwordx4 v[48:51], v11, s[4:7], s40 offen offset:0 sc1
s_sub_u32 s37, s37, 1
s_cbranch_scc1 Lend_1
s_branch Lps_239
Lpf_266:
buffer_load_dwordx4 v[56:59], v11, s[4:7], s40 offen offset:0 sc1
s_branch Lps_251
Lpf_268:
buffer_load_dwordx4 v[52:55], v11, s[4:7], s40 offen offset:1024 sc1
Lps_271:
s_waitcnt vmcnt(2)
v_max3_u32 v44, v56, v57, v58
v_max_u32 v44, v44, v59
v_cmp_eq_u32 vcc, -1, v44
s_cbranch_vccnz Lpf_272
v_smfmac_f32_16x16x64_bf16 v[72:75], v[56:59], v[96:103], v15
v_mov_b32 v112, v56
v_mov_b32 v113, v57
v_mov_b32 v114, v58
v_mov_b32 v115, v59
s_branch Lpd_232
Lpf_270:
buffer_load_dwordx4 v[52:55], v11, s[4:7], s40 offen offset:1024 sc1
s_branch Lps_247
Lpf_272:
buffer_load_dwordx4 v[56:59], v11, s[4:7], s40 offen offset:0 sc1
s_branch Lps_259
Lvr_160:
buffer_load_dwordx2 v[120:121], v12, s[4:7], s40 offen sc1
buffer_load_dwordx2 v[122:123], v13, s[4:7], s40 offen sc1
s_sub_u32 s37, s37, 1
s_cbranch_scc1 Lend_1
s_waitcnt vmcnt(0)
v_max3_u32 v44, v120, v121, v122
v_max_u32 v44, v44, v123
v_cmp_eq_u32 vcc, -1, v44
s_cbranch_vccnz Lvr_160
s_branch Lvo_161
Lend_1:
s_endpgm
Lkvo_2:
v_mov_b32 v44, v0
v_mov_b32 v45, v1
v_and_b32 v46, 127, v44
s_sub_u32 s54, s34, 8
s_lshl_b32 s45, s33, 18
s_add_u32 s45, s45, 2097152
s_lshl_b32 s59, s33, 12
s_add_u32 s59, s59, 3276800
s_lshl_b32 s38, s32, 12
v_lshl_add_u32 v8, v45, 4, s38
v_add_u32 v9, 49152, v8
s_lshl_b32 s38, s54, 10
v_lshl_add_u32 v10, v46, 3, s38
v_lshl_add_u32 v50, v44, 2, s38
v_xor_b32 v11, 20480, v50
v_xor_b32 v27, 34816, v50
s_lshl_b32 s38, s32, 8
v_lshl_add_u32 v1, v45, 2, s38
v_add_u32 v2, 2048, v1
s_lshr_b32 s38, s54, 2
s_lshl_b32 s38, s38, 8
s_and_b32 s39, s54, 3
s_lshl_b32 s39, s39, 2
s_add_u32 s38, s38, s39
v_min_u32 v50, 1, v44
v_lshl_add_u32 v3, v50, 30, s38
s_lshr_b32 s38, s54, 3
s_lshl_b32 s38, s38, 14
s_and_b32 s39, s54, 7
s_lshl_b32 s39, s39, 10
s_add_u32 s38, s38, s39
s_lshl_b32 s39, s33, 16
s_add_u32 s38, s38, s39
v_lshl_add_u32 v12, v46, 3, s38
v_xor_b32 v13, 0x10000, v12
v_xor_b32 v14, 0x20000, v12
v_xor_b32 v15, 0x30000, v12
s_mov_b32 s55, 0x00003f80
s_mov_b32 s56, 0x3f800000
v_and_b32 v50, 1, v45
v_mul_u32_u24 v50, 0xaaaa, v50
v_add_u32 v126, 0x4444, v50
s_lshl_b32 s38, s32, 11
v_lshl_add_u32 v25, v45, 5, s38
v_lshlrev_b32 v127, 3, v44
v_bfe_u32 v50, v46, 5, 1
v_lshlrev_b32 v50, 2, v50
v_and_b32 v51, 1, v46
v_lshl_add_u32 v50, v51, 1, v50
v_bfe_u32 v51, v46, 1, 1
v_add_u32 v50, v50, v51
v_and_b32 v51, 24, v46
v_add_u32 v51, v51, v50
v_lshlrev_b32 v51, 3, v51
v_bfe_u32 v52, v46, 2, 1
v_mul_u32_u24 v52, 288, v52
v_add_u32 v51, v51, v52
v_lshrrev_b32 v52, 6, v46
v_mul_u32_u24 v53, 1152, v52
v_add_u32 v0, v51, v53
v_lshl_add_u32 v50, v52, 4, v50
v_bfe_u32 v51, v46, 2, 3
v_lshlrev_b32 v51, 11, v51
v_lshl_add_u32 v58, v50, 2, v51
s_mov_b32 s8, s16
s_and_b32 s9, s17, 0xffff
s_mov_b32 s10, 0x4000
s_mov_b32 s11, 0x20000
v_and_b32 v50, 1, v45
s_and_b32 s38, s32, 2
v_add_u32 v51, s38, v50
s_and_b32 s39, s32, 1
s_lshl_b32 s39, s39, 3
v_bfe_u32 v52, v45, 1, 1
v_lshl_add_u32 v52, v52, 2, s39
v_bfe_u32 v53, v45, 2, 1
v_lshl_add_u32 v52, v53, 1, v52
v_bfe_u32 v53, v45, 3, 1
v_and_b32 v54, 48, v45
v_add_u32 v54, v54, v52
v_lshlrev_b32 v54, 2, v54
v_mul_u32_u24 v53, 640, v53
v_mul_u32_u24 v55, 288, v50
v_add3_u32 v54, v54, v53, v55
s_mul_i32 s38, s38, 640
v_add_u32 v24, s38, v54
v_mov_b32 v16, 0
v_mov_b32 v17, 0
v_mov_b32 v18, 0
v_mov_b32 v19, 0
v_mov_b32 v20, 0
v_mov_b32 v21, 0
v_mov_b32 v22, 0
v_mov_b32 v23, 0
v_mov_b32 v120, -1
v_mov_b32 v121, -1
v_mov_b32 v122, -1
v_mov_b32 v123, -1
s_add_u32 s38, s45, 0
buffer_store_dwordx2 v[120:121], v10, s[4:7], s38 offen sc1
buffer_store_dword v120, v11, s[4:7], s38 offen sc1
buffer_store_dword v120, v27, s[4:7], s38 offen sc1
s_mov_b32 s38, 0
s_mov_b32 s46, 0
s_lshl_b32 s88, s38, 18
s_add_u32 s88, s88, s46
s_add_u32 s89, s88, 0x100000
s_cmp_ge_u32 s32, 2
s_cbranch_scc1 Lco_273
buffer_store_dwordx2 v[120:121], v12, s[4:7], s88 offen sc1
buffer_store_dwordx2 v[120:121], v12, s[4:7], s89 offen sc1
Lco_273:
s_mov_b32 s46, 8192
s_lshl_b32 s88, s38, 18
s_add_u32 s88, s88, s46
s_add_u32 s89, s88, 0x100000
s_cmp_ge_u32 s32, 2
s_cbranch_scc1 Lco_274
buffer_store_dwordx2 v[120:121], v12, s[4:7], s88 offen sc1
buffer_store_dwordx2 v[120:121], v12, s[4:7], s89 offen sc1
Lco_274:
s_add_u32 s38, s45, 65536
buffer_store_dwordx2 v[120:121], v10, s[4:7], s38 offen sc1
buffer_store_dword v120, v11, s[4:7], s38 offen sc1
buffer_store_dword v120, v27, s[4:7], s38 offen sc1
s_mov_b32 s38, 1
s_mov_b32 s46, 0
s_lshl_b32 s88, s38, 18
s_add_u32 s88, s88, s46
s_add_u32 s89, s88, 0x100000
s_cmp_ge_u32 s32, 2
s_cbranch_scc1 Lco_275
buffer_store_dwordx2 v[120:121], v12, s[4:7], s88 offen sc1
buffer_store_dwordx2 v[120:121], v12, s[4:7], s89 offen sc1
Lco_275:
s_mov_b32 s46, 8192
s_lshl_b32 s88, s38, 18
s_add_u32 s88, s88, s46
s_add_u32 s89, s88, 0x100000
s_cmp_ge_u32 s32, 2
s_cbranch_scc1 Lco_276
buffer_store_dwordx2 v[120:121], v12, s[4:7], s88 offen sc1
buffer_store_dwordx2 v[120:121], v12, s[4:7], s89 offen sc1
Lco_276:
s_add_u32 s38, s45, 131072
buffer_store_dwordx2 v[120:121], v10, s[4:7], s38 offen sc1
buffer_store_dword v120, v11, s[4:7], s38 offen sc1
buffer_store_dword v120, v27, s[4:7], s38 offen sc1
s_mov_b32 s38, 2
s_mov_b32 s46, 0
s_lshl_b32 s88, s38, 18
s_add_u32 s88, s88, s46
s_add_u32 s89, s88, 0x100000
s_cmp_ge_u32 s32, 2
s_cbranch_scc1 Lco_277
buffer_store_dwordx2 v[120:121], v12, s[4:7], s88 offen sc1
buffer_store_dwordx2 v[120:121], v12, s[4:7], s89 offen sc1
Lco_277:
s_mov_b32 s46, 8192
s_lshl_b32 s88, s38, 18
s_add_u32 s88, s88, s46
s_add_u32 s89, s88, 0x100000
s_cmp_ge_u32 s32, 2
s_cbranch_scc1 Lco_278
buffer_store_dwordx2 v[120:121], v12, s[4:7], s88 offen sc1
buffer_store_dwordx2 v[120:121], v12, s[4:7], s89 offen sc1
Lco_278:
s_add_u32 s38, s45, 196608
buffer_store_dwordx2 v[120:121], v10, s[4:7], s38 offen sc1
buffer_store_dword v120, v11, s[4:7], s38 offen sc1
buffer_store_dword v120, v27, s[4:7], s38 offen sc1
s_mov_b32 s38, 3
s_mov_b32 s46, 0
s_lshl_b32 s88, s38, 18
s_add_u32 s88, s88, s46
s_add_u32 s89, s88, 0x100000
s_cmp_ge_u32 s32, 2
s_cbranch_scc1 Lco_279
buffer_store_dwordx2 v[120:121], v12, s[4:7], s88 offen sc1
buffer_store_dwordx2 v[120:121], v12, s[4:7], s89 offen sc1
Lco_279:
s_mov_b32 s46, 8192
s_lshl_b32 s88, s38, 18
s_add_u32 s88, s88, s46
s_add_u32 s89, s88, 0x100000
s_cmp_ge_u32 s32, 2
s_cbranch_scc1 Lco_280
buffer_store_dwordx2 v[120:121], v12, s[4:7], s88 offen sc1
buffer_store_dwordx2 v[120:121], v12, s[4:7], s89 offen sc1
Lco_280:
v_mov_b32 v7, 1
buffer_store_dword v7, v3, s[4:7], s59 offen sc1
s_lshl_b32 s52, s35, 16
s_or_b32 s52, s52, 1
s_waitcnt vmcnt(0)
s_barrier
s_cmp_lg_u32 s32, 0
s_cbranch_scc1 Lar_281
s_mov_b64 exec, 1
v_mov_b32 v48, 32
v_mov_b32 v49, s52
buffer_atomic_add v49, v48, s[12:15], 0 offen sc1
s_mov_b64 exec, -1
Lar_281:
s_lshl_b32 s38, s54, 7
buffer_load_dword v56, v58, s[8:11], s38 offen
buffer_load_dword v57, v58, s[8:11], s38 offen offset:32
v_lshrrev_b32 v54, 3, v45
v_and_b32 v55, 7, v45
v_lshlrev_b32 v55, 4, v55
v_lshl_add_u32 v50, v54, 13, v55
v_lshl_add_u32 v51, v54, 11, v55
s_mul_i32 s38, s32, 40960
v_and_b32 v55, 3, v45
v_lshl_add_u32 v55, v55, 3, s38
v_lshrrev_b32 v54, 2, v45
v_lshl_add_u32 v52, v54, 7, v55
v_and_b32 v53, 16, v45
v_bfe_u32 v54, v45, 5, 1
v_lshl_add_u32 v53, v54, 3, v53
v_bfe_u32 v54, v45, 3, 1
v_lshl_add_u32 v53, v54, 2, v53
v_bfe_u32 v54, v45, 2, 1
v_add_u32 v53, v53, v54
v_lshl_add_u32 v53, v53, 7, v55
s_mov_b32 s8, s20
s_and_b32 s9, s21, 0xffff
s_mov_b32 s10, 0x800000
s_mov_b32 s11, 0x20000
s_lshl_b32 s39, s32, 21
s_lshl_b32 s38, s33, 4
s_add_u32 s38, s38, s54
s_xor_b32 s38, s38, 4
s_lshl_b32 s38, s38, 7
s_add_u32 s39, s39, s38
s_add_u32 s39, s39, 1572864
s_mul_i32 s38, s32, 40960
s_add_u32 m0, s38, 0
s_nop 0
buffer_load_dwordx4 v50, s[8:11], s39 offen lds
s_add_u32 m0, m0, 1024
s_add_u32 s39, s39, 65536
buffer_load_dwordx4 v50, s[8:11], s39 offen lds
s_add_u32 m0, m0, 1024
s_add_u32 s39, s39, 65536
buffer_load_dwordx4 v50, s[8:11], s39 offen lds
s_add_u32 m0, m0, 1024
s_add_u32 s39, s39, 65536
buffer_load_dwordx4 v50, s[8:11], s39 offen lds
s_add_u32 m0, m0, 1024
s_add_u32 s39, s39, 65536
buffer_load_dwordx4 v50, s[8:11], s39 offen lds
s_add_u32 m0, m0, 1024
s_add_u32 s39, s39, 65536
buffer_load_dwordx4 v50, s[8:11], s39 offen lds
s_add_u32 m0, m0, 1024
s_add_u32 s39, s39, 65536
buffer_load_dwordx4 v50, s[8:11], s39 offen lds
s_add_u32 m0, m0, 1024
s_add_u32 s39, s39, 65536
buffer_load_dwordx4 v50, s[8:11], s39 offen lds
s_mov_b32 s8, s22
s_and_b32 s9, s23, 0xffff
s_mov_b32 s10, 0x800000
s_mov_b32 s11, 0x20000
s_lshl_b32 s39, s32, 21
s_lshl_b32 s38, s33, 4
s_add_u32 s38, s38, s54
s_xor_b32 s38, s38, 2
s_lshl_b32 s38, s38, 7
s_add_u32 s39, s39, s38
s_add_u32 s39, s39, 1572864
s_mul_i32 s38, s32, 40960
s_add_u32 m0, s38, 8192
s_nop 0
buffer_load_dwordx4 v50, s[8:11], s39 offen lds
s_add_u32 m0, m0, 1024
s_add_u32 s39, s39, 65536
buffer_load_dwordx4 v50, s[8:11], s39 offen lds
s_add_u32 m0, m0, 1024
s_add_u32 s39, s39, 65536
buffer_load_dwordx4 v50, s[8:11], s39 offen lds
s_add_u32 m0, m0, 1024
s_add_u32 s39, s39, 65536
buffer_load_dwordx4 v50, s[8:11], s39 offen lds
s_add_u32 m0, m0, 1024
s_add_u32 s39, s39, 65536
buffer_load_dwordx4 v50, s[8:11], s39 offen lds
s_add_u32 m0, m0, 1024
s_add_u32 s39, s39, 65536
buffer_load_dwordx4 v50, s[8:11], s39 offen lds
s_add_u32 m0, m0, 1024
s_add_u32 s39, s39, 65536
buffer_load_dwordx4 v50, s[8:11], s39 offen lds
s_add_u32 m0, m0, 1024
s_add_u32 s39, s39, 65536
buffer_load_dwordx4 v50, s[8:11], s39 offen lds
s_mov_b32 s8, s20
s_and_b32 s9, s21, 0xffff
s_mov_b32 s10, 0x800000
s_mov_b32 s11, 0x20000
s_lshl_b32 s39, s32, 21
s_lshl_b32 s38, s33, 4
s_add_u32 s38, s38, s54
s_xor_b32 s38, s38, 4
s_lshl_b32 s38, s38, 7
s_add_u32 s39, s39, s38
s_add_u32 s39, s39, 1048576
s_mul_i32 s38, s32, 40960
s_add_u32 m0, s38, 16384
s_nop 0
buffer_load_dwordx4 v50, s[8:11], s39 offen lds
s_add_u32 m0, m0, 1024
s_add_u32 s39, s39, 65536
buffer_load_dwordx4 v50, s[8:11], s39 offen lds
s_add_u32 m0, m0, 1024
s_add_u32 s39, s39, 65536
buffer_load_dwordx4 v50, s[8:11], s39 offen lds
s_add_u32 m0, m0, 1024
s_add_u32 s39, s39, 65536
buffer_load_dwordx4 v50, s[8:11], s39 offen lds
s_add_u32 m0, m0, 1024
s_add_u32 s39, s39, 65536
buffer_load_dwordx4 v50, s[8:11], s39 offen lds
s_add_u32 m0, m0, 1024
s_add_u32 s39, s39, 65536
buffer_load_dwordx4 v50, s[8:11], s39 offen lds
s_add_u32 m0, m0, 1024
s_add_u32 s39, s39, 65536
buffer_load_dwordx4 v50, s[8:11], s39 offen lds
s_add_u32 m0, m0, 1024
s_add_u32 s39, s39, 65536
buffer_load_dwordx4 v50, s[8:11], s39 offen lds
s_mov_b32 s8, s22
s_and_b32 s9, s23, 0xffff
s_mov_b32 s10, 0x800000
s_mov_b32 s11, 0x20000
s_lshl_b32 s39, s32, 21
s_lshl_b32 s38, s33, 4
s_add_u32 s38, s38, s54
s_xor_b32 s38, s38, 2
s_lshl_b32 s38, s38, 7
s_add_u32 s39, s39, s38
s_add_u32 s39, s39, 1048576
s_mul_i32 s38, s32, 40960
s_add_u32 m0, s38, 24576
s_nop 0
buffer_load_dwordx4 v50, s[8:11], s39 offen lds
s_add_u32 m0, m0, 1024
s_add_u32 s39, s39, 65536
buffer_load_dwordx4 v50, s[8:11], s39 offen lds
s_add_u32 m0, m0, 1024
s_add_u32 s39, s39, 65536
buffer_load_dwordx4 v50, s[8:11], s39 offen lds
s_add_u32 m0, m0, 1024
s_add_u32 s39, s39, 65536
buffer_load_dwordx4 v50, s[8:11], s39 offen lds
s_add_u32 m0, m0, 1024
s_add_u32 s39, s39, 65536
buffer_load_dwordx4 v50, s[8:11], s39 offen lds
s_add_u32 m0, m0, 1024
s_add_u32 s39, s39, 65536
buffer_load_dwordx4 v50, s[8:11], s39 offen lds
s_add_u32 m0, m0, 1024
s_add_u32 s39, s39, 65536
buffer_load_dwordx4 v50, s[8:11], s39 offen lds
s_add_u32 m0, m0, 1024
s_add_u32 s39, s39, 65536
buffer_load_dwordx4 v50, s[8:11], s39 offen lds
s_mov_b32 s8, s20
s_and_b32 s9, s21, 0xffff
s_mov_b32 s10, 0x800000
s_mov_b32 s11, 0x20000
s_lshl_b32 s39, s32, 21
s_lshl_b32 s38, s33, 4
s_add_u32 s38, s38, s54
s_xor_b32 s38, s38, 4
s_lshl_b32 s38, s38, 7
s_add_u32 s39, s39, s38
s_add_u32 s39, s39, 524288
s_mul_i32 s38, s32, 40960
s_add_u32 m0, s38, 32768
s_nop 0
buffer_load_dwordx4 v50, s[8:11], s39 offen lds
s_add_u32 m0, m0, 1024
s_add_u32 s39, s39, 65536
buffer_load_dwordx4 v50, s[8:11], s39 offen lds
s_add_u32 m0, m0, 1024
s_add_u32 s39, s39, 65536
buffer_load_dwordx4 v50, s[8:11], s39 offen lds
s_add_u32 m0, m0, 1024
s_add_u32 s39, s39, 65536
buffer_load_dwordx4 v50, s[8:11], s39 offen lds
s_add_u32 m0, m0, 1024
s_add_u32 s39, s39, 65536
buffer_load_dwordx4 v50, s[8:11], s39 offen lds
s_add_u32 m0, m0, 1024
s_add_u32 s39, s39, 65536
buffer_load_dwordx4 v50, s[8:11], s39 offen lds
s_add_u32 m0, m0, 1024
s_add_u32 s39, s39, 65536
buffer_load_dwordx4 v50, s[8:11], s39 offen lds
s_add_u32 m0, m0, 1024
s_add_u32 s39, s39, 65536
buffer_load_dwordx4 v50, s[8:11], s39 offen lds
s_waitcnt vmcnt(32)
v_min_u32 v56, -2, v56
v_min_u32 v57, -2, v57
buffer_store_dwordx2 v[56:57], v10, s[4:7], s45 offen sc1
ds_read_b64_tr_b16 a[96:97], v52 offset:0
ds_read_b64_tr_b16 a[98:99], v52 offset:2048
ds_read_b64_tr_b16 a[100:101], v52 offset:4096
ds_read_b64_tr_b16 a[102:103], v52 offset:6144
ds_read_b64_tr_b16 a[104:105], v52 offset:32
ds_read_b64_tr_b16 a[106:107], v52 offset:2080
ds_read_b64_tr_b16 a[108:109], v52 offset:4128
ds_read_b64_tr_b16 a[110:111], v52 offset:6176
ds_read_b64_tr_b16 a[112:113], v52 offset:64
ds_read_b64_tr_b16 a[114:115], v52 offset:2112
ds_read_b64_tr_b16 a[116:117], v52 offset:4160
ds_read_b64_tr_b16 a[118:119], v52 offset:6208
ds_read_b64_tr_b16 a[120:121], v52 offset:96
ds_read_b64_tr_b16 a[122:123], v52 offset:2144
ds_read_b64_tr_b16 a[124:125], v52 offset:4192
ds_read_b64_tr_b16 a[126:127], v52 offset:6240
s_waitcnt lgkmcnt(0)
s_mov_b32 s8, s22
s_and_b32 s9, s23, 0xffff
s_mov_b32 s10, 0x800000
s_mov_b32 s11, 0x20000
s_lshl_b32 s39, s32, 21
s_lshl_b32 s38, s33, 4
s_add_u32 s38, s38, s54
s_xor_b32 s38, s38, 2
s_lshl_b32 s38, s38, 7
s_add_u32 s39, s39, s38
s_add_u32 s39, s39, 524288
s_mul_i32 s38, s32, 40960
s_add_u32 m0, s38, 0
s_nop 0
buffer_load_dwordx4 v50, s[8:11], s39 offen lds
s_add_u32 m0, m0, 1024
s_add_u32 s39, s39, 65536
buffer_load_dwordx4 v50, s[8:11], s39 offen lds
s_add_u32 m0, m0, 1024
s_add_u32 s39, s39, 65536
buffer_load_dwordx4 v50, s[8:11], s39 offen lds
s_add_u32 m0, m0, 1024
s_add_u32 s39, s39, 65536
buffer_load_dwordx4 v50, s[8:11], s39 offen lds
s_add_u32 m0, m0, 1024
s_add_u32 s39, s39, 65536
buffer_load_dwordx4 v50, s[8:11], s39 offen lds
s_add_u32 m0, m0, 1024
s_add_u32 s39, s39, 65536
buffer_load_dwordx4 v50, s[8:11], s39 offen lds
s_add_u32 m0, m0, 1024
s_add_u32 s39, s39, 65536
buffer_load_dwordx4 v50, s[8:11], s39 offen lds
s_add_u32 m0, m0, 1024
s_add_u32 s39, s39, 65536
buffer_load_dwordx4 v50, s[8:11], s39 offen lds
s_waitcnt vmcnt(32)
ds_read_b64_tr_b16 v[224:225], v52 offset:8192
ds_read_b64_tr_b16 v[226:227], v52 offset:10240
ds_read_b64_tr_b16 v[228:229], v52 offset:12288
ds_read_b64_tr_b16 v[230:231], v52 offset:14336
ds_read_b64_tr_b16 v[232:233], v52 offset:8224
ds_read_b64_tr_b16 v[234:235], v52 offset:10272
ds_read_b64_tr_b16 v[236:237], v52 offset:12320
ds_read_b64_tr_b16 v[238:239], v52 offset:14368
ds_read_b64_tr_b16 v[240:241], v52 offset:8256
ds_read_b64_tr_b16 v[242:243], v52 offset:10304
ds_read_b64_tr_b16 v[244:245], v52 offset:12352
ds_read_b64_tr_b16 v[246:247], v52 offset:14400
ds_read_b64_tr_b16 v[248:249], v52 offset:8288
ds_read_b64_tr_b16 v[250:251], v52 offset:10336
ds_read_b64_tr_b16 v[252:253], v52 offset:12384
ds_read_b64_tr_b16 v[254:255], v52 offset:14432
s_waitcnt lgkmcnt(0)
s_mov_b32 s8, s20
s_and_b32 s9, s21, 0xffff
s_mov_b32 s10, 0x800000
s_mov_b32 s11, 0x20000
s_lshl_b32 s39, s32, 21
s_lshl_b32 s38, s33, 4
s_add_u32 s38, s38, s54
s_xor_b32 s38, s38, 4
s_lshl_b32 s38, s38, 7
s_add_u32 s39, s39, s38
s_add_u32 s39, s39, 0
s_mul_i32 s38, s32, 40960
s_add_u32 m0, s38, 8192
s_nop 0
buffer_load_dwordx4 v50, s[8:11], s39 offen lds
s_add_u32 m0, m0, 1024
s_add_u32 s39, s39, 65536
buffer_load_dwordx4 v50, s[8:11], s39 offen lds
s_add_u32 m0, m0, 1024
s_add_u32 s39, s39, 65536
buffer_load_dwordx4 v50, s[8:11], s39 offen lds
s_add_u32 m0, m0, 1024
s_add_u32 s39, s39, 65536
buffer_load_dwordx4 v50, s[8:11], s39 offen lds
s_add_u32 m0, m0, 1024
s_add_u32 s39, s39, 65536
buffer_load_dwordx4 v50, s[8:11], s39 offen lds
s_add_u32 m0, m0, 1024
s_add_u32 s39, s39, 65536
buffer_load_dwordx4 v50, s[8:11], s39 offen lds
s_add_u32 m0, m0, 1024
s_add_u32 s39, s39, 65536
buffer_load_dwordx4 v50, s[8:11], s39 offen lds
s_add_u32 m0, m0, 1024
s_add_u32 s39, s39, 65536
buffer_load_dwordx4 v50, s[8:11], s39 offen lds
s_waitcnt vmcnt(32)
ds_read_b64_tr_b16 a[64:65], v52 offset:16384
ds_read_b64_tr_b16 a[66:67], v52 offset:18432
ds_read_b64_tr_b16 a[68:69], v52 offset:20480
ds_read_b64_tr_b16 a[70:71], v52 offset:22528
ds_read_b64_tr_b16 a[72:73], v52 offset:16416
ds_read_b64_tr_b16 a[74:75], v52 offset:18464
ds_read_b64_tr_b16 a[76:77], v52 offset:20512
ds_read_b64_tr_b16 a[78:79], v52 offset:22560
ds_read_b64_tr_b16 a[80:81], v52 offset:16448
ds_read_b64_tr_b16 a[82:83], v52 offset:18496
ds_read_b64_tr_b16 a[84:85], v52 offset:20544
ds_read_b64_tr_b16 a[86:87], v52 offset:22592
ds_read_b64_tr_b16 a[88:89], v52 offset:16480
ds_read_b64_tr_b16 a[90:91], v52 offset:18528
ds_read_b64_tr_b16 a[92:93], v52 offset:20576
ds_read_b64_tr_b16 a[94:95], v52 offset:22624
s_waitcnt lgkmcnt(0)
s_mov_b32 s8, s22
s_and_b32 s9, s23, 0xffff
s_mov_b32 s10, 0x800000
s_mov_b32 s11, 0x20000
s_lshl_b32 s39, s32, 21
s_lshl_b32 s38, s33, 4
s_add_u32 s38, s38, s54
s_xor_b32 s38, s38, 2
s_lshl_b32 s38, s38, 7
s_add_u32 s39, s39, s38
s_add_u32 s39, s39, 0
s_mul_i32 s38, s32, 40960
s_add_u32 m0, s38, 16384
s_nop 0
buffer_load_dwordx4 v50, s[8:11], s39 offen lds
s_add_u32 m0, m0, 1024
s_add_u32 s39, s39, 65536
buffer_load_dwordx4 v50, s[8:11], s39 offen lds
s_add_u32 m0, m0, 1024
s_add_u32 s39, s39, 65536
buffer_load_dwordx4 v50, s[8:11], s39 offen lds
s_add_u32 m0, m0, 1024
s_add_u32 s39, s39, 65536
buffer_load_dwordx4 v50, s[8:11], s39 offen lds
s_add_u32 m0, m0, 1024
s_add_u32 s39, s39, 65536
buffer_load_dwordx4 v50, s[8:11], s39 offen lds
s_add_u32 m0, m0, 1024
s_add_u32 s39, s39, 65536
buffer_load_dwordx4 v50, s[8:11], s39 offen lds
s_add_u32 m0, m0, 1024
s_add_u32 s39, s39, 65536
buffer_load_dwordx4 v50, s[8:11], s39 offen lds
s_add_u32 m0, m0, 1024
s_add_u32 s39, s39, 65536
buffer_load_dwordx4 v50, s[8:11], s39 offen lds
s_waitcnt vmcnt(32)
ds_read_b64_tr_b16 v[192:193], v52 offset:24576
ds_read_b64_tr_b16 v[194:195], v52 offset:26624
ds_read_b64_tr_b16 v[196:197], v52 offset:28672
ds_read_b64_tr_b16 v[198:199], v52 offset:30720
ds_read_b64_tr_b16 v[200:201], v52 offset:24608
ds_read_b64_tr_b16 v[202:203], v52 offset:26656
ds_read_b64_tr_b16 v[204:205], v52 offset:28704
ds_read_b64_tr_b16 v[206:207], v52 offset:30752
ds_read_b64_tr_b16 v[208:209], v52 offset:24640
ds_read_b64_tr_b16 v[210:211], v52 offset:26688
ds_read_b64_tr_b16 v[212:213], v52 offset:28736
ds_read_b64_tr_b16 v[214:215], v52 offset:30784
ds_read_b64_tr_b16 v[216:217], v52 offset:24672
ds_read_b64_tr_b16 v[218:219], v52 offset:26720
ds_read_b64_tr_b16 v[220:221], v52 offset:28768
ds_read_b64_tr_b16 v[222:223], v52 offset:30816
s_waitcnt lgkmcnt(0)
s_mov_b32 s8, s24
s_and_b32 s9, s25, 0xffff
s_mov_b32 s10, 0x800000
s_mov_b32 s11, 0x20000
s_lshl_b32 s39, s33, 2
s_add_u32 s39, s39, s32
s_lshl_b32 s39, s39, 19
s_lshl_b32 s38, s54, 7
s_add_u32 s39, s39, s38
s_add_u32 s39, s39, 0
s_mul_i32 s38, s32, 40960
s_add_u32 m0, s38, 24576
s_nop 0
buffer_load_dwordx4 v51, s[8:11], s39 offen lds
s_add_u32 m0, m0, 1024
s_add_u32 s39, s39, 16384
buffer_load_dwordx4 v51, s[8:11], s39 offen lds
s_add_u32 m0, m0, 1024
s_add_u32 s39, s39, 16384
buffer_load_dwordx4 v51, s[8:11], s39 offen lds
s_add_u32 m0, m0, 1024
s_add_u32 s39, s39, 16384
buffer_load_dwordx4 v51, s[8:11], s39 offen lds
s_add_u32 m0, m0, 1024
s_add_u32 s39, s39, 16384
buffer_load_dwordx4 v51, s[8:11], s39 offen lds
s_add_u32 m0, m0, 1024
s_add_u32 s39, s39, 16384
buffer_load_dwordx4 v51, s[8:11], s39 offen lds
s_add_u32 m0, m0, 1024
s_add_u32 s39, s39, 16384
buffer_load_dwordx4 v51, s[8:11], s39 offen lds
s_add_u32 m0, m0, 1024
s_add_u32 s39, s39, 16384
buffer_load_dwordx4 v51, s[8:11], s39 offen lds
s_waitcnt vmcnt(32)
ds_read_b64_tr_b16 a[32:33], v52 offset:32768
ds_read_b64_tr_b16 a[34:35], v52 offset:34816
ds_read_b64_tr_b16 a[36:37], v52 offset:36864
ds_read_b64_tr_b16 a[38:39], v52 offset:38912
ds_read_b64_tr_b16 a[40:41], v52 offset:32800
ds_read_b64_tr_b16 a[42:43], v52 offset:34848
ds_read_b64_tr_b16 a[44:45], v52 offset:36896
ds_read_b64_tr_b16 a[46:47], v52 offset:38944
ds_read_b64_tr_b16 a[48:49], v52 offset:32832
ds_read_b64_tr_b16 a[50:51], v52 offset:34880
ds_read_b64_tr_b16 a[52:53], v52 offset:36928
ds_read_b64_tr_b16 a[54:55], v52 offset:38976
ds_read_b64_tr_b16 a[56:57], v52 offset:32864
ds_read_b64_tr_b16 a[58:59], v52 offset:34912
ds_read_b64_tr_b16 a[60:61], v52 offset:36960
ds_read_b64_tr_b16 a[62:63], v52 offset:39008
s_waitcnt lgkmcnt(0)
s_mov_b32 s8, s24
s_and_b32 s9, s25, 0xffff
s_mov_b32 s10, 0x800000
s_mov_b32 s11, 0x20000
s_lshl_b32 s39, s33, 2
s_add_u32 s39, s39, s32
s_lshl_b32 s39, s39, 19
s_lshl_b32 s38, s54, 7
s_add_u32 s39, s39, s38
s_add_u32 s39, s39, 131072
s_mul_i32 s38, s32, 40960
s_add_u32 m0, s38, 32768
s_nop 0
buffer_load_dwordx4 v51, s[8:11], s39 offen lds
s_add_u32 m0, m0, 1024
s_add_u32 s39, s39, 16384
buffer_load_dwordx4 v51, s[8:11], s39 offen lds
s_add_u32 m0, m0, 1024
s_add_u32 s39, s39, 16384
buffer_load_dwordx4 v51, s[8:11], s39 offen lds
s_add_u32 m0, m0, 1024
s_add_u32 s39, s39, 16384
buffer_load_dwordx4 v51, s[8:11], s39 offen lds
s_add_u32 m0, m0, 1024
s_add_u32 s39, s39, 16384
buffer_load_dwordx4 v51, s[8:11], s39 offen lds
s_add_u32 m0, m0, 1024
s_add_u32 s39, s39, 16384
buffer_load_dwordx4 v51, s[8:11], s39 offen lds
s_add_u32 m0, m0, 1024
s_add_u32 s39, s39, 16384
buffer_load_dwordx4 v51, s[8:11], s39 offen lds
s_add_u32 m0, m0, 1024
s_add_u32 s39, s39, 16384
buffer_load_dwordx4 v51, s[8:11], s39 offen lds
s_waitcnt vmcnt(32)
ds_read_b64_tr_b16 v[160:161], v52 offset:0
ds_read_b64_tr_b16 v[162:163], v52 offset:2048
ds_read_b64_tr_b16 v[164:165], v52 offset:4096
ds_read_b64_tr_b16 v[166:167], v52 offset:6144
ds_read_b64_tr_b16 v[168:169], v52 offset:32
ds_read_b64_tr_b16 v[170:171], v52 offset:2080
ds_read_b64_tr_b16 v[172:173], v52 offset:4128
ds_read_b64_tr_b16 v[174:175], v52 offset:6176
ds_read_b64_tr_b16 v[176:177], v52 offset:64
ds_read_b64_tr_b16 v[178:179], v52 offset:2112
ds_read_b64_tr_b16 v[180:181], v52 offset:4160
ds_read_b64_tr_b16 v[182:183], v52 offset:6208
ds_read_b64_tr_b16 v[184:185], v52 offset:96
ds_read_b64_tr_b16 v[186:187], v52 offset:2144
ds_read_b64_tr_b16 v[188:189], v52 offset:4192
ds_read_b64_tr_b16 v[190:191], v52 offset:6240
s_waitcnt lgkmcnt(0)
s_mov_b32 s8, s24
s_and_b32 s9, s25, 0xffff
s_mov_b32 s10, 0x800000
s_mov_b32 s11, 0x20000
s_lshl_b32 s39, s33, 2
s_add_u32 s39, s39, s32
s_lshl_b32 s39, s39, 19
s_lshl_b32 s38, s54, 7
s_add_u32 s39, s39, s38
s_add_u32 s39, s39, 262144
s_mul_i32 s38, s32, 40960
s_add_u32 m0, s38, 0
s_nop 0
buffer_load_dwordx4 v51, s[8:11], s39 offen lds
s_add_u32 m0, m0, 1024
s_add_u32 s39, s39, 16384
buffer_load_dwordx4 v51, s[8:11], s39 offen lds
s_add_u32 m0, m0, 1024
s_add_u32 s39, s39, 16384
buffer_load_dwordx4 v51, s[8:11], s39 offen lds
s_add_u32 m0, m0, 1024
s_add_u32 s39, s39, 16384
buffer_load_dwordx4 v51, s[8:11], s39 offen lds
s_add_u32 m0, m0, 1024
s_add_u32 s39, s39, 16384
buffer_load_dwordx4 v51, s[8:11], s39 offen lds
s_add_u32 m0, m0, 1024
s_add_u32 s39, s39, 16384
buffer_load_dwordx4 v51, s[8:11], s39 offen lds
s_add_u32 m0, m0, 1024
s_add_u32 s39, s39, 16384
buffer_load_dwordx4 v51, s[8:11], s39 offen lds
s_add_u32 m0, m0, 1024
s_add_u32 s39, s39, 16384
buffer_load_dwordx4 v51, s[8:11], s39 offen lds
s_waitcnt vmcnt(32)
ds_read_b64_tr_b16 a[0:1], v52 offset:8192
ds_read_b64_tr_b16 a[2:3], v52 offset:10240
ds_read_b64_tr_b16 a[4:5], v52 offset:12288
ds_read_b64_tr_b16 a[6:7], v52 offset:14336
ds_read_b64_tr_b16 a[8:9], v52 offset:8224
ds_read_b64_tr_b16 a[10:11], v52 offset:10272
ds_read_b64_tr_b16 a[12:13], v52 offset:12320
ds_read_b64_tr_b16 a[14:15], v52 offset:14368
ds_read_b64_tr_b16 a[16:17], v52 offset:8256
ds_read_b64_tr_b16 a[18:19], v52 offset:10304
ds_read_b64_tr_b16 a[20:21], v52 offset:12352
ds_read_b64_tr_b16 a[22:23], v52 offset:14400
ds_read_b64_tr_b16 a[24:25], v52 offset:8288
ds_read_b64_tr_b16 a[26:27], v52 offset:10336
ds_read_b64_tr_b16 a[28:29], v52 offset:12384
ds_read_b64_tr_b16 a[30:31], v52 offset:14432
s_waitcnt lgkmcnt(0)
s_mov_b32 s8, s24
s_and_b32 s9, s25, 0xffff
s_mov_b32 s10, 0x800000
s_mov_b32 s11, 0x20000
s_lshl_b32 s39, s33, 2
s_add_u32 s39, s39, s32
s_lshl_b32 s39, s39, 19
s_lshl_b32 s38, s54, 7
s_add_u32 s39, s39, s38
s_add_u32 s39, s39, 393216
s_mul_i32 s38, s32, 40960
s_add_u32 m0, s38, 8192
s_nop 0
buffer_load_dwordx4 v51, s[8:11], s39 offen lds
s_add_u32 m0, m0, 1024
s_add_u32 s39, s39, 16384
buffer_load_dwordx4 v51, s[8:11], s39 offen lds
s_add_u32 m0, m0, 1024
s_add_u32 s39, s39, 16384
buffer_load_dwordx4 v51, s[8:11], s39 offen lds
s_add_u32 m0, m0, 1024
s_add_u32 s39, s39, 16384
buffer_load_dwordx4 v51, s[8:11], s39 offen lds
s_add_u32 m0, m0, 1024
s_add_u32 s39, s39, 16384
buffer_load_dwordx4 v51, s[8:11], s39 offen lds
s_add_u32 m0, m0, 1024
s_add_u32 s39, s39, 16384
buffer_load_dwordx4 v51, s[8:11], s39 offen lds
s_add_u32 m0, m0, 1024
s_add_u32 s39, s39, 16384
buffer_load_dwordx4 v51, s[8:11], s39 offen lds
s_add_u32 m0, m0, 1024
s_add_u32 s39, s39, 16384
buffer_load_dwordx4 v51, s[8:11], s39 offen lds
s_waitcnt vmcnt(32)
ds_read_b64_tr_b16 v[128:129], v52 offset:16384
ds_read_b64_tr_b16 v[130:131], v52 offset:18432
ds_read_b64_tr_b16 v[132:133], v52 offset:20480
ds_read_b64_tr_b16 v[134:135], v52 offset:22528
ds_read_b64_tr_b16 v[136:137], v52 offset:16416
ds_read_b64_tr_b16 v[138:139], v52 offset:18464
ds_read_b64_tr_b16 v[140:141], v52 offset:20512
ds_read_b64_tr_b16 v[142:143], v52 offset:22560
ds_read_b64_tr_b16 v[144:145], v52 offset:16448
ds_read_b64_tr_b16 v[146:147], v52 offset:18496
ds_read_b64_tr_b16 v[148:149], v52 offset:20544
ds_read_b64_tr_b16 v[150:151], v52 offset:22592
ds_read_b64_tr_b16 v[152:153], v52 offset:16480
ds_read_b64_tr_b16 v[154:155], v52 offset:18528
ds_read_b64_tr_b16 v[156:157], v52 offset:20576
ds_read_b64_tr_b16 v[158:159], v52 offset:22624
s_waitcnt lgkmcnt(0)
s_waitcnt vmcnt(24)
ds_read_b64_tr_b16 a[128:129], v53 offset:24576
ds_read_b64_tr_b16 a[130:131], v53 offset:24832
ds_read_b64_tr_b16 a[132:133], v53 offset:28672
ds_read_b64_tr_b16 a[134:135], v53 offset:28928
ds_read_b64_tr_b16 a[136:137], v53 offset:24608
ds_read_b64_tr_b16 a[138:139], v53 offset:24864
ds_read_b64_tr_b16 a[140:141], v53 offset:28704
ds_read_b64_tr_b16 a[142:143], v53 offset:28960
ds_read_b64_tr_b16 a[144:145], v53 offset:24640
ds_read_b64_tr_b16 a[146:147], v53 offset:24896
ds_read_b64_tr_b16 a[148:149], v53 offset:28736
ds_read_b64_tr_b16 a[150:151], v53 offset:28992
ds_read_b64_tr_b16 a[152:153], v53 offset:24672
ds_read_b64_tr_b16 a[154:155], v53 offset:24928
ds_read_b64_tr_b16 a[156:157], v53 offset:28768
ds_read_b64_tr_b16 a[158:159], v53 offset:29024
s_waitcnt lgkmcnt(0)
s_waitcnt vmcnt(16)
ds_read_b64_tr_b16 a[160:161], v53 offset:32768
ds_read_b64_tr_b16 a[162:163], v53 offset:33024
ds_read_b64_tr_b16 a[164:165], v53 offset:36864
ds_read_b64_tr_b16 a[166:167], v53 offset:37120
ds_read_b64_tr_b16 a[168:169], v53 offset:32800
ds_read_b64_tr_b16 a[170:171], v53 offset:33056
ds_read_b64_tr_b16 a[172:173], v53 offset:36896
ds_read_b64_tr_b16 a[174:175], v53 offset:37152
ds_read_b64_tr_b16 a[176:177], v53 offset:32832
ds_read_b64_tr_b16 a[178:179], v53 offset:33088
ds_read_b64_tr_b16 a[180:181], v53 offset:36928
ds_read_b64_tr_b16 a[182:183], v53 offset:37184
ds_read_b64_tr_b16 a[184:185], v53 offset:32864
ds_read_b64_tr_b16 a[186:187], v53 offset:33120
ds_read_b64_tr_b16 a[188:189], v53 offset:36960
ds_read_b64_tr_b16 a[190:191], v53 offset:37216
s_waitcnt lgkmcnt(0)
s_waitcnt vmcnt(8)
ds_read_b64_tr_b16 a[192:193], v53 offset:0
ds_read_b64_tr_b16 a[194:195], v53 offset:256
ds_read_b64_tr_b16 a[196:197], v53 offset:4096
ds_read_b64_tr_b16 a[198:199], v53 offset:4352
ds_read_b64_tr_b16 a[200:201], v53 offset:32
ds_read_b64_tr_b16 a[202:203], v53 offset:288
ds_read_b64_tr_b16 a[204:205], v53 offset:4128
ds_read_b64_tr_b16 a[206:207], v53 offset:4384
ds_read_b64_tr_b16 a[208:209], v53 offset:64
ds_read_b64_tr_b16 a[210:211], v53 offset:320
ds_read_b64_tr_b16 a[212:213], v53 offset:4160
ds_read_b64_tr_b16 a[214:215], v53 offset:4416
ds_read_b64_tr_b16 a[216:217], v53 offset:96
ds_read_b64_tr_b16 a[218:219], v53 offset:352
ds_read_b64_tr_b16 a[220:221], v53 offset:4192
ds_read_b64_tr_b16 a[222:223], v53 offset:4448
s_waitcnt lgkmcnt(0)
s_waitcnt vmcnt(0)
ds_read_b64_tr_b16 a[224:225], v53 offset:8192
ds_read_b64_tr_b16 a[226:227], v53 offset:8448
ds_read_b64_tr_b16 a[228:229], v53 offset:12288
ds_read_b64_tr_b16 a[230:231], v53 offset:12544
ds_read_b64_tr_b16 a[232:233], v53 offset:8224
ds_read_b64_tr_b16 a[234:235], v53 offset:8480
ds_read_b64_tr_b16 a[236:237], v53 offset:12320
ds_read_b64_tr_b16 a[238:239], v53 offset:12576
ds_read_b64_tr_b16 a[240:241], v53 offset:8256
ds_read_b64_tr_b16 a[242:243], v53 offset:8512
ds_read_b64_tr_b16 a[244:245], v53 offset:12352
ds_read_b64_tr_b16 a[246:247], v53 offset:12608
ds_read_b64_tr_b16 a[248:249], v53 offset:8288
ds_read_b64_tr_b16 a[250:251], v53 offset:8544
ds_read_b64_tr_b16 a[252:253], v53 offset:12384
ds_read_b64_tr_b16 a[254:255], v53 offset:12640
s_waitcnt lgkmcnt(0)
Lst_282:
buffer_load_dword v48, off, s[12:15], 0 offset:32 sc1
buffer_load_dword v49, off, s[12:15], 0 offset:160 sc1
s_waitcnt vmcnt(0)
v_add_u32 v48, v48, v49
s_nop 0
v_readfirstlane_b32 s38, v48
s_nop 3
s_and_b32 s39, s38, 0x200ffff
s_cmp_eq_u32 s39, 0x2000100
s_cbranch_scc1 Lso_283
s_sub_u32 s37, s37, 1
s_cbranch_scc1 Lend_1
s_sleep 8
s_branch Lst_282
Lso_283:
s_bfe_u32 s35, s38, 0x80010
s_bfe_u32 s46, s38, 0x10018
s_lshl_b32 s46, s46, 13
s_barrier
s_mul_i32 m0, s32, 2560
v_mov_b32 v44, 0
v_mov_b32 v45, 0
v_mov_b32 v46, 0
v_mov_b32 v47, 0
v_mov_b32 v48, 0
v_mov_b32 v49, 0
v_mov_b32 v50, 0
v_mov_b32 v51, 0
v_mov_b32 v52, 0
v_mov_b32 v53, 0
v_mov_b32 v54, 0
v_mov_b32 v55, 0
v_mov_b32 v56, 0
v_mov_b32 v57, 0
v_mov_b32 v58, 0
v_mov_b32 v59, 0
v_mov_b32 v60, 0
v_mov_b32 v61, 0
v_mov_b32 v62, 0
v_mov_b32 v63, 0
v_mov_b32 v64, 0
v_mov_b32 v65, 0
v_mov_b32 v66, 0
v_mov_b32 v67, 0
v_mov_b32 v68, 0
v_mov_b32 v69, 0
v_mov_b32 v70, 0
v_mov_b32 v71, 0
v_mov_b32 v72, 0
v_mov_b32 v73, 0
v_mov_b32 v74, 0
v_mov_b32 v75, 0
s_mov_b32 s36, 0
s_cmp_lg_u32 s35, 0
s_cbranch_scc1 Lkvo_sc1_284
Lkvo_285:
s_and_b32 s38, s36, 3
s_lshl_b32 s39, s38, 16
s_add_u32 s40, s39, s45
s_xor_b32 s42, s40, 0x20000
s_add_u32 s26, s36, 1
s_mov_b64 exec, 15
buffer_load_dword v4, v1, s[4:7], s59 offen sc1
s_nop 11
buffer_load_dword v5, v1, s[4:7], s59 offen sc1
s_nop 11
buffer_load_dword v6, v1, s[4:7], s59 offen sc1
Lft_289:
s_waitcnt vmcnt(2)
v_cmp_gt_u32 vcc, s26, v4
s_cbranch_vccz Lfg_288
buffer_load_dword v4, v1, s[4:7], s59 offen sc1
s_waitcnt vmcnt(2)
v_cmp_gt_u32 vcc, s26, v5
s_cbranch_vccz Lfg_288
buffer_load_dword v5, v1, s[4:7], s59 offen sc1
s_waitcnt vmcnt(2)
v_cmp_gt_u32 vcc, s26, v6
s_cbranch_vccz Lfg_288
buffer_load_dword v6, v1, s[4:7], s59 offen sc1
s_sub_u32 s37, s37, 1
s_cbranch_scc1 Lend_1
s_branch Lft_289
Lfg_288:
s_mov_b64 exec, -1
Lkvo3_287:
buffer_load_dwordx4 v[28:31], v8, s[4:7], s40 offen offset:0 sc1
v_mfma_f32_16x16x32_bf16 v[16:19], v[20:23], v[20:23], 0
v_mfma_f32_16x16x32_bf16 v[16:19], v[20:23], v[20:23], 0
v_mfma_f32_16x16x32_bf16 v[16:19], v[20:23], v[20:23], 0
v_mfma_f32_16x16x32_bf16 v[16:19], v[20:23], v[20:23], 0
buffer_load_dwordx4 v[32:35], v8, s[4:7], s40 offen offset:1024 sc1
v_mfma_f32_16x16x32_bf16 v[16:19], v[20:23], v[20:23], 0
v_mfma_f32_16x16x32_bf16 v[16:19], v[20:23], v[20:23], 0
v_mfma_f32_16x16x32_bf16 v[16:19], v[20:23], v[20:23], 0
v_mfma_f32_16x16x32_bf16 v[16:19], v[20:23], v[20:23], 0
buffer_load_dwordx4 v[36:39], v8, s[4:7], s40 offen offset:2048 sc1
v_mfma_f32_16x16x32_bf16 v[16:19], v[20:23], v[20:23], 0
v_mfma_f32_16x16x32_bf16 v[16:19], v[20:23], v[20:23], 0
v_mfma_f32_16x16x32_bf16 v[16:19], v[20:23], v[20:23], 0
v_mfma_f32_16x16x32_bf16 v[16:19], v[20:23], v[20:23], 0
buffer_load_dwordx4 v[40:43], v8, s[4:7], s40 offen offset:3072 sc1
v_mfma_f32_16x16x32_bf16 v[16:19], v[20:23], v[20:23], 0
s_waitcnt vmcnt(3)
v_max3_u32 v26, v28, v29, v30
v_max_u32 v26, v26, v31
v_cmp_eq_u32 vcc, -1, v26
s_cbranch_vccnz Lpf_291
v_smfmac_f32_16x16x64_bf16 v[44:47], v[28:31], a[0:7], v126
v_smfmac_f32_16x16x64_bf16 v[48:51], v[28:31], a[8:15], v126
v_smfmac_f32_16x16x64_bf16 v[52:55], v[28:31], a[16:23], v126
v_smfmac_f32_16x16x64_bf16 v[56:59], v[28:31], a[24:31], v126
s_waitcnt vmcnt(2)
v_max3_u32 v26, v32, v33, v34
v_max_u32 v26, v26, v35
v_cmp_eq_u32 vcc, -1, v26
v_smfmac_f32_16x16x64_bf16 v[60:63], v[28:31], v[128:135], v126
v_smfmac_f32_16x16x64_bf16 v[64:67], v[28:31], v[136:143], v126
s_cbranch_vccnz Lpf_292
v_smfmac_f32_16x16x64_bf16 v[44:47], v[32:35], a[32:39], v126
v_smfmac_f32_16x16x64_bf16 v[48:51], v[32:35], a[40:47], v126
v_smfmac_f32_16x16x64_bf16 v[52:55], v[32:35], a[48:55], v126
v_smfmac_f32_16x16x64_bf16 v[56:59], v[32:35], a[56:63], v126
s_waitcnt vmcnt(1)
v_max3_u32 v26, v36, v37, v38
v_max_u32 v26, v26, v39
v_cmp_eq_u32 vcc, -1, v26
v_smfmac_f32_16x16x64_bf16 v[60:63], v[32:35], v[160:167], v126
v_smfmac_f32_16x16x64_bf16 v[64:67], v[32:35], v[168:175], v126
s_cbranch_vccnz Lpf_293
v_smfmac_f32_16x16x64_bf16 v[44:47], v[36:39], a[64:71], v126
v_smfmac_f32_16x16x64_bf16 v[48:51], v[36:39], a[72:79], v126
v_smfmac_f32_16x16x64_bf16 v[52:55], v[36:39], a[80:87], v126
v_smfmac_f32_16x16x64_bf16 v[56:59], v[36:39], a[88:95], v126
s_waitcnt vmcnt(0)
v_max3_u32 v26, v40, v41, v42
v_max_u32 v26, v26, v43
v_cmp_eq_u32 vcc, -1, v26
v_smfmac_f32_16x16x64_bf16 v[60:63], v[36:39], v[192:199], v126
v_smfmac_f32_16x16x64_bf16 v[64:67], v[36:39], v[200:207], v126
s_cbranch_vccnz Lpf_294
v_smfmac_f32_16x16x64_bf16 v[44:47], v[40:43], a[96:103], v126
v_smfmac_f32_16x16x64_bf16 v[48:51], v[40:43], a[104:111], v126
v_smfmac_f32_16x16x64_bf16 v[52:55], v[40:43], a[112:119], v126
v_smfmac_f32_16x16x64_bf16 v[56:59], v[40:43], a[120:127], v126
v_smfmac_f32_16x16x64_bf16 v[60:63], v[40:43], v[224:231], v126
v_smfmac_f32_16x16x64_bf16 v[64:67], v[40:43], v[232:239], v126
Lpd_290:
s_nop 2
v_add_f32 v92, v44, v45
v_add_f32 v93, v46, v47
v_add_f32 v94, v48, v49
v_add_f32 v95, v50, v51
v_add_f32 v96, v52, v53
ds_write_addtid_b32 v92 offset:0
v_add_f32 v97, v54, v55
ds_write_addtid_b32 v93 offset:640
v_add_f32 v98, v56, v57
ds_write_addtid_b32 v94 offset:288
v_add_f32 v99, v58, v59
ds_write_addtid_b32 v95 offset:928
ds_write_addtid_b32 v96 offset:1280
ds_write_addtid_b32 v97 offset:1920
ds_write_addtid_b32 v98 offset:1568
v_smfmac_f32_16x16x64_bf16 v[68:71], v[28:31], v[144:151], v126
ds_write_addtid_b32 v99 offset:2208
v_smfmac_f32_16x16x64_bf16 v[72:75], v[28:31], v[152:159], v126
v_smfmac_f32_16x16x64_bf16 v[68:71], v[32:35], v[176:183], v126
v_smfmac_f32_16x16x64_bf16 v[72:75], v[32:35], v[184:191], v126
s_waitcnt lgkmcnt(0)
s_barrier
ds_read_b64 v[100:101], v24 offset:0
ds_read_b64 v[102:103], v24 offset:2560
ds_read_b64 v[104:105], v24 offset:5120
ds_read_b64 v[106:107], v24 offset:7680
v_smfmac_f32_16x16x64_bf16 v[68:71], v[36:39], v[208:215], v126
v_smfmac_f32_16x16x64_bf16 v[72:75], v[36:39], v[216:223], v126
v_smfmac_f32_16x16x64_bf16 v[68:71], v[40:43], v[240:247], v126
s_waitcnt lgkmcnt(0)
v_pk_add_f32 v[100:101], v[100:101], v[102:103]
v_pk_add_f32 v[104:105], v[104:105], v[106:107]
v_pk_add_f32 v[116:117], v[100:101], v[104:105]
v_cvt_pk_bf16_f32 v116, v116, v117
v_min_u32 v116, -2, v116
buffer_store_dword v116, v11, s[4:7], s40 offen
v_smfmac_f32_16x16x64_bf16 v[72:75], v[40:43], v[248:255], v126
s_nop 5
v_add_f32 v92, v60, v61
v_add_f32 v93, v62, v63
v_add_f32 v94, v64, v65
v_add_f32 v95, v66, v67
v_add_f32 v96, v68, v69
v_add_f32 v97, v70, v71
v_add_f32 v98, v72, v73
v_add_f32 v99, v74, v75
ds_write_b128 v25, v[92:95] offset:20480
ds_write_b128 v25, v[96:99] offset:20496
s_waitcnt lgkmcnt(0)
s_barrier
ds_read_b64 v[100:101], v127 offset:20480
ds_read_b64 v[102:103], v127 offset:22528
ds_read_b64 v[104:105], v127 offset:24576
ds_read_b64 v[106:107], v127 offset:26624
s_waitcnt lgkmcnt(0)
v_pk_add_f32 v[100:101], v[100:101], v[102:103]
v_pk_add_f32 v[104:105], v[104:105], v[106:107]
v_pk_add_f32 v[116:117], v[100:101], v[104:105]
v_cvt_pk_bf16_f32 v116, v116, v117
v_min_u32 v116, -2, v116
buffer_store_dword v116, v27, s[4:7], s40 offen
s_cmp_eq_u32 s36, 63
s_cbranch_scc1 Lend_1
buffer_store_dword v120, v11, s[4:7], s42 offen
buffer_store_dword v120, v27, s[4:7], s42 offen
s_cmp_lt_u32 s32, 2
s_cbranch_scc1 Lr1_295
buffer_store_dwordx2 v[120:121], v10, s[4:7], s42 offen
Lr1_295:
v_pk_mul_f32 v[44:45], 0, 0
v_pk_mul_f32 v[46:47], 0, 0
v_pk_mul_f32 v[48:49], 0, 0
v_pk_mul_f32 v[50:51], 0, 0
v_pk_mul_f32 v[52:53], 0, 0
v_pk_mul_f32 v[54:55], 0, 0
v_pk_mul_f32 v[56:57], 0, 0
v_pk_mul_f32 v[58:59], 0, 0
v_pk_mul_f32 v[60:61], 0, 0
v_pk_mul_f32 v[62:63], 0, 0
v_pk_mul_f32 v[64:65], 0, 0
v_pk_mul_f32 v[66:67], 0, 0
v_pk_mul_f32 v[68:69], 0, 0
v_pk_mul_f32 v[70:71], 0, 0
v_pk_mul_f32 v[72:73], 0, 0
v_pk_mul_f32 v[74:75], 0, 0
v_pk_mul_f32 v[76:77], 0, 0
v_pk_mul_f32 v[78:79], 0, 0
v_pk_mul_f32 v[80:81], 0, 0
v_pk_mul_f32 v[82:83], 0, 0
v_pk_mul_f32 v[84:85], 0, 0
v_pk_mul_f32 v[86:87], 0, 0
v_pk_mul_f32 v[88:89], 0, 0
v_pk_mul_f32 v[90:91], 0, 0
v_add_u32 v7, 1, v7
s_and_b32 s38, s36, 3
s_lshl_b32 s84, s38, 18
s_add_u32 s84, s84, s46
s_add_u32 s85, s84, 0x100000
s_and_b32 s38, s26, 3
s_lshl_b32 s38, s38, 16
s_add_u32 s41, s38, s45
s_mov_b64 exec, 3
buffer_load_dword v4, v2, s[4:7], s59 offen sc1
s_nop 11
buffer_load_dword v5, v2, s[4:7], s59 offen sc1
s_nop 11
buffer_load_dword v6, v2, s[4:7], s59 offen sc1
Lft_297:
s_waitcnt vmcnt(2)
v_cmp_gt_u32 vcc, s26, v4
s_cbranch_vccz Lfg_296
buffer_load_dword v4, v2, s[4:7], s59 offen sc1
s_waitcnt vmcnt(2)
v_cmp_gt_u32 vcc, s26, v5
s_cbranch_vccz Lfg_296
buffer_load_dword v5, v2, s[4:7], s59 offen sc1
s_waitcnt vmcnt(2)
v_cmp_gt_u32 vcc, s26, v6
s_cbranch_vccz Lfg_296
buffer_load_dword v6, v2, s[4:7], s59 offen sc1
s_sub_u32 s37, s37, 1
s_cbranch_scc1 Lend_1
s_branch Lft_297
Lfg_296:
s_mov_b64 exec, -1
buffer_load_dwordx4 v[28:31], v9, s[4:7], s40 offen offset:0 sc1
v_mfma_f32_16x16x32_bf16 v[16:19], v[20:23], v[20:23], 0
v_mfma_f32_16x16x32_bf16 v[16:19], v[20:23], v[20:23], 0
v_mfma_f32_16x16x32_bf16 v[16:19], v[20:23], v[20:23], 0
v_mfma_f32_16x16x32_bf16 v[16:19], v[20:23], v[20:23], 0
buffer_load_dwordx4 v[32:35], v9, s[4:7], s40 offen offset:1024 sc1
v_mfma_f32_16x16x32_bf16 v[16:19], v[20:23], v[20:23], 0
v_mfma_f32_16x16x32_bf16 v[16:19], v[20:23], v[20:23], 0
v_mfma_f32_16x16x32_bf16 v[16:19], v[20:23], v[20:23], 0
v_mfma_f32_16x16x32_bf16 v[16:19], v[20:23], v[20:23], 0
buffer_load_dwordx4 v[36:39], v9, s[4:7], s40 offen offset:2048 sc1
v_mfma_f32_16x16x32_bf16 v[16:19], v[20:23], v[20:23], 0
v_mfma_f32_16x16x32_bf16 v[16:19], v[20:23], v[20:23], 0
v_mfma_f32_16x16x32_bf16 v[16:19], v[20:23], v[20:23], 0
v_mfma_f32_16x16x32_bf16 v[16:19], v[20:23], v[20:23], 0
buffer_load_dwordx4 v[40:43], v9, s[4:7], s40 offen offset:3072 sc1
v_mfma_f32_16x16x32_bf16 v[16:19], v[20:23], v[20:23], 0
s_waitcnt vmcnt(3)
v_max3_u32 v26, v28, v29, v30
v_max_u32 v26, v26, v31
v_cmp_eq_u32 vcc, -1, v26
s_cbranch_vccnz Lpf_299
v_smfmac_f32_16x16x64_bf16 v[76:79], v[28:31], a[128:135], v126
v_smfmac_f32_16x16x64_bf16 v[80:83], v[28:31], a[136:143], v126
s_waitcnt vmcnt(2)
v_max3_u32 v26, v32, v33, v34
v_max_u32 v26, v26, v35
v_cmp_eq_u32 vcc, -1, v26
v_smfmac_f32_16x16x64_bf16 v[84:87], v[28:31], a[144:151], v126
v_smfmac_f32_16x16x64_bf16 v[88:91], v[28:31], a[152:159], v126
s_cbranch_vccnz Lpf_300
v_smfmac_f32_16x16x64_bf16 v[76:79], v[32:35], a[160:167], v126
v_smfmac_f32_16x16x64_bf16 v[80:83], v[32:35], a[168:175], v126
s_waitcnt vmcnt(1)
v_max3_u32 v26, v36, v37, v38
v_max_u32 v26, v26, v39
v_cmp_eq_u32 vcc, -1, v26
v_smfmac_f32_16x16x64_bf16 v[84:87], v[32:35], a[176:183], v126
v_smfmac_f32_16x16x64_bf16 v[88:91], v[32:35], a[184:191], v126
s_cbranch_vccnz Lpf_301
v_smfmac_f32_16x16x64_bf16 v[76:79], v[36:39], a[192:199], v126
v_smfmac_f32_16x16x64_bf16 v[80:83], v[36:39], a[200:207], v126
s_waitcnt vmcnt(0)
v_max3_u32 v26, v40, v41, v42
v_max_u32 v26, v26, v43
v_cmp_eq_u32 vcc, -1, v26
v_smfmac_f32_16x16x64_bf16 v[84:87], v[36:39], a[208:215], v126
v_smfmac_f32_16x16x64_bf16 v[88:91], v[36:39], a[216:223], v126
s_cbranch_vccnz Lpf_302
v_smfmac_f32_16x16x64_bf16 v[76:79], v[40:43], a[224:231], v126
v_smfmac_f32_16x16x64_bf16 v[80:83], v[40:43], a[232:239], v126
v_smfmac_f32_16x16x64_bf16 v[84:87], v[40:43], a[240:247], v126
v_smfmac_f32_16x16x64_bf16 v[88:91], v[40:43], a[248:255], v126
Lpd_298:
s_nop 4
v_add_f32 v92, v76, v77
v_add_f32 v93, v78, v79
v_add_f32 v94, v80, v81
v_add_f32 v95, v82, v83
v_add_f32 v96, v84, v85
ds_write_addtid_b32 v92 offset:10240
v_add_f32 v97, v86, v87
ds_write_addtid_b32 v93 offset:10528
v_add_f32 v98, v88, v89
ds_write_addtid_b32 v94 offset:10816
v_add_f32 v99, v90, v91
ds_write_addtid_b32 v95 offset:11104
ds_write_addtid_b32 v96 offset:11392
ds_write_addtid_b32 v97 offset:11680
ds_write_addtid_b32 v98 offset:11968
ds_write_addtid_b32 v99 offset:12256
v_mfma_f32_16x16x32_bf16 v[16:19], v[20:23], v[20:23], 0
v_mfma_f32_16x16x32_bf16 v[16:19], v[20:23], v[20:23], 0
s_cmp_ge_u32 s32, 2
s_cbranch_scc1 Lxl_303
s_waitcnt lgkmcnt(0)
s_barrier
ds_read_b64 v[100:101], v0 offset:10240
ds_read_b64 v[102:103], v0 offset:10816
ds_read_b64 v[104:105], v0 offset:12800
ds_read_b64 v[106:107], v0 offset:13376
ds_read_b64 v[108:109], v0 offset:15360
ds_read_b64 v[110:111], v0 offset:15936
ds_read_b64 v[112:113], v0 offset:17920
ds_read_b64 v[114:115], v0 offset:18496
s_waitcnt lgkmcnt(4)
v_pk_add_f32 v[100:101], v[100:101], v[104:105]
v_pk_add_f32 v[102:103], v[102:103], v[106:107]
s_waitcnt lgkmcnt(0)
v_pk_add_f32 v[108:109], v[108:109], v[112:113]
v_pk_add_f32 v[110:111], v[110:111], v[114:115]
v_pk_add_f32 v[116:117], v[100:101], v[108:109]
v_pk_add_f32 v[118:119], v[102:103], v[110:111]
v_cvt_pk_bf16_f32 v116, v116, v117
v_cvt_pk_bf16_f32 v117, v118, v119
v_min_u32 v116, -2, v116
v_min_u32 v117, -2, v117
buffer_store_dwordx2 v[116:117], v12, s[4:7], s84 offen sc1
buffer_store_dwordx2 v[116:117], v12, s[4:7], s85 offen sc1
v_mfma_f32_16x16x32_bf16 v[16:19], v[20:23], v[20:23], 0
v_mfma_f32_16x16x32_bf16 v[16:19], v[20:23], v[20:23], 0
v_mfma_f32_16x16x32_bf16 v[16:19], v[20:23], v[20:23], 0
v_mfma_f32_16x16x32_bf16 v[16:19], v[20:23], v[20:23], 0
v_mfma_f32_16x16x32_bf16 v[16:19], v[20:23], v[20:23], 0
v_mfma_f32_16x16x32_bf16 v[16:19], v[20:23], v[20:23], 0
v_mfma_f32_16x16x32_bf16 v[16:19], v[20:23], v[20:23], 0
v_mfma_f32_16x16x32_bf16 v[16:19], v[20:23], v[20:23], 0
v_mfma_f32_16x16x32_bf16 v[16:19], v[20:23], v[20:23], 0
v_mfma_f32_16x16x32_bf16 v[16:19], v[20:23], v[20:23], 0
v_mfma_f32_16x16x32_bf16 v[16:19], v[20:23], v[20:23], 0
v_mfma_f32_16x16x32_bf16 v[16:19], v[20:23], v[20:23], 0
v_mfma_f32_16x16x32_bf16 v[16:19], v[20:23], v[20:23], 0
v_mfma_f32_16x16x32_bf16 v[16:19], v[20:23], v[20:23], 0
v_mfma_f32_16x16x32_bf16 v[16:19], v[20:23], v[20:23], 0
v_mfma_f32_16x16x32_bf16 v[16:19], v[20:23], v[20:23], 0
v_mfma_f32_16x16x32_bf16 v[16:19], v[20:23], v[20:23], 0
v_mfma_f32_16x16x32_bf16 v[16:19], v[20:23], v[20:23], 0
v_mfma_f32_16x16x32_bf16 v[16:19], v[20:23], v[20:23], 0
v_mfma_f32_16x16x32_bf16 v[16:19], v[20:23], v[20:23], 0
v_mfma_f32_16x16x32_bf16 v[16:19], v[20:23], v[20:23], 0
v_mfma_f32_16x16x32_bf16 v[16:19], v[20:23], v[20:23], 0
v_mfma_f32_16x16x32_bf16 v[16:19], v[20:23], v[20:23], 0
v_mfma_f32_16x16x32_bf16 v[16:19], v[20:23], v[20:23], 0
v_mfma_f32_16x16x32_bf16 v[16:19], v[20:23], v[20:23], 0
v_mfma_f32_16x16x32_bf16 v[16:19], v[20:23], v[20:23], 0
v_mfma_f32_16x16x32_bf16 v[16:19], v[20:23], v[20:23], 0
v_mfma_f32_16x16x32_bf16 v[16:19], v[20:23], v[20:23], 0
v_mfma_f32_16x16x32_bf16 v[16:19], v[20:23], v[20:23], 0
v_mfma_f32_16x16x32_bf16 v[16:19], v[20:23], v[20:23], 0
v_mfma_f32_16x16x32_bf16 v[16:19], v[20:23], v[20:23], 0
v_mfma_f32_16x16x32_bf16 v[16:19], v[20:23], v[20:23], 0
v_mfma_f32_16x16x32_bf16 v[16:19], v[20:23], v[20:23], 0
v_mfma_f32_16x16x32_bf16 v[16:19], v[20:23], v[20:23], 0
v_mfma_f32_16x16x32_bf16 v[16:19], v[20:23], v[20:23], 0
v_mfma_f32_16x16x32_bf16 v[16:19], v[20:23], v[20:23], 0
buffer_store_dword v7, v3, s[4:7], s59 offen
s_add_u32 s36, s36, 1
s_branch Lkvo_285
Lxl_303:
s_waitcnt lgkmcnt(0)
s_barrier
v_mfma_f32_16x16x32_bf16 v[16:19], v[20:23], v[20:23], 0
v_mfma_f32_16x16x32_bf16 v[16:19], v[20:23], v[20:23], 0
v_mfma_f32_16x16x32_bf16 v[16:19], v[20:23], v[20:23], 0
v_mfma_f32_16x16x32_bf16 v[16:19], v[20:23], v[20:23], 0
v_mfma_f32_16x16x32_bf16 v[16:19], v[20:23], v[20:23], 0
v_mfma_f32_16x16x32_bf16 v[16:19], v[20:23], v[20:23], 0
v_mfma_f32_16x16x32_bf16 v[16:19], v[20:23], v[20:23], 0
v_mfma_f32_16x16x32_bf16 v[16:19], v[20:23], v[20:23], 0
v_mfma_f32_16x16x32_bf16 v[16:19], v[20:23], v[20:23], 0
v_mfma_f32_16x16x32_bf16 v[16:19], v[20:23], v[20:23], 0
v_mfma_f32_16x16x32_bf16 v[16:19], v[20:23], v[20:23], 0
v_mfma_f32_16x16x32_bf16 v[16:19], v[20:23], v[20:23], 0
v_mfma_f32_16x16x32_bf16 v[16:19], v[20:23], v[20:23], 0
v_mfma_f32_16x16x32_bf16 v[16:19], v[20:23], v[20:23], 0
v_mfma_f32_16x16x32_bf16 v[16:19], v[20:23], v[20:23], 0
v_mfma_f32_16x16x32_bf16 v[16:19], v[20:23], v[20:23], 0
v_mfma_f32_16x16x32_bf16 v[16:19], v[20:23], v[20:23], 0
v_mfma_f32_16x16x32_bf16 v[16:19], v[20:23], v[20:23], 0
v_mfma_f32_16x16x32_bf16 v[16:19], v[20:23], v[20:23], 0
v_mfma_f32_16x16x32_bf16 v[16:19], v[20:23], v[20:23], 0
v_mfma_f32_16x16x32_bf16 v[16:19], v[20:23], v[20:23], 0
v_mfma_f32_16x16x32_bf16 v[16:19], v[20:23], v[20:23], 0
v_mfma_f32_16x16x32_bf16 v[16:19], v[20:23], v[20:23], 0
v_mfma_f32_16x16x32_bf16 v[16:19], v[20:23], v[20:23], 0
v_mfma_f32_16x16x32_bf16 v[16:19], v[20:23], v[20:23], 0
v_mfma_f32_16x16x32_bf16 v[16:19], v[20:23], v[20:23], 0
v_mfma_f32_16x16x32_bf16 v[16:19], v[20:23], v[20:23], 0
v_mfma_f32_16x16x32_bf16 v[16:19], v[20:23], v[20:23], 0
buffer_load_dwordx2 v[76:77], v13, s[4:7], s84 offen sc1
buffer_load_dwordx2 v[78:79], v14, s[4:7], s84 offen sc1
buffer_load_dwordx2 v[80:81], v15, s[4:7], s84 offen sc1
v_mfma_f32_16x16x32_bf16 v[16:19], v[20:23], v[20:23], 0
v_mfma_f32_16x16x32_bf16 v[16:19], v[20:23], v[20:23], 0
v_mfma_f32_16x16x32_bf16 v[16:19], v[20:23], v[20:23], 0
v_mfma_f32_16x16x32_bf16 v[16:19], v[20:23], v[20:23], 0
v_mfma_f32_16x16x32_bf16 v[16:19], v[20:23], v[20:23], 0
v_mfma_f32_16x16x32_bf16 v[16:19], v[20:23], v[20:23], 0
v_mfma_f32_16x16x32_bf16 v[16:19], v[20:23], v[20:23], 0
v_mfma_f32_16x16x32_bf16 v[16:19], v[20:23], v[20:23], 0
v_mfma_f32_16x16x32_bf16 v[16:19], v[20:23], v[20:23], 0
v_mfma_f32_16x16x32_bf16 v[16:19], v[20:23], v[20:23], 0
v_mfma_f32_16x16x32_bf16 v[16:19], v[20:23], v[20:23], 0
v_mfma_f32_16x16x32_bf16 v[16:19], v[20:23], v[20:23], 0
buffer_load_dwordx2 v[88:89], v13, s[4:7], s85 offen sc1
buffer_load_dwordx2 v[90:91], v14, s[4:7], s85 offen sc1
buffer_load_dwordx2 v[92:93], v15, s[4:7], s85 offen sc1
ds_read_b64 v[100:101], v0 offset:10240
ds_read_b64 v[102:103], v0 offset:10816
ds_read_b64 v[104:105], v0 offset:12800
ds_read_b64 v[106:107], v0 offset:13376
ds_read_b64 v[108:109], v0 offset:15360
ds_read_b64 v[110:111], v0 offset:15936
ds_read_b64 v[112:113], v0 offset:17920
ds_read_b64 v[114:115], v0 offset:18496
s_waitcnt lgkmcnt(4)
v_pk_add_f32 v[100:101], v[100:101], v[104:105]
v_pk_add_f32 v[102:103], v[102:103], v[106:107]
s_waitcnt lgkmcnt(0)
v_pk_add_f32 v[108:109], v[108:109], v[112:113]
v_pk_add_f32 v[110:111], v[110:111], v[114:115]
v_pk_add_f32 v[116:117], v[100:101], v[108:109]
v_pk_add_f32 v[118:119], v[102:103], v[110:111]
v_cvt_pk_bf16_f32 v100, v116, v117
v_cvt_pk_bf16_f32 v101, v118, v119
v_lshlrev_b32 v116, 16, v100
v_and_b32 v117, 0xffff0000, v100
v_lshlrev_b32 v118, 16, v101
v_and_b32 v119, 0xffff0000, v101
v_mfma_f32_16x16x32_bf16 v[16:19], v[20:23], v[20:23], 0
v_mfma_f32_16x16x32_bf16 v[16:19], v[20:23], v[20:23], 0
v_mfma_f32_16x16x32_bf16 v[16:19], v[20:23], v[20:23], 0
v_mfma_f32_16x16x32_bf16 v[16:19], v[20:23], v[20:23], 0
buffer_load_dwordx2 v[28:29], v13, s[4:7], s84 offen sc1
buffer_load_dwordx2 v[30:31], v14, s[4:7], s84 offen sc1
buffer_load_dwordx2 v[32:33], v15, s[4:7], s84 offen sc1
s_waitcnt vmcnt(6)
v_max3_u32 v26, v76, v77, v78
v_max3_u32 v26, v26, v79, v80
v_max_u32 v26, v26, v81
v_cmp_eq_u32 vcc, -1, v26
v_dot2_f32_bf16 v100, v76, s55, v116
v_dot2_f32_bf16 v101, v76, s56, v117
v_dot2_f32_bf16 v102, v77, s55, v118
v_dot2_f32_bf16 v103, v77, s56, v119
v_dot2_f32_bf16 v100, v78, s55, v100
v_dot2_f32_bf16 v101, v78, s56, v101
v_dot2_f32_bf16 v102, v79, s55, v102
v_dot2_f32_bf16 v103, v79, s56, v103
v_dot2_f32_bf16 v100, v80, s55, v100
v_dot2_f32_bf16 v101, v80, s56, v101
v_dot2_f32_bf16 v102, v81, s55, v102
v_dot2_f32_bf16 v103, v81, s56, v103
s_nop 1
v_cvt_pk_bf16_f32 v100, v100, v101
v_cvt_pk_bf16_f32 v101, v102, v103
v_min_u32 v100, -2, v100
v_min_u32 v101, -2, v101
s_cbranch_vccnz Lx2_304
Lxs_305:
buffer_store_dwordx2 v[100:101], v10, s[4:7], s41 offen
s_add_u32 s36, s36, 1
s_and_b32 s38, s36, 3
s_lshl_b32 s39, s38, 16
s_add_u32 s40, s39, s45
s_xor_b32 s42, s40, 0x20000
s_add_u32 s26, s36, 1
v_mfma_f32_16x16x32_bf16 v[16:19], v[20:23], v[20:23], 0
v_mfma_f32_16x16x32_bf16 v[16:19], v[20:23], v[20:23], 0
v_mfma_f32_16x16x32_bf16 v[16:19], v[20:23], v[20:23], 0
v_mfma_f32_16x16x32_bf16 v[16:19], v[20:23], v[20:23], 0
v_mfma_f32_16x16x32_bf16 v[16:19], v[20:23], v[20:23], 0
v_mfma_f32_16x16x32_bf16 v[16:19], v[20:23], v[20:23], 0
v_mfma_f32_16x16x32_bf16 v[16:19], v[20:23], v[20:23], 0
v_mfma_f32_16x16x32_bf16 v[16:19], v[20:23], v[20:23], 0
s_branch Lkvo3_287
Lx2_304:
buffer_load_dwordx2 v[76:77], v13, s[4:7], s85 offen sc1
buffer_load_dwordx2 v[78:79], v14, s[4:7], s85 offen sc1
buffer_load_dwordx2 v[80:81], v15, s[4:7], s85 offen sc1
s_waitcnt vmcnt(6)
v_max3_u32 v26, v88, v89, v90
v_max3_u32 v26, v26, v91, v92
v_max_u32 v26, v26, v93
v_cmp_eq_u32 vcc, -1, v26
v_dot2_f32_bf16 v100, v88, s55, v116
v_dot2_f32_bf16 v101, v88, s56, v117
v_dot2_f32_bf16 v102, v89, s55, v118
v_dot2_f32_bf16 v103, v89, s56, v119
v_dot2_f32_bf16 v100, v90, s55, v100
v_dot2_f32_bf16 v101, v90, s56, v101
v_dot2_f32_bf16 v102, v91, s55, v102
v_dot2_f32_bf16 v103, v91, s56, v103
v_dot2_f32_bf16 v100, v92, s55, v100
v_dot2_f32_bf16 v101, v92, s56, v101
v_dot2_f32_bf16 v102, v93, s55, v102
v_dot2_f32_bf16 v103, v93, s56, v103
s_nop 1
v_cvt_pk_bf16_f32 v100, v100, v101
v_cvt_pk_bf16_f32 v101, v102, v103
v_min_u32 v100, -2, v100
v_min_u32 v101, -2, v101
s_cbranch_vccz Lxs_305
buffer_load_dwordx2 v[88:89], v13, s[4:7], s84 offen sc1
buffer_load_dwordx2 v[90:91], v14, s[4:7], s84 offen sc1
buffer_load_dwordx2 v[92:93], v15, s[4:7], s84 offen sc1
s_waitcnt vmcnt(6)
v_max3_u32 v26, v28, v29, v30
v_max3_u32 v26, v26, v31, v32
v_max_u32 v26, v26, v33
v_cmp_eq_u32 vcc, -1, v26
v_dot2_f32_bf16 v100, v28, s55, v116
v_dot2_f32_bf16 v101, v28, s56, v117
v_dot2_f32_bf16 v102, v29, s55, v118
v_dot2_f32_bf16 v103, v29, s56, v119
v_dot2_f32_bf16 v100, v30, s55, v100
v_dot2_f32_bf16 v101, v30, s56, v101
v_dot2_f32_bf16 v102, v31, s55, v102
v_dot2_f32_bf16 v103, v31, s56, v103
v_dot2_f32_bf16 v100, v32, s55, v100
v_dot2_f32_bf16 v101, v32, s56, v101
v_dot2_f32_bf16 v102, v33, s55, v102
v_dot2_f32_bf16 v103, v33, s56, v103
s_nop 1
v_cvt_pk_bf16_f32 v100, v100, v101
v_cvt_pk_bf16_f32 v101, v102, v103
v_min_u32 v100, -2, v100
v_min_u32 v101, -2, v101
s_cbranch_vccz Lxs_305
buffer_load_dwordx2 v[28:29], v13, s[4:7], s85 offen sc1
buffer_load_dwordx2 v[30:31], v14, s[4:7], s85 offen sc1
buffer_load_dwordx2 v[32:33], v15, s[4:7], s85 offen sc1
s_waitcnt vmcnt(6)
v_max3_u32 v26, v76, v77, v78
v_max3_u32 v26, v26, v79, v80
v_max_u32 v26, v26, v81
v_cmp_eq_u32 vcc, -1, v26
v_dot2_f32_bf16 v100, v76, s55, v116
v_dot2_f32_bf16 v101, v76, s56, v117
v_dot2_f32_bf16 v102, v77, s55, v118
v_dot2_f32_bf16 v103, v77, s56, v119
v_dot2_f32_bf16 v100, v78, s55, v100
v_dot2_f32_bf16 v101, v78, s56, v101
v_dot2_f32_bf16 v102, v79, s55, v102
v_dot2_f32_bf16 v103, v79, s56, v103
v_dot2_f32_bf16 v100, v80, s55, v100
v_dot2_f32_bf16 v101, v80, s56, v101
v_dot2_f32_bf16 v102, v81, s55, v102
v_dot2_f32_bf16 v103, v81, s56, v103
s_nop 1
v_cvt_pk_bf16_f32 v100, v100, v101
v_cvt_pk_bf16_f32 v101, v102, v103
v_min_u32 v100, -2, v100
v_min_u32 v101, -2, v101
s_cbranch_vccz Lxs_305
buffer_load_dwordx2 v[76:77], v13, s[4:7], s84 offen sc1
buffer_load_dwordx2 v[78:79], v14, s[4:7], s84 offen sc1
buffer_load_dwordx2 v[80:81], v15, s[4:7], s84 offen sc1
s_waitcnt vmcnt(6)
v_max3_u32 v26, v88, v89, v90
v_max3_u32 v26, v26, v91, v92
v_max_u32 v26, v26, v93
v_cmp_eq_u32 vcc, -1, v26
v_dot2_f32_bf16 v100, v88, s55, v116
v_dot2_f32_bf16 v101, v88, s56, v117
v_dot2_f32_bf16 v102, v89, s55, v118
v_dot2_f32_bf16 v103, v89, s56, v119
v_dot2_f32_bf16 v100, v90, s55, v100
v_dot2_f32_bf16 v101, v90, s56, v101
v_dot2_f32_bf16 v102, v91, s55, v102
v_dot2_f32_bf16 v103, v91, s56, v103
v_dot2_f32_bf16 v100, v92, s55, v100
v_dot2_f32_bf16 v101, v92, s56, v101
v_dot2_f32_bf16 v102, v93, s55, v102
v_dot2_f32_bf16 v103, v93, s56, v103
s_nop 1
v_cvt_pk_bf16_f32 v100, v100, v101
v_cvt_pk_bf16_f32 v101, v102, v103
v_min_u32 v100, -2, v100
v_min_u32 v101, -2, v101
s_cbranch_vccz Lxs_305
buffer_load_dwordx2 v[88:89], v13, s[4:7], s85 offen sc1
buffer_load_dwordx2 v[90:91], v14, s[4:7], s85 offen sc1
buffer_load_dwordx2 v[92:93], v15, s[4:7], s85 offen sc1
s_waitcnt vmcnt(6)
v_max3_u32 v26, v28, v29, v30
v_max3_u32 v26, v26, v31, v32
v_max_u32 v26, v26, v33
v_cmp_eq_u32 vcc, -1, v26
v_dot2_f32_bf16 v100, v28, s55, v116
v_dot2_f32_bf16 v101, v28, s56, v117
v_dot2_f32_bf16 v102, v29, s55, v118
v_dot2_f32_bf16 v103, v29, s56, v119
v_dot2_f32_bf16 v100, v30, s55, v100
v_dot2_f32_bf16 v101, v30, s56, v101
v_dot2_f32_bf16 v102, v31, s55, v102
v_dot2_f32_bf16 v103, v31, s56, v103
v_dot2_f32_bf16 v100, v32, s55, v100
v_dot2_f32_bf16 v101, v32, s56, v101
v_dot2_f32_bf16 v102, v33, s55, v102
v_dot2_f32_bf16 v103, v33, s56, v103
s_nop 1
v_cvt_pk_bf16_f32 v100, v100, v101
v_cvt_pk_bf16_f32 v101, v102, v103
v_min_u32 v100, -2, v100
v_min_u32 v101, -2, v101
s_cbranch_vccz Lxs_305
buffer_load_dwordx2 v[28:29], v13, s[4:7], s84 offen sc1
buffer_load_dwordx2 v[30:31], v14, s[4:7], s84 offen sc1
buffer_load_dwordx2 v[32:33], v15, s[4:7], s84 offen sc1
s_waitcnt vmcnt(6)
v_max3_u32 v26, v76, v77, v78
v_max3_u32 v26, v26, v79, v80
v_max_u32 v26, v26, v81
v_cmp_eq_u32 vcc, -1, v26
v_dot2_f32_bf16 v100, v76, s55, v116
v_dot2_f32_bf16 v101, v76, s56, v117
v_dot2_f32_bf16 v102, v77, s55, v118
v_dot2_f32_bf16 v103, v77, s56, v119
v_dot2_f32_bf16 v100, v78, s55, v100
v_dot2_f32_bf16 v101, v78, s56, v101
v_dot2_f32_bf16 v102, v79, s55, v102
v_dot2_f32_bf16 v103, v79, s56, v103
v_dot2_f32_bf16 v100, v80, s55, v100
v_dot2_f32_bf16 v101, v80, s56, v101
v_dot2_f32_bf16 v102, v81, s55, v102
v_dot2_f32_bf16 v103, v81, s56, v103
s_nop 1
v_cvt_pk_bf16_f32 v100, v100, v101
v_cvt_pk_bf16_f32 v101, v102, v103
v_min_u32 v100, -2, v100
v_min_u32 v101, -2, v101
s_cbranch_vccz Lxs_305
s_sub_u32 s37, s37, 1
s_cbranch_scc1 Lend_1
s_branch Lx2_304
Lpf_291:
buffer_load_dwordx4 v[28:31], v8, s[4:7], s40 offen offset:0 sc1
v_mfma_f32_16x16x32_bf16 v[16:19], v[20:23], v[20:23], 0
s_sub_u32 s37, s37, 1
s_cbranch_scc1 Lend_1
Lps_306:
s_waitcnt vmcnt(3)
v_max3_u32 v26, v32, v33, v34
v_max_u32 v26, v26, v35
v_cmp_eq_u32 vcc, -1, v26
s_cbranch_vccnz Lpf_307
v_smfmac_f32_16x16x64_bf16 v[44:47], v[32:35], a[32:39], v126
v_smfmac_f32_16x16x64_bf16 v[48:51], v[32:35], a[40:47], v126
v_smfmac_f32_16x16x64_bf16 v[52:55], v[32:35], a[48:55], v126
v_smfmac_f32_16x16x64_bf16 v[56:59], v[32:35], a[56:63], v126
v_smfmac_f32_16x16x64_bf16 v[60:63], v[32:35], v[160:167], v126
v_smfmac_f32_16x16x64_bf16 v[64:67], v[32:35], v[168:175], v126
Lps_308:
s_waitcnt vmcnt(2)
v_max3_u32 v26, v36, v37, v38
v_max_u32 v26, v26, v39
v_cmp_eq_u32 vcc, -1, v26
s_cbranch_vccnz Lpf_309
v_smfmac_f32_16x16x64_bf16 v[44:47], v[36:39], a[64:71], v126
v_smfmac_f32_16x16x64_bf16 v[48:51], v[36:39], a[72:79], v126
v_smfmac_f32_16x16x64_bf16 v[52:55], v[36:39], a[80:87], v126
v_smfmac_f32_16x16x64_bf16 v[56:59], v[36:39], a[88:95], v126
v_smfmac_f32_16x16x64_bf16 v[60:63], v[36:39], v[192:199], v126
v_smfmac_f32_16x16x64_bf16 v[64:67], v[36:39], v[200:207], v126
Lps_310:
s_waitcnt vmcnt(1)
v_max3_u32 v26, v40, v41, v42
v_max_u32 v26, v26, v43
v_cmp_eq_u32 vcc, -1, v26
s_cbranch_vccnz Lpf_311
v_smfmac_f32_16x16x64_bf16 v[44:47], v[40:43], a[96:103], v126
v_smfmac_f32_16x16x64_bf16 v[48:51], v[40:43], a[104:111], v126
v_smfmac_f32_16x16x64_bf16 v[52:55], v[40:43], a[112:119], v126
v_smfmac_f32_16x16x64_bf16 v[56:59], v[40:43], a[120:127], v126
v_smfmac_f32_16x16x64_bf16 v[60:63], v[40:43], v[224:231], v126
v_smfmac_f32_16x16x64_bf16 v[64:67], v[40:43], v[232:239], v126
Lps_312:
s_waitcnt vmcnt(0)
v_max3_u32 v26, v28, v29, v30
v_max_u32 v26, v26, v31
v_cmp_eq_u32 vcc, -1, v26
s_cbranch_vccnz Lpf_313
v_smfmac_f32_16x16x64_bf16 v[44:47], v[28:31], a[0:7], v126
v_smfmac_f32_16x16x64_bf16 v[48:51], v[28:31], a[8:15], v126
v_smfmac_f32_16x16x64_bf16 v[52:55], v[28:31], a[16:23], v126
v_smfmac_f32_16x16x64_bf16 v[56:59], v[28:31], a[24:31], v126
v_smfmac_f32_16x16x64_bf16 v[60:63], v[28:31], v[128:135], v126
v_smfmac_f32_16x16x64_bf16 v[64:67], v[28:31], v[136:143], v126
s_branch Lpd_290
Lpf_292:
buffer_load_dwordx4 v[32:35], v8, s[4:7], s40 offen offset:1024 sc1
v_mfma_f32_16x16x32_bf16 v[16:19], v[20:23], v[20:23], 0
s_sub_u32 s37, s37, 1
s_cbranch_scc1 Lend_1
Lps_314:
s_waitcnt vmcnt(2)
v_max3_u32 v26, v36, v37, v38
v_max_u32 v26, v26, v39
v_cmp_eq_u32 vcc, -1, v26
s_cbranch_vccnz Lpf_315
v_smfmac_f32_16x16x64_bf16 v[44:47], v[36:39], a[64:71], v126
v_smfmac_f32_16x16x64_bf16 v[48:51], v[36:39], a[72:79], v126
v_smfmac_f32_16x16x64_bf16 v[52:55], v[36:39], a[80:87], v126
v_smfmac_f32_16x16x64_bf16 v[56:59], v[36:39], a[88:95], v126
v_smfmac_f32_16x16x64_bf16 v[60:63], v[36:39], v[192:199], v126
v_smfmac_f32_16x16x64_bf16 v[64:67], v[36:39], v[200:207], v126
Lps_316:
s_waitcnt vmcnt(1)
v_max3_u32 v26, v40, v41, v42
v_max_u32 v26, v26, v43
v_cmp_eq_u32 vcc, -1, v26
s_cbranch_vccnz Lpf_317
v_smfmac_f32_16x16x64_bf16 v[44:47], v[40:43], a[96:103], v126
v_smfmac_f32_16x16x64_bf16 v[48:51], v[40:43], a[104:111], v126
v_smfmac_f32_16x16x64_bf16 v[52:55], v[40:43], a[112:119], v126
v_smfmac_f32_16x16x64_bf16 v[56:59], v[40:43], a[120:127], v126
v_smfmac_f32_16x16x64_bf16 v[60:63], v[40:43], v[224:231], v126
v_smfmac_f32_16x16x64_bf16 v[64:67], v[40:43], v[232:239], v126
Lps_318:
s_waitcnt vmcnt(0)
v_max3_u32 v26, v32, v33, v34
v_max_u32 v26, v26, v35
v_cmp_eq_u32 vcc, -1, v26
s_cbranch_vccnz Lpf_319
v_smfmac_f32_16x16x64_bf16 v[44:47], v[32:35], a[32:39], v126
v_smfmac_f32_16x16x64_bf16 v[48:51], v[32:35], a[40:47], v126
v_smfmac_f32_16x16x64_bf16 v[52:55], v[32:35], a[48:55], v126
v_smfmac_f32_16x16x64_bf16 v[56:59], v[32:35], a[56:63], v126
v_smfmac_f32_16x16x64_bf16 v[60:63], v[32:35], v[160:167], v126
v_smfmac_f32_16x16x64_bf16 v[64:67], v[32:35], v[168:175], v126
s_branch Lpd_290
Lpf_293:
buffer_load_dwordx4 v[36:39], v8, s[4:7], s40 offen offset:2048 sc1
v_mfma_f32_16x16x32_bf16 v[16:19], v[20:23], v[20:23], 0
s_sub_u32 s37, s37, 1
s_cbranch_scc1 Lend_1
Lps_320:
s_waitcnt vmcnt(1)
v_max3_u32 v26, v40, v41, v42
v_max_u32 v26, v26, v43
v_cmp_eq_u32 vcc, -1, v26
s_cbranch_vccnz Lpf_321
v_smfmac_f32_16x16x64_bf16 v[44:47], v[40:43], a[96:103], v126
v_smfmac_f32_16x16x64_bf16 v[48:51], v[40:43], a[104:111], v126
v_smfmac_f32_16x16x64_bf16 v[52:55], v[40:43], a[112:119], v126
v_smfmac_f32_16x16x64_bf16 v[56:59], v[40:43], a[120:127], v126
v_smfmac_f32_16x16x64_bf16 v[60:63], v[40:43], v[224:231], v126
v_smfmac_f32_16x16x64_bf16 v[64:67], v[40:43], v[232:239], v126
Lps_322:
s_waitcnt vmcnt(0)
v_max3_u32 v26, v36, v37, v38
v_max_u32 v26, v26, v39
v_cmp_eq_u32 vcc, -1, v26
s_cbranch_vccnz Lpf_323
v_smfmac_f32_16x16x64_bf16 v[44:47], v[36:39], a[64:71], v126
v_smfmac_f32_16x16x64_bf16 v[48:51], v[36:39], a[72:79], v126
v_smfmac_f32_16x16x64_bf16 v[52:55], v[36:39], a[80:87], v126
v_smfmac_f32_16x16x64_bf16 v[56:59], v[36:39], a[88:95], v126
v_smfmac_f32_16x16x64_bf16 v[60:63], v[36:39], v[192:199], v126
v_smfmac_f32_16x16x64_bf16 v[64:67], v[36:39], v[200:207], v126
s_branch Lpd_290
Lpf_294:
buffer_load_dwordx4 v[40:43], v8, s[4:7], s40 offen offset:3072 sc1
v_mfma_f32_16x16x32_bf16 v[16:19], v[20:23], v[20:23], 0
s_sub_u32 s37, s37, 1
s_cbranch_scc1 Lend_1
Lps_324:
s_waitcnt vmcnt(0)
v_max3_u32 v26, v40, v41, v42
v_max_u32 v26, v26, v43
v_cmp_eq_u32 vcc, -1, v26
s_cbranch_vccnz Lpf_325
v_smfmac_f32_16x16x64_bf16 v[44:47], v[40:43], a[96:103], v126
v_smfmac_f32_16x16x64_bf16 v[48:51], v[40:43], a[104:111], v126
v_smfmac_f32_16x16x64_bf16 v[52:55], v[40:43], a[112:119], v126
v_smfmac_f32_16x16x64_bf16 v[56:59], v[40:43], a[120:127], v126
v_smfmac_f32_16x16x64_bf16 v[60:63], v[40:43], v[224:231], v126
v_smfmac_f32_16x16x64_bf16 v[64:67], v[40:43], v[232:239], v126
s_branch Lpd_290
Lpf_307:
buffer_load_dwordx4 v[32:35], v8, s[4:7], s40 offen offset:1024 sc1
v_mfma_f32_16x16x32_bf16 v[16:19], v[20:23], v[20:23], 0
Lps_326:
s_waitcnt vmcnt(3)
v_max3_u32 v26, v36, v37, v38
v_max_u32 v26, v26, v39
v_cmp_eq_u32 vcc, -1, v26
s_cbranch_vccnz Lpf_327
v_smfmac_f32_16x16x64_bf16 v[44:47], v[36:39], a[64:71], v126
v_smfmac_f32_16x16x64_bf16 v[48:51], v[36:39], a[72:79], v126
v_smfmac_f32_16x16x64_bf16 v[52:55], v[36:39], a[80:87], v126
v_smfmac_f32_16x16x64_bf16 v[56:59], v[36:39], a[88:95], v126
v_smfmac_f32_16x16x64_bf16 v[60:63], v[36:39], v[192:199], v126
v_smfmac_f32_16x16x64_bf16 v[64:67], v[36:39], v[200:207], v126
Lps_328:
s_waitcnt vmcnt(2)
v_max3_u32 v26, v40, v41, v42
v_max_u32 v26, v26, v43
v_cmp_eq_u32 vcc, -1, v26
s_cbranch_vccnz Lpf_329
v_smfmac_f32_16x16x64_bf16 v[44:47], v[40:43], a[96:103], v126
v_smfmac_f32_16x16x64_bf16 v[48:51], v[40:43], a[104:111], v126
v_smfmac_f32_16x16x64_bf16 v[52:55], v[40:43], a[112:119], v126
v_smfmac_f32_16x16x64_bf16 v[56:59], v[40:43], a[120:127], v126
v_smfmac_f32_16x16x64_bf16 v[60:63], v[40:43], v[224:231], v126
v_smfmac_f32_16x16x64_bf16 v[64:67], v[40:43], v[232:239], v126
Lps_330:
s_waitcnt vmcnt(1)
v_max3_u32 v26, v28, v29, v30
v_max_u32 v26, v26, v31
v_cmp_eq_u32 vcc, -1, v26
s_cbranch_vccnz Lpf_331
v_smfmac_f32_16x16x64_bf16 v[44:47], v[28:31], a[0:7], v126
v_smfmac_f32_16x16x64_bf16 v[48:51], v[28:31], a[8:15], v126
v_smfmac_f32_16x16x64_bf16 v[52:55], v[28:31], a[16:23], v126
v_smfmac_f32_16x16x64_bf16 v[56:59], v[28:31], a[24:31], v126
v_smfmac_f32_16x16x64_bf16 v[60:63], v[28:31], v[128:135], v126
v_smfmac_f32_16x16x64_bf16 v[64:67], v[28:31], v[136:143], v126
s_branch Lps_318
Lpf_309:
buffer_load_dwordx4 v[36:39], v8, s[4:7], s40 offen offset:2048 sc1
v_mfma_f32_16x16x32_bf16 v[16:19], v[20:23], v[20:23], 0
Lps_332:
s_waitcnt vmcnt(2)
v_max3_u32 v26, v40, v41, v42
v_max_u32 v26, v26, v43
v_cmp_eq_u32 vcc, -1, v26
s_cbranch_vccnz Lpf_333
v_smfmac_f32_16x16x64_bf16 v[44:47], v[40:43], a[96:103], v126
v_smfmac_f32_16x16x64_bf16 v[48:51], v[40:43], a[104:111], v126
v_smfmac_f32_16x16x64_bf16 v[52:55], v[40:43], a[112:119], v126
v_smfmac_f32_16x16x64_bf16 v[56:59], v[40:43], a[120:127], v126
v_smfmac_f32_16x16x64_bf16 v[60:63], v[40:43], v[224:231], v126
v_smfmac_f32_16x16x64_bf16 v[64:67], v[40:43], v[232:239], v126
Lps_334:
s_waitcnt vmcnt(1)
v_max3_u32 v26, v28, v29, v30
v_max_u32 v26, v26, v31
v_cmp_eq_u32 vcc, -1, v26
s_cbranch_vccnz Lpf_335
v_smfmac_f32_16x16x64_bf16 v[44:47], v[28:31], a[0:7], v126
v_smfmac_f32_16x16x64_bf16 v[48:51], v[28:31], a[8:15], v126
v_smfmac_f32_16x16x64_bf16 v[52:55], v[28:31], a[16:23], v126
v_smfmac_f32_16x16x64_bf16 v[56:59], v[28:31], a[24:31], v126
v_smfmac_f32_16x16x64_bf16 v[60:63], v[28:31], v[128:135], v126
v_smfmac_f32_16x16x64_bf16 v[64:67], v[28:31], v[136:143], v126
s_branch Lps_322
Lpf_311:
buffer_load_dwordx4 v[40:43], v8, s[4:7], s40 offen offset:3072 sc1
v_mfma_f32_16x16x32_bf16 v[16:19], v[20:23], v[20:23], 0
Lps_336:
s_waitcnt vmcnt(1)
v_max3_u32 v26, v28, v29, v30
v_max_u32 v26, v26, v31
v_cmp_eq_u32 vcc, -1, v26
s_cbranch_vccnz Lpf_337
v_smfmac_f32_16x16x64_bf16 v[44:47], v[28:31], a[0:7], v126
v_smfmac_f32_16x16x64_bf16 v[48:51], v[28:31], a[8:15], v126
v_smfmac_f32_16x16x64_bf16 v[52:55], v[28:31], a[16:23], v126
v_smfmac_f32_16x16x64_bf16 v[56:59], v[28:31], a[24:31], v126
v_smfmac_f32_16x16x64_bf16 v[60:63], v[28:31], v[128:135], v126
v_smfmac_f32_16x16x64_bf16 v[64:67], v[28:31], v[136:143], v126
s_branch Lps_324
Lpf_313:
buffer_load_dwordx4 v[28:31], v8, s[4:7], s40 offen offset:0 sc1
v_mfma_f32_16x16x32_bf16 v[16:19], v[20:23], v[20:23], 0
s_sub_u32 s37, s37, 1
s_cbranch_scc1 Lend_1
s_branch Lps_312
Lpf_315:
buffer_load_dwordx4 v[36:39], v8, s[4:7], s40 offen offset:2048 sc1
v_mfma_f32_16x16x32_bf16 v[16:19], v[20:23], v[20:23], 0
Lps_338:
s_waitcnt vmcnt(2)
v_max3_u32 v26, v40, v41, v42
v_max_u32 v26, v26, v43
v_cmp_eq_u32 vcc, -1, v26
s_cbranch_vccnz Lpf_339
v_smfmac_f32_16x16x64_bf16 v[44:47], v[40:43], a[96:103], v126
v_smfmac_f32_16x16x64_bf16 v[48:51], v[40:43], a[104:111], v126
v_smfmac_f32_16x16x64_bf16 v[52:55], v[40:43], a[112:119], v126
v_smfmac_f32_16x16x64_bf16 v[56:59], v[40:43], a[120:127], v126
v_smfmac_f32_16x16x64_bf16 v[60:63], v[40:43], v[224:231], v126
v_smfmac_f32_16x16x64_bf16 v[64:67], v[40:43], v[232:239], v126
Lps_340:
s_waitcnt vmcnt(1)
v_max3_u32 v26, v32, v33, v34
v_max_u32 v26, v26, v35
v_cmp_eq_u32 vcc, -1, v26
s_cbranch_vccnz Lpf_341
v_smfmac_f32_16x16x64_bf16 v[44:47], v[32:35], a[32:39], v126
v_smfmac_f32_16x16x64_bf16 v[48:51], v[32:35], a[40:47], v126
v_smfmac_f32_16x16x64_bf16 v[52:55], v[32:35], a[48:55], v126
v_smfmac_f32_16x16x64_bf16 v[56:59], v[32:35], a[56:63], v126
v_smfmac_f32_16x16x64_bf16 v[60:63], v[32:35], v[160:167], v126
v_smfmac_f32_16x16x64_bf16 v[64:67], v[32:35], v[168:175], v126
s_branch Lps_322
Lpf_317:
buffer_load_dwordx4 v[40:43], v8, s[4:7], s40 offen offset:3072 sc1
v_mfma_f32_16x16x32_bf16 v[16:19], v[20:23], v[20:23], 0
Lps_342:
s_waitcnt vmcnt(1)
v_max3_u32 v26, v32, v33, v34
v_max_u32 v26, v26, v35
v_cmp_eq_u32 vcc, -1, v26
s_cbranch_vccnz Lpf_343
v_smfmac_f32_16x16x64_bf16 v[44:47], v[32:35], a[32:39], v126
v_smfmac_f32_16x16x64_bf16 v[48:51], v[32:35], a[40:47], v126
v_smfmac_f32_16x16x64_bf16 v[52:55], v[32:35], a[48:55], v126
v_smfmac_f32_16x16x64_bf16 v[56:59], v[32:35], a[56:63], v126
v_smfmac_f32_16x16x64_bf16 v[60:63], v[32:35], v[160:167], v126
v_smfmac_f32_16x16x64_bf16 v[64:67], v[32:35], v[168:175], v126
s_branch Lps_324
Lpf_319:
buffer_load_dwordx4 v[32:35], v8, s[4:7], s40 offen offset:1024 sc1
v_mfma_f32_16x16x32_bf16 v[16:19], v[20:23], v[20:23], 0
s_sub_u32 s37, s37, 1
s_cbranch_scc1 Lend_1
s_branch Lps_318
Lpf_321:
buffer_load_dwordx4 v[40:43], v8, s[4:7], s40 offen offset:3072 sc1
v_mfma_f32_16x16x32_bf16 v[16:19], v[20:23], v[20:23], 0
Lps_344:
s_waitcnt vmcnt(1)
v_max3_u32 v26, v36, v37, v38
v_max_u32 v26, v26, v39
v_cmp_eq_u32 vcc, -1, v26
s_cbranch_vccnz Lpf_345
v_smfmac_f32_16x16x64_bf16 v[44:47], v[36:39], a[64:71], v126
v_smfmac_f32_16x16x64_bf16 v[48:51], v[36:39], a[72:79], v126
v_smfmac_f32_16x16x64_bf16 v[52:55], v[36:39], a[80:87], v126
v_smfmac_f32_16x16x64_bf16 v[56:59], v[36:39], a[88:95], v126
v_smfmac_f32_16x16x64_bf16 v[60:63], v[36:39], v[192:199], v126
v_smfmac_f32_16x16x64_bf16 v[64:67], v[36:39], v[200:207], v126
s_branch Lps_324
Lpf_323:
buffer_load_dwordx4 v[36:39], v8, s[4:7], s40 offen offset:2048 sc1
v_mfma_f32_16x16x32_bf16 v[16:19], v[20:23], v[20:23], 0
s_sub_u32 s37, s37, 1
s_cbranch_scc1 Lend_1
s_branch Lps_322
Lpf_325:
buffer_load_dwordx4 v[40:43], v8, s[4:7], s40 offen offset:3072 sc1
v_mfma_f32_16x16x32_bf16 v[16:19], v[20:23], v[20:23], 0
s_sub_u32 s37, s37, 1
s_cbranch_scc1 Lend_1
s_branch Lps_324
Lpf_327:
buffer_load_dwordx4 v[36:39], v8, s[4:7], s40 offen offset:2048 sc1
v_mfma_f32_16x16x32_bf16 v[16:19], v[20:23], v[20:23], 0
Lps_346:
s_waitcnt vmcnt(3)
v_max3_u32 v26, v40, v41, v42
v_max_u32 v26, v26, v43
v_cmp_eq_u32 vcc, -1, v26
s_cbranch_vccnz Lpf_347
v_smfmac_f32_16x16x64_bf16 v[44:47], v[40:43], a[96:103], v126
v_smfmac_f32_16x16x64_bf16 v[48:51], v[40:43], a[104:111], v126
v_smfmac_f32_16x16x64_bf16 v[52:55], v[40:43], a[112:119], v126
v_smfmac_f32_16x16x64_bf16 v[56:59], v[40:43], a[120:127], v126
v_smfmac_f32_16x16x64_bf16 v[60:63], v[40:43], v[224:231], v126
v_smfmac_f32_16x16x64_bf16 v[64:67], v[40:43], v[232:239], v126
Lps_348:
s_waitcnt vmcnt(2)
v_max3_u32 v26, v28, v29, v30
v_max_u32 v26, v26, v31
v_cmp_eq_u32 vcc, -1, v26
s_cbranch_vccnz Lpf_349
v_smfmac_f32_16x16x64_bf16 v[44:47], v[28:31], a[0:7], v126
v_smfmac_f32_16x16x64_bf16 v[48:51], v[28:31], a[8:15], v126
v_smfmac_f32_16x16x64_bf16 v[52:55], v[28:31], a[16:23], v126
v_smfmac_f32_16x16x64_bf16 v[56:59], v[28:31], a[24:31], v126
v_smfmac_f32_16x16x64_bf16 v[60:63], v[28:31], v[128:135], v126
v_smfmac_f32_16x16x64_bf16 v[64:67], v[28:31], v[136:143], v126
s_branch Lps_340
Lpf_329:
buffer_load_dwordx4 v[40:43], v8, s[4:7], s40 offen offset:3072 sc1
v_mfma_f32_16x16x32_bf16 v[16:19], v[20:23], v[20:23], 0
Lps_350:
s_waitcnt vmcnt(2)
v_max3_u32 v26, v28, v29, v30
v_max_u32 v26, v26, v31
v_cmp_eq_u32 vcc, -1, v26
s_cbranch_vccnz Lpf_351
v_smfmac_f32_16x16x64_bf16 v[44:47], v[28:31], a[0:7], v126
v_smfmac_f32_16x16x64_bf16 v[48:51], v[28:31], a[8:15], v126
v_smfmac_f32_16x16x64_bf16 v[52:55], v[28:31], a[16:23], v126
v_smfmac_f32_16x16x64_bf16 v[56:59], v[28:31], a[24:31], v126
v_smfmac_f32_16x16x64_bf16 v[60:63], v[28:31], v[128:135], v126
v_smfmac_f32_16x16x64_bf16 v[64:67], v[28:31], v[136:143], v126
s_branch Lps_342
Lpf_331:
buffer_load_dwordx4 v[28:31], v8, s[4:7], s40 offen offset:0 sc1
v_mfma_f32_16x16x32_bf16 v[16:19], v[20:23], v[20:23], 0
s_sub_u32 s37, s37, 1
s_cbranch_scc1 Lend_1
Lps_352:
s_waitcnt vmcnt(1)
v_max3_u32 v26, v32, v33, v34
v_max_u32 v26, v26, v35
v_cmp_eq_u32 vcc, -1, v26
s_cbranch_vccnz Lpf_353
v_smfmac_f32_16x16x64_bf16 v[44:47], v[32:35], a[32:39], v126
v_smfmac_f32_16x16x64_bf16 v[48:51], v[32:35], a[40:47], v126
v_smfmac_f32_16x16x64_bf16 v[52:55], v[32:35], a[48:55], v126
v_smfmac_f32_16x16x64_bf16 v[56:59], v[32:35], a[56:63], v126
v_smfmac_f32_16x16x64_bf16 v[60:63], v[32:35], v[160:167], v126
v_smfmac_f32_16x16x64_bf16 v[64:67], v[32:35], v[168:175], v126
s_branch Lps_312
Lpf_333:
buffer_load_dwordx4 v[40:43], v8, s[4:7], s40 offen offset:3072 sc1
v_mfma_f32_16x16x32_bf16 v[16:19], v[20:23], v[20:23], 0
Lps_354:
s_waitcnt vmcnt(2)
v_max3_u32 v26, v28, v29, v30
v_max_u32 v26, v26, v31
v_cmp_eq_u32 vcc, -1, v26
s_cbranch_vccnz Lpf_355
v_smfmac_f32_16x16x64_bf16 v[44:47], v[28:31], a[0:7], v126
v_smfmac_f32_16x16x64_bf16 v[48:51], v[28:31], a[8:15], v126
v_smfmac_f32_16x16x64_bf16 v[52:55], v[28:31], a[16:23], v126
v_smfmac_f32_16x16x64_bf16 v[56:59], v[28:31], a[24:31], v126
v_smfmac_f32_16x16x64_bf16 v[60:63], v[28:31], v[128:135], v126
v_smfmac_f32_16x16x64_bf16 v[64:67], v[28:31], v[136:143], v126
s_branch Lps_344
Lpf_335:
buffer_load_dwordx4 v[28:31], v8, s[4:7], s40 offen offset:0 sc1
v_mfma_f32_16x16x32_bf16 v[16:19], v[20:23], v[20:23], 0
s_sub_u32 s37, s37, 1
s_cbranch_scc1 Lend_1
Lps_356:
s_waitcnt vmcnt(1)
v_max3_u32 v26, v36, v37, v38
v_max_u32 v26, v26, v39
v_cmp_eq_u32 vcc, -1, v26
s_cbranch_vccnz Lpf_357
v_smfmac_f32_16x16x64_bf16 v[44:47], v[36:39], a[64:71], v126
v_smfmac_f32_16x16x64_bf16 v[48:51], v[36:39], a[72:79], v126
v_smfmac_f32_16x16x64_bf16 v[52:55], v[36:39], a[80:87], v126
v_smfmac_f32_16x16x64_bf16 v[56:59], v[36:39], a[88:95], v126
v_smfmac_f32_16x16x64_bf16 v[60:63], v[36:39], v[192:199], v126
v_smfmac_f32_16x16x64_bf16 v[64:67], v[36:39], v[200:207], v126
s_branch Lps_312
Lpf_337:
buffer_load_dwordx4 v[28:31], v8, s[4:7], s40 offen offset:0 sc1
v_mfma_f32_16x16x32_bf16 v[16:19], v[20:23], v[20:23], 0
s_sub_u32 s37, s37, 1
s_cbranch_scc1 Lend_1
s_branch Lps_310
Lpf_339:
buffer_load_dwordx4 v[40:43], v8, s[4:7], s40 offen offset:3072 sc1
v_mfma_f32_16x16x32_bf16 v[16:19], v[20:23], v[20:23], 0
Lps_358:
s_waitcnt vmcnt(2)
v_max3_u32 v26, v32, v33, v34
v_max_u32 v26, v26, v35
v_cmp_eq_u32 vcc, -1, v26
s_cbranch_vccnz Lpf_359
v_smfmac_f32_16x16x64_bf16 v[44:47], v[32:35], a[32:39], v126
v_smfmac_f32_16x16x64_bf16 v[48:51], v[32:35], a[40:47], v126
v_smfmac_f32_16x16x64_bf16 v[52:55], v[32:35], a[48:55], v126
v_smfmac_f32_16x16x64_bf16 v[56:59], v[32:35], a[56:63], v126
v_smfmac_f32_16x16x64_bf16 v[60:63], v[32:35], v[160:167], v126
v_smfmac_f32_16x16x64_bf16 v[64:67], v[32:35], v[168:175], v126
s_branch Lps_344
Lpf_341:
buffer_load_dwordx4 v[32:35], v8, s[4:7], s40 offen offset:1024 sc1
v_mfma_f32_16x16x32_bf16 v[16:19], v[20:23], v[20:23], 0
s_sub_u32 s37, s37, 1
s_cbranch_scc1 Lend_1
Lps_360:
s_waitcnt vmcnt(1)
v_max3_u32 v26, v36, v37, v38
v_max_u32 v26, v26, v39
v_cmp_eq_u32 vcc, -1, v26
s_cbranch_vccnz Lpf_361
v_smfmac_f32_16x16x64_bf16 v[44:47], v[36:39], a[64:71], v126
v_smfmac_f32_16x16x64_bf16 v[48:51], v[36:39], a[72:79], v126
v_smfmac_f32_16x16x64_bf16 v[52:55], v[36:39], a[80:87], v126
v_smfmac_f32_16x16x64_bf16 v[56:59], v[36:39], a[88:95], v126
v_smfmac_f32_16x16x64_bf16 v[60:63], v[36:39], v[192:199], v126
v_smfmac_f32_16x16x64_bf16 v[64:67], v[36:39], v[200:207], v126
s_branch Lps_318
Lpf_343:
buffer_load_dwordx4 v[32:35], v8, s[4:7], s40 offen offset:1024 sc1
v_mfma_f32_16x16x32_bf16 v[16:19], v[20:23], v[20:23], 0
s_sub_u32 s37, s37, 1
s_cbranch_scc1 Lend_1
s_branch Lps_316
Lpf_345:
buffer_load_dwordx4 v[36:39], v8, s[4:7], s40 offen offset:2048 sc1
v_mfma_f32_16x16x32_bf16 v[16:19], v[20:23], v[20:23], 0
s_sub_u32 s37, s37, 1
s_cbranch_scc1 Lend_1
s_branch Lps_320
Lpf_347:
buffer_load_dwordx4 v[40:43], v8, s[4:7], s40 offen offset:3072 sc1
v_mfma_f32_16x16x32_bf16 v[16:19], v[20:23], v[20:23], 0
Lps_362:
s_waitcnt vmcnt(3)
v_max3_u32 v26, v28, v29, v30
v_max_u32 v26, v26, v31
v_cmp_eq_u32 vcc, -1, v26
s_cbranch_vccnz Lpf_363
v_smfmac_f32_16x16x64_bf16 v[44:47], v[28:31], a[0:7], v126
v_smfmac_f32_16x16x64_bf16 v[48:51], v[28:31], a[8:15], v126
v_smfmac_f32_16x16x64_bf16 v[52:55], v[28:31], a[16:23], v126
v_smfmac_f32_16x16x64_bf16 v[56:59], v[28:31], a[24:31], v126
v_smfmac_f32_16x16x64_bf16 v[60:63], v[28:31], v[128:135], v126
v_smfmac_f32_16x16x64_bf16 v[64:67], v[28:31], v[136:143], v126
s_branch Lps_358
Lpf_349:
buffer_load_dwordx4 v[28:31], v8, s[4:7], s40 offen offset:0 sc1
v_mfma_f32_16x16x32_bf16 v[16:19], v[20:23], v[20:23], 0
s_sub_u32 s37, s37, 1
s_cbranch_scc1 Lend_1
Lps_364:
s_waitcnt vmcnt(2)
v_max3_u32 v26, v32, v33, v34
v_max_u32 v26, v26, v35
v_cmp_eq_u32 vcc, -1, v26
s_cbranch_vccnz Lpf_365
v_smfmac_f32_16x16x64_bf16 v[44:47], v[32:35], a[32:39], v126
v_smfmac_f32_16x16x64_bf16 v[48:51], v[32:35], a[40:47], v126
v_smfmac_f32_16x16x64_bf16 v[52:55], v[32:35], a[48:55], v126
v_smfmac_f32_16x16x64_bf16 v[56:59], v[32:35], a[56:63], v126
v_smfmac_f32_16x16x64_bf16 v[60:63], v[32:35], v[160:167], v126
v_smfmac_f32_16x16x64_bf16 v[64:67], v[32:35], v[168:175], v126
s_branch Lps_356
Lpf_351:
buffer_load_dwordx4 v[28:31], v8, s[4:7], s40 offen offset:0 sc1
v_mfma_f32_16x16x32_bf16 v[16:19], v[20:23], v[20:23], 0
s_sub_u32 s37, s37, 1
s_cbranch_scc1 Lend_1
Lps_366:
s_waitcnt vmcnt(2)
v_max3_u32 v26, v32, v33, v34
v_max_u32 v26, v26, v35
v_cmp_eq_u32 vcc, -1, v26
s_cbranch_vccnz Lpf_367
v_smfmac_f32_16x16x64_bf16 v[44:47], v[32:35], a[32:39], v126
v_smfmac_f32_16x16x64_bf16 v[48:51], v[32:35], a[40:47], v126
v_smfmac_f32_16x16x64_bf16 v[52:55], v[32:35], a[48:55], v126
v_smfmac_f32_16x16x64_bf16 v[56:59], v[32:35], a[56:63], v126
v_smfmac_f32_16x16x64_bf16 v[60:63], v[32:35], v[160:167], v126
v_smfmac_f32_16x16x64_bf16 v[64:67], v[32:35], v[168:175], v126
s_branch Lps_310
Lpf_353:
buffer_load_dwordx4 v[32:35], v8, s[4:7], s40 offen offset:1024 sc1
v_mfma_f32_16x16x32_bf16 v[16:19], v[20:23], v[20:23], 0
s_branch Lps_330
Lpf_355:
buffer_load_dwordx4 v[28:31], v8, s[4:7], s40 offen offset:0 sc1
v_mfma_f32_16x16x32_bf16 v[16:19], v[20:23], v[20:23], 0
s_sub_u32 s37, s37, 1
s_cbranch_scc1 Lend_1
s_branch Lps_308
Lpf_357:
buffer_load_dwordx4 v[36:39], v8, s[4:7], s40 offen offset:2048 sc1
v_mfma_f32_16x16x32_bf16 v[16:19], v[20:23], v[20:23], 0
s_branch Lps_334
Lpf_359:
buffer_load_dwordx4 v[32:35], v8, s[4:7], s40 offen offset:1024 sc1
v_mfma_f32_16x16x32_bf16 v[16:19], v[20:23], v[20:23], 0
s_sub_u32 s37, s37, 1
s_cbranch_scc1 Lend_1
s_branch Lps_314
Lpf_361:
buffer_load_dwordx4 v[36:39], v8, s[4:7], s40 offen offset:2048 sc1
v_mfma_f32_16x16x32_bf16 v[16:19], v[20:23], v[20:23], 0
s_branch Lps_340
Lpf_363:
buffer_load_dwordx4 v[28:31], v8, s[4:7], s40 offen offset:0 sc1
v_mfma_f32_16x16x32_bf16 v[16:19], v[20:23], v[20:23], 0
s_sub_u32 s37, s37, 1
s_cbranch_scc1 Lend_1
s_branch Lps_306
Lpf_365:
buffer_load_dwordx4 v[32:35], v8, s[4:7], s40 offen offset:1024 sc1
v_mfma_f32_16x16x32_bf16 v[16:19], v[20:23], v[20:23], 0
Lps_368:
s_waitcnt vmcnt(2)
v_max3_u32 v26, v36, v37, v38
v_max_u32 v26, v26, v39
v_cmp_eq_u32 vcc, -1, v26
s_cbranch_vccnz Lpf_369
v_smfmac_f32_16x16x64_bf16 v[44:47], v[36:39], a[64:71], v126
v_smfmac_f32_16x16x64_bf16 v[48:51], v[36:39], a[72:79], v126
v_smfmac_f32_16x16x64_bf16 v[52:55], v[36:39], a[80:87], v126
v_smfmac_f32_16x16x64_bf16 v[56:59], v[36:39], a[88:95], v126
v_smfmac_f32_16x16x64_bf16 v[60:63], v[36:39], v[192:199], v126
v_smfmac_f32_16x16x64_bf16 v[64:67], v[36:39], v[200:207], v126
s_branch Lps_330
Lpf_367:
buffer_load_dwordx4 v[32:35], v8, s[4:7], s40 offen offset:1024 sc1
v_mfma_f32_16x16x32_bf16 v[16:19], v[20:23], v[20:23], 0
s_branch Lps_328
Lpf_369:
buffer_load_dwordx4 v[36:39], v8, s[4:7], s40 offen offset:2048 sc1
v_mfma_f32_16x16x32_bf16 v[16:19], v[20:23], v[20:23], 0
s_branch Lps_348
Lpf_299:
buffer_load_dwordx4 v[28:31], v9, s[4:7], s40 offen offset:0 sc1
v_mfma_f32_16x16x32_bf16 v[16:19], v[20:23], v[20:23], 0
s_sub_u32 s37, s37, 1
s_cbranch_scc1 Lend_1
Lps_370:
s_waitcnt vmcnt(3)
v_max3_u32 v26, v32, v33, v34
v_max_u32 v26, v26, v35
v_cmp_eq_u32 vcc, -1, v26
s_cbranch_vccnz Lpf_371
v_smfmac_f32_16x16x64_bf16 v[76:79], v[32:35], a[160:167], v126
v_smfmac_f32_16x16x64_bf16 v[80:83], v[32:35], a[168:175], v126
v_smfmac_f32_16x16x64_bf16 v[84:87], v[32:35], a[176:183], v126
v_smfmac_f32_16x16x64_bf16 v[88:91], v[32:35], a[184:191], v126
Lps_372:
s_waitcnt vmcnt(2)
v_max3_u32 v26, v36, v37, v38
v_max_u32 v26, v26, v39
v_cmp_eq_u32 vcc, -1, v26
s_cbranch_vccnz Lpf_373
v_smfmac_f32_16x16x64_bf16 v[76:79], v[36:39], a[192:199], v126
v_smfmac_f32_16x16x64_bf16 v[80:83], v[36:39], a[200:207], v126
v_smfmac_f32_16x16x64_bf16 v[84:87], v[36:39], a[208:215], v126
v_smfmac_f32_16x16x64_bf16 v[88:91], v[36:39], a[216:223], v126
Lps_374:
s_waitcnt vmcnt(1)
v_max3_u32 v26, v40, v41, v42
v_max_u32 v26, v26, v43
v_cmp_eq_u32 vcc, -1, v26
s_cbranch_vccnz Lpf_375
v_smfmac_f32_16x16x64_bf16 v[76:79], v[40:43], a[224:231], v126
v_smfmac_f32_16x16x64_bf16 v[80:83], v[40:43], a[232:239], v126
v_smfmac_f32_16x16x64_bf16 v[84:87], v[40:43], a[240:247], v126
v_smfmac_f32_16x16x64_bf16 v[88:91], v[40:43], a[248:255], v126
Lps_376:
s_waitcnt vmcnt(0)
v_max3_u32 v26, v28, v29, v30
v_max_u32 v26, v26, v31
v_cmp_eq_u32 vcc, -1, v26
s_cbranch_vccnz Lpf_377
v_smfmac_f32_16x16x64_bf16 v[76:79], v[28:31], a[128:135], v126
v_smfmac_f32_16x16x64_bf16 v[80:83], v[28:31], a[136:143], v126
v_smfmac_f32_16x16x64_bf16 v[84:87], v[28:31], a[144:151], v126
v_smfmac_f32_16x16x64_bf16 v[88:91], v[28:31], a[152:159], v126
s_branch Lpd_298
Lpf_300:
buffer_load_dwordx4 v[32:35], v9, s[4:7], s40 offen offset:1024 sc1
v_mfma_f32_16x16x32_bf16 v[16:19], v[20:23], v[20:23], 0
s_sub_u32 s37, s37, 1
s_cbranch_scc1 Lend_1
Lps_378:
s_waitcnt vmcnt(2)
v_max3_u32 v26, v36, v37, v38
v_max_u32 v26, v26, v39
v_cmp_eq_u32 vcc, -1, v26
s_cbranch_vccnz Lpf_379
v_smfmac_f32_16x16x64_bf16 v[76:79], v[36:39], a[192:199], v126
v_smfmac_f32_16x16x64_bf16 v[80:83], v[36:39], a[200:207], v126
v_smfmac_f32_16x16x64_bf16 v[84:87], v[36:39], a[208:215], v126
v_smfmac_f32_16x16x64_bf16 v[88:91], v[36:39], a[216:223], v126
Lps_380:
s_waitcnt vmcnt(1)
v_max3_u32 v26, v40, v41, v42
v_max_u32 v26, v26, v43
v_cmp_eq_u32 vcc, -1, v26
s_cbranch_vccnz Lpf_381
v_smfmac_f32_16x16x64_bf16 v[76:79], v[40:43], a[224:231], v126
v_smfmac_f32_16x16x64_bf16 v[80:83], v[40:43], a[232:239], v126
v_smfmac_f32_16x16x64_bf16 v[84:87], v[40:43], a[240:247], v126
v_smfmac_f32_16x16x64_bf16 v[88:91], v[40:43], a[248:255], v126
Lps_382:
s_waitcnt vmcnt(0)
v_max3_u32 v26, v32, v33, v34
v_max_u32 v26, v26, v35
v_cmp_eq_u32 vcc, -1, v26
s_cbranch_vccnz Lpf_383
v_smfmac_f32_16x16x64_bf16 v[76:79], v[32:35], a[160:167], v126
v_smfmac_f32_16x16x64_bf16 v[80:83], v[32:35], a[168:175], v126
v_smfmac_f32_16x16x64_bf16 v[84:87], v[32:35], a[176:183], v126
v_smfmac_f32_16x16x64_bf16 v[88:91], v[32:35], a[184:191], v126
s_branch Lpd_298
Lpf_301:
buffer_load_dwordx4 v[36:39], v9, s[4:7], s40 offen offset:2048 sc1
v_mfma_f32_16x16x32_bf16 v[16:19], v[20:23], v[20:23], 0
s_sub_u32 s37, s37, 1
s_cbranch_scc1 Lend_1
Lps_384:
s_waitcnt vmcnt(1)
v_max3_u32 v26, v40, v41, v42
v_max_u32 v26, v26, v43
v_cmp_eq_u32 vcc, -1, v26
s_cbranch_vccnz Lpf_385
v_smfmac_f32_16x16x64_bf16 v[76:79], v[40:43], a[224:231], v126
v_smfmac_f32_16x16x64_bf16 v[80:83], v[40:43], a[232:239], v126
v_smfmac_f32_16x16x64_bf16 v[84:87], v[40:43], a[240:247], v126
v_smfmac_f32_16x16x64_bf16 v[88:91], v[40:43], a[248:255], v126
Lps_386:
s_waitcnt vmcnt(0)
v_max3_u32 v26, v36, v37, v38
v_max_u32 v26, v26, v39
v_cmp_eq_u32 vcc, -1, v26
s_cbranch_vccnz Lpf_387
v_smfmac_f32_16x16x64_bf16 v[76:79], v[36:39], a[192:199], v126
v_smfmac_f32_16x16x64_bf16 v[80:83], v[36:39], a[200:207], v126
v_smfmac_f32_16x16x64_bf16 v[84:87], v[36:39], a[208:215], v126
v_smfmac_f32_16x16x64_bf16 v[88:91], v[36:39], a[216:223], v126
s_branch Lpd_298
Lpf_302:
buffer_load_dwordx4 v[40:43], v9, s[4:7], s40 offen offset:3072 sc1
v_mfma_f32_16x16x32_bf16 v[16:19], v[20:23], v[20:23], 0
s_sub_u32 s37, s37, 1
s_cbranch_scc1 Lend_1
Lps_388:
s_waitcnt vmcnt(0)
v_max3_u32 v26, v40, v41, v42
v_max_u32 v26, v26, v43
v_cmp_eq_u32 vcc, -1, v26
s_cbranch_vccnz Lpf_389
v_smfmac_f32_16x16x64_bf16 v[76:79], v[40:43], a[224:231], v126
v_smfmac_f32_16x16x64_bf16 v[80:83], v[40:43], a[232:239], v126
v_smfmac_f32_16x16x64_bf16 v[84:87], v[40:43], a[240:247], v126
v_smfmac_f32_16x16x64_bf16 v[88:91], v[40:43], a[248:255], v126
s_branch Lpd_298
Lpf_371:
buffer_load_dwordx4 v[32:35], v9, s[4:7], s40 offen offset:1024 sc1
v_mfma_f32_16x16x32_bf16 v[16:19], v[20:23], v[20:23], 0
Lps_390:
s_waitcnt vmcnt(3)
v_max3_u32 v26, v36, v37, v38
v_max_u32 v26, v26, v39
v_cmp_eq_u32 vcc, -1, v26
s_cbranch_vccnz Lpf_391
v_smfmac_f32_16x16x64_bf16 v[76:79], v[36:39], a[192:199], v126
v_smfmac_f32_16x16x64_bf16 v[80:83], v[36:39], a[200:207], v126
v_smfmac_f32_16x16x64_bf16 v[84:87], v[36:39], a[208:215], v126
v_smfmac_f32_16x16x64_bf16 v[88:91], v[36:39], a[216:223], v126
Lps_392:
s_waitcnt vmcnt(2)
v_max3_u32 v26, v40, v41, v42
v_max_u32 v26, v26, v43
v_cmp_eq_u32 vcc, -1, v26
s_cbranch_vccnz Lpf_393
v_smfmac_f32_16x16x64_bf16 v[76:79], v[40:43], a[224:231], v126
v_smfmac_f32_16x16x64_bf16 v[80:83], v[40:43], a[232:239], v126
v_smfmac_f32_16x16x64_bf16 v[84:87], v[40:43], a[240:247], v126
v_smfmac_f32_16x16x64_bf16 v[88:91], v[40:43], a[248:255], v126
Lps_394:
s_waitcnt vmcnt(1)
v_max3_u32 v26, v28, v29, v30
v_max_u32 v26, v26, v31
v_cmp_eq_u32 vcc, -1, v26
s_cbranch_vccnz Lpf_395
v_smfmac_f32_16x16x64_bf16 v[76:79], v[28:31], a[128:135], v126
v_smfmac_f32_16x16x64_bf16 v[80:83], v[28:31], a[136:143], v126
v_smfmac_f32_16x16x64_bf16 v[84:87], v[28:31], a[144:151], v126
v_smfmac_f32_16x16x64_bf16 v[88:91], v[28:31], a[152:159], v126
s_branch Lps_382
Lpf_373:
buffer_load_dwordx4 v[36:39], v9, s[4:7], s40 offen offset:2048 sc1
v_mfma_f32_16x16x32_bf16 v[16:19], v[20:23], v[20:23], 0
Lps_396:
s_waitcnt vmcnt(2)
v_max3_u32 v26, v40, v41, v42
v_max_u32 v26, v26, v43
v_cmp_eq_u32 vcc, -1, v26
s_cbranch_vccnz Lpf_397
v_smfmac_f32_16x16x64_bf16 v[76:79], v[40:43], a[224:231], v126
v_smfmac_f32_16x16x64_bf16 v[80:83], v[40:43], a[232:239], v126
v_smfmac_f32_16x16x64_bf16 v[84:87], v[40:43], a[240:247], v126
v_smfmac_f32_16x16x64_bf16 v[88:91], v[40:43], a[248:255], v126
Lps_398:
s_waitcnt vmcnt(1)
v_max3_u32 v26, v28, v29, v30
v_max_u32 v26, v26, v31
v_cmp_eq_u32 vcc, -1, v26
s_cbranch_vccnz Lpf_399
v_smfmac_f32_16x16x64_bf16 v[76:79], v[28:31], a[128:135], v126
v_smfmac_f32_16x16x64_bf16 v[80:83], v[28:31], a[136:143], v126
v_smfmac_f32_16x16x64_bf16 v[84:87], v[28:31], a[144:151], v126
v_smfmac_f32_16x16x64_bf16 v[88:91], v[28:31], a[152:159], v126
s_branch Lps_386
Lpf_375:
buffer_load_dwordx4 v[40:43], v9, s[4:7], s40 offen offset:3072 sc1
v_mfma_f32_16x16x32_bf16 v[16:19], v[20:23], v[20:23], 0
Lps_400:
s_waitcnt vmcnt(1)
v_max3_u32 v26, v28, v29, v30
v_max_u32 v26, v26, v31
v_cmp_eq_u32 vcc, -1, v26
s_cbranch_vccnz Lpf_401
v_smfmac_f32_16x16x64_bf16 v[76:79], v[28:31], a[128:135], v126
v_smfmac_f32_16x16x64_bf16 v[80:83], v[28:31], a[136:143], v126
v_smfmac_f32_16x16x64_bf16 v[84:87], v[28:31], a[144:151], v126
v_smfmac_f32_16x16x64_bf16 v[88:91], v[28:31], a[152:159], v126
s_branch Lps_388
Lpf_377:
buffer_load_dwordx4 v[28:31], v9, s[4:7], s40 offen offset:0 sc1
v_mfma_f32_16x16x32_bf16 v[16:19], v[20:23], v[20:23], 0
s_sub_u32 s37, s37, 1
s_cbranch_scc1 Lend_1
s_branch Lps_376
Lpf_379:
buffer_load_dwordx4 v[36:39], v9, s[4:7], s40 offen offset:2048 sc1
v_mfma_f32_16x16x32_bf16 v[16:19], v[20:23], v[20:23], 0
Lps_402:
s_waitcnt vmcnt(2)
v_max3_u32 v26, v40, v41, v42
v_max_u32 v26, v26, v43
v_cmp_eq_u32 vcc, -1, v26
s_cbranch_vccnz Lpf_403
v_smfmac_f32_16x16x64_bf16 v[76:79], v[40:43], a[224:231], v126
v_smfmac_f32_16x16x64_bf16 v[80:83], v[40:43], a[232:239], v126
v_smfmac_f32_16x16x64_bf16 v[84:87], v[40:43], a[240:247], v126
v_smfmac_f32_16x16x64_bf16 v[88:91], v[40:43], a[248:255], v126
Lps_404:
s_waitcnt vmcnt(1)
v_max3_u32 v26, v32, v33, v34
v_max_u32 v26, v26, v35
v_cmp_eq_u32 vcc, -1, v26
s_cbranch_vccnz Lpf_405
v_smfmac_f32_16x16x64_bf16 v[76:79], v[32:35], a[160:167], v126
v_smfmac_f32_16x16x64_bf16 v[80:83], v[32:35], a[168:175], v126
v_smfmac_f32_16x16x64_bf16 v[84:87], v[32:35], a[176:183], v126
v_smfmac_f32_16x16x64_bf16 v[88:91], v[32:35], a[184:191], v126
s_branch Lps_386
Lpf_381:
buffer_load_dwordx4 v[40:43], v9, s[4:7], s40 offen offset:3072 sc1
v_mfma_f32_16x16x32_bf16 v[16:19], v[20:23], v[20:23], 0
Lps_406:
s_waitcnt vmcnt(1)
v_max3_u32 v26, v32, v33, v34
v_max_u32 v26, v26, v35
v_cmp_eq_u32 vcc, -1, v26
s_cbranch_vccnz Lpf_407
v_smfmac_f32_16x16x64_bf16 v[76:79], v[32:35], a[160:167], v126
v_smfmac_f32_16x16x64_bf16 v[80:83], v[32:35], a[168:175], v126
v_smfmac_f32_16x16x64_bf16 v[84:87], v[32:35], a[176:183], v126
v_smfmac_f32_16x16x64_bf16 v[88:91], v[32:35], a[184:191], v126
s_branch Lps_388
Lpf_383:
buffer_load_dwordx4 v[32:35], v9, s[4:7], s40 offen offset:1024 sc1
v_mfma_f32_16x16x32_bf16 v[16:19], v[20:23], v[20:23], 0
s_sub_u32 s37, s37, 1
s_cbranch_scc1 Lend_1
s_branch Lps_382
Lpf_385:
buffer_load_dwordx4 v[40:43], v9, s[4:7], s40 offen offset:3072 sc1
v_mfma_f32_16x16x32_bf16 v[16:19], v[20:23], v[20:23], 0
Lps_408:
s_waitcnt vmcnt(1)
v_max3_u32 v26, v36, v37, v38
v_max_u32 v26, v26, v39
v_cmp_eq_u32 vcc, -1, v26
s_cbranch_vccnz Lpf_409
v_smfmac_f32_16x16x64_bf16 v[76:79], v[36:39], a[192:199], v126
v_smfmac_f32_16x16x64_bf16 v[80:83], v[36:39], a[200:207], v126
v_smfmac_f32_16x16x64_bf16 v[84:87], v[36:39], a[208:215], v126
v_smfmac_f32_16x16x64_bf16 v[88:91], v[36:39], a[216:223], v126
s_branch Lps_388
Lpf_387:
buffer_load_dwordx4 v[36:39], v9, s[4:7], s40 offen offset:2048 sc1
v_mfma_f32_16x16x32_bf16 v[16:19], v[20:23], v[20:23], 0
s_sub_u32 s37, s37, 1
s_cbranch_scc1 Lend_1
s_branch Lps_386
Lpf_389:
buffer_load_dwordx4 v[40:43], v9, s[4:7], s40 offen offset:3072 sc1
v_mfma_f32_16x16x32_bf16 v[16:19], v[20:23], v[20:23], 0
s_sub_u32 s37, s37, 1
s_cbranch_scc1 Lend_1
s_branch Lps_388
Lpf_391:
buffer_load_dwordx4 v[36:39], v9, s[4:7], s40 offen offset:2048 sc1
v_mfma_f32_16x16x32_bf16 v[16:19], v[20:23], v[20:23], 0
Lps_410:
s_waitcnt vmcnt(3)
v_max3_u32 v26, v40, v41, v42
v_max_u32 v26, v26, v43
v_cmp_eq_u32 vcc, -1, v26
s_cbranch_vccnz Lpf_411
v_smfmac_f32_16x16x64_bf16 v[76:79], v[40:43], a[224:231], v126
v_smfmac_f32_16x16x64_bf16 v[80:83], v[40:43], a[232:239], v126
v_smfmac_f32_16x16x64_bf16 v[84:87], v[40:43], a[240:247], v126
v_smfmac_f32_16x16x64_bf16 v[88:91], v[40:43], a[248:255], v126
Lps_412:
s_waitcnt vmcnt(2)
v_max3_u32 v26, v28, v29, v30
v_max_u32 v26, v26, v31
v_cmp_eq_u32 vcc, -1, v26
s_cbranch_vccnz Lpf_413
v_smfmac_f32_16x16x64_bf16 v[76:79], v[28:31], a[128:135], v126
v_smfmac_f32_16x16x64_bf16 v[80:83], v[28:31], a[136:143], v126
v_smfmac_f32_16x16x64_bf16 v[84:87], v[28:31], a[144:151], v126
v_smfmac_f32_16x16x64_bf16 v[88:91], v[28:31], a[152:159], v126
s_branch Lps_404
Lpf_393:
buffer_load_dwordx4 v[40:43], v9, s[4:7], s40 offen offset:3072 sc1
v_mfma_f32_16x16x32_bf16 v[16:19], v[20:23], v[20:23], 0
Lps_414:
s_waitcnt vmcnt(2)
v_max3_u32 v26, v28, v29, v30
v_max_u32 v26, v26, v31
v_cmp_eq_u32 vcc, -1, v26
s_cbranch_vccnz Lpf_415
v_smfmac_f32_16x16x64_bf16 v[76:79], v[28:31], a[128:135], v126
v_smfmac_f32_16x16x64_bf16 v[80:83], v[28:31], a[136:143], v126
v_smfmac_f32_16x16x64_bf16 v[84:87], v[28:31], a[144:151], v126
v_smfmac_f32_16x16x64_bf16 v[88:91], v[28:31], a[152:159], v126
s_branch Lps_406
Lpf_395:
buffer_load_dwordx4 v[28:31], v9, s[4:7], s40 offen offset:0 sc1
v_mfma_f32_16x16x32_bf16 v[16:19], v[20:23], v[20:23], 0
s_sub_u32 s37, s37, 1
s_cbranch_scc1 Lend_1
Lps_416:
s_waitcnt vmcnt(1)
v_max3_u32 v26, v32, v33, v34
v_max_u32 v26, v26, v35
v_cmp_eq_u32 vcc, -1, v26
s_cbranch_vccnz Lpf_417
v_smfmac_f32_16x16x64_bf16 v[76:79], v[32:35], a[160:167], v126
v_smfmac_f32_16x16x64_bf16 v[80:83], v[32:35], a[168:175], v126
v_smfmac_f32_16x16x64_bf16 v[84:87], v[32:35], a[176:183], v126
v_smfmac_f32_16x16x64_bf16 v[88:91], v[32:35], a[184:191], v126
s_branch Lps_376
Lpf_397:
buffer_load_dwordx4 v[40:43], v9, s[4:7], s40 offen offset:3072 sc1
v_mfma_f32_16x16x32_bf16 v[16:19], v[20:23], v[20:23], 0
Lps_418:
s_waitcnt vmcnt(2)
v_max3_u32 v26, v28, v29, v30
v_max_u32 v26, v26, v31
v_cmp_eq_u32 vcc, -1, v26
s_cbranch_vccnz Lpf_419
v_smfmac_f32_16x16x64_bf16 v[76:79], v[28:31], a[128:135], v126
v_smfmac_f32_16x16x64_bf16 v[80:83], v[28:31], a[136:143], v126
v_smfmac_f32_16x16x64_bf16 v[84:87], v[28:31], a[144:151], v126
v_smfmac_f32_16x16x64_bf16 v[88:91], v[28:31], a[152:159], v126
s_branch Lps_408
Lpf_399:
buffer_load_dwordx4 v[28:31], v9, s[4:7], s40 offen offset:0 sc1
v_mfma_f32_16x16x32_bf16 v[16:19], v[20:23], v[20:23], 0
s_sub_u32 s37, s37, 1
s_cbranch_scc1 Lend_1
Lps_420:
s_waitcnt vmcnt(1)
v_max3_u32 v26, v36, v37, v38
v_max_u32 v26, v26, v39
v_cmp_eq_u32 vcc, -1, v26
s_cbranch_vccnz Lpf_421
v_smfmac_f32_16x16x64_bf16 v[76:79], v[36:39], a[192:199], v126
v_smfmac_f32_16x16x64_bf16 v[80:83], v[36:39], a[200:207], v126
v_smfmac_f32_16x16x64_bf16 v[84:87], v[36:39], a[208:215], v126
v_smfmac_f32_16x16x64_bf16 v[88:91], v[36:39], a[216:223], v126
s_branch Lps_376
Lpf_401:
buffer_load_dwordx4 v[28:31], v9, s[4:7], s40 offen offset:0 sc1
v_mfma_f32_16x16x32_bf16 v[16:19], v[20:23], v[20:23], 0
s_sub_u32 s37, s37, 1
s_cbranch_scc1 Lend_1
s_branch Lps_374
Lpf_403:
buffer_load_dwordx4 v[40:43], v9, s[4:7], s40 offen offset:3072 sc1
v_mfma_f32_16x16x32_bf16 v[16:19], v[20:23], v[20:23], 0
Lps_422:
s_waitcnt vmcnt(2)
v_max3_u32 v26, v32, v33, v34
v_max_u32 v26, v26, v35
v_cmp_eq_u32 vcc, -1, v26
s_cbranch_vccnz Lpf_423
v_smfmac_f32_16x16x64_bf16 v[76:79], v[32:35], a[160:167], v126
v_smfmac_f32_16x16x64_bf16 v[80:83], v[32:35], a[168:175], v126
v_smfmac_f32_16x16x64_bf16 v[84:87], v[32:35], a[176:183], v126
v_smfmac_f32_16x16x64_bf16 v[88:91], v[32:35], a[184:191], v126
s_branch Lps_408
Lpf_405:
buffer_load_dwordx4 v[32:35], v9, s[4:7], s40 offen offset:1024 sc1
v_mfma_f32_16x16x32_bf16 v[16:19], v[20:23], v[20:23], 0
s_sub_u32 s37, s37, 1
s_cbranch_scc1 Lend_1
Lps_424:
s_waitcnt vmcnt(1)
v_max3_u32 v26, v36, v37, v38
v_max_u32 v26, v26, v39
v_cmp_eq_u32 vcc, -1, v26
s_cbranch_vccnz Lpf_425
v_smfmac_f32_16x16x64_bf16 v[76:79], v[36:39], a[192:199], v126
v_smfmac_f32_16x16x64_bf16 v[80:83], v[36:39], a[200:207], v126
v_smfmac_f32_16x16x64_bf16 v[84:87], v[36:39], a[208:215], v126
v_smfmac_f32_16x16x64_bf16 v[88:91], v[36:39], a[216:223], v126
s_branch Lps_382
Lpf_407:
buffer_load_dwordx4 v[32:35], v9, s[4:7], s40 offen offset:1024 sc1
v_mfma_f32_16x16x32_bf16 v[16:19], v[20:23], v[20:23], 0
s_sub_u32 s37, s37, 1
s_cbranch_scc1 Lend_1
s_branch Lps_380
Lpf_409:
buffer_load_dwordx4 v[36:39], v9, s[4:7], s40 offen offset:2048 sc1
v_mfma_f32_16x16x32_bf16 v[16:19], v[20:23], v[20:23], 0
s_sub_u32 s37, s37, 1
s_cbranch_scc1 Lend_1
s_branch Lps_384
Lpf_411:
buffer_load_dwordx4 v[40:43], v9, s[4:7], s40 offen offset:3072 sc1
v_mfma_f32_16x16x32_bf16 v[16:19], v[20:23], v[20:23], 0
Lps_426:
s_waitcnt vmcnt(3)
v_max3_u32 v26, v28, v29, v30
v_max_u32 v26, v26, v31
v_cmp_eq_u32 vcc, -1, v26
s_cbranch_vccnz Lpf_427
v_smfmac_f32_16x16x64_bf16 v[76:79], v[28:31], a[128:135], v126
v_smfmac_f32_16x16x64_bf16 v[80:83], v[28:31], a[136:143], v126
v_smfmac_f32_16x16x64_bf16 v[84:87], v[28:31], a[144:151], v126
v_smfmac_f32_16x16x64_bf16 v[88:91], v[28:31], a[152:159], v126
s_branch Lps_422
Lpf_413:
buffer_load_dwordx4 v[28:31], v9, s[4:7], s40 offen offset:0 sc1
v_mfma_f32_16x16x32_bf16 v[16:19], v[20:23], v[20:23], 0
s_sub_u32 s37, s37, 1
s_cbranch_scc1 Lend_1
Lps_428:
s_waitcnt vmcnt(2)
v_max3_u32 v26, v32, v33, v34
v_max_u32 v26, v26, v35
v_cmp_eq_u32 vcc, -1, v26
s_cbranch_vccnz Lpf_429
v_smfmac_f32_16x16x64_bf16 v[76:79], v[32:35], a[160:167], v126
v_smfmac_f32_16x16x64_bf16 v[80:83], v[32:35], a[168:175], v126
v_smfmac_f32_16x16x64_bf16 v[84:87], v[32:35], a[176:183], v126
v_smfmac_f32_16x16x64_bf16 v[88:91], v[32:35], a[184:191], v126
s_branch Lps_420
Lpf_415:
buffer_load_dwordx4 v[28:31], v9, s[4:7], s40 offen offset:0 sc1
v_mfma_f32_16x16x32_bf16 v[16:19], v[20:23], v[20:23], 0
s_sub_u32 s37, s37, 1
s_cbranch_scc1 Lend_1
Lps_430:
s_waitcnt vmcnt(2)
v_max3_u32 v26, v32, v33, v34
v_max_u32 v26, v26, v35
v_cmp_eq_u32 vcc, -1, v26
s_cbranch_vccnz Lpf_431
v_smfmac_f32_16x16x64_bf16 v[76:79], v[32:35], a[160:167], v126
v_smfmac_f32_16x16x64_bf16 v[80:83], v[32:35], a[168:175], v126
v_smfmac_f32_16x16x64_bf16 v[84:87], v[32:35], a[176:183], v126
v_smfmac_f32_16x16x64_bf16 v[88:91], v[32:35], a[184:191], v126
s_branch Lps_374
Lpf_417:
buffer_load_dwordx4 v[32:35], v9, s[4:7], s40 offen offset:1024 sc1
v_mfma_f32_16x16x32_bf16 v[16:19], v[20:23], v[20:23], 0
s_branch Lps_394
Lpf_419:
buffer_load_dwordx4 v[28:31], v9, s[4:7], s40 offen offset:0 sc1
v_mfma_f32_16x16x32_bf16 v[16:19], v[20:23], v[20:23], 0
s_sub_u32 s37, s37, 1
s_cbranch_scc1 Lend_1
s_branch Lps_372
Lpf_421:
buffer_load_dwordx4 v[36:39], v9, s[4:7], s40 offen offset:2048 sc1
v_mfma_f32_16x16x32_bf16 v[16:19], v[20:23], v[20:23], 0
s_branch Lps_398
Lpf_423:
buffer_load_dwordx4 v[32:35], v9, s[4:7], s40 offen offset:1024 sc1
v_mfma_f32_16x16x32_bf16 v[16:19], v[20:23], v[20:23], 0
s_sub_u32 s37, s37, 1
s_cbranch_scc1 Lend_1
s_branch Lps_378
Lpf_425:
buffer_load_dwordx4 v[36:39], v9, s[4:7], s40 offen offset:2048 sc1
v_mfma_f32_16x16x32_bf16 v[16:19], v[20:23], v[20:23], 0
s_branch Lps_404
Lpf_427:
buffer_load_dwordx4 v[28:31], v9, s[4:7], s40 offen offset:0 sc1
v_mfma_f32_16x16x32_bf16 v[16:19], v[20:23], v[20:23], 0
s_sub_u32 s37, s37, 1
s_cbranch_scc1 Lend_1
s_branch Lps_370
Lpf_429:
buffer_load_dwordx4 v[32:35], v9, s[4:7], s40 offen offset:1024 sc1
v_mfma_f32_16x16x32_bf16 v[16:19], v[20:23], v[20:23], 0
Lps_432:
s_waitcnt vmcnt(2)
v_max3_u32 v26, v36, v37, v38
v_max_u32 v26, v26, v39
v_cmp_eq_u32 vcc, -1, v26
s_cbranch_vccnz Lpf_433
v_smfmac_f32_16x16x64_bf16 v[76:79], v[36:39], a[192:199], v126
v_smfmac_f32_16x16x64_bf16 v[80:83], v[36:39], a[200:207], v126
v_smfmac_f32_16x16x64_bf16 v[84:87], v[36:39], a[208:215], v126
v_smfmac_f32_16x16x64_bf16 v[88:91], v[36:39], a[216:223], v126
s_branch Lps_394
Lpf_431:
buffer_load_dwordx4 v[32:35], v9, s[4:7], s40 offen offset:1024 sc1
v_mfma_f32_16x16x32_bf16 v[16:19], v[20:23], v[20:23], 0
s_branch Lps_392
Lpf_433:
buffer_load_dwordx4 v[36:39], v9, s[4:7], s40 offen offset:2048 sc1
v_mfma_f32_16x16x32_bf16 v[16:19], v[20:23], v[20:23], 0
s_branch Lps_412
Lkvo_sc1_284:
Lkvo_434:
s_and_b32 s38, s36, 3
s_lshl_b32 s39, s38, 16
s_add_u32 s40, s39, s45
s_xor_b32 s42, s40, 0x20000
s_add_u32 s26, s36, 1
s_mov_b64 exec, 15
buffer_load_dword v4, v1, s[4:7], s59 offen sc1
s_nop 11
buffer_load_dword v5, v1, s[4:7], s59 offen sc1
s_nop 11
buffer_load_dword v6, v1, s[4:7], s59 offen sc1
Lft_438:
s_waitcnt vmcnt(2)
v_cmp_gt_u32 vcc, s26, v4
s_cbranch_vccz Lfg_437
buffer_load_dword v4, v1, s[4:7], s59 offen sc1
s_waitcnt vmcnt(2)
v_cmp_gt_u32 vcc, s26, v5
s_cbranch_vccz Lfg_437
buffer_load_dword v5, v1, s[4:7], s59 offen sc1
s_waitcnt vmcnt(2)
v_cmp_gt_u32 vcc, s26, v6
s_cbranch_vccz Lfg_437
buffer_load_dword v6, v1, s[4:7], s59 offen sc1
s_sub_u32 s37, s37, 1
s_cbranch_scc1 Lend_1
s_branch Lft_438
Lfg_437:
s_mov_b64 exec, -1
Lkvo3_436:
buffer_load_dwordx4 v[28:31], v8, s[4:7], s40 offen offset:0 sc1
v_mfma_f32_16x16x32_bf16 v[16:19], v[20:23], v[20:23], 0
v_mfma_f32_16x16x32_bf16 v[16:19], v[20:23], v[20:23], 0
v_mfma_f32_16x16x32_bf16 v[16:19], v[20:23], v[20:23], 0
v_mfma_f32_16x16x32_bf16 v[16:19], v[20:23], v[20:23], 0
buffer_load_dwordx4 v[32:35], v8, s[4:7], s40 offen offset:1024 sc1
v_mfma_f32_16x16x32_bf16 v[16:19], v[20:23], v[20:23], 0
v_mfma_f32_16x16x32_bf16 v[16:19], v[20:23], v[20:23], 0
v_mfma_f32_16x16x32_bf16 v[16:19], v[20:23], v[20:23], 0
v_mfma_f32_16x16x32_bf16 v[16:19], v[20:23], v[20:23], 0
buffer_load_dwordx4 v[36:39], v8, s[4:7], s40 offen offset:2048 sc1
v_mfma_f32_16x16x32_bf16 v[16:19], v[20:23], v[20:23], 0
v_mfma_f32_16x16x32_bf16 v[16:19], v[20:23], v[20:23], 0
v_mfma_f32_16x16x32_bf16 v[16:19], v[20:23], v[20:23], 0
v_mfma_f32_16x16x32_bf16 v[16:19], v[20:23], v[20:23], 0
buffer_load_dwordx4 v[40:43], v8, s[4:7], s40 offen offset:3072 sc1
v_mfma_f32_16x16x32_bf16 v[16:19], v[20:23], v[20:23], 0
s_waitcnt vmcnt(3)
v_max3_u32 v26, v28, v29, v30
v_max_u32 v26, v26, v31
v_cmp_eq_u32 vcc, -1, v26
s_cbranch_vccnz Lpf_440
v_smfmac_f32_16x16x64_bf16 v[44:47], v[28:31], a[0:7], v126
v_smfmac_f32_16x16x64_bf16 v[48:51], v[28:31], a[8:15], v126
v_smfmac_f32_16x16x64_bf16 v[52:55], v[28:31], a[16:23], v126
v_smfmac_f32_16x16x64_bf16 v[56:59], v[28:31], a[24:31], v126
s_waitcnt vmcnt(2)
v_max3_u32 v26, v32, v33, v34
v_max_u32 v26, v26, v35
v_cmp_eq_u32 vcc, -1, v26
v_smfmac_f32_16x16x64_bf16 v[60:63], v[28:31], v[128:135], v126
v_smfmac_f32_16x16x64_bf16 v[64:67], v[28:31], v[136:143], v126
s_cbranch_vccnz Lpf_441
v_smfmac_f32_16x16x64_bf16 v[44:47], v[32:35], a[32:39], v126
v_smfmac_f32_16x16x64_bf16 v[48:51], v[32:35], a[40:47], v126
v_smfmac_f32_16x16x64_bf16 v[52:55], v[32:35], a[48:55], v126
v_smfmac_f32_16x16x64_bf16 v[56:59], v[32:35], a[56:63], v126
s_waitcnt vmcnt(1)
v_max3_u32 v26, v36, v37, v38
v_max_u32 v26, v26, v39
v_cmp_eq_u32 vcc, -1, v26
v_smfmac_f32_16x16x64_bf16 v[60:63], v[32:35], v[160:167], v126
v_smfmac_f32_16x16x64_bf16 v[64:67], v[32:35], v[168:175], v126
s_cbranch_vccnz Lpf_442
v_smfmac_f32_16x16x64_bf16 v[44:47], v[36:39], a[64:71], v126
v_smfmac_f32_16x16x64_bf16 v[48:51], v[36:39], a[72:79], v126
v_smfmac_f32_16x16x64_bf16 v[52:55], v[36:39], a[80:87], v126
v_smfmac_f32_16x16x64_bf16 v[56:59], v[36:39], a[88:95], v126
s_waitcnt vmcnt(0)
v_max3_u32 v26, v40, v41, v42
v_max_u32 v26, v26, v43
v_cmp_eq_u32 vcc, -1, v26
v_smfmac_f32_16x16x64_bf16 v[60:63], v[36:39], v[192:199], v126
v_smfmac_f32_16x16x64_bf16 v[64:67], v[36:39], v[200:207], v126
s_cbranch_vccnz Lpf_443
v_smfmac_f32_16x16x64_bf16 v[44:47], v[40:43], a[96:103], v126
v_smfmac_f32_16x16x64_bf16 v[48:51], v[40:43], a[104:111], v126
v_smfmac_f32_16x16x64_bf16 v[52:55], v[40:43], a[112:119], v126
v_smfmac_f32_16x16x64_bf16 v[56:59], v[40:43], a[120:127], v126
v_smfmac_f32_16x16x64_bf16 v[60:63], v[40:43], v[224:231], v126
v_smfmac_f32_16x16x64_bf16 v[64:67], v[40:43], v[232:239], v126
Lpd_439:
s_nop 2
v_add_f32 v92, v44, v45
v_add_f32 v93, v46, v47
v_add_f32 v94, v48, v49
v_add_f32 v95, v50, v51
v_add_f32 v96, v52, v53
ds_write_addtid_b32 v92 offset:0
v_add_f32 v97, v54, v55
ds_write_addtid_b32 v93 offset:640
v_add_f32 v98, v56, v57
ds_write_addtid_b32 v94 offset:288
v_add_f32 v99, v58, v59
ds_write_addtid_b32 v95 offset:928
ds_write_addtid_b32 v96 offset:1280
ds_write_addtid_b32 v97 offset:1920
ds_write_addtid_b32 v98 offset:1568
v_smfmac_f32_16x16x64_bf16 v[68:71], v[28:31], v[144:151], v126
ds_write_addtid_b32 v99 offset:2208
v_smfmac_f32_16x16x64_bf16 v[72:75], v[28:31], v[152:159], v126
v_smfmac_f32_16x16x64_bf16 v[68:71], v[32:35], v[176:183], v126
v_smfmac_f32_16x16x64_bf16 v[72:75], v[32:35], v[184:191], v126
s_waitcnt lgkmcnt(0)
s_barrier
ds_read_b64 v[100:101], v24 offset:0
ds_read_b64 v[102:103], v24 offset:2560
ds_read_b64 v[104:105], v24 offset:5120
ds_read_b64 v[106:107], v24 offset:7680
v_smfmac_f32_16x16x64_bf16 v[68:71], v[36:39], v[208:215], v126
v_smfmac_f32_16x16x64_bf16 v[72:75], v[36:39], v[216:223], v126
v_smfmac_f32_16x16x64_bf16 v[68:71], v[40:43], v[240:247], v126
s_waitcnt lgkmcnt(0)
v_pk_add_f32 v[100:101], v[100:101], v[102:103]
v_pk_add_f32 v[104:105], v[104:105], v[106:107]
v_pk_add_f32 v[116:117], v[100:101], v[104:105]
v_cvt_pk_bf16_f32 v116, v116, v117
v_min_u32 v116, -2, v116
buffer_store_dword v116, v11, s[4:7], s40 offen sc1
v_smfmac_f32_16x16x64_bf16 v[72:75], v[40:43], v[248:255], v126
s_nop 5
v_add_f32 v92, v60, v61
v_add_f32 v93, v62, v63
v_add_f32 v94, v64, v65
v_add_f32 v95, v66, v67
v_add_f32 v96, v68, v69
v_add_f32 v97, v70, v71
v_add_f32 v98, v72, v73
v_add_f32 v99, v74, v75
ds_write_b128 v25, v[92:95] offset:20480
ds_write_b128 v25, v[96:99] offset:20496
s_waitcnt lgkmcnt(0)
s_barrier
ds_read_b64 v[100:101], v127 offset:20480
ds_read_b64 v[102:103], v127 offset:22528
ds_read_b64 v[104:105], v127 offset:24576
ds_read_b64 v[106:107], v127 offset:26624
s_waitcnt lgkmcnt(0)
v_pk_add_f32 v[100:101], v[100:101], v[102:103]
v_pk_add_f32 v[104:105], v[104:105], v[106:107]
v_pk_add_f32 v[116:117], v[100:101], v[104:105]
v_cvt_pk_bf16_f32 v116, v116, v117
v_min_u32 v116, -2, v116
buffer_store_dword v116, v27, s[4:7], s40 offen sc1
s_cmp_eq_u32 s36, 63
s_cbranch_scc1 Lend_1
buffer_store_dword v120, v11, s[4:7], s42 offen sc1
buffer_store_dword v120, v27, s[4:7], s42 offen sc1
s_cmp_lt_u32 s32, 2
s_cbranch_scc1 Lr1_444
buffer_store_dwordx2 v[120:121], v10, s[4:7], s42 offen sc1
Lr1_444:
v_pk_mul_f32 v[44:45], 0, 0
v_pk_mul_f32 v[46:47], 0, 0
v_pk_mul_f32 v[48:49], 0, 0
v_pk_mul_f32 v[50:51], 0, 0
v_pk_mul_f32 v[52:53], 0, 0
v_pk_mul_f32 v[54:55], 0, 0
v_pk_mul_f32 v[56:57], 0, 0
v_pk_mul_f32 v[58:59], 0, 0
v_pk_mul_f32 v[60:61], 0, 0
v_pk_mul_f32 v[62:63], 0, 0
v_pk_mul_f32 v[64:65], 0, 0
v_pk_mul_f32 v[66:67], 0, 0
v_pk_mul_f32 v[68:69], 0, 0
v_pk_mul_f32 v[70:71], 0, 0
v_pk_mul_f32 v[72:73], 0, 0
v_pk_mul_f32 v[74:75], 0, 0
v_pk_mul_f32 v[76:77], 0, 0
v_pk_mul_f32 v[78:79], 0, 0
v_pk_mul_f32 v[80:81], 0, 0
v_pk_mul_f32 v[82:83], 0, 0
v_pk_mul_f32 v[84:85], 0, 0
v_pk_mul_f32 v[86:87], 0, 0
v_pk_mul_f32 v[88:89], 0, 0
v_pk_mul_f32 v[90:91], 0, 0
v_add_u32 v7, 1, v7
s_and_b32 s38, s36, 3
s_lshl_b32 s84, s38, 18
s_add_u32 s84, s84, s46
s_add_u32 s85, s84, 0x100000
s_and_b32 s38, s26, 3
s_lshl_b32 s38, s38, 16
s_add_u32 s41, s38, s45
s_mov_b64 exec, 3
buffer_load_dword v4, v2, s[4:7], s59 offen sc1
s_nop 11
buffer_load_dword v5, v2, s[4:7], s59 offen sc1
s_nop 11
buffer_load_dword v6, v2, s[4:7], s59 offen sc1
Lft_446:
s_waitcnt vmcnt(2)
v_cmp_gt_u32 vcc, s26, v4
s_cbranch_vccz Lfg_445
buffer_load_dword v4, v2, s[4:7], s59 offen sc1
s_waitcnt vmcnt(2)
v_cmp_gt_u32 vcc, s26, v5
s_cbranch_vccz Lfg_445
buffer_load_dword v5, v2, s[4:7], s59 offen sc1
s_waitcnt vmcnt(2)
v_cmp_gt_u32 vcc, s26, v6
s_cbranch_vccz Lfg_445
buffer_load_dword v6, v2, s[4:7], s59 offen sc1
s_sub_u32 s37, s37, 1
s_cbranch_scc1 Lend_1
s_branch Lft_446
Lfg_445:
s_mov_b64 exec, -1
buffer_load_dwordx4 v[28:31], v9, s[4:7], s40 offen offset:0 sc1
v_mfma_f32_16x16x32_bf16 v[16:19], v[20:23], v[20:23], 0
v_mfma_f32_16x16x32_bf16 v[16:19], v[20:23], v[20:23], 0
v_mfma_f32_16x16x32_bf16 v[16:19], v[20:23], v[20:23], 0
v_mfma_f32_16x16x32_bf16 v[16:19], v[20:23], v[20:23], 0
buffer_load_dwordx4 v[32:35], v9, s[4:7], s40 offen offset:1024 sc1
v_mfma_f32_16x16x32_bf16 v[16:19], v[20:23], v[20:23], 0
v_mfma_f32_16x16x32_bf16 v[16:19], v[20:23], v[20:23], 0
v_mfma_f32_16x16x32_bf16 v[16:19], v[20:23], v[20:23], 0
v_mfma_f32_16x16x32_bf16 v[16:19], v[20:23], v[20:23], 0
buffer_load_dwordx4 v[36:39], v9, s[4:7], s40 offen offset:2048 sc1
v_mfma_f32_16x16x32_bf16 v[16:19], v[20:23], v[20:23], 0
v_mfma_f32_16x16x32_bf16 v[16:19], v[20:23], v[20:23], 0
v_mfma_f32_16x16x32_bf16 v[16:19], v[20:23], v[20:23], 0
v_mfma_f32_16x16x32_bf16 v[16:19], v[20:23], v[20:23], 0
buffer_load_dwordx4 v[40:43], v9, s[4:7], s40 offen offset:3072 sc1
v_mfma_f32_16x16x32_bf16 v[16:19], v[20:23], v[20:23], 0
s_waitcnt vmcnt(3)
v_max3_u32 v26, v28, v29, v30
v_max_u32 v26, v26, v31
v_cmp_eq_u32 vcc, -1, v26
s_cbranch_vccnz Lpf_448
v_smfmac_f32_16x16x64_bf16 v[76:79], v[28:31], a[128:135], v126
v_smfmac_f32_16x16x64_bf16 v[80:83], v[28:31], a[136:143], v126
s_waitcnt vmcnt(2)
v_max3_u32 v26, v32, v33, v34
v_max_u32 v26, v26, v35
v_cmp_eq_u32 vcc, -1, v26
v_smfmac_f32_16x16x64_bf16 v[84:87], v[28:31], a[144:151], v126
v_smfmac_f32_16x16x64_bf16 v[88:91], v[28:31], a[152:159], v126
s_cbranch_vccnz Lpf_449
v_smfmac_f32_16x16x64_bf16 v[76:79], v[32:35], a[160:167], v126
v_smfmac_f32_16x16x64_bf16 v[80:83], v[32:35], a[168:175], v126
s_waitcnt vmcnt(1)
v_max3_u32 v26, v36, v37, v38
v_max_u32 v26, v26, v39
v_cmp_eq_u32 vcc, -1, v26
v_smfmac_f32_16x16x64_bf16 v[84:87], v[32:35], a[176:183], v126
v_smfmac_f32_16x16x64_bf16 v[88:91], v[32:35], a[184:191], v126
s_cbranch_vccnz Lpf_450
v_smfmac_f32_16x16x64_bf16 v[76:79], v[36:39], a[192:199], v126
v_smfmac_f32_16x16x64_bf16 v[80:83], v[36:39], a[200:207], v126
s_waitcnt vmcnt(0)
v_max3_u32 v26, v40, v41, v42
v_max_u32 v26, v26, v43
v_cmp_eq_u32 vcc, -1, v26
v_smfmac_f32_16x16x64_bf16 v[84:87], v[36:39], a[208:215], v126
v_smfmac_f32_16x16x64_bf16 v[88:91], v[36:39], a[216:223], v126
s_cbranch_vccnz Lpf_451
v_smfmac_f32_16x16x64_bf16 v[76:79], v[40:43], a[224:231], v126
v_smfmac_f32_16x16x64_bf16 v[80:83], v[40:43], a[232:239], v126
v_smfmac_f32_16x16x64_bf16 v[84:87], v[40:43], a[240:247], v126
v_smfmac_f32_16x16x64_bf16 v[88:91], v[40:43], a[248:255], v126
Lpd_447:
s_nop 4
v_add_f32 v92, v76, v77
v_add_f32 v93, v78, v79
v_add_f32 v94, v80, v81
v_add_f32 v95, v82, v83
v_add_f32 v96, v84, v85
ds_write_addtid_b32 v92 offset:10240
v_add_f32 v97, v86, v87
ds_write_addtid_b32 v93 offset:10528
v_add_f32 v98, v88, v89
ds_write_addtid_b32 v94 offset:10816
v_add_f32 v99, v90, v91
ds_write_addtid_b32 v95 offset:11104
ds_write_addtid_b32 v96 offset:11392
ds_write_addtid_b32 v97 offset:11680
ds_write_addtid_b32 v98 offset:11968
ds_write_addtid_b32 v99 offset:12256
v_mfma_f32_16x16x32_bf16 v[16:19], v[20:23], v[20:23], 0
v_mfma_f32_16x16x32_bf16 v[16:19], v[20:23], v[20:23], 0
s_cmp_ge_u32 s32, 2
s_cbranch_scc1 Lxl_452
s_waitcnt lgkmcnt(0)
s_barrier
ds_read_b64 v[100:101], v0 offset:10240
ds_read_b64 v[102:103], v0 offset:10816
ds_read_b64 v[104:105], v0 offset:12800
ds_read_b64 v[106:107], v0 offset:13376
ds_read_b64 v[108:109], v0 offset:15360
ds_read_b64 v[110:111], v0 offset:15936
ds_read_b64 v[112:113], v0 offset:17920
ds_read_b64 v[114:115], v0 offset:18496
s_waitcnt lgkmcnt(4)
v_pk_add_f32 v[100:101], v[100:101], v[104:105]
v_pk_add_f32 v[102:103], v[102:103], v[106:107]
s_waitcnt lgkmcnt(0)
v_pk_add_f32 v[108:109], v[108:109], v[112:113]
v_pk_add_f32 v[110:111], v[110:111], v[114:115]
v_pk_add_f32 v[116:117], v[100:101], v[108:109]
v_pk_add_f32 v[118:119], v[102:103], v[110:111]
v_cvt_pk_bf16_f32 v116, v116, v117
v_cvt_pk_bf16_f32 v117, v118, v119
v_min_u32 v116, -2, v116
v_min_u32 v117, -2, v117
buffer_store_dwordx2 v[116:117], v12, s[4:7], s84 offen sc1
buffer_store_dwordx2 v[116:117], v12, s[4:7], s85 offen sc1
v_mfma_f32_16x16x32_bf16 v[16:19], v[20:23], v[20:23], 0
v_mfma_f32_16x16x32_bf16 v[16:19], v[20:23], v[20:23], 0
v_mfma_f32_16x16x32_bf16 v[16:19], v[20:23], v[20:23], 0
v_mfma_f32_16x16x32_bf16 v[16:19], v[20:23], v[20:23], 0
v_mfma_f32_16x16x32_bf16 v[16:19], v[20:23], v[20:23], 0
v_mfma_f32_16x16x32_bf16 v[16:19], v[20:23], v[20:23], 0
v_mfma_f32_16x16x32_bf16 v[16:19], v[20:23], v[20:23], 0
v_mfma_f32_16x16x32_bf16 v[16:19], v[20:23], v[20:23], 0
v_mfma_f32_16x16x32_bf16 v[16:19], v[20:23], v[20:23], 0
v_mfma_f32_16x16x32_bf16 v[16:19], v[20:23], v[20:23], 0
v_mfma_f32_16x16x32_bf16 v[16:19], v[20:23], v[20:23], 0
v_mfma_f32_16x16x32_bf16 v[16:19], v[20:23], v[20:23], 0
v_mfma_f32_16x16x32_bf16 v[16:19], v[20:23], v[20:23], 0
v_mfma_f32_16x16x32_bf16 v[16:19], v[20:23], v[20:23], 0
v_mfma_f32_16x16x32_bf16 v[16:19], v[20:23], v[20:23], 0
v_mfma_f32_16x16x32_bf16 v[16:19], v[20:23], v[20:23], 0
v_mfma_f32_16x16x32_bf16 v[16:19], v[20:23], v[20:23], 0
v_mfma_f32_16x16x32_bf16 v[16:19], v[20:23], v[20:23], 0
v_mfma_f32_16x16x32_bf16 v[16:19], v[20:23], v[20:23], 0
v_mfma_f32_16x16x32_bf16 v[16:19], v[20:23], v[20:23], 0
v_mfma_f32_16x16x32_bf16 v[16:19], v[20:23], v[20:23], 0
v_mfma_f32_16x16x32_bf16 v[16:19], v[20:23], v[20:23], 0
v_mfma_f32_16x16x32_bf16 v[16:19], v[20:23], v[20:23], 0
v_mfma_f32_16x16x32_bf16 v[16:19], v[20:23], v[20:23], 0
v_mfma_f32_16x16x32_bf16 v[16:19], v[20:23], v[20:23], 0
v_mfma_f32_16x16x32_bf16 v[16:19], v[20:23], v[20:23], 0
v_mfma_f32_16x16x32_bf16 v[16:19], v[20:23], v[20:23], 0
v_mfma_f32_16x16x32_bf16 v[16:19], v[20:23], v[20:23], 0
v_mfma_f32_16x16x32_bf16 v[16:19], v[20:23], v[20:23], 0
v_mfma_f32_16x16x32_bf16 v[16:19], v[20:23], v[20:23], 0
v_mfma_f32_16x16x32_bf16 v[16:19], v[20:23], v[20:23], 0
v_mfma_f32_16x16x32_bf16 v[16:19], v[20:23], v[20:23], 0
v_mfma_f32_16x16x32_bf16 v[16:19], v[20:23], v[20:23], 0
v_mfma_f32_16x16x32_bf16 v[16:19], v[20:23], v[20:23], 0
v_mfma_f32_16x16x32_bf16 v[16:19], v[20:23], v[20:23], 0
v_mfma_f32_16x16x32_bf16 v[16:19], v[20:23], v[20:23], 0
buffer_store_dword v7, v3, s[4:7], s59 offen sc1
s_add_u32 s36, s36, 1
s_branch Lkvo_434
Lxl_452:
s_waitcnt lgkmcnt(0)
s_barrier
v_mfma_f32_16x16x32_bf16 v[16:19], v[20:23], v[20:23], 0
v_mfma_f32_16x16x32_bf16 v[16:19], v[20:23], v[20:23], 0
v_mfma_f32_16x16x32_bf16 v[16:19], v[20:23], v[20:23], 0
v_mfma_f32_16x16x32_bf16 v[16:19], v[20:23], v[20:23], 0
v_mfma_f32_16x16x32_bf16 v[16:19], v[20:23], v[20:23], 0
v_mfma_f32_16x16x32_bf16 v[16:19], v[20:23], v[20:23], 0
v_mfma_f32_16x16x32_bf16 v[16:19], v[20:23], v[20:23], 0
v_mfma_f32_16x16x32_bf16 v[16:19], v[20:23], v[20:23], 0
v_mfma_f32_16x16x32_bf16 v[16:19], v[20:23], v[20:23], 0
v_mfma_f32_16x16x32_bf16 v[16:19], v[20:23], v[20:23], 0
v_mfma_f32_16x16x32_bf16 v[16:19], v[20:23], v[20:23], 0
v_mfma_f32_16x16x32_bf16 v[16:19], v[20:23], v[20:23], 0
v_mfma_f32_16x16x32_bf16 v[16:19], v[20:23], v[20:23], 0
v_mfma_f32_16x16x32_bf16 v[16:19], v[20:23], v[20:23], 0
v_mfma_f32_16x16x32_bf16 v[16:19], v[20:23], v[20:23], 0
v_mfma_f32_16x16x32_bf16 v[16:19], v[20:23], v[20:23], 0
v_mfma_f32_16x16x32_bf16 v[16:19], v[20:23], v[20:23], 0
v_mfma_f32_16x16x32_bf16 v[16:19], v[20:23], v[20:23], 0
v_mfma_f32_16x16x32_bf16 v[16:19], v[20:23], v[20:23], 0
v_mfma_f32_16x16x32_bf16 v[16:19], v[20:23], v[20:23], 0
v_mfma_f32_16x16x32_bf16 v[16:19], v[20:23], v[20:23], 0
v_mfma_f32_16x16x32_bf16 v[16:19], v[20:23], v[20:23], 0
v_mfma_f32_16x16x32_bf16 v[16:19], v[20:23], v[20:23], 0
v_mfma_f32_16x16x32_bf16 v[16:19], v[20:23], v[20:23], 0
v_mfma_f32_16x16x32_bf16 v[16:19], v[20:23], v[20:23], 0
v_mfma_f32_16x16x32_bf16 v[16:19], v[20:23], v[20:23], 0
v_mfma_f32_16x16x32_bf16 v[16:19], v[20:23], v[20:23], 0
v_mfma_f32_16x16x32_bf16 v[16:19], v[20:23], v[20:23], 0
buffer_load_dwordx2 v[76:77], v13, s[4:7], s84 offen sc1
buffer_load_dwordx2 v[78:79], v14, s[4:7], s84 offen sc1
buffer_load_dwordx2 v[80:81], v15, s[4:7], s84 offen sc1
v_mfma_f32_16x16x32_bf16 v[16:19], v[20:23], v[20:23], 0
v_mfma_f32_16x16x32_bf16 v[16:19], v[20:23], v[20:23], 0
v_mfma_f32_16x16x32_bf16 v[16:19], v[20:23], v[20:23], 0
v_mfma_f32_16x16x32_bf16 v[16:19], v[20:23], v[20:23], 0
v_mfma_f32_16x16x32_bf16 v[16:19], v[20:23], v[20:23], 0
v_mfma_f32_16x16x32_bf16 v[16:19], v[20:23], v[20:23], 0
v_mfma_f32_16x16x32_bf16 v[16:19], v[20:23], v[20:23], 0
v_mfma_f32_16x16x32_bf16 v[16:19], v[20:23], v[20:23], 0
v_mfma_f32_16x16x32_bf16 v[16:19], v[20:23], v[20:23], 0
v_mfma_f32_16x16x32_bf16 v[16:19], v[20:23], v[20:23], 0
v_mfma_f32_16x16x32_bf16 v[16:19], v[20:23], v[20:23], 0
v_mfma_f32_16x16x32_bf16 v[16:19], v[20:23], v[20:23], 0
buffer_load_dwordx2 v[88:89], v13, s[4:7], s85 offen sc1
buffer_load_dwordx2 v[90:91], v14, s[4:7], s85 offen sc1
buffer_load_dwordx2 v[92:93], v15, s[4:7], s85 offen sc1
ds_read_b64 v[100:101], v0 offset:10240
ds_read_b64 v[102:103], v0 offset:10816
ds_read_b64 v[104:105], v0 offset:12800
ds_read_b64 v[106:107], v0 offset:13376
ds_read_b64 v[108:109], v0 offset:15360
ds_read_b64 v[110:111], v0 offset:15936
ds_read_b64 v[112:113], v0 offset:17920
ds_read_b64 v[114:115], v0 offset:18496
s_waitcnt lgkmcnt(4)
v_pk_add_f32 v[100:101], v[100:101], v[104:105]
v_pk_add_f32 v[102:103], v[102:103], v[106:107]
s_waitcnt lgkmcnt(0)
v_pk_add_f32 v[108:109], v[108:109], v[112:113]
v_pk_add_f32 v[110:111], v[110:111], v[114:115]
v_pk_add_f32 v[116:117], v[100:101], v[108:109]
v_pk_add_f32 v[118:119], v[102:103], v[110:111]
v_cvt_pk_bf16_f32 v100, v116, v117
v_cvt_pk_bf16_f32 v101, v118, v119
v_lshlrev_b32 v116, 16, v100
v_and_b32 v117, 0xffff0000, v100
v_lshlrev_b32 v118, 16, v101
v_and_b32 v119, 0xffff0000, v101
v_mfma_f32_16x16x32_bf16 v[16:19], v[20:23], v[20:23], 0
v_mfma_f32_16x16x32_bf16 v[16:19], v[20:23], v[20:23], 0
v_mfma_f32_16x16x32_bf16 v[16:19], v[20:23], v[20:23], 0
v_mfma_f32_16x16x32_bf16 v[16:19], v[20:23], v[20:23], 0
buffer_load_dwordx2 v[28:29], v13, s[4:7], s84 offen sc1
buffer_load_dwordx2 v[30:31], v14, s[4:7], s84 offen sc1
buffer_load_dwordx2 v[32:33], v15, s[4:7], s84 offen sc1
s_waitcnt vmcnt(6)
v_max3_u32 v26, v76, v77, v78
v_max3_u32 v26, v26, v79, v80
v_max_u32 v26, v26, v81
v_cmp_eq_u32 vcc, -1, v26
v_dot2_f32_bf16 v100, v76, s55, v116
v_dot2_f32_bf16 v101, v76, s56, v117
v_dot2_f32_bf16 v102, v77, s55, v118
v_dot2_f32_bf16 v103, v77, s56, v119
v_dot2_f32_bf16 v100, v78, s55, v100
v_dot2_f32_bf16 v101, v78, s56, v101
v_dot2_f32_bf16 v102, v79, s55, v102
v_dot2_f32_bf16 v103, v79, s56, v103
v_dot2_f32_bf16 v100, v80, s55, v100
v_dot2_f32_bf16 v101, v80, s56, v101
v_dot2_f32_bf16 v102, v81, s55, v102
v_dot2_f32_bf16 v103, v81, s56, v103
s_nop 1
v_cvt_pk_bf16_f32 v100, v100, v101
v_cvt_pk_bf16_f32 v101, v102, v103
v_min_u32 v100, -2, v100
v_min_u32 v101, -2, v101
s_cbranch_vccnz Lx2_453
Lxs_454:
buffer_store_dwordx2 v[100:101], v10, s[4:7], s41 offen sc1
s_add_u32 s36, s36, 1
s_and_b32 s38, s36, 3
s_lshl_b32 s39, s38, 16
s_add_u32 s40, s39, s45
s_xor_b32 s42, s40, 0x20000
s_add_u32 s26, s36, 1
v_mfma_f32_16x16x32_bf16 v[16:19], v[20:23], v[20:23], 0
v_mfma_f32_16x16x32_bf16 v[16:19], v[20:23], v[20:23], 0
v_mfma_f32_16x16x32_bf16 v[16:19], v[20:23], v[20:23], 0
v_mfma_f32_16x16x32_bf16 v[16:19], v[20:23], v[20:23], 0
v_mfma_f32_16x16x32_bf16 v[16:19], v[20:23], v[20:23], 0
v_mfma_f32_16x16x32_bf16 v[16:19], v[20:23], v[20:23], 0
v_mfma_f32_16x16x32_bf16 v[16:19], v[20:23], v[20:23], 0
v_mfma_f32_16x16x32_bf16 v[16:19], v[20:23], v[20:23], 0
s_branch Lkvo3_436
Lx2_453:
buffer_load_dwordx2 v[76:77], v13, s[4:7], s85 offen sc1
buffer_load_dwordx2 v[78:79], v14, s[4:7], s85 offen sc1
buffer_load_dwordx2 v[80:81], v15, s[4:7], s85 offen sc1
s_waitcnt vmcnt(6)
v_max3_u32 v26, v88, v89, v90
v_max3_u32 v26, v26, v91, v92
v_max_u32 v26, v26, v93
v_cmp_eq_u32 vcc, -1, v26
v_dot2_f32_bf16 v100, v88, s55, v116
v_dot2_f32_bf16 v101, v88, s56, v117
v_dot2_f32_bf16 v102, v89, s55, v118
v_dot2_f32_bf16 v103, v89, s56, v119
v_dot2_f32_bf16 v100, v90, s55, v100
v_dot2_f32_bf16 v101, v90, s56, v101
v_dot2_f32_bf16 v102, v91, s55, v102
v_dot2_f32_bf16 v103, v91, s56, v103
v_dot2_f32_bf16 v100, v92, s55, v100
v_dot2_f32_bf16 v101, v92, s56, v101
v_dot2_f32_bf16 v102, v93, s55, v102
v_dot2_f32_bf16 v103, v93, s56, v103
s_nop 1
v_cvt_pk_bf16_f32 v100, v100, v101
v_cvt_pk_bf16_f32 v101, v102, v103
v_min_u32 v100, -2, v100
v_min_u32 v101, -2, v101
s_cbranch_vccz Lxs_454
buffer_load_dwordx2 v[88:89], v13, s[4:7], s84 offen sc1
buffer_load_dwordx2 v[90:91], v14, s[4:7], s84 offen sc1
buffer_load_dwordx2 v[92:93], v15, s[4:7], s84 offen sc1
s_waitcnt vmcnt(6)
v_max3_u32 v26, v28, v29, v30
v_max3_u32 v26, v26, v31, v32
v_max_u32 v26, v26, v33
v_cmp_eq_u32 vcc, -1, v26
v_dot2_f32_bf16 v100, v28, s55, v116
v_dot2_f32_bf16 v101, v28, s56, v117
v_dot2_f32_bf16 v102, v29, s55, v118
v_dot2_f32_bf16 v103, v29, s56, v119
v_dot2_f32_bf16 v100, v30, s55, v100
v_dot2_f32_bf16 v101, v30, s56, v101
v_dot2_f32_bf16 v102, v31, s55, v102
v_dot2_f32_bf16 v103, v31, s56, v103
v_dot2_f32_bf16 v100, v32, s55, v100
v_dot2_f32_bf16 v101, v32, s56, v101
v_dot2_f32_bf16 v102, v33, s55, v102
v_dot2_f32_bf16 v103, v33, s56, v103
s_nop 1
v_cvt_pk_bf16_f32 v100, v100, v101
v_cvt_pk_bf16_f32 v101, v102, v103
v_min_u32 v100, -2, v100
v_min_u32 v101, -2, v101
s_cbranch_vccz Lxs_454
buffer_load_dwordx2 v[28:29], v13, s[4:7], s85 offen sc1
buffer_load_dwordx2 v[30:31], v14, s[4:7], s85 offen sc1
buffer_load_dwordx2 v[32:33], v15, s[4:7], s85 offen sc1
s_waitcnt vmcnt(6)
v_max3_u32 v26, v76, v77, v78
v_max3_u32 v26, v26, v79, v80
v_max_u32 v26, v26, v81
v_cmp_eq_u32 vcc, -1, v26
v_dot2_f32_bf16 v100, v76, s55, v116
v_dot2_f32_bf16 v101, v76, s56, v117
v_dot2_f32_bf16 v102, v77, s55, v118
v_dot2_f32_bf16 v103, v77, s56, v119
v_dot2_f32_bf16 v100, v78, s55, v100
v_dot2_f32_bf16 v101, v78, s56, v101
v_dot2_f32_bf16 v102, v79, s55, v102
v_dot2_f32_bf16 v103, v79, s56, v103
v_dot2_f32_bf16 v100, v80, s55, v100
v_dot2_f32_bf16 v101, v80, s56, v101
v_dot2_f32_bf16 v102, v81, s55, v102
v_dot2_f32_bf16 v103, v81, s56, v103
s_nop 1
v_cvt_pk_bf16_f32 v100, v100, v101
v_cvt_pk_bf16_f32 v101, v102, v103
v_min_u32 v100, -2, v100
v_min_u32 v101, -2, v101
s_cbranch_vccz Lxs_454
buffer_load_dwordx2 v[76:77], v13, s[4:7], s84 offen sc1
buffer_load_dwordx2 v[78:79], v14, s[4:7], s84 offen sc1
buffer_load_dwordx2 v[80:81], v15, s[4:7], s84 offen sc1
s_waitcnt vmcnt(6)
v_max3_u32 v26, v88, v89, v90
v_max3_u32 v26, v26, v91, v92
v_max_u32 v26, v26, v93
v_cmp_eq_u32 vcc, -1, v26
v_dot2_f32_bf16 v100, v88, s55, v116
v_dot2_f32_bf16 v101, v88, s56, v117
v_dot2_f32_bf16 v102, v89, s55, v118
v_dot2_f32_bf16 v103, v89, s56, v119
v_dot2_f32_bf16 v100, v90, s55, v100
v_dot2_f32_bf16 v101, v90, s56, v101
v_dot2_f32_bf16 v102, v91, s55, v102
v_dot2_f32_bf16 v103, v91, s56, v103
v_dot2_f32_bf16 v100, v92, s55, v100
v_dot2_f32_bf16 v101, v92, s56, v101
v_dot2_f32_bf16 v102, v93, s55, v102
v_dot2_f32_bf16 v103, v93, s56, v103
s_nop 1
v_cvt_pk_bf16_f32 v100, v100, v101
v_cvt_pk_bf16_f32 v101, v102, v103
v_min_u32 v100, -2, v100
v_min_u32 v101, -2, v101
s_cbranch_vccz Lxs_454
buffer_load_dwordx2 v[88:89], v13, s[4:7], s85 offen sc1
buffer_load_dwordx2 v[90:91], v14, s[4:7], s85 offen sc1
buffer_load_dwordx2 v[92:93], v15, s[4:7], s85 offen sc1
s_waitcnt vmcnt(6)
v_max3_u32 v26, v28, v29, v30
v_max3_u32 v26, v26, v31, v32
v_max_u32 v26, v26, v33
v_cmp_eq_u32 vcc, -1, v26
v_dot2_f32_bf16 v100, v28, s55, v116
v_dot2_f32_bf16 v101, v28, s56, v117
v_dot2_f32_bf16 v102, v29, s55, v118
v_dot2_f32_bf16 v103, v29, s56, v119
v_dot2_f32_bf16 v100, v30, s55, v100
v_dot2_f32_bf16 v101, v30, s56, v101
v_dot2_f32_bf16 v102, v31, s55, v102
v_dot2_f32_bf16 v103, v31, s56, v103
v_dot2_f32_bf16 v100, v32, s55, v100
v_dot2_f32_bf16 v101, v32, s56, v101
v_dot2_f32_bf16 v102, v33, s55, v102
v_dot2_f32_bf16 v103, v33, s56, v103
s_nop 1
v_cvt_pk_bf16_f32 v100, v100, v101
v_cvt_pk_bf16_f32 v101, v102, v103
v_min_u32 v100, -2, v100
v_min_u32 v101, -2, v101
s_cbranch_vccz Lxs_454
buffer_load_dwordx2 v[28:29], v13, s[4:7], s84 offen sc1
buffer_load_dwordx2 v[30:31], v14, s[4:7], s84 offen sc1
buffer_load_dwordx2 v[32:33], v15, s[4:7], s84 offen sc1
s_waitcnt vmcnt(6)
v_max3_u32 v26, v76, v77, v78
v_max3_u32 v26, v26, v79, v80
v_max_u32 v26, v26, v81
v_cmp_eq_u32 vcc, -1, v26
v_dot2_f32_bf16 v100, v76, s55, v116
v_dot2_f32_bf16 v101, v76, s56, v117
v_dot2_f32_bf16 v102, v77, s55, v118
v_dot2_f32_bf16 v103, v77, s56, v119
v_dot2_f32_bf16 v100, v78, s55, v100
v_dot2_f32_bf16 v101, v78, s56, v101
v_dot2_f32_bf16 v102, v79, s55, v102
v_dot2_f32_bf16 v103, v79, s56, v103
v_dot2_f32_bf16 v100, v80, s55, v100
v_dot2_f32_bf16 v101, v80, s56, v101
v_dot2_f32_bf16 v102, v81, s55, v102
v_dot2_f32_bf16 v103, v81, s56, v103
s_nop 1
v_cvt_pk_bf16_f32 v100, v100, v101
v_cvt_pk_bf16_f32 v101, v102, v103
v_min_u32 v100, -2, v100
v_min_u32 v101, -2, v101
s_cbranch_vccz Lxs_454
s_sub_u32 s37, s37, 1
s_cbranch_scc1 Lend_1
s_branch Lx2_453
Lpf_440:
buffer_load_dwordx4 v[28:31], v8, s[4:7], s40 offen offset:0 sc1
v_mfma_f32_16x16x32_bf16 v[16:19], v[20:23], v[20:23], 0
s_sub_u32 s37, s37, 1
s_cbranch_scc1 Lend_1
Lps_455:
s_waitcnt vmcnt(3)
v_max3_u32 v26, v32, v33, v34
v_max_u32 v26, v26, v35
v_cmp_eq_u32 vcc, -1, v26
s_cbranch_vccnz Lpf_456
v_smfmac_f32_16x16x64_bf16 v[44:47], v[32:35], a[32:39], v126
v_smfmac_f32_16x16x64_bf16 v[48:51], v[32:35], a[40:47], v126
v_smfmac_f32_16x16x64_bf16 v[52:55], v[32:35], a[48:55], v126
v_smfmac_f32_16x16x64_bf16 v[56:59], v[32:35], a[56:63], v126
v_smfmac_f32_16x16x64_bf16 v[60:63], v[32:35], v[160:167], v126
v_smfmac_f32_16x16x64_bf16 v[64:67], v[32:35], v[168:175], v126
Lps_457:
s_waitcnt vmcnt(2)
v_max3_u32 v26, v36, v37, v38
v_max_u32 v26, v26, v39
v_cmp_eq_u32 vcc, -1, v26
s_cbranch_vccnz Lpf_458
v_smfmac_f32_16x16x64_bf16 v[44:47], v[36:39], a[64:71], v126
v_smfmac_f32_16x16x64_bf16 v[48:51], v[36:39], a[72:79], v126
v_smfmac_f32_16x16x64_bf16 v[52:55], v[36:39], a[80:87], v126
v_smfmac_f32_16x16x64_bf16 v[56:59], v[36:39], a[88:95], v126
v_smfmac_f32_16x16x64_bf16 v[60:63], v[36:39], v[192:199], v126
v_smfmac_f32_16x16x64_bf16 v[64:67], v[36:39], v[200:207], v126
Lps_459:
s_waitcnt vmcnt(1)
v_max3_u32 v26, v40, v41, v42
v_max_u32 v26, v26, v43
v_cmp_eq_u32 vcc, -1, v26
s_cbranch_vccnz Lpf_460
v_smfmac_f32_16x16x64_bf16 v[44:47], v[40:43], a[96:103], v126
v_smfmac_f32_16x16x64_bf16 v[48:51], v[40:43], a[104:111], v126
v_smfmac_f32_16x16x64_bf16 v[52:55], v[40:43], a[112:119], v126
v_smfmac_f32_16x16x64_bf16 v[56:59], v[40:43], a[120:127], v126
v_smfmac_f32_16x16x64_bf16 v[60:63], v[40:43], v[224:231], v126
v_smfmac_f32_16x16x64_bf16 v[64:67], v[40:43], v[232:239], v126
Lps_461:
s_waitcnt vmcnt(0)
v_max3_u32 v26, v28, v29, v30
v_max_u32 v26, v26, v31
v_cmp_eq_u32 vcc, -1, v26
s_cbranch_vccnz Lpf_462
v_smfmac_f32_16x16x64_bf16 v[44:47], v[28:31], a[0:7], v126
v_smfmac_f32_16x16x64_bf16 v[48:51], v[28:31], a[8:15], v126
v_smfmac_f32_16x16x64_bf16 v[52:55], v[28:31], a[16:23], v126
v_smfmac_f32_16x16x64_bf16 v[56:59], v[28:31], a[24:31], v126
v_smfmac_f32_16x16x64_bf16 v[60:63], v[28:31], v[128:135], v126
v_smfmac_f32_16x16x64_bf16 v[64:67], v[28:31], v[136:143], v126
s_branch Lpd_439
Lpf_441:
buffer_load_dwordx4 v[32:35], v8, s[4:7], s40 offen offset:1024 sc1
v_mfma_f32_16x16x32_bf16 v[16:19], v[20:23], v[20:23], 0
s_sub_u32 s37, s37, 1
s_cbranch_scc1 Lend_1
Lps_463:
s_waitcnt vmcnt(2)
v_max3_u32 v26, v36, v37, v38
v_max_u32 v26, v26, v39
v_cmp_eq_u32 vcc, -1, v26
s_cbranch_vccnz Lpf_464
v_smfmac_f32_16x16x64_bf16 v[44:47], v[36:39], a[64:71], v126
v_smfmac_f32_16x16x64_bf16 v[48:51], v[36:39], a[72:79], v126
v_smfmac_f32_16x16x64_bf16 v[52:55], v[36:39], a[80:87], v126
v_smfmac_f32_16x16x64_bf16 v[56:59], v[36:39], a[88:95], v126
v_smfmac_f32_16x16x64_bf16 v[60:63], v[36:39], v[192:199], v126
v_smfmac_f32_16x16x64_bf16 v[64:67], v[36:39], v[200:207], v126
Lps_465:
s_waitcnt vmcnt(1)
v_max3_u32 v26, v40, v41, v42
v_max_u32 v26, v26, v43
v_cmp_eq_u32 vcc, -1, v26
s_cbranch_vccnz Lpf_466
v_smfmac_f32_16x16x64_bf16 v[44:47], v[40:43], a[96:103], v126
v_smfmac_f32_16x16x64_bf16 v[48:51], v[40:43], a[104:111], v126
v_smfmac_f32_16x16x64_bf16 v[52:55], v[40:43], a[112:119], v126
v_smfmac_f32_16x16x64_bf16 v[56:59], v[40:43], a[120:127], v126
v_smfmac_f32_16x16x64_bf16 v[60:63], v[40:43], v[224:231], v126
v_smfmac_f32_16x16x64_bf16 v[64:67], v[40:43], v[232:239], v126
Lps_467:
s_waitcnt vmcnt(0)
v_max3_u32 v26, v32, v33, v34
v_max_u32 v26, v26, v35
v_cmp_eq_u32 vcc, -1, v26
s_cbranch_vccnz Lpf_468
v_smfmac_f32_16x16x64_bf16 v[44:47], v[32:35], a[32:39], v126
v_smfmac_f32_16x16x64_bf16 v[48:51], v[32:35], a[40:47], v126
v_smfmac_f32_16x16x64_bf16 v[52:55], v[32:35], a[48:55], v126
v_smfmac_f32_16x16x64_bf16 v[56:59], v[32:35], a[56:63], v126
v_smfmac_f32_16x16x64_bf16 v[60:63], v[32:35], v[160:167], v126
v_smfmac_f32_16x16x64_bf16 v[64:67], v[32:35], v[168:175], v126
s_branch Lpd_439
Lpf_442:
buffer_load_dwordx4 v[36:39], v8, s[4:7], s40 offen offset:2048 sc1
v_mfma_f32_16x16x32_bf16 v[16:19], v[20:23], v[20:23], 0
s_sub_u32 s37, s37, 1
s_cbranch_scc1 Lend_1
Lps_469:
s_waitcnt vmcnt(1)
v_max3_u32 v26, v40, v41, v42
v_max_u32 v26, v26, v43
v_cmp_eq_u32 vcc, -1, v26
s_cbranch_vccnz Lpf_470
v_smfmac_f32_16x16x64_bf16 v[44:47], v[40:43], a[96:103], v126
v_smfmac_f32_16x16x64_bf16 v[48:51], v[40:43], a[104:111], v126
v_smfmac_f32_16x16x64_bf16 v[52:55], v[40:43], a[112:119], v126
v_smfmac_f32_16x16x64_bf16 v[56:59], v[40:43], a[120:127], v126
v_smfmac_f32_16x16x64_bf16 v[60:63], v[40:43], v[224:231], v126
v_smfmac_f32_16x16x64_bf16 v[64:67], v[40:43], v[232:239], v126
Lps_471:
s_waitcnt vmcnt(0)
v_max3_u32 v26, v36, v37, v38
v_max_u32 v26, v26, v39
v_cmp_eq_u32 vcc, -1, v26
s_cbranch_vccnz Lpf_472
v_smfmac_f32_16x16x64_bf16 v[44:47], v[36:39], a[64:71], v126
v_smfmac_f32_16x16x64_bf16 v[48:51], v[36:39], a[72:79], v126
v_smfmac_f32_16x16x64_bf16 v[52:55], v[36:39], a[80:87], v126
v_smfmac_f32_16x16x64_bf16 v[56:59], v[36:39], a[88:95], v126
v_smfmac_f32_16x16x64_bf16 v[60:63], v[36:39], v[192:199], v126
v_smfmac_f32_16x16x64_bf16 v[64:67], v[36:39], v[200:207], v126
s_branch Lpd_439
Lpf_443:
buffer_load_dwordx4 v[40:43], v8, s[4:7], s40 offen offset:3072 sc1
v_mfma_f32_16x16x32_bf16 v[16:19], v[20:23], v[20:23], 0
s_sub_u32 s37, s37, 1
s_cbranch_scc1 Lend_1
Lps_473:
s_waitcnt vmcnt(0)
v_max3_u32 v26, v40, v41, v42
v_max_u32 v26, v26, v43
v_cmp_eq_u32 vcc, -1, v26
s_cbranch_vccnz Lpf_474
v_smfmac_f32_16x16x64_bf16 v[44:47], v[40:43], a[96:103], v126
v_smfmac_f32_16x16x64_bf16 v[48:51], v[40:43], a[104:111], v126
v_smfmac_f32_16x16x64_bf16 v[52:55], v[40:43], a[112:119], v126
v_smfmac_f32_16x16x64_bf16 v[56:59], v[40:43], a[120:127], v126
v_smfmac_f32_16x16x64_bf16 v[60:63], v[40:43], v[224:231], v126
v_smfmac_f32_16x16x64_bf16 v[64:67], v[40:43], v[232:239], v126
s_branch Lpd_439
Lpf_456:
buffer_load_dwordx4 v[32:35], v8, s[4:7], s40 offen offset:1024 sc1
v_mfma_f32_16x16x32_bf16 v[16:19], v[20:23], v[20:23], 0
Lps_475:
s_waitcnt vmcnt(3)
v_max3_u32 v26, v36, v37, v38
v_max_u32 v26, v26, v39
v_cmp_eq_u32 vcc, -1, v26
s_cbranch_vccnz Lpf_476
v_smfmac_f32_16x16x64_bf16 v[44:47], v[36:39], a[64:71], v126
v_smfmac_f32_16x16x64_bf16 v[48:51], v[36:39], a[72:79], v126
v_smfmac_f32_16x16x64_bf16 v[52:55], v[36:39], a[80:87], v126
v_smfmac_f32_16x16x64_bf16 v[56:59], v[36:39], a[88:95], v126
v_smfmac_f32_16x16x64_bf16 v[60:63], v[36:39], v[192:199], v126
v_smfmac_f32_16x16x64_bf16 v[64:67], v[36:39], v[200:207], v126
Lps_477:
s_waitcnt vmcnt(2)
v_max3_u32 v26, v40, v41, v42
v_max_u32 v26, v26, v43
v_cmp_eq_u32 vcc, -1, v26
s_cbranch_vccnz Lpf_478
v_smfmac_f32_16x16x64_bf16 v[44:47], v[40:43], a[96:103], v126
v_smfmac_f32_16x16x64_bf16 v[48:51], v[40:43], a[104:111], v126
v_smfmac_f32_16x16x64_bf16 v[52:55], v[40:43], a[112:119], v126
v_smfmac_f32_16x16x64_bf16 v[56:59], v[40:43], a[120:127], v126
v_smfmac_f32_16x16x64_bf16 v[60:63], v[40:43], v[224:231], v126
v_smfmac_f32_16x16x64_bf16 v[64:67], v[40:43], v[232:239], v126
Lps_479:
s_waitcnt vmcnt(1)
v_max3_u32 v26, v28, v29, v30
v_max_u32 v26, v26, v31
v_cmp_eq_u32 vcc, -1, v26
s_cbranch_vccnz Lpf_480
v_smfmac_f32_16x16x64_bf16 v[44:47], v[28:31], a[0:7], v126
v_smfmac_f32_16x16x64_bf16 v[48:51], v[28:31], a[8:15], v126
v_smfmac_f32_16x16x64_bf16 v[52:55], v[28:31], a[16:23], v126
v_smfmac_f32_16x16x64_bf16 v[56:59], v[28:31], a[24:31], v126
v_smfmac_f32_16x16x64_bf16 v[60:63], v[28:31], v[128:135], v126
v_smfmac_f32_16x16x64_bf16 v[64:67], v[28:31], v[136:143], v126
s_branch Lps_467
Lpf_458:
buffer_load_dwordx4 v[36:39], v8, s[4:7], s40 offen offset:2048 sc1
v_mfma_f32_16x16x32_bf16 v[16:19], v[20:23], v[20:23], 0
Lps_481:
s_waitcnt vmcnt(2)
v_max3_u32 v26, v40, v41, v42
v_max_u32 v26, v26, v43
v_cmp_eq_u32 vcc, -1, v26
s_cbranch_vccnz Lpf_482
v_smfmac_f32_16x16x64_bf16 v[44:47], v[40:43], a[96:103], v126
v_smfmac_f32_16x16x64_bf16 v[48:51], v[40:43], a[104:111], v126
v_smfmac_f32_16x16x64_bf16 v[52:55], v[40:43], a[112:119], v126
v_smfmac_f32_16x16x64_bf16 v[56:59], v[40:43], a[120:127], v126
v_smfmac_f32_16x16x64_bf16 v[60:63], v[40:43], v[224:231], v126
v_smfmac_f32_16x16x64_bf16 v[64:67], v[40:43], v[232:239], v126
Lps_483:
s_waitcnt vmcnt(1)
v_max3_u32 v26, v28, v29, v30
v_max_u32 v26, v26, v31
v_cmp_eq_u32 vcc, -1, v26
s_cbranch_vccnz Lpf_484
v_smfmac_f32_16x16x64_bf16 v[44:47], v[28:31], a[0:7], v126
v_smfmac_f32_16x16x64_bf16 v[48:51], v[28:31], a[8:15], v126
v_smfmac_f32_16x16x64_bf16 v[52:55], v[28:31], a[16:23], v126
v_smfmac_f32_16x16x64_bf16 v[56:59], v[28:31], a[24:31], v126
v_smfmac_f32_16x16x64_bf16 v[60:63], v[28:31], v[128:135], v126
v_smfmac_f32_16x16x64_bf16 v[64:67], v[28:31], v[136:143], v126
s_branch Lps_471
Lpf_460:
buffer_load_dwordx4 v[40:43], v8, s[4:7], s40 offen offset:3072 sc1
v_mfma_f32_16x16x32_bf16 v[16:19], v[20:23], v[20:23], 0
Lps_485:
s_waitcnt vmcnt(1)
v_max3_u32 v26, v28, v29, v30
v_max_u32 v26, v26, v31
v_cmp_eq_u32 vcc, -1, v26
s_cbranch_vccnz Lpf_486
v_smfmac_f32_16x16x64_bf16 v[44:47], v[28:31], a[0:7], v126
v_smfmac_f32_16x16x64_bf16 v[48:51], v[28:31], a[8:15], v126
v_smfmac_f32_16x16x64_bf16 v[52:55], v[28:31], a[16:23], v126
v_smfmac_f32_16x16x64_bf16 v[56:59], v[28:31], a[24:31], v126
v_smfmac_f32_16x16x64_bf16 v[60:63], v[28:31], v[128:135], v126
v_smfmac_f32_16x16x64_bf16 v[64:67], v[28:31], v[136:143], v126
s_branch Lps_473
Lpf_462:
buffer_load_dwordx4 v[28:31], v8, s[4:7], s40 offen offset:0 sc1
v_mfma_f32_16x16x32_bf16 v[16:19], v[20:23], v[20:23], 0
s_sub_u32 s37, s37, 1
s_cbranch_scc1 Lend_1
s_branch Lps_461
Lpf_464:
buffer_load_dwordx4 v[36:39], v8, s[4:7], s40 offen offset:2048 sc1
v_mfma_f32_16x16x32_bf16 v[16:19], v[20:23], v[20:23], 0
Lps_487:
s_waitcnt vmcnt(2)
v_max3_u32 v26, v40, v41, v42
v_max_u32 v26, v26, v43
v_cmp_eq_u32 vcc, -1, v26
s_cbranch_vccnz Lpf_488
v_smfmac_f32_16x16x64_bf16 v[44:47], v[40:43], a[96:103], v126
v_smfmac_f32_16x16x64_bf16 v[48:51], v[40:43], a[104:111], v126
v_smfmac_f32_16x16x64_bf16 v[52:55], v[40:43], a[112:119], v126
v_smfmac_f32_16x16x64_bf16 v[56:59], v[40:43], a[120:127], v126
v_smfmac_f32_16x16x64_bf16 v[60:63], v[40:43], v[224:231], v126
v_smfmac_f32_16x16x64_bf16 v[64:67], v[40:43], v[232:239], v126
Lps_489:
s_waitcnt vmcnt(1)
v_max3_u32 v26, v32, v33, v34
v_max_u32 v26, v26, v35
v_cmp_eq_u32 vcc, -1, v26
s_cbranch_vccnz Lpf_490
v_smfmac_f32_16x16x64_bf16 v[44:47], v[32:35], a[32:39], v126
v_smfmac_f32_16x16x64_bf16 v[48:51], v[32:35], a[40:47], v126
v_smfmac_f32_16x16x64_bf16 v[52:55], v[32:35], a[48:55], v126
v_smfmac_f32_16x16x64_bf16 v[56:59], v[32:35], a[56:63], v126
v_smfmac_f32_16x16x64_bf16 v[60:63], v[32:35], v[160:167], v126
v_smfmac_f32_16x16x64_bf16 v[64:67], v[32:35], v[168:175], v126
s_branch Lps_471
Lpf_466:
buffer_load_dwordx4 v[40:43], v8, s[4:7], s40 offen offset:3072 sc1
v_mfma_f32_16x16x32_bf16 v[16:19], v[20:23], v[20:23], 0
Lps_491:
s_waitcnt vmcnt(1)
v_max3_u32 v26, v32, v33, v34
v_max_u32 v26, v26, v35
v_cmp_eq_u32 vcc, -1, v26
s_cbranch_vccnz Lpf_492
v_smfmac_f32_16x16x64_bf16 v[44:47], v[32:35], a[32:39], v126
v_smfmac_f32_16x16x64_bf16 v[48:51], v[32:35], a[40:47], v126
v_smfmac_f32_16x16x64_bf16 v[52:55], v[32:35], a[48:55], v126
v_smfmac_f32_16x16x64_bf16 v[56:59], v[32:35], a[56:63], v126
v_smfmac_f32_16x16x64_bf16 v[60:63], v[32:35], v[160:167], v126
v_smfmac_f32_16x16x64_bf16 v[64:67], v[32:35], v[168:175], v126
s_branch Lps_473
Lpf_468:
buffer_load_dwordx4 v[32:35], v8, s[4:7], s40 offen offset:1024 sc1
v_mfma_f32_16x16x32_bf16 v[16:19], v[20:23], v[20:23], 0
s_sub_u32 s37, s37, 1
s_cbranch_scc1 Lend_1
s_branch Lps_467
Lpf_470:
buffer_load_dwordx4 v[40:43], v8, s[4:7], s40 offen offset:3072 sc1
v_mfma_f32_16x16x32_bf16 v[16:19], v[20:23], v[20:23], 0
Lps_493:
s_waitcnt vmcnt(1)
v_max3_u32 v26, v36, v37, v38
v_max_u32 v26, v26, v39
v_cmp_eq_u32 vcc, -1, v26
s_cbranch_vccnz Lpf_494
v_smfmac_f32_16x16x64_bf16 v[44:47], v[36:39], a[64:71], v126
v_smfmac_f32_16x16x64_bf16 v[48:51], v[36:39], a[72:79], v126
v_smfmac_f32_16x16x64_bf16 v[52:55], v[36:39], a[80:87], v126
v_smfmac_f32_16x16x64_bf16 v[56:59], v[36:39], a[88:95], v126
v_smfmac_f32_16x16x64_bf16 v[60:63], v[36:39], v[192:199], v126
v_smfmac_f32_16x16x64_bf16 v[64:67], v[36:39], v[200:207], v126
s_branch Lps_473
Lpf_472:
buffer_load_dwordx4 v[36:39], v8, s[4:7], s40 offen offset:2048 sc1
v_mfma_f32_16x16x32_bf16 v[16:19], v[20:23], v[20:23], 0
s_sub_u32 s37, s37, 1
s_cbranch_scc1 Lend_1
s_branch Lps_471
Lpf_474:
buffer_load_dwordx4 v[40:43], v8, s[4:7], s40 offen offset:3072 sc1
v_mfma_f32_16x16x32_bf16 v[16:19], v[20:23], v[20:23], 0
s_sub_u32 s37, s37, 1
s_cbranch_scc1 Lend_1
s_branch Lps_473
Lpf_476:
buffer_load_dwordx4 v[36:39], v8, s[4:7], s40 offen offset:2048 sc1
v_mfma_f32_16x16x32_bf16 v[16:19], v[20:23], v[20:23], 0
Lps_495:
s_waitcnt vmcnt(3)
v_max3_u32 v26, v40, v41, v42
v_max_u32 v26, v26, v43
v_cmp_eq_u32 vcc, -1, v26
s_cbranch_vccnz Lpf_496
v_smfmac_f32_16x16x64_bf16 v[44:47], v[40:43], a[96:103], v126
v_smfmac_f32_16x16x64_bf16 v[48:51], v[40:43], a[104:111], v126
v_smfmac_f32_16x16x64_bf16 v[52:55], v[40:43], a[112:119], v126
v_smfmac_f32_16x16x64_bf16 v[56:59], v[40:43], a[120:127], v126
v_smfmac_f32_16x16x64_bf16 v[60:63], v[40:43], v[224:231], v126
v_smfmac_f32_16x16x64_bf16 v[64:67], v[40:43], v[232:239], v126
Lps_497:
s_waitcnt vmcnt(2)
v_max3_u32 v26, v28, v29, v30
v_max_u32 v26, v26, v31
v_cmp_eq_u32 vcc, -1, v26
s_cbranch_vccnz Lpf_498
v_smfmac_f32_16x16x64_bf16 v[44:47], v[28:31], a[0:7], v126
v_smfmac_f32_16x16x64_bf16 v[48:51], v[28:31], a[8:15], v126
v_smfmac_f32_16x16x64_bf16 v[52:55], v[28:31], a[16:23], v126
v_smfmac_f32_16x16x64_bf16 v[56:59], v[28:31], a[24:31], v126
v_smfmac_f32_16x16x64_bf16 v[60:63], v[28:31], v[128:135], v126
v_smfmac_f32_16x16x64_bf16 v[64:67], v[28:31], v[136:143], v126
s_branch Lps_489
Lpf_478:
buffer_load_dwordx4 v[40:43], v8, s[4:7], s40 offen offset:3072 sc1
v_mfma_f32_16x16x32_bf16 v[16:19], v[20:23], v[20:23], 0
Lps_499:
s_waitcnt vmcnt(2)
v_max3_u32 v26, v28, v29, v30
v_max_u32 v26, v26, v31
v_cmp_eq_u32 vcc, -1, v26
s_cbranch_vccnz Lpf_500
v_smfmac_f32_16x16x64_bf16 v[44:47], v[28:31], a[0:7], v126
v_smfmac_f32_16x16x64_bf16 v[48:51], v[28:31], a[8:15], v126
v_smfmac_f32_16x16x64_bf16 v[52:55], v[28:31], a[16:23], v126
v_smfmac_f32_16x16x64_bf16 v[56:59], v[28:31], a[24:31], v126
v_smfmac_f32_16x16x64_bf16 v[60:63], v[28:31], v[128:135], v126
v_smfmac_f32_16x16x64_bf16 v[64:67], v[28:31], v[136:143], v126
s_branch Lps_491
Lpf_480:
buffer_load_dwordx4 v[28:31], v8, s[4:7], s40 offen offset:0 sc1
v_mfma_f32_16x16x32_bf16 v[16:19], v[20:23], v[20:23], 0
s_sub_u32 s37, s37, 1
s_cbranch_scc1 Lend_1
Lps_501:
s_waitcnt vmcnt(1)
v_max3_u32 v26, v32, v33, v34
v_max_u32 v26, v26, v35
v_cmp_eq_u32 vcc, -1, v26
s_cbranch_vccnz Lpf_502
v_smfmac_f32_16x16x64_bf16 v[44:47], v[32:35], a[32:39], v126
v_smfmac_f32_16x16x64_bf16 v[48:51], v[32:35], a[40:47], v126
v_smfmac_f32_16x16x64_bf16 v[52:55], v[32:35], a[48:55], v126
v_smfmac_f32_16x16x64_bf16 v[56:59], v[32:35], a[56:63], v126
v_smfmac_f32_16x16x64_bf16 v[60:63], v[32:35], v[160:167], v126
v_smfmac_f32_16x16x64_bf16 v[64:67], v[32:35], v[168:175], v126
s_branch Lps_461
Lpf_482:
buffer_load_dwordx4 v[40:43], v8, s[4:7], s40 offen offset:3072 sc1
v_mfma_f32_16x16x32_bf16 v[16:19], v[20:23], v[20:23], 0
Lps_503:
s_waitcnt vmcnt(2)
v_max3_u32 v26, v28, v29, v30
v_max_u32 v26, v26, v31
v_cmp_eq_u32 vcc, -1, v26
s_cbranch_vccnz Lpf_504
v_smfmac_f32_16x16x64_bf16 v[44:47], v[28:31], a[0:7], v126
v_smfmac_f32_16x16x64_bf16 v[48:51], v[28:31], a[8:15], v126
v_smfmac_f32_16x16x64_bf16 v[52:55], v[28:31], a[16:23], v126
v_smfmac_f32_16x16x64_bf16 v[56:59], v[28:31], a[24:31], v126
v_smfmac_f32_16x16x64_bf16 v[60:63], v[28:31], v[128:135], v126
v_smfmac_f32_16x16x64_bf16 v[64:67], v[28:31], v[136:143], v126
s_branch Lps_493
Lpf_484:
buffer_load_dwordx4 v[28:31], v8, s[4:7], s40 offen offset:0 sc1
v_mfma_f32_16x16x32_bf16 v[16:19], v[20:23], v[20:23], 0
s_sub_u32 s37, s37, 1
s_cbranch_scc1 Lend_1
Lps_505:
s_waitcnt vmcnt(1)
v_max3_u32 v26, v36, v37, v38
v_max_u32 v26, v26, v39
v_cmp_eq_u32 vcc, -1, v26
s_cbranch_vccnz Lpf_506
v_smfmac_f32_16x16x64_bf16 v[44:47], v[36:39], a[64:71], v126
v_smfmac_f32_16x16x64_bf16 v[48:51], v[36:39], a[72:79], v126
v_smfmac_f32_16x16x64_bf16 v[52:55], v[36:39], a[80:87], v126
v_smfmac_f32_16x16x64_bf16 v[56:59], v[36:39], a[88:95], v126
v_smfmac_f32_16x16x64_bf16 v[60:63], v[36:39], v[192:199], v126
v_smfmac_f32_16x16x64_bf16 v[64:67], v[36:39], v[200:207], v126
s_branch Lps_461
Lpf_486:
buffer_load_dwordx4 v[28:31], v8, s[4:7], s40 offen offset:0 sc1
v_mfma_f32_16x16x32_bf16 v[16:19], v[20:23], v[20:23], 0
s_sub_u32 s37, s37, 1
s_cbranch_scc1 Lend_1
s_branch Lps_459
Lpf_488:
buffer_load_dwordx4 v[40:43], v8, s[4:7], s40 offen offset:3072 sc1
v_mfma_f32_16x16x32_bf16 v[16:19], v[20:23], v[20:23], 0
Lps_507:
s_waitcnt vmcnt(2)
v_max3_u32 v26, v32, v33, v34
v_max_u32 v26, v26, v35
v_cmp_eq_u32 vcc, -1, v26
s_cbranch_vccnz Lpf_508
v_smfmac_f32_16x16x64_bf16 v[44:47], v[32:35], a[32:39], v126
v_smfmac_f32_16x16x64_bf16 v[48:51], v[32:35], a[40:47], v126
v_smfmac_f32_16x16x64_bf16 v[52:55], v[32:35], a[48:55], v126
v_smfmac_f32_16x16x64_bf16 v[56:59], v[32:35], a[56:63], v126
v_smfmac_f32_16x16x64_bf16 v[60:63], v[32:35], v[160:167], v126
v_smfmac_f32_16x16x64_bf16 v[64:67], v[32:35], v[168:175], v126
s_branch Lps_493
Lpf_490:
buffer_load_dwordx4 v[32:35], v8, s[4:7], s40 offen offset:1024 sc1
v_mfma_f32_16x16x32_bf16 v[16:19], v[20:23], v[20:23], 0
s_sub_u32 s37, s37, 1
s_cbranch_scc1 Lend_1
Lps_509:
s_waitcnt vmcnt(1)
v_max3_u32 v26, v36, v37, v38
v_max_u32 v26, v26, v39
v_cmp_eq_u32 vcc, -1, v26
s_cbranch_vccnz Lpf_510
v_smfmac_f32_16x16x64_bf16 v[44:47], v[36:39], a[64:71], v126
v_smfmac_f32_16x16x64_bf16 v[48:51], v[36:39], a[72:79], v126
v_smfmac_f32_16x16x64_bf16 v[52:55], v[36:39], a[80:87], v126
v_smfmac_f32_16x16x64_bf16 v[56:59], v[36:39], a[88:95], v126
v_smfmac_f32_16x16x64_bf16 v[60:63], v[36:39], v[192:199], v126
v_smfmac_f32_16x16x64_bf16 v[64:67], v[36:39], v[200:207], v126
s_branch Lps_467
Lpf_492:
buffer_load_dwordx4 v[32:35], v8, s[4:7], s40 offen offset:1024 sc1
v_mfma_f32_16x16x32_bf16 v[16:19], v[20:23], v[20:23], 0
s_sub_u32 s37, s37, 1
s_cbranch_scc1 Lend_1
s_branch Lps_465
Lpf_494:
buffer_load_dwordx4 v[36:39], v8, s[4:7], s40 offen offset:2048 sc1
v_mfma_f32_16x16x32_bf16 v[16:19], v[20:23], v[20:23], 0
s_sub_u32 s37, s37, 1
s_cbranch_scc1 Lend_1
s_branch Lps_469
Lpf_496:
buffer_load_dwordx4 v[40:43], v8, s[4:7], s40 offen offset:3072 sc1
v_mfma_f32_16x16x32_bf16 v[16:19], v[20:23], v[20:23], 0
Lps_511:
s_waitcnt vmcnt(3)
v_max3_u32 v26, v28, v29, v30
v_max_u32 v26, v26, v31
v_cmp_eq_u32 vcc, -1, v26
s_cbranch_vccnz Lpf_512
v_smfmac_f32_16x16x64_bf16 v[44:47], v[28:31], a[0:7], v126
v_smfmac_f32_16x16x64_bf16 v[48:51], v[28:31], a[8:15], v126
v_smfmac_f32_16x16x64_bf16 v[52:55], v[28:31], a[16:23], v126
v_smfmac_f32_16x16x64_bf16 v[56:59], v[28:31], a[24:31], v126
v_smfmac_f32_16x16x64_bf16 v[60:63], v[28:31], v[128:135], v126
v_smfmac_f32_16x16x64_bf16 v[64:67], v[28:31], v[136:143], v126
s_branch Lps_507
Lpf_498:
buffer_load_dwordx4 v[28:31], v8, s[4:7], s40 offen offset:0 sc1
v_mfma_f32_16x16x32_bf16 v[16:19], v[20:23], v[20:23], 0
s_sub_u32 s37, s37, 1
s_cbranch_scc1 Lend_1
Lps_513:
s_waitcnt vmcnt(2)
v_max3_u32 v26, v32, v33, v34
v_max_u32 v26, v26, v35
v_cmp_eq_u32 vcc, -1, v26
s_cbranch_vccnz Lpf_514
v_smfmac_f32_16x16x64_bf16 v[44:47], v[32:35], a[32:39], v126
v_smfmac_f32_16x16x64_bf16 v[48:51], v[32:35], a[40:47], v126
v_smfmac_f32_16x16x64_bf16 v[52:55], v[32:35], a[48:55], v126
v_smfmac_f32_16x16x64_bf16 v[56:59], v[32:35], a[56:63], v126
v_smfmac_f32_16x16x64_bf16 v[60:63], v[32:35], v[160:167], v126
v_smfmac_f32_16x16x64_bf16 v[64:67], v[32:35], v[168:175], v126
s_branch Lps_505
Lpf_500:
buffer_load_dwordx4 v[28:31], v8, s[4:7], s40 offen offset:0 sc1
v_mfma_f32_16x16x32_bf16 v[16:19], v[20:23], v[20:23], 0
s_sub_u32 s37, s37, 1
s_cbranch_scc1 Lend_1
Lps_515:
s_waitcnt vmcnt(2)
v_max3_u32 v26, v32, v33, v34
v_max_u32 v26, v26, v35
v_cmp_eq_u32 vcc, -1, v26
s_cbranch_vccnz Lpf_516
v_smfmac_f32_16x16x64_bf16 v[44:47], v[32:35], a[32:39], v126
v_smfmac_f32_16x16x64_bf16 v[48:51], v[32:35], a[40:47], v126
v_smfmac_f32_16x16x64_bf16 v[52:55], v[32:35], a[48:55], v126
v_smfmac_f32_16x16x64_bf16 v[56:59], v[32:35], a[56:63], v126
v_smfmac_f32_16x16x64_bf16 v[60:63], v[32:35], v[160:167], v126
v_smfmac_f32_16x16x64_bf16 v[64:67], v[32:35], v[168:175], v126
s_branch Lps_459
Lpf_502:
buffer_load_dwordx4 v[32:35], v8, s[4:7], s40 offen offset:1024 sc1
v_mfma_f32_16x16x32_bf16 v[16:19], v[20:23], v[20:23], 0
s_branch Lps_479
Lpf_504:
buffer_load_dwordx4 v[28:31], v8, s[4:7], s40 offen offset:0 sc1
v_mfma_f32_16x16x32_bf16 v[16:19], v[20:23], v[20:23], 0
s_sub_u32 s37, s37, 1
s_cbranch_scc1 Lend_1
s_branch Lps_457
Lpf_506:
buffer_load_dwordx4 v[36:39], v8, s[4:7], s40 offen offset:2048 sc1
v_mfma_f32_16x16x32_bf16 v[16:19], v[20:23], v[20:23], 0
s_branch Lps_483
Lpf_508:
buffer_load_dwordx4 v[32:35], v8, s[4:7], s40 offen offset:1024 sc1
v_mfma_f32_16x16x32_bf16 v[16:19], v[20:23], v[20:23], 0
s_sub_u32 s37, s37, 1
s_cbranch_scc1 Lend_1
s_branch Lps_463
Lpf_510:
buffer_load_dwordx4 v[36:39], v8, s[4:7], s40 offen offset:2048 sc1
v_mfma_f32_16x16x32_bf16 v[16:19], v[20:23], v[20:23], 0
s_branch Lps_489
Lpf_512:
buffer_load_dwordx4 v[28:31], v8, s[4:7], s40 offen offset:0 sc1
v_mfma_f32_16x16x32_bf16 v[16:19], v[20:23], v[20:23], 0
s_sub_u32 s37, s37, 1
s_cbranch_scc1 Lend_1
s_branch Lps_455
Lpf_514:
buffer_load_dwordx4 v[32:35], v8, s[4:7], s40 offen offset:1024 sc1
v_mfma_f32_16x16x32_bf16 v[16:19], v[20:23], v[20:23], 0
Lps_517:
s_waitcnt vmcnt(2)
v_max3_u32 v26, v36, v37, v38
v_max_u32 v26, v26, v39
v_cmp_eq_u32 vcc, -1, v26
s_cbranch_vccnz Lpf_518
v_smfmac_f32_16x16x64_bf16 v[44:47], v[36:39], a[64:71], v126
v_smfmac_f32_16x16x64_bf16 v[48:51], v[36:39], a[72:79], v126
v_smfmac_f32_16x16x64_bf16 v[52:55], v[36:39], a[80:87], v126
v_smfmac_f32_16x16x64_bf16 v[56:59], v[36:39], a[88:95], v126
v_smfmac_f32_16x16x64_bf16 v[60:63], v[36:39], v[192:199], v126
v_smfmac_f32_16x16x64_bf16 v[64:67], v[36:39], v[200:207], v126
s_branch Lps_479
Lpf_516:
buffer_load_dwordx4 v[32:35], v8, s[4:7], s40 offen offset:1024 sc1
v_mfma_f32_16x16x32_bf16 v[16:19], v[20:23], v[20:23], 0
s_branch Lps_477
Lpf_518:
buffer_load_dwordx4 v[36:39], v8, s[4:7], s40 offen offset:2048 sc1
v_mfma_f32_16x16x32_bf16 v[16:19], v[20:23], v[20:23], 0
s_branch Lps_497
Lpf_448:
buffer_load_dwordx4 v[28:31], v9, s[4:7], s40 offen offset:0 sc1
v_mfma_f32_16x16x32_bf16 v[16:19], v[20:23], v[20:23], 0
s_sub_u32 s37, s37, 1
s_cbranch_scc1 Lend_1
Lps_519:
s_waitcnt vmcnt(3)
v_max3_u32 v26, v32, v33, v34
v_max_u32 v26, v26, v35
v_cmp_eq_u32 vcc, -1, v26
s_cbranch_vccnz Lpf_520
v_smfmac_f32_16x16x64_bf16 v[76:79], v[32:35], a[160:167], v126
v_smfmac_f32_16x16x64_bf16 v[80:83], v[32:35], a[168:175], v126
v_smfmac_f32_16x16x64_bf16 v[84:87], v[32:35], a[176:183], v126
v_smfmac_f32_16x16x64_bf16 v[88:91], v[32:35], a[184:191], v126
Lps_521:
s_waitcnt vmcnt(2)
v_max3_u32 v26, v36, v37, v38
v_max_u32 v26, v26, v39
v_cmp_eq_u32 vcc, -1, v26
s_cbranch_vccnz Lpf_522
v_smfmac_f32_16x16x64_bf16 v[76:79], v[36:39], a[192:199], v126
v_smfmac_f32_16x16x64_bf16 v[80:83], v[36:39], a[200:207], v126
v_smfmac_f32_16x16x64_bf16 v[84:87], v[36:39], a[208:215], v126
v_smfmac_f32_16x16x64_bf16 v[88:91], v[36:39], a[216:223], v126
Lps_523:
s_waitcnt vmcnt(1)
v_max3_u32 v26, v40, v41, v42
v_max_u32 v26, v26, v43
v_cmp_eq_u32 vcc, -1, v26
s_cbranch_vccnz Lpf_524
v_smfmac_f32_16x16x64_bf16 v[76:79], v[40:43], a[224:231], v126
v_smfmac_f32_16x16x64_bf16 v[80:83], v[40:43], a[232:239], v126
v_smfmac_f32_16x16x64_bf16 v[84:87], v[40:43], a[240:247], v126
v_smfmac_f32_16x16x64_bf16 v[88:91], v[40:43], a[248:255], v126
Lps_525:
s_waitcnt vmcnt(0)
v_max3_u32 v26, v28, v29, v30
v_max_u32 v26, v26, v31
v_cmp_eq_u32 vcc, -1, v26
s_cbranch_vccnz Lpf_526
v_smfmac_f32_16x16x64_bf16 v[76:79], v[28:31], a[128:135], v126
v_smfmac_f32_16x16x64_bf16 v[80:83], v[28:31], a[136:143], v126
v_smfmac_f32_16x16x64_bf16 v[84:87], v[28:31], a[144:151], v126
v_smfmac_f32_16x16x64_bf16 v[88:91], v[28:31], a[152:159], v126
s_branch Lpd_447
Lpf_449:
buffer_load_dwordx4 v[32:35], v9, s[4:7], s40 offen offset:1024 sc1
v_mfma_f32_16x16x32_bf16 v[16:19], v[20:23], v[20:23], 0
s_sub_u32 s37, s37, 1
s_cbranch_scc1 Lend_1
Lps_527:
s_waitcnt vmcnt(2)
v_max3_u32 v26, v36, v37, v38
v_max_u32 v26, v26, v39
v_cmp_eq_u32 vcc, -1, v26
s_cbranch_vccnz Lpf_528
v_smfmac_f32_16x16x64_bf16 v[76:79], v[36:39], a[192:199], v126
v_smfmac_f32_16x16x64_bf16 v[80:83], v[36:39], a[200:207], v126
v_smfmac_f32_16x16x64_bf16 v[84:87], v[36:39], a[208:215], v126
v_smfmac_f32_16x16x64_bf16 v[88:91], v[36:39], a[216:223], v126
Lps_529:
s_waitcnt vmcnt(1)
v_max3_u32 v26, v40, v41, v42
v_max_u32 v26, v26, v43
v_cmp_eq_u32 vcc, -1, v26
s_cbranch_vccnz Lpf_530
v_smfmac_f32_16x16x64_bf16 v[76:79], v[40:43], a[224:231], v126
v_smfmac_f32_16x16x64_bf16 v[80:83], v[40:43], a[232:239], v126
v_smfmac_f32_16x16x64_bf16 v[84:87], v[40:43], a[240:247], v126
v_smfmac_f32_16x16x64_bf16 v[88:91], v[40:43], a[248:255], v126
Lps_531:
s_waitcnt vmcnt(0)
v_max3_u32 v26, v32, v33, v34
v_max_u32 v26, v26, v35
v_cmp_eq_u32 vcc, -1, v26
s_cbranch_vccnz Lpf_532
v_smfmac_f32_16x16x64_bf16 v[76:79], v[32:35], a[160:167], v126
v_smfmac_f32_16x16x64_bf16 v[80:83], v[32:35], a[168:175], v126
v_smfmac_f32_16x16x64_bf16 v[84:87], v[32:35], a[176:183], v126
v_smfmac_f32_16x16x64_bf16 v[88:91], v[32:35], a[184:191], v126
s_branch Lpd_447
Lpf_450:
buffer_load_dwordx4 v[36:39], v9, s[4:7], s40 offen offset:2048 sc1
v_mfma_f32_16x16x32_bf16 v[16:19], v[20:23], v[20:23], 0
s_sub_u32 s37, s37, 1
s_cbranch_scc1 Lend_1
Lps_533:
s_waitcnt vmcnt(1)
v_max3_u32 v26, v40, v41, v42
v_max_u32 v26, v26, v43
v_cmp_eq_u32 vcc, -1, v26
s_cbranch_vccnz Lpf_534
v_smfmac_f32_16x16x64_bf16 v[76:79], v[40:43], a[224:231], v126
v_smfmac_f32_16x16x64_bf16 v[80:83], v[40:43], a[232:239], v126
v_smfmac_f32_16x16x64_bf16 v[84:87], v[40:43], a[240:247], v126
v_smfmac_f32_16x16x64_bf16 v[88:91], v[40:43], a[248:255], v126
Lps_535:
s_waitcnt vmcnt(0)
v_max3_u32 v26, v36, v37, v38
v_max_u32 v26, v26, v39
v_cmp_eq_u32 vcc, -1, v26
s_cbranch_vccnz Lpf_536
v_smfmac_f32_16x16x64_bf16 v[76:79], v[36:39], a[192:199], v126
v_smfmac_f32_16x16x64_bf16 v[80:83], v[36:39], a[200:207], v126
v_smfmac_f32_16x16x64_bf16 v[84:87], v[36:39], a[208:215], v126
v_smfmac_f32_16x16x64_bf16 v[88:91], v[36:39], a[216:223], v126
s_branch Lpd_447
Lpf_451:
buffer_load_dwordx4 v[40:43], v9, s[4:7], s40 offen offset:3072 sc1
v_mfma_f32_16x16x32_bf16 v[16:19], v[20:23], v[20:23], 0
s_sub_u32 s37, s37, 1
s_cbranch_scc1 Lend_1
Lps_537:
s_waitcnt vmcnt(0)
v_max3_u32 v26, v40, v41, v42
v_max_u32 v26, v26, v43
v_cmp_eq_u32 vcc, -1, v26
s_cbranch_vccnz Lpf_538
v_smfmac_f32_16x16x64_bf16 v[76:79], v[40:43], a[224:231], v126
v_smfmac_f32_16x16x64_bf16 v[80:83], v[40:43], a[232:239], v126
v_smfmac_f32_16x16x64_bf16 v[84:87], v[40:43], a[240:247], v126
v_smfmac_f32_16x16x64_bf16 v[88:91], v[40:43], a[248:255], v126
s_branch Lpd_447
Lpf_520:
buffer_load_dwordx4 v[32:35], v9, s[4:7], s40 offen offset:1024 sc1
v_mfma_f32_16x16x32_bf16 v[16:19], v[20:23], v[20:23], 0
Lps_539:
s_waitcnt vmcnt(3)
v_max3_u32 v26, v36, v37, v38
v_max_u32 v26, v26, v39
v_cmp_eq_u32 vcc, -1, v26
s_cbranch_vccnz Lpf_540
v_smfmac_f32_16x16x64_bf16 v[76:79], v[36:39], a[192:199], v126
v_smfmac_f32_16x16x64_bf16 v[80:83], v[36:39], a[200:207], v126
v_smfmac_f32_16x16x64_bf16 v[84:87], v[36:39], a[208:215], v126
v_smfmac_f32_16x16x64_bf16 v[88:91], v[36:39], a[216:223], v126
Lps_541:
s_waitcnt vmcnt(2)
v_max3_u32 v26, v40, v41, v42
v_max_u32 v26, v26, v43
v_cmp_eq_u32 vcc, -1, v26
s_cbranch_vccnz Lpf_542
v_smfmac_f32_16x16x64_bf16 v[76:79], v[40:43], a[224:231], v126
v_smfmac_f32_16x16x64_bf16 v[80:83], v[40:43], a[232:239], v126
v_smfmac_f32_16x16x64_bf16 v[84:87], v[40:43], a[240:247], v126
v_smfmac_f32_16x16x64_bf16 v[88:91], v[40:43], a[248:255], v126
Lps_543:
s_waitcnt vmcnt(1)
v_max3_u32 v26, v28, v29, v30
v_max_u32 v26, v26, v31
v_cmp_eq_u32 vcc, -1, v26
s_cbranch_vccnz Lpf_544
v_smfmac_f32_16x16x64_bf16 v[76:79], v[28:31], a[128:135], v126
v_smfmac_f32_16x16x64_bf16 v[80:83], v[28:31], a[136:143], v126
v_smfmac_f32_16x16x64_bf16 v[84:87], v[28:31], a[144:151], v126
v_smfmac_f32_16x16x64_bf16 v[88:91], v[28:31], a[152:159], v126
s_branch Lps_531
Lpf_522:
buffer_load_dwordx4 v[36:39], v9, s[4:7], s40 offen offset:2048 sc1
v_mfma_f32_16x16x32_bf16 v[16:19], v[20:23], v[20:23], 0
Lps_545:
s_waitcnt vmcnt(2)
v_max3_u32 v26, v40, v41, v42
v_max_u32 v26, v26, v43
v_cmp_eq_u32 vcc, -1, v26
s_cbranch_vccnz Lpf_546
v_smfmac_f32_16x16x64_bf16 v[76:79], v[40:43], a[224:231], v126
v_smfmac_f32_16x16x64_bf16 v[80:83], v[40:43], a[232:239], v126
v_smfmac_f32_16x16x64_bf16 v[84:87], v[40:43], a[240:247], v126
v_smfmac_f32_16x16x64_bf16 v[88:91], v[40:43], a[248:255], v126
Lps_547:
s_waitcnt vmcnt(1)
v_max3_u32 v26, v28, v29, v30
v_max_u32 v26, v26, v31
v_cmp_eq_u32 vcc, -1, v26
s_cbranch_vccnz Lpf_548
v_smfmac_f32_16x16x64_bf16 v[76:79], v[28:31], a[128:135], v126
v_smfmac_f32_16x16x64_bf16 v[80:83], v[28:31], a[136:143], v126
v_smfmac_f32_16x16x64_bf16 v[84:87], v[28:31], a[144:151], v126
v_smfmac_f32_16x16x64_bf16 v[88:91], v[28:31], a[152:159], v126
s_branch Lps_535
Lpf_524:
buffer_load_dwordx4 v[40:43], v9, s[4:7], s40 offen offset:3072 sc1
v_mfma_f32_16x16x32_bf16 v[16:19], v[20:23], v[20:23], 0
Lps_549:
s_waitcnt vmcnt(1)
v_max3_u32 v26, v28, v29, v30
v_max_u32 v26, v26, v31
v_cmp_eq_u32 vcc, -1, v26
s_cbranch_vccnz Lpf_550
v_smfmac_f32_16x16x64_bf16 v[76:79], v[28:31], a[128:135], v126
v_smfmac_f32_16x16x64_bf16 v[80:83], v[28:31], a[136:143], v126
v_smfmac_f32_16x16x64_bf16 v[84:87], v[28:31], a[144:151], v126
v_smfmac_f32_16x16x64_bf16 v[88:91], v[28:31], a[152:159], v126
s_branch Lps_537
Lpf_526:
buffer_load_dwordx4 v[28:31], v9, s[4:7], s40 offen offset:0 sc1
v_mfma_f32_16x16x32_bf16 v[16:19], v[20:23], v[20:23], 0
s_sub_u32 s37, s37, 1
s_cbranch_scc1 Lend_1
s_branch Lps_525
Lpf_528:
buffer_load_dwordx4 v[36:39], v9, s[4:7], s40 offen offset:2048 sc1
v_mfma_f32_16x16x32_bf16 v[16:19], v[20:23], v[20:23], 0
Lps_551:
s_waitcnt vmcnt(2)
v_max3_u32 v26, v40, v41, v42
v_max_u32 v26, v26, v43
v_cmp_eq_u32 vcc, -1, v26
s_cbranch_vccnz Lpf_552
v_smfmac_f32_16x16x64_bf16 v[76:79], v[40:43], a[224:231], v126
v_smfmac_f32_16x16x64_bf16 v[80:83], v[40:43], a[232:239], v126
v_smfmac_f32_16x16x64_bf16 v[84:87], v[40:43], a[240:247], v126
v_smfmac_f32_16x16x64_bf16 v[88:91], v[40:43], a[248:255], v126
Lps_553:
s_waitcnt vmcnt(1)
v_max3_u32 v26, v32, v33, v34
v_max_u32 v26, v26, v35
v_cmp_eq_u32 vcc, -1, v26
s_cbranch_vccnz Lpf_554
v_smfmac_f32_16x16x64_bf16 v[76:79], v[32:35], a[160:167], v126
v_smfmac_f32_16x16x64_bf16 v[80:83], v[32:35], a[168:175], v126
v_smfmac_f32_16x16x64_bf16 v[84:87], v[32:35], a[176:183], v126
v_smfmac_f32_16x16x64_bf16 v[88:91], v[32:35], a[184:191], v126
s_branch Lps_535
Lpf_530:
buffer_load_dwordx4 v[40:43], v9, s[4:7], s40 offen offset:3072 sc1
v_mfma_f32_16x16x32_bf16 v[16:19], v[20:23], v[20:23], 0
Lps_555:
s_waitcnt vmcnt(1)
v_max3_u32 v26, v32, v33, v34
v_max_u32 v26, v26, v35
v_cmp_eq_u32 vcc, -1, v26
s_cbranch_vccnz Lpf_556
v_smfmac_f32_16x16x64_bf16 v[76:79], v[32:35], a[160:167], v126
v_smfmac_f32_16x16x64_bf16 v[80:83], v[32:35], a[168:175], v126
v_smfmac_f32_16x16x64_bf16 v[84:87], v[32:35], a[176:183], v126
v_smfmac_f32_16x16x64_bf16 v[88:91], v[32:35], a[184:191], v126
s_branch Lps_537
Lpf_532:
buffer_load_dwordx4 v[32:35], v9, s[4:7], s40 offen offset:1024 sc1
v_mfma_f32_16x16x32_bf16 v[16:19], v[20:23], v[20:23], 0
s_sub_u32 s37, s37, 1
s_cbranch_scc1 Lend_1
s_branch Lps_531
Lpf_534:
buffer_load_dwordx4 v[40:43], v9, s[4:7], s40 offen offset:3072 sc1
v_mfma_f32_16x16x32_bf16 v[16:19], v[20:23], v[20:23], 0
Lps_557:
s_waitcnt vmcnt(1)
v_max3_u32 v26, v36, v37, v38
v_max_u32 v26, v26, v39
v_cmp_eq_u32 vcc, -1, v26
s_cbranch_vccnz Lpf_558
v_smfmac_f32_16x16x64_bf16 v[76:79], v[36:39], a[192:199], v126
v_smfmac_f32_16x16x64_bf16 v[80:83], v[36:39], a[200:207], v126
v_smfmac_f32_16x16x64_bf16 v[84:87], v[36:39], a[208:215], v126
v_smfmac_f32_16x16x64_bf16 v[88:91], v[36:39], a[216:223], v126
s_branch Lps_537
Lpf_536:
buffer_load_dwordx4 v[36:39], v9, s[4:7], s40 offen offset:2048 sc1
v_mfma_f32_16x16x32_bf16 v[16:19], v[20:23], v[20:23], 0
s_sub_u32 s37, s37, 1
s_cbranch_scc1 Lend_1
s_branch Lps_535
Lpf_538:
buffer_load_dwordx4 v[40:43], v9, s[4:7], s40 offen offset:3072 sc1
v_mfma_f32_16x16x32_bf16 v[16:19], v[20:23], v[20:23], 0
s_sub_u32 s37, s37, 1
s_cbranch_scc1 Lend_1
s_branch Lps_537
Lpf_540:
buffer_load_dwordx4 v[36:39], v9, s[4:7], s40 offen offset:2048 sc1
v_mfma_f32_16x16x32_bf16 v[16:19], v[20:23], v[20:23], 0
Lps_559:
s_waitcnt vmcnt(3)
v_max3_u32 v26, v40, v41, v42
v_max_u32 v26, v26, v43
v_cmp_eq_u32 vcc, -1, v26
s_cbranch_vccnz Lpf_560
v_smfmac_f32_16x16x64_bf16 v[76:79], v[40:43], a[224:231], v126
v_smfmac_f32_16x16x64_bf16 v[80:83], v[40:43], a[232:239], v126
v_smfmac_f32_16x16x64_bf16 v[84:87], v[40:43], a[240:247], v126
v_smfmac_f32_16x16x64_bf16 v[88:91], v[40:43], a[248:255], v126
Lps_561:
s_waitcnt vmcnt(2)
v_max3_u32 v26, v28, v29, v30
v_max_u32 v26, v26, v31
v_cmp_eq_u32 vcc, -1, v26
s_cbranch_vccnz Lpf_562
v_smfmac_f32_16x16x64_bf16 v[76:79], v[28:31], a[128:135], v126
v_smfmac_f32_16x16x64_bf16 v[80:83], v[28:31], a[136:143], v126
v_smfmac_f32_16x16x64_bf16 v[84:87], v[28:31], a[144:151], v126
v_smfmac_f32_16x16x64_bf16 v[88:91], v[28:31], a[152:159], v126
s_branch Lps_553
Lpf_542:
buffer_load_dwordx4 v[40:43], v9, s[4:7], s40 offen offset:3072 sc1
v_mfma_f32_16x16x32_bf16 v[16:19], v[20:23], v[20:23], 0
Lps_563:
s_waitcnt vmcnt(2)
v_max3_u32 v26, v28, v29, v30
v_max_u32 v26, v26, v31
v_cmp_eq_u32 vcc, -1, v26
s_cbranch_vccnz Lpf_564
v_smfmac_f32_16x16x64_bf16 v[76:79], v[28:31], a[128:135], v126
v_smfmac_f32_16x16x64_bf16 v[80:83], v[28:31], a[136:143], v126
v_smfmac_f32_16x16x64_bf16 v[84:87], v[28:31], a[144:151], v126
v_smfmac_f32_16x16x64_bf16 v[88:91], v[28:31], a[152:159], v126
s_branch Lps_555
Lpf_544:
buffer_load_dwordx4 v[28:31], v9, s[4:7], s40 offen offset:0 sc1
v_mfma_f32_16x16x32_bf16 v[16:19], v[20:23], v[20:23], 0
s_sub_u32 s37, s37, 1
s_cbranch_scc1 Lend_1
Lps_565:
s_waitcnt vmcnt(1)
v_max3_u32 v26, v32, v33, v34
v_max_u32 v26, v26, v35
v_cmp_eq_u32 vcc, -1, v26
s_cbranch_vccnz Lpf_566
v_smfmac_f32_16x16x64_bf16 v[76:79], v[32:35], a[160:167], v126
v_smfmac_f32_16x16x64_bf16 v[80:83], v[32:35], a[168:175], v126
v_smfmac_f32_16x16x64_bf16 v[84:87], v[32:35], a[176:183], v126
v_smfmac_f32_16x16x64_bf16 v[88:91], v[32:35], a[184:191], v126
s_branch Lps_525
Lpf_546:
buffer_load_dwordx4 v[40:43], v9, s[4:7], s40 offen offset:3072 sc1
v_mfma_f32_16x16x32_bf16 v[16:19], v[20:23], v[20:23], 0
Lps_567:
s_waitcnt vmcnt(2)
v_max3_u32 v26, v28, v29, v30
v_max_u32 v26, v26, v31
v_cmp_eq_u32 vcc, -1, v26
s_cbranch_vccnz Lpf_568
v_smfmac_f32_16x16x64_bf16 v[76:79], v[28:31], a[128:135], v126
v_smfmac_f32_16x16x64_bf16 v[80:83], v[28:31], a[136:143], v126
v_smfmac_f32_16x16x64_bf16 v[84:87], v[28:31], a[144:151], v126
v_smfmac_f32_16x16x64_bf16 v[88:91], v[28:31], a[152:159], v126
s_branch Lps_557
Lpf_548:
buffer_load_dwordx4 v[28:31], v9, s[4:7], s40 offen offset:0 sc1
v_mfma_f32_16x16x32_bf16 v[16:19], v[20:23], v[20:23], 0
s_sub_u32 s37, s37, 1
s_cbranch_scc1 Lend_1
Lps_569:
s_waitcnt vmcnt(1)
v_max3_u32 v26, v36, v37, v38
v_max_u32 v26, v26, v39
v_cmp_eq_u32 vcc, -1, v26
s_cbranch_vccnz Lpf_570
v_smfmac_f32_16x16x64_bf16 v[76:79], v[36:39], a[192:199], v126
v_smfmac_f32_16x16x64_bf16 v[80:83], v[36:39], a[200:207], v126
v_smfmac_f32_16x16x64_bf16 v[84:87], v[36:39], a[208:215], v126
v_smfmac_f32_16x16x64_bf16 v[88:91], v[36:39], a[216:223], v126
s_branch Lps_525
Lpf_550:
buffer_load_dwordx4 v[28:31], v9, s[4:7], s40 offen offset:0 sc1
v_mfma_f32_16x16x32_bf16 v[16:19], v[20:23], v[20:23], 0
s_sub_u32 s37, s37, 1
s_cbranch_scc1 Lend_1
s_branch Lps_523
Lpf_552:
buffer_load_dwordx4 v[40:43], v9, s[4:7], s40 offen offset:3072 sc1
v_mfma_f32_16x16x32_bf16 v[16:19], v[20:23], v[20:23], 0
Lps_571:
s_waitcnt vmcnt(2)
v_max3_u32 v26, v32, v33, v34
v_max_u32 v26, v26, v35
v_cmp_eq_u32 vcc, -1, v26
s_cbranch_vccnz Lpf_572
v_smfmac_f32_16x16x64_bf16 v[76:79], v[32:35], a[160:167], v126
v_smfmac_f32_16x16x64_bf16 v[80:83], v[32:35], a[168:175], v126
v_smfmac_f32_16x16x64_bf16 v[84:87], v[32:35], a[176:183], v126
v_smfmac_f32_16x16x64_bf16 v[88:91], v[32:35], a[184:191], v126
s_branch Lps_557
Lpf_554:
buffer_load_dwordx4 v[32:35], v9, s[4:7], s40 offen offset:1024 sc1
v_mfma_f32_16x16x32_bf16 v[16:19], v[20:23], v[20:23], 0
s_sub_u32 s37, s37, 1
s_cbranch_scc1 Lend_1
Lps_573:
s_waitcnt vmcnt(1)
v_max3_u32 v26, v36, v37, v38
v_max_u32 v26, v26, v39
v_cmp_eq_u32 vcc, -1, v26
s_cbranch_vccnz Lpf_574
v_smfmac_f32_16x16x64_bf16 v[76:79], v[36:39], a[192:199], v126
v_smfmac_f32_16x16x64_bf16 v[80:83], v[36:39], a[200:207], v126
v_smfmac_f32_16x16x64_bf16 v[84:87], v[36:39], a[208:215], v126
v_smfmac_f32_16x16x64_bf16 v[88:91], v[36:39], a[216:223], v126
s_branch Lps_531
Lpf_556:
buffer_load_dwordx4 v[32:35], v9, s[4:7], s40 offen offset:1024 sc1
v_mfma_f32_16x16x32_bf16 v[16:19], v[20:23], v[20:23], 0
s_sub_u32 s37, s37, 1
s_cbranch_scc1 Lend_1
s_branch Lps_529
Lpf_558:
buffer_load_dwordx4 v[36:39], v9, s[4:7], s40 offen offset:2048 sc1
v_mfma_f32_16x16x32_bf16 v[16:19], v[20:23], v[20:23], 0
s_sub_u32 s37, s37, 1
s_cbranch_scc1 Lend_1
s_branch Lps_533
Lpf_560:
buffer_load_dwordx4 v[40:43], v9, s[4:7], s40 offen offset:3072 sc1
v_mfma_f32_16x16x32_bf16 v[16:19], v[20:23], v[20:23], 0
Lps_575:
s_waitcnt vmcnt(3)
v_max3_u32 v26, v28, v29, v30
v_max_u32 v26, v26, v31
v_cmp_eq_u32 vcc, -1, v26
s_cbranch_vccnz Lpf_576
v_smfmac_f32_16x16x64_bf16 v[76:79], v[28:31], a[128:135], v126
v_smfmac_f32_16x16x64_bf16 v[80:83], v[28:31], a[136:143], v126
v_smfmac_f32_16x16x64_bf16 v[84:87], v[28:31], a[144:151], v126
v_smfmac_f32_16x16x64_bf16 v[88:91], v[28:31], a[152:159], v126
s_branch Lps_571
Lpf_562:
buffer_load_dwordx4 v[28:31], v9, s[4:7], s40 offen offset:0 sc1
v_mfma_f32_16x16x32_bf16 v[16:19], v[20:23], v[20:23], 0
s_sub_u32 s37, s37, 1
s_cbranch_scc1 Lend_1
Lps_577:
s_waitcnt vmcnt(2)
v_max3_u32 v26, v32, v33, v34
v_max_u32 v26, v26, v35
v_cmp_eq_u32 vcc, -1, v26
s_cbranch_vccnz Lpf_578
v_smfmac_f32_16x16x64_bf16 v[76:79], v[32:35], a[160:167], v126
v_smfmac_f32_16x16x64_bf16 v[80:83], v[32:35], a[168:175], v126
v_smfmac_f32_16x16x64_bf16 v[84:87], v[32:35], a[176:183], v126
v_smfmac_f32_16x16x64_bf16 v[88:91], v[32:35], a[184:191], v126
s_branch Lps_569
Lpf_564:
buffer_load_dwordx4 v[28:31], v9, s[4:7], s40 offen offset:0 sc1
v_mfma_f32_16x16x32_bf16 v[16:19], v[20:23], v[20:23], 0
s_sub_u32 s37, s37, 1
s_cbranch_scc1 Lend_1
Lps_579:
s_waitcnt vmcnt(2)
v_max3_u32 v26, v32, v33, v34
v_max_u32 v26, v26, v35
v_cmp_eq_u32 vcc, -1, v26
s_cbranch_vccnz Lpf_580
v_smfmac_f32_16x16x64_bf16 v[76:79], v[32:35], a[160:167], v126
v_smfmac_f32_16x16x64_bf16 v[80:83], v[32:35], a[168:175], v126
v_smfmac_f32_16x16x64_bf16 v[84:87], v[32:35], a[176:183], v126
v_smfmac_f32_16x16x64_bf16 v[88:91], v[32:35], a[184:191], v126
s_branch Lps_523
Lpf_566:
buffer_load_dwordx4 v[32:35], v9, s[4:7], s40 offen offset:1024 sc1
v_mfma_f32_16x16x32_bf16 v[16:19], v[20:23], v[20:23], 0
s_branch Lps_543
Lpf_568:
buffer_load_dwordx4 v[28:31], v9, s[4:7], s40 offen offset:0 sc1
v_mfma_f32_16x16x32_bf16 v[16:19], v[20:23], v[20:23], 0
s_sub_u32 s37, s37, 1
s_cbranch_scc1 Lend_1
s_branch Lps_521
Lpf_570:
buffer_load_dwordx4 v[36:39], v9, s[4:7], s40 offen offset:2048 sc1
v_mfma_f32_16x16x32_bf16 v[16:19], v[20:23], v[20:23], 0
s_branch Lps_547
Lpf_572:
buffer_load_dwordx4 v[32:35], v9, s[4:7], s40 offen offset:1024 sc1
v_mfma_f32_16x16x32_bf16 v[16:19], v[20:23], v[20:23], 0
s_sub_u32 s37, s37, 1
s_cbranch_scc1 Lend_1
s_branch Lps_527
Lpf_574:
buffer_load_dwordx4 v[36:39], v9, s[4:7], s40 offen offset:2048 sc1
v_mfma_f32_16x16x32_bf16 v[16:19], v[20:23], v[20:23], 0
s_branch Lps_553
Lpf_576:
buffer_load_dwordx4 v[28:31], v9, s[4:7], s40 offen offset:0 sc1
v_mfma_f32_16x16x32_bf16 v[16:19], v[20:23], v[20:23], 0
s_sub_u32 s37, s37, 1
s_cbranch_scc1 Lend_1
s_branch Lps_519
Lpf_578:
buffer_load_dwordx4 v[32:35], v9, s[4:7], s40 offen offset:1024 sc1
v_mfma_f32_16x16x32_bf16 v[16:19], v[20:23], v[20:23], 0
Lps_581:
s_waitcnt vmcnt(2)
v_max3_u32 v26, v36, v37, v38
v_max_u32 v26, v26, v39
v_cmp_eq_u32 vcc, -1, v26
s_cbranch_vccnz Lpf_582
v_smfmac_f32_16x16x64_bf16 v[76:79], v[36:39], a[192:199], v126
v_smfmac_f32_16x16x64_bf16 v[80:83], v[36:39], a[200:207], v126
v_smfmac_f32_16x16x64_bf16 v[84:87], v[36:39], a[208:215], v126
v_smfmac_f32_16x16x64_bf16 v[88:91], v[36:39], a[216:223], v126
s_branch Lps_543
Lpf_580:
buffer_load_dwordx4 v[32:35], v9, s[4:7], s40 offen offset:1024 sc1
v_mfma_f32_16x16x32_bf16 v[16:19], v[20:23], v[20:23], 0
s_branch Lps_541
Lpf_582:
buffer_load_dwordx4 v[36:39], v9, s[4:7], s40 offen offset:2048 sc1
v_mfma_f32_16x16x32_bf16 v[16:19], v[20:23], v[20:23], 0
s_branch Lps_561
Lg3_3:
v_mov_b32 v9, v1
s_sub_u32 s26, s34, 24
s_lshl_b32 s44, s33, 3
s_add_u32 s44, s44, s26
s_lshl_b32 s38, s44, 7
s_add_u32 s38, s38, 3440640
v_min_u32 v80, 1, v0
v_lshl_add_u32 v4, v80, 30, s38
v_mov_b32 v5, 0
buffer_store_dword v5, v4, s[4:7], 0 offen sc1
s_mov_b32 s52, 1
s_mov_b32 s38, 4096
buffer_store_dword v5, v4, s[4:7], s38 offen sc1
s_lshl_b32 s38, s44, 7
s_add_u32 s38, s38, 3436544
v_min_u32 v80, 1, v0
v_lshl_add_u32 v7, v80, 30, s38
buffer_store_dword v5, v7, s[4:7], 0 offen sc1
s_lshl_b32 s38, s35, 16
s_or_b32 s52, s52, s38
s_waitcnt vmcnt(0)
s_cmp_lg_u32 s32, 0
s_cbranch_scc1 Lar_584
s_mov_b64 exec, 1
v_mov_b32 v48, 32
v_mov_b32 v49, s52
buffer_atomic_add v49, v48, s[12:15], 0 offen sc1
s_mov_b64 exec, -1
Lar_584:
s_mov_b32 s8, s24
s_and_b32 s9, s25, 0xffff
s_mov_b32 s10, 0x800000
s_mov_b32 s11, 0x20000
s_lshl_b32 s60, s33, 21
s_lshl_b32 s38, s26, 8
s_add_u32 s60, s60, s38
s_add_u32 s61, s60, 128
s_lshr_b32 s52, s32, 1
s_lshl_b32 s52, s52, 14
s_and_b32 s53, s32, 1
s_lshl_b32 s53, s53, 6
s_add_u32 s52, s52, s53
v_bfe_u32 v84, v9, 2, 2
v_lshrrev_b32 v85, 4, v9
v_lshl_add_u32 v84, v85, 2, v84
v_lshl_add_u32 v84, v84, 7, s52
v_and_b32 v85, 3, v9
v_lshl_add_u32 v84, v85, 4, v84
v_add_u32 v80, 0, v84
v_bfe_u32 v84, v9, 2, 2
v_lshrrev_b32 v85, 4, v9
v_lshl_add_u32 v84, v85, 2, v84
v_lshl_add_u32 v84, v84, 7, s52
v_and_b32 v85, 3, v9
v_lshl_add_u32 v84, v85, 4, v84
v_add_u32 v81, 8, v84
v_lshrrev_b32 v84, 3, v9
s_mul_i32 s38, s32, 256
v_add_u32 v84, s38, v84
v_mul_u32_u24 v84, 2048, v84
v_and_b32 v85, 7, v9
v_lshl_add_u32 v84, v85, 4, v84
s_lshl_b32 s38, s32, 12
s_barrier
s_add_u32 m0, s38, 0
s_add_u32 s39, s60, 0
buffer_load_dwordx4 v84, s[8:11], s39 offen lds
s_add_u32 m0, s38, 1024
s_add_u32 s39, s60, 16384
buffer_load_dwordx4 v84, s[8:11], s39 offen lds
s_add_u32 m0, s38, 2048
s_add_u32 s39, s60, 32768
buffer_load_dwordx4 v84, s[8:11], s39 offen lds
s_add_u32 m0, s38, 3072
s_add_u32 s39, s60, 49152
buffer_load_dwordx4 v84, s[8:11], s39 offen lds
s_add_u32 m0, s38, 16384
s_add_u32 s39, s61, 0
buffer_load_dwordx4 v84, s[8:11], s39 offen lds
s_add_u32 m0, s38, 17408
s_add_u32 s39, s61, 16384
buffer_load_dwordx4 v84, s[8:11], s39 offen lds
s_add_u32 m0, s38, 18432
s_add_u32 s39, s61, 32768
buffer_load_dwordx4 v84, s[8:11], s39 offen lds
s_add_u32 m0, s38, 19456
s_add_u32 s39, s61, 49152
buffer_load_dwordx4 v84, s[8:11], s39 offen lds
s_add_u32 m0, s38, 32768
s_add_u32 s39, s60, 65536
buffer_load_dwordx4 v84, s[8:11], s39 offen lds
s_add_u32 m0, s38, 33792
s_add_u32 s39, s60, 81920
buffer_load_dwordx4 v84, s[8:11], s39 offen lds
s_add_u32 m0, s38, 34816
s_add_u32 s39, s60, 98304
buffer_load_dwordx4 v84, s[8:11], s39 offen lds
s_add_u32 m0, s38, 35840
s_add_u32 s39, s60, 114688
buffer_load_dwordx4 v84, s[8:11], s39 offen lds
s_add_u32 m0, s38, 49152
s_add_u32 s39, s61, 65536
buffer_load_dwordx4 v84, s[8:11], s39 offen lds
s_add_u32 m0, s38, 50176
s_add_u32 s39, s61, 81920
buffer_load_dwordx4 v84, s[8:11], s39 offen lds
s_add_u32 m0, s38, 51200
s_add_u32 s39, s61, 98304
buffer_load_dwordx4 v84, s[8:11], s39 offen lds
s_add_u32 m0, s38, 52224
s_add_u32 s39, s61, 114688
buffer_load_dwordx4 v84, s[8:11], s39 offen lds
s_add_u32 m0, s38, 65536
s_add_u32 s39, s60, 131072
buffer_load_dwordx4 v84, s[8:11], s39 offen lds
s_add_u32 m0, s38, 66560
s_add_u32 s39, s60, 147456
buffer_load_dwordx4 v84, s[8:11], s39 offen lds
s_add_u32 m0, s38, 67584
s_add_u32 s39, s60, 163840
buffer_load_dwordx4 v84, s[8:11], s39 offen lds
s_add_u32 m0, s38, 68608
s_add_u32 s39, s60, 180224
buffer_load_dwordx4 v84, s[8:11], s39 offen lds
s_add_u32 m0, s38, 81920
s_add_u32 s39, s61, 131072
buffer_load_dwordx4 v84, s[8:11], s39 offen lds
s_add_u32 m0, s38, 82944
s_add_u32 s39, s61, 147456
buffer_load_dwordx4 v84, s[8:11], s39 offen lds
s_add_u32 m0, s38, 83968
s_add_u32 s39, s61, 163840
buffer_load_dwordx4 v84, s[8:11], s39 offen lds
s_add_u32 m0, s38, 84992
s_add_u32 s39, s61, 180224
buffer_load_dwordx4 v84, s[8:11], s39 offen lds
s_add_u32 m0, s38, 98304
s_add_u32 s39, s60, 196608
buffer_load_dwordx4 v84, s[8:11], s39 offen lds
s_add_u32 m0, s38, 99328
s_add_u32 s39, s60, 212992
buffer_load_dwordx4 v84, s[8:11], s39 offen lds
s_add_u32 m0, s38, 100352
s_add_u32 s39, s60, 229376
buffer_load_dwordx4 v84, s[8:11], s39 offen lds
s_add_u32 m0, s38, 101376
s_add_u32 s39, s60, 245760
buffer_load_dwordx4 v84, s[8:11], s39 offen lds
s_add_u32 m0, s38, 114688
s_add_u32 s39, s61, 196608
buffer_load_dwordx4 v84, s[8:11], s39 offen lds
s_add_u32 m0, s38, 115712
s_add_u32 s39, s61, 212992
buffer_load_dwordx4 v84, s[8:11], s39 offen lds
s_add_u32 m0, s38, 116736
s_add_u32 s39, s61, 229376
buffer_load_dwordx4 v84, s[8:11], s39 offen lds
s_add_u32 m0, s38, 117760
s_add_u32 s39, s61, 245760
buffer_load_dwordx4 v84, s[8:11], s39 offen lds
s_add_u32 m0, s38, 131072
s_add_u32 s39, s60, 262144
buffer_load_dwordx4 v84, s[8:11], s39 offen lds
s_add_u32 m0, s38, 132096
s_add_u32 s39, s60, 278528
buffer_load_dwordx4 v84, s[8:11], s39 offen lds
s_add_u32 m0, s38, 133120
s_add_u32 s39, s60, 294912
buffer_load_dwordx4 v84, s[8:11], s39 offen lds
s_add_u32 m0, s38, 134144
s_add_u32 s39, s60, 311296
buffer_load_dwordx4 v84, s[8:11], s39 offen lds
s_add_u32 m0, s38, 147456
s_add_u32 s39, s61, 262144
buffer_load_dwordx4 v84, s[8:11], s39 offen lds
s_add_u32 m0, s38, 148480
s_add_u32 s39, s61, 278528
buffer_load_dwordx4 v84, s[8:11], s39 offen lds
s_add_u32 m0, s38, 149504
s_add_u32 s39, s61, 294912
buffer_load_dwordx4 v84, s[8:11], s39 offen lds
s_add_u32 m0, s38, 150528
s_add_u32 s39, s61, 311296
buffer_load_dwordx4 v84, s[8:11], s39 offen lds
s_waitcnt vmcnt(32)
s_barrier
ds_read_b64_tr_b16 a[0:1], v80 offset:0
ds_read_b64_tr_b16 a[2:3], v80 offset:2048
ds_read_b64_tr_b16 a[32:33], v80 offset:4096
ds_read_b64_tr_b16 a[34:35], v80 offset:6144
ds_read_b64_tr_b16 a[64:65], v80 offset:8192
ds_read_b64_tr_b16 a[66:67], v80 offset:10240
ds_read_b64_tr_b16 a[96:97], v80 offset:12288
ds_read_b64_tr_b16 a[98:99], v80 offset:14336
ds_read_b64_tr_b16 a[128:129], v81 offset:0
ds_read_b64_tr_b16 a[130:131], v81 offset:2048
ds_read_b64_tr_b16 a[160:161], v81 offset:4096
ds_read_b64_tr_b16 a[162:163], v81 offset:6144
ds_read_b64_tr_b16 a[192:193], v81 offset:8192
ds_read_b64_tr_b16 a[194:195], v81 offset:10240
ds_read_b64_tr_b16 a[224:225], v81 offset:12288
ds_read_b64_tr_b16 a[226:227], v81 offset:14336
v_add_u32 v80, 32768, v80
v_add_u32 v81, 32768, v81
s_waitcnt lgkmcnt(0)
s_barrier
s_add_u32 m0, s38, 0
s_add_u32 s39, s60, 327680
buffer_load_dwordx4 v84, s[8:11], s39 offen lds
s_add_u32 m0, s38, 1024
s_add_u32 s39, s60, 344064
buffer_load_dwordx4 v84, s[8:11], s39 offen lds
s_add_u32 m0, s38, 2048
s_add_u32 s39, s60, 360448
buffer_load_dwordx4 v84, s[8:11], s39 offen lds
s_add_u32 m0, s38, 3072
s_add_u32 s39, s60, 376832
buffer_load_dwordx4 v84, s[8:11], s39 offen lds
s_add_u32 m0, s38, 16384
s_add_u32 s39, s61, 327680
buffer_load_dwordx4 v84, s[8:11], s39 offen lds
s_add_u32 m0, s38, 17408
s_add_u32 s39, s61, 344064
buffer_load_dwordx4 v84, s[8:11], s39 offen lds
s_add_u32 m0, s38, 18432
s_add_u32 s39, s61, 360448
buffer_load_dwordx4 v84, s[8:11], s39 offen lds
s_add_u32 m0, s38, 19456
s_add_u32 s39, s61, 376832
buffer_load_dwordx4 v84, s[8:11], s39 offen lds
s_waitcnt vmcnt(32)
s_barrier
ds_read_b64_tr_b16 a[4:5], v80 offset:0
ds_read_b64_tr_b16 a[6:7], v80 offset:2048
ds_read_b64_tr_b16 a[36:37], v80 offset:4096
ds_read_b64_tr_b16 a[38:39], v80 offset:6144
ds_read_b64_tr_b16 a[68:69], v80 offset:8192
ds_read_b64_tr_b16 a[70:71], v80 offset:10240
ds_read_b64_tr_b16 a[100:101], v80 offset:12288
ds_read_b64_tr_b16 a[102:103], v80 offset:14336
ds_read_b64_tr_b16 a[132:133], v81 offset:0
ds_read_b64_tr_b16 a[134:135], v81 offset:2048
ds_read_b64_tr_b16 a[164:165], v81 offset:4096
ds_read_b64_tr_b16 a[166:167], v81 offset:6144
ds_read_b64_tr_b16 a[196:197], v81 offset:8192
ds_read_b64_tr_b16 a[198:199], v81 offset:10240
ds_read_b64_tr_b16 a[228:229], v81 offset:12288
ds_read_b64_tr_b16 a[230:231], v81 offset:14336
v_add_u32 v80, 32768, v80
v_add_u32 v81, 32768, v81
s_waitcnt lgkmcnt(0)
s_barrier
s_add_u32 m0, s38, 32768
s_add_u32 s39, s60, 393216
buffer_load_dwordx4 v84, s[8:11], s39 offen lds
s_add_u32 m0, s38, 33792
s_add_u32 s39, s60, 409600
buffer_load_dwordx4 v84, s[8:11], s39 offen lds
s_add_u32 m0, s38, 34816
s_add_u32 s39, s60, 425984
buffer_load_dwordx4 v84, s[8:11], s39 offen lds
s_add_u32 m0, s38, 35840
s_add_u32 s39, s60, 442368
buffer_load_dwordx4 v84, s[8:11], s39 offen lds
s_add_u32 m0, s38, 49152
s_add_u32 s39, s61, 393216
buffer_load_dwordx4 v84, s[8:11], s39 offen lds
s_add_u32 m0, s38, 50176
s_add_u32 s39, s61, 409600
buffer_load_dwordx4 v84, s[8:11], s39 offen lds
s_add_u32 m0, s38, 51200
s_add_u32 s39, s61, 425984
buffer_load_dwordx4 v84, s[8:11], s39 offen lds
s_add_u32 m0, s38, 52224
s_add_u32 s39, s61, 442368
buffer_load_dwordx4 v84, s[8:11], s39 offen lds
s_waitcnt vmcnt(32)
s_barrier
ds_read_b64_tr_b16 a[8:9], v80 offset:0
ds_read_b64_tr_b16 a[10:11], v80 offset:2048
ds_read_b64_tr_b16 a[40:41], v80 offset:4096
ds_read_b64_tr_b16 a[42:43], v80 offset:6144
ds_read_b64_tr_b16 a[72:73], v80 offset:8192
ds_read_b64_tr_b16 a[74:75], v80 offset:10240
ds_read_b64_tr_b16 a[104:105], v80 offset:12288
ds_read_b64_tr_b16 a[106:107], v80 offset:14336
ds_read_b64_tr_b16 a[136:137], v81 offset:0
ds_read_b64_tr_b16 a[138:139], v81 offset:2048
ds_read_b64_tr_b16 a[168:169], v81 offset:4096
ds_read_b64_tr_b16 a[170:171], v81 offset:6144
ds_read_b64_tr_b16 a[200:201], v81 offset:8192
ds_read_b64_tr_b16 a[202:203], v81 offset:10240
ds_read_b64_tr_b16 a[232:233], v81 offset:12288
ds_read_b64_tr_b16 a[234:235], v81 offset:14336
v_add_u32 v80, 32768, v80
v_add_u32 v81, 32768, v81
s_waitcnt lgkmcnt(0)
s_barrier
s_add_u32 m0, s38, 65536
s_add_u32 s39, s60, 458752
buffer_load_dwordx4 v84, s[8:11], s39 offen lds
s_add_u32 m0, s38, 66560
s_add_u32 s39, s60, 475136
buffer_load_dwordx4 v84, s[8:11], s39 offen lds
s_add_u32 m0, s38, 67584
s_add_u32 s39, s60, 491520
buffer_load_dwordx4 v84, s[8:11], s39 offen lds
s_add_u32 m0, s38, 68608
s_add_u32 s39, s60, 507904
buffer_load_dwordx4 v84, s[8:11], s39 offen lds
s_add_u32 m0, s38, 81920
s_add_u32 s39, s61, 458752
buffer_load_dwordx4 v84, s[8:11], s39 offen lds
s_add_u32 m0, s38, 82944
s_add_u32 s39, s61, 475136
buffer_load_dwordx4 v84, s[8:11], s39 offen lds
s_add_u32 m0, s38, 83968
s_add_u32 s39, s61, 491520
buffer_load_dwordx4 v84, s[8:11], s39 offen lds
s_add_u32 m0, s38, 84992
s_add_u32 s39, s61, 507904
buffer_load_dwordx4 v84, s[8:11], s39 offen lds
s_waitcnt vmcnt(32)
s_barrier
ds_read_b64_tr_b16 a[12:13], v80 offset:0
ds_read_b64_tr_b16 a[14:15], v80 offset:2048
ds_read_b64_tr_b16 a[44:45], v80 offset:4096
ds_read_b64_tr_b16 a[46:47], v80 offset:6144
ds_read_b64_tr_b16 a[76:77], v80 offset:8192
ds_read_b64_tr_b16 a[78:79], v80 offset:10240
ds_read_b64_tr_b16 a[108:109], v80 offset:12288
ds_read_b64_tr_b16 a[110:111], v80 offset:14336
ds_read_b64_tr_b16 a[140:141], v81 offset:0
ds_read_b64_tr_b16 a[142:143], v81 offset:2048
ds_read_b64_tr_b16 a[172:173], v81 offset:4096
ds_read_b64_tr_b16 a[174:175], v81 offset:6144
ds_read_b64_tr_b16 a[204:205], v81 offset:8192
ds_read_b64_tr_b16 a[206:207], v81 offset:10240
ds_read_b64_tr_b16 a[236:237], v81 offset:12288
ds_read_b64_tr_b16 a[238:239], v81 offset:14336
v_add_u32 v80, 32768, v80
v_add_u32 v81, 32768, v81
s_waitcnt lgkmcnt(0)
s_barrier
s_waitcnt vmcnt(24)
s_barrier
ds_read_b64_tr_b16 a[16:17], v80 offset:0
ds_read_b64_tr_b16 a[18:19], v80 offset:2048
ds_read_b64_tr_b16 a[48:49], v80 offset:4096
ds_read_b64_tr_b16 a[50:51], v80 offset:6144
ds_read_b64_tr_b16 a[80:81], v80 offset:8192
ds_read_b64_tr_b16 a[82:83], v80 offset:10240
ds_read_b64_tr_b16 a[112:113], v80 offset:12288
ds_read_b64_tr_b16 a[114:115], v80 offset:14336
ds_read_b64_tr_b16 a[144:145], v81 offset:0
ds_read_b64_tr_b16 a[146:147], v81 offset:2048
ds_read_b64_tr_b16 a[176:177], v81 offset:4096
ds_read_b64_tr_b16 a[178:179], v81 offset:6144
ds_read_b64_tr_b16 a[208:209], v81 offset:8192
ds_read_b64_tr_b16 a[210:211], v81 offset:10240
ds_read_b64_tr_b16 a[240:241], v81 offset:12288
ds_read_b64_tr_b16 a[242:243], v81 offset:14336
v_add_u32 v80, -131072, v80
v_add_u32 v81, -131072, v81
s_waitcnt lgkmcnt(0)
s_barrier
s_waitcnt vmcnt(16)
s_barrier
ds_read_b64_tr_b16 a[20:21], v80 offset:0
ds_read_b64_tr_b16 a[22:23], v80 offset:2048
ds_read_b64_tr_b16 a[52:53], v80 offset:4096
ds_read_b64_tr_b16 a[54:55], v80 offset:6144
ds_read_b64_tr_b16 a[84:85], v80 offset:8192
ds_read_b64_tr_b16 a[86:87], v80 offset:10240
ds_read_b64_tr_b16 a[116:117], v80 offset:12288
ds_read_b64_tr_b16 a[118:119], v80 offset:14336
ds_read_b64_tr_b16 a[148:149], v81 offset:0
ds_read_b64_tr_b16 a[150:151], v81 offset:2048
ds_read_b64_tr_b16 a[180:181], v81 offset:4096
ds_read_b64_tr_b16 a[182:183], v81 offset:6144
ds_read_b64_tr_b16 a[212:213], v81 offset:8192
ds_read_b64_tr_b16 a[214:215], v81 offset:10240
ds_read_b64_tr_b16 a[244:245], v81 offset:12288
ds_read_b64_tr_b16 a[246:247], v81 offset:14336
v_add_u32 v80, 32768, v80
v_add_u32 v81, 32768, v81
s_waitcnt lgkmcnt(0)
s_barrier
s_waitcnt vmcnt(8)
s_barrier
ds_read_b64_tr_b16 a[24:25], v80 offset:0
ds_read_b64_tr_b16 a[26:27], v80 offset:2048
ds_read_b64_tr_b16 a[56:57], v80 offset:4096
ds_read_b64_tr_b16 a[58:59], v80 offset:6144
ds_read_b64_tr_b16 a[88:89], v80 offset:8192
ds_read_b64_tr_b16 a[90:91], v80 offset:10240
ds_read_b64_tr_b16 a[120:121], v80 offset:12288
ds_read_b64_tr_b16 a[122:123], v80 offset:14336
ds_read_b64_tr_b16 a[152:153], v81 offset:0
ds_read_b64_tr_b16 a[154:155], v81 offset:2048
ds_read_b64_tr_b16 a[184:185], v81 offset:4096
ds_read_b64_tr_b16 a[186:187], v81 offset:6144
ds_read_b64_tr_b16 a[216:217], v81 offset:8192
ds_read_b64_tr_b16 a[218:219], v81 offset:10240
ds_read_b64_tr_b16 a[248:249], v81 offset:12288
ds_read_b64_tr_b16 a[250:251], v81 offset:14336
v_add_u32 v80, 32768, v80
v_add_u32 v81, 32768, v81
s_waitcnt lgkmcnt(0)
s_barrier
s_waitcnt vmcnt(0)
s_barrier
ds_read_b64_tr_b16 a[28:29], v80 offset:0
ds_read_b64_tr_b16 a[30:31], v80 offset:2048
ds_read_b64_tr_b16 a[60:61], v80 offset:4096
ds_read_b64_tr_b16 a[62:63], v80 offset:6144
ds_read_b64_tr_b16 a[92:93], v80 offset:8192
ds_read_b64_tr_b16 a[94:95], v80 offset:10240
ds_read_b64_tr_b16 a[124:125], v80 offset:12288
ds_read_b64_tr_b16 a[126:127], v80 offset:14336
ds_read_b64_tr_b16 a[156:157], v81 offset:0
ds_read_b64_tr_b16 a[158:159], v81 offset:2048
ds_read_b64_tr_b16 a[188:189], v81 offset:4096
ds_read_b64_tr_b16 a[190:191], v81 offset:6144
ds_read_b64_tr_b16 a[220:221], v81 offset:8192
ds_read_b64_tr_b16 a[222:223], v81 offset:10240
ds_read_b64_tr_b16 a[252:253], v81 offset:12288
ds_read_b64_tr_b16 a[254:255], v81 offset:14336
v_add_u32 v80, 32768, v80
v_add_u32 v81, 32768, v81
s_waitcnt lgkmcnt(0)
s_barrier
Lst_585:
buffer_load_dword v48, off, s[12:15], 0 offset:32 sc1
buffer_load_dword v49, off, s[12:15], 0 offset:160 sc1
s_waitcnt vmcnt(0)
v_add_u32 v48, v48, v49
s_nop 0
v_readfirstlane_b32 s38, v48
s_nop 3
s_and_b32 s39, s38, 0xffff
s_cmp_eq_u32 s39, 0x100
s_cbranch_scc1 Lso_586
s_sub_u32 s37, s37, 1
s_cbranch_scc1 Lend_7
s_sleep 8
s_branch Lst_585
Lso_586:
s_bfe_u32 s35, s38, 0x80010
s_bfe_u32 s46, s38, 0x10018
s_lshl_b32 s46, s46, 13
s_barrier
s_mul_i32 s50, s32, 4096
v_lshlrev_b32 v1, 4, v9
v_add_u32 v0, s50, v1
v_lshrrev_b32 v80, 2, v9
v_min_u32 v80, 7, v80
v_lshlrev_b32 v80, 7, v80
v_and_b32 v2, 3, v9
v_lshl_add_u32 v2, v2, 2, v80
s_lshl_b32 s47, s33, 10
s_add_u32 s47, s47, 3432448
v_mov_b32 v6, v1
s_lshl_b32 s38, s26, 2
s_add_u32 s38, s38, s32
s_lshl_b32 s38, s38, 11
s_lshl_b32 s49, s33, 22
s_add_u32 s49, s49, s38
s_add_u32 s49, s49, 117374976
s_lshl_b32 s54, s33, 16
s_add_u32 s54, s54, 83886080
s_lshl_b32 s45, s26, 18
s_add_u32 s45, s45, s54
s_add_u32 m0, s50, 0
s_add_u32 s39, s45, 0
buffer_load_dwordx4 v0, s[4:7], s39 offen offset:0 sc1 lds
buffer_load_dwordx4 v0, s[4:7], s39 offen offset:1024 sc1 lds
buffer_load_dwordx4 v0, s[4:7], s39 offen offset:2048 sc1 lds
buffer_load_dwordx4 v0, s[4:7], s39 offen offset:3072 sc1 lds
s_add_u32 m0, s50, 16384
s_add_u32 s39, s45, 16384
buffer_load_dwordx4 v0, s[4:7], s39 offen offset:0 sc1 lds
buffer_load_dwordx4 v0, s[4:7], s39 offen offset:1024 sc1 lds
buffer_load_dwordx4 v0, s[4:7], s39 offen offset:2048 sc1 lds
buffer_load_dwordx4 v0, s[4:7], s39 offen offset:3072 sc1 lds
s_add_u32 m0, s50, 32768
s_add_u32 s39, s45, 32768
buffer_load_dwordx4 v0, s[4:7], s39 offen offset:0 sc1 lds
buffer_load_dwordx4 v0, s[4:7], s39 offen offset:1024 sc1 lds
buffer_load_dwordx4 v0, s[4:7], s39 offen offset:2048 sc1 lds
buffer_load_dwordx4 v0, s[4:7], s39 offen offset:3072 sc1 lds
s_add_u32 m0, s50, 49152
s_add_u32 s39, s45, 49152
buffer_load_dwordx4 v0, s[4:7], s39 offen offset:0 sc1 lds
buffer_load_dwordx4 v0, s[4:7], s39 offen offset:1024 sc1 lds
buffer_load_dwordx4 v0, s[4:7], s39 offen offset:2048 sc1 lds
buffer_load_dwordx4 v0, s[4:7], s39 offen offset:3072 sc1 lds
v_mov_b32 v8, 0
s_mov_b32 s36, 0
s_add_u32 s48, s36, 1
Lsw_587:
Lbw_592:
buffer_load_dword v3, v2, s[4:7], s47 offen sc1
s_waitcnt vmcnt(0)
v_cmp_gt_u32 vcc, s48, v3
s_cbranch_vccz Lbo_593
s_sub_u32 s37, s37, 1
s_cbranch_scc1 Lend_7
s_sleep 1
s_branch Lbw_592
Lbo_593:
s_add_u32 m0, s50, 0
s_add_u32 s39, s54, 0
buffer_load_dwordx4 v0, s[4:7], s39 offen offset:0 sc1 lds
buffer_load_dwordx4 v0, s[4:7], s39 offen offset:1024 sc1 lds
buffer_load_dwordx4 v0, s[4:7], s39 offen offset:2048 sc1 lds
buffer_load_dwordx4 v0, s[4:7], s39 offen offset:3072 sc1 lds
s_add_u32 m0, s50, 16384
s_add_u32 s39, s54, 16384
buffer_load_dwordx4 v0, s[4:7], s39 offen offset:0 sc1 lds
buffer_load_dwordx4 v0, s[4:7], s39 offen offset:1024 sc1 lds
buffer_load_dwordx4 v0, s[4:7], s39 offen offset:2048 sc1 lds
buffer_load_dwordx4 v0, s[4:7], s39 offen offset:3072 sc1 lds
s_add_u32 m0, s50, 32768
s_add_u32 s39, s54, 32768
buffer_load_dwordx4 v0, s[4:7], s39 offen offset:0 sc1 lds
buffer_load_dwordx4 v0, s[4:7], s39 offen offset:1024 sc1 lds
buffer_load_dwordx4 v0, s[4:7], s39 offen offset:2048 sc1 lds
buffer_load_dwordx4 v0, s[4:7], s39 offen offset:3072 sc1 lds
s_add_u32 m0, s50, 49152
s_add_u32 s39, s54, 49152
buffer_load_dwordx4 v0, s[4:7], s39 offen offset:0 sc1 lds
buffer_load_dwordx4 v0, s[4:7], s39 offen offset:1024 sc1 lds
buffer_load_dwordx4 v0, s[4:7], s39 offen offset:2048 sc1 lds
buffer_load_dwordx4 v0, s[4:7], s39 offen offset:3072 sc1 lds
buffer_load_dword v3, v2, s[4:7], s47 offen sc1
Lse_588:
s_waitcnt vmcnt(13)
s_barrier
ds_read_b128 v[16:19], v1 offset:0
ds_read_b128 v[20:23], v1 offset:1024
ds_read_b128 v[24:27], v1 offset:2048
ds_read_b128 v[28:31], v1 offset:3072
ds_read_b128 v[32:35], v1 offset:4096
ds_read_b128 v[36:39], v1 offset:5120
ds_read_b128 v[40:43], v1 offset:6144
s_add_u32 s54, s54, 262144
s_bitset0_b32 s54, 21
s_xor_b32 s50, s50, 0x10000
s_add_u32 s49, s49, 65536
s_add_u32 s36, s36, 1
s_add_u32 s48, s36, 1
s_waitcnt lgkmcnt(5)
v_mfma_f32_16x16x32_bf16 v[48:51], a[0:3], v[16:19], 0
ds_read_b128 v[44:47], v1 offset:7168
v_mfma_f32_16x16x32_bf16 v[52:55], a[128:131], v[16:19], 0
v_mfma_f32_16x16x32_bf16 v[56:59], a[0:3], v[20:23], 0
ds_read_b128 v[16:19], v1 offset:8192
v_mfma_f32_16x16x32_bf16 v[60:63], a[128:131], v[20:23], 0
s_waitcnt lgkmcnt(5)
v_mfma_f32_16x16x32_bf16 v[48:51], a[4:7], v[24:27], v[48:51]
ds_read_b128 v[20:23], v1 offset:9216
v_mfma_f32_16x16x32_bf16 v[52:55], a[132:135], v[24:27], v[52:55]
v_mfma_f32_16x16x32_bf16 v[56:59], a[4:7], v[28:31], v[56:59]
ds_read_b128 v[24:27], v1 offset:10240
v_mfma_f32_16x16x32_bf16 v[60:63], a[132:135], v[28:31], v[60:63]
s_waitcnt lgkmcnt(5)
v_mfma_f32_16x16x32_bf16 v[48:51], a[8:11], v[32:35], v[48:51]
ds_read_b128 v[28:31], v1 offset:11264
v_mfma_f32_16x16x32_bf16 v[52:55], a[136:139], v[32:35], v[52:55]
v_mfma_f32_16x16x32_bf16 v[56:59], a[8:11], v[36:39], v[56:59]
ds_read_b128 v[32:35], v1 offset:12288
v_mfma_f32_16x16x32_bf16 v[60:63], a[136:139], v[36:39], v[60:63]
s_waitcnt lgkmcnt(5)
v_mfma_f32_16x16x32_bf16 v[48:51], a[12:15], v[40:43], v[48:51]
ds_read_b128 v[36:39], v1 offset:13312
v_mfma_f32_16x16x32_bf16 v[52:55], a[140:143], v[40:43], v[52:55]
v_mfma_f32_16x16x32_bf16 v[56:59], a[12:15], v[44:47], v[56:59]
ds_read_b128 v[40:43], v1 offset:14336
v_mfma_f32_16x16x32_bf16 v[60:63], a[140:143], v[44:47], v[60:63]
s_waitcnt lgkmcnt(5)
v_mfma_f32_16x16x32_bf16 v[48:51], a[16:19], v[16:19], v[48:51]
ds_read_b128 v[44:47], v1 offset:15360
v_mfma_f32_16x16x32_bf16 v[52:55], a[144:147], v[16:19], v[52:55]
v_mfma_f32_16x16x32_bf16 v[56:59], a[16:19], v[20:23], v[56:59]
s_waitcnt vmcnt(9)
s_barrier
ds_read_b128 v[16:19], v1 offset:16384
v_mfma_f32_16x16x32_bf16 v[60:63], a[144:147], v[20:23], v[60:63]
s_waitcnt lgkmcnt(5)
v_mfma_f32_16x16x32_bf16 v[48:51], a[20:23], v[24:27], v[48:51]
ds_read_b128 v[20:23], v1 offset:17408
v_mfma_f32_16x16x32_bf16 v[52:55], a[148:151], v[24:27], v[52:55]
v_mfma_f32_16x16x32_bf16 v[56:59], a[20:23], v[28:31], v[56:59]
ds_read_b128 v[24:27], v1 offset:18432
v_mfma_f32_16x16x32_bf16 v[60:63], a[148:151], v[28:31], v[60:63]
s_waitcnt lgkmcnt(5)
v_mfma_f32_16x16x32_bf16 v[48:51], a[24:27], v[32:35], v[48:51]
ds_read_b128 v[28:31], v1 offset:19456
v_mfma_f32_16x16x32_bf16 v[52:55], a[152:155], v[32:35], v[52:55]
v_mfma_f32_16x16x32_bf16 v[56:59], a[24:27], v[36:39], v[56:59]
ds_read_b128 v[32:35], v1 offset:20480
v_mfma_f32_16x16x32_bf16 v[60:63], a[152:155], v[36:39], v[60:63]
s_waitcnt lgkmcnt(5)
v_mfma_f32_16x16x32_bf16 v[48:51], a[28:31], v[40:43], v[48:51]
ds_read_b128 v[36:39], v1 offset:21504
v_mfma_f32_16x16x32_bf16 v[52:55], a[156:159], v[40:43], v[52:55]
v_mfma_f32_16x16x32_bf16 v[56:59], a[28:31], v[44:47], v[56:59]
ds_read_b128 v[40:43], v1 offset:22528
v_mfma_f32_16x16x32_bf16 v[60:63], a[156:159], v[44:47], v[60:63]
s_waitcnt lgkmcnt(5)
v_mfma_f32_16x16x32_bf16 v[48:51], a[32:35], v[16:19], v[48:51]
ds_read_b128 v[44:47], v1 offset:23552
v_mfma_f32_16x16x32_bf16 v[52:55], a[160:163], v[16:19], v[52:55]
v_mfma_f32_16x16x32_bf16 v[56:59], a[32:35], v[20:23], v[56:59]
ds_read_b128 v[16:19], v1 offset:24576
v_mfma_f32_16x16x32_bf16 v[60:63], a[160:163], v[20:23], v[60:63]
s_waitcnt lgkmcnt(5)
v_mfma_f32_16x16x32_bf16 v[48:51], a[36:39], v[24:27], v[48:51]
ds_read_b128 v[20:23], v1 offset:25600
v_mfma_f32_16x16x32_bf16 v[52:55], a[164:167], v[24:27], v[52:55]
v_mfma_f32_16x16x32_bf16 v[56:59], a[36:39], v[28:31], v[56:59]
ds_read_b128 v[24:27], v1 offset:26624
v_mfma_f32_16x16x32_bf16 v[60:63], a[164:167], v[28:31], v[60:63]
s_waitcnt lgkmcnt(5)
v_mfma_f32_16x16x32_bf16 v[48:51], a[40:43], v[32:35], v[48:51]
ds_read_b128 v[28:31], v1 offset:27648
v_mfma_f32_16x16x32_bf16 v[52:55], a[168:171], v[32:35], v[52:55]
v_mfma_f32_16x16x32_bf16 v[56:59], a[40:43], v[36:39], v[56:59]
ds_read_b128 v[32:35], v1 offset:28672
v_mfma_f32_16x16x32_bf16 v[60:63], a[168:171], v[36:39], v[60:63]
s_waitcnt lgkmcnt(5)
v_mfma_f32_16x16x32_bf16 v[48:51], a[44:47], v[40:43], v[48:51]
ds_read_b128 v[36:39], v1 offset:29696
v_mfma_f32_16x16x32_bf16 v[52:55], a[172:175], v[40:43], v[52:55]
v_mfma_f32_16x16x32_bf16 v[56:59], a[44:47], v[44:47], v[56:59]
ds_read_b128 v[40:43], v1 offset:30720
v_mfma_f32_16x16x32_bf16 v[60:63], a[172:175], v[44:47], v[60:63]
s_waitcnt lgkmcnt(5)
v_mfma_f32_16x16x32_bf16 v[48:51], a[48:51], v[16:19], v[48:51]
ds_read_b128 v[44:47], v1 offset:31744
v_mfma_f32_16x16x32_bf16 v[52:55], a[176:179], v[16:19], v[52:55]
v_mfma_f32_16x16x32_bf16 v[56:59], a[48:51], v[20:23], v[56:59]
s_waitcnt vmcnt(5)
s_barrier
ds_read_b128 v[16:19], v1 offset:32768
v_mfma_f32_16x16x32_bf16 v[60:63], a[176:179], v[20:23], v[60:63]
s_waitcnt lgkmcnt(5)
v_mfma_f32_16x16x32_bf16 v[48:51], a[52:55], v[24:27], v[48:51]
ds_read_b128 v[20:23], v1 offset:33792
v_mfma_f32_16x16x32_bf16 v[52:55], a[180:183], v[24:27], v[52:55]
v_mfma_f32_16x16x32_bf16 v[56:59], a[52:55], v[28:31], v[56:59]
ds_read_b128 v[24:27], v1 offset:34816
v_mfma_f32_16x16x32_bf16 v[60:63], a[180:183], v[28:31], v[60:63]
s_waitcnt lgkmcnt(5)
v_mfma_f32_16x16x32_bf16 v[48:51], a[56:59], v[32:35], v[48:51]
ds_read_b128 v[28:31], v1 offset:35840
v_mfma_f32_16x16x32_bf16 v[52:55], a[184:187], v[32:35], v[52:55]
v_mfma_f32_16x16x32_bf16 v[56:59], a[56:59], v[36:39], v[56:59]
ds_read_b128 v[32:35], v1 offset:36864
v_mfma_f32_16x16x32_bf16 v[60:63], a[184:187], v[36:39], v[60:63]
s_waitcnt lgkmcnt(5)
v_mfma_f32_16x16x32_bf16 v[48:51], a[60:63], v[40:43], v[48:51]
ds_read_b128 v[36:39], v1 offset:37888
v_mfma_f32_16x16x32_bf16 v[52:55], a[188:191], v[40:43], v[52:55]
v_mfma_f32_16x16x32_bf16 v[56:59], a[60:63], v[44:47], v[56:59]
ds_read_b128 v[40:43], v1 offset:38912
v_mfma_f32_16x16x32_bf16 v[60:63], a[188:191], v[44:47], v[60:63]
s_waitcnt lgkmcnt(5)
v_mfma_f32_16x16x32_bf16 v[48:51], a[64:67], v[16:19], v[48:51]
ds_read_b128 v[44:47], v1 offset:39936
v_mfma_f32_16x16x32_bf16 v[52:55], a[192:195], v[16:19], v[52:55]
v_mfma_f32_16x16x32_bf16 v[56:59], a[64:67], v[20:23], v[56:59]
ds_read_b128 v[16:19], v1 offset:40960
v_mfma_f32_16x16x32_bf16 v[60:63], a[192:195], v[20:23], v[60:63]
s_waitcnt lgkmcnt(5)
v_mfma_f32_16x16x32_bf16 v[48:51], a[68:71], v[24:27], v[48:51]
ds_read_b128 v[20:23], v1 offset:41984
v_mfma_f32_16x16x32_bf16 v[52:55], a[196:199], v[24:27], v[52:55]
v_mfma_f32_16x16x32_bf16 v[56:59], a[68:71], v[28:31], v[56:59]
ds_read_b128 v[24:27], v1 offset:43008
v_mfma_f32_16x16x32_bf16 v[60:63], a[196:199], v[28:31], v[60:63]
s_waitcnt lgkmcnt(5)
v_mfma_f32_16x16x32_bf16 v[48:51], a[72:75], v[32:35], v[48:51]
ds_read_b128 v[28:31], v1 offset:44032
v_mfma_f32_16x16x32_bf16 v[52:55], a[200:203], v[32:35], v[52:55]
v_mfma_f32_16x16x32_bf16 v[56:59], a[72:75], v[36:39], v[56:59]
ds_read_b128 v[32:35], v1 offset:45056
v_mfma_f32_16x16x32_bf16 v[60:63], a[200:203], v[36:39], v[60:63]
s_waitcnt lgkmcnt(5)
v_mfma_f32_16x16x32_bf16 v[48:51], a[76:79], v[40:43], v[48:51]
ds_read_b128 v[36:39], v1 offset:46080
v_mfma_f32_16x16x32_bf16 v[52:55], a[204:207], v[40:43], v[52:55]
v_mfma_f32_16x16x32_bf16 v[56:59], a[76:79], v[44:47], v[56:59]
ds_read_b128 v[40:43], v1 offset:47104
v_mfma_f32_16x16x32_bf16 v[60:63], a[204:207], v[44:47], v[60:63]
s_waitcnt lgkmcnt(5)
v_mfma_f32_16x16x32_bf16 v[48:51], a[80:83], v[16:19], v[48:51]
ds_read_b128 v[44:47], v1 offset:48128
v_mfma_f32_16x16x32_bf16 v[52:55], a[208:211], v[16:19], v[52:55]
v_mfma_f32_16x16x32_bf16 v[56:59], a[80:83], v[20:23], v[56:59]
s_waitcnt vmcnt(1)
s_barrier
ds_read_b128 v[16:19], v1 offset:49152
v_mfma_f32_16x16x32_bf16 v[60:63], a[208:211], v[20:23], v[60:63]
s_waitcnt lgkmcnt(5)
v_mfma_f32_16x16x32_bf16 v[48:51], a[84:87], v[24:27], v[48:51]
ds_read_b128 v[20:23], v1 offset:50176
v_mfma_f32_16x16x32_bf16 v[52:55], a[212:215], v[24:27], v[52:55]
v_mfma_f32_16x16x32_bf16 v[56:59], a[84:87], v[28:31], v[56:59]
ds_read_b128 v[24:27], v1 offset:51200
v_mfma_f32_16x16x32_bf16 v[60:63], a[212:215], v[28:31], v[60:63]
s_waitcnt lgkmcnt(5)
v_mfma_f32_16x16x32_bf16 v[48:51], a[88:91], v[32:35], v[48:51]
ds_read_b128 v[28:31], v1 offset:52224
v_mfma_f32_16x16x32_bf16 v[52:55], a[216:219], v[32:35], v[52:55]
v_mfma_f32_16x16x32_bf16 v[56:59], a[88:91], v[36:39], v[56:59]
ds_read_b128 v[32:35], v1 offset:53248
v_mfma_f32_16x16x32_bf16 v[60:63], a[216:219], v[36:39], v[60:63]
s_waitcnt lgkmcnt(5)
v_mfma_f32_16x16x32_bf16 v[48:51], a[92:95], v[40:43], v[48:51]
ds_read_b128 v[36:39], v1 offset:54272
buffer_load_dword v3, v2, s[4:7], s47 offen sc1
v_mfma_f32_16x16x32_bf16 v[52:55], a[220:223], v[40:43], v[52:55]
v_mfma_f32_16x16x32_bf16 v[56:59], a[92:95], v[44:47], v[56:59]
ds_read_b128 v[40:43], v1 offset:55296
v_mfma_f32_16x16x32_bf16 v[60:63], a[220:223], v[44:47], v[60:63]
s_waitcnt lgkmcnt(5)
v_mfma_f32_16x16x32_bf16 v[48:51], a[96:99], v[16:19], v[48:51]
ds_read_b128 v[44:47], v1 offset:56320
v_mfma_f32_16x16x32_bf16 v[52:55], a[224:227], v[16:19], v[52:55]
v_mfma_f32_16x16x32_bf16 v[56:59], a[96:99], v[20:23], v[56:59]
ds_read_b128 v[16:19], v1 offset:57344
v_mfma_f32_16x16x32_bf16 v[60:63], a[224:227], v[20:23], v[60:63]
s_waitcnt lgkmcnt(5)
v_mfma_f32_16x16x32_bf16 v[48:51], a[100:103], v[24:27], v[48:51]
ds_read_b128 v[20:23], v1 offset:58368
v_mfma_f32_16x16x32_bf16 v[52:55], a[228:231], v[24:27], v[52:55]
v_mfma_f32_16x16x32_bf16 v[56:59], a[100:103], v[28:31], v[56:59]
ds_read_b128 v[24:27], v1 offset:59392
v_mfma_f32_16x16x32_bf16 v[60:63], a[228:231], v[28:31], v[60:63]
s_waitcnt lgkmcnt(5)
v_mfma_f32_16x16x32_bf16 v[48:51], a[104:107], v[32:35], v[48:51]
ds_read_b128 v[28:31], v1 offset:60416
v_mfma_f32_16x16x32_bf16 v[52:55], a[232:235], v[32:35], v[52:55]
v_mfma_f32_16x16x32_bf16 v[56:59], a[104:107], v[36:39], v[56:59]
ds_read_b128 v[32:35], v1 offset:61440
v_mfma_f32_16x16x32_bf16 v[60:63], a[232:235], v[36:39], v[60:63]
s_waitcnt lgkmcnt(5)
v_mfma_f32_16x16x32_bf16 v[48:51], a[108:111], v[40:43], v[48:51]
ds_read_b128 v[36:39], v1 offset:62464
v_mfma_f32_16x16x32_bf16 v[52:55], a[236:239], v[40:43], v[52:55]
v_mfma_f32_16x16x32_bf16 v[56:59], a[108:111], v[44:47], v[56:59]
ds_read_b128 v[40:43], v1 offset:63488
v_mfma_f32_16x16x32_bf16 v[60:63], a[236:239], v[44:47], v[60:63]
s_waitcnt lgkmcnt(5)
v_mfma_f32_16x16x32_bf16 v[48:51], a[112:115], v[16:19], v[48:51]
ds_read_b128 v[44:47], v1 offset:64512
v_mfma_f32_16x16x32_bf16 v[52:55], a[240:243], v[16:19], v[52:55]
v_mfma_f32_16x16x32_bf16 v[56:59], a[112:115], v[20:23], v[56:59]
v_mfma_f32_16x16x32_bf16 v[60:63], a[240:243], v[20:23], v[60:63]
s_waitcnt lgkmcnt(4)
v_mfma_f32_16x16x32_bf16 v[48:51], a[116:119], v[24:27], v[48:51]
v_mfma_f32_16x16x32_bf16 v[52:55], a[244:247], v[24:27], v[52:55]
v_mfma_f32_16x16x32_bf16 v[56:59], a[116:119], v[28:31], v[56:59]
v_mfma_f32_16x16x32_bf16 v[60:63], a[244:247], v[28:31], v[60:63]
s_waitcnt lgkmcnt(2)
v_mfma_f32_16x16x32_bf16 v[48:51], a[120:123], v[32:35], v[48:51]
v_mfma_f32_16x16x32_bf16 v[52:55], a[248:251], v[32:35], v[52:55]
v_mfma_f32_16x16x32_bf16 v[56:59], a[120:123], v[36:39], v[56:59]
v_mfma_f32_16x16x32_bf16 v[60:63], a[248:251], v[36:39], v[60:63]
s_waitcnt lgkmcnt(0)
v_mfma_f32_16x16x32_bf16 v[48:51], a[124:127], v[40:43], v[48:51]
v_mfma_f32_16x16x32_bf16 v[52:55], a[252:255], v[40:43], v[52:55]
v_mfma_f32_16x16x32_bf16 v[56:59], a[124:127], v[44:47], v[56:59]
v_mfma_f32_16x16x32_bf16 v[60:63], a[252:255], v[44:47], v[60:63]
v_xor_b32 v1, 0x10000, v1
v_mov_b32 v5, s36
s_waitcnt vmcnt(0)
v_cmp_gt_u32 vcc, s48, v3
v_add_u32 v8, 1, v8
s_cmp_lg_u32 s35, 0
s_cbranch_scc1 Llf_594
buffer_store_dword v8, v7, s[4:7], 0 offen
s_branch Llo_595
Llf_594:
buffer_store_dword v8, v7, s[4:7], 0 offen sc1
Llo_595:
s_nop 3
v_cvt_pk_bf16_f32 v80, v48, v49
v_cvt_pk_bf16_f32 v81, v50, v51
v_cvt_pk_bf16_f32 v82, v52, v53
v_cvt_pk_bf16_f32 v83, v54, v55
buffer_store_dwordx4 v[80:83], v6, s[4:7], s49 offen offset:0 sc1
v_cvt_pk_bf16_f32 v84, v56, v57
v_cvt_pk_bf16_f32 v85, v58, v59
v_cvt_pk_bf16_f32 v86, v60, v61
v_cvt_pk_bf16_f32 v87, v62, v63
buffer_store_dwordx4 v[84:87], v6, s[4:7], s49 offen offset:1024 sc1
s_mov_b32 s46, 0
s_cbranch_vccnz Lsk_590
s_mov_b32 s46, 1
s_add_u32 m0, s50, 0
s_add_u32 s39, s54, 0
buffer_load_dwordx4 v0, s[4:7], s39 offen offset:0 sc1 lds
buffer_load_dwordx4 v0, s[4:7], s39 offen offset:1024 sc1 lds
buffer_load_dwordx4 v0, s[4:7], s39 offen offset:2048 sc1 lds
buffer_load_dwordx4 v0, s[4:7], s39 offen offset:3072 sc1 lds
s_add_u32 m0, s50, 16384
s_add_u32 s39, s54, 16384
buffer_load_dwordx4 v0, s[4:7], s39 offen offset:0 sc1 lds
buffer_load_dwordx4 v0, s[4:7], s39 offen offset:1024 sc1 lds
buffer_load_dwordx4 v0, s[4:7], s39 offen offset:2048 sc1 lds
buffer_load_dwordx4 v0, s[4:7], s39 offen offset:3072 sc1 lds
s_add_u32 m0, s50, 32768
s_add_u32 s39, s54, 32768
buffer_load_dwordx4 v0, s[4:7], s39 offen offset:0 sc1 lds
buffer_load_dwordx4 v0, s[4:7], s39 offen offset:1024 sc1 lds
buffer_load_dwordx4 v0, s[4:7], s39 offen offset:2048 sc1 lds
buffer_load_dwordx4 v0, s[4:7], s39 offen offset:3072 sc1 lds
s_add_u32 m0, s50, 49152
s_add_u32 s39, s54, 49152
buffer_load_dwordx4 v0, s[4:7], s39 offen offset:0 sc1 lds
buffer_load_dwordx4 v0, s[4:7], s39 offen offset:1024 sc1 lds
buffer_load_dwordx4 v0, s[4:7], s39 offen offset:2048 sc1 lds
buffer_load_dwordx4 v0, s[4:7], s39 offen offset:3072 sc1 lds
s_waitcnt vmcnt(16)
s_branch Lsj_591
Lsk_590:
s_waitcnt vmcnt(0)
Lsj_591:
s_barrier
s_and_b32 s38, s36, 1
s_lshl_b32 s38, s38, 12
buffer_store_dword v5, v4, s[4:7], s38 offen sc1
s_cmp_eq_u32 s36, 64
s_cbranch_scc1 Lso_589
s_cmp_lg_u32 s46, 0
s_cbranch_scc1 Lse_588
s_branch Lsw_587
Lso_589:
s_endpgm
Lhi_4:
s_cmp_ge_u32 s34, 16
s_cbranch_scc1 Lhelper_5
v_mov_b32 v9, v1
s_sub_u32 s44, s33, 4
s_lshl_b32 s44, s44, 4
s_add_u32 s44, s44, s34
s_lshl_b32 s38, s44, 7
s_add_u32 s38, s38, 3407872
v_min_u32 v80, 1, v0
v_lshl_add_u32 v4, v80, 30, s38
v_mov_b32 v5, 0
buffer_store_dword v5, v4, s[4:7], 0 offen sc1
s_mov_b32 s52, 1
s_waitcnt vmcnt(0)
s_cmp_lg_u32 s32, 0
s_cbranch_scc1 Lar_596
s_mov_b64 exec, 1
v_mov_b32 v48, 160
v_mov_b32 v49, s52
buffer_atomic_add v49, v48, s[12:15], 0 offen sc1
s_mov_b64 exec, -1
Lar_596:
s_mov_b32 s8, s18
s_and_b32 s9, s19, 0xffff
s_mov_b32 s10, 0x800000
s_mov_b32 s11, 0x20000
s_mov_b32 s84, s20
s_and_b32 s85, s21, 0xffff
s_mov_b32 s86, 0x800000
s_mov_b32 s87, 0x20000
s_mov_b32 s88, s22
s_and_b32 s89, s23, 0xffff
s_mov_b32 s90, 0x800000
s_mov_b32 s91, 0x20000
s_lshl_b32 s60, s44, 7
s_xor_b32 s61, s60, 512
s_xor_b32 s62, s60, 256
s_lshr_b32 s52, s32, 1
s_lshl_b32 s52, s52, 14
s_and_b32 s53, s32, 1
s_lshl_b32 s53, s53, 6
s_add_u32 s52, s52, s53
v_bfe_u32 v84, v9, 2, 2
v_lshrrev_b32 v85, 4, v9
v_lshl_add_u32 v84, v85, 3, v84
v_lshl_add_u32 v84, v84, 7, s52
v_and_b32 v85, 3, v9
v_lshl_add_u32 v84, v85, 3, v84
v_add_u32 v80, 0, v84
v_bfe_u32 v84, v9, 2, 2
v_lshrrev_b32 v85, 4, v9
v_lshl_add_u32 v84, v85, 3, v84
v_lshl_add_u32 v84, v84, 7, s52
v_and_b32 v85, 3, v9
v_lshl_add_u32 v84, v85, 3, v84
v_add_u32 v81, 32, v84
s_lshl_b32 s52, s32, 5
v_bfe_u32 v84, v9, 2, 2
v_lshrrev_b32 v85, 4, v9
v_lshl_add_u32 v84, v85, 3, v84
v_lshl_add_u32 v84, v84, 7, s52
v_and_b32 v85, 3, v9
v_lshl_add_u32 v84, v85, 3, v84
v_add_u32 v82, 32768, v84
v_lshrrev_b32 v84, 3, v9
s_mul_i32 s38, s32, 256
v_add_u32 v84, s38, v84
v_mul_u32_u24 v84, 8192, v84
v_and_b32 v85, 7, v9
v_lshl_add_u32 v84, v85, 4, v84
s_lshl_b32 s38, s32, 12
s_barrier
s_add_u32 m0, s38, 0
s_add_u32 s39, s60, 0
buffer_load_dwordx4 v84, s[8:11], s39 offen lds
s_add_u32 m0, s38, 1024
s_add_u32 s39, s60, 65536
buffer_load_dwordx4 v84, s[8:11], s39 offen lds
s_add_u32 m0, s38, 2048
s_add_u32 s39, s60, 131072
buffer_load_dwordx4 v84, s[8:11], s39 offen lds
s_add_u32 m0, s38, 3072
s_add_u32 s39, s60, 196608
buffer_load_dwordx4 v84, s[8:11], s39 offen lds
s_add_u32 m0, s38, 16384
s_add_u32 s39, s61, 0
buffer_load_dwordx4 v84, s[84:87], s39 offen lds
s_add_u32 m0, s38, 17408
s_add_u32 s39, s61, 65536
buffer_load_dwordx4 v84, s[84:87], s39 offen lds
s_add_u32 m0, s38, 18432
s_add_u32 s39, s61, 131072
buffer_load_dwordx4 v84, s[84:87], s39 offen lds
s_add_u32 m0, s38, 19456
s_add_u32 s39, s61, 196608
buffer_load_dwordx4 v84, s[84:87], s39 offen lds
s_add_u32 m0, s38, 32768
s_add_u32 s39, s62, 0
buffer_load_dwordx4 v84, s[88:91], s39 offen lds
s_add_u32 m0, s38, 33792
s_add_u32 s39, s62, 65536
buffer_load_dwordx4 v84, s[88:91], s39 offen lds
s_add_u32 m0, s38, 34816
s_add_u32 s39, s62, 131072
buffer_load_dwordx4 v84, s[88:91], s39 offen lds
s_add_u32 m0, s38, 35840
s_add_u32 s39, s62, 196608
buffer_load_dwordx4 v84, s[88:91], s39 offen lds
s_add_u32 m0, s38, 49152
s_add_u32 s39, s60, 262144
buffer_load_dwordx4 v84, s[8:11], s39 offen lds
s_add_u32 m0, s38, 50176
s_add_u32 s39, s60, 327680
buffer_load_dwordx4 v84, s[8:11], s39 offen lds
s_add_u32 m0, s38, 51200
s_add_u32 s39, s60, 393216
buffer_load_dwordx4 v84, s[8:11], s39 offen lds
s_add_u32 m0, s38, 52224
s_add_u32 s39, s60, 458752
buffer_load_dwordx4 v84, s[8:11], s39 offen lds
s_add_u32 m0, s38, 65536
s_add_u32 s39, s61, 262144
buffer_load_dwordx4 v84, s[84:87], s39 offen lds
s_add_u32 m0, s38, 66560
s_add_u32 s39, s61, 327680
buffer_load_dwordx4 v84, s[84:87], s39 offen lds
s_add_u32 m0, s38, 67584
s_add_u32 s39, s61, 393216
buffer_load_dwordx4 v84, s[84:87], s39 offen lds
s_add_u32 m0, s38, 68608
s_add_u32 s39, s61, 458752
buffer_load_dwordx4 v84, s[84:87], s39 offen lds
s_add_u32 m0, s38, 81920
s_add_u32 s39, s62, 262144
buffer_load_dwordx4 v84, s[88:91], s39 offen lds
s_add_u32 m0, s38, 82944
s_add_u32 s39, s62, 327680
buffer_load_dwordx4 v84, s[88:91], s39 offen lds
s_add_u32 m0, s38, 83968
s_add_u32 s39, s62, 393216
buffer_load_dwordx4 v84, s[88:91], s39 offen lds
s_add_u32 m0, s38, 84992
s_add_u32 s39, s62, 458752
buffer_load_dwordx4 v84, s[88:91], s39 offen lds
s_add_u32 m0, s38, 98304
s_add_u32 s39, s60, 524288
buffer_load_dwordx4 v84, s[8:11], s39 offen lds
s_add_u32 m0, s38, 99328
s_add_u32 s39, s60, 589824
buffer_load_dwordx4 v84, s[8:11], s39 offen lds
s_add_u32 m0, s38, 100352
s_add_u32 s39, s60, 655360
buffer_load_dwordx4 v84, s[8:11], s39 offen lds
s_add_u32 m0, s38, 101376
s_add_u32 s39, s60, 720896
buffer_load_dwordx4 v84, s[8:11], s39 offen lds
s_add_u32 m0, s38, 114688
s_add_u32 s39, s61, 524288
buffer_load_dwordx4 v84, s[84:87], s39 offen lds
s_add_u32 m0, s38, 115712
s_add_u32 s39, s61, 589824
buffer_load_dwordx4 v84, s[84:87], s39 offen lds
s_add_u32 m0, s38, 116736
s_add_u32 s39, s61, 655360
buffer_load_dwordx4 v84, s[84:87], s39 offen lds
s_add_u32 m0, s38, 117760
s_add_u32 s39, s61, 720896
buffer_load_dwordx4 v84, s[84:87], s39 offen lds
s_add_u32 m0, s38, 131072
s_add_u32 s39, s62, 524288
buffer_load_dwordx4 v84, s[88:91], s39 offen lds
s_add_u32 m0, s38, 132096
s_add_u32 s39, s62, 589824
buffer_load_dwordx4 v84, s[88:91], s39 offen lds
s_add_u32 m0, s38, 133120
s_add_u32 s39, s62, 655360
buffer_load_dwordx4 v84, s[88:91], s39 offen lds
s_add_u32 m0, s38, 134144
s_add_u32 s39, s62, 720896
buffer_load_dwordx4 v84, s[88:91], s39 offen lds
s_waitcnt vmcnt(24)
s_barrier
ds_read_b64_tr_b16 a[0:1], v80 offset:0
ds_read_b64_tr_b16 a[2:3], v80 offset:512
ds_read_b64_tr_b16 a[32:33], v80 offset:4096
ds_read_b64_tr_b16 a[34:35], v80 offset:4608
ds_read_b64_tr_b16 a[64:65], v80 offset:8192
ds_read_b64_tr_b16 a[66:67], v80 offset:8704
ds_read_b64_tr_b16 a[96:97], v80 offset:12288
ds_read_b64_tr_b16 a[98:99], v80 offset:12800
ds_read_b64_tr_b16 a[128:129], v81 offset:0
ds_read_b64_tr_b16 a[130:131], v81 offset:512
ds_read_b64_tr_b16 a[160:161], v81 offset:4096
ds_read_b64_tr_b16 a[162:163], v81 offset:4608
ds_read_b64_tr_b16 a[192:193], v81 offset:8192
ds_read_b64_tr_b16 a[194:195], v81 offset:8704
ds_read_b64_tr_b16 a[224:225], v81 offset:12288
ds_read_b64_tr_b16 a[226:227], v81 offset:12800
ds_read_b64_tr_b16 v[128:129], v82 offset:0
ds_read_b64_tr_b16 v[130:131], v82 offset:512
ds_read_b64_tr_b16 v[160:161], v82 offset:4096
ds_read_b64_tr_b16 v[162:163], v82 offset:4608
ds_read_b64_tr_b16 v[192:193], v82 offset:8192
ds_read_b64_tr_b16 v[194:195], v82 offset:8704
ds_read_b64_tr_b16 v[224:225], v82 offset:12288
ds_read_b64_tr_b16 v[226:227], v82 offset:12800
v_add_u32 v80, 49152, v80
v_add_u32 v81, 49152, v81
v_add_u32 v82, 49152, v82
s_waitcnt lgkmcnt(0)
s_barrier
s_add_u32 m0, s38, 0
s_add_u32 s39, s60, 786432
buffer_load_dwordx4 v84, s[8:11], s39 offen lds
s_add_u32 m0, s38, 1024
s_add_u32 s39, s60, 851968
buffer_load_dwordx4 v84, s[8:11], s39 offen lds
s_add_u32 m0, s38, 2048
s_add_u32 s39, s60, 917504
buffer_load_dwordx4 v84, s[8:11], s39 offen lds
s_add_u32 m0, s38, 3072
s_add_u32 s39, s60, 983040
buffer_load_dwordx4 v84, s[8:11], s39 offen lds
s_add_u32 m0, s38, 16384
s_add_u32 s39, s61, 786432
buffer_load_dwordx4 v84, s[84:87], s39 offen lds
s_add_u32 m0, s38, 17408
s_add_u32 s39, s61, 851968
buffer_load_dwordx4 v84, s[84:87], s39 offen lds
s_add_u32 m0, s38, 18432
s_add_u32 s39, s61, 917504
buffer_load_dwordx4 v84, s[84:87], s39 offen lds
s_add_u32 m0, s38, 19456
s_add_u32 s39, s61, 983040
buffer_load_dwordx4 v84, s[84:87], s39 offen lds
s_add_u32 m0, s38, 32768
s_add_u32 s39, s62, 786432
buffer_load_dwordx4 v84, s[88:91], s39 offen lds
s_add_u32 m0, s38, 33792
s_add_u32 s39, s62, 851968
buffer_load_dwordx4 v84, s[88:91], s39 offen lds
s_add_u32 m0, s38, 34816
s_add_u32 s39, s62, 917504
buffer_load_dwordx4 v84, s[88:91], s39 offen lds
s_add_u32 m0, s38, 35840
s_add_u32 s39, s62, 983040
buffer_load_dwordx4 v84, s[88:91], s39 offen lds
s_waitcnt vmcnt(24)
s_barrier
ds_read_b64_tr_b16 a[4:5], v80 offset:0
ds_read_b64_tr_b16 a[6:7], v80 offset:512
ds_read_b64_tr_b16 a[36:37], v80 offset:4096
ds_read_b64_tr_b16 a[38:39], v80 offset:4608
ds_read_b64_tr_b16 a[68:69], v80 offset:8192
ds_read_b64_tr_b16 a[70:71], v80 offset:8704
ds_read_b64_tr_b16 a[100:101], v80 offset:12288
ds_read_b64_tr_b16 a[102:103], v80 offset:12800
ds_read_b64_tr_b16 a[132:133], v81 offset:0
ds_read_b64_tr_b16 a[134:135], v81 offset:512
ds_read_b64_tr_b16 a[164:165], v81 offset:4096
ds_read_b64_tr_b16 a[166:167], v81 offset:4608
ds_read_b64_tr_b16 a[196:197], v81 offset:8192
ds_read_b64_tr_b16 a[198:199], v81 offset:8704
ds_read_b64_tr_b16 a[228:229], v81 offset:12288
ds_read_b64_tr_b16 a[230:231], v81 offset:12800
ds_read_b64_tr_b16 v[132:133], v82 offset:0
ds_read_b64_tr_b16 v[134:135], v82 offset:512
ds_read_b64_tr_b16 v[164:165], v82 offset:4096
ds_read_b64_tr_b16 v[166:167], v82 offset:4608
ds_read_b64_tr_b16 v[196:197], v82 offset:8192
ds_read_b64_tr_b16 v[198:199], v82 offset:8704
ds_read_b64_tr_b16 v[228:229], v82 offset:12288
ds_read_b64_tr_b16 v[230:231], v82 offset:12800
v_add_u32 v80, 49152, v80
v_add_u32 v81, 49152, v81
v_add_u32 v82, 49152, v82
s_waitcnt lgkmcnt(0)
s_barrier
s_add_u32 m0, s38, 49152
s_add_u32 s39, s60, 1048576
buffer_load_dwordx4 v84, s[8:11], s39 offen lds
s_add_u32 m0, s38, 50176
s_add_u32 s39, s60, 1114112
buffer_load_dwordx4 v84, s[8:11], s39 offen lds
s_add_u32 m0, s38, 51200
s_add_u32 s39, s60, 1179648
buffer_load_dwordx4 v84, s[8:11], s39 offen lds
s_add_u32 m0, s38, 52224
s_add_u32 s39, s60, 1245184
buffer_load_dwordx4 v84, s[8:11], s39 offen lds
s_add_u32 m0, s38, 65536
s_add_u32 s39, s61, 1048576
buffer_load_dwordx4 v84, s[84:87], s39 offen lds
s_add_u32 m0, s38, 66560
s_add_u32 s39, s61, 1114112
buffer_load_dwordx4 v84, s[84:87], s39 offen lds
s_add_u32 m0, s38, 67584
s_add_u32 s39, s61, 1179648
buffer_load_dwordx4 v84, s[84:87], s39 offen lds
s_add_u32 m0, s38, 68608
s_add_u32 s39, s61, 1245184
buffer_load_dwordx4 v84, s[84:87], s39 offen lds
s_add_u32 m0, s38, 81920
s_add_u32 s39, s62, 1048576
buffer_load_dwordx4 v84, s[88:91], s39 offen lds
s_add_u32 m0, s38, 82944
s_add_u32 s39, s62, 1114112
buffer_load_dwordx4 v84, s[88:91], s39 offen lds
s_add_u32 m0, s38, 83968
s_add_u32 s39, s62, 1179648
buffer_load_dwordx4 v84, s[88:91], s39 offen lds
s_add_u32 m0, s38, 84992
s_add_u32 s39, s62, 1245184
buffer_load_dwordx4 v84, s[88:91], s39 offen lds
s_waitcnt vmcnt(24)
s_barrier
ds_read_b64_tr_b16 a[8:9], v80 offset:0
ds_read_b64_tr_b16 a[10:11], v80 offset:512
ds_read_b64_tr_b16 a[40:41], v80 offset:4096
ds_read_b64_tr_b16 a[42:43], v80 offset:4608
ds_read_b64_tr_b16 a[72:73], v80 offset:8192
ds_read_b64_tr_b16 a[74:75], v80 offset:8704
ds_read_b64_tr_b16 a[104:105], v80 offset:12288
ds_read_b64_tr_b16 a[106:107], v80 offset:12800
ds_read_b64_tr_b16 a[136:137], v81 offset:0
ds_read_b64_tr_b16 a[138:139], v81 offset:512
ds_read_b64_tr_b16 a[168:169], v81 offset:4096
ds_read_b64_tr_b16 a[170:171], v81 offset:4608
ds_read_b64_tr_b16 a[200:201], v81 offset:8192
ds_read_b64_tr_b16 a[202:203], v81 offset:8704
ds_read_b64_tr_b16 a[232:233], v81 offset:12288
ds_read_b64_tr_b16 a[234:235], v81 offset:12800
ds_read_b64_tr_b16 v[136:137], v82 offset:0
ds_read_b64_tr_b16 v[138:139], v82 offset:512
ds_read_b64_tr_b16 v[168:169], v82 offset:4096
ds_read_b64_tr_b16 v[170:171], v82 offset:4608
ds_read_b64_tr_b16 v[200:201], v82 offset:8192
ds_read_b64_tr_b16 v[202:203], v82 offset:8704
ds_read_b64_tr_b16 v[232:233], v82 offset:12288
ds_read_b64_tr_b16 v[234:235], v82 offset:12800
v_add_u32 v80, -98304, v80
v_add_u32 v81, -98304, v81
v_add_u32 v82, -98304, v82
s_waitcnt lgkmcnt(0)
s_barrier
s_add_u32 m0, s38, 98304
s_add_u32 s39, s60, 1310720
buffer_load_dwordx4 v84, s[8:11], s39 offen lds
s_add_u32 m0, s38, 99328
s_add_u32 s39, s60, 1376256
buffer_load_dwordx4 v84, s[8:11], s39 offen lds
s_add_u32 m0, s38, 100352
s_add_u32 s39, s60, 1441792
buffer_load_dwordx4 v84, s[8:11], s39 offen lds
s_add_u32 m0, s38, 101376
s_add_u32 s39, s60, 1507328
buffer_load_dwordx4 v84, s[8:11], s39 offen lds
s_add_u32 m0, s38, 114688
s_add_u32 s39, s61, 1310720
buffer_load_dwordx4 v84, s[84:87], s39 offen lds
s_add_u32 m0, s38, 115712
s_add_u32 s39, s61, 1376256
buffer_load_dwordx4 v84, s[84:87], s39 offen lds
s_add_u32 m0, s38, 116736
s_add_u32 s39, s61, 1441792
buffer_load_dwordx4 v84, s[84:87], s39 offen lds
s_add_u32 m0, s38, 117760
s_add_u32 s39, s61, 1507328
buffer_load_dwordx4 v84, s[84:87], s39 offen lds
s_add_u32 m0, s38, 131072
s_add_u32 s39, s62, 1310720
buffer_load_dwordx4 v84, s[88:91], s39 offen lds
s_add_u32 m0, s38, 132096
s_add_u32 s39, s62, 1376256
buffer_load_dwordx4 v84, s[88:91], s39 offen lds
s_add_u32 m0, s38, 133120
s_add_u32 s39, s62, 1441792
buffer_load_dwordx4 v84, s[88:91], s39 offen lds
s_add_u32 m0, s38, 134144
s_add_u32 s39, s62, 1507328
buffer_load_dwordx4 v84, s[88:91], s39 offen lds
s_waitcnt vmcnt(24)
s_barrier
ds_read_b64_tr_b16 a[12:13], v80 offset:0
ds_read_b64_tr_b16 a[14:15], v80 offset:512
ds_read_b64_tr_b16 a[44:45], v80 offset:4096
ds_read_b64_tr_b16 a[46:47], v80 offset:4608
ds_read_b64_tr_b16 a[76:77], v80 offset:8192
ds_read_b64_tr_b16 a[78:79], v80 offset:8704
ds_read_b64_tr_b16 a[108:109], v80 offset:12288
ds_read_b64_tr_b16 a[110:111], v80 offset:12800
ds_read_b64_tr_b16 a[140:141], v81 offset:0
ds_read_b64_tr_b16 a[142:143], v81 offset:512
ds_read_b64_tr_b16 a[172:173], v81 offset:4096
ds_read_b64_tr_b16 a[174:175], v81 offset:4608
ds_read_b64_tr_b16 a[204:205], v81 offset:8192
ds_read_b64_tr_b16 a[206:207], v81 offset:8704
ds_read_b64_tr_b16 a[236:237], v81 offset:12288
ds_read_b64_tr_b16 a[238:239], v81 offset:12800
ds_read_b64_tr_b16 v[140:141], v82 offset:0
ds_read_b64_tr_b16 v[142:143], v82 offset:512
ds_read_b64_tr_b16 v[172:173], v82 offset:4096
ds_read_b64_tr_b16 v[174:175], v82 offset:4608
ds_read_b64_tr_b16 v[204:205], v82 offset:8192
ds_read_b64_tr_b16 v[206:207], v82 offset:8704
ds_read_b64_tr_b16 v[236:237], v82 offset:12288
ds_read_b64_tr_b16 v[238:239], v82 offset:12800
v_add_u32 v80, 49152, v80
v_add_u32 v81, 49152, v81
v_add_u32 v82, 49152, v82
s_waitcnt lgkmcnt(0)
s_barrier
s_add_u32 m0, s38, 0
s_add_u32 s39, s60, 1572864
buffer_load_dwordx4 v84, s[8:11], s39 offen lds
s_add_u32 m0, s38, 1024
s_add_u32 s39, s60, 1638400
buffer_load_dwordx4 v84, s[8:11], s39 offen lds
s_add_u32 m0, s38, 2048
s_add_u32 s39, s60, 1703936
buffer_load_dwordx4 v84, s[8:11], s39 offen lds
s_add_u32 m0, s38, 3072
s_add_u32 s39, s60, 1769472
buffer_load_dwordx4 v84, s[8:11], s39 offen lds
s_add_u32 m0, s38, 16384
s_add_u32 s39, s61, 1572864
buffer_load_dwordx4 v84, s[84:87], s39 offen lds
s_add_u32 m0, s38, 17408
s_add_u32 s39, s61, 1638400
buffer_load_dwordx4 v84, s[84:87], s39 offen lds
s_add_u32 m0, s38, 18432
s_add_u32 s39, s61, 1703936
buffer_load_dwordx4 v84, s[84:87], s39 offen lds
s_add_u32 m0, s38, 19456
s_add_u32 s39, s61, 1769472
buffer_load_dwordx4 v84, s[84:87], s39 offen lds
s_add_u32 m0, s38, 32768
s_add_u32 s39, s62, 1572864
buffer_load_dwordx4 v84, s[88:91], s39 offen lds
s_add_u32 m0, s38, 33792
s_add_u32 s39, s62, 1638400
buffer_load_dwordx4 v84, s[88:91], s39 offen lds
s_add_u32 m0, s38, 34816
s_add_u32 s39, s62, 1703936
buffer_load_dwordx4 v84, s[88:91], s39 offen lds
s_add_u32 m0, s38, 35840
s_add_u32 s39, s62, 1769472
buffer_load_dwordx4 v84, s[88:91], s39 offen lds
s_waitcnt vmcnt(24)
s_barrier
ds_read_b64_tr_b16 a[16:17], v80 offset:0
ds_read_b64_tr_b16 a[18:19], v80 offset:512
ds_read_b64_tr_b16 a[48:49], v80 offset:4096
ds_read_b64_tr_b16 a[50:51], v80 offset:4608
ds_read_b64_tr_b16 a[80:81], v80 offset:8192
ds_read_b64_tr_b16 a[82:83], v80 offset:8704
ds_read_b64_tr_b16 a[112:113], v80 offset:12288
ds_read_b64_tr_b16 a[114:115], v80 offset:12800
ds_read_b64_tr_b16 a[144:145], v81 offset:0
ds_read_b64_tr_b16 a[146:147], v81 offset:512
ds_read_b64_tr_b16 a[176:177], v81 offset:4096
ds_read_b64_tr_b16 a[178:179], v81 offset:4608
ds_read_b64_tr_b16 a[208:209], v81 offset:8192
ds_read_b64_tr_b16 a[210:211], v81 offset:8704
ds_read_b64_tr_b16 a[240:241], v81 offset:12288
ds_read_b64_tr_b16 a[242:243], v81 offset:12800
ds_read_b64_tr_b16 v[144:145], v82 offset:0
ds_read_b64_tr_b16 v[146:147], v82 offset:512
ds_read_b64_tr_b16 v[176:177], v82 offset:4096
ds_read_b64_tr_b16 v[178:179], v82 offset:4608
ds_read_b64_tr_b16 v[208:209], v82 offset:8192
ds_read_b64_tr_b16 v[210:211], v82 offset:8704
ds_read_b64_tr_b16 v[240:241], v82 offset:12288
ds_read_b64_tr_b16 v[242:243], v82 offset:12800
v_add_u32 v80, 49152, v80
v_add_u32 v81, 49152, v81
v_add_u32 v82, 49152, v82
s_waitcnt lgkmcnt(0)
s_barrier
s_add_u32 m0, s38, 49152
s_add_u32 s39, s60, 1835008
buffer_load_dwordx4 v84, s[8:11], s39 offen lds
s_add_u32 m0, s38, 50176
s_add_u32 s39, s60, 1900544
buffer_load_dwordx4 v84, s[8:11], s39 offen lds
s_add_u32 m0, s38, 51200
s_add_u32 s39, s60, 1966080
buffer_load_dwordx4 v84, s[8:11], s39 offen lds
s_add_u32 m0, s38, 52224
s_add_u32 s39, s60, 2031616
buffer_load_dwordx4 v84, s[8:11], s39 offen lds
s_add_u32 m0, s38, 65536
s_add_u32 s39, s61, 1835008
buffer_load_dwordx4 v84, s[84:87], s39 offen lds
s_add_u32 m0, s38, 66560
s_add_u32 s39, s61, 1900544
buffer_load_dwordx4 v84, s[84:87], s39 offen lds
s_add_u32 m0, s38, 67584
s_add_u32 s39, s61, 1966080
buffer_load_dwordx4 v84, s[84:87], s39 offen lds
s_add_u32 m0, s38, 68608
s_add_u32 s39, s61, 2031616
buffer_load_dwordx4 v84, s[84:87], s39 offen lds
s_add_u32 m0, s38, 81920
s_add_u32 s39, s62, 1835008
buffer_load_dwordx4 v84, s[88:91], s39 offen lds
s_add_u32 m0, s38, 82944
s_add_u32 s39, s62, 1900544
buffer_load_dwordx4 v84, s[88:91], s39 offen lds
s_add_u32 m0, s38, 83968
s_add_u32 s39, s62, 1966080
buffer_load_dwordx4 v84, s[88:91], s39 offen lds
s_add_u32 m0, s38, 84992
s_add_u32 s39, s62, 2031616
buffer_load_dwordx4 v84, s[88:91], s39 offen lds
s_waitcnt vmcnt(24)
s_barrier
ds_read_b64_tr_b16 a[20:21], v80 offset:0
ds_read_b64_tr_b16 a[22:23], v80 offset:512
ds_read_b64_tr_b16 a[52:53], v80 offset:4096
ds_read_b64_tr_b16 a[54:55], v80 offset:4608
ds_read_b64_tr_b16 a[84:85], v80 offset:8192
ds_read_b64_tr_b16 a[86:87], v80 offset:8704
ds_read_b64_tr_b16 a[116:117], v80 offset:12288
ds_read_b64_tr_b16 a[118:119], v80 offset:12800
ds_read_b64_tr_b16 a[148:149], v81 offset:0
ds_read_b64_tr_b16 a[150:151], v81 offset:512
ds_read_b64_tr_b16 a[180:181], v81 offset:4096
ds_read_b64_tr_b16 a[182:183], v81 offset:4608
ds_read_b64_tr_b16 a[212:213], v81 offset:8192
ds_read_b64_tr_b16 a[214:215], v81 offset:8704
ds_read_b64_tr_b16 a[244:245], v81 offset:12288
ds_read_b64_tr_b16 a[246:247], v81 offset:12800
ds_read_b64_tr_b16 v[148:149], v82 offset:0
ds_read_b64_tr_b16 v[150:151], v82 offset:512
ds_read_b64_tr_b16 v[180:181], v82 offset:4096
ds_read_b64_tr_b16 v[182:183], v82 offset:4608
ds_read_b64_tr_b16 v[212:213], v82 offset:8192
ds_read_b64_tr_b16 v[214:215], v82 offset:8704
ds_read_b64_tr_b16 v[244:245], v82 offset:12288
ds_read_b64_tr_b16 v[246:247], v82 offset:12800
v_add_u32 v80, -98304, v80
v_add_u32 v81, -98304, v81
v_add_u32 v82, -98304, v82
s_waitcnt lgkmcnt(0)
s_barrier
s_waitcnt vmcnt(12)
s_barrier
ds_read_b64_tr_b16 a[24:25], v80 offset:0
ds_read_b64_tr_b16 a[26:27], v80 offset:512
ds_read_b64_tr_b16 a[56:57], v80 offset:4096
ds_read_b64_tr_b16 a[58:59], v80 offset:4608
ds_read_b64_tr_b16 a[88:89], v80 offset:8192
ds_read_b64_tr_b16 a[90:91], v80 offset:8704
ds_read_b64_tr_b16 a[120:121], v80 offset:12288
ds_read_b64_tr_b16 a[122:123], v80 offset:12800
ds_read_b64_tr_b16 a[152:153], v81 offset:0
ds_read_b64_tr_b16 a[154:155], v81 offset:512
ds_read_b64_tr_b16 a[184:185], v81 offset:4096
ds_read_b64_tr_b16 a[186:187], v81 offset:4608
ds_read_b64_tr_b16 a[216:217], v81 offset:8192
ds_read_b64_tr_b16 a[218:219], v81 offset:8704
ds_read_b64_tr_b16 a[248:249], v81 offset:12288
ds_read_b64_tr_b16 a[250:251], v81 offset:12800
ds_read_b64_tr_b16 v[152:153], v82 offset:0
ds_read_b64_tr_b16 v[154:155], v82 offset:512
ds_read_b64_tr_b16 v[184:185], v82 offset:4096
ds_read_b64_tr_b16 v[186:187], v82 offset:4608
ds_read_b64_tr_b16 v[216:217], v82 offset:8192
ds_read_b64_tr_b16 v[218:219], v82 offset:8704
ds_read_b64_tr_b16 v[248:249], v82 offset:12288
ds_read_b64_tr_b16 v[250:251], v82 offset:12800
v_add_u32 v80, 49152, v80
v_add_u32 v81, 49152, v81
v_add_u32 v82, 49152, v82
s_waitcnt lgkmcnt(0)
s_barrier
s_waitcnt vmcnt(0)
s_barrier
ds_read_b64_tr_b16 a[28:29], v80 offset:0
ds_read_b64_tr_b16 a[30:31], v80 offset:512
ds_read_b64_tr_b16 a[60:61], v80 offset:4096
ds_read_b64_tr_b16 a[62:63], v80 offset:4608
ds_read_b64_tr_b16 a[92:93], v80 offset:8192
ds_read_b64_tr_b16 a[94:95], v80 offset:8704
ds_read_b64_tr_b16 a[124:125], v80 offset:12288
ds_read_b64_tr_b16 a[126:127], v80 offset:12800
ds_read_b64_tr_b16 a[156:157], v81 offset:0
ds_read_b64_tr_b16 a[158:159], v81 offset:512
ds_read_b64_tr_b16 a[188:189], v81 offset:4096
ds_read_b64_tr_b16 a[190:191], v81 offset:4608
ds_read_b64_tr_b16 a[220:221], v81 offset:8192
ds_read_b64_tr_b16 a[222:223], v81 offset:8704
ds_read_b64_tr_b16 a[252:253], v81 offset:12288
ds_read_b64_tr_b16 a[254:255], v81 offset:12800
ds_read_b64_tr_b16 v[156:157], v82 offset:0
ds_read_b64_tr_b16 v[158:159], v82 offset:512
ds_read_b64_tr_b16 v[188:189], v82 offset:4096
ds_read_b64_tr_b16 v[190:191], v82 offset:4608
ds_read_b64_tr_b16 v[220:221], v82 offset:8192
ds_read_b64_tr_b16 v[222:223], v82 offset:8704
ds_read_b64_tr_b16 v[252:253], v82 offset:12288
ds_read_b64_tr_b16 v[254:255], v82 offset:12800
v_add_u32 v80, 49152, v80
v_add_u32 v81, 49152, v81
v_add_u32 v82, 49152, v82
s_waitcnt lgkmcnt(0)
s_barrier
Lst_597:
buffer_load_dword v48, off, s[12:15], 0 offset:160 sc1
buffer_load_dword v49, off, s[12:15], 0 offset:160 sc1
s_waitcnt vmcnt(0)
v_add_u32 v48, v48, v49
s_nop 0
v_readfirstlane_b32 s38, v48
s_nop 3
s_and_b32 s39, s38, 0xffff
s_cmp_eq_u32 s39, 0x100
s_cbranch_scc1 Lso_598
s_sub_u32 s37, s37, 1
s_cbranch_scc1 Lend_7
s_sleep 8
s_branch Lst_597
Lso_598:
s_bfe_u32 s35, s38, 0x80010
s_bfe_u32 s46, s38, 0x10018
s_lshl_b32 s46, s46, 13
s_barrier
s_mul_i32 s50, s32, 4096
v_lshlrev_b32 v1, 4, v9
v_add_u32 v0, s50, v1
v_min_u32 v2, 1, v9
v_lshlrev_b32 v2, 7, v2
s_and_b32 s52, s44, 1
s_lshr_b32 s38, s32, 1
s_lshl_b32 s38, s38, 3
s_and_b32 s39, s32, 1
s_add_u32 s38, s38, s39
s_lshl_b32 s39, s52, 1
s_add_u32 s38, s38, s39
s_lshl_b32 s38, s38, 10
s_lshr_b32 s53, s44, 1
s_and_b32 s39, s32, 2
s_xor_b32 s39, s39, s53
s_mul_i32 s39, s39, 24576
s_add_u32 s38, s38, s39
v_add_u32 v6, s38, v1
v_add_u32 v7, 4096, v6
s_lshl_b32 s38, s52, 2
s_add_u32 s38, s38, s32
s_add_u32 s38, s38, 16
s_lshl_b32 s38, s38, 10
s_xor_b32 s39, s53, 1
s_mul_i32 s39, s39, 24576
s_add_u32 s38, s38, s39
v_add_u32 v8, s38, v1
s_mov_b32 s49, 32768000
s_mov_b32 s54, 8388608
s_mov_b32 s36, 0
s_add_u32 s48, s36, 0
s_and_b32 s47, s48, 31
s_lshl_b32 s47, s47, 8
s_add_u32 s47, s47, 3424256
s_lshr_b32 s48, s48, 5
s_lshl_b32 s48, 1, s48
s_add_u32 s48, s48, 1
Lsw_599:
Lbw_604:
buffer_load_dword v3, v2, s[4:7], s47 offen sc1
s_waitcnt vmcnt(0)
v_cmp_gt_u32 vcc, s48, v3
s_cbranch_vccz Lbo_605
s_sub_u32 s37, s37, 1
s_cbranch_scc1 Lend_7
s_sleep 1
s_branch Lbw_604
Lbo_605:
s_add_u32 m0, s50, 0
s_add_u32 s39, s54, 0
buffer_load_dwordx4 v0, s[4:7], s39 offen offset:0 sc1 lds
buffer_load_dwordx4 v0, s[4:7], s39 offen offset:1024 sc1 lds
buffer_load_dwordx4 v0, s[4:7], s39 offen offset:2048 sc1 lds
buffer_load_dwordx4 v0, s[4:7], s39 offen offset:3072 sc1 lds
s_add_u32 m0, s50, 16384
s_add_u32 s39, s54, 16384
buffer_load_dwordx4 v0, s[4:7], s39 offen offset:0 sc1 lds
buffer_load_dwordx4 v0, s[4:7], s39 offen offset:1024 sc1 lds
buffer_load_dwordx4 v0, s[4:7], s39 offen offset:2048 sc1 lds
buffer_load_dwordx4 v0, s[4:7], s39 offen offset:3072 sc1 lds
s_add_u32 m0, s50, 32768
s_add_u32 s39, s54, 32768
buffer_load_dwordx4 v0, s[4:7], s39 offen offset:0 sc1 lds
buffer_load_dwordx4 v0, s[4:7], s39 offen offset:1024 sc1 lds
buffer_load_dwordx4 v0, s[4:7], s39 offen offset:2048 sc1 lds
buffer_load_dwordx4 v0, s[4:7], s39 offen offset:3072 sc1 lds
s_add_u32 m0, s50, 49152
s_add_u32 s39, s54, 49152
buffer_load_dwordx4 v0, s[4:7], s39 offen offset:0 sc1 lds
buffer_load_dwordx4 v0, s[4:7], s39 offen offset:1024 sc1 lds
buffer_load_dwordx4 v0, s[4:7], s39 offen offset:2048 sc1 lds
buffer_load_dwordx4 v0, s[4:7], s39 offen offset:3072 sc1 lds
buffer_load_dword v3, v2, s[4:7], s47 offen sc1
Lse_600:
s_waitcnt vmcnt(13)
s_barrier
ds_read_b128 v[16:19], v1 offset:0
ds_read_b128 v[20:23], v1 offset:1024
ds_read_b128 v[24:27], v1 offset:2048
ds_read_b128 v[28:31], v1 offset:3072
ds_read_b128 v[32:35], v1 offset:4096
ds_read_b128 v[36:39], v1 offset:5120
ds_read_b128 v[40:43], v1 offset:6144
s_add_u32 s54, s54, 65536
s_xor_b32 s50, s50, 0x10000
s_add_u32 s49, s49, 786432
s_add_u32 s36, s36, 1
s_add_u32 s48, s36, 0
s_and_b32 s47, s48, 31
s_lshl_b32 s47, s47, 8
s_add_u32 s47, s47, 3424256
s_lshr_b32 s48, s48, 5
s_lshl_b32 s48, 1, s48
s_add_u32 s48, s48, 1
s_waitcnt lgkmcnt(5)
v_mfma_f32_16x16x32_bf16 v[48:51], a[0:3], v[16:19], 0
ds_read_b128 v[44:47], v1 offset:7168
v_mfma_f32_16x16x32_bf16 v[52:55], a[128:131], v[16:19], 0
v_mfma_f32_16x16x32_bf16 v[64:67], v[16:19], v[128:131], 0
v_mfma_f32_16x16x32_bf16 v[56:59], a[0:3], v[20:23], 0
ds_read_b128 v[16:19], v1 offset:8192
v_mfma_f32_16x16x32_bf16 v[60:63], a[128:131], v[20:23], 0
v_mfma_f32_16x16x32_bf16 v[68:71], v[20:23], v[128:131], 0
s_waitcnt lgkmcnt(5)
v_mfma_f32_16x16x32_bf16 v[48:51], a[4:7], v[24:27], v[48:51]
ds_read_b128 v[20:23], v1 offset:9216
v_mfma_f32_16x16x32_bf16 v[52:55], a[132:135], v[24:27], v[52:55]
v_mfma_f32_16x16x32_bf16 v[64:67], v[24:27], v[132:135], v[64:67]
v_mfma_f32_16x16x32_bf16 v[56:59], a[4:7], v[28:31], v[56:59]
ds_read_b128 v[24:27], v1 offset:10240
v_mfma_f32_16x16x32_bf16 v[60:63], a[132:135], v[28:31], v[60:63]
v_mfma_f32_16x16x32_bf16 v[68:71], v[28:31], v[132:135], v[68:71]
s_waitcnt lgkmcnt(5)
v_mfma_f32_16x16x32_bf16 v[48:51], a[8:11], v[32:35], v[48:51]
ds_read_b128 v[28:31], v1 offset:11264
v_mfma_f32_16x16x32_bf16 v[52:55], a[136:139], v[32:35], v[52:55]
v_mfma_f32_16x16x32_bf16 v[64:67], v[32:35], v[136:139], v[64:67]
v_mfma_f32_16x16x32_bf16 v[56:59], a[8:11], v[36:39], v[56:59]
ds_read_b128 v[32:35], v1 offset:12288
v_mfma_f32_16x16x32_bf16 v[60:63], a[136:139], v[36:39], v[60:63]
v_mfma_f32_16x16x32_bf16 v[68:71], v[36:39], v[136:139], v[68:71]
s_waitcnt lgkmcnt(5)
v_mfma_f32_16x16x32_bf16 v[48:51], a[12:15], v[40:43], v[48:51]
ds_read_b128 v[36:39], v1 offset:13312
v_mfma_f32_16x16x32_bf16 v[52:55], a[140:143], v[40:43], v[52:55]
v_mfma_f32_16x16x32_bf16 v[64:67], v[40:43], v[140:143], v[64:67]
v_mfma_f32_16x16x32_bf16 v[56:59], a[12:15], v[44:47], v[56:59]
ds_read_b128 v[40:43], v1 offset:14336
v_mfma_f32_16x16x32_bf16 v[60:63], a[140:143], v[44:47], v[60:63]
v_mfma_f32_16x16x32_bf16 v[68:71], v[44:47], v[140:143], v[68:71]
s_waitcnt lgkmcnt(5)
v_mfma_f32_16x16x32_bf16 v[48:51], a[16:19], v[16:19], v[48:51]
ds_read_b128 v[44:47], v1 offset:15360
v_mfma_f32_16x16x32_bf16 v[52:55], a[144:147], v[16:19], v[52:55]
v_mfma_f32_16x16x32_bf16 v[64:67], v[16:19], v[144:147], v[64:67]
v_mfma_f32_16x16x32_bf16 v[56:59], a[16:19], v[20:23], v[56:59]
s_waitcnt vmcnt(9)
s_barrier
ds_read_b128 v[16:19], v1 offset:16384
v_mfma_f32_16x16x32_bf16 v[60:63], a[144:147], v[20:23], v[60:63]
v_mfma_f32_16x16x32_bf16 v[68:71], v[20:23], v[144:147], v[68:71]
s_waitcnt lgkmcnt(5)
v_mfma_f32_16x16x32_bf16 v[48:51], a[20:23], v[24:27], v[48:51]
ds_read_b128 v[20:23], v1 offset:17408
v_mfma_f32_16x16x32_bf16 v[52:55], a[148:151], v[24:27], v[52:55]
v_mfma_f32_16x16x32_bf16 v[64:67], v[24:27], v[148:151], v[64:67]
v_mfma_f32_16x16x32_bf16 v[56:59], a[20:23], v[28:31], v[56:59]
ds_read_b128 v[24:27], v1 offset:18432
v_mfma_f32_16x16x32_bf16 v[60:63], a[148:151], v[28:31], v[60:63]
v_mfma_f32_16x16x32_bf16 v[68:71], v[28:31], v[148:151], v[68:71]
s_waitcnt lgkmcnt(5)
v_mfma_f32_16x16x32_bf16 v[48:51], a[24:27], v[32:35], v[48:51]
ds_read_b128 v[28:31], v1 offset:19456
v_mfma_f32_16x16x32_bf16 v[52:55], a[152:155], v[32:35], v[52:55]
v_mfma_f32_16x16x32_bf16 v[64:67], v[32:35], v[152:155], v[64:67]
v_mfma_f32_16x16x32_bf16 v[56:59], a[24:27], v[36:39], v[56:59]
ds_read_b128 v[32:35], v1 offset:20480
v_mfma_f32_16x16x32_bf16 v[60:63], a[152:155], v[36:39], v[60:63]
v_mfma_f32_16x16x32_bf16 v[68:71], v[36:39], v[152:155], v[68:71]
s_waitcnt lgkmcnt(5)
v_mfma_f32_16x16x32_bf16 v[48:51], a[28:31], v[40:43], v[48:51]
ds_read_b128 v[36:39], v1 offset:21504
v_mfma_f32_16x16x32_bf16 v[52:55], a[156:159], v[40:43], v[52:55]
v_mfma_f32_16x16x32_bf16 v[64:67], v[40:43], v[156:159], v[64:67]
v_mfma_f32_16x16x32_bf16 v[56:59], a[28:31], v[44:47], v[56:59]
ds_read_b128 v[40:43], v1 offset:22528
v_mfma_f32_16x16x32_bf16 v[60:63], a[156:159], v[44:47], v[60:63]
v_mfma_f32_16x16x32_bf16 v[68:71], v[44:47], v[156:159], v[68:71]
s_waitcnt lgkmcnt(5)
v_mfma_f32_16x16x32_bf16 v[48:51], a[32:35], v[16:19], v[48:51]
ds_read_b128 v[44:47], v1 offset:23552
v_mfma_f32_16x16x32_bf16 v[52:55], a[160:163], v[16:19], v[52:55]
v_mfma_f32_16x16x32_bf16 v[64:67], v[16:19], v[160:163], v[64:67]
v_mfma_f32_16x16x32_bf16 v[56:59], a[32:35], v[20:23], v[56:59]
ds_read_b128 v[16:19], v1 offset:24576
v_mfma_f32_16x16x32_bf16 v[60:63], a[160:163], v[20:23], v[60:63]
v_mfma_f32_16x16x32_bf16 v[68:71], v[20:23], v[160:163], v[68:71]
s_waitcnt lgkmcnt(5)
v_mfma_f32_16x16x32_bf16 v[48:51], a[36:39], v[24:27], v[48:51]
ds_read_b128 v[20:23], v1 offset:25600
v_mfma_f32_16x16x32_bf16 v[52:55], a[164:167], v[24:27], v[52:55]
v_mfma_f32_16x16x32_bf16 v[64:67], v[24:27], v[164:167], v[64:67]
v_mfma_f32_16x16x32_bf16 v[56:59], a[36:39], v[28:31], v[56:59]
ds_read_b128 v[24:27], v1 offset:26624
v_mfma_f32_16x16x32_bf16 v[60:63], a[164:167], v[28:31], v[60:63]
v_mfma_f32_16x16x32_bf16 v[68:71], v[28:31], v[164:167], v[68:71]
s_waitcnt lgkmcnt(5)
v_mfma_f32_16x16x32_bf16 v[48:51], a[40:43], v[32:35], v[48:51]
ds_read_b128 v[28:31], v1 offset:27648
v_mfma_f32_16x16x32_bf16 v[52:55], a[168:171], v[32:35], v[52:55]
v_mfma_f32_16x16x32_bf16 v[64:67], v[32:35], v[168:171], v[64:67]
v_mfma_f32_16x16x32_bf16 v[56:59], a[40:43], v[36:39], v[56:59]
ds_read_b128 v[32:35], v1 offset:28672
v_mfma_f32_16x16x32_bf16 v[60:63], a[168:171], v[36:39], v[60:63]
v_mfma_f32_16x16x32_bf16 v[68:71], v[36:39], v[168:171], v[68:71]
s_waitcnt lgkmcnt(5)
v_mfma_f32_16x16x32_bf16 v[48:51], a[44:47], v[40:43], v[48:51]
ds_read_b128 v[36:39], v1 offset:29696
v_mfma_f32_16x16x32_bf16 v[52:55], a[172:175], v[40:43], v[52:55]
v_mfma_f32_16x16x32_bf16 v[64:67], v[40:43], v[172:175], v[64:67]
v_mfma_f32_16x16x32_bf16 v[56:59], a[44:47], v[44:47], v[56:59]
ds_read_b128 v[40:43], v1 offset:30720
v_mfma_f32_16x16x32_bf16 v[60:63], a[172:175], v[44:47], v[60:63]
v_mfma_f32_16x16x32_bf16 v[68:71], v[44:47], v[172:175], v[68:71]
s_waitcnt lgkmcnt(5)
v_mfma_f32_16x16x32_bf16 v[48:51], a[48:51], v[16:19], v[48:51]
ds_read_b128 v[44:47], v1 offset:31744
v_mfma_f32_16x16x32_bf16 v[52:55], a[176:179], v[16:19], v[52:55]
v_mfma_f32_16x16x32_bf16 v[64:67], v[16:19], v[176:179], v[64:67]
v_mfma_f32_16x16x32_bf16 v[56:59], a[48:51], v[20:23], v[56:59]
s_waitcnt vmcnt(5)
s_barrier
ds_read_b128 v[16:19], v1 offset:32768
v_mfma_f32_16x16x32_bf16 v[60:63], a[176:179], v[20:23], v[60:63]
v_mfma_f32_16x16x32_bf16 v[68:71], v[20:23], v[176:179], v[68:71]
s_waitcnt lgkmcnt(5)
v_mfma_f32_16x16x32_bf16 v[48:51], a[52:55], v[24:27], v[48:51]
ds_read_b128 v[20:23], v1 offset:33792
v_mfma_f32_16x16x32_bf16 v[52:55], a[180:183], v[24:27], v[52:55]
v_mfma_f32_16x16x32_bf16 v[64:67], v[24:27], v[180:183], v[64:67]
v_mfma_f32_16x16x32_bf16 v[56:59], a[52:55], v[28:31], v[56:59]
ds_read_b128 v[24:27], v1 offset:34816
v_mfma_f32_16x16x32_bf16 v[60:63], a[180:183], v[28:31], v[60:63]
v_mfma_f32_16x16x32_bf16 v[68:71], v[28:31], v[180:183], v[68:71]
s_waitcnt lgkmcnt(5)
v_mfma_f32_16x16x32_bf16 v[48:51], a[56:59], v[32:35], v[48:51]
ds_read_b128 v[28:31], v1 offset:35840
v_mfma_f32_16x16x32_bf16 v[52:55], a[184:187], v[32:35], v[52:55]
v_mfma_f32_16x16x32_bf16 v[64:67], v[32:35], v[184:187], v[64:67]
v_mfma_f32_16x16x32_bf16 v[56:59], a[56:59], v[36:39], v[56:59]
ds_read_b128 v[32:35], v1 offset:36864
v_mfma_f32_16x16x32_bf16 v[60:63], a[184:187], v[36:39], v[60:63]
v_mfma_f32_16x16x32_bf16 v[68:71], v[36:39], v[184:187], v[68:71]
s_waitcnt lgkmcnt(5)
v_mfma_f32_16x16x32_bf16 v[48:51], a[60:63], v[40:43], v[48:51]
ds_read_b128 v[36:39], v1 offset:37888
v_mfma_f32_16x16x32_bf16 v[52:55], a[188:191], v[40:43], v[52:55]
v_mfma_f32_16x16x32_bf16 v[64:67], v[40:43], v[188:191], v[64:67]
v_mfma_f32_16x16x32_bf16 v[56:59], a[60:63], v[44:47], v[56:59]
ds_read_b128 v[40:43], v1 offset:38912
v_mfma_f32_16x16x32_bf16 v[60:63], a[188:191], v[44:47], v[60:63]
v_mfma_f32_16x16x32_bf16 v[68:71], v[44:47], v[188:191], v[68:71]
s_waitcnt lgkmcnt(5)
v_mfma_f32_16x16x32_bf16 v[48:51], a[64:67], v[16:19], v[48:51]
ds_read_b128 v[44:47], v1 offset:39936
v_mfma_f32_16x16x32_bf16 v[52:55], a[192:195], v[16:19], v[52:55]
v_mfma_f32_16x16x32_bf16 v[64:67], v[16:19], v[192:195], v[64:67]
v_mfma_f32_16x16x32_bf16 v[56:59], a[64:67], v[20:23], v[56:59]
ds_read_b128 v[16:19], v1 offset:40960
v_mfma_f32_16x16x32_bf16 v[60:63], a[192:195], v[20:23], v[60:63]
v_mfma_f32_16x16x32_bf16 v[68:71], v[20:23], v[192:195], v[68:71]
s_waitcnt lgkmcnt(5)
v_mfma_f32_16x16x32_bf16 v[48:51], a[68:71], v[24:27], v[48:51]
ds_read_b128 v[20:23], v1 offset:41984
v_mfma_f32_16x16x32_bf16 v[52:55], a[196:199], v[24:27], v[52:55]
v_mfma_f32_16x16x32_bf16 v[64:67], v[24:27], v[196:199], v[64:67]
v_mfma_f32_16x16x32_bf16 v[56:59], a[68:71], v[28:31], v[56:59]
ds_read_b128 v[24:27], v1 offset:43008
v_mfma_f32_16x16x32_bf16 v[60:63], a[196:199], v[28:31], v[60:63]
v_mfma_f32_16x16x32_bf16 v[68:71], v[28:31], v[196:199], v[68:71]
s_waitcnt lgkmcnt(5)
v_mfma_f32_16x16x32_bf16 v[48:51], a[72:75], v[32:35], v[48:51]
ds_read_b128 v[28:31], v1 offset:44032
v_mfma_f32_16x16x32_bf16 v[52:55], a[200:203], v[32:35], v[52:55]
v_mfma_f32_16x16x32_bf16 v[64:67], v[32:35], v[200:203], v[64:67]
v_mfma_f32_16x16x32_bf16 v[56:59], a[72:75], v[36:39], v[56:59]
ds_read_b128 v[32:35], v1 offset:45056
v_mfma_f32_16x16x32_bf16 v[60:63], a[200:203], v[36:39], v[60:63]
v_mfma_f32_16x16x32_bf16 v[68:71], v[36:39], v[200:203], v[68:71]
s_waitcnt lgkmcnt(5)
v_mfma_f32_16x16x32_bf16 v[48:51], a[76:79], v[40:43], v[48:51]
ds_read_b128 v[36:39], v1 offset:46080
v_mfma_f32_16x16x32_bf16 v[52:55], a[204:207], v[40:43], v[52:55]
v_mfma_f32_16x16x32_bf16 v[64:67], v[40:43], v[204:207], v[64:67]
v_mfma_f32_16x16x32_bf16 v[56:59], a[76:79], v[44:47], v[56:59]
ds_read_b128 v[40:43], v1 offset:47104
v_mfma_f32_16x16x32_bf16 v[60:63], a[204:207], v[44:47], v[60:63]
v_mfma_f32_16x16x32_bf16 v[68:71], v[44:47], v[204:207], v[68:71]
s_waitcnt lgkmcnt(5)
v_mfma_f32_16x16x32_bf16 v[48:51], a[80:83], v[16:19], v[48:51]
ds_read_b128 v[44:47], v1 offset:48128
v_mfma_f32_16x16x32_bf16 v[52:55], a[208:211], v[16:19], v[52:55]
v_mfma_f32_16x16x32_bf16 v[64:67], v[16:19], v[208:211], v[64:67]
v_mfma_f32_16x16x32_bf16 v[56:59], a[80:83], v[20:23], v[56:59]
s_waitcnt vmcnt(1)
s_barrier
ds_read_b128 v[16:19], v1 offset:49152
v_mfma_f32_16x16x32_bf16 v[60:63], a[208:211], v[20:23], v[60:63]
v_mfma_f32_16x16x32_bf16 v[68:71], v[20:23], v[208:211], v[68:71]
s_waitcnt lgkmcnt(5)
v_mfma_f32_16x16x32_bf16 v[48:51], a[84:87], v[24:27], v[48:51]
ds_read_b128 v[20:23], v1 offset:50176
v_mfma_f32_16x16x32_bf16 v[52:55], a[212:215], v[24:27], v[52:55]
v_mfma_f32_16x16x32_bf16 v[64:67], v[24:27], v[212:215], v[64:67]
v_mfma_f32_16x16x32_bf16 v[56:59], a[84:87], v[28:31], v[56:59]
ds_read_b128 v[24:27], v1 offset:51200
v_mfma_f32_16x16x32_bf16 v[60:63], a[212:215], v[28:31], v[60:63]
v_mfma_f32_16x16x32_bf16 v[68:71], v[28:31], v[212:215], v[68:71]
s_waitcnt lgkmcnt(5)
v_mfma_f32_16x16x32_bf16 v[48:51], a[88:91], v[32:35], v[48:51]
ds_read_b128 v[28:31], v1 offset:52224
v_mfma_f32_16x16x32_bf16 v[52:55], a[216:219], v[32:35], v[52:55]
v_mfma_f32_16x16x32_bf16 v[64:67], v[32:35], v[216:219], v[64:67]
v_mfma_f32_16x16x32_bf16 v[56:59], a[88:91], v[36:39], v[56:59]
ds_read_b128 v[32:35], v1 offset:53248
v_mfma_f32_16x16x32_bf16 v[60:63], a[216:219], v[36:39], v[60:63]
v_mfma_f32_16x16x32_bf16 v[68:71], v[36:39], v[216:219], v[68:71]
s_waitcnt lgkmcnt(5)
v_mfma_f32_16x16x32_bf16 v[48:51], a[92:95], v[40:43], v[48:51]
ds_read_b128 v[36:39], v1 offset:54272
v_mfma_f32_16x16x32_bf16 v[52:55], a[220:223], v[40:43], v[52:55]
v_mfma_f32_16x16x32_bf16 v[64:67], v[40:43], v[220:223], v[64:67]
v_mfma_f32_16x16x32_bf16 v[56:59], a[92:95], v[44:47], v[56:59]
ds_read_b128 v[40:43], v1 offset:55296
v_mfma_f32_16x16x32_bf16 v[60:63], a[220:223], v[44:47], v[60:63]
v_mfma_f32_16x16x32_bf16 v[68:71], v[44:47], v[220:223], v[68:71]
s_waitcnt lgkmcnt(5)
v_mfma_f32_16x16x32_bf16 v[48:51], a[96:99], v[16:19], v[48:51]
ds_read_b128 v[44:47], v1 offset:56320
v_mfma_f32_16x16x32_bf16 v[52:55], a[224:227], v[16:19], v[52:55]
v_mfma_f32_16x16x32_bf16 v[64:67], v[16:19], v[224:227], v[64:67]
v_mfma_f32_16x16x32_bf16 v[56:59], a[96:99], v[20:23], v[56:59]
ds_read_b128 v[16:19], v1 offset:57344
v_mfma_f32_16x16x32_bf16 v[60:63], a[224:227], v[20:23], v[60:63]
v_mfma_f32_16x16x32_bf16 v[68:71], v[20:23], v[224:227], v[68:71]
s_waitcnt lgkmcnt(5)
v_mfma_f32_16x16x32_bf16 v[48:51], a[100:103], v[24:27], v[48:51]
ds_read_b128 v[20:23], v1 offset:58368
v_mfma_f32_16x16x32_bf16 v[52:55], a[228:231], v[24:27], v[52:55]
v_mfma_f32_16x16x32_bf16 v[64:67], v[24:27], v[228:231], v[64:67]
v_mfma_f32_16x16x32_bf16 v[56:59], a[100:103], v[28:31], v[56:59]
ds_read_b128 v[24:27], v1 offset:59392
v_mfma_f32_16x16x32_bf16 v[60:63], a[228:231], v[28:31], v[60:63]
v_mfma_f32_16x16x32_bf16 v[68:71], v[28:31], v[228:231], v[68:71]
s_waitcnt lgkmcnt(5)
v_mfma_f32_16x16x32_bf16 v[48:51], a[104:107], v[32:35], v[48:51]
ds_read_b128 v[28:31], v1 offset:60416
buffer_load_dword v3, v2, s[4:7], s47 offen sc1
v_mfma_f32_16x16x32_bf16 v[52:55], a[232:235], v[32:35], v[52:55]
v_mfma_f32_16x16x32_bf16 v[64:67], v[32:35], v[232:235], v[64:67]
v_mfma_f32_16x16x32_bf16 v[56:59], a[104:107], v[36:39], v[56:59]
ds_read_b128 v[32:35], v1 offset:61440
v_mfma_f32_16x16x32_bf16 v[60:63], a[232:235], v[36:39], v[60:63]
v_mfma_f32_16x16x32_bf16 v[68:71], v[36:39], v[232:235], v[68:71]
s_waitcnt lgkmcnt(5)
v_mfma_f32_16x16x32_bf16 v[48:51], a[108:111], v[40:43], v[48:51]
ds_read_b128 v[36:39], v1 offset:62464
v_mfma_f32_16x16x32_bf16 v[52:55], a[236:239], v[40:43], v[52:55]
v_mfma_f32_16x16x32_bf16 v[64:67], v[40:43], v[236:239], v[64:67]
v_mfma_f32_16x16x32_bf16 v[56:59], a[108:111], v[44:47], v[56:59]
ds_read_b128 v[40:43], v1 offset:63488
v_mfma_f32_16x16x32_bf16 v[60:63], a[236:239], v[44:47], v[60:63]
v_mfma_f32_16x16x32_bf16 v[68:71], v[44:47], v[236:239], v[68:71]
s_waitcnt lgkmcnt(5)
v_mfma_f32_16x16x32_bf16 v[48:51], a[112:115], v[16:19], v[48:51]
ds_read_b128 v[44:47], v1 offset:64512
v_mfma_f32_16x16x32_bf16 v[52:55], a[240:243], v[16:19], v[52:55]
v_mfma_f32_16x16x32_bf16 v[64:67], v[16:19], v[240:243], v[64:67]
v_mfma_f32_16x16x32_bf16 v[56:59], a[112:115], v[20:23], v[56:59]
v_mfma_f32_16x16x32_bf16 v[60:63], a[240:243], v[20:23], v[60:63]
v_mfma_f32_16x16x32_bf16 v[68:71], v[20:23], v[240:243], v[68:71]
s_waitcnt lgkmcnt(4)
v_mfma_f32_16x16x32_bf16 v[48:51], a[116:119], v[24:27], v[48:51]
v_mfma_f32_16x16x32_bf16 v[52:55], a[244:247], v[24:27], v[52:55]
v_mfma_f32_16x16x32_bf16 v[64:67], v[24:27], v[244:247], v[64:67]
v_mfma_f32_16x16x32_bf16 v[56:59], a[116:119], v[28:31], v[56:59]
v_mfma_f32_16x16x32_bf16 v[60:63], a[244:247], v[28:31], v[60:63]
v_mfma_f32_16x16x32_bf16 v[68:71], v[28:31], v[244:247], v[68:71]
s_waitcnt lgkmcnt(2)
v_mfma_f32_16x16x32_bf16 v[48:51], a[120:123], v[32:35], v[48:51]
v_mfma_f32_16x16x32_bf16 v[52:55], a[248:251], v[32:35], v[52:55]
v_mfma_f32_16x16x32_bf16 v[64:67], v[32:35], v[248:251], v[64:67]
v_mfma_f32_16x16x32_bf16 v[56:59], a[120:123], v[36:39], v[56:59]
v_mfma_f32_16x16x32_bf16 v[60:63], a[248:251], v[36:39], v[60:63]
v_mfma_f32_16x16x32_bf16 v[68:71], v[36:39], v[248:251], v[68:71]
s_waitcnt lgkmcnt(0)
v_mfma_f32_16x16x32_bf16 v[48:51], a[124:127], v[40:43], v[48:51]
v_mfma_f32_16x16x32_bf16 v[52:55], a[252:255], v[40:43], v[52:55]
v_mfma_f32_16x16x32_bf16 v[64:67], v[40:43], v[252:255], v[64:67]
v_mfma_f32_16x16x32_bf16 v[56:59], a[124:127], v[44:47], v[56:59]
v_mfma_f32_16x16x32_bf16 v[60:63], a[252:255], v[44:47], v[60:63]
v_mfma_f32_16x16x32_bf16 v[68:71], v[44:47], v[252:255], v[68:71]
v_xor_b32 v1, 0x10000, v1
v_mov_b32 v5, s36
s_waitcnt vmcnt(0)
v_cmp_gt_u32 vcc, s48, v3
s_nop 3
v_cvt_pk_bf16_f32 v80, v48, v49
v_cvt_pk_bf16_f32 v81, v50, v51
v_cvt_pk_bf16_f32 v82, v52, v53
v_cvt_pk_bf16_f32 v83, v54, v55
buffer_store_dwordx4 v[80:83], v6, s[4:7], s49 offen sc1
v_cvt_pk_bf16_f32 v84, v56, v57
v_cvt_pk_bf16_f32 v85, v58, v59
v_cvt_pk_bf16_f32 v86, v60, v61
v_cvt_pk_bf16_f32 v87, v62, v63
buffer_store_dwordx4 v[84:87], v7, s[4:7], s49 offen sc1
v_cvt_pk_bf16_f32 v88, v64, v65
v_cvt_pk_bf16_f32 v89, v66, v67
v_cvt_pk_bf16_f32 v90, v68, v69
v_cvt_pk_bf16_f32 v91, v70, v71
buffer_store_dwordx4 v[88:91], v8, s[4:7], s49 offen sc1
s_mov_b32 s46, 0
s_cbranch_vccnz Lsk_602
s_mov_b32 s46, 1
s_add_u32 m0, s50, 0
s_add_u32 s39, s54, 0
buffer_load_dwordx4 v0, s[4:7], s39 offen offset:0 sc1 lds
buffer_load_dwordx4 v0, s[4:7], s39 offen offset:1024 sc1 lds
buffer_load_dwordx4 v0, s[4:7], s39 offen offset:2048 sc1 lds
buffer_load_dwordx4 v0, s[4:7], s39 offen offset:3072 sc1 lds
s_add_u32 m0, s50, 16384
s_add_u32 s39, s54, 16384
buffer_load_dwordx4 v0, s[4:7], s39 offen offset:0 sc1 lds
buffer_load_dwordx4 v0, s[4:7], s39 offen offset:1024 sc1 lds
buffer_load_dwordx4 v0, s[4:7], s39 offen offset:2048 sc1 lds
buffer_load_dwordx4 v0, s[4:7], s39 offen offset:3072 sc1 lds
s_add_u32 m0, s50, 32768
s_add_u32 s39, s54, 32768
buffer_load_dwordx4 v0, s[4:7], s39 offen offset:0 sc1 lds
buffer_load_dwordx4 v0, s[4:7], s39 offen offset:1024 sc1 lds
buffer_load_dwordx4 v0, s[4:7], s39 offen offset:2048 sc1 lds
buffer_load_dwordx4 v0, s[4:7], s39 offen offset:3072 sc1 lds
s_add_u32 m0, s50, 49152
s_add_u32 s39, s54, 49152
buffer_load_dwordx4 v0, s[4:7], s39 offen offset:0 sc1 lds
buffer_load_dwordx4 v0, s[4:7], s39 offen offset:1024 sc1 lds
buffer_load_dwordx4 v0, s[4:7], s39 offen offset:2048 sc1 lds
buffer_load_dwordx4 v0, s[4:7], s39 offen offset:3072 sc1 lds
s_waitcnt vmcnt(16)
s_branch Lsj_603
Lsk_602:
s_waitcnt vmcnt(0)
Lsj_603:
s_barrier
buffer_store_dword v5, v4, s[4:7], 0 offen sc1
s_cmp_eq_u32 s36, 3
s_cbranch_scc1 Lso_601
s_cmp_lg_u32 s46, 0
s_cbranch_scc1 Lse_600
s_branch Lsw_599
Lso_601:
v_lshlrev_b32 v80, 7, v9
s_mov_b32 s38, 3424256
Lbw_608:
buffer_load_dword v81, v80, s[4:7], s38 offen sc1
s_waitcnt vmcnt(0)
v_cmp_gt_u32 vcc, 3, v81
s_cbranch_vccz Lbo_609
s_sub_u32 s37, s37, 1
s_cbranch_scc1 Lend_7
s_sleep 2
s_branch Lbw_608
Lbo_609:
s_cmp_lg_u32 s46, 0
s_cbranch_scc1 Lqh_606
s_add_u32 m0, s50, 0
s_add_u32 s39, s54, 0
buffer_load_dwordx4 v0, s[4:7], s39 offen offset:0 sc1 lds
buffer_load_dwordx4 v0, s[4:7], s39 offen offset:1024 sc1 lds
buffer_load_dwordx4 v0, s[4:7], s39 offen offset:2048 sc1 lds
buffer_load_dwordx4 v0, s[4:7], s39 offen offset:3072 sc1 lds
s_add_u32 m0, s50, 16384
s_add_u32 s39, s54, 16384
buffer_load_dwordx4 v0, s[4:7], s39 offen offset:0 sc1 lds
buffer_load_dwordx4 v0, s[4:7], s39 offen offset:1024 sc1 lds
buffer_load_dwordx4 v0, s[4:7], s39 offen offset:2048 sc1 lds
buffer_load_dwordx4 v0, s[4:7], s39 offen offset:3072 sc1 lds
s_add_u32 m0, s50, 32768
s_add_u32 s39, s54, 32768
buffer_load_dwordx4 v0, s[4:7], s39 offen offset:0 sc1 lds
buffer_load_dwordx4 v0, s[4:7], s39 offen offset:1024 sc1 lds
buffer_load_dwordx4 v0, s[4:7], s39 offen offset:2048 sc1 lds
buffer_load_dwordx4 v0, s[4:7], s39 offen offset:3072 sc1 lds
s_add_u32 m0, s50, 49152
s_add_u32 s39, s54, 49152
buffer_load_dwordx4 v0, s[4:7], s39 offen offset:0 sc1 lds
buffer_load_dwordx4 v0, s[4:7], s39 offen offset:1024 sc1 lds
buffer_load_dwordx4 v0, s[4:7], s39 offen offset:2048 sc1 lds
buffer_load_dwordx4 v0, s[4:7], s39 offen offset:3072 sc1 lds
s_waitcnt vmcnt(0)
Lqh_606:
s_barrier
ds_read_b128 v[16:19], v1 offset:0
ds_read_b128 v[20:23], v1 offset:2048
ds_read_b128 v[24:27], v1 offset:4096
ds_read_b128 v[28:31], v1 offset:6144
ds_read_b128 v[32:35], v1 offset:8192
ds_read_b128 v[36:39], v1 offset:10240
ds_read_b128 v[40:43], v1 offset:12288
s_mov_b32 s55, 0x70000000
Lql_607:
s_waitcnt lgkmcnt(5)
v_mfma_f32_16x16x32_bf16 v[48:51], a[0:3], v[16:19], 0
s_add_u32 s54, s54, 65536
ds_read_b128 v[44:47], v1 offset:14336
s_xor_b32 s50, s50, 0x10000
v_mfma_f32_16x16x32_bf16 v[52:55], a[128:131], v[16:19], 0
s_cmp_lt_u32 s36, 63
s_cselect_b32 s45, s54, 0x70000000
v_mfma_f32_16x16x32_bf16 v[64:67], v[16:19], v[128:131], 0
v_mfma_f32_16x16x32_bf16 v[48:51], a[4:7], v[20:23], v[48:51]
ds_read_b128 v[16:19], v1 offset:16384
v_mfma_f32_16x16x32_bf16 v[52:55], a[132:135], v[20:23], v[52:55]
v_mfma_f32_16x16x32_bf16 v[64:67], v[20:23], v[132:135], v[64:67]
s_waitcnt lgkmcnt(5)
v_mfma_f32_16x16x32_bf16 v[48:51], a[8:11], v[24:27], v[48:51]
ds_read_b128 v[20:23], v1 offset:18432
v_mfma_f32_16x16x32_bf16 v[52:55], a[136:139], v[24:27], v[52:55]
v_mfma_f32_16x16x32_bf16 v[64:67], v[24:27], v[136:139], v[64:67]
v_cvt_pk_bf16_f32 v84, v56, v57
v_cvt_pk_bf16_f32 v85, v58, v59
v_mfma_f32_16x16x32_bf16 v[48:51], a[12:15], v[28:31], v[48:51]
ds_read_b128 v[24:27], v1 offset:20480
v_cvt_pk_bf16_f32 v86, v60, v61
v_mfma_f32_16x16x32_bf16 v[52:55], a[140:143], v[28:31], v[52:55]
v_cvt_pk_bf16_f32 v87, v62, v63
v_cvt_pk_bf16_f32 v90, v68, v69
v_mfma_f32_16x16x32_bf16 v[64:67], v[28:31], v[140:143], v[64:67]
s_waitcnt lgkmcnt(5)
v_cvt_pk_bf16_f32 v91, v70, v71
v_mfma_f32_16x16x32_bf16 v[48:51], a[16:19], v[32:35], v[48:51]
ds_read_b128 v[28:31], v1 offset:22528
v_mfma_f32_16x16x32_bf16 v[52:55], a[144:147], v[32:35], v[52:55]
buffer_store_dwordx4 v[80:83], v6, s[4:7], s55 offen sc1
v_mfma_f32_16x16x32_bf16 v[64:67], v[32:35], v[144:147], v[64:67]
v_mfma_f32_16x16x32_bf16 v[48:51], a[20:23], v[36:39], v[48:51]
ds_read_b128 v[32:35], v1 offset:24576
v_mfma_f32_16x16x32_bf16 v[52:55], a[148:151], v[36:39], v[52:55]
v_mfma_f32_16x16x32_bf16 v[64:67], v[36:39], v[148:151], v[64:67]
s_waitcnt lgkmcnt(5)
buffer_store_dwordx4 v[84:87], v7, s[4:7], s55 offen sc1
v_mfma_f32_16x16x32_bf16 v[48:51], a[24:27], v[40:43], v[48:51]
ds_read_b128 v[36:39], v1 offset:26624
v_mfma_f32_16x16x32_bf16 v[52:55], a[152:155], v[40:43], v[52:55]
v_mfma_f32_16x16x32_bf16 v[64:67], v[40:43], v[152:155], v[64:67]
v_mfma_f32_16x16x32_bf16 v[48:51], a[28:31], v[44:47], v[48:51]
ds_read_b128 v[40:43], v1 offset:28672
v_mfma_f32_16x16x32_bf16 v[52:55], a[156:159], v[44:47], v[52:55]
buffer_store_dwordx4 v[88:91], v8, s[4:7], s55 offen sc1
v_mfma_f32_16x16x32_bf16 v[64:67], v[44:47], v[156:159], v[64:67]
s_waitcnt lgkmcnt(5)
v_mfma_f32_16x16x32_bf16 v[48:51], a[32:35], v[16:19], v[48:51]
ds_read_b128 v[44:47], v1 offset:30720
v_mfma_f32_16x16x32_bf16 v[52:55], a[160:163], v[16:19], v[52:55]
v_mfma_f32_16x16x32_bf16 v[64:67], v[16:19], v[160:163], v[64:67]
v_mov_b32 v5, s36
s_add_u32 m0, s50, 0
v_mfma_f32_16x16x32_bf16 v[48:51], a[36:39], v[20:23], v[48:51]
s_add_u32 s39, s45, 0
ds_read_b128 v[16:19], v1 offset:32768
buffer_load_dwordx4 v0, s[4:7], s39 offen offset:0 sc1 lds
v_mfma_f32_16x16x32_bf16 v[52:55], a[164:167], v[20:23], v[52:55]
v_mfma_f32_16x16x32_bf16 v[64:67], v[20:23], v[164:167], v[64:67]
s_waitcnt lgkmcnt(5)
v_mfma_f32_16x16x32_bf16 v[48:51], a[40:43], v[24:27], v[48:51]
ds_read_b128 v[20:23], v1 offset:34816
v_mfma_f32_16x16x32_bf16 v[52:55], a[168:171], v[24:27], v[52:55]
v_mfma_f32_16x16x32_bf16 v[64:67], v[24:27], v[168:171], v[64:67]
buffer_load_dwordx4 v0, s[4:7], s39 offen offset:1024 sc1 lds
v_mfma_f32_16x16x32_bf16 v[48:51], a[44:47], v[28:31], v[48:51]
ds_read_b128 v[24:27], v1 offset:36864
v_mfma_f32_16x16x32_bf16 v[52:55], a[172:175], v[28:31], v[52:55]
v_mfma_f32_16x16x32_bf16 v[64:67], v[28:31], v[172:175], v[64:67]
s_waitcnt lgkmcnt(5)
v_mfma_f32_16x16x32_bf16 v[48:51], a[48:51], v[32:35], v[48:51]
ds_read_b128 v[28:31], v1 offset:38912
v_mfma_f32_16x16x32_bf16 v[52:55], a[176:179], v[32:35], v[52:55]
buffer_load_dwordx4 v0, s[4:7], s39 offen offset:2048 sc1 lds
v_mfma_f32_16x16x32_bf16 v[64:67], v[32:35], v[176:179], v[64:67]
v_mfma_f32_16x16x32_bf16 v[48:51], a[52:55], v[36:39], v[48:51]
ds_read_b128 v[32:35], v1 offset:40960
v_mfma_f32_16x16x32_bf16 v[52:55], a[180:183], v[36:39], v[52:55]
v_mfma_f32_16x16x32_bf16 v[64:67], v[36:39], v[180:183], v[64:67]
s_waitcnt lgkmcnt(5)
v_mfma_f32_16x16x32_bf16 v[48:51], a[56:59], v[40:43], v[48:51]
ds_read_b128 v[36:39], v1 offset:43008
buffer_load_dwordx4 v0, s[4:7], s39 offen offset:3072 sc1 lds
v_mfma_f32_16x16x32_bf16 v[52:55], a[184:187], v[40:43], v[52:55]
v_mfma_f32_16x16x32_bf16 v[64:67], v[40:43], v[184:187], v[64:67]
v_mfma_f32_16x16x32_bf16 v[48:51], a[60:63], v[44:47], v[48:51]
ds_read_b128 v[40:43], v1 offset:45056
v_mfma_f32_16x16x32_bf16 v[52:55], a[188:191], v[44:47], v[52:55]
v_mfma_f32_16x16x32_bf16 v[64:67], v[44:47], v[188:191], v[64:67]
s_waitcnt lgkmcnt(5)
s_add_u32 m0, s50, 16384
s_add_u32 s39, s45, 16384
v_mfma_f32_16x16x32_bf16 v[48:51], a[64:67], v[16:19], v[48:51]
ds_read_b128 v[44:47], v1 offset:47104
buffer_load_dwordx4 v0, s[4:7], s39 offen offset:0 sc1 lds
v_mfma_f32_16x16x32_bf16 v[52:55], a[192:195], v[16:19], v[52:55]
v_mfma_f32_16x16x32_bf16 v[64:67], v[16:19], v[192:195], v[64:67]
v_mfma_f32_16x16x32_bf16 v[48:51], a[68:71], v[20:23], v[48:51]
ds_read_b128 v[16:19], v1 offset:49152
v_mfma_f32_16x16x32_bf16 v[52:55], a[196:199], v[20:23], v[52:55]
v_mfma_f32_16x16x32_bf16 v[64:67], v[20:23], v[196:199], v[64:67]
s_waitcnt lgkmcnt(5)
buffer_load_dwordx4 v0, s[4:7], s39 offen offset:1024 sc1 lds
v_mfma_f32_16x16x32_bf16 v[48:51], a[72:75], v[24:27], v[48:51]
ds_read_b128 v[20:23], v1 offset:51200
v_mfma_f32_16x16x32_bf16 v[52:55], a[200:203], v[24:27], v[52:55]
v_mfma_f32_16x16x32_bf16 v[64:67], v[24:27], v[200:203], v[64:67]
v_mfma_f32_16x16x32_bf16 v[48:51], a[76:79], v[28:31], v[48:51]
ds_read_b128 v[24:27], v1 offset:53248
v_mfma_f32_16x16x32_bf16 v[52:55], a[204:207], v[28:31], v[52:55]
buffer_load_dwordx4 v0, s[4:7], s39 offen offset:2048 sc1 lds
v_mfma_f32_16x16x32_bf16 v[64:67], v[28:31], v[204:207], v[64:67]
s_waitcnt lgkmcnt(5)
v_mfma_f32_16x16x32_bf16 v[48:51], a[80:83], v[32:35], v[48:51]
ds_read_b128 v[28:31], v1 offset:55296
v_mfma_f32_16x16x32_bf16 v[52:55], a[208:211], v[32:35], v[52:55]
v_mfma_f32_16x16x32_bf16 v[64:67], v[32:35], v[208:211], v[64:67]
v_mfma_f32_16x16x32_bf16 v[48:51], a[84:87], v[36:39], v[48:51]
ds_read_b128 v[32:35], v1 offset:57344
buffer_load_dwordx4 v0, s[4:7], s39 offen offset:3072 sc1 lds
v_mfma_f32_16x16x32_bf16 v[52:55], a[212:215], v[36:39], v[52:55]
v_mfma_f32_16x16x32_bf16 v[64:67], v[36:39], v[212:215], v[64:67]
s_waitcnt lgkmcnt(5)
v_mfma_f32_16x16x32_bf16 v[48:51], a[88:91], v[40:43], v[48:51]
ds_read_b128 v[36:39], v1 offset:59392
v_mfma_f32_16x16x32_bf16 v[52:55], a[216:219], v[40:43], v[52:55]
v_mfma_f32_16x16x32_bf16 v[64:67], v[40:43], v[216:219], v[64:67]
v_mfma_f32_16x16x32_bf16 v[48:51], a[92:95], v[44:47], v[48:51]
ds_read_b128 v[40:43], v1 offset:61440
v_mfma_f32_16x16x32_bf16 v[52:55], a[220:223], v[44:47], v[52:55]
s_waitcnt vmcnt(8)
s_barrier
buffer_store_dword v5, v4, s[4:7], 0 offen sc1
v_mfma_f32_16x16x32_bf16 v[64:67], v[44:47], v[220:223], v[64:67]
s_waitcnt lgkmcnt(5)
v_mfma_f32_16x16x32_bf16 v[48:51], a[96:99], v[16:19], v[48:51]
ds_read_b128 v[44:47], v1 offset:63488
v_mfma_f32_16x16x32_bf16 v[52:55], a[224:227], v[16:19], v[52:55]
s_add_u32 m0, s50, 32768
s_add_u32 s39, s45, 32768
buffer_load_dwordx4 v0, s[4:7], s39 offen offset:0 sc1 lds
v_mfma_f32_16x16x32_bf16 v[64:67], v[16:19], v[224:227], v[64:67]
v_mfma_f32_16x16x32_bf16 v[48:51], a[100:103], v[20:23], v[48:51]
ds_read_b128 v[16:19], v1 offset:1024
v_mfma_f32_16x16x32_bf16 v[52:55], a[228:231], v[20:23], v[52:55]
v_mfma_f32_16x16x32_bf16 v[64:67], v[20:23], v[228:231], v[64:67]
s_waitcnt lgkmcnt(5)
v_mfma_f32_16x16x32_bf16 v[48:51], a[104:107], v[24:27], v[48:51]
ds_read_b128 v[20:23], v1 offset:3072
buffer_load_dwordx4 v0, s[4:7], s39 offen offset:1024 sc1 lds
v_mfma_f32_16x16x32_bf16 v[52:55], a[232:235], v[24:27], v[52:55]
v_mfma_f32_16x16x32_bf16 v[64:67], v[24:27], v[232:235], v[64:67]
v_mfma_f32_16x16x32_bf16 v[48:51], a[108:111], v[28:31], v[48:51]
ds_read_b128 v[24:27], v1 offset:5120
v_mfma_f32_16x16x32_bf16 v[52:55], a[236:239], v[28:31], v[52:55]
v_mfma_f32_16x16x32_bf16 v[64:67], v[28:31], v[236:239], v[64:67]
s_waitcnt lgkmcnt(5)
buffer_load_dwordx4 v0, s[4:7], s39 offen offset:2048 sc1 lds
v_mfma_f32_16x16x32_bf16 v[48:51], a[112:115], v[32:35], v[48:51]
ds_read_b128 v[28:31], v1 offset:7168
v_mfma_f32_16x16x32_bf16 v[52:55], a[240:243], v[32:35], v[52:55]
v_mfma_f32_16x16x32_bf16 v[64:67], v[32:35], v[240:243], v[64:67]
v_mfma_f32_16x16x32_bf16 v[48:51], a[116:119], v[36:39], v[48:51]
ds_read_b128 v[32:35], v1 offset:9216
v_mfma_f32_16x16x32_bf16 v[52:55], a[244:247], v[36:39], v[52:55]
buffer_load_dwordx4 v0, s[4:7], s39 offen offset:3072 sc1 lds
v_mfma_f32_16x16x32_bf16 v[64:67], v[36:39], v[244:247], v[64:67]
s_waitcnt lgkmcnt(5)
v_mfma_f32_16x16x32_bf16 v[48:51], a[120:123], v[40:43], v[48:51]
ds_read_b128 v[36:39], v1 offset:11264
v_mfma_f32_16x16x32_bf16 v[52:55], a[248:251], v[40:43], v[52:55]
v_mfma_f32_16x16x32_bf16 v[64:67], v[40:43], v[248:251], v[64:67]
v_mfma_f32_16x16x32_bf16 v[48:51], a[124:127], v[44:47], v[48:51]
s_add_u32 m0, s50, 49152
ds_read_b128 v[40:43], v1 offset:13312
s_add_u32 s39, s45, 49152
v_mfma_f32_16x16x32_bf16 v[52:55], a[252:255], v[44:47], v[52:55]
buffer_load_dwordx4 v0, s[4:7], s39 offen offset:0 sc1 lds
v_mfma_f32_16x16x32_bf16 v[64:67], v[44:47], v[252:255], v[64:67]
s_waitcnt lgkmcnt(5)
v_mfma_f32_16x16x32_bf16 v[56:59], a[0:3], v[16:19], 0
ds_read_b128 v[44:47], v1 offset:15360
v_mfma_f32_16x16x32_bf16 v[60:63], a[128:131], v[16:19], 0
v_mfma_f32_16x16x32_bf16 v[68:71], v[16:19], v[128:131], 0
v_mfma_f32_16x16x32_bf16 v[56:59], a[4:7], v[20:23], v[56:59]
ds_read_b128 v[16:19], v1 offset:17408
buffer_load_dwordx4 v0, s[4:7], s39 offen offset:1024 sc1 lds
v_mfma_f32_16x16x32_bf16 v[60:63], a[132:135], v[20:23], v[60:63]
v_mfma_f32_16x16x32_bf16 v[68:71], v[20:23], v[132:135], v[68:71]
s_waitcnt lgkmcnt(5)
v_mfma_f32_16x16x32_bf16 v[56:59], a[8:11], v[24:27], v[56:59]
ds_read_b128 v[20:23], v1 offset:19456
v_mfma_f32_16x16x32_bf16 v[60:63], a[136:139], v[24:27], v[60:63]
v_mfma_f32_16x16x32_bf16 v[68:71], v[24:27], v[136:139], v[68:71]
buffer_load_dwordx4 v0, s[4:7], s39 offen offset:2048 sc1 lds
v_mfma_f32_16x16x32_bf16 v[56:59], a[12:15], v[28:31], v[56:59]
ds_read_b128 v[24:27], v1 offset:21504
v_cvt_pk_bf16_f32 v80, v48, v49
v_mfma_f32_16x16x32_bf16 v[60:63], a[140:143], v[28:31], v[60:63]
v_cvt_pk_bf16_f32 v81, v50, v51
v_cvt_pk_bf16_f32 v82, v52, v53
v_mfma_f32_16x16x32_bf16 v[68:71], v[28:31], v[140:143], v[68:71]
s_waitcnt lgkmcnt(5)
v_cvt_pk_bf16_f32 v83, v54, v55
v_cvt_pk_bf16_f32 v88, v64, v65
v_mfma_f32_16x16x32_bf16 v[56:59], a[16:19], v[32:35], v[56:59]
ds_read_b128 v[28:31], v1 offset:23552
v_cvt_pk_bf16_f32 v89, v66, v67
v_mfma_f32_16x16x32_bf16 v[60:63], a[144:147], v[32:35], v[60:63]
buffer_load_dwordx4 v0, s[4:7], s39 offen offset:3072 sc1 lds
s_add_u32 s49, s49, 786432
v_mfma_f32_16x16x32_bf16 v[68:71], v[32:35], v[144:147], v[68:71]
s_mov_b32 s55, s49
s_add_u32 s36, s36, 1
v_mfma_f32_16x16x32_bf16 v[56:59], a[20:23], v[36:39], v[56:59]
ds_read_b128 v[32:35], v1 offset:25600
v_mfma_f32_16x16x32_bf16 v[60:63], a[148:151], v[36:39], v[60:63]
v_mfma_f32_16x16x32_bf16 v[68:71], v[36:39], v[148:151], v[68:71]
s_waitcnt lgkmcnt(5)
v_mfma_f32_16x16x32_bf16 v[56:59], a[24:27], v[40:43], v[56:59]
ds_read_b128 v[36:39], v1 offset:27648
v_mfma_f32_16x16x32_bf16 v[60:63], a[152:155], v[40:43], v[60:63]
v_mfma_f32_16x16x32_bf16 v[68:71], v[40:43], v[152:155], v[68:71]
v_mfma_f32_16x16x32_bf16 v[56:59], a[28:31], v[44:47], v[56:59]
ds_read_b128 v[40:43], v1 offset:29696
v_mfma_f32_16x16x32_bf16 v[60:63], a[156:159], v[44:47], v[60:63]
v_mfma_f32_16x16x32_bf16 v[68:71], v[44:47], v[156:159], v[68:71]
s_waitcnt lgkmcnt(5)
v_mfma_f32_16x16x32_bf16 v[56:59], a[32:35], v[16:19], v[56:59]
ds_read_b128 v[44:47], v1 offset:31744
v_mfma_f32_16x16x32_bf16 v[60:63], a[160:163], v[16:19], v[60:63]
v_mfma_f32_16x16x32_bf16 v[68:71], v[16:19], v[160:163], v[68:71]
v_mfma_f32_16x16x32_bf16 v[56:59], a[36:39], v[20:23], v[56:59]
ds_read_b128 v[16:19], v1 offset:33792
v_mfma_f32_16x16x32_bf16 v[60:63], a[164:167], v[20:23], v[60:63]
v_mfma_f32_16x16x32_bf16 v[68:71], v[20:23], v[164:167], v[68:71]
s_waitcnt lgkmcnt(5)
v_mfma_f32_16x16x32_bf16 v[56:59], a[40:43], v[24:27], v[56:59]
ds_read_b128 v[20:23], v1 offset:35840
v_mfma_f32_16x16x32_bf16 v[60:63], a[168:171], v[24:27], v[60:63]
v_mfma_f32_16x16x32_bf16 v[68:71], v[24:27], v[168:171], v[68:71]
v_mfma_f32_16x16x32_bf16 v[56:59], a[44:47], v[28:31], v[56:59]
ds_read_b128 v[24:27], v1 offset:37888
v_mfma_f32_16x16x32_bf16 v[60:63], a[172:175], v[28:31], v[60:63]
v_mfma_f32_16x16x32_bf16 v[68:71], v[28:31], v[172:175], v[68:71]
s_waitcnt lgkmcnt(5)
v_mfma_f32_16x16x32_bf16 v[56:59], a[48:51], v[32:35], v[56:59]
ds_read_b128 v[28:31], v1 offset:39936
v_mfma_f32_16x16x32_bf16 v[60:63], a[176:179], v[32:35], v[60:63]
v_mfma_f32_16x16x32_bf16 v[68:71], v[32:35], v[176:179], v[68:71]
v_mfma_f32_16x16x32_bf16 v[56:59], a[52:55], v[36:39], v[56:59]
ds_read_b128 v[32:35], v1 offset:41984
v_mfma_f32_16x16x32_bf16 v[60:63], a[180:183], v[36:39], v[60:63]
v_mfma_f32_16x16x32_bf16 v[68:71], v[36:39], v[180:183], v[68:71]
s_waitcnt lgkmcnt(5)
v_mfma_f32_16x16x32_bf16 v[56:59], a[56:59], v[40:43], v[56:59]
ds_read_b128 v[36:39], v1 offset:44032
v_mfma_f32_16x16x32_bf16 v[60:63], a[184:187], v[40:43], v[60:63]
v_mfma_f32_16x16x32_bf16 v[68:71], v[40:43], v[184:187], v[68:71]
v_mfma_f32_16x16x32_bf16 v[56:59], a[60:63], v[44:47], v[56:59]
ds_read_b128 v[40:43], v1 offset:46080
v_mfma_f32_16x16x32_bf16 v[60:63], a[188:191], v[44:47], v[60:63]
v_mfma_f32_16x16x32_bf16 v[68:71], v[44:47], v[188:191], v[68:71]
s_waitcnt lgkmcnt(5)
v_mfma_f32_16x16x32_bf16 v[56:59], a[64:67], v[16:19], v[56:59]
ds_read_b128 v[44:47], v1 offset:48128
v_mfma_f32_16x16x32_bf16 v[60:63], a[192:195], v[16:19], v[60:63]
v_mfma_f32_16x16x32_bf16 v[68:71], v[16:19], v[192:195], v[68:71]
v_mfma_f32_16x16x32_bf16 v[56:59], a[68:71], v[20:23], v[56:59]
ds_read_b128 v[16:19], v1 offset:50176
v_mfma_f32_16x16x32_bf16 v[60:63], a[196:199], v[20:23], v[60:63]
v_mfma_f32_16x16x32_bf16 v[68:71], v[20:23], v[196:199], v[68:71]
s_waitcnt lgkmcnt(5)
v_mfma_f32_16x16x32_bf16 v[56:59], a[72:75], v[24:27], v[56:59]
ds_read_b128 v[20:23], v1 offset:52224
v_mfma_f32_16x16x32_bf16 v[60:63], a[200:203], v[24:27], v[60:63]
v_mfma_f32_16x16x32_bf16 v[68:71], v[24:27], v[200:203], v[68:71]
v_mfma_f32_16x16x32_bf16 v[56:59], a[76:79], v[28:31], v[56:59]
ds_read_b128 v[24:27], v1 offset:54272
v_mfma_f32_16x16x32_bf16 v[60:63], a[204:207], v[28:31], v[60:63]
v_mfma_f32_16x16x32_bf16 v[68:71], v[28:31], v[204:207], v[68:71]
s_waitcnt lgkmcnt(5)
v_mfma_f32_16x16x32_bf16 v[56:59], a[80:83], v[32:35], v[56:59]
ds_read_b128 v[28:31], v1 offset:56320
v_mfma_f32_16x16x32_bf16 v[60:63], a[208:211], v[32:35], v[60:63]
v_mfma_f32_16x16x32_bf16 v[68:71], v[32:35], v[208:211], v[68:71]
v_mfma_f32_16x16x32_bf16 v[56:59], a[84:87], v[36:39], v[56:59]
ds_read_b128 v[32:35], v1 offset:58368
v_mfma_f32_16x16x32_bf16 v[60:63], a[212:215], v[36:39], v[60:63]
v_mfma_f32_16x16x32_bf16 v[68:71], v[36:39], v[212:215], v[68:71]
s_waitcnt lgkmcnt(5)
v_mfma_f32_16x16x32_bf16 v[56:59], a[88:91], v[40:43], v[56:59]
ds_read_b128 v[36:39], v1 offset:60416
v_mfma_f32_16x16x32_bf16 v[60:63], a[216:219], v[40:43], v[60:63]
v_mfma_f32_16x16x32_bf16 v[68:71], v[40:43], v[216:219], v[68:71]
v_mfma_f32_16x16x32_bf16 v[56:59], a[92:95], v[44:47], v[56:59]
ds_read_b128 v[40:43], v1 offset:62464
v_mfma_f32_16x16x32_bf16 v[60:63], a[220:223], v[44:47], v[60:63]
v_mfma_f32_16x16x32_bf16 v[68:71], v[44:47], v[220:223], v[68:71]
s_waitcnt lgkmcnt(5)
v_mfma_f32_16x16x32_bf16 v[56:59], a[96:99], v[16:19], v[56:59]
ds_read_b128 v[44:47], v1 offset:64512
v_mfma_f32_16x16x32_bf16 v[60:63], a[224:227], v[16:19], v[60:63]
v_mfma_f32_16x16x32_bf16 v[68:71], v[16:19], v[224:227], v[68:71]
v_mfma_f32_16x16x32_bf16 v[56:59], a[100:103], v[20:23], v[56:59]
v_mfma_f32_16x16x32_bf16 v[60:63], a[228:231], v[20:23], v[60:63]
v_mfma_f32_16x16x32_bf16 v[68:71], v[20:23], v[228:231], v[68:71]
s_waitcnt lgkmcnt(4)
v_mfma_f32_16x16x32_bf16 v[56:59], a[104:107], v[24:27], v[56:59]
v_mfma_f32_16x16x32_bf16 v[60:63], a[232:235], v[24:27], v[60:63]
v_mfma_f32_16x16x32_bf16 v[68:71], v[24:27], v[232:235], v[68:71]
v_xor_b32 v1, 0x10000, v1
s_waitcnt vmcnt(0) lgkmcnt(0)
s_barrier
v_mfma_f32_16x16x32_bf16 v[56:59], a[108:111], v[28:31], v[56:59]
ds_read_b128 v[16:19], v1 offset:0
ds_read_b128 v[20:23], v1 offset:2048
v_mfma_f32_16x16x32_bf16 v[60:63], a[236:239], v[28:31], v[60:63]
ds_read_b128 v[24:27], v1 offset:4096
v_mfma_f32_16x16x32_bf16 v[68:71], v[28:31], v[236:239], v[68:71]
v_mfma_f32_16x16x32_bf16 v[56:59], a[112:115], v[32:35], v[56:59]
ds_read_b128 v[28:31], v1 offset:6144
v_mfma_f32_16x16x32_bf16 v[60:63], a[240:243], v[32:35], v[60:63]
v_mfma_f32_16x16x32_bf16 v[68:71], v[32:35], v[240:243], v[68:71]
v_mfma_f32_16x16x32_bf16 v[56:59], a[116:119], v[36:39], v[56:59]
ds_read_b128 v[32:35], v1 offset:8192
v_mfma_f32_16x16x32_bf16 v[60:63], a[244:247], v[36:39], v[60:63]
v_mfma_f32_16x16x32_bf16 v[68:71], v[36:39], v[244:247], v[68:71]
v_mfma_f32_16x16x32_bf16 v[56:59], a[120:123], v[40:43], v[56:59]
ds_read_b128 v[36:39], v1 offset:10240
v_mfma_f32_16x16x32_bf16 v[60:63], a[248:251], v[40:43], v[60:63]
v_mfma_f32_16x16x32_bf16 v[68:71], v[40:43], v[248:251], v[68:71]
s_cmp_lt_u32 s36, 64
v_mfma_f32_16x16x32_bf16 v[56:59], a[124:127], v[44:47], v[56:59]
ds_read_b128 v[40:43], v1 offset:12288
v_mfma_f32_16x16x32_bf16 v[60:63], a[252:255], v[44:47], v[60:63]
v_mfma_f32_16x16x32_bf16 v[68:71], v[44:47], v[252:255], v[68:71]
s_cbranch_scc1 Lql_607
s_nop 7
v_cvt_pk_bf16_f32 v84, v56, v57
v_cvt_pk_bf16_f32 v85, v58, v59
v_cvt_pk_bf16_f32 v86, v60, v61
v_cvt_pk_bf16_f32 v87, v62, v63
v_cvt_pk_bf16_f32 v90, v68, v69
v_cvt_pk_bf16_f32 v91, v70, v71
buffer_store_dwordx4 v[80:83], v6, s[4:7], s55 offen sc1
buffer_store_dwordx4 v[84:87], v7, s[4:7], s55 offen sc1
buffer_store_dwordx4 v[88:91], v8, s[4:7], s55 offen sc1
v_mov_b32 v5, 64
s_waitcnt vmcnt(0) lgkmcnt(0)
s_barrier
buffer_store_dword v5, v4, s[4:7], 0 offen sc1
s_load_dwordx2 s[16:17], s[0:1], 104
s_and_b32 s52, s44, 3
s_lshr_b32 s53, s44, 2
v_lshrrev_b32 v80, 3, v9
v_and_b32 v81, 7, v9
s_lshr_b32 s38, s52, 1
s_lshl_b32 s38, s38, 10
s_and_b32 s39, s52, 1
s_lshl_b32 s39, s39, 7
s_add_u32 s38, s38, s39
s_lshl_b32 s39, s53, 12
s_add_u32 s38, s38, s39
v_lshl_add_u32 v6, v81, 4, s38
v_and_b32 v82, 3, v80
v_lshl_add_u32 v6, v82, 8, v6
v_lshrrev_b32 v82, 2, v80
v_lshl_add_u32 v6, v82, 11, v6
s_lshl_b32 s38, s52, 14
s_lshl_b32 s39, s53, 7
s_add_u32 s38, s38, s39
v_lshl_add_u32 v7, v81, 11, s38
v_lshl_add_u32 v7, v80, 4, v7
s_lshl_b32 s38, s53, 8
v_lshl_add_u32 v8, v80, 5, s38
v_min_u32 v2, 6, v9
v_lshlrev_b32 v2, 10, v2
s_lshr_b32 s47, s44, 3
s_lshl_b32 s47, s47, 7
s_add_u32 s47, s47, 3416068
s_mov_b32 s60, 0x00003f80
s_mov_b32 s61, 0x3f800000
s_waitcnt lgkmcnt(0)
s_mov_b32 s8, s16
s_and_b32 s9, s17, 0xffff
s_mov_b32 s10, 0x400000
s_mov_b32 s11, 0x20000
v_lshlrev_b32 v80, 7, v9
s_mov_b32 s38, 3424256
Lbw_610:
buffer_load_dword v81, v80, s[4:7], s38 offen sc1
s_waitcnt vmcnt(0)
v_cmp_gt_u32 vcc, 4, v81
s_cbranch_vccz Lbo_611
s_sub_u32 s37, s37, 1
s_cbranch_scc1 Lend_7
s_sleep 2
s_branch Lbw_610
Lbo_611:
s_mov_b32 s38, 3166208
buffer_load_dwordx4 v[16:19], v8, s[4:7], s38 offen offset:0 sc1
buffer_load_dwordx4 v[20:23], v8, s[4:7], s38 offen offset:16 sc1
s_mov_b32 s36, s32
Lfin_612:
s_add_u32 s48, s36, 13
Lbw_613:
buffer_load_dword v3, v2, s[4:7], s47 offen sc1
s_waitcnt vmcnt(0)
v_cmp_gt_u32 vcc, s48, v3
s_cbranch_vccz Lbo_614
s_sub_u32 s37, s37, 1
s_cbranch_scc1 Lend_7
s_sleep 32
s_branch Lbw_613
Lbo_614:
s_lshl_b32 s49, s36, 16
s_add_u32 s39, s49, 134217728
buffer_load_dwordx4 v[64:67], v6, s[4:7], s39 offen sc1
s_add_u32 s39, s49, 138412032
buffer_load_dwordx4 v[68:71], v6, s[4:7], s39 offen sc1
s_add_u32 s39, s49, 142606336
buffer_load_dwordx4 v[72:75], v6, s[4:7], s39 offen sc1
s_add_u32 s39, s49, 146800640
buffer_load_dwordx4 v[76:79], v6, s[4:7], s39 offen sc1
s_add_u32 s39, s49, 150994944
buffer_load_dwordx4 v[80:83], v6, s[4:7], s39 offen sc1
s_add_u32 s39, s49, 155189248
buffer_load_dwordx4 v[84:87], v6, s[4:7], s39 offen sc1
s_add_u32 s39, s49, 159383552
buffer_load_dwordx4 v[88:91], v6, s[4:7], s39 offen sc1
s_add_u32 s39, s49, 12582912
buffer_load_dwordx4 v[92:95], v6, s[4:7], s39 offen sc1
s_add_u32 s39, s49, 134479872
buffer_load_dwordx4 v[96:99], v6, s[4:7], s39 offen sc1
s_add_u32 s39, s49, 138674176
buffer_load_dwordx4 v[100:103], v6, s[4:7], s39 offen sc1
s_add_u32 s39, s49, 142868480
buffer_load_dwordx4 v[104:107], v6, s[4:7], s39 offen sc1
s_add_u32 s39, s49, 147062784
buffer_load_dwordx4 v[108:111], v6, s[4:7], s39 offen sc1
s_add_u32 s39, s49, 151257088
buffer_load_dwordx4 v[112:115], v6, s[4:7], s39 offen sc1
s_add_u32 s39, s49, 155451392
buffer_load_dwordx4 v[116:119], v6, s[4:7], s39 offen sc1
s_add_u32 s39, s49, 159645696
buffer_load_dwordx4 v[120:123], v6, s[4:7], s39 offen sc1
s_add_u32 s39, s49, 12845056
buffer_load_dwordx4 v[124:127], v6, s[4:7], s39 offen sc1
s_add_u32 s39, s49, 134742016
buffer_load_dwordx4 v[128:131], v6, s[4:7], s39 offen sc1
s_add_u32 s39, s49, 138936320
buffer_load_dwordx4 v[132:135], v6, s[4:7], s39 offen sc1
s_add_u32 s39, s49, 143130624
buffer_load_dwordx4 v[136:139], v6, s[4:7], s39 offen sc1
s_add_u32 s39, s49, 147324928
buffer_load_dwordx4 v[140:143], v6, s[4:7], s39 offen sc1
s_add_u32 s39, s49, 151519232
buffer_load_dwordx4 v[144:147], v6, s[4:7], s39 offen sc1
s_add_u32 s39, s49, 155713536
buffer_load_dwordx4 v[148:151], v6, s[4:7], s39 offen sc1
s_add_u32 s39, s49, 159907840
buffer_load_dwordx4 v[152:155], v6, s[4:7], s39 offen sc1
s_add_u32 s39, s49, 13107200
buffer_load_dwordx4 v[156:159], v6, s[4:7], s39 offen sc1
s_add_u32 s39, s49, 135004160
buffer_load_dwordx4 v[160:163], v6, s[4:7], s39 offen sc1
s_add_u32 s39, s49, 139198464
buffer_load_dwordx4 v[164:167], v6, s[4:7], s39 offen sc1
s_add_u32 s39, s49, 143392768
buffer_load_dwordx4 v[168:171], v6, s[4:7], s39 offen sc1
s_add_u32 s39, s49, 147587072
buffer_load_dwordx4 v[172:175], v6, s[4:7], s39 offen sc1
s_add_u32 s39, s49, 151781376
buffer_load_dwordx4 v[176:179], v6, s[4:7], s39 offen sc1
s_add_u32 s39, s49, 155975680
buffer_load_dwordx4 v[180:183], v6, s[4:7], s39 offen sc1
s_add_u32 s39, s49, 160169984
buffer_load_dwordx4 v[184:187], v6, s[4:7], s39 offen sc1
s_add_u32 s39, s49, 13369344
buffer_load_dwordx4 v[188:191], v6, s[4:7], s39 offen sc1
s_waitcnt vmcnt(24)
v_dot2_f32_bf16 v24, v64, s60, 0
v_dot2_f32_bf16 v25, v64, s61, 0
v_dot2_f32_bf16 v26, v65, s60, 0
v_dot2_f32_bf16 v27, v65, s61, 0
v_dot2_f32_bf16 v28, v66, s60, 0
v_dot2_f32_bf16 v29, v66, s61, 0
v_dot2_f32_bf16 v30, v67, s60, 0
v_dot2_f32_bf16 v31, v67, s61, 0
v_dot2_f32_bf16 v24, v68, s60, v24
v_dot2_f32_bf16 v25, v68, s61, v25
v_dot2_f32_bf16 v26, v69, s60, v26
v_dot2_f32_bf16 v27, v69, s61, v27
v_dot2_f32_bf16 v28, v70, s60, v28
v_dot2_f32_bf16 v29, v70, s61, v29
v_dot2_f32_bf16 v30, v71, s60, v30
v_dot2_f32_bf16 v31, v71, s61, v31
v_dot2_f32_bf16 v24, v72, s60, v24
v_dot2_f32_bf16 v25, v72, s61, v25
v_dot2_f32_bf16 v26, v73, s60, v26
v_dot2_f32_bf16 v27, v73, s61, v27
v_dot2_f32_bf16 v28, v74, s60, v28
v_dot2_f32_bf16 v29, v74, s61, v29
v_dot2_f32_bf16 v30, v75, s60, v30
v_dot2_f32_bf16 v31, v75, s61, v31
v_dot2_f32_bf16 v24, v76, s60, v24
v_dot2_f32_bf16 v25, v76, s61, v25
v_dot2_f32_bf16 v26, v77, s60, v26
v_dot2_f32_bf16 v27, v77, s61, v27
v_dot2_f32_bf16 v28, v78, s60, v28
v_dot2_f32_bf16 v29, v78, s61, v29
v_dot2_f32_bf16 v30, v79, s60, v30
v_dot2_f32_bf16 v31, v79, s61, v31
v_dot2_f32_bf16 v24, v80, s60, v24
v_dot2_f32_bf16 v25, v80, s61, v25
v_dot2_f32_bf16 v26, v81, s60, v26
v_dot2_f32_bf16 v27, v81, s61, v27
v_dot2_f32_bf16 v28, v82, s60, v28
v_dot2_f32_bf16 v29, v82, s61, v29
v_dot2_f32_bf16 v30, v83, s60, v30
v_dot2_f32_bf16 v31, v83, s61, v31
v_dot2_f32_bf16 v24, v84, s60, v24
v_dot2_f32_bf16 v25, v84, s61, v25
v_dot2_f32_bf16 v26, v85, s60, v26
v_dot2_f32_bf16 v27, v85, s61, v27
v_dot2_f32_bf16 v28, v86, s60, v28
v_dot2_f32_bf16 v29, v86, s61, v29
v_dot2_f32_bf16 v30, v87, s60, v30
v_dot2_f32_bf16 v31, v87, s61, v31
v_dot2_f32_bf16 v24, v88, s60, v24
v_dot2_f32_bf16 v25, v88, s61, v25
v_dot2_f32_bf16 v26, v89, s60, v26
v_dot2_f32_bf16 v27, v89, s61, v27
v_dot2_f32_bf16 v28, v90, s60, v28
v_dot2_f32_bf16 v29, v90, s61, v29
v_dot2_f32_bf16 v30, v91, s60, v30
v_dot2_f32_bf16 v31, v91, s61, v31
v_lshlrev_b32 v32, 16, v92
v_and_b32 v33, 0xffff0000, v92
v_lshlrev_b32 v34, 16, v93
v_and_b32 v35, 0xffff0000, v93
v_lshlrev_b32 v36, 16, v94
v_and_b32 v37, 0xffff0000, v94
v_lshlrev_b32 v38, 16, v95
v_and_b32 v39, 0xffff0000, v95
v_pk_fma_f32 v[32:33], v[24:25], v[16:17], v[32:33]
v_pk_fma_f32 v[34:35], v[26:27], v[18:19], v[34:35]
v_pk_fma_f32 v[36:37], v[28:29], v[20:21], v[36:37]
v_pk_fma_f32 v[38:39], v[30:31], v[22:23], v[38:39]
v_cvt_pk_bf16_f32 v40, v32, v33
v_cvt_pk_bf16_f32 v41, v34, v35
v_cvt_pk_bf16_f32 v42, v36, v37
v_cvt_pk_bf16_f32 v43, v38, v39
s_add_u32 s39, s49, 0
buffer_store_dwordx4 v[40:43], v7, s[8:11], s39 offen sc1
s_waitcnt vmcnt(17)
v_dot2_f32_bf16 v24, v96, s60, 0
v_dot2_f32_bf16 v25, v96, s61, 0
v_dot2_f32_bf16 v26, v97, s60, 0
v_dot2_f32_bf16 v27, v97, s61, 0
v_dot2_f32_bf16 v28, v98, s60, 0
v_dot2_f32_bf16 v29, v98, s61, 0
v_dot2_f32_bf16 v30, v99, s60, 0
v_dot2_f32_bf16 v31, v99, s61, 0
v_dot2_f32_bf16 v24, v100, s60, v24
v_dot2_f32_bf16 v25, v100, s61, v25
v_dot2_f32_bf16 v26, v101, s60, v26
v_dot2_f32_bf16 v27, v101, s61, v27
v_dot2_f32_bf16 v28, v102, s60, v28
v_dot2_f32_bf16 v29, v102, s61, v29
v_dot2_f32_bf16 v30, v103, s60, v30
v_dot2_f32_bf16 v31, v103, s61, v31
v_dot2_f32_bf16 v24, v104, s60, v24
v_dot2_f32_bf16 v25, v104, s61, v25
v_dot2_f32_bf16 v26, v105, s60, v26
v_dot2_f32_bf16 v27, v105, s61, v27
v_dot2_f32_bf16 v28, v106, s60, v28
v_dot2_f32_bf16 v29, v106, s61, v29
v_dot2_f32_bf16 v30, v107, s60, v30
v_dot2_f32_bf16 v31, v107, s61, v31
v_dot2_f32_bf16 v24, v108, s60, v24
v_dot2_f32_bf16 v25, v108, s61, v25
v_dot2_f32_bf16 v26, v109, s60, v26
v_dot2_f32_bf16 v27, v109, s61, v27
v_dot2_f32_bf16 v28, v110, s60, v28
v_dot2_f32_bf16 v29, v110, s61, v29
v_dot2_f32_bf16 v30, v111, s60, v30
v_dot2_f32_bf16 v31, v111, s61, v31
v_dot2_f32_bf16 v24, v112, s60, v24
v_dot2_f32_bf16 v25, v112, s61, v25
v_dot2_f32_bf16 v26, v113, s60, v26
v_dot2_f32_bf16 v27, v113, s61, v27
v_dot2_f32_bf16 v28, v114, s60, v28
v_dot2_f32_bf16 v29, v114, s61, v29
v_dot2_f32_bf16 v30, v115, s60, v30
v_dot2_f32_bf16 v31, v115, s61, v31
v_dot2_f32_bf16 v24, v116, s60, v24
v_dot2_f32_bf16 v25, v116, s61, v25
v_dot2_f32_bf16 v26, v117, s60, v26
v_dot2_f32_bf16 v27, v117, s61, v27
v_dot2_f32_bf16 v28, v118, s60, v28
v_dot2_f32_bf16 v29, v118, s61, v29
v_dot2_f32_bf16 v30, v119, s60, v30
v_dot2_f32_bf16 v31, v119, s61, v31
v_dot2_f32_bf16 v24, v120, s60, v24
v_dot2_f32_bf16 v25, v120, s61, v25
v_dot2_f32_bf16 v26, v121, s60, v26
v_dot2_f32_bf16 v27, v121, s61, v27
v_dot2_f32_bf16 v28, v122, s60, v28
v_dot2_f32_bf16 v29, v122, s61, v29
v_dot2_f32_bf16 v30, v123, s60, v30
v_dot2_f32_bf16 v31, v123, s61, v31
v_lshlrev_b32 v32, 16, v124
v_and_b32 v33, 0xffff0000, v124
v_lshlrev_b32 v34, 16, v125
v_and_b32 v35, 0xffff0000, v125
v_lshlrev_b32 v36, 16, v126
v_and_b32 v37, 0xffff0000, v126
v_lshlrev_b32 v38, 16, v127
v_and_b32 v39, 0xffff0000, v127
v_pk_fma_f32 v[32:33], v[24:25], v[16:17], v[32:33]
v_pk_fma_f32 v[34:35], v[26:27], v[18:19], v[34:35]
v_pk_fma_f32 v[36:37], v[28:29], v[20:21], v[36:37]
v_pk_fma_f32 v[38:39], v[30:31], v[22:23], v[38:39]
v_cvt_pk_bf16_f32 v44, v32, v33
v_cvt_pk_bf16_f32 v45, v34, v35
v_cvt_pk_bf16_f32 v46, v36, v37
v_cvt_pk_bf16_f32 v47, v38, v39
s_add_u32 s39, s49, 262144
buffer_store_dwordx4 v[44:47], v7, s[8:11], s39 offen sc1
s_waitcnt vmcnt(10)
v_dot2_f32_bf16 v24, v128, s60, 0
v_dot2_f32_bf16 v25, v128, s61, 0
v_dot2_f32_bf16 v26, v129, s60, 0
v_dot2_f32_bf16 v27, v129, s61, 0
v_dot2_f32_bf16 v28, v130, s60, 0
v_dot2_f32_bf16 v29, v130, s61, 0
v_dot2_f32_bf16 v30, v131, s60, 0
v_dot2_f32_bf16 v31, v131, s61, 0
v_dot2_f32_bf16 v24, v132, s60, v24
v_dot2_f32_bf16 v25, v132, s61, v25
v_dot2_f32_bf16 v26, v133, s60, v26
v_dot2_f32_bf16 v27, v133, s61, v27
v_dot2_f32_bf16 v28, v134, s60, v28
v_dot2_f32_bf16 v29, v134, s61, v29
v_dot2_f32_bf16 v30, v135, s60, v30
v_dot2_f32_bf16 v31, v135, s61, v31
v_dot2_f32_bf16 v24, v136, s60, v24
v_dot2_f32_bf16 v25, v136, s61, v25
v_dot2_f32_bf16 v26, v137, s60, v26
v_dot2_f32_bf16 v27, v137, s61, v27
v_dot2_f32_bf16 v28, v138, s60, v28
v_dot2_f32_bf16 v29, v138, s61, v29
v_dot2_f32_bf16 v30, v139, s60, v30
v_dot2_f32_bf16 v31, v139, s61, v31
v_dot2_f32_bf16 v24, v140, s60, v24
v_dot2_f32_bf16 v25, v140, s61, v25
v_dot2_f32_bf16 v26, v141, s60, v26
v_dot2_f32_bf16 v27, v141, s61, v27
v_dot2_f32_bf16 v28, v142, s60, v28
v_dot2_f32_bf16 v29, v142, s61, v29
v_dot2_f32_bf16 v30, v143, s60, v30
v_dot2_f32_bf16 v31, v143, s61, v31
v_dot2_f32_bf16 v24, v144, s60, v24
v_dot2_f32_bf16 v25, v144, s61, v25
v_dot2_f32_bf16 v26, v145, s60, v26
v_dot2_f32_bf16 v27, v145, s61, v27
v_dot2_f32_bf16 v28, v146, s60, v28
v_dot2_f32_bf16 v29, v146, s61, v29
v_dot2_f32_bf16 v30, v147, s60, v30
v_dot2_f32_bf16 v31, v147, s61, v31
v_dot2_f32_bf16 v24, v148, s60, v24
v_dot2_f32_bf16 v25, v148, s61, v25
v_dot2_f32_bf16 v26, v149, s60, v26
v_dot2_f32_bf16 v27, v149, s61, v27
v_dot2_f32_bf16 v28, v150, s60, v28
v_dot2_f32_bf16 v29, v150, s61, v29
v_dot2_f32_bf16 v30, v151, s60, v30
v_dot2_f32_bf16 v31, v151, s61, v31
v_dot2_f32_bf16 v24, v152, s60, v24
v_dot2_f32_bf16 v25, v152, s61, v25
v_dot2_f32_bf16 v26, v153, s60, v26
v_dot2_f32_bf16 v27, v153, s61, v27
v_dot2_f32_bf16 v28, v154, s60, v28
v_dot2_f32_bf16 v29, v154, s61, v29
v_dot2_f32_bf16 v30, v155, s60, v30
v_dot2_f32_bf16 v31, v155, s61, v31
v_lshlrev_b32 v32, 16, v156
v_and_b32 v33, 0xffff0000, v156
v_lshlrev_b32 v34, 16, v157
v_and_b32 v35, 0xffff0000, v157
v_lshlrev_b32 v36, 16, v158
v_and_b32 v37, 0xffff0000, v158
v_lshlrev_b32 v38, 16, v159
v_and_b32 v39, 0xffff0000, v159
v_pk_fma_f32 v[32:33], v[24:25], v[16:17], v[32:33]
v_pk_fma_f32 v[34:35], v[26:27], v[18:19], v[34:35]
v_pk_fma_f32 v[36:37], v[28:29], v[20:21], v[36:37]
v_pk_fma_f32 v[38:39], v[30:31], v[22:23], v[38:39]
v_cvt_pk_bf16_f32 v48, v32, v33
v_cvt_pk_bf16_f32 v49, v34, v35
v_cvt_pk_bf16_f32 v50, v36, v37
v_cvt_pk_bf16_f32 v51, v38, v39
s_add_u32 s39, s49, 524288
buffer_store_dwordx4 v[48:51], v7, s[8:11], s39 offen sc1
s_waitcnt vmcnt(3)
v_dot2_f32_bf16 v24, v160, s60, 0
v_dot2_f32_bf16 v25, v160, s61, 0
v_dot2_f32_bf16 v26, v161, s60, 0
v_dot2_f32_bf16 v27, v161, s61, 0
v_dot2_f32_bf16 v28, v162, s60, 0
v_dot2_f32_bf16 v29, v162, s61, 0
v_dot2_f32_bf16 v30, v163, s60, 0
v_dot2_f32_bf16 v31, v163, s61, 0
v_dot2_f32_bf16 v24, v164, s60, v24
v_dot2_f32_bf16 v25, v164, s61, v25
v_dot2_f32_bf16 v26, v165, s60, v26
v_dot2_f32_bf16 v27, v165, s61, v27
v_dot2_f32_bf16 v28, v166, s60, v28
v_dot2_f32_bf16 v29, v166, s61, v29
v_dot2_f32_bf16 v30, v167, s60, v30
v_dot2_f32_bf16 v31, v167, s61, v31
v_dot2_f32_bf16 v24, v168, s60, v24
v_dot2_f32_bf16 v25, v168, s61, v25
v_dot2_f32_bf16 v26, v169, s60, v26
v_dot2_f32_bf16 v27, v169, s61, v27
v_dot2_f32_bf16 v28, v170, s60, v28
v_dot2_f32_bf16 v29, v170, s61, v29
v_dot2_f32_bf16 v30, v171, s60, v30
v_dot2_f32_bf16 v31, v171, s61, v31
v_dot2_f32_bf16 v24, v172, s60, v24
v_dot2_f32_bf16 v25, v172, s61, v25
v_dot2_f32_bf16 v26, v173, s60, v26
v_dot2_f32_bf16 v27, v173, s61, v27
v_dot2_f32_bf16 v28, v174, s60, v28
v_dot2_f32_bf16 v29, v174, s61, v29
v_dot2_f32_bf16 v30, v175, s60, v30
v_dot2_f32_bf16 v31, v175, s61, v31
v_dot2_f32_bf16 v24, v176, s60, v24
v_dot2_f32_bf16 v25, v176, s61, v25
v_dot2_f32_bf16 v26, v177, s60, v26
v_dot2_f32_bf16 v27, v177, s61, v27
v_dot2_f32_bf16 v28, v178, s60, v28
v_dot2_f32_bf16 v29, v178, s61, v29
v_dot2_f32_bf16 v30, v179, s60, v30
v_dot2_f32_bf16 v31, v179, s61, v31
v_dot2_f32_bf16 v24, v180, s60, v24
v_dot2_f32_bf16 v25, v180, s61, v25
v_dot2_f32_bf16 v26, v181, s60, v26
v_dot2_f32_bf16 v27, v181, s61, v27
v_dot2_f32_bf16 v28, v182, s60, v28
v_dot2_f32_bf16 v29, v182, s61, v29
v_dot2_f32_bf16 v30, v183, s60, v30
v_dot2_f32_bf16 v31, v183, s61, v31
v_dot2_f32_bf16 v24, v184, s60, v24
v_dot2_f32_bf16 v25, v184, s61, v25
v_dot2_f32_bf16 v26, v185, s60, v26
v_dot2_f32_bf16 v27, v185, s61, v27
v_dot2_f32_bf16 v28, v186, s60, v28
v_dot2_f32_bf16 v29, v186, s61, v29
v_dot2_f32_bf16 v30, v187, s60, v30
v_dot2_f32_bf16 v31, v187, s61, v31
v_lshlrev_b32 v32, 16, v188
v_and_b32 v33, 0xffff0000, v188
v_lshlrev_b32 v34, 16, v189
v_and_b32 v35, 0xffff0000, v189
v_lshlrev_b32 v36, 16, v190
v_and_b32 v37, 0xffff0000, v190
v_lshlrev_b32 v38, 16, v191
v_and_b32 v39, 0xffff0000, v191
v_pk_fma_f32 v[32:33], v[24:25], v[16:17], v[32:33]
v_pk_fma_f32 v[34:35], v[26:27], v[18:19], v[34:35]
v_pk_fma_f32 v[36:37], v[28:29], v[20:21], v[36:37]
v_pk_fma_f32 v[38:39], v[30:31], v[22:23], v[38:39]
v_cvt_pk_bf16_f32 v52, v32, v33
v_cvt_pk_bf16_f32 v53, v34, v35
v_cvt_pk_bf16_f32 v54, v36, v37
v_cvt_pk_bf16_f32 v55, v38, v39
s_add_u32 s39, s49, 786432
buffer_store_dwordx4 v[52:55], v7, s[8:11], s39 offen sc1
s_add_u32 s36, s36, 16
s_cmp_lt_u32 s36, 48
s_cbranch_scc1 Lfin_612
Lfin_615:
s_add_u32 s48, s36, 1
Lbw_616:
buffer_load_dword v3, v2, s[4:7], s47 offen sc1
s_waitcnt vmcnt(0)
v_cmp_gt_u32 vcc, s48, v3
s_cbranch_vccz Lbo_617
s_sub_u32 s37, s37, 1
s_cbranch_scc1 Lend_7
s_sleep 4
s_branch Lbw_616
Lbo_617:
s_lshl_b32 s49, s36, 16
s_add_u32 s39, s49, 134217728
buffer_load_dwordx4 v[64:67], v6, s[4:7], s39 offen sc1
s_add_u32 s39, s49, 138412032
buffer_load_dwordx4 v[68:71], v6, s[4:7], s39 offen sc1
s_add_u32 s39, s49, 142606336
buffer_load_dwordx4 v[72:75], v6, s[4:7], s39 offen sc1
s_add_u32 s39, s49, 146800640
buffer_load_dwordx4 v[76:79], v6, s[4:7], s39 offen sc1
s_add_u32 s39, s49, 150994944
buffer_load_dwordx4 v[80:83], v6, s[4:7], s39 offen sc1
s_add_u32 s39, s49, 155189248
buffer_load_dwordx4 v[84:87], v6, s[4:7], s39 offen sc1
s_add_u32 s39, s49, 159383552
buffer_load_dwordx4 v[88:91], v6, s[4:7], s39 offen sc1
s_add_u32 s39, s49, 12582912
buffer_load_dwordx4 v[92:95], v6, s[4:7], s39 offen sc1
s_waitcnt vmcnt(0)
v_dot2_f32_bf16 v24, v64, s60, 0
v_dot2_f32_bf16 v25, v64, s61, 0
v_dot2_f32_bf16 v26, v65, s60, 0
v_dot2_f32_bf16 v27, v65, s61, 0
v_dot2_f32_bf16 v28, v66, s60, 0
v_dot2_f32_bf16 v29, v66, s61, 0
v_dot2_f32_bf16 v30, v67, s60, 0
v_dot2_f32_bf16 v31, v67, s61, 0
v_dot2_f32_bf16 v24, v68, s60, v24
v_dot2_f32_bf16 v25, v68, s61, v25
v_dot2_f32_bf16 v26, v69, s60, v26
v_dot2_f32_bf16 v27, v69, s61, v27
v_dot2_f32_bf16 v28, v70, s60, v28
v_dot2_f32_bf16 v29, v70, s61, v29
v_dot2_f32_bf16 v30, v71, s60, v30
v_dot2_f32_bf16 v31, v71, s61, v31
v_dot2_f32_bf16 v24, v72, s60, v24
v_dot2_f32_bf16 v25, v72, s61, v25
v_dot2_f32_bf16 v26, v73, s60, v26
v_dot2_f32_bf16 v27, v73, s61, v27
v_dot2_f32_bf16 v28, v74, s60, v28
v_dot2_f32_bf16 v29, v74, s61, v29
v_dot2_f32_bf16 v30, v75, s60, v30
v_dot2_f32_bf16 v31, v75, s61, v31
v_dot2_f32_bf16 v24, v76, s60, v24
v_dot2_f32_bf16 v25, v76, s61, v25
v_dot2_f32_bf16 v26, v77, s60, v26
v_dot2_f32_bf16 v27, v77, s61, v27
v_dot2_f32_bf16 v28, v78, s60, v28
v_dot2_f32_bf16 v29, v78, s61, v29
v_dot2_f32_bf16 v30, v79, s60, v30
v_dot2_f32_bf16 v31, v79, s61, v31
v_dot2_f32_bf16 v24, v80, s60, v24
v_dot2_f32_bf16 v25, v80, s61, v25
v_dot2_f32_bf16 v26, v81, s60, v26
v_dot2_f32_bf16 v27, v81, s61, v27
v_dot2_f32_bf16 v28, v82, s60, v28
v_dot2_f32_bf16 v29, v82, s61, v29
v_dot2_f32_bf16 v30, v83, s60, v30
v_dot2_f32_bf16 v31, v83, s61, v31
v_dot2_f32_bf16 v24, v84, s60, v24
v_dot2_f32_bf16 v25, v84, s61, v25
v_dot2_f32_bf16 v26, v85, s60, v26
v_dot2_f32_bf16 v27, v85, s61, v27
v_dot2_f32_bf16 v28, v86, s60, v28
v_dot2_f32_bf16 v29, v86, s61, v29
v_dot2_f32_bf16 v30, v87, s60, v30
v_dot2_f32_bf16 v31, v87, s61, v31
v_dot2_f32_bf16 v24, v88, s60, v24
v_dot2_f32_bf16 v25, v88, s61, v25
v_dot2_f32_bf16 v26, v89, s60, v26
v_dot2_f32_bf16 v27, v89, s61, v27
v_dot2_f32_bf16 v28, v90, s60, v28
v_dot2_f32_bf16 v29, v90, s61, v29
v_dot2_f32_bf16 v30, v91, s60, v30
v_dot2_f32_bf16 v31, v91, s61, v31
v_lshlrev_b32 v32, 16, v92
v_and_b32 v33, 0xffff0000, v92
v_lshlrev_b32 v34, 16, v93
v_and_b32 v35, 0xffff0000, v93
v_lshlrev_b32 v36, 16, v94
v_and_b32 v37, 0xffff0000, v94
v_lshlrev_b32 v38, 16, v95
v_and_b32 v39, 0xffff0000, v95
v_pk_fma_f32 v[32:33], v[24:25], v[16:17], v[32:33]
v_pk_fma_f32 v[34:35], v[26:27], v[18:19], v[34:35]
v_pk_fma_f32 v[36:37], v[28:29], v[20:21], v[36:37]
v_pk_fma_f32 v[38:39], v[30:31], v[22:23], v[38:39]
v_cvt_pk_bf16_f32 v40, v32, v33
v_cvt_pk_bf16_f32 v41, v34, v35
v_cvt_pk_bf16_f32 v42, v36, v37
v_cvt_pk_bf16_f32 v43, v38, v39
s_add_u32 s39, s49, 0
buffer_store_dwordx4 v[40:43], v7, s[8:11], s39 offen sc1
s_add_u32 s36, s36, 4
s_cmp_lt_u32 s36, 64
s_cbranch_scc1 Lfin_615
s_endpgm
Lend_7:
s_endpgm
Lhelper_5:
v_mov_b32 v9, v1
s_sub_u32 s52, s33, 4
s_lshl_b32 s26, s34, 2
s_add_u32 s26, s26, s52
s_sub_u32 s26, s26, 64
s_mul_i32 s44, s52, 14
s_add_u32 s44, s44, s34
s_sub_u32 s44, s44, 16
s_lshl_b32 s53, s52, 1
s_add_u32 s53, s53, s34
s_add_u32 s53, s53, 26
s_cmp_ge_u32 s34, 30
s_cselect_b32 s44, s53, s44
s_load_dwordx2 s[16:17], s[0:1], 96
s_load_dwordx2 s[18:19], s[0:1], 88
s_load_dwordx2 s[20:21], s[0:1], 0
s_lshl_b32 s38, s26, 7
s_add_u32 s38, s38, 3424256
v_min_u32 v80, 1, v0
v_lshl_add_u32 v10, v80, 30, s38
s_lshl_b32 s38, s44, 7
s_add_u32 s38, s38, 3416064
v_min_u32 v80, 1, v0
v_lshl_add_u32 v8, v80, 30, s38
v_mov_b32 v14, 0
v_mov_b32 v15, 0
buffer_store_dword v14, v10, s[4:7], 0 offen sc1
buffer_store_dwordx2 v[14:15], v8, s[4:7], 0 offen sc1
s_waitcnt lgkmcnt(0)
s_mov_b32 s8, s16
s_and_b32 s9, s17, 0xffff
s_mov_b32 s10, 0xc00000
s_mov_b32 s11, 0x20000
s_mov_b32 s84, s18
s_and_b32 s85, s19, 0xffff
s_mov_b32 s86, 0x800
s_mov_b32 s87, 0x20000
s_mov_b32 s88, s20
s_and_b32 s89, s21, 0xffff
s_mov_b32 s90, 0x400000
s_mov_b32 s91, 0x20000
v_and_b32 v12, 15, v9
v_lshlrev_b32 v12, 4, v12
s_lshl_b32 s38, s32, 2
v_add_u32 v11, s38, v12
v_lshlrev_b32 v13, 4, v9
v_lshrrev_b32 v7, 4, v9
v_lshlrev_b32 v6, 7, v12
v_lshl_add_u32 v6, v7, 4, v6
v_lshlrev_b32 v7, 5, v7
s_lshr_b32 s60, s26, 1
s_and_b32 s61, s26, 1
s_lshl_b32 s62, s60, 8
s_lshl_b32 s38, s61, 13
s_add_u32 s62, s62, s38
s_add_u32 s62, s62, 3178496
s_min_u32 s38, s32, 1
s_lshl_b32 s38, s38, 30
s_add_u32 s38, s38, s62
v_lshlrev_b32 v2, 2, v9
v_mov_b32 v3, -1
buffer_store_dword v3, v2, s[4:7], s38 offen sc1
s_mov_b32 s52, 1
s_waitcnt vmcnt(0)
s_cmp_lg_u32 s32, 0
s_cbranch_scc1 Lar_618
s_mov_b64 exec, 1
v_mov_b32 v14, 160
v_mov_b32 v15, s52
buffer_atomic_add v15, v14, s[12:15], 0 offen sc1
s_mov_b64 exec, -1
Lar_618:
v_lshrrev_b32 v2, 3, v0
v_and_b32 v3, 7, v0
v_mul_u32_u24 v4, 12288, v2
v_lshl_add_u32 v4, v3, 4, v4
v_lshlrev_b32 v5, 1, v2
v_mov_b32 v96, 0
v_mov_b32 v97, 0
v_mov_b32 v98, 0
v_mov_b32 v99, 0
v_mov_b32 v100, 0
v_mov_b32 v101, 0
v_mov_b32 v102, 0
v_mov_b32 v103, 0
s_lshl_b32 s41, s61, 10
s_mul_i32 s40, s61, 6291456
s_lshl_b32 s42, s60, 7
s_add_u32 s40, s40, s42
buffer_load_ushort v80, v5, s[84:87], s41 offen offset:0
buffer_load_ushort v81, v5, s[84:87], s41 offen offset:64
buffer_load_ushort v82, v5, s[84:87], s41 offen offset:128
buffer_load_ushort v83, v5, s[84:87], s41 offen offset:192
buffer_load_ushort v84, v5, s[84:87], s41 offen offset:256
buffer_load_ushort v85, v5, s[84:87], s41 offen offset:320
buffer_load_ushort v86, v5, s[84:87], s41 offen offset:384
buffer_load_ushort v87, v5, s[84:87], s41 offen offset:448
buffer_load_ushort v88, v5, s[84:87], s41 offen offset:512
buffer_load_ushort v89, v5, s[84:87], s41 offen offset:576
buffer_load_ushort v90, v5, s[84:87], s41 offen offset:640
buffer_load_ushort v91, v5, s[84:87], s41 offen offset:704
buffer_load_ushort v92, v5, s[84:87], s41 offen offset:768
buffer_load_ushort v93, v5, s[84:87], s41 offen offset:832
buffer_load_ushort v94, v5, s[84:87], s41 offen offset:896
buffer_load_ushort v95, v5, s[84:87], s41 offen offset:960
buffer_load_dwordx4 v[16:19], v4, s[8:11], s40 offen
s_add_u32 s40, s40, 393216
buffer_load_dwordx4 v[20:23], v4, s[8:11], s40 offen
s_add_u32 s40, s40, 393216
buffer_load_dwordx4 v[24:27], v4, s[8:11], s40 offen
s_add_u32 s40, s40, 393216
buffer_load_dwordx4 v[28:31], v4, s[8:11], s40 offen
s_add_u32 s40, s40, 393216
buffer_load_dwordx4 v[32:35], v4, s[8:11], s40 offen
s_add_u32 s40, s40, 393216
buffer_load_dwordx4 v[36:39], v4, s[8:11], s40 offen
s_add_u32 s40, s40, 393216
buffer_load_dwordx4 v[40:43], v4, s[8:11], s40 offen
s_add_u32 s40, s40, 393216
buffer_load_dwordx4 v[44:47], v4, s[8:11], s40 offen
s_add_u32 s40, s40, 393216
buffer_load_dwordx4 v[48:51], v4, s[8:11], s40 offen
s_add_u32 s40, s40, 393216
buffer_load_dwordx4 v[52:55], v4, s[8:11], s40 offen
s_add_u32 s40, s40, 393216
buffer_load_dwordx4 v[56:59], v4, s[8:11], s40 offen
s_add_u32 s40, s40, 393216
buffer_load_dwordx4 v[60:63], v4, s[8:11], s40 offen
s_add_u32 s40, s40, 393216
buffer_load_dwordx4 v[64:67], v4, s[8:11], s40 offen
s_add_u32 s40, s40, 393216
buffer_load_dwordx4 v[68:71], v4, s[8:11], s40 offen
s_add_u32 s40, s40, 393216
buffer_load_dwordx4 v[72:75], v4, s[8:11], s40 offen
s_add_u32 s40, s40, 393216
buffer_load_dwordx4 v[76:79], v4, s[8:11], s40 offen
s_add_u32 s40, s40, 393216
s_add_u32 s52, s26, 0
s_lshl_b32 s41, s52, 15
s_lshl_b32 s42, s32, 9
s_add_u32 s41, s41, s42
buffer_load_dwordx4 a[0:3], v6, s[88:91], s41 offen offset:0
buffer_load_dwordx4 a[4:7], v6, s[88:91], s41 offen offset:64
buffer_load_dwordx4 a[8:11], v6, s[88:91], s41 offen offset:128
buffer_load_dwordx4 a[12:15], v6, s[88:91], s41 offen offset:192
buffer_load_dwordx4 a[16:19], v6, s[88:91], s41 offen offset:256
buffer_load_dwordx4 a[20:23], v6, s[88:91], s41 offen offset:320
buffer_load_dwordx4 a[24:27], v6, s[88:91], s41 offen offset:384
buffer_load_dwordx4 a[28:31], v6, s[88:91], s41 offen offset:448
s_add_u32 s52, s26, 64
s_lshl_b32 s41, s52, 15
s_lshl_b32 s42, s32, 9
s_add_u32 s41, s41, s42
buffer_load_dwordx4 a[32:35], v6, s[88:91], s41 offen offset:0
buffer_load_dwordx4 a[36:39], v6, s[88:91], s41 offen offset:64
buffer_load_dwordx4 a[40:43], v6, s[88:91], s41 offen offset:128
buffer_load_dwordx4 a[44:47], v6, s[88:91], s41 offen offset:192
buffer_load_dwordx4 a[48:51], v6, s[88:91], s41 offen offset:256
buffer_load_dwordx4 a[52:55], v6, s[88:91], s41 offen offset:320
buffer_load_dwordx4 a[56:59], v6, s[88:91], s41 offen offset:384
buffer_load_dwordx4 a[60:63], v6, s[88:91], s41 offen offset:448
s_waitcnt vmcnt(32)
v_lshlrev_b32 v80, 16, v80
v_mul_f32 v104, 0xbfb8aa3b, v80
v_exp_f32 v104, v104
s_nop 0
v_add_f32 v104, 1.0, v104
v_rcp_f32 v104, v104
s_nop 0
v_mul_f32 v104, v104, v80
v_cvt_pk_bf16_f32 v80, 0, v104
v_lshlrev_b32 v81, 16, v81
v_mul_f32 v104, 0xbfb8aa3b, v81
v_exp_f32 v104, v104
s_nop 0
v_add_f32 v104, 1.0, v104
v_rcp_f32 v104, v104
s_nop 0
v_mul_f32 v104, v104, v81
v_cvt_pk_bf16_f32 v81, 0, v104
v_lshlrev_b32 v82, 16, v82
v_mul_f32 v104, 0xbfb8aa3b, v82
v_exp_f32 v104, v104
s_nop 0
v_add_f32 v104, 1.0, v104
v_rcp_f32 v104, v104
s_nop 0
v_mul_f32 v104, v104, v82
v_cvt_pk_bf16_f32 v82, 0, v104
v_lshlrev_b32 v83, 16, v83
v_mul_f32 v104, 0xbfb8aa3b, v83
v_exp_f32 v104, v104
s_nop 0
v_add_f32 v104, 1.0, v104
v_rcp_f32 v104, v104
s_nop 0
v_mul_f32 v104, v104, v83
v_cvt_pk_bf16_f32 v83, 0, v104
v_lshlrev_b32 v84, 16, v84
v_mul_f32 v104, 0xbfb8aa3b, v84
v_exp_f32 v104, v104
s_nop 0
v_add_f32 v104, 1.0, v104
v_rcp_f32 v104, v104
s_nop 0
v_mul_f32 v104, v104, v84
v_cvt_pk_bf16_f32 v84, 0, v104
v_lshlrev_b32 v85, 16, v85
v_mul_f32 v104, 0xbfb8aa3b, v85
v_exp_f32 v104, v104
s_nop 0
v_add_f32 v104, 1.0, v104
v_rcp_f32 v104, v104
s_nop 0
v_mul_f32 v104, v104, v85
v_cvt_pk_bf16_f32 v85, 0, v104
v_lshlrev_b32 v86, 16, v86
v_mul_f32 v104, 0xbfb8aa3b, v86
v_exp_f32 v104, v104
s_nop 0
v_add_f32 v104, 1.0, v104
v_rcp_f32 v104, v104
s_nop 0
v_mul_f32 v104, v104, v86
v_cvt_pk_bf16_f32 v86, 0, v104
v_lshlrev_b32 v87, 16, v87
v_mul_f32 v104, 0xbfb8aa3b, v87
v_exp_f32 v104, v104
s_nop 0
v_add_f32 v104, 1.0, v104
v_rcp_f32 v104, v104
s_nop 0
v_mul_f32 v104, v104, v87
v_cvt_pk_bf16_f32 v87, 0, v104
v_lshlrev_b32 v88, 16, v88
v_mul_f32 v104, 0xbfb8aa3b, v88
v_exp_f32 v104, v104
s_nop 0
v_add_f32 v104, 1.0, v104
v_rcp_f32 v104, v104
s_nop 0
v_mul_f32 v104, v104, v88
v_cvt_pk_bf16_f32 v88, 0, v104
v_lshlrev_b32 v89, 16, v89
v_mul_f32 v104, 0xbfb8aa3b, v89
v_exp_f32 v104, v104
s_nop 0
v_add_f32 v104, 1.0, v104
v_rcp_f32 v104, v104
s_nop 0
v_mul_f32 v104, v104, v89
v_cvt_pk_bf16_f32 v89, 0, v104
v_lshlrev_b32 v90, 16, v90
v_mul_f32 v104, 0xbfb8aa3b, v90
v_exp_f32 v104, v104
s_nop 0
v_add_f32 v104, 1.0, v104
v_rcp_f32 v104, v104
s_nop 0
v_mul_f32 v104, v104, v90
v_cvt_pk_bf16_f32 v90, 0, v104
v_lshlrev_b32 v91, 16, v91
v_mul_f32 v104, 0xbfb8aa3b, v91
v_exp_f32 v104, v104
s_nop 0
v_add_f32 v104, 1.0, v104
v_rcp_f32 v104, v104
s_nop 0
v_mul_f32 v104, v104, v91
v_cvt_pk_bf16_f32 v91, 0, v104
v_lshlrev_b32 v92, 16, v92
v_mul_f32 v104, 0xbfb8aa3b, v92
v_exp_f32 v104, v104
s_nop 0
v_add_f32 v104, 1.0, v104
v_rcp_f32 v104, v104
s_nop 0
v_mul_f32 v104, v104, v92
v_cvt_pk_bf16_f32 v92, 0, v104
v_lshlrev_b32 v93, 16, v93
v_mul_f32 v104, 0xbfb8aa3b, v93
v_exp_f32 v104, v104
s_nop 0
v_add_f32 v104, 1.0, v104
v_rcp_f32 v104, v104
s_nop 0
v_mul_f32 v104, v104, v93
v_cvt_pk_bf16_f32 v93, 0, v104
v_lshlrev_b32 v94, 16, v94
v_mul_f32 v104, 0xbfb8aa3b, v94
v_exp_f32 v104, v104
s_nop 0
v_add_f32 v104, 1.0, v104
v_rcp_f32 v104, v104
s_nop 0
v_mul_f32 v104, v104, v94
v_cvt_pk_bf16_f32 v94, 0, v104
v_lshlrev_b32 v95, 16, v95
v_mul_f32 v104, 0xbfb8aa3b, v95
v_exp_f32 v104, v104
s_nop 0
v_add_f32 v104, 1.0, v104
v_rcp_f32 v104, v104
s_nop 0
v_mul_f32 v104, v104, v95
v_cvt_pk_bf16_f32 v95, 0, v104
s_waitcnt vmcnt(31)
v_lshlrev_b32 v104, 16, v16
v_and_b32 v105, 0xffff0000, v16
v_fmac_f32 v96, v104, v80
v_fmac_f32 v97, v105, v80
v_lshlrev_b32 v104, 16, v17
v_and_b32 v105, 0xffff0000, v17
v_fmac_f32 v98, v104, v80
v_fmac_f32 v99, v105, v80
v_lshlrev_b32 v104, 16, v18
v_and_b32 v105, 0xffff0000, v18
v_fmac_f32 v100, v104, v80
v_fmac_f32 v101, v105, v80
v_lshlrev_b32 v104, 16, v19
v_and_b32 v105, 0xffff0000, v19
v_fmac_f32 v102, v104, v80
v_fmac_f32 v103, v105, v80
s_waitcnt vmcnt(30)
v_lshlrev_b32 v104, 16, v20
v_and_b32 v105, 0xffff0000, v20
v_fmac_f32 v96, v104, v81
v_fmac_f32 v97, v105, v81
v_lshlrev_b32 v104, 16, v21
v_and_b32 v105, 0xffff0000, v21
v_fmac_f32 v98, v104, v81
v_fmac_f32 v99, v105, v81
v_lshlrev_b32 v104, 16, v22
v_and_b32 v105, 0xffff0000, v22
v_fmac_f32 v100, v104, v81
v_fmac_f32 v101, v105, v81
v_lshlrev_b32 v104, 16, v23
v_and_b32 v105, 0xffff0000, v23
v_fmac_f32 v102, v104, v81
v_fmac_f32 v103, v105, v81
s_waitcnt vmcnt(29)
v_lshlrev_b32 v104, 16, v24
v_and_b32 v105, 0xffff0000, v24
v_fmac_f32 v96, v104, v82
v_fmac_f32 v97, v105, v82
v_lshlrev_b32 v104, 16, v25
v_and_b32 v105, 0xffff0000, v25
v_fmac_f32 v98, v104, v82
v_fmac_f32 v99, v105, v82
v_lshlrev_b32 v104, 16, v26
v_and_b32 v105, 0xffff0000, v26
v_fmac_f32 v100, v104, v82
v_fmac_f32 v101, v105, v82
v_lshlrev_b32 v104, 16, v27
v_and_b32 v105, 0xffff0000, v27
v_fmac_f32 v102, v104, v82
v_fmac_f32 v103, v105, v82
s_waitcnt vmcnt(28)
v_lshlrev_b32 v104, 16, v28
v_and_b32 v105, 0xffff0000, v28
v_fmac_f32 v96, v104, v83
v_fmac_f32 v97, v105, v83
v_lshlrev_b32 v104, 16, v29
v_and_b32 v105, 0xffff0000, v29
v_fmac_f32 v98, v104, v83
v_fmac_f32 v99, v105, v83
v_lshlrev_b32 v104, 16, v30
v_and_b32 v105, 0xffff0000, v30
v_fmac_f32 v100, v104, v83
v_fmac_f32 v101, v105, v83
v_lshlrev_b32 v104, 16, v31
v_and_b32 v105, 0xffff0000, v31
v_fmac_f32 v102, v104, v83
v_fmac_f32 v103, v105, v83
s_waitcnt vmcnt(27)
v_lshlrev_b32 v104, 16, v32
v_and_b32 v105, 0xffff0000, v32
v_fmac_f32 v96, v104, v84
v_fmac_f32 v97, v105, v84
v_lshlrev_b32 v104, 16, v33
v_and_b32 v105, 0xffff0000, v33
v_fmac_f32 v98, v104, v84
v_fmac_f32 v99, v105, v84
v_lshlrev_b32 v104, 16, v34
v_and_b32 v105, 0xffff0000, v34
v_fmac_f32 v100, v104, v84
v_fmac_f32 v101, v105, v84
v_lshlrev_b32 v104, 16, v35
v_and_b32 v105, 0xffff0000, v35
v_fmac_f32 v102, v104, v84
v_fmac_f32 v103, v105, v84
s_waitcnt vmcnt(26)
v_lshlrev_b32 v104, 16, v36
v_and_b32 v105, 0xffff0000, v36
v_fmac_f32 v96, v104, v85
v_fmac_f32 v97, v105, v85
v_lshlrev_b32 v104, 16, v37
v_and_b32 v105, 0xffff0000, v37
v_fmac_f32 v98, v104, v85
v_fmac_f32 v99, v105, v85
v_lshlrev_b32 v104, 16, v38
v_and_b32 v105, 0xffff0000, v38
v_fmac_f32 v100, v104, v85
v_fmac_f32 v101, v105, v85
v_lshlrev_b32 v104, 16, v39
v_and_b32 v105, 0xffff0000, v39
v_fmac_f32 v102, v104, v85
v_fmac_f32 v103, v105, v85
s_waitcnt vmcnt(25)
v_lshlrev_b32 v104, 16, v40
v_and_b32 v105, 0xffff0000, v40
v_fmac_f32 v96, v104, v86
v_fmac_f32 v97, v105, v86
v_lshlrev_b32 v104, 16, v41
v_and_b32 v105, 0xffff0000, v41
v_fmac_f32 v98, v104, v86
v_fmac_f32 v99, v105, v86
v_lshlrev_b32 v104, 16, v42
v_and_b32 v105, 0xffff0000, v42
v_fmac_f32 v100, v104, v86
v_fmac_f32 v101, v105, v86
v_lshlrev_b32 v104, 16, v43
v_and_b32 v105, 0xffff0000, v43
v_fmac_f32 v102, v104, v86
v_fmac_f32 v103, v105, v86
s_waitcnt vmcnt(24)
v_lshlrev_b32 v104, 16, v44
v_and_b32 v105, 0xffff0000, v44
v_fmac_f32 v96, v104, v87
v_fmac_f32 v97, v105, v87
v_lshlrev_b32 v104, 16, v45
v_and_b32 v105, 0xffff0000, v45
v_fmac_f32 v98, v104, v87
v_fmac_f32 v99, v105, v87
v_lshlrev_b32 v104, 16, v46
v_and_b32 v105, 0xffff0000, v46
v_fmac_f32 v100, v104, v87
v_fmac_f32 v101, v105, v87
v_lshlrev_b32 v104, 16, v47
v_and_b32 v105, 0xffff0000, v47
v_fmac_f32 v102, v104, v87
v_fmac_f32 v103, v105, v87
s_waitcnt vmcnt(23)
v_lshlrev_b32 v104, 16, v48
v_and_b32 v105, 0xffff0000, v48
v_fmac_f32 v96, v104, v88
v_fmac_f32 v97, v105, v88
v_lshlrev_b32 v104, 16, v49
v_and_b32 v105, 0xffff0000, v49
v_fmac_f32 v98, v104, v88
v_fmac_f32 v99, v105, v88
v_lshlrev_b32 v104, 16, v50
v_and_b32 v105, 0xffff0000, v50
v_fmac_f32 v100, v104, v88
v_fmac_f32 v101, v105, v88
v_lshlrev_b32 v104, 16, v51
v_and_b32 v105, 0xffff0000, v51
v_fmac_f32 v102, v104, v88
v_fmac_f32 v103, v105, v88
s_waitcnt vmcnt(22)
v_lshlrev_b32 v104, 16, v52
v_and_b32 v105, 0xffff0000, v52
v_fmac_f32 v96, v104, v89
v_fmac_f32 v97, v105, v89
v_lshlrev_b32 v104, 16, v53
v_and_b32 v105, 0xffff0000, v53
v_fmac_f32 v98, v104, v89
v_fmac_f32 v99, v105, v89
v_lshlrev_b32 v104, 16, v54
v_and_b32 v105, 0xffff0000, v54
v_fmac_f32 v100, v104, v89
v_fmac_f32 v101, v105, v89
v_lshlrev_b32 v104, 16, v55
v_and_b32 v105, 0xffff0000, v55
v_fmac_f32 v102, v104, v89
v_fmac_f32 v103, v105, v89
s_waitcnt vmcnt(21)
v_lshlrev_b32 v104, 16, v56
v_and_b32 v105, 0xffff0000, v56
v_fmac_f32 v96, v104, v90
v_fmac_f32 v97, v105, v90
v_lshlrev_b32 v104, 16, v57
v_and_b32 v105, 0xffff0000, v57
v_fmac_f32 v98, v104, v90
v_fmac_f32 v99, v105, v90
v_lshlrev_b32 v104, 16, v58
v_and_b32 v105, 0xffff0000, v58
v_fmac_f32 v100, v104, v90
v_fmac_f32 v101, v105, v90
v_lshlrev_b32 v104, 16, v59
v_and_b32 v105, 0xffff0000, v59
v_fmac_f32 v102, v104, v90
v_fmac_f32 v103, v105, v90
s_waitcnt vmcnt(20)
v_lshlrev_b32 v104, 16, v60
v_and_b32 v105, 0xffff0000, v60
v_fmac_f32 v96, v104, v91
v_fmac_f32 v97, v105, v91
v_lshlrev_b32 v104, 16, v61
v_and_b32 v105, 0xffff0000, v61
v_fmac_f32 v98, v104, v91
v_fmac_f32 v99, v105, v91
v_lshlrev_b32 v104, 16, v62
v_and_b32 v105, 0xffff0000, v62
v_fmac_f32 v100, v104, v91
v_fmac_f32 v101, v105, v91
v_lshlrev_b32 v104, 16, v63
v_and_b32 v105, 0xffff0000, v63
v_fmac_f32 v102, v104, v91
v_fmac_f32 v103, v105, v91
s_waitcnt vmcnt(19)
v_lshlrev_b32 v104, 16, v64
v_and_b32 v105, 0xffff0000, v64
v_fmac_f32 v96, v104, v92
v_fmac_f32 v97, v105, v92
v_lshlrev_b32 v104, 16, v65
v_and_b32 v105, 0xffff0000, v65
v_fmac_f32 v98, v104, v92
v_fmac_f32 v99, v105, v92
v_lshlrev_b32 v104, 16, v66
v_and_b32 v105, 0xffff0000, v66
v_fmac_f32 v100, v104, v92
v_fmac_f32 v101, v105, v92
v_lshlrev_b32 v104, 16, v67
v_and_b32 v105, 0xffff0000, v67
v_fmac_f32 v102, v104, v92
v_fmac_f32 v103, v105, v92
s_waitcnt vmcnt(18)
v_lshlrev_b32 v104, 16, v68
v_and_b32 v105, 0xffff0000, v68
v_fmac_f32 v96, v104, v93
v_fmac_f32 v97, v105, v93
v_lshlrev_b32 v104, 16, v69
v_and_b32 v105, 0xffff0000, v69
v_fmac_f32 v98, v104, v93
v_fmac_f32 v99, v105, v93
v_lshlrev_b32 v104, 16, v70
v_and_b32 v105, 0xffff0000, v70
v_fmac_f32 v100, v104, v93
v_fmac_f32 v101, v105, v93
v_lshlrev_b32 v104, 16, v71
v_and_b32 v105, 0xffff0000, v71
v_fmac_f32 v102, v104, v93
v_fmac_f32 v103, v105, v93
s_waitcnt vmcnt(17)
v_lshlrev_b32 v104, 16, v72
v_and_b32 v105, 0xffff0000, v72
v_fmac_f32 v96, v104, v94
v_fmac_f32 v97, v105, v94
v_lshlrev_b32 v104, 16, v73
v_and_b32 v105, 0xffff0000, v73
v_fmac_f32 v98, v104, v94
v_fmac_f32 v99, v105, v94
v_lshlrev_b32 v104, 16, v74
v_and_b32 v105, 0xffff0000, v74
v_fmac_f32 v100, v104, v94
v_fmac_f32 v101, v105, v94
v_lshlrev_b32 v104, 16, v75
v_and_b32 v105, 0xffff0000, v75
v_fmac_f32 v102, v104, v94
v_fmac_f32 v103, v105, v94
s_waitcnt vmcnt(16)
v_lshlrev_b32 v104, 16, v76
v_and_b32 v105, 0xffff0000, v76
v_fmac_f32 v96, v104, v95
v_fmac_f32 v97, v105, v95
v_lshlrev_b32 v104, 16, v77
v_and_b32 v105, 0xffff0000, v77
v_fmac_f32 v98, v104, v95
v_fmac_f32 v99, v105, v95
v_lshlrev_b32 v104, 16, v78
v_and_b32 v105, 0xffff0000, v78
v_fmac_f32 v100, v104, v95
v_fmac_f32 v101, v105, v95
v_lshlrev_b32 v104, 16, v79
v_and_b32 v105, 0xffff0000, v79
v_fmac_f32 v102, v104, v95
v_fmac_f32 v103, v105, v95
s_nop 1
v_add_f32_dpp v96, v96, v96 row_ror:8 row_mask:0xf bank_mask:0xf
v_add_f32_dpp v97, v97, v97 row_ror:8 row_mask:0xf bank_mask:0xf
v_add_f32_dpp v98, v98, v98 row_ror:8 row_mask:0xf bank_mask:0xf
v_add_f32_dpp v99, v99, v99 row_ror:8 row_mask:0xf bank_mask:0xf
v_add_f32_dpp v100, v100, v100 row_ror:8 row_mask:0xf bank_mask:0xf
v_add_f32_dpp v101, v101, v101 row_ror:8 row_mask:0xf bank_mask:0xf
v_add_f32_dpp v102, v102, v102 row_ror:8 row_mask:0xf bank_mask:0xf
v_add_f32_dpp v103, v103, v103 row_ror:8 row_mask:0xf bank_mask:0xf
v_mov_b32 v16, v96
v_mov_b32 v17, v97
v_mov_b32 v18, v98
v_mov_b32 v19, v99
v_mov_b32 v20, v100
v_mov_b32 v21, v101
v_mov_b32 v22, v102
v_mov_b32 v23, v103
v_permlane16_swap_b32 v96, v16
v_permlane16_swap_b32 v97, v17
v_permlane16_swap_b32 v98, v18
v_permlane16_swap_b32 v99, v19
v_permlane16_swap_b32 v100, v20
v_permlane16_swap_b32 v101, v21
v_permlane16_swap_b32 v102, v22
v_permlane16_swap_b32 v103, v23
v_add_f32 v96, v96, v16
v_add_f32 v97, v97, v17
v_add_f32 v98, v98, v18
v_add_f32 v99, v99, v19
v_add_f32 v100, v100, v20
v_add_f32 v101, v101, v21
v_add_f32 v102, v102, v22
v_add_f32 v103, v103, v23
v_mov_b32 v16, v96
v_mov_b32 v17, v97
v_mov_b32 v18, v98
v_mov_b32 v19, v99
v_mov_b32 v20, v100
v_mov_b32 v21, v101
v_mov_b32 v22, v102
v_mov_b32 v23, v103
v_permlane32_swap_b32 v96, v16
v_permlane32_swap_b32 v97, v17
v_permlane32_swap_b32 v98, v18
v_permlane32_swap_b32 v99, v19
v_permlane32_swap_b32 v100, v20
v_permlane32_swap_b32 v101, v21
v_permlane32_swap_b32 v102, v22
v_permlane32_swap_b32 v103, v23
v_add_f32 v96, v96, v16
v_add_f32 v97, v97, v17
v_add_f32 v98, v98, v18
v_add_f32 v99, v99, v19
v_add_f32 v100, v100, v20
v_add_f32 v101, v101, v21
v_add_f32 v102, v102, v22
v_add_f32 v103, v103, v23
s_lshl_b32 s40, s32, 8
v_lshl_add_u32 v2, v3, 5, s40
ds_write_b128 v2, v[96:99] offset:1024
ds_write_b128 v2, v[100:103] offset:1040
s_waitcnt lgkmcnt(0)
s_barrier
v_and_b32 v2, 63, v0
v_lshlrev_b32 v2, 2, v2
ds_read_b32 v96, v2 offset:1024
ds_read_b32 v97, v2 offset:1280
ds_read_b32 v98, v2 offset:1536
ds_read_b32 v99, v2 offset:1792
s_min_u32 s40, s32, 1
s_lshl_b32 s40, s40, 30
s_add_u32 s40, s40, s62
s_waitcnt lgkmcnt(0)
v_add_f32 v96, v96, v97
v_add_f32 v98, v98, v99
v_add_f32 v96, v96, v98
v_min_u32 v96, -2, v96
buffer_store_dword v96, v2, s[4:7], s40 offen sc1
Lst_619:
buffer_load_dword v14, off, s[12:15], 0 offset:160 sc1
buffer_load_dword v15, off, s[12:15], 0 offset:160 sc1
s_waitcnt vmcnt(0)
v_add_u32 v14, v14, v15
s_nop 0
v_readfirstlane_b32 s38, v14
s_nop 3
s_and_b32 s39, s38, 0xffff
s_cmp_eq_u32 s39, 0x100
s_cbranch_scc1 Lso_620
s_sub_u32 s37, s37, 1
s_cbranch_scc1 Lend_7
s_sleep 8
s_branch Lst_619
Lso_620:
s_bfe_u32 s35, s38, 0x80010
s_bfe_u32 s46, s38, 0x10018
s_lshl_b32 s46, s46, 13
s_barrier
s_add_u32 s52, s26, 0
v_accvgpr_read_b32 v16, a0
v_accvgpr_read_b32 v17, a1
v_accvgpr_read_b32 v18, a2
v_accvgpr_read_b32 v19, a3
v_accvgpr_read_b32 v20, a4
v_accvgpr_read_b32 v21, a5
v_accvgpr_read_b32 v22, a6
v_accvgpr_read_b32 v23, a7
v_accvgpr_read_b32 v24, a8
v_accvgpr_read_b32 v25, a9
v_accvgpr_read_b32 v26, a10
v_accvgpr_read_b32 v27, a11
v_accvgpr_read_b32 v28, a12
v_accvgpr_read_b32 v29, a13
v_accvgpr_read_b32 v30, a14
v_accvgpr_read_b32 v31, a15
v_accvgpr_read_b32 v32, a16
v_accvgpr_read_b32 v33, a17
v_accvgpr_read_b32 v34, a18
v_accvgpr_read_b32 v35, a19
v_accvgpr_read_b32 v36, a20
v_accvgpr_read_b32 v37, a21
v_accvgpr_read_b32 v38, a22
v_accvgpr_read_b32 v39, a23
v_accvgpr_read_b32 v40, a24
v_accvgpr_read_b32 v41, a25
v_accvgpr_read_b32 v42, a26
v_accvgpr_read_b32 v43, a27
v_accvgpr_read_b32 v44, a28
v_accvgpr_read_b32 v45, a29
v_accvgpr_read_b32 v46, a30
v_accvgpr_read_b32 v47, a31
s_lshr_b32 s40, s52, 1
s_lshl_b32 s40, s40, 2
s_add_u32 s40, s40, s32
s_lshl_b32 s40, s40, 14
s_and_b32 s41, s52, 1
s_lshl_b32 s41, s41, 10
s_add_u32 s40, s40, s41
v_lshlrev_b32 v48, 16, v16
v_and_b32 v49, 0xffff0000, v16
v_lshlrev_b32 v50, 16, v17
v_and_b32 v51, 0xffff0000, v17
v_lshlrev_b32 v52, 16, v18
v_and_b32 v53, 0xffff0000, v18
v_lshlrev_b32 v54, 16, v19
v_and_b32 v55, 0xffff0000, v19
v_lshlrev_b32 v56, 16, v20
v_and_b32 v57, 0xffff0000, v20
v_lshlrev_b32 v58, 16, v21
v_and_b32 v59, 0xffff0000, v21
v_lshlrev_b32 v60, 16, v22
v_and_b32 v61, 0xffff0000, v22
v_lshlrev_b32 v62, 16, v23
v_and_b32 v63, 0xffff0000, v23
v_lshlrev_b32 v64, 16, v24
v_and_b32 v65, 0xffff0000, v24
v_lshlrev_b32 v66, 16, v25
v_and_b32 v67, 0xffff0000, v25
v_lshlrev_b32 v68, 16, v26
v_and_b32 v69, 0xffff0000, v26
v_lshlrev_b32 v70, 16, v27
v_and_b32 v71, 0xffff0000, v27
v_lshlrev_b32 v72, 16, v28
v_and_b32 v73, 0xffff0000, v28
v_lshlrev_b32 v74, 16, v29
v_and_b32 v75, 0xffff0000, v29
v_lshlrev_b32 v76, 16, v30
v_and_b32 v77, 0xffff0000, v30
v_lshlrev_b32 v78, 16, v31
v_and_b32 v79, 0xffff0000, v31
v_lshlrev_b32 v80, 16, v32
v_and_b32 v81, 0xffff0000, v32
v_lshlrev_b32 v82, 16, v33
v_and_b32 v83, 0xffff0000, v33
v_lshlrev_b32 v84, 16, v34
v_and_b32 v85, 0xffff0000, v34
v_lshlrev_b32 v86, 16, v35
v_and_b32 v87, 0xffff0000, v35
v_lshlrev_b32 v88, 16, v36
v_and_b32 v89, 0xffff0000, v36
v_lshlrev_b32 v90, 16, v37
v_and_b32 v91, 0xffff0000, v37
v_lshlrev_b32 v92, 16, v38
v_and_b32 v93, 0xffff0000, v38
v_lshlrev_b32 v94, 16, v39
v_and_b32 v95, 0xffff0000, v39
v_lshlrev_b32 v96, 16, v40
v_and_b32 v97, 0xffff0000, v40
v_lshlrev_b32 v98, 16, v41
v_and_b32 v99, 0xffff0000, v41
v_lshlrev_b32 v100, 16, v42
v_and_b32 v101, 0xffff0000, v42
v_lshlrev_b32 v102, 16, v43
v_and_b32 v103, 0xffff0000, v43
v_lshlrev_b32 v104, 16, v44
v_and_b32 v105, 0xffff0000, v44
v_lshlrev_b32 v106, 16, v45
v_and_b32 v107, 0xffff0000, v45
v_lshlrev_b32 v108, 16, v46
v_and_b32 v109, 0xffff0000, v46
v_lshlrev_b32 v110, 16, v47
v_and_b32 v111, 0xffff0000, v47
v_pk_add_f32 v[240:241], v[48:49], v[50:51]
v_pk_add_f32 v[240:241], v[240:241], v[52:53]
v_pk_add_f32 v[240:241], v[240:241], v[54:55]
v_pk_add_f32 v[240:241], v[240:241], v[56:57]
v_pk_add_f32 v[240:241], v[240:241], v[58:59]
v_pk_add_f32 v[240:241], v[240:241], v[60:61]
v_pk_add_f32 v[240:241], v[240:241], v[62:63]
v_pk_add_f32 v[240:241], v[240:241], v[64:65]
v_pk_add_f32 v[240:241], v[240:241], v[66:67]
v_pk_add_f32 v[240:241], v[240:241], v[68:69]
v_pk_add_f32 v[240:241], v[240:241], v[70:71]
v_pk_add_f32 v[240:241], v[240:241], v[72:73]
v_pk_add_f32 v[240:241], v[240:241], v[74:75]
v_pk_add_f32 v[240:241], v[240:241], v[76:77]
v_pk_add_f32 v[240:241], v[240:241], v[78:79]
v_pk_add_f32 v[240:241], v[240:241], v[80:81]
v_pk_add_f32 v[240:241], v[240:241], v[82:83]
v_pk_add_f32 v[240:241], v[240:241], v[84:85]
v_pk_add_f32 v[240:241], v[240:241], v[86:87]
v_pk_add_f32 v[240:241], v[240:241], v[88:89]
v_pk_add_f32 v[240:241], v[240:241], v[90:91]
v_pk_add_f32 v[240:241], v[240:241], v[92:93]
v_pk_add_f32 v[240:241], v[240:241], v[94:95]
v_pk_add_f32 v[240:241], v[240:241], v[96:97]
v_pk_add_f32 v[240:241], v[240:241], v[98:99]
v_pk_add_f32 v[240:241], v[240:241], v[100:101]
v_pk_add_f32 v[240:241], v[240:241], v[102:103]
v_pk_add_f32 v[240:241], v[240:241], v[104:105]
v_pk_add_f32 v[240:241], v[240:241], v[106:107]
v_pk_add_f32 v[240:241], v[240:241], v[108:109]
v_pk_add_f32 v[240:241], v[240:241], v[110:111]
v_add_f32 v240, v240, v241
v_mov_b32 v241, v240
s_nop 1
v_permlane16_swap_b32 v240, v241
s_nop 0
v_add_f32 v240, v240, v241
v_mov_b32 v241, v240
s_nop 1
v_permlane32_swap_b32 v240, v241
s_nop 0
v_add_f32 v240, v240, v241
ds_write_b32 v11, v240 offset:512
s_waitcnt lgkmcnt(0)
s_barrier
ds_read_b128 v[240:243], v12 offset:512
s_waitcnt lgkmcnt(0)
v_pk_add_f32 v[240:241], v[240:241], v[242:243]
v_add_f32 v240, v240, v241
v_mul_f32 v240, 0x3a800000, v240
v_pk_add_f32 v[48:49], v[48:49], v[240:241] op_sel_hi:[1,0] neg_lo:[0,1] neg_hi:[0,1]
v_pk_add_f32 v[50:51], v[50:51], v[240:241] op_sel_hi:[1,0] neg_lo:[0,1] neg_hi:[0,1]
v_pk_add_f32 v[52:53], v[52:53], v[240:241] op_sel_hi:[1,0] neg_lo:[0,1] neg_hi:[0,1]
v_pk_add_f32 v[54:55], v[54:55], v[240:241] op_sel_hi:[1,0] neg_lo:[0,1] neg_hi:[0,1]
v_pk_add_f32 v[56:57], v[56:57], v[240:241] op_sel_hi:[1,0] neg_lo:[0,1] neg_hi:[0,1]
v_pk_add_f32 v[58:59], v[58:59], v[240:241] op_sel_hi:[1,0] neg_lo:[0,1] neg_hi:[0,1]
v_pk_add_f32 v[60:61], v[60:61], v[240:241] op_sel_hi:[1,0] neg_lo:[0,1] neg_hi:[0,1]
v_pk_add_f32 v[62:63], v[62:63], v[240:241] op_sel_hi:[1,0] neg_lo:[0,1] neg_hi:[0,1]
v_pk_add_f32 v[64:65], v[64:65], v[240:241] op_sel_hi:[1,0] neg_lo:[0,1] neg_hi:[0,1]
v_pk_add_f32 v[66:67], v[66:67], v[240:241] op_sel_hi:[1,0] neg_lo:[0,1] neg_hi:[0,1]
v_pk_add_f32 v[68:69], v[68:69], v[240:241] op_sel_hi:[1,0] neg_lo:[0,1] neg_hi:[0,1]
v_pk_add_f32 v[70:71], v[70:71], v[240:241] op_sel_hi:[1,0] neg_lo:[0,1] neg_hi:[0,1]
v_pk_add_f32 v[72:73], v[72:73], v[240:241] op_sel_hi:[1,0] neg_lo:[0,1] neg_hi:[0,1]
v_pk_add_f32 v[74:75], v[74:75], v[240:241] op_sel_hi:[1,0] neg_lo:[0,1] neg_hi:[0,1]
v_pk_add_f32 v[76:77], v[76:77], v[240:241] op_sel_hi:[1,0] neg_lo:[0,1] neg_hi:[0,1]
v_pk_add_f32 v[78:79], v[78:79], v[240:241] op_sel_hi:[1,0] neg_lo:[0,1] neg_hi:[0,1]
v_pk_add_f32 v[80:81], v[80:81], v[240:241] op_sel_hi:[1,0] neg_lo:[0,1] neg_hi:[0,1]
v_pk_add_f32 v[82:83], v[82:83], v[240:241] op_sel_hi:[1,0] neg_lo:[0,1] neg_hi:[0,1]
v_pk_add_f32 v[84:85], v[84:85], v[240:241] op_sel_hi:[1,0] neg_lo:[0,1] neg_hi:[0,1]
v_pk_add_f32 v[86:87], v[86:87], v[240:241] op_sel_hi:[1,0] neg_lo:[0,1] neg_hi:[0,1]
v_pk_add_f32 v[88:89], v[88:89], v[240:241] op_sel_hi:[1,0] neg_lo:[0,1] neg_hi:[0,1]
v_pk_add_f32 v[90:91], v[90:91], v[240:241] op_sel_hi:[1,0] neg_lo:[0,1] neg_hi:[0,1]
v_pk_add_f32 v[92:93], v[92:93], v[240:241] op_sel_hi:[1,0] neg_lo:[0,1] neg_hi:[0,1]
v_pk_add_f32 v[94:95], v[94:95], v[240:241] op_sel_hi:[1,0] neg_lo:[0,1] neg_hi:[0,1]
v_pk_add_f32 v[96:97], v[96:97], v[240:241] op_sel_hi:[1,0] neg_lo:[0,1] neg_hi:[0,1]
v_pk_add_f32 v[98:99], v[98:99], v[240:241] op_sel_hi:[1,0] neg_lo:[0,1] neg_hi:[0,1]
v_pk_add_f32 v[100:101], v[100:101], v[240:241] op_sel_hi:[1,0] neg_lo:[0,1] neg_hi:[0,1]
v_pk_add_f32 v[102:103], v[102:103], v[240:241] op_sel_hi:[1,0] neg_lo:[0,1] neg_hi:[0,1]
v_pk_add_f32 v[104:105], v[104:105], v[240:241] op_sel_hi:[1,0] neg_lo:[0,1] neg_hi:[0,1]
v_pk_add_f32 v[106:107], v[106:107], v[240:241] op_sel_hi:[1,0] neg_lo:[0,1] neg_hi:[0,1]
v_pk_add_f32 v[108:109], v[108:109], v[240:241] op_sel_hi:[1,0] neg_lo:[0,1] neg_hi:[0,1]
v_pk_add_f32 v[110:111], v[110:111], v[240:241] op_sel_hi:[1,0] neg_lo:[0,1] neg_hi:[0,1]
v_pk_mul_f32 v[240:241], v[48:49], v[48:49]
v_pk_fma_f32 v[240:241], v[50:51], v[50:51], v[240:241]
v_pk_fma_f32 v[240:241], v[52:53], v[52:53], v[240:241]
v_pk_fma_f32 v[240:241], v[54:55], v[54:55], v[240:241]
v_pk_fma_f32 v[240:241], v[56:57], v[56:57], v[240:241]
v_pk_fma_f32 v[240:241], v[58:59], v[58:59], v[240:241]
v_pk_fma_f32 v[240:241], v[60:61], v[60:61], v[240:241]
v_pk_fma_f32 v[240:241], v[62:63], v[62:63], v[240:241]
v_pk_fma_f32 v[240:241], v[64:65], v[64:65], v[240:241]
v_pk_fma_f32 v[240:241], v[66:67], v[66:67], v[240:241]
v_pk_fma_f32 v[240:241], v[68:69], v[68:69], v[240:241]
v_pk_fma_f32 v[240:241], v[70:71], v[70:71], v[240:241]
v_pk_fma_f32 v[240:241], v[72:73], v[72:73], v[240:241]
v_pk_fma_f32 v[240:241], v[74:75], v[74:75], v[240:241]
v_pk_fma_f32 v[240:241], v[76:77], v[76:77], v[240:241]
v_pk_fma_f32 v[240:241], v[78:79], v[78:79], v[240:241]
v_pk_fma_f32 v[240:241], v[80:81], v[80:81], v[240:241]
v_pk_fma_f32 v[240:241], v[82:83], v[82:83], v[240:241]
v_pk_fma_f32 v[240:241], v[84:85], v[84:85], v[240:241]
v_pk_fma_f32 v[240:241], v[86:87], v[86:87], v[240:241]
v_pk_fma_f32 v[240:241], v[88:89], v[88:89], v[240:241]
v_pk_fma_f32 v[240:241], v[90:91], v[90:91], v[240:241]
v_pk_fma_f32 v[240:241], v[92:93], v[92:93], v[240:241]
v_pk_fma_f32 v[240:241], v[94:95], v[94:95], v[240:241]
v_pk_fma_f32 v[240:241], v[96:97], v[96:97], v[240:241]
v_pk_fma_f32 v[240:241], v[98:99], v[98:99], v[240:241]
v_pk_fma_f32 v[240:241], v[100:101], v[100:101], v[240:241]
v_pk_fma_f32 v[240:241], v[102:103], v[102:103], v[240:241]
v_pk_fma_f32 v[240:241], v[104:105], v[104:105], v[240:241]
v_pk_fma_f32 v[240:241], v[106:107], v[106:107], v[240:241]
v_pk_fma_f32 v[240:241], v[108:109], v[108:109], v[240:241]
v_pk_fma_f32 v[240:241], v[110:111], v[110:111], v[240:241]
v_add_f32 v240, v240, v241
v_mov_b32 v241, v240
s_nop 1
v_permlane16_swap_b32 v240, v241
s_nop 0
v_add_f32 v240, v240, v241
v_mov_b32 v241, v240
s_nop 1
v_permlane32_swap_b32 v240, v241
s_nop 0
v_add_f32 v240, v240, v241
ds_write_b32 v11, v240 offset:768
s_waitcnt lgkmcnt(0)
s_barrier
ds_read_b128 v[240:243], v12 offset:768
s_waitcnt lgkmcnt(0)
v_pk_add_f32 v[240:241], v[240:241], v[242:243]
v_add_f32 v240, v240, v241
v_mul_f32 v240, 0x3a800000, v240
v_add_f32 v240, 0x3727c5ac, v240
v_rsq_f32 v240, v240
s_nop 0
v_pk_mul_f32 v[48:49], v[48:49], v[240:241] op_sel_hi:[1,0]
v_pk_mul_f32 v[50:51], v[50:51], v[240:241] op_sel_hi:[1,0]
v_pk_mul_f32 v[52:53], v[52:53], v[240:241] op_sel_hi:[1,0]
v_pk_mul_f32 v[54:55], v[54:55], v[240:241] op_sel_hi:[1,0]
v_pk_mul_f32 v[56:57], v[56:57], v[240:241] op_sel_hi:[1,0]
v_pk_mul_f32 v[58:59], v[58:59], v[240:241] op_sel_hi:[1,0]
v_pk_mul_f32 v[60:61], v[60:61], v[240:241] op_sel_hi:[1,0]
v_pk_mul_f32 v[62:63], v[62:63], v[240:241] op_sel_hi:[1,0]
v_pk_mul_f32 v[64:65], v[64:65], v[240:241] op_sel_hi:[1,0]
v_pk_mul_f32 v[66:67], v[66:67], v[240:241] op_sel_hi:[1,0]
v_pk_mul_f32 v[68:69], v[68:69], v[240:241] op_sel_hi:[1,0]
v_pk_mul_f32 v[70:71], v[70:71], v[240:241] op_sel_hi:[1,0]
v_pk_mul_f32 v[72:73], v[72:73], v[240:241] op_sel_hi:[1,0]
v_pk_mul_f32 v[74:75], v[74:75], v[240:241] op_sel_hi:[1,0]
v_pk_mul_f32 v[76:77], v[76:77], v[240:241] op_sel_hi:[1,0]
v_pk_mul_f32 v[78:79], v[78:79], v[240:241] op_sel_hi:[1,0]
v_pk_mul_f32 v[80:81], v[80:81], v[240:241] op_sel_hi:[1,0]
v_pk_mul_f32 v[82:83], v[82:83], v[240:241] op_sel_hi:[1,0]
v_pk_mul_f32 v[84:85], v[84:85], v[240:241] op_sel_hi:[1,0]
v_pk_mul_f32 v[86:87], v[86:87], v[240:241] op_sel_hi:[1,0]
v_pk_mul_f32 v[88:89], v[88:89], v[240:241] op_sel_hi:[1,0]
v_pk_mul_f32 v[90:91], v[90:91], v[240:241] op_sel_hi:[1,0]
v_pk_mul_f32 v[92:93], v[92:93], v[240:241] op_sel_hi:[1,0]
v_pk_mul_f32 v[94:95], v[94:95], v[240:241] op_sel_hi:[1,0]
v_pk_mul_f32 v[96:97], v[96:97], v[240:241] op_sel_hi:[1,0]
v_pk_mul_f32 v[98:99], v[98:99], v[240:241] op_sel_hi:[1,0]
v_pk_mul_f32 v[100:101], v[100:101], v[240:241] op_sel_hi:[1,0]
v_pk_mul_f32 v[102:103], v[102:103], v[240:241] op_sel_hi:[1,0]
v_pk_mul_f32 v[104:105], v[104:105], v[240:241] op_sel_hi:[1,0]
v_pk_mul_f32 v[106:107], v[106:107], v[240:241] op_sel_hi:[1,0]
v_pk_mul_f32 v[108:109], v[108:109], v[240:241] op_sel_hi:[1,0]
v_pk_mul_f32 v[110:111], v[110:111], v[240:241] op_sel_hi:[1,0]
v_lshlrev_b32 v14, 5, v0
Lbw_621:
s_mov_b32 s42, 3178496
buffer_load_dwordx4 v[16:19], v14, s[4:7], s42 offen offset:0 sc1
buffer_load_dwordx4 v[20:23], v14, s[4:7], s42 offen offset:16 sc1
s_mov_b32 s42, 3186688
buffer_load_dwordx4 v[24:27], v14, s[4:7], s42 offen offset:0 sc1
buffer_load_dwordx4 v[28:31], v14, s[4:7], s42 offen offset:16 sc1
s_waitcnt vmcnt(0)
v_max3_u32 v15, v16, v17, v18
v_max3_u32 v15, v15, v19, v20
v_max3_u32 v15, v15, v21, v22
v_max3_u32 v15, v15, v23, v24
v_max3_u32 v15, v15, v25, v26
v_max3_u32 v15, v15, v27, v28
v_max3_u32 v15, v15, v29, v30
v_max_u32 v15, v15, v31
v_cmp_eq_u32 vcc, -1, v15
s_cbranch_vccz Lbo_622
s_sub_u32 s37, s37, 1
s_cbranch_scc1 Lend_7
s_sleep 4
s_branch Lbw_621
Lbo_622:
s_cmp_ge_u32 s32, 2
s_cselect_b32 s42, 1.0, 0
s_lshl_b32 s43, s32, 10
v_add_u32 v7, s43, v7
s_waitcnt vmcnt(0)
v_add_f32 v16, v16, v24
v_add_f32 v17, v17, v25
v_add_f32 v18, v18, v26
v_add_f32 v19, v19, v27
v_add_f32 v20, v20, v28
v_add_f32 v21, v21, v29
v_add_f32 v22, v22, v30
v_add_f32 v23, v23, v31
v_cvt_pk_bf16_f32 v16, 0, v16
v_cvt_pk_bf16_f32 v17, 0, v17
v_cvt_pk_bf16_f32 v18, 0, v18
v_cvt_pk_bf16_f32 v19, 0, v19
v_cvt_pk_bf16_f32 v20, 0, v20
v_cvt_pk_bf16_f32 v21, 0, v21
v_cvt_pk_bf16_f32 v22, 0, v22
v_cvt_pk_bf16_f32 v23, 0, v23
v_add_f32 v16, s42, v16
v_add_f32 v17, s42, v17
v_add_f32 v18, s42, v18
v_add_f32 v19, s42, v19
v_add_f32 v20, s42, v20
v_add_f32 v21, s42, v21
v_add_f32 v22, s42, v22
v_add_f32 v23, s42, v23
ds_write_b128 v14, v[16:19] offset:4096
ds_write_b128 v14, v[20:23] offset:4112
s_waitcnt lgkmcnt(0)
s_barrier
ds_read_b128 v[112:115], v7 offset:4096
ds_read_b128 v[176:179], v7 offset:8192
ds_read_b128 v[116:119], v7 offset:4112
ds_read_b128 v[180:183], v7 offset:8208
ds_read_b128 v[120:123], v7 offset:4224
ds_read_b128 v[184:187], v7 offset:8320
ds_read_b128 v[124:127], v7 offset:4240
ds_read_b128 v[188:191], v7 offset:8336
ds_read_b128 v[128:131], v7 offset:4352
ds_read_b128 v[192:195], v7 offset:8448
ds_read_b128 v[132:135], v7 offset:4368
ds_read_b128 v[196:199], v7 offset:8464
ds_read_b128 v[136:139], v7 offset:4480
ds_read_b128 v[200:203], v7 offset:8576
ds_read_b128 v[140:143], v7 offset:4496
ds_read_b128 v[204:207], v7 offset:8592
ds_read_b128 v[144:147], v7 offset:4608
ds_read_b128 v[208:211], v7 offset:8704
ds_read_b128 v[148:151], v7 offset:4624
ds_read_b128 v[212:215], v7 offset:8720
ds_read_b128 v[152:155], v7 offset:4736
ds_read_b128 v[216:219], v7 offset:8832
ds_read_b128 v[156:159], v7 offset:4752
ds_read_b128 v[220:223], v7 offset:8848
ds_read_b128 v[160:163], v7 offset:4864
ds_read_b128 v[224:227], v7 offset:8960
ds_read_b128 v[164:167], v7 offset:4880
ds_read_b128 v[228:231], v7 offset:8976
ds_read_b128 v[168:171], v7 offset:4992
ds_read_b128 v[232:235], v7 offset:9088
ds_read_b128 v[172:175], v7 offset:5008
ds_read_b128 v[236:239], v7 offset:9104
s_waitcnt lgkmcnt(0)
v_pk_fma_f32 v[48:49], v[48:49], v[176:177], v[112:113]
v_pk_fma_f32 v[50:51], v[50:51], v[178:179], v[114:115]
v_pk_fma_f32 v[52:53], v[52:53], v[180:181], v[116:117]
v_pk_fma_f32 v[54:55], v[54:55], v[182:183], v[118:119]
v_cvt_pk_bf16_f32 v16, v48, v49
v_cvt_pk_bf16_f32 v17, v50, v51
v_cvt_pk_bf16_f32 v18, v52, v53
v_cvt_pk_bf16_f32 v19, v54, v55
s_add_u32 s41, s40, 8388608
buffer_store_dwordx4 v[16:19], v13, s[4:7], s41 offen sc1
v_pk_fma_f32 v[56:57], v[56:57], v[184:185], v[120:121]
v_pk_fma_f32 v[58:59], v[58:59], v[186:187], v[122:123]
v_pk_fma_f32 v[60:61], v[60:61], v[188:189], v[124:125]
v_pk_fma_f32 v[62:63], v[62:63], v[190:191], v[126:127]
v_cvt_pk_bf16_f32 v20, v56, v57
v_cvt_pk_bf16_f32 v21, v58, v59
v_cvt_pk_bf16_f32 v22, v60, v61
v_cvt_pk_bf16_f32 v23, v62, v63
s_add_u32 s41, s40, 8390656
buffer_store_dwordx4 v[20:23], v13, s[4:7], s41 offen sc1
v_pk_fma_f32 v[64:65], v[64:65], v[192:193], v[128:129]
v_pk_fma_f32 v[66:67], v[66:67], v[194:195], v[130:131]
v_pk_fma_f32 v[68:69], v[68:69], v[196:197], v[132:133]
v_pk_fma_f32 v[70:71], v[70:71], v[198:199], v[134:135]
v_cvt_pk_bf16_f32 v24, v64, v65
v_cvt_pk_bf16_f32 v25, v66, v67
v_cvt_pk_bf16_f32 v26, v68, v69
v_cvt_pk_bf16_f32 v27, v70, v71
s_add_u32 s41, s40, 8392704
buffer_store_dwordx4 v[24:27], v13, s[4:7], s41 offen sc1
v_pk_fma_f32 v[72:73], v[72:73], v[200:201], v[136:137]
v_pk_fma_f32 v[74:75], v[74:75], v[202:203], v[138:139]
v_pk_fma_f32 v[76:77], v[76:77], v[204:205], v[140:141]
v_pk_fma_f32 v[78:79], v[78:79], v[206:207], v[142:143]
v_cvt_pk_bf16_f32 v28, v72, v73
v_cvt_pk_bf16_f32 v29, v74, v75
v_cvt_pk_bf16_f32 v30, v76, v77
v_cvt_pk_bf16_f32 v31, v78, v79
s_add_u32 s41, s40, 8394752
buffer_store_dwordx4 v[28:31], v13, s[4:7], s41 offen sc1
v_pk_fma_f32 v[80:81], v[80:81], v[208:209], v[144:145]
v_pk_fma_f32 v[82:83], v[82:83], v[210:211], v[146:147]
v_pk_fma_f32 v[84:85], v[84:85], v[212:213], v[148:149]
v_pk_fma_f32 v[86:87], v[86:87], v[214:215], v[150:151]
v_cvt_pk_bf16_f32 v32, v80, v81
v_cvt_pk_bf16_f32 v33, v82, v83
v_cvt_pk_bf16_f32 v34, v84, v85
v_cvt_pk_bf16_f32 v35, v86, v87
s_add_u32 s41, s40, 8396800
buffer_store_dwordx4 v[32:35], v13, s[4:7], s41 offen sc1
v_pk_fma_f32 v[88:89], v[88:89], v[216:217], v[152:153]
v_pk_fma_f32 v[90:91], v[90:91], v[218:219], v[154:155]
v_pk_fma_f32 v[92:93], v[92:93], v[220:221], v[156:157]
v_pk_fma_f32 v[94:95], v[94:95], v[222:223], v[158:159]
v_cvt_pk_bf16_f32 v36, v88, v89
v_cvt_pk_bf16_f32 v37, v90, v91
v_cvt_pk_bf16_f32 v38, v92, v93
v_cvt_pk_bf16_f32 v39, v94, v95
s_add_u32 s41, s40, 8398848
buffer_store_dwordx4 v[36:39], v13, s[4:7], s41 offen sc1
v_pk_fma_f32 v[96:97], v[96:97], v[224:225], v[160:161]
v_pk_fma_f32 v[98:99], v[98:99], v[226:227], v[162:163]
v_pk_fma_f32 v[100:101], v[100:101], v[228:229], v[164:165]
v_pk_fma_f32 v[102:103], v[102:103], v[230:231], v[166:167]
v_cvt_pk_bf16_f32 v40, v96, v97
v_cvt_pk_bf16_f32 v41, v98, v99
v_cvt_pk_bf16_f32 v42, v100, v101
v_cvt_pk_bf16_f32 v43, v102, v103
s_add_u32 s41, s40, 8400896
buffer_store_dwordx4 v[40:43], v13, s[4:7], s41 offen sc1
v_pk_fma_f32 v[104:105], v[104:105], v[232:233], v[168:169]
v_pk_fma_f32 v[106:107], v[106:107], v[234:235], v[170:171]
v_pk_fma_f32 v[108:109], v[108:109], v[236:237], v[172:173]
v_pk_fma_f32 v[110:111], v[110:111], v[238:239], v[174:175]
v_cvt_pk_bf16_f32 v44, v104, v105
v_cvt_pk_bf16_f32 v45, v106, v107
v_cvt_pk_bf16_f32 v46, v108, v109
v_cvt_pk_bf16_f32 v47, v110, v111
s_add_u32 s41, s40, 8402944
buffer_store_dwordx4 v[44:47], v13, s[4:7], s41 offen sc1
v_mov_b32 v14, 2
s_waitcnt vmcnt(0)
s_barrier
buffer_store_dword v14, v10, s[4:7], 0 offen sc1
s_add_u32 s52, s26, 64
v_accvgpr_read_b32 v16, a32
v_accvgpr_read_b32 v17, a33
v_accvgpr_read_b32 v18, a34
v_accvgpr_read_b32 v19, a35
v_accvgpr_read_b32 v20, a36
v_accvgpr_read_b32 v21, a37
v_accvgpr_read_b32 v22, a38
v_accvgpr_read_b32 v23, a39
v_accvgpr_read_b32 v24, a40
v_accvgpr_read_b32 v25, a41
v_accvgpr_read_b32 v26, a42
v_accvgpr_read_b32 v27, a43
v_accvgpr_read_b32 v28, a44
v_accvgpr_read_b32 v29, a45
v_accvgpr_read_b32 v30, a46
v_accvgpr_read_b32 v31, a47
v_accvgpr_read_b32 v32, a48
v_accvgpr_read_b32 v33, a49
v_accvgpr_read_b32 v34, a50
v_accvgpr_read_b32 v35, a51
v_accvgpr_read_b32 v36, a52
v_accvgpr_read_b32 v37, a53
v_accvgpr_read_b32 v38, a54
v_accvgpr_read_b32 v39, a55
v_accvgpr_read_b32 v40, a56
v_accvgpr_read_b32 v41, a57
v_accvgpr_read_b32 v42, a58
v_accvgpr_read_b32 v43, a59
v_accvgpr_read_b32 v44, a60
v_accvgpr_read_b32 v45, a61
v_accvgpr_read_b32 v46, a62
v_accvgpr_read_b32 v47, a63
s_lshr_b32 s40, s52, 1
s_lshl_b32 s40, s40, 2
s_add_u32 s40, s40, s32
s_lshl_b32 s40, s40, 14
s_and_b32 s41, s52, 1
s_lshl_b32 s41, s41, 10
s_add_u32 s40, s40, s41
v_lshlrev_b32 v48, 16, v16
v_and_b32 v49, 0xffff0000, v16
v_lshlrev_b32 v50, 16, v17
v_and_b32 v51, 0xffff0000, v17
v_lshlrev_b32 v52, 16, v18
v_and_b32 v53, 0xffff0000, v18
v_lshlrev_b32 v54, 16, v19
v_and_b32 v55, 0xffff0000, v19
v_lshlrev_b32 v56, 16, v20
v_and_b32 v57, 0xffff0000, v20
v_lshlrev_b32 v58, 16, v21
v_and_b32 v59, 0xffff0000, v21
v_lshlrev_b32 v60, 16, v22
v_and_b32 v61, 0xffff0000, v22
v_lshlrev_b32 v62, 16, v23
v_and_b32 v63, 0xffff0000, v23
v_lshlrev_b32 v64, 16, v24
v_and_b32 v65, 0xffff0000, v24
v_lshlrev_b32 v66, 16, v25
v_and_b32 v67, 0xffff0000, v25
v_lshlrev_b32 v68, 16, v26
v_and_b32 v69, 0xffff0000, v26
v_lshlrev_b32 v70, 16, v27
v_and_b32 v71, 0xffff0000, v27
v_lshlrev_b32 v72, 16, v28
v_and_b32 v73, 0xffff0000, v28
v_lshlrev_b32 v74, 16, v29
v_and_b32 v75, 0xffff0000, v29
v_lshlrev_b32 v76, 16, v30
v_and_b32 v77, 0xffff0000, v30
v_lshlrev_b32 v78, 16, v31
v_and_b32 v79, 0xffff0000, v31
v_lshlrev_b32 v80, 16, v32
v_and_b32 v81, 0xffff0000, v32
v_lshlrev_b32 v82, 16, v33
v_and_b32 v83, 0xffff0000, v33
v_lshlrev_b32 v84, 16, v34
v_and_b32 v85, 0xffff0000, v34
v_lshlrev_b32 v86, 16, v35
v_and_b32 v87, 0xffff0000, v35
v_lshlrev_b32 v88, 16, v36
v_and_b32 v89, 0xffff0000, v36
v_lshlrev_b32 v90, 16, v37
v_and_b32 v91, 0xffff0000, v37
v_lshlrev_b32 v92, 16, v38
v_and_b32 v93, 0xffff0000, v38
v_lshlrev_b32 v94, 16, v39
v_and_b32 v95, 0xffff0000, v39
v_lshlrev_b32 v96, 16, v40
v_and_b32 v97, 0xffff0000, v40
v_lshlrev_b32 v98, 16, v41
v_and_b32 v99, 0xffff0000, v41
v_lshlrev_b32 v100, 16, v42
v_and_b32 v101, 0xffff0000, v42
v_lshlrev_b32 v102, 16, v43
v_and_b32 v103, 0xffff0000, v43
v_lshlrev_b32 v104, 16, v44
v_and_b32 v105, 0xffff0000, v44
v_lshlrev_b32 v106, 16, v45
v_and_b32 v107, 0xffff0000, v45
v_lshlrev_b32 v108, 16, v46
v_and_b32 v109, 0xffff0000, v46
v_lshlrev_b32 v110, 16, v47
v_and_b32 v111, 0xffff0000, v47
v_pk_add_f32 v[240:241], v[48:49], v[50:51]
v_pk_add_f32 v[240:241], v[240:241], v[52:53]
v_pk_add_f32 v[240:241], v[240:241], v[54:55]
v_pk_add_f32 v[240:241], v[240:241], v[56:57]
v_pk_add_f32 v[240:241], v[240:241], v[58:59]
v_pk_add_f32 v[240:241], v[240:241], v[60:61]
v_pk_add_f32 v[240:241], v[240:241], v[62:63]
v_pk_add_f32 v[240:241], v[240:241], v[64:65]
v_pk_add_f32 v[240:241], v[240:241], v[66:67]
v_pk_add_f32 v[240:241], v[240:241], v[68:69]
v_pk_add_f32 v[240:241], v[240:241], v[70:71]
v_pk_add_f32 v[240:241], v[240:241], v[72:73]
v_pk_add_f32 v[240:241], v[240:241], v[74:75]
v_pk_add_f32 v[240:241], v[240:241], v[76:77]
v_pk_add_f32 v[240:241], v[240:241], v[78:79]
v_pk_add_f32 v[240:241], v[240:241], v[80:81]
v_pk_add_f32 v[240:241], v[240:241], v[82:83]
v_pk_add_f32 v[240:241], v[240:241], v[84:85]
v_pk_add_f32 v[240:241], v[240:241], v[86:87]
v_pk_add_f32 v[240:241], v[240:241], v[88:89]
v_pk_add_f32 v[240:241], v[240:241], v[90:91]
v_pk_add_f32 v[240:241], v[240:241], v[92:93]
v_pk_add_f32 v[240:241], v[240:241], v[94:95]
v_pk_add_f32 v[240:241], v[240:241], v[96:97]
v_pk_add_f32 v[240:241], v[240:241], v[98:99]
v_pk_add_f32 v[240:241], v[240:241], v[100:101]
v_pk_add_f32 v[240:241], v[240:241], v[102:103]
v_pk_add_f32 v[240:241], v[240:241], v[104:105]
v_pk_add_f32 v[240:241], v[240:241], v[106:107]
v_pk_add_f32 v[240:241], v[240:241], v[108:109]
v_pk_add_f32 v[240:241], v[240:241], v[110:111]
v_add_f32 v240, v240, v241
v_mov_b32 v241, v240
s_nop 1
v_permlane16_swap_b32 v240, v241
s_nop 0
v_add_f32 v240, v240, v241
v_mov_b32 v241, v240
s_nop 1
v_permlane32_swap_b32 v240, v241
s_nop 0
v_add_f32 v240, v240, v241
ds_write_b32 v11, v240 offset:512
s_waitcnt lgkmcnt(0)
s_barrier
ds_read_b128 v[240:243], v12 offset:512
s_waitcnt lgkmcnt(0)
v_pk_add_f32 v[240:241], v[240:241], v[242:243]
v_add_f32 v240, v240, v241
v_mul_f32 v240, 0x3a800000, v240
v_pk_add_f32 v[48:49], v[48:49], v[240:241] op_sel_hi:[1,0] neg_lo:[0,1] neg_hi:[0,1]
v_pk_add_f32 v[50:51], v[50:51], v[240:241] op_sel_hi:[1,0] neg_lo:[0,1] neg_hi:[0,1]
v_pk_add_f32 v[52:53], v[52:53], v[240:241] op_sel_hi:[1,0] neg_lo:[0,1] neg_hi:[0,1]
v_pk_add_f32 v[54:55], v[54:55], v[240:241] op_sel_hi:[1,0] neg_lo:[0,1] neg_hi:[0,1]
v_pk_add_f32 v[56:57], v[56:57], v[240:241] op_sel_hi:[1,0] neg_lo:[0,1] neg_hi:[0,1]
v_pk_add_f32 v[58:59], v[58:59], v[240:241] op_sel_hi:[1,0] neg_lo:[0,1] neg_hi:[0,1]
v_pk_add_f32 v[60:61], v[60:61], v[240:241] op_sel_hi:[1,0] neg_lo:[0,1] neg_hi:[0,1]
v_pk_add_f32 v[62:63], v[62:63], v[240:241] op_sel_hi:[1,0] neg_lo:[0,1] neg_hi:[0,1]
v_pk_add_f32 v[64:65], v[64:65], v[240:241] op_sel_hi:[1,0] neg_lo:[0,1] neg_hi:[0,1]
v_pk_add_f32 v[66:67], v[66:67], v[240:241] op_sel_hi:[1,0] neg_lo:[0,1] neg_hi:[0,1]
v_pk_add_f32 v[68:69], v[68:69], v[240:241] op_sel_hi:[1,0] neg_lo:[0,1] neg_hi:[0,1]
v_pk_add_f32 v[70:71], v[70:71], v[240:241] op_sel_hi:[1,0] neg_lo:[0,1] neg_hi:[0,1]
v_pk_add_f32 v[72:73], v[72:73], v[240:241] op_sel_hi:[1,0] neg_lo:[0,1] neg_hi:[0,1]
v_pk_add_f32 v[74:75], v[74:75], v[240:241] op_sel_hi:[1,0] neg_lo:[0,1] neg_hi:[0,1]
v_pk_add_f32 v[76:77], v[76:77], v[240:241] op_sel_hi:[1,0] neg_lo:[0,1] neg_hi:[0,1]
v_pk_add_f32 v[78:79], v[78:79], v[240:241] op_sel_hi:[1,0] neg_lo:[0,1] neg_hi:[0,1]
v_pk_add_f32 v[80:81], v[80:81], v[240:241] op_sel_hi:[1,0] neg_lo:[0,1] neg_hi:[0,1]
v_pk_add_f32 v[82:83], v[82:83], v[240:241] op_sel_hi:[1,0] neg_lo:[0,1] neg_hi:[0,1]
v_pk_add_f32 v[84:85], v[84:85], v[240:241] op_sel_hi:[1,0] neg_lo:[0,1] neg_hi:[0,1]
v_pk_add_f32 v[86:87], v[86:87], v[240:241] op_sel_hi:[1,0] neg_lo:[0,1] neg_hi:[0,1]
v_pk_add_f32 v[88:89], v[88:89], v[240:241] op_sel_hi:[1,0] neg_lo:[0,1] neg_hi:[0,1]
v_pk_add_f32 v[90:91], v[90:91], v[240:241] op_sel_hi:[1,0] neg_lo:[0,1] neg_hi:[0,1]
v_pk_add_f32 v[92:93], v[92:93], v[240:241] op_sel_hi:[1,0] neg_lo:[0,1] neg_hi:[0,1]
v_pk_add_f32 v[94:95], v[94:95], v[240:241] op_sel_hi:[1,0] neg_lo:[0,1] neg_hi:[0,1]
v_pk_add_f32 v[96:97], v[96:97], v[240:241] op_sel_hi:[1,0] neg_lo:[0,1] neg_hi:[0,1]
v_pk_add_f32 v[98:99], v[98:99], v[240:241] op_sel_hi:[1,0] neg_lo:[0,1] neg_hi:[0,1]
v_pk_add_f32 v[100:101], v[100:101], v[240:241] op_sel_hi:[1,0] neg_lo:[0,1] neg_hi:[0,1]
v_pk_add_f32 v[102:103], v[102:103], v[240:241] op_sel_hi:[1,0] neg_lo:[0,1] neg_hi:[0,1]
v_pk_add_f32 v[104:105], v[104:105], v[240:241] op_sel_hi:[1,0] neg_lo:[0,1] neg_hi:[0,1]
v_pk_add_f32 v[106:107], v[106:107], v[240:241] op_sel_hi:[1,0] neg_lo:[0,1] neg_hi:[0,1]
v_pk_add_f32 v[108:109], v[108:109], v[240:241] op_sel_hi:[1,0] neg_lo:[0,1] neg_hi:[0,1]
v_pk_add_f32 v[110:111], v[110:111], v[240:241] op_sel_hi:[1,0] neg_lo:[0,1] neg_hi:[0,1]
v_pk_mul_f32 v[240:241], v[48:49], v[48:49]
v_pk_fma_f32 v[240:241], v[50:51], v[50:51], v[240:241]
v_pk_fma_f32 v[240:241], v[52:53], v[52:53], v[240:241]
v_pk_fma_f32 v[240:241], v[54:55], v[54:55], v[240:241]
v_pk_fma_f32 v[240:241], v[56:57], v[56:57], v[240:241]
v_pk_fma_f32 v[240:241], v[58:59], v[58:59], v[240:241]
v_pk_fma_f32 v[240:241], v[60:61], v[60:61], v[240:241]
v_pk_fma_f32 v[240:241], v[62:63], v[62:63], v[240:241]
v_pk_fma_f32 v[240:241], v[64:65], v[64:65], v[240:241]
v_pk_fma_f32 v[240:241], v[66:67], v[66:67], v[240:241]
v_pk_fma_f32 v[240:241], v[68:69], v[68:69], v[240:241]
v_pk_fma_f32 v[240:241], v[70:71], v[70:71], v[240:241]
v_pk_fma_f32 v[240:241], v[72:73], v[72:73], v[240:241]
v_pk_fma_f32 v[240:241], v[74:75], v[74:75], v[240:241]
v_pk_fma_f32 v[240:241], v[76:77], v[76:77], v[240:241]
v_pk_fma_f32 v[240:241], v[78:79], v[78:79], v[240:241]
v_pk_fma_f32 v[240:241], v[80:81], v[80:81], v[240:241]
v_pk_fma_f32 v[240:241], v[82:83], v[82:83], v[240:241]
v_pk_fma_f32 v[240:241], v[84:85], v[84:85], v[240:241]
v_pk_fma_f32 v[240:241], v[86:87], v[86:87], v[240:241]
v_pk_fma_f32 v[240:241], v[88:89], v[88:89], v[240:241]
v_pk_fma_f32 v[240:241], v[90:91], v[90:91], v[240:241]
v_pk_fma_f32 v[240:241], v[92:93], v[92:93], v[240:241]
v_pk_fma_f32 v[240:241], v[94:95], v[94:95], v[240:241]
v_pk_fma_f32 v[240:241], v[96:97], v[96:97], v[240:241]
v_pk_fma_f32 v[240:241], v[98:99], v[98:99], v[240:241]
v_pk_fma_f32 v[240:241], v[100:101], v[100:101], v[240:241]
v_pk_fma_f32 v[240:241], v[102:103], v[102:103], v[240:241]
v_pk_fma_f32 v[240:241], v[104:105], v[104:105], v[240:241]
v_pk_fma_f32 v[240:241], v[106:107], v[106:107], v[240:241]
v_pk_fma_f32 v[240:241], v[108:109], v[108:109], v[240:241]
v_pk_fma_f32 v[240:241], v[110:111], v[110:111], v[240:241]
v_add_f32 v240, v240, v241
v_mov_b32 v241, v240
s_nop 1
v_permlane16_swap_b32 v240, v241
s_nop 0
v_add_f32 v240, v240, v241
v_mov_b32 v241, v240
s_nop 1
v_permlane32_swap_b32 v240, v241
s_nop 0
v_add_f32 v240, v240, v241
ds_write_b32 v11, v240 offset:768
s_waitcnt lgkmcnt(0)
s_barrier
ds_read_b128 v[240:243], v12 offset:768
s_waitcnt lgkmcnt(0)
v_pk_add_f32 v[240:241], v[240:241], v[242:243]
v_add_f32 v240, v240, v241
v_mul_f32 v240, 0x3a800000, v240
v_add_f32 v240, 0x3727c5ac, v240
v_rsq_f32 v240, v240
s_nop 0
v_pk_mul_f32 v[48:49], v[48:49], v[240:241] op_sel_hi:[1,0]
v_pk_mul_f32 v[50:51], v[50:51], v[240:241] op_sel_hi:[1,0]
v_pk_mul_f32 v[52:53], v[52:53], v[240:241] op_sel_hi:[1,0]
v_pk_mul_f32 v[54:55], v[54:55], v[240:241] op_sel_hi:[1,0]
v_pk_mul_f32 v[56:57], v[56:57], v[240:241] op_sel_hi:[1,0]
v_pk_mul_f32 v[58:59], v[58:59], v[240:241] op_sel_hi:[1,0]
v_pk_mul_f32 v[60:61], v[60:61], v[240:241] op_sel_hi:[1,0]
v_pk_mul_f32 v[62:63], v[62:63], v[240:241] op_sel_hi:[1,0]
v_pk_mul_f32 v[64:65], v[64:65], v[240:241] op_sel_hi:[1,0]
v_pk_mul_f32 v[66:67], v[66:67], v[240:241] op_sel_hi:[1,0]
v_pk_mul_f32 v[68:69], v[68:69], v[240:241] op_sel_hi:[1,0]
v_pk_mul_f32 v[70:71], v[70:71], v[240:241] op_sel_hi:[1,0]
v_pk_mul_f32 v[72:73], v[72:73], v[240:241] op_sel_hi:[1,0]
v_pk_mul_f32 v[74:75], v[74:75], v[240:241] op_sel_hi:[1,0]
v_pk_mul_f32 v[76:77], v[76:77], v[240:241] op_sel_hi:[1,0]
v_pk_mul_f32 v[78:79], v[78:79], v[240:241] op_sel_hi:[1,0]
v_pk_mul_f32 v[80:81], v[80:81], v[240:241] op_sel_hi:[1,0]
v_pk_mul_f32 v[82:83], v[82:83], v[240:241] op_sel_hi:[1,0]
v_pk_mul_f32 v[84:85], v[84:85], v[240:241] op_sel_hi:[1,0]
v_pk_mul_f32 v[86:87], v[86:87], v[240:241] op_sel_hi:[1,0]
v_pk_mul_f32 v[88:89], v[88:89], v[240:241] op_sel_hi:[1,0]
v_pk_mul_f32 v[90:91], v[90:91], v[240:241] op_sel_hi:[1,0]
v_pk_mul_f32 v[92:93], v[92:93], v[240:241] op_sel_hi:[1,0]
v_pk_mul_f32 v[94:95], v[94:95], v[240:241] op_sel_hi:[1,0]
v_pk_mul_f32 v[96:97], v[96:97], v[240:241] op_sel_hi:[1,0]
v_pk_mul_f32 v[98:99], v[98:99], v[240:241] op_sel_hi:[1,0]
v_pk_mul_f32 v[100:101], v[100:101], v[240:241] op_sel_hi:[1,0]
v_pk_mul_f32 v[102:103], v[102:103], v[240:241] op_sel_hi:[1,0]
v_pk_mul_f32 v[104:105], v[104:105], v[240:241] op_sel_hi:[1,0]
v_pk_mul_f32 v[106:107], v[106:107], v[240:241] op_sel_hi:[1,0]
v_pk_mul_f32 v[108:109], v[108:109], v[240:241] op_sel_hi:[1,0]
v_pk_mul_f32 v[110:111], v[110:111], v[240:241] op_sel_hi:[1,0]
v_pk_fma_f32 v[48:49], v[48:49], v[176:177], v[112:113]
v_pk_fma_f32 v[50:51], v[50:51], v[178:179], v[114:115]
v_pk_fma_f32 v[52:53], v[52:53], v[180:181], v[116:117]
v_pk_fma_f32 v[54:55], v[54:55], v[182:183], v[118:119]
v_cvt_pk_bf16_f32 v16, v48, v49
v_cvt_pk_bf16_f32 v17, v50, v51
v_cvt_pk_bf16_f32 v18, v52, v53
v_cvt_pk_bf16_f32 v19, v54, v55
s_add_u32 s41, s40, 8388608
buffer_store_dwordx4 v[16:19], v13, s[4:7], s41 offen sc1
v_pk_fma_f32 v[56:57], v[56:57], v[184:185], v[120:121]
v_pk_fma_f32 v[58:59], v[58:59], v[186:187], v[122:123]
v_pk_fma_f32 v[60:61], v[60:61], v[188:189], v[124:125]
v_pk_fma_f32 v[62:63], v[62:63], v[190:191], v[126:127]
v_cvt_pk_bf16_f32 v20, v56, v57
v_cvt_pk_bf16_f32 v21, v58, v59
v_cvt_pk_bf16_f32 v22, v60, v61
v_cvt_pk_bf16_f32 v23, v62, v63
s_add_u32 s41, s40, 8390656
buffer_store_dwordx4 v[20:23], v13, s[4:7], s41 offen sc1
v_pk_fma_f32 v[64:65], v[64:65], v[192:193], v[128:129]
v_pk_fma_f32 v[66:67], v[66:67], v[194:195], v[130:131]
v_pk_fma_f32 v[68:69], v[68:69], v[196:197], v[132:133]
v_pk_fma_f32 v[70:71], v[70:71], v[198:199], v[134:135]
v_cvt_pk_bf16_f32 v24, v64, v65
v_cvt_pk_bf16_f32 v25, v66, v67
v_cvt_pk_bf16_f32 v26, v68, v69
v_cvt_pk_bf16_f32 v27, v70, v71
s_add_u32 s41, s40, 8392704
buffer_store_dwordx4 v[24:27], v13, s[4:7], s41 offen sc1
v_pk_fma_f32 v[72:73], v[72:73], v[200:201], v[136:137]
v_pk_fma_f32 v[74:75], v[74:75], v[202:203], v[138:139]
v_pk_fma_f32 v[76:77], v[76:77], v[204:205], v[140:141]
v_pk_fma_f32 v[78:79], v[78:79], v[206:207], v[142:143]
v_cvt_pk_bf16_f32 v28, v72, v73
v_cvt_pk_bf16_f32 v29, v74, v75
v_cvt_pk_bf16_f32 v30, v76, v77
v_cvt_pk_bf16_f32 v31, v78, v79
s_add_u32 s41, s40, 8394752
buffer_store_dwordx4 v[28:31], v13, s[4:7], s41 offen sc1
v_pk_fma_f32 v[80:81], v[80:81], v[208:209], v[144:145]
v_pk_fma_f32 v[82:83], v[82:83], v[210:211], v[146:147]
v_pk_fma_f32 v[84:85], v[84:85], v[212:213], v[148:149]
v_pk_fma_f32 v[86:87], v[86:87], v[214:215], v[150:151]
v_cvt_pk_bf16_f32 v32, v80, v81
v_cvt_pk_bf16_f32 v33, v82, v83
v_cvt_pk_bf16_f32 v34, v84, v85
v_cvt_pk_bf16_f32 v35, v86, v87
s_add_u32 s41, s40, 8396800
buffer_store_dwordx4 v[32:35], v13, s[4:7], s41 offen sc1
v_pk_fma_f32 v[88:89], v[88:89], v[216:217], v[152:153]
v_pk_fma_f32 v[90:91], v[90:91], v[218:219], v[154:155]
v_pk_fma_f32 v[92:93], v[92:93], v[220:221], v[156:157]
v_pk_fma_f32 v[94:95], v[94:95], v[222:223], v[158:159]
v_cvt_pk_bf16_f32 v36, v88, v89
v_cvt_pk_bf16_f32 v37, v90, v91
v_cvt_pk_bf16_f32 v38, v92, v93
v_cvt_pk_bf16_f32 v39, v94, v95
s_add_u32 s41, s40, 8398848
buffer_store_dwordx4 v[36:39], v13, s[4:7], s41 offen sc1
v_pk_fma_f32 v[96:97], v[96:97], v[224:225], v[160:161]
v_pk_fma_f32 v[98:99], v[98:99], v[226:227], v[162:163]
v_pk_fma_f32 v[100:101], v[100:101], v[228:229], v[164:165]
v_pk_fma_f32 v[102:103], v[102:103], v[230:231], v[166:167]
v_cvt_pk_bf16_f32 v40, v96, v97
v_cvt_pk_bf16_f32 v41, v98, v99
v_cvt_pk_bf16_f32 v42, v100, v101
v_cvt_pk_bf16_f32 v43, v102, v103
s_add_u32 s41, s40, 8400896
buffer_store_dwordx4 v[40:43], v13, s[4:7], s41 offen sc1
v_pk_fma_f32 v[104:105], v[104:105], v[232:233], v[168:169]
v_pk_fma_f32 v[106:107], v[106:107], v[234:235], v[170:171]
v_pk_fma_f32 v[108:109], v[108:109], v[236:237], v[172:173]
v_pk_fma_f32 v[110:111], v[110:111], v[238:239], v[174:175]
v_cvt_pk_bf16_f32 v44, v104, v105
v_cvt_pk_bf16_f32 v45, v106, v107
v_cvt_pk_bf16_f32 v46, v108, v109
v_cvt_pk_bf16_f32 v47, v110, v111
s_add_u32 s41, s40, 8402944
buffer_store_dwordx4 v[44:47], v13, s[4:7], s41 offen sc1
v_mov_b32 v14, 3
s_waitcnt vmcnt(0)
s_barrier
buffer_store_dword v14, v10, s[4:7], 0 offen sc1
s_add_u32 s60, s26, 32
s_mov_b32 s61, 0
v_lshrrev_b32 v2, 3, v0
v_and_b32 v3, 7, v0
v_mul_u32_u24 v4, 12288, v2
v_lshl_add_u32 v4, v3, 4, v4
v_lshlrev_b32 v5, 1, v2
v_mov_b32 v96, 0
v_mov_b32 v97, 0
v_mov_b32 v98, 0
v_mov_b32 v99, 0
v_mov_b32 v100, 0
v_mov_b32 v101, 0
v_mov_b32 v102, 0
v_mov_b32 v103, 0
Lmd_623:
s_lshl_b32 s41, s61, 10
s_mul_i32 s40, s61, 6291456
s_lshl_b32 s42, s60, 7
s_add_u32 s40, s40, s42
buffer_load_ushort v80, v5, s[84:87], s41 offen offset:0
buffer_load_ushort v81, v5, s[84:87], s41 offen offset:64
buffer_load_ushort v82, v5, s[84:87], s41 offen offset:128
buffer_load_ushort v83, v5, s[84:87], s41 offen offset:192
buffer_load_ushort v84, v5, s[84:87], s41 offen offset:256
buffer_load_ushort v85, v5, s[84:87], s41 offen offset:320
buffer_load_ushort v86, v5, s[84:87], s41 offen offset:384
buffer_load_ushort v87, v5, s[84:87], s41 offen offset:448
buffer_load_ushort v88, v5, s[84:87], s41 offen offset:512
buffer_load_ushort v89, v5, s[84:87], s41 offen offset:576
buffer_load_ushort v90, v5, s[84:87], s41 offen offset:640
buffer_load_ushort v91, v5, s[84:87], s41 offen offset:704
buffer_load_ushort v92, v5, s[84:87], s41 offen offset:768
buffer_load_ushort v93, v5, s[84:87], s41 offen offset:832
buffer_load_ushort v94, v5, s[84:87], s41 offen offset:896
buffer_load_ushort v95, v5, s[84:87], s41 offen offset:960
buffer_load_dwordx4 v[16:19], v4, s[8:11], s40 offen
s_add_u32 s40, s40, 393216
buffer_load_dwordx4 v[20:23], v4, s[8:11], s40 offen
s_add_u32 s40, s40, 393216
buffer_load_dwordx4 v[24:27], v4, s[8:11], s40 offen
s_add_u32 s40, s40, 393216
buffer_load_dwordx4 v[28:31], v4, s[8:11], s40 offen
s_add_u32 s40, s40, 393216
buffer_load_dwordx4 v[32:35], v4, s[8:11], s40 offen
s_add_u32 s40, s40, 393216
buffer_load_dwordx4 v[36:39], v4, s[8:11], s40 offen
s_add_u32 s40, s40, 393216
buffer_load_dwordx4 v[40:43], v4, s[8:11], s40 offen
s_add_u32 s40, s40, 393216
buffer_load_dwordx4 v[44:47], v4, s[8:11], s40 offen
s_add_u32 s40, s40, 393216
buffer_load_dwordx4 v[48:51], v4, s[8:11], s40 offen
s_add_u32 s40, s40, 393216
buffer_load_dwordx4 v[52:55], v4, s[8:11], s40 offen
s_add_u32 s40, s40, 393216
buffer_load_dwordx4 v[56:59], v4, s[8:11], s40 offen
s_add_u32 s40, s40, 393216
buffer_load_dwordx4 v[60:63], v4, s[8:11], s40 offen
s_add_u32 s40, s40, 393216
buffer_load_dwordx4 v[64:67], v4, s[8:11], s40 offen
s_add_u32 s40, s40, 393216
buffer_load_dwordx4 v[68:71], v4, s[8:11], s40 offen
s_add_u32 s40, s40, 393216
buffer_load_dwordx4 v[72:75], v4, s[8:11], s40 offen
s_add_u32 s40, s40, 393216
buffer_load_dwordx4 v[76:79], v4, s[8:11], s40 offen
s_add_u32 s40, s40, 393216
s_waitcnt vmcnt(16)
v_lshlrev_b32 v80, 16, v80
v_mul_f32 v104, 0xbfb8aa3b, v80
v_exp_f32 v104, v104
s_nop 0
v_add_f32 v104, 1.0, v104
v_rcp_f32 v104, v104
s_nop 0
v_mul_f32 v104, v104, v80
v_cvt_pk_bf16_f32 v80, 0, v104
v_lshlrev_b32 v81, 16, v81
v_mul_f32 v104, 0xbfb8aa3b, v81
v_exp_f32 v104, v104
s_nop 0
v_add_f32 v104, 1.0, v104
v_rcp_f32 v104, v104
s_nop 0
v_mul_f32 v104, v104, v81
v_cvt_pk_bf16_f32 v81, 0, v104
v_lshlrev_b32 v82, 16, v82
v_mul_f32 v104, 0xbfb8aa3b, v82
v_exp_f32 v104, v104
s_nop 0
v_add_f32 v104, 1.0, v104
v_rcp_f32 v104, v104
s_nop 0
v_mul_f32 v104, v104, v82
v_cvt_pk_bf16_f32 v82, 0, v104
v_lshlrev_b32 v83, 16, v83
v_mul_f32 v104, 0xbfb8aa3b, v83
v_exp_f32 v104, v104
s_nop 0
v_add_f32 v104, 1.0, v104
v_rcp_f32 v104, v104
s_nop 0
v_mul_f32 v104, v104, v83
v_cvt_pk_bf16_f32 v83, 0, v104
v_lshlrev_b32 v84, 16, v84
v_mul_f32 v104, 0xbfb8aa3b, v84
v_exp_f32 v104, v104
s_nop 0
v_add_f32 v104, 1.0, v104
v_rcp_f32 v104, v104
s_nop 0
v_mul_f32 v104, v104, v84
v_cvt_pk_bf16_f32 v84, 0, v104
v_lshlrev_b32 v85, 16, v85
v_mul_f32 v104, 0xbfb8aa3b, v85
v_exp_f32 v104, v104
s_nop 0
v_add_f32 v104, 1.0, v104
v_rcp_f32 v104, v104
s_nop 0
v_mul_f32 v104, v104, v85
v_cvt_pk_bf16_f32 v85, 0, v104
v_lshlrev_b32 v86, 16, v86
v_mul_f32 v104, 0xbfb8aa3b, v86
v_exp_f32 v104, v104
s_nop 0
v_add_f32 v104, 1.0, v104
v_rcp_f32 v104, v104
s_nop 0
v_mul_f32 v104, v104, v86
v_cvt_pk_bf16_f32 v86, 0, v104
v_lshlrev_b32 v87, 16, v87
v_mul_f32 v104, 0xbfb8aa3b, v87
v_exp_f32 v104, v104
s_nop 0
v_add_f32 v104, 1.0, v104
v_rcp_f32 v104, v104
s_nop 0
v_mul_f32 v104, v104, v87
v_cvt_pk_bf16_f32 v87, 0, v104
v_lshlrev_b32 v88, 16, v88
v_mul_f32 v104, 0xbfb8aa3b, v88
v_exp_f32 v104, v104
s_nop 0
v_add_f32 v104, 1.0, v104
v_rcp_f32 v104, v104
s_nop 0
v_mul_f32 v104, v104, v88
v_cvt_pk_bf16_f32 v88, 0, v104
v_lshlrev_b32 v89, 16, v89
v_mul_f32 v104, 0xbfb8aa3b, v89
v_exp_f32 v104, v104
s_nop 0
v_add_f32 v104, 1.0, v104
v_rcp_f32 v104, v104
s_nop 0
v_mul_f32 v104, v104, v89
v_cvt_pk_bf16_f32 v89, 0, v104
v_lshlrev_b32 v90, 16, v90
v_mul_f32 v104, 0xbfb8aa3b, v90
v_exp_f32 v104, v104
s_nop 0
v_add_f32 v104, 1.0, v104
v_rcp_f32 v104, v104
s_nop 0
v_mul_f32 v104, v104, v90
v_cvt_pk_bf16_f32 v90, 0, v104
v_lshlrev_b32 v91, 16, v91
v_mul_f32 v104, 0xbfb8aa3b, v91
v_exp_f32 v104, v104
s_nop 0
v_add_f32 v104, 1.0, v104
v_rcp_f32 v104, v104
s_nop 0
v_mul_f32 v104, v104, v91
v_cvt_pk_bf16_f32 v91, 0, v104
v_lshlrev_b32 v92, 16, v92
v_mul_f32 v104, 0xbfb8aa3b, v92
v_exp_f32 v104, v104
s_nop 0
v_add_f32 v104, 1.0, v104
v_rcp_f32 v104, v104
s_nop 0
v_mul_f32 v104, v104, v92
v_cvt_pk_bf16_f32 v92, 0, v104
v_lshlrev_b32 v93, 16, v93
v_mul_f32 v104, 0xbfb8aa3b, v93
v_exp_f32 v104, v104
s_nop 0
v_add_f32 v104, 1.0, v104
v_rcp_f32 v104, v104
s_nop 0
v_mul_f32 v104, v104, v93
v_cvt_pk_bf16_f32 v93, 0, v104
v_lshlrev_b32 v94, 16, v94
v_mul_f32 v104, 0xbfb8aa3b, v94
v_exp_f32 v104, v104
s_nop 0
v_add_f32 v104, 1.0, v104
v_rcp_f32 v104, v104
s_nop 0
v_mul_f32 v104, v104, v94
v_cvt_pk_bf16_f32 v94, 0, v104
v_lshlrev_b32 v95, 16, v95
v_mul_f32 v104, 0xbfb8aa3b, v95
v_exp_f32 v104, v104
s_nop 0
v_add_f32 v104, 1.0, v104
v_rcp_f32 v104, v104
s_nop 0
v_mul_f32 v104, v104, v95
v_cvt_pk_bf16_f32 v95, 0, v104
s_waitcnt vmcnt(15)
v_lshlrev_b32 v104, 16, v16
v_and_b32 v105, 0xffff0000, v16
v_fmac_f32 v96, v104, v80
v_fmac_f32 v97, v105, v80
v_lshlrev_b32 v104, 16, v17
v_and_b32 v105, 0xffff0000, v17
v_fmac_f32 v98, v104, v80
v_fmac_f32 v99, v105, v80
v_lshlrev_b32 v104, 16, v18
v_and_b32 v105, 0xffff0000, v18
v_fmac_f32 v100, v104, v80
v_fmac_f32 v101, v105, v80
v_lshlrev_b32 v104, 16, v19
v_and_b32 v105, 0xffff0000, v19
v_fmac_f32 v102, v104, v80
v_fmac_f32 v103, v105, v80
s_waitcnt vmcnt(14)
v_lshlrev_b32 v104, 16, v20
v_and_b32 v105, 0xffff0000, v20
v_fmac_f32 v96, v104, v81
v_fmac_f32 v97, v105, v81
v_lshlrev_b32 v104, 16, v21
v_and_b32 v105, 0xffff0000, v21
v_fmac_f32 v98, v104, v81
v_fmac_f32 v99, v105, v81
v_lshlrev_b32 v104, 16, v22
v_and_b32 v105, 0xffff0000, v22
v_fmac_f32 v100, v104, v81
v_fmac_f32 v101, v105, v81
v_lshlrev_b32 v104, 16, v23
v_and_b32 v105, 0xffff0000, v23
v_fmac_f32 v102, v104, v81
v_fmac_f32 v103, v105, v81
s_waitcnt vmcnt(13)
v_lshlrev_b32 v104, 16, v24
v_and_b32 v105, 0xffff0000, v24
v_fmac_f32 v96, v104, v82
v_fmac_f32 v97, v105, v82
v_lshlrev_b32 v104, 16, v25
v_and_b32 v105, 0xffff0000, v25
v_fmac_f32 v98, v104, v82
v_fmac_f32 v99, v105, v82
v_lshlrev_b32 v104, 16, v26
v_and_b32 v105, 0xffff0000, v26
v_fmac_f32 v100, v104, v82
v_fmac_f32 v101, v105, v82
v_lshlrev_b32 v104, 16, v27
v_and_b32 v105, 0xffff0000, v27
v_fmac_f32 v102, v104, v82
v_fmac_f32 v103, v105, v82
s_waitcnt vmcnt(12)
v_lshlrev_b32 v104, 16, v28
v_and_b32 v105, 0xffff0000, v28
v_fmac_f32 v96, v104, v83
v_fmac_f32 v97, v105, v83
v_lshlrev_b32 v104, 16, v29
v_and_b32 v105, 0xffff0000, v29
v_fmac_f32 v98, v104, v83
v_fmac_f32 v99, v105, v83
v_lshlrev_b32 v104, 16, v30
v_and_b32 v105, 0xffff0000, v30
v_fmac_f32 v100, v104, v83
v_fmac_f32 v101, v105, v83
v_lshlrev_b32 v104, 16, v31
v_and_b32 v105, 0xffff0000, v31
v_fmac_f32 v102, v104, v83
v_fmac_f32 v103, v105, v83
s_waitcnt vmcnt(11)
v_lshlrev_b32 v104, 16, v32
v_and_b32 v105, 0xffff0000, v32
v_fmac_f32 v96, v104, v84
v_fmac_f32 v97, v105, v84
v_lshlrev_b32 v104, 16, v33
v_and_b32 v105, 0xffff0000, v33
v_fmac_f32 v98, v104, v84
v_fmac_f32 v99, v105, v84
v_lshlrev_b32 v104, 16, v34
v_and_b32 v105, 0xffff0000, v34
v_fmac_f32 v100, v104, v84
v_fmac_f32 v101, v105, v84
v_lshlrev_b32 v104, 16, v35
v_and_b32 v105, 0xffff0000, v35
v_fmac_f32 v102, v104, v84
v_fmac_f32 v103, v105, v84
s_waitcnt vmcnt(10)
v_lshlrev_b32 v104, 16, v36
v_and_b32 v105, 0xffff0000, v36
v_fmac_f32 v96, v104, v85
v_fmac_f32 v97, v105, v85
v_lshlrev_b32 v104, 16, v37
v_and_b32 v105, 0xffff0000, v37
v_fmac_f32 v98, v104, v85
v_fmac_f32 v99, v105, v85
v_lshlrev_b32 v104, 16, v38
v_and_b32 v105, 0xffff0000, v38
v_fmac_f32 v100, v104, v85
v_fmac_f32 v101, v105, v85
v_lshlrev_b32 v104, 16, v39
v_and_b32 v105, 0xffff0000, v39
v_fmac_f32 v102, v104, v85
v_fmac_f32 v103, v105, v85
s_waitcnt vmcnt(9)
v_lshlrev_b32 v104, 16, v40
v_and_b32 v105, 0xffff0000, v40
v_fmac_f32 v96, v104, v86
v_fmac_f32 v97, v105, v86
v_lshlrev_b32 v104, 16, v41
v_and_b32 v105, 0xffff0000, v41
v_fmac_f32 v98, v104, v86
v_fmac_f32 v99, v105, v86
v_lshlrev_b32 v104, 16, v42
v_and_b32 v105, 0xffff0000, v42
v_fmac_f32 v100, v104, v86
v_fmac_f32 v101, v105, v86
v_lshlrev_b32 v104, 16, v43
v_and_b32 v105, 0xffff0000, v43
v_fmac_f32 v102, v104, v86
v_fmac_f32 v103, v105, v86
s_waitcnt vmcnt(8)
v_lshlrev_b32 v104, 16, v44
v_and_b32 v105, 0xffff0000, v44
v_fmac_f32 v96, v104, v87
v_fmac_f32 v97, v105, v87
v_lshlrev_b32 v104, 16, v45
v_and_b32 v105, 0xffff0000, v45
v_fmac_f32 v98, v104, v87
v_fmac_f32 v99, v105, v87
v_lshlrev_b32 v104, 16, v46
v_and_b32 v105, 0xffff0000, v46
v_fmac_f32 v100, v104, v87
v_fmac_f32 v101, v105, v87
v_lshlrev_b32 v104, 16, v47
v_and_b32 v105, 0xffff0000, v47
v_fmac_f32 v102, v104, v87
v_fmac_f32 v103, v105, v87
s_waitcnt vmcnt(7)
v_lshlrev_b32 v104, 16, v48
v_and_b32 v105, 0xffff0000, v48
v_fmac_f32 v96, v104, v88
v_fmac_f32 v97, v105, v88
v_lshlrev_b32 v104, 16, v49
v_and_b32 v105, 0xffff0000, v49
v_fmac_f32 v98, v104, v88
v_fmac_f32 v99, v105, v88
v_lshlrev_b32 v104, 16, v50
v_and_b32 v105, 0xffff0000, v50
v_fmac_f32 v100, v104, v88
v_fmac_f32 v101, v105, v88
v_lshlrev_b32 v104, 16, v51
v_and_b32 v105, 0xffff0000, v51
v_fmac_f32 v102, v104, v88
v_fmac_f32 v103, v105, v88
s_waitcnt vmcnt(6)
v_lshlrev_b32 v104, 16, v52
v_and_b32 v105, 0xffff0000, v52
v_fmac_f32 v96, v104, v89
v_fmac_f32 v97, v105, v89
v_lshlrev_b32 v104, 16, v53
v_and_b32 v105, 0xffff0000, v53
v_fmac_f32 v98, v104, v89
v_fmac_f32 v99, v105, v89
v_lshlrev_b32 v104, 16, v54
v_and_b32 v105, 0xffff0000, v54
v_fmac_f32 v100, v104, v89
v_fmac_f32 v101, v105, v89
v_lshlrev_b32 v104, 16, v55
v_and_b32 v105, 0xffff0000, v55
v_fmac_f32 v102, v104, v89
v_fmac_f32 v103, v105, v89
s_waitcnt vmcnt(5)
v_lshlrev_b32 v104, 16, v56
v_and_b32 v105, 0xffff0000, v56
v_fmac_f32 v96, v104, v90
v_fmac_f32 v97, v105, v90
v_lshlrev_b32 v104, 16, v57
v_and_b32 v105, 0xffff0000, v57
v_fmac_f32 v98, v104, v90
v_fmac_f32 v99, v105, v90
v_lshlrev_b32 v104, 16, v58
v_and_b32 v105, 0xffff0000, v58
v_fmac_f32 v100, v104, v90
v_fmac_f32 v101, v105, v90
v_lshlrev_b32 v104, 16, v59
v_and_b32 v105, 0xffff0000, v59
v_fmac_f32 v102, v104, v90
v_fmac_f32 v103, v105, v90
s_waitcnt vmcnt(4)
v_lshlrev_b32 v104, 16, v60
v_and_b32 v105, 0xffff0000, v60
v_fmac_f32 v96, v104, v91
v_fmac_f32 v97, v105, v91
v_lshlrev_b32 v104, 16, v61
v_and_b32 v105, 0xffff0000, v61
v_fmac_f32 v98, v104, v91
v_fmac_f32 v99, v105, v91
v_lshlrev_b32 v104, 16, v62
v_and_b32 v105, 0xffff0000, v62
v_fmac_f32 v100, v104, v91
v_fmac_f32 v101, v105, v91
v_lshlrev_b32 v104, 16, v63
v_and_b32 v105, 0xffff0000, v63
v_fmac_f32 v102, v104, v91
v_fmac_f32 v103, v105, v91
s_waitcnt vmcnt(3)
v_lshlrev_b32 v104, 16, v64
v_and_b32 v105, 0xffff0000, v64
v_fmac_f32 v96, v104, v92
v_fmac_f32 v97, v105, v92
v_lshlrev_b32 v104, 16, v65
v_and_b32 v105, 0xffff0000, v65
v_fmac_f32 v98, v104, v92
v_fmac_f32 v99, v105, v92
v_lshlrev_b32 v104, 16, v66
v_and_b32 v105, 0xffff0000, v66
v_fmac_f32 v100, v104, v92
v_fmac_f32 v101, v105, v92
v_lshlrev_b32 v104, 16, v67
v_and_b32 v105, 0xffff0000, v67
v_fmac_f32 v102, v104, v92
v_fmac_f32 v103, v105, v92
s_waitcnt vmcnt(2)
v_lshlrev_b32 v104, 16, v68
v_and_b32 v105, 0xffff0000, v68
v_fmac_f32 v96, v104, v93
v_fmac_f32 v97, v105, v93
v_lshlrev_b32 v104, 16, v69
v_and_b32 v105, 0xffff0000, v69
v_fmac_f32 v98, v104, v93
v_fmac_f32 v99, v105, v93
v_lshlrev_b32 v104, 16, v70
v_and_b32 v105, 0xffff0000, v70
v_fmac_f32 v100, v104, v93
v_fmac_f32 v101, v105, v93
v_lshlrev_b32 v104, 16, v71
v_and_b32 v105, 0xffff0000, v71
v_fmac_f32 v102, v104, v93
v_fmac_f32 v103, v105, v93
s_waitcnt vmcnt(1)
v_lshlrev_b32 v104, 16, v72
v_and_b32 v105, 0xffff0000, v72
v_fmac_f32 v96, v104, v94
v_fmac_f32 v97, v105, v94
v_lshlrev_b32 v104, 16, v73
v_and_b32 v105, 0xffff0000, v73
v_fmac_f32 v98, v104, v94
v_fmac_f32 v99, v105, v94
v_lshlrev_b32 v104, 16, v74
v_and_b32 v105, 0xffff0000, v74
v_fmac_f32 v100, v104, v94
v_fmac_f32 v101, v105, v94
v_lshlrev_b32 v104, 16, v75
v_and_b32 v105, 0xffff0000, v75
v_fmac_f32 v102, v104, v94
v_fmac_f32 v103, v105, v94
s_waitcnt vmcnt(0)
v_lshlrev_b32 v104, 16, v76
v_and_b32 v105, 0xffff0000, v76
v_fmac_f32 v96, v104, v95
v_fmac_f32 v97, v105, v95
v_lshlrev_b32 v104, 16, v77
v_and_b32 v105, 0xffff0000, v77
v_fmac_f32 v98, v104, v95
v_fmac_f32 v99, v105, v95
v_lshlrev_b32 v104, 16, v78
v_and_b32 v105, 0xffff0000, v78
v_fmac_f32 v100, v104, v95
v_fmac_f32 v101, v105, v95
v_lshlrev_b32 v104, 16, v79
v_and_b32 v105, 0xffff0000, v79
v_fmac_f32 v102, v104, v95
v_fmac_f32 v103, v105, v95
s_add_u32 s61, s61, 1
s_cmp_lt_u32 s61, 2
s_cbranch_scc1 Lmd_623
s_lshl_b32 s60, s60, 8
s_add_u32 s60, s60, 3145728
s_nop 1
v_add_f32_dpp v96, v96, v96 row_ror:8 row_mask:0xf bank_mask:0xf
v_add_f32_dpp v97, v97, v97 row_ror:8 row_mask:0xf bank_mask:0xf
v_add_f32_dpp v98, v98, v98 row_ror:8 row_mask:0xf bank_mask:0xf
v_add_f32_dpp v99, v99, v99 row_ror:8 row_mask:0xf bank_mask:0xf
v_add_f32_dpp v100, v100, v100 row_ror:8 row_mask:0xf bank_mask:0xf
v_add_f32_dpp v101, v101, v101 row_ror:8 row_mask:0xf bank_mask:0xf
v_add_f32_dpp v102, v102, v102 row_ror:8 row_mask:0xf bank_mask:0xf
v_add_f32_dpp v103, v103, v103 row_ror:8 row_mask:0xf bank_mask:0xf
v_mov_b32 v16, v96
v_mov_b32 v17, v97
v_mov_b32 v18, v98
v_mov_b32 v19, v99
v_mov_b32 v20, v100
v_mov_b32 v21, v101
v_mov_b32 v22, v102
v_mov_b32 v23, v103
v_permlane16_swap_b32 v96, v16
v_permlane16_swap_b32 v97, v17
v_permlane16_swap_b32 v98, v18
v_permlane16_swap_b32 v99, v19
v_permlane16_swap_b32 v100, v20
v_permlane16_swap_b32 v101, v21
v_permlane16_swap_b32 v102, v22
v_permlane16_swap_b32 v103, v23
v_add_f32 v96, v96, v16
v_add_f32 v97, v97, v17
v_add_f32 v98, v98, v18
v_add_f32 v99, v99, v19
v_add_f32 v100, v100, v20
v_add_f32 v101, v101, v21
v_add_f32 v102, v102, v22
v_add_f32 v103, v103, v23
v_mov_b32 v16, v96
v_mov_b32 v17, v97
v_mov_b32 v18, v98
v_mov_b32 v19, v99
v_mov_b32 v20, v100
v_mov_b32 v21, v101
v_mov_b32 v22, v102
v_mov_b32 v23, v103
v_permlane32_swap_b32 v96, v16
v_permlane32_swap_b32 v97, v17
v_permlane32_swap_b32 v98, v18
v_permlane32_swap_b32 v99, v19
v_permlane32_swap_b32 v100, v20
v_permlane32_swap_b32 v101, v21
v_permlane32_swap_b32 v102, v22
v_permlane32_swap_b32 v103, v23
v_add_f32 v96, v96, v16
v_add_f32 v97, v97, v17
v_add_f32 v98, v98, v18
v_add_f32 v99, v99, v19
v_add_f32 v100, v100, v20
v_add_f32 v101, v101, v21
v_add_f32 v102, v102, v22
v_add_f32 v103, v103, v23
s_lshl_b32 s40, s32, 8
v_lshl_add_u32 v2, v3, 5, s40
ds_write_b128 v2, v[96:99] offset:1024
ds_write_b128 v2, v[100:103] offset:1040
s_waitcnt lgkmcnt(0)
s_barrier
v_and_b32 v2, 63, v0
v_lshlrev_b32 v2, 2, v2
ds_read_b32 v96, v2 offset:1024
ds_read_b32 v97, v2 offset:1280
ds_read_b32 v98, v2 offset:1536
ds_read_b32 v99, v2 offset:1792
s_min_u32 s40, s32, 1
s_lshl_b32 s40, s40, 30
s_add_u32 s40, s40, s60
s_waitcnt lgkmcnt(0)
v_add_f32 v96, v96, v97
v_add_f32 v98, v98, v99
v_add_f32 v96, v96, v98
v_cvt_pk_bf16_f32 v96, 0, v96
buffer_store_dword v96, v2, s[4:7], s40 offen sc1
v_mov_b32 v14, 4
s_waitcnt vmcnt(0)
buffer_store_dword v14, v10, s[4:7], 0 offen sc1
v_mov_b32 v4, v8
v_mov_b32 v5, 0
s_cmp_ge_u32 s34, 30
s_cbranch_scc1 Lln_6
s_load_dwordx2 s[16:17], s[0:1], 64
s_load_dwordx2 s[18:19], s[0:1], 72
s_load_dwordx2 s[20:21], s[0:1], 80
s_waitcnt lgkmcnt(0)
s_mov_b32 s8, s16
s_and_b32 s9, s17, 0xffff
s_mov_b32 s10, 0x700000
s_mov_b32 s11, 0x20000
s_mov_b32 s84, s18
s_and_b32 s85, s19, 0xffff
s_mov_b32 s86, 0x700000
s_mov_b32 s87, 0x20000
s_mov_b32 s88, s20
s_and_b32 s89, s21, 0xffff
s_mov_b32 s90, 0x700000
s_mov_b32 s91, 0x20000
s_lshl_b32 s60, s44, 7
s_lshl_b32 s52, s32, 5
v_bfe_u32 v84, v9, 2, 2
v_lshrrev_b32 v85, 4, v9
v_lshl_add_u32 v84, v85, 3, v84
v_lshl_add_u32 v84, v84, 7, s52
v_and_b32 v85, 3, v9
v_lshl_add_u32 v84, v85, 3, v84
v_add_u32 v80, 0, v84
v_bfe_u32 v84, v9, 2, 2
v_lshrrev_b32 v85, 4, v9
v_lshl_add_u32 v84, v85, 3, v84
v_lshl_add_u32 v84, v84, 7, s52
v_and_b32 v85, 3, v9
v_lshl_add_u32 v84, v85, 3, v84
v_add_u32 v81, 16384, v84
v_lshrrev_b32 v84, 3, v9
s_mul_i32 s38, s32, 256
v_add_u32 v84, s38, v84
v_mul_u32_u24 v84, 7168, v84
v_and_b32 v85, 7, v9
v_lshl_add_u32 v84, v85, 4, v84
s_lshl_b32 s38, s32, 12
s_barrier
s_add_u32 m0, s38, 0
s_add_u32 s39, s60, 0
buffer_load_dwordx4 v84, s[8:11], s39 offen lds
s_add_u32 m0, s38, 1024
s_add_u32 s39, s60, 57344
buffer_load_dwordx4 v84, s[8:11], s39 offen lds
s_add_u32 m0, s38, 2048
s_add_u32 s39, s60, 114688
buffer_load_dwordx4 v84, s[8:11], s39 offen lds
s_add_u32 m0, s38, 3072
s_add_u32 s39, s60, 172032
buffer_load_dwordx4 v84, s[8:11], s39 offen lds
s_add_u32 m0, s38, 16384
s_add_u32 s39, s60, 0
buffer_load_dwordx4 v84, s[84:87], s39 offen lds
s_add_u32 m0, s38, 17408
s_add_u32 s39, s60, 57344
buffer_load_dwordx4 v84, s[84:87], s39 offen lds
s_add_u32 m0, s38, 18432
s_add_u32 s39, s60, 114688
buffer_load_dwordx4 v84, s[84:87], s39 offen lds
s_add_u32 m0, s38, 19456
s_add_u32 s39, s60, 172032
buffer_load_dwordx4 v84, s[84:87], s39 offen lds
s_add_u32 m0, s38, 32768
s_add_u32 s39, s60, 229376
buffer_load_dwordx4 v84, s[8:11], s39 offen lds
s_add_u32 m0, s38, 33792
s_add_u32 s39, s60, 286720
buffer_load_dwordx4 v84, s[8:11], s39 offen lds
s_add_u32 m0, s38, 34816
s_add_u32 s39, s60, 344064
buffer_load_dwordx4 v84, s[8:11], s39 offen lds
s_add_u32 m0, s38, 35840
s_add_u32 s39, s60, 401408
buffer_load_dwordx4 v84, s[8:11], s39 offen lds
s_add_u32 m0, s38, 49152
s_add_u32 s39, s60, 229376
buffer_load_dwordx4 v84, s[84:87], s39 offen lds
s_add_u32 m0, s38, 50176
s_add_u32 s39, s60, 286720
buffer_load_dwordx4 v84, s[84:87], s39 offen lds
s_add_u32 m0, s38, 51200
s_add_u32 s39, s60, 344064
buffer_load_dwordx4 v84, s[84:87], s39 offen lds
s_add_u32 m0, s38, 52224
s_add_u32 s39, s60, 401408
buffer_load_dwordx4 v84, s[84:87], s39 offen lds
s_add_u32 m0, s38, 65536
s_add_u32 s39, s60, 458752
buffer_load_dwordx4 v84, s[8:11], s39 offen lds
s_add_u32 m0, s38, 66560
s_add_u32 s39, s60, 516096
buffer_load_dwordx4 v84, s[8:11], s39 offen lds
s_add_u32 m0, s38, 67584
s_add_u32 s39, s60, 573440
buffer_load_dwordx4 v84, s[8:11], s39 offen lds
s_add_u32 m0, s38, 68608
s_add_u32 s39, s60, 630784
buffer_load_dwordx4 v84, s[8:11], s39 offen lds
s_add_u32 m0, s38, 81920
s_add_u32 s39, s60, 458752
buffer_load_dwordx4 v84, s[84:87], s39 offen lds
s_add_u32 m0, s38, 82944
s_add_u32 s39, s60, 516096
buffer_load_dwordx4 v84, s[84:87], s39 offen lds
s_add_u32 m0, s38, 83968
s_add_u32 s39, s60, 573440
buffer_load_dwordx4 v84, s[84:87], s39 offen lds
s_add_u32 m0, s38, 84992
s_add_u32 s39, s60, 630784
buffer_load_dwordx4 v84, s[84:87], s39 offen lds
s_add_u32 m0, s38, 98304
s_add_u32 s39, s60, 688128
buffer_load_dwordx4 v84, s[8:11], s39 offen lds
s_add_u32 m0, s38, 99328
s_add_u32 s39, s60, 745472
buffer_load_dwordx4 v84, s[8:11], s39 offen lds
s_add_u32 m0, s38, 100352
s_add_u32 s39, s60, 802816
buffer_load_dwordx4 v84, s[8:11], s39 offen lds
s_add_u32 m0, s38, 101376
s_add_u32 s39, s60, 860160
buffer_load_dwordx4 v84, s[8:11], s39 offen lds
s_add_u32 m0, s38, 114688
s_add_u32 s39, s60, 688128
buffer_load_dwordx4 v84, s[84:87], s39 offen lds
s_add_u32 m0, s38, 115712
s_add_u32 s39, s60, 745472
buffer_load_dwordx4 v84, s[84:87], s39 offen lds
s_add_u32 m0, s38, 116736
s_add_u32 s39, s60, 802816
buffer_load_dwordx4 v84, s[84:87], s39 offen lds
s_add_u32 m0, s38, 117760
s_add_u32 s39, s60, 860160
buffer_load_dwordx4 v84, s[84:87], s39 offen lds
s_add_u32 m0, s38, 131072
s_add_u32 s39, s60, 917504
buffer_load_dwordx4 v84, s[8:11], s39 offen lds
s_add_u32 m0, s38, 132096
s_add_u32 s39, s60, 974848
buffer_load_dwordx4 v84, s[8:11], s39 offen lds
s_add_u32 m0, s38, 133120
s_add_u32 s39, s60, 1032192
buffer_load_dwordx4 v84, s[8:11], s39 offen lds
s_add_u32 m0, s38, 134144
s_add_u32 s39, s60, 1089536
buffer_load_dwordx4 v84, s[8:11], s39 offen lds
s_add_u32 m0, s38, 147456
s_add_u32 s39, s60, 917504
buffer_load_dwordx4 v84, s[84:87], s39 offen lds
s_add_u32 m0, s38, 148480
s_add_u32 s39, s60, 974848
buffer_load_dwordx4 v84, s[84:87], s39 offen lds
s_add_u32 m0, s38, 149504
s_add_u32 s39, s60, 1032192
buffer_load_dwordx4 v84, s[84:87], s39 offen lds
s_add_u32 m0, s38, 150528
s_add_u32 s39, s60, 1089536
buffer_load_dwordx4 v84, s[84:87], s39 offen lds
s_waitcnt vmcnt(32)
s_barrier
ds_read_b64_tr_b16 a[0:1], v80 offset:0
ds_read_b64_tr_b16 a[2:3], v80 offset:512
ds_read_b64_tr_b16 a[32:33], v80 offset:4096
ds_read_b64_tr_b16 a[34:35], v80 offset:4608
ds_read_b64_tr_b16 a[64:65], v80 offset:8192
ds_read_b64_tr_b16 a[66:67], v80 offset:8704
ds_read_b64_tr_b16 a[96:97], v80 offset:12288
ds_read_b64_tr_b16 a[98:99], v80 offset:12800
ds_read_b64_tr_b16 a[128:129], v81 offset:0
ds_read_b64_tr_b16 a[130:131], v81 offset:512
ds_read_b64_tr_b16 a[160:161], v81 offset:4096
ds_read_b64_tr_b16 a[162:163], v81 offset:4608
ds_read_b64_tr_b16 a[192:193], v81 offset:8192
ds_read_b64_tr_b16 a[194:195], v81 offset:8704
ds_read_b64_tr_b16 a[224:225], v81 offset:12288
ds_read_b64_tr_b16 a[226:227], v81 offset:12800
v_add_u32 v80, 32768, v80
v_add_u32 v81, 32768, v81
s_waitcnt lgkmcnt(0)
s_barrier
s_add_u32 m0, s38, 0
s_add_u32 s39, s60, 1146880
buffer_load_dwordx4 v84, s[8:11], s39 offen lds
s_add_u32 m0, s38, 1024
s_add_u32 s39, s60, 1204224
buffer_load_dwordx4 v84, s[8:11], s39 offen lds
s_add_u32 m0, s38, 2048
s_add_u32 s39, s60, 1261568
buffer_load_dwordx4 v84, s[8:11], s39 offen lds
s_add_u32 m0, s38, 3072
s_add_u32 s39, s60, 1318912
buffer_load_dwordx4 v84, s[8:11], s39 offen lds
s_add_u32 m0, s38, 16384
s_add_u32 s39, s60, 1146880
buffer_load_dwordx4 v84, s[84:87], s39 offen lds
s_add_u32 m0, s38, 17408
s_add_u32 s39, s60, 1204224
buffer_load_dwordx4 v84, s[84:87], s39 offen lds
s_add_u32 m0, s38, 18432
s_add_u32 s39, s60, 1261568
buffer_load_dwordx4 v84, s[84:87], s39 offen lds
s_add_u32 m0, s38, 19456
s_add_u32 s39, s60, 1318912
buffer_load_dwordx4 v84, s[84:87], s39 offen lds
s_waitcnt vmcnt(32)
s_barrier
ds_read_b64_tr_b16 a[4:5], v80 offset:0
ds_read_b64_tr_b16 a[6:7], v80 offset:512
ds_read_b64_tr_b16 a[36:37], v80 offset:4096
ds_read_b64_tr_b16 a[38:39], v80 offset:4608
ds_read_b64_tr_b16 a[68:69], v80 offset:8192
ds_read_b64_tr_b16 a[70:71], v80 offset:8704
ds_read_b64_tr_b16 a[100:101], v80 offset:12288
ds_read_b64_tr_b16 a[102:103], v80 offset:12800
ds_read_b64_tr_b16 a[132:133], v81 offset:0
ds_read_b64_tr_b16 a[134:135], v81 offset:512
ds_read_b64_tr_b16 a[164:165], v81 offset:4096
ds_read_b64_tr_b16 a[166:167], v81 offset:4608
ds_read_b64_tr_b16 a[196:197], v81 offset:8192
ds_read_b64_tr_b16 a[198:199], v81 offset:8704
ds_read_b64_tr_b16 a[228:229], v81 offset:12288
ds_read_b64_tr_b16 a[230:231], v81 offset:12800
v_add_u32 v80, 32768, v80
v_add_u32 v81, 32768, v81
s_waitcnt lgkmcnt(0)
s_barrier
s_add_u32 m0, s38, 32768
s_add_u32 s39, s60, 1376256
buffer_load_dwordx4 v84, s[8:11], s39 offen lds
s_add_u32 m0, s38, 33792
s_add_u32 s39, s60, 1433600
buffer_load_dwordx4 v84, s[8:11], s39 offen lds
s_add_u32 m0, s38, 34816
s_add_u32 s39, s60, 1490944
buffer_load_dwordx4 v84, s[8:11], s39 offen lds
s_add_u32 m0, s38, 35840
s_add_u32 s39, s60, 1548288
buffer_load_dwordx4 v84, s[8:11], s39 offen lds
s_add_u32 m0, s38, 49152
s_add_u32 s39, s60, 1376256
buffer_load_dwordx4 v84, s[84:87], s39 offen lds
s_add_u32 m0, s38, 50176
s_add_u32 s39, s60, 1433600
buffer_load_dwordx4 v84, s[84:87], s39 offen lds
s_add_u32 m0, s38, 51200
s_add_u32 s39, s60, 1490944
buffer_load_dwordx4 v84, s[84:87], s39 offen lds
s_add_u32 m0, s38, 52224
s_add_u32 s39, s60, 1548288
buffer_load_dwordx4 v84, s[84:87], s39 offen lds
s_waitcnt vmcnt(32)
s_barrier
ds_read_b64_tr_b16 a[8:9], v80 offset:0
ds_read_b64_tr_b16 a[10:11], v80 offset:512
ds_read_b64_tr_b16 a[40:41], v80 offset:4096
ds_read_b64_tr_b16 a[42:43], v80 offset:4608
ds_read_b64_tr_b16 a[72:73], v80 offset:8192
ds_read_b64_tr_b16 a[74:75], v80 offset:8704
ds_read_b64_tr_b16 a[104:105], v80 offset:12288
ds_read_b64_tr_b16 a[106:107], v80 offset:12800
ds_read_b64_tr_b16 a[136:137], v81 offset:0
ds_read_b64_tr_b16 a[138:139], v81 offset:512
ds_read_b64_tr_b16 a[168:169], v81 offset:4096
ds_read_b64_tr_b16 a[170:171], v81 offset:4608
ds_read_b64_tr_b16 a[200:201], v81 offset:8192
ds_read_b64_tr_b16 a[202:203], v81 offset:8704
ds_read_b64_tr_b16 a[232:233], v81 offset:12288
ds_read_b64_tr_b16 a[234:235], v81 offset:12800
v_add_u32 v80, 32768, v80
v_add_u32 v81, 32768, v81
s_waitcnt lgkmcnt(0)
s_barrier
s_add_u32 m0, s38, 65536
s_add_u32 s39, s60, 1605632
buffer_load_dwordx4 v84, s[8:11], s39 offen lds
s_add_u32 m0, s38, 66560
s_add_u32 s39, s60, 1662976
buffer_load_dwordx4 v84, s[8:11], s39 offen lds
s_add_u32 m0, s38, 67584
s_add_u32 s39, s60, 1720320
buffer_load_dwordx4 v84, s[8:11], s39 offen lds
s_add_u32 m0, s38, 68608
s_add_u32 s39, s60, 1777664
buffer_load_dwordx4 v84, s[8:11], s39 offen lds
s_add_u32 m0, s38, 81920
s_add_u32 s39, s60, 1605632
buffer_load_dwordx4 v84, s[84:87], s39 offen lds
s_add_u32 m0, s38, 82944
s_add_u32 s39, s60, 1662976
buffer_load_dwordx4 v84, s[84:87], s39 offen lds
s_add_u32 m0, s38, 83968
s_add_u32 s39, s60, 1720320
buffer_load_dwordx4 v84, s[84:87], s39 offen lds
s_add_u32 m0, s38, 84992
s_add_u32 s39, s60, 1777664
buffer_load_dwordx4 v84, s[84:87], s39 offen lds
s_waitcnt vmcnt(32)
s_barrier
ds_read_b64_tr_b16 a[12:13], v80 offset:0
ds_read_b64_tr_b16 a[14:15], v80 offset:512
ds_read_b64_tr_b16 a[44:45], v80 offset:4096
ds_read_b64_tr_b16 a[46:47], v80 offset:4608
ds_read_b64_tr_b16 a[76:77], v80 offset:8192
ds_read_b64_tr_b16 a[78:79], v80 offset:8704
ds_read_b64_tr_b16 a[108:109], v80 offset:12288
ds_read_b64_tr_b16 a[110:111], v80 offset:12800
ds_read_b64_tr_b16 a[140:141], v81 offset:0
ds_read_b64_tr_b16 a[142:143], v81 offset:512
ds_read_b64_tr_b16 a[172:173], v81 offset:4096
ds_read_b64_tr_b16 a[174:175], v81 offset:4608
ds_read_b64_tr_b16 a[204:205], v81 offset:8192
ds_read_b64_tr_b16 a[206:207], v81 offset:8704
ds_read_b64_tr_b16 a[236:237], v81 offset:12288
ds_read_b64_tr_b16 a[238:239], v81 offset:12800
v_add_u32 v80, 32768, v80
v_add_u32 v81, 32768, v81
s_waitcnt lgkmcnt(0)
s_barrier
s_waitcnt vmcnt(24)
s_barrier
ds_read_b64_tr_b16 a[16:17], v80 offset:0
ds_read_b64_tr_b16 a[18:19], v80 offset:512
ds_read_b64_tr_b16 a[48:49], v80 offset:4096
ds_read_b64_tr_b16 a[50:51], v80 offset:4608
ds_read_b64_tr_b16 a[80:81], v80 offset:8192
ds_read_b64_tr_b16 a[82:83], v80 offset:8704
ds_read_b64_tr_b16 a[112:113], v80 offset:12288
ds_read_b64_tr_b16 a[114:115], v80 offset:12800
ds_read_b64_tr_b16 a[144:145], v81 offset:0
ds_read_b64_tr_b16 a[146:147], v81 offset:512
ds_read_b64_tr_b16 a[176:177], v81 offset:4096
ds_read_b64_tr_b16 a[178:179], v81 offset:4608
ds_read_b64_tr_b16 a[208:209], v81 offset:8192
ds_read_b64_tr_b16 a[210:211], v81 offset:8704
ds_read_b64_tr_b16 a[240:241], v81 offset:12288
ds_read_b64_tr_b16 a[242:243], v81 offset:12800
v_add_u32 v80, -131072, v80
v_add_u32 v81, -131072, v81
s_waitcnt lgkmcnt(0)
s_barrier
s_waitcnt vmcnt(16)
s_barrier
ds_read_b64_tr_b16 a[20:21], v80 offset:0
ds_read_b64_tr_b16 a[22:23], v80 offset:512
ds_read_b64_tr_b16 a[52:53], v80 offset:4096
ds_read_b64_tr_b16 a[54:55], v80 offset:4608
ds_read_b64_tr_b16 a[84:85], v80 offset:8192
ds_read_b64_tr_b16 a[86:87], v80 offset:8704
ds_read_b64_tr_b16 a[116:117], v80 offset:12288
ds_read_b64_tr_b16 a[118:119], v80 offset:12800
ds_read_b64_tr_b16 a[148:149], v81 offset:0
ds_read_b64_tr_b16 a[150:151], v81 offset:512
ds_read_b64_tr_b16 a[180:181], v81 offset:4096
ds_read_b64_tr_b16 a[182:183], v81 offset:4608
ds_read_b64_tr_b16 a[212:213], v81 offset:8192
ds_read_b64_tr_b16 a[214:215], v81 offset:8704
ds_read_b64_tr_b16 a[244:245], v81 offset:12288
ds_read_b64_tr_b16 a[246:247], v81 offset:12800
v_add_u32 v80, 32768, v80
v_add_u32 v81, 32768, v81
s_waitcnt lgkmcnt(0)
s_barrier
s_waitcnt vmcnt(8)
s_barrier
ds_read_b64_tr_b16 a[24:25], v80 offset:0
ds_read_b64_tr_b16 a[26:27], v80 offset:512
ds_read_b64_tr_b16 a[56:57], v80 offset:4096
ds_read_b64_tr_b16 a[58:59], v80 offset:4608
ds_read_b64_tr_b16 a[88:89], v80 offset:8192
ds_read_b64_tr_b16 a[90:91], v80 offset:8704
ds_read_b64_tr_b16 a[120:121], v80 offset:12288
ds_read_b64_tr_b16 a[122:123], v80 offset:12800
ds_read_b64_tr_b16 a[152:153], v81 offset:0
ds_read_b64_tr_b16 a[154:155], v81 offset:512
ds_read_b64_tr_b16 a[184:185], v81 offset:4096
ds_read_b64_tr_b16 a[186:187], v81 offset:4608
ds_read_b64_tr_b16 a[216:217], v81 offset:8192
ds_read_b64_tr_b16 a[218:219], v81 offset:8704
ds_read_b64_tr_b16 a[248:249], v81 offset:12288
ds_read_b64_tr_b16 a[250:251], v81 offset:12800
v_add_u32 v80, 32768, v80
v_add_u32 v81, 32768, v81
s_waitcnt lgkmcnt(0)
s_barrier
s_waitcnt vmcnt(0)
s_barrier
ds_read_b64_tr_b16 a[28:29], v80 offset:0
ds_read_b64_tr_b16 a[30:31], v80 offset:512
ds_read_b64_tr_b16 a[60:61], v80 offset:4096
ds_read_b64_tr_b16 a[62:63], v80 offset:4608
ds_read_b64_tr_b16 a[92:93], v80 offset:8192
ds_read_b64_tr_b16 a[94:95], v80 offset:8704
ds_read_b64_tr_b16 a[124:125], v80 offset:12288
ds_read_b64_tr_b16 a[126:127], v80 offset:12800
ds_read_b64_tr_b16 a[156:157], v81 offset:0
ds_read_b64_tr_b16 a[158:159], v81 offset:512
ds_read_b64_tr_b16 a[188:189], v81 offset:4096
ds_read_b64_tr_b16 a[190:191], v81 offset:4608
ds_read_b64_tr_b16 a[220:221], v81 offset:8192
ds_read_b64_tr_b16 a[222:223], v81 offset:8704
ds_read_b64_tr_b16 a[252:253], v81 offset:12288
ds_read_b64_tr_b16 a[254:255], v81 offset:12800
v_add_u32 v80, 32768, v80
v_add_u32 v81, 32768, v81
s_waitcnt lgkmcnt(0)
s_barrier
s_lshr_b32 s26, s44, 3
s_and_b32 s62, s44, 7
s_lshl_b32 s60, s26, 20
s_lshl_b32 s38, s62, 8
s_add_u32 s60, s60, s38
s_add_u32 s61, s60, 128
s_lshr_b32 s52, s32, 1
s_lshl_b32 s52, s52, 14
s_and_b32 s53, s32, 1
s_lshl_b32 s53, s53, 6
s_add_u32 s52, s52, s53
v_bfe_u32 v84, v9, 2, 2
v_lshrrev_b32 v85, 4, v9
v_lshl_add_u32 v84, v85, 3, v84
v_lshl_add_u32 v84, v84, 7, s52
v_and_b32 v85, 3, v9
v_lshl_add_u32 v84, v85, 4, v84
v_add_u32 v80, 0, v84
v_bfe_u32 v84, v9, 2, 2
v_lshrrev_b32 v85, 4, v9
v_lshl_add_u32 v84, v85, 3, v84
v_lshl_add_u32 v84, v84, 7, s52
v_and_b32 v85, 3, v9
v_lshl_add_u32 v84, v85, 4, v84
v_add_u32 v81, 8, v84
v_lshrrev_b32 v84, 3, v9
s_mul_i32 s38, s32, 128
v_add_u32 v84, s38, v84
v_mul_u32_u24 v84, 2048, v84
v_and_b32 v85, 7, v9
v_lshl_add_u32 v84, v85, 4, v84
s_lshl_b32 s38, s32, 12
s_barrier
s_add_u32 m0, s38, 0
s_add_u32 s39, s60, 0
buffer_load_dwordx4 v84, s[88:91], s39 offen lds
s_add_u32 m0, s38, 1024
s_add_u32 s39, s60, 16384
buffer_load_dwordx4 v84, s[88:91], s39 offen lds
s_add_u32 m0, s38, 2048
s_add_u32 s39, s60, 32768
buffer_load_dwordx4 v84, s[88:91], s39 offen lds
s_add_u32 m0, s38, 3072
s_add_u32 s39, s60, 49152
buffer_load_dwordx4 v84, s[88:91], s39 offen lds
s_add_u32 m0, s38, 16384
s_add_u32 s39, s61, 0
buffer_load_dwordx4 v84, s[88:91], s39 offen lds
s_add_u32 m0, s38, 17408
s_add_u32 s39, s61, 16384
buffer_load_dwordx4 v84, s[88:91], s39 offen lds
s_add_u32 m0, s38, 18432
s_add_u32 s39, s61, 32768
buffer_load_dwordx4 v84, s[88:91], s39 offen lds
s_add_u32 m0, s38, 19456
s_add_u32 s39, s61, 49152
buffer_load_dwordx4 v84, s[88:91], s39 offen lds
s_add_u32 m0, s38, 32768
s_add_u32 s39, s60, 65536
buffer_load_dwordx4 v84, s[88:91], s39 offen lds
s_add_u32 m0, s38, 33792
s_add_u32 s39, s60, 81920
buffer_load_dwordx4 v84, s[88:91], s39 offen lds
s_add_u32 m0, s38, 34816
s_add_u32 s39, s60, 98304
buffer_load_dwordx4 v84, s[88:91], s39 offen lds
s_add_u32 m0, s38, 35840
s_add_u32 s39, s60, 114688
buffer_load_dwordx4 v84, s[88:91], s39 offen lds
s_add_u32 m0, s38, 49152
s_add_u32 s39, s61, 65536
buffer_load_dwordx4 v84, s[88:91], s39 offen lds
s_add_u32 m0, s38, 50176
s_add_u32 s39, s61, 81920
buffer_load_dwordx4 v84, s[88:91], s39 offen lds
s_add_u32 m0, s38, 51200
s_add_u32 s39, s61, 98304
buffer_load_dwordx4 v84, s[88:91], s39 offen lds
s_add_u32 m0, s38, 52224
s_add_u32 s39, s61, 114688
buffer_load_dwordx4 v84, s[88:91], s39 offen lds
s_add_u32 m0, s38, 65536
s_add_u32 s39, s60, 131072
buffer_load_dwordx4 v84, s[88:91], s39 offen lds
s_add_u32 m0, s38, 66560
s_add_u32 s39, s60, 147456
buffer_load_dwordx4 v84, s[88:91], s39 offen lds
s_add_u32 m0, s38, 67584
s_add_u32 s39, s60, 163840
buffer_load_dwordx4 v84, s[88:91], s39 offen lds
s_add_u32 m0, s38, 68608
s_add_u32 s39, s60, 180224
buffer_load_dwordx4 v84, s[88:91], s39 offen lds
s_add_u32 m0, s38, 81920
s_add_u32 s39, s61, 131072
buffer_load_dwordx4 v84, s[88:91], s39 offen lds
s_add_u32 m0, s38, 82944
s_add_u32 s39, s61, 147456
buffer_load_dwordx4 v84, s[88:91], s39 offen lds
s_add_u32 m0, s38, 83968
s_add_u32 s39, s61, 163840
buffer_load_dwordx4 v84, s[88:91], s39 offen lds
s_add_u32 m0, s38, 84992
s_add_u32 s39, s61, 180224
buffer_load_dwordx4 v84, s[88:91], s39 offen lds
s_add_u32 m0, s38, 98304
s_add_u32 s39, s60, 196608
buffer_load_dwordx4 v84, s[88:91], s39 offen lds
s_add_u32 m0, s38, 99328
s_add_u32 s39, s60, 212992
buffer_load_dwordx4 v84, s[88:91], s39 offen lds
s_add_u32 m0, s38, 100352
s_add_u32 s39, s60, 229376
buffer_load_dwordx4 v84, s[88:91], s39 offen lds
s_add_u32 m0, s38, 101376
s_add_u32 s39, s60, 245760
buffer_load_dwordx4 v84, s[88:91], s39 offen lds
s_add_u32 m0, s38, 114688
s_add_u32 s39, s61, 196608
buffer_load_dwordx4 v84, s[88:91], s39 offen lds
s_add_u32 m0, s38, 115712
s_add_u32 s39, s61, 212992
buffer_load_dwordx4 v84, s[88:91], s39 offen lds
s_add_u32 m0, s38, 116736
s_add_u32 s39, s61, 229376
buffer_load_dwordx4 v84, s[88:91], s39 offen lds
s_add_u32 m0, s38, 117760
s_add_u32 s39, s61, 245760
buffer_load_dwordx4 v84, s[88:91], s39 offen lds
s_waitcnt vmcnt(24)
s_barrier
ds_read_b64_tr_b16 v[128:129], v80 offset:0
ds_read_b64_tr_b16 v[130:131], v80 offset:512
ds_read_b64_tr_b16 v[144:145], v80 offset:4096
ds_read_b64_tr_b16 v[146:147], v80 offset:4608
ds_read_b64_tr_b16 v[160:161], v80 offset:8192
ds_read_b64_tr_b16 v[162:163], v80 offset:8704
ds_read_b64_tr_b16 v[176:177], v80 offset:12288
ds_read_b64_tr_b16 v[178:179], v80 offset:12800
ds_read_b64_tr_b16 v[192:193], v81 offset:0
ds_read_b64_tr_b16 v[194:195], v81 offset:512
ds_read_b64_tr_b16 v[208:209], v81 offset:4096
ds_read_b64_tr_b16 v[210:211], v81 offset:4608
ds_read_b64_tr_b16 v[224:225], v81 offset:8192
ds_read_b64_tr_b16 v[226:227], v81 offset:8704
ds_read_b64_tr_b16 v[240:241], v81 offset:12288
ds_read_b64_tr_b16 v[242:243], v81 offset:12800
v_add_u32 v80, 32768, v80
v_add_u32 v81, 32768, v81
s_waitcnt lgkmcnt(0)
s_barrier
s_waitcnt vmcnt(16)
s_barrier
ds_read_b64_tr_b16 v[132:133], v80 offset:0
ds_read_b64_tr_b16 v[134:135], v80 offset:512
ds_read_b64_tr_b16 v[148:149], v80 offset:4096
ds_read_b64_tr_b16 v[150:151], v80 offset:4608
ds_read_b64_tr_b16 v[164:165], v80 offset:8192
ds_read_b64_tr_b16 v[166:167], v80 offset:8704
ds_read_b64_tr_b16 v[180:181], v80 offset:12288
ds_read_b64_tr_b16 v[182:183], v80 offset:12800
ds_read_b64_tr_b16 v[196:197], v81 offset:0
ds_read_b64_tr_b16 v[198:199], v81 offset:512
ds_read_b64_tr_b16 v[212:213], v81 offset:4096
ds_read_b64_tr_b16 v[214:215], v81 offset:4608
ds_read_b64_tr_b16 v[228:229], v81 offset:8192
ds_read_b64_tr_b16 v[230:231], v81 offset:8704
ds_read_b64_tr_b16 v[244:245], v81 offset:12288
ds_read_b64_tr_b16 v[246:247], v81 offset:12800
v_add_u32 v80, 32768, v80
v_add_u32 v81, 32768, v81
s_waitcnt lgkmcnt(0)
s_barrier
s_waitcnt vmcnt(8)
s_barrier
ds_read_b64_tr_b16 v[136:137], v80 offset:0
ds_read_b64_tr_b16 v[138:139], v80 offset:512
ds_read_b64_tr_b16 v[152:153], v80 offset:4096
ds_read_b64_tr_b16 v[154:155], v80 offset:4608
ds_read_b64_tr_b16 v[168:169], v80 offset:8192
ds_read_b64_tr_b16 v[170:171], v80 offset:8704
ds_read_b64_tr_b16 v[184:185], v80 offset:12288
ds_read_b64_tr_b16 v[186:187], v80 offset:12800
ds_read_b64_tr_b16 v[200:201], v81 offset:0
ds_read_b64_tr_b16 v[202:203], v81 offset:512
ds_read_b64_tr_b16 v[216:217], v81 offset:4096
ds_read_b64_tr_b16 v[218:219], v81 offset:4608
ds_read_b64_tr_b16 v[232:233], v81 offset:8192
ds_read_b64_tr_b16 v[234:235], v81 offset:8704
ds_read_b64_tr_b16 v[248:249], v81 offset:12288
ds_read_b64_tr_b16 v[250:251], v81 offset:12800
v_add_u32 v80, 32768, v80
v_add_u32 v81, 32768, v81
s_waitcnt lgkmcnt(0)
s_barrier
s_waitcnt vmcnt(0)
s_barrier
ds_read_b64_tr_b16 v[140:141], v80 offset:0
ds_read_b64_tr_b16 v[142:143], v80 offset:512
ds_read_b64_tr_b16 v[156:157], v80 offset:4096
ds_read_b64_tr_b16 v[158:159], v80 offset:4608
ds_read_b64_tr_b16 v[172:173], v80 offset:8192
ds_read_b64_tr_b16 v[174:175], v80 offset:8704
ds_read_b64_tr_b16 v[188:189], v80 offset:12288
ds_read_b64_tr_b16 v[190:191], v80 offset:12800
ds_read_b64_tr_b16 v[204:205], v81 offset:0
ds_read_b64_tr_b16 v[206:207], v81 offset:512
ds_read_b64_tr_b16 v[220:221], v81 offset:4096
ds_read_b64_tr_b16 v[222:223], v81 offset:4608
ds_read_b64_tr_b16 v[236:237], v81 offset:8192
ds_read_b64_tr_b16 v[238:239], v81 offset:8704
ds_read_b64_tr_b16 v[252:253], v81 offset:12288
ds_read_b64_tr_b16 v[254:255], v81 offset:12800
v_add_u32 v80, -98304, v80
v_add_u32 v81, -98304, v81
s_waitcnt lgkmcnt(0)
s_barrier
s_mul_i32 s50, s32, 4096
v_lshlrev_b32 v1, 4, v9
v_add_u32 v0, s50, v1
s_mov_b32 s60, s50
v_add_u32 v11, 0x20000, v1
v_mov_b32 v7, v1
v_min_u32 v2, 3, v9
v_lshlrev_b32 v2, 7, v2
v_min_u32 v12, 7, v9
v_lshlrev_b32 v12, 7, v12
s_lshl_b32 s61, s26, 10
s_add_u32 s61, s61, 3416064
s_lshl_b32 s38, s44, 1
s_lshr_b32 s39, s32, 1
s_add_u32 s38, s38, s39
s_lshl_b32 s38, s38, 11
s_and_b32 s39, s32, 1
s_lshl_b32 s39, s39, 9
s_add_u32 s38, s38, s39
v_and_b32 v80, 15, v9
v_lshl_add_u32 v6, v80, 4, s38
v_bfe_u32 v80, v9, 4, 1
v_lshl_add_u32 v6, v80, 10, v6
v_lshrrev_b32 v80, 5, v9
v_lshl_add_u32 v6, v80, 8, v6
s_mov_b32 s49, 100663296
s_mov_b32 s54, 16777216
s_lshl_b32 s59, s26, 15
s_add_u32 s59, s59, 99975168
s_lshl_b32 s38, s62, 2
s_add_u32 s38, s38, s32
s_lshl_b32 s38, s38, 11
s_lshl_b32 s62, s26, 22
s_add_u32 s62, s62, s38
s_add_u32 s62, s62, 134021120
s_mov_b32 s64, 0xbfb8aa3b
v_mov_b32 v100, 0
v_mov_b32 v101, 0
s_mov_b32 s36, 0
Lfw_625:
s_add_u32 s48, s36, 0
s_and_b32 s47, s48, 1
s_lshl_b32 s47, s47, 9
s_add_u32 s47, s47, 3423232
s_add_u32 s48, s48, 1
Lbw_630:
buffer_load_dword v3, v2, s[4:7], s47 offen sc1
s_waitcnt vmcnt(0)
v_cmp_gt_u32 vcc, s48, v3
s_cbranch_vccz Lbo_631
s_sub_u32 s37, s37, 1
s_cbranch_scc1 Lend_7
s_sleep 4
s_branch Lbw_630
Lbo_631:
s_add_u32 m0, s50, 0
s_add_u32 s39, s54, 0
buffer_load_dwordx4 v0, s[4:7], s39 offen offset:0 sc1 lds
buffer_load_dwordx4 v0, s[4:7], s39 offen offset:2048 sc1 lds
s_add_u32 m0, s50, 16384
s_add_u32 s39, s54, 16384
buffer_load_dwordx4 v0, s[4:7], s39 offen offset:0 sc1 lds
buffer_load_dwordx4 v0, s[4:7], s39 offen offset:2048 sc1 lds
s_add_u32 m0, s50, 32768
s_add_u32 s39, s54, 32768
buffer_load_dwordx4 v0, s[4:7], s39 offen offset:0 sc1 lds
buffer_load_dwordx4 v0, s[4:7], s39 offen offset:2048 sc1 lds
s_add_u32 m0, s50, 49152
s_add_u32 s39, s54, 49152
buffer_load_dwordx4 v0, s[4:7], s39 offen offset:0 sc1 lds
buffer_load_dwordx4 v0, s[4:7], s39 offen offset:2048 sc1 lds
s_add_u32 s48, s36, 1
s_and_b32 s47, s48, 1
s_lshl_b32 s47, s47, 9
s_add_u32 s47, s47, 3423232
s_add_u32 s48, s48, 1
buffer_load_dword v3, v2, s[4:7], s47 offen sc1
buffer_load_dword v13, v12, s[4:7], s61 offen sc1
s_add_u32 m0, s50, 0
s_add_u32 s39, s54, 0
buffer_load_dwordx4 v0, s[4:7], s39 offen offset:1024 sc1 lds
buffer_load_dwordx4 v0, s[4:7], s39 offen offset:3072 sc1 lds
s_add_u32 m0, s50, 16384
s_add_u32 s39, s54, 16384
buffer_load_dwordx4 v0, s[4:7], s39 offen offset:1024 sc1 lds
buffer_load_dwordx4 v0, s[4:7], s39 offen offset:3072 sc1 lds
s_add_u32 m0, s50, 32768
s_add_u32 s39, s54, 32768
buffer_load_dwordx4 v0, s[4:7], s39 offen offset:1024 sc1 lds
buffer_load_dwordx4 v0, s[4:7], s39 offen offset:3072 sc1 lds
s_add_u32 m0, s50, 49152
s_add_u32 s39, s54, 49152
buffer_load_dwordx4 v0, s[4:7], s39 offen offset:1024 sc1 lds
buffer_load_dwordx4 v0, s[4:7], s39 offen offset:3072 sc1 lds
s_mov_b32 s58, 0x70000000
s_waitcnt vmcnt(8)
s_barrier
ds_read_b128 v[16:19], v1 offset:0
ds_read_b128 v[20:23], v1 offset:2048
ds_read_b128 v[24:27], v1 offset:4096
ds_read_b128 v[28:31], v1 offset:6144
ds_read_b128 v[32:35], v1 offset:8192
ds_read_b128 v[36:39], v1 offset:10240
ds_read_b128 v[40:43], v1 offset:12288
Lfb_624:
s_waitcnt lgkmcnt(5)
v_mfma_f32_16x16x32_bf16 v[48:51], a[0:3], v[16:19], 0
s_add_u32 s54, s54, 65536
ds_read_b128 v[44:47], v1 offset:14336
s_xor_b32 s50, s50, 0x10000
v_mfma_f32_16x16x32_bf16 v[56:59], a[128:131], v[16:19], 0
s_sub_u32 s57, s36, 2
s_max_i32 s57, s57, 0
v_cmp_gt_u32 vcc, s48, v3
v_mfma_f32_16x16x32_bf16 v[48:51], a[4:7], v[20:23], v[48:51]
ds_read_b128 v[16:19], v1 offset:16384
v_mfma_f32_16x16x32_bf16 v[56:59], a[132:135], v[20:23], v[56:59]
s_waitcnt lgkmcnt(5)
s_cmp_eq_u64 vcc, 0
s_cselect_b32 s46, 1, 0
v_mfma_f32_16x16x32_bf16 v[48:51], a[8:11], v[24:27], v[48:51]
s_cselect_b32 s45, s54, 0x70000000
ds_read_b128 v[20:23], v1 offset:18432
v_cmp_gt_u32 vcc, s57, v13
v_mfma_f32_16x16x32_bf16 v[56:59], a[136:139], v[24:27], v[56:59]
v_mfma_f32_16x16x32_bf16 v[48:51], a[12:15], v[28:31], v[48:51]
s_cmp_eq_u64 vcc, 0
ds_read_b128 v[24:27], v1 offset:20480
s_cselect_b32 s56, 1, 0
v_mfma_f32_16x16x32_bf16 v[56:59], a[140:143], v[28:31], v[56:59]
s_waitcnt lgkmcnt(5)
s_cselect_b32 s55, s59, 0x70000000
s_add_u32 m0, s60, 131072
v_mfma_f32_16x16x32_bf16 v[48:51], a[16:19], v[32:35], v[48:51]
s_add_u32 s39, s55, 0
ds_read_b128 v[28:31], v1 offset:22528
buffer_load_dwordx4 v0, s[4:7], s39 offen offset:0 sc1 lds
v_mfma_f32_16x16x32_bf16 v[56:59], a[144:147], v[32:35], v[56:59]
v_mfma_f32_16x16x32_bf16 v[48:51], a[20:23], v[36:39], v[48:51]
ds_read_b128 v[32:35], v1 offset:24576
v_cvt_pk_bf16_f32 v80, v64, v65
v_mfma_f32_16x16x32_bf16 v[56:59], a[148:151], v[36:39], v[56:59]
s_waitcnt lgkmcnt(5)
v_cvt_pk_bf16_f32 v81, v66, v67
v_cvt_pk_bf16_f32 v82, v68, v69
v_mfma_f32_16x16x32_bf16 v[48:51], a[24:27], v[40:43], v[48:51]
ds_read_b128 v[36:39], v1 offset:26624
v_cvt_pk_bf16_f32 v83, v70, v71
v_mfma_f32_16x16x32_bf16 v[56:59], a[152:155], v[40:43], v[56:59]
buffer_load_dwordx4 v0, s[4:7], s39 offen offset:1024 sc1 lds
v_cvt_pk_bf16_f32 v84, v72, v73
v_mfma_f32_16x16x32_bf16 v[48:51], a[28:31], v[44:47], v[48:51]
ds_read_b128 v[40:43], v1 offset:28672
v_cvt_pk_bf16_f32 v85, v74, v75
v_mfma_f32_16x16x32_bf16 v[56:59], a[156:159], v[44:47], v[56:59]
s_waitcnt lgkmcnt(5)
v_cvt_pk_bf16_f32 v86, v76, v77
v_cvt_pk_bf16_f32 v87, v78, v79
v_mfma_f32_16x16x32_bf16 v[48:51], a[32:35], v[16:19], v[48:51]
ds_read_b128 v[44:47], v1 offset:30720
v_mfma_f32_16x16x32_bf16 v[56:59], a[160:163], v[16:19], v[56:59]
v_mfma_f32_16x16x32_bf16 v[48:51], a[36:39], v[20:23], v[48:51]
ds_read_b128 v[16:19], v1 offset:32768
buffer_load_dwordx4 v0, s[4:7], s39 offen offset:2048 sc1 lds
v_mfma_f32_16x16x32_bf16 v[56:59], a[164:167], v[20:23], v[56:59]
s_waitcnt lgkmcnt(5)
v_mfma_f32_16x16x32_bf16 v[48:51], a[40:43], v[24:27], v[48:51]
ds_read_b128 v[20:23], v1 offset:34816
v_mfma_f32_16x16x32_bf16 v[56:59], a[168:171], v[24:27], v[56:59]
v_mfma_f32_16x16x32_bf16 v[48:51], a[44:47], v[28:31], v[48:51]
ds_read_b128 v[24:27], v1 offset:36864
v_mfma_f32_16x16x32_bf16 v[56:59], a[172:175], v[28:31], v[56:59]
s_waitcnt lgkmcnt(5)
buffer_load_dwordx4 v0, s[4:7], s39 offen offset:3072 sc1 lds
v_mfma_f32_16x16x32_bf16 v[48:51], a[48:51], v[32:35], v[48:51]
ds_read_b128 v[28:31], v1 offset:38912
v_mfma_f32_16x16x32_bf16 v[56:59], a[176:179], v[32:35], v[56:59]
v_mfma_f32_16x16x32_bf16 v[48:51], a[52:55], v[36:39], v[48:51]
ds_read_b128 v[32:35], v1 offset:40960
v_mfma_f32_16x16x32_bf16 v[56:59], a[180:183], v[36:39], v[56:59]
s_waitcnt lgkmcnt(5)
v_mfma_f32_16x16x32_bf16 v[48:51], a[56:59], v[40:43], v[48:51]
s_add_u32 m0, s60, 147456
ds_read_b128 v[36:39], v1 offset:43008
s_add_u32 s39, s55, 16384
v_mfma_f32_16x16x32_bf16 v[56:59], a[184:187], v[40:43], v[56:59]
buffer_load_dwordx4 v0, s[4:7], s39 offen offset:0 sc1 lds
v_mfma_f32_16x16x32_bf16 v[48:51], a[60:63], v[44:47], v[48:51]
ds_read_b128 v[40:43], v1 offset:45056
v_mfma_f32_16x16x32_bf16 v[56:59], a[188:191], v[44:47], v[56:59]
s_waitcnt lgkmcnt(5)
v_mfma_f32_16x16x32_bf16 v[48:51], a[64:67], v[16:19], v[48:51]
ds_read_b128 v[44:47], v1 offset:47104
v_mfma_f32_16x16x32_bf16 v[56:59], a[192:195], v[16:19], v[56:59]
v_mfma_f32_16x16x32_bf16 v[48:51], a[68:71], v[20:23], v[48:51]
ds_read_b128 v[16:19], v1 offset:49152
buffer_load_dwordx4 v0, s[4:7], s39 offen offset:1024 sc1 lds
v_mfma_f32_16x16x32_bf16 v[56:59], a[196:199], v[20:23], v[56:59]
s_waitcnt lgkmcnt(5)
v_mfma_f32_16x16x32_bf16 v[48:51], a[72:75], v[24:27], v[48:51]
ds_read_b128 v[20:23], v1 offset:51200
v_mfma_f32_16x16x32_bf16 v[56:59], a[200:203], v[24:27], v[56:59]
v_mfma_f32_16x16x32_bf16 v[48:51], a[76:79], v[28:31], v[48:51]
ds_read_b128 v[24:27], v1 offset:53248
v_mfma_f32_16x16x32_bf16 v[56:59], a[204:207], v[28:31], v[56:59]
s_waitcnt lgkmcnt(5)
buffer_load_dwordx4 v0, s[4:7], s39 offen offset:2048 sc1 lds
v_mfma_f32_16x16x32_bf16 v[48:51], a[80:83], v[32:35], v[48:51]
ds_read_b128 v[28:31], v1 offset:55296
v_mfma_f32_16x16x32_bf16 v[56:59], a[208:211], v[32:35], v[56:59]
v_mfma_f32_16x16x32_bf16 v[48:51], a[84:87], v[36:39], v[48:51]
ds_read_b128 v[32:35], v1 offset:57344
v_mfma_f32_16x16x32_bf16 v[56:59], a[212:215], v[36:39], v[56:59]
s_waitcnt lgkmcnt(5)
v_mfma_f32_16x16x32_bf16 v[48:51], a[88:91], v[40:43], v[48:51]
ds_read_b128 v[36:39], v1 offset:59392
buffer_load_dwordx4 v0, s[4:7], s39 offen offset:3072 sc1 lds
v_mfma_f32_16x16x32_bf16 v[56:59], a[216:219], v[40:43], v[56:59]
v_mfma_f32_16x16x32_bf16 v[48:51], a[92:95], v[44:47], v[48:51]
ds_read_b128 v[40:43], v1 offset:61440
v_mfma_f32_16x16x32_bf16 v[56:59], a[220:223], v[44:47], v[56:59]
s_waitcnt lgkmcnt(5)
v_mfma_f32_16x16x32_bf16 v[48:51], a[96:99], v[16:19], v[48:51]
ds_read_b128 v[44:47], v1 offset:63488
v_mfma_f32_16x16x32_bf16 v[56:59], a[224:227], v[16:19], v[56:59]
v_mfma_f32_16x16x32_bf16 v[48:51], a[100:103], v[20:23], v[48:51]
s_waitcnt vmcnt(8)
s_barrier
ds_read_b128 v[16:19], v1 offset:1024
v_mfma_f32_16x16x32_bf16 v[56:59], a[228:231], v[20:23], v[56:59]
s_waitcnt lgkmcnt(5)
v_min_u32 v100, s36, 64
s_sub_u32 s38, s36, 4
v_mfma_f32_16x16x32_bf16 v[48:51], a[104:107], v[24:27], v[48:51]
ds_read_b128 v[20:23], v1 offset:3072
v_max_i32 v101, s38, 0
v_mfma_f32_16x16x32_bf16 v[56:59], a[232:235], v[24:27], v[56:59]
buffer_store_dwordx2 v[100:101], v4, s[4:7], 0 offen sc1
v_mfma_f32_16x16x32_bf16 v[48:51], a[108:111], v[28:31], v[48:51]
ds_read_b128 v[24:27], v1 offset:5120
v_mfma_f32_16x16x32_bf16 v[56:59], a[236:239], v[28:31], v[56:59]
s_waitcnt lgkmcnt(5)
s_add_u32 m0, s50, 0
s_add_u32 s39, s45, 0
v_mfma_f32_16x16x32_bf16 v[48:51], a[112:115], v[32:35], v[48:51]
ds_read_b128 v[28:31], v1 offset:7168
buffer_load_dwordx4 v0, s[4:7], s39 offen offset:0 sc1 lds
v_mfma_f32_16x16x32_bf16 v[56:59], a[240:243], v[32:35], v[56:59]
v_mfma_f32_16x16x32_bf16 v[48:51], a[116:119], v[36:39], v[48:51]
ds_read_b128 v[32:35], v1 offset:9216
v_mfma_f32_16x16x32_bf16 v[56:59], a[244:247], v[36:39], v[56:59]
s_waitcnt lgkmcnt(5)
v_mfma_f32_16x16x32_bf16 v[48:51], a[120:123], v[40:43], v[48:51]
ds_read_b128 v[36:39], v1 offset:11264
v_mfma_f32_16x16x32_bf16 v[56:59], a[248:251], v[40:43], v[56:59]
buffer_load_dwordx4 v0, s[4:7], s39 offen offset:1024 sc1 lds
v_mfma_f32_16x16x32_bf16 v[48:51], a[124:127], v[44:47], v[48:51]
ds_read_b128 v[40:43], v1 offset:13312
v_mfma_f32_16x16x32_bf16 v[56:59], a[252:255], v[44:47], v[56:59]
s_waitcnt lgkmcnt(5)
v_mfma_f32_16x16x32_bf16 v[52:55], a[0:3], v[16:19], 0
ds_read_b128 v[44:47], v1 offset:15360
v_mfma_f32_16x16x32_bf16 v[60:63], a[128:131], v[16:19], 0
v_mfma_f32_16x16x32_bf16 v[52:55], a[4:7], v[20:23], v[52:55]
ds_read_b128 v[16:19], v1 offset:17408
buffer_load_dwordx4 v0, s[4:7], s39 offen offset:2048 sc1 lds
v_mfma_f32_16x16x32_bf16 v[60:63], a[132:135], v[20:23], v[60:63]
s_waitcnt lgkmcnt(5)
v_mfma_f32_16x16x32_bf16 v[52:55], a[8:11], v[24:27], v[52:55]
ds_read_b128 v[20:23], v1 offset:19456
v_mfma_f32_16x16x32_bf16 v[60:63], a[136:139], v[24:27], v[60:63]
v_mfma_f32_16x16x32_bf16 v[52:55], a[12:15], v[28:31], v[52:55]
ds_read_b128 v[24:27], v1 offset:21504
v_mfma_f32_16x16x32_bf16 v[60:63], a[140:143], v[28:31], v[60:63]
s_waitcnt lgkmcnt(5)
buffer_load_dwordx4 v0, s[4:7], s39 offen offset:3072 sc1 lds
v_mfma_f32_16x16x32_bf16 v[52:55], a[16:19], v[32:35], v[52:55]
ds_read_b128 v[28:31], v1 offset:23552
v_mul_f32 v88, s64, v48
v_mfma_f32_16x16x32_bf16 v[60:63], a[144:147], v[32:35], v[60:63]
v_mul_f32 v89, s64, v49
v_mul_f32 v90, s64, v50
v_mfma_f32_16x16x32_bf16 v[52:55], a[20:23], v[36:39], v[52:55]
ds_read_b128 v[32:35], v1 offset:25600
v_mul_f32 v91, s64, v51
v_mfma_f32_16x16x32_bf16 v[60:63], a[148:151], v[36:39], v[60:63]
s_waitcnt lgkmcnt(5)
v_exp_f32 v88, v88
v_mfma_f32_16x16x32_bf16 v[52:55], a[24:27], v[40:43], v[52:55]
s_add_u32 m0, s50, 16384
ds_read_b128 v[36:39], v1 offset:27648
s_add_u32 s39, s45, 16384
v_mfma_f32_16x16x32_bf16 v[60:63], a[152:155], v[40:43], v[60:63]
buffer_load_dwordx4 v0, s[4:7], s39 offen offset:0 sc1 lds
v_mfma_f32_16x16x32_bf16 v[52:55], a[28:31], v[44:47], v[52:55]
ds_read_b128 v[40:43], v1 offset:29696
v_mfma_f32_16x16x32_bf16 v[60:63], a[156:159], v[44:47], v[60:63]
s_waitcnt lgkmcnt(5)
v_exp_f32 v89, v89
v_mfma_f32_16x16x32_bf16 v[52:55], a[32:35], v[16:19], v[52:55]
ds_read_b128 v[44:47], v1 offset:31744
v_mfma_f32_16x16x32_bf16 v[60:63], a[160:163], v[16:19], v[60:63]
v_exp_f32 v90, v90
v_mfma_f32_16x16x32_bf16 v[52:55], a[36:39], v[20:23], v[52:55]
ds_read_b128 v[16:19], v1 offset:33792
buffer_load_dwordx4 v0, s[4:7], s39 offen offset:1024 sc1 lds
v_mfma_f32_16x16x32_bf16 v[60:63], a[164:167], v[20:23], v[60:63]
s_waitcnt lgkmcnt(5)
v_exp_f32 v91, v91
v_mfma_f32_16x16x32_bf16 v[52:55], a[40:43], v[24:27], v[52:55]
ds_read_b128 v[20:23], v1 offset:35840
v_mul_f32 v104, v48, v56
v_mfma_f32_16x16x32_bf16 v[60:63], a[168:171], v[24:27], v[60:63]
v_mul_f32 v105, v49, v57
v_mul_f32 v106, v50, v58
v_mfma_f32_16x16x32_bf16 v[52:55], a[44:47], v[28:31], v[52:55]
ds_read_b128 v[24:27], v1 offset:37888
v_mul_f32 v107, v51, v59
v_mfma_f32_16x16x32_bf16 v[60:63], a[172:175], v[28:31], v[60:63]
s_waitcnt lgkmcnt(5)
buffer_load_dwordx4 v0, s[4:7], s39 offen offset:2048 sc1 lds
v_add_f32 v88, 1.0, v88
v_mfma_f32_16x16x32_bf16 v[52:55], a[48:51], v[32:35], v[52:55]
ds_read_b128 v[28:31], v1 offset:39936
v_add_f32 v89, 1.0, v89
v_mfma_f32_16x16x32_bf16 v[60:63], a[176:179], v[32:35], v[60:63]
v_add_f32 v90, 1.0, v90
v_add_f32 v91, 1.0, v91
v_mfma_f32_16x16x32_bf16 v[52:55], a[52:55], v[36:39], v[52:55]
ds_read_b128 v[32:35], v1 offset:41984
v_mfma_f32_16x16x32_bf16 v[60:63], a[180:183], v[36:39], v[60:63]
s_waitcnt lgkmcnt(5)
v_rcp_f32 v88, v88
v_mfma_f32_16x16x32_bf16 v[52:55], a[56:59], v[40:43], v[52:55]
ds_read_b128 v[36:39], v1 offset:44032
buffer_load_dwordx4 v0, s[4:7], s39 offen offset:3072 sc1 lds
v_mfma_f32_16x16x32_bf16 v[60:63], a[184:187], v[40:43], v[60:63]
v_rcp_f32 v89, v89
v_mfma_f32_16x16x32_bf16 v[52:55], a[60:63], v[44:47], v[52:55]
ds_read_b128 v[40:43], v1 offset:46080
v_mfma_f32_16x16x32_bf16 v[60:63], a[188:191], v[44:47], v[60:63]
s_waitcnt lgkmcnt(5)
v_rcp_f32 v90, v90
v_mfma_f32_16x16x32_bf16 v[52:55], a[64:67], v[16:19], v[52:55]
ds_read_b128 v[44:47], v1 offset:48128
v_mfma_f32_16x16x32_bf16 v[60:63], a[192:195], v[16:19], v[60:63]
s_add_u32 m0, s50, 32768
s_add_u32 s39, s45, 32768
buffer_load_dwordx4 v0, s[4:7], s39 offen offset:0 sc1 lds
v_mfma_f32_16x16x32_bf16 v[52:55], a[68:71], v[20:23], v[52:55]
ds_read_b128 v[16:19], v1 offset:50176
v_mfma_f32_16x16x32_bf16 v[60:63], a[196:199], v[20:23], v[60:63]
s_waitcnt lgkmcnt(5)
v_rcp_f32 v91, v91
v_mfma_f32_16x16x32_bf16 v[52:55], a[72:75], v[24:27], v[52:55]
ds_read_b128 v[20:23], v1 offset:52224
v_mul_f32 v104, v104, v88
v_mfma_f32_16x16x32_bf16 v[60:63], a[200:203], v[24:27], v[60:63]
v_mul_f32 v105, v105, v89
v_mul_f32 v106, v106, v90
v_mfma_f32_16x16x32_bf16 v[52:55], a[76:79], v[28:31], v[52:55]
ds_read_b128 v[24:27], v1 offset:54272
buffer_load_dwordx4 v0, s[4:7], s39 offen offset:1024 sc1 lds
v_mfma_f32_16x16x32_bf16 v[60:63], a[204:207], v[28:31], v[60:63]
s_waitcnt lgkmcnt(5)
v_mul_f32 v107, v107, v91
v_mfma_f32_16x16x32_bf16 v[52:55], a[80:83], v[32:35], v[52:55]
ds_read_b128 v[28:31], v1 offset:56320
v_mfma_f32_16x16x32_bf16 v[60:63], a[208:211], v[32:35], v[60:63]
v_mfma_f32_16x16x32_bf16 v[52:55], a[84:87], v[36:39], v[52:55]
ds_read_b128 v[32:35], v1 offset:58368
v_mfma_f32_16x16x32_bf16 v[60:63], a[212:215], v[36:39], v[60:63]
s_waitcnt lgkmcnt(5)
buffer_load_dwordx4 v0, s[4:7], s39 offen offset:2048 sc1 lds
v_mfma_f32_16x16x32_bf16 v[52:55], a[88:91], v[40:43], v[52:55]
ds_read_b128 v[36:39], v1 offset:60416
v_mfma_f32_16x16x32_bf16 v[60:63], a[216:219], v[40:43], v[60:63]
v_mfma_f32_16x16x32_bf16 v[52:55], a[92:95], v[44:47], v[52:55]
ds_read_b128 v[40:43], v1 offset:62464
v_mfma_f32_16x16x32_bf16 v[60:63], a[220:223], v[44:47], v[60:63]
s_waitcnt lgkmcnt(5)
v_mfma_f32_16x16x32_bf16 v[52:55], a[96:99], v[16:19], v[52:55]
ds_read_b128 v[44:47], v1 offset:64512
buffer_load_dwordx4 v0, s[4:7], s39 offen offset:3072 sc1 lds
v_mfma_f32_16x16x32_bf16 v[60:63], a[224:227], v[16:19], v[60:63]
v_mfma_f32_16x16x32_bf16 v[52:55], a[100:103], v[20:23], v[52:55]
v_mfma_f32_16x16x32_bf16 v[60:63], a[228:231], v[20:23], v[60:63]
s_waitcnt lgkmcnt(4)
v_mfma_f32_16x16x32_bf16 v[52:55], a[104:107], v[24:27], v[52:55]
v_mfma_f32_16x16x32_bf16 v[60:63], a[232:235], v[24:27], v[60:63]
s_add_u32 m0, s50, 49152
s_add_u32 s39, s45, 49152
buffer_load_dwordx4 v0, s[4:7], s39 offen offset:0 sc1 lds
s_cmp_eq_u32 s56, 0
s_cbranch_scc1 Lfl_626
s_waitcnt vmcnt(14) lgkmcnt(0)
Lfg_627:
s_barrier
v_mfma_f32_16x16x32_bf16 v[52:55], a[108:111], v[28:31], v[52:55]
ds_read_b128 v[16:19], v11 offset:0
ds_read_b128 v[20:23], v11 offset:1024
v_mfma_f32_16x16x32_bf16 v[60:63], a[236:239], v[28:31], v[60:63]
s_add_u32 s48, s36, 2
ds_read_b128 v[24:27], v11 offset:2048
s_and_b32 s47, s48, 1
v_mfma_f32_16x16x32_bf16 v[52:55], a[112:115], v[32:35], v[52:55]
ds_read_b128 v[28:31], v11 offset:3072
buffer_load_dwordx4 v0, s[4:7], s39 offen offset:1024 sc1 lds
v_mfma_f32_16x16x32_bf16 v[60:63], a[240:243], v[32:35], v[60:63]
s_lshl_b32 s47, s47, 9
s_add_u32 s47, s47, 3423232
s_add_u32 s48, s48, 1
v_mfma_f32_16x16x32_bf16 v[52:55], a[116:119], v[36:39], v[52:55]
ds_read_b128 v[32:35], v11 offset:4096
v_xor_b32 v1, 0x10000, v1
v_mfma_f32_16x16x32_bf16 v[60:63], a[244:247], v[36:39], v[60:63]
v_mfma_f32_16x16x32_bf16 v[52:55], a[120:123], v[40:43], v[52:55]
ds_read_b128 v[36:39], v11 offset:5120
buffer_load_dwordx4 v0, s[4:7], s39 offen offset:2048 sc1 lds
v_mfma_f32_16x16x32_bf16 v[60:63], a[248:251], v[40:43], v[60:63]
v_mfma_f32_16x16x32_bf16 v[52:55], a[124:127], v[44:47], v[52:55]
ds_read_b128 v[40:43], v11 offset:6144
v_mfma_f32_16x16x32_bf16 v[60:63], a[252:255], v[44:47], v[60:63]
s_waitcnt lgkmcnt(5)
v_mfma_f32_16x16x32_bf16 v[64:67], v[128:131], v[16:19], 0
ds_read_b128 v[44:47], v11 offset:7168
buffer_load_dwordx4 v0, s[4:7], s39 offen offset:3072 sc1 lds
v_mfma_f32_16x16x32_bf16 v[68:71], v[192:195], v[16:19], 0
v_mfma_f32_16x16x32_bf16 v[72:75], v[128:131], v[20:23], 0
ds_read_b128 v[16:19], v11 offset:8192
v_mfma_f32_16x16x32_bf16 v[76:79], v[192:195], v[20:23], 0
s_waitcnt lgkmcnt(5)
v_mfma_f32_16x16x32_bf16 v[64:67], v[132:135], v[24:27], v[64:67]
ds_read_b128 v[20:23], v11 offset:9216
buffer_load_dword v3, v2, s[4:7], s47 offen sc1
v_mfma_f32_16x16x32_bf16 v[68:71], v[196:199], v[24:27], v[68:71]
v_mfma_f32_16x16x32_bf16 v[72:75], v[132:135], v[28:31], v[72:75]
ds_read_b128 v[24:27], v11 offset:10240
buffer_load_dword v13, v12, s[4:7], s61 offen sc1
v_mfma_f32_16x16x32_bf16 v[76:79], v[196:199], v[28:31], v[76:79]
s_waitcnt lgkmcnt(5)
v_mfma_f32_16x16x32_bf16 v[64:67], v[136:139], v[32:35], v[64:67]
ds_read_b128 v[28:31], v11 offset:11264
v_mul_f32 v88, s64, v52
v_mfma_f32_16x16x32_bf16 v[68:71], v[200:203], v[32:35], v[68:71]
buffer_store_dwordx4 v[80:83], v7, s[4:7], s58 offen offset:0 sc1
v_mfma_f32_16x16x32_bf16 v[72:75], v[136:139], v[36:39], v[72:75]
ds_read_b128 v[32:35], v11 offset:12288
v_mul_f32 v89, s64, v53
v_mfma_f32_16x16x32_bf16 v[76:79], v[200:203], v[36:39], v[76:79]
s_waitcnt lgkmcnt(5)
v_mul_f32 v90, s64, v54
v_mul_f32 v91, s64, v55
v_mfma_f32_16x16x32_bf16 v[64:67], v[140:143], v[40:43], v[64:67]
ds_read_b128 v[36:39], v11 offset:13312
v_mfma_f32_16x16x32_bf16 v[68:71], v[204:207], v[40:43], v[68:71]
buffer_store_dwordx4 v[84:87], v7, s[4:7], s58 offen offset:1024 sc1
v_mfma_f32_16x16x32_bf16 v[72:75], v[140:143], v[44:47], v[72:75]
ds_read_b128 v[40:43], v11 offset:14336
v_mfma_f32_16x16x32_bf16 v[76:79], v[204:207], v[44:47], v[76:79]
s_waitcnt lgkmcnt(5)
v_exp_f32 v88, v88
v_mfma_f32_16x16x32_bf16 v[64:67], v[144:147], v[16:19], v[64:67]
ds_read_b128 v[44:47], v11 offset:15360
v_mfma_f32_16x16x32_bf16 v[68:71], v[208:211], v[16:19], v[68:71]
v_exp_f32 v89, v89
v_mfma_f32_16x16x32_bf16 v[72:75], v[144:147], v[20:23], v[72:75]
ds_read_b128 v[16:19], v11 offset:16384
v_mfma_f32_16x16x32_bf16 v[76:79], v[208:211], v[20:23], v[76:79]
s_waitcnt lgkmcnt(5)
v_exp_f32 v90, v90
v_mfma_f32_16x16x32_bf16 v[64:67], v[148:151], v[24:27], v[64:67]
ds_read_b128 v[20:23], v11 offset:17408
v_mfma_f32_16x16x32_bf16 v[68:71], v[212:215], v[24:27], v[68:71]
v_exp_f32 v91, v91
v_mfma_f32_16x16x32_bf16 v[72:75], v[148:151], v[28:31], v[72:75]
ds_read_b128 v[24:27], v11 offset:18432
v_mul_f32 v108, v52, v60
v_mfma_f32_16x16x32_bf16 v[76:79], v[212:215], v[28:31], v[76:79]
s_waitcnt lgkmcnt(5)
v_mul_f32 v109, v53, v61
v_mul_f32 v110, v54, v62
v_mfma_f32_16x16x32_bf16 v[64:67], v[152:155], v[32:35], v[64:67]
ds_read_b128 v[28:31], v11 offset:19456
v_mul_f32 v111, v55, v63
v_mfma_f32_16x16x32_bf16 v[68:71], v[216:219], v[32:35], v[68:71]
v_add_f32 v88, 1.0, v88
v_add_f32 v89, 1.0, v89
v_mfma_f32_16x16x32_bf16 v[72:75], v[152:155], v[36:39], v[72:75]
ds_read_b128 v[32:35], v11 offset:20480
v_add_f32 v90, 1.0, v90
v_mfma_f32_16x16x32_bf16 v[76:79], v[216:219], v[36:39], v[76:79]
s_waitcnt lgkmcnt(5)
v_add_f32 v91, 1.0, v91
v_mfma_f32_16x16x32_bf16 v[64:67], v[156:159], v[40:43], v[64:67]
ds_read_b128 v[36:39], v11 offset:21504
v_mfma_f32_16x16x32_bf16 v[68:71], v[220:223], v[40:43], v[68:71]
v_rcp_f32 v88, v88
v_mfma_f32_16x16x32_bf16 v[72:75], v[156:159], v[44:47], v[72:75]
ds_read_b128 v[40:43], v11 offset:22528
v_mfma_f32_16x16x32_bf16 v[76:79], v[220:223], v[44:47], v[76:79]
s_waitcnt lgkmcnt(5)
v_rcp_f32 v89, v89
v_mfma_f32_16x16x32_bf16 v[64:67], v[160:163], v[16:19], v[64:67]
ds_read_b128 v[44:47], v11 offset:23552
v_mfma_f32_16x16x32_bf16 v[68:71], v[224:227], v[16:19], v[68:71]
v_rcp_f32 v90, v90
v_mfma_f32_16x16x32_bf16 v[72:75], v[160:163], v[20:23], v[72:75]
ds_read_b128 v[16:19], v11 offset:24576
v_mfma_f32_16x16x32_bf16 v[76:79], v[224:227], v[20:23], v[76:79]
s_waitcnt lgkmcnt(5)
v_rcp_f32 v91, v91
v_mfma_f32_16x16x32_bf16 v[64:67], v[164:167], v[24:27], v[64:67]
ds_read_b128 v[20:23], v11 offset:25600
v_mul_f32 v108, v108, v88
v_mfma_f32_16x16x32_bf16 v[68:71], v[228:231], v[24:27], v[68:71]
v_mul_f32 v109, v109, v89
v_mul_f32 v110, v110, v90
v_mfma_f32_16x16x32_bf16 v[72:75], v[164:167], v[28:31], v[72:75]
ds_read_b128 v[24:27], v11 offset:26624
v_mul_f32 v111, v111, v91
v_mfma_f32_16x16x32_bf16 v[76:79], v[228:231], v[28:31], v[76:79]
s_waitcnt lgkmcnt(5)
v_cvt_pk_bf16_f32 v96, v104, v105
v_cvt_pk_bf16_f32 v97, v106, v107
v_mfma_f32_16x16x32_bf16 v[64:67], v[168:171], v[32:35], v[64:67]
ds_read_b128 v[28:31], v11 offset:27648
v_cvt_pk_bf16_f32 v98, v108, v109
v_mfma_f32_16x16x32_bf16 v[68:71], v[232:235], v[32:35], v[68:71]
v_cvt_pk_bf16_f32 v99, v110, v111
v_mfma_f32_16x16x32_bf16 v[72:75], v[168:171], v[36:39], v[72:75]
ds_read_b128 v[32:35], v11 offset:28672
v_mfma_f32_16x16x32_bf16 v[76:79], v[232:235], v[36:39], v[76:79]
s_waitcnt lgkmcnt(5)
v_permlane16_swap_b32 v96, v98
v_permlane16_swap_b32 v97, v99
v_mfma_f32_16x16x32_bf16 v[64:67], v[172:175], v[40:43], v[64:67]
ds_read_b128 v[36:39], v11 offset:29696
v_mfma_f32_16x16x32_bf16 v[68:71], v[236:239], v[40:43], v[68:71]
buffer_store_dwordx4 v[96:99], v6, s[4:7], s49 offen sc1
v_mfma_f32_16x16x32_bf16 v[72:75], v[172:175], v[44:47], v[72:75]
s_cmp_ge_u32 s36, 3
ds_read_b128 v[40:43], v11 offset:30720
s_cselect_b32 s58, s62, 0x70000000
v_mfma_f32_16x16x32_bf16 v[76:79], v[236:239], v[44:47], v[76:79]
s_waitcnt lgkmcnt(5)
s_add_u32 s49, s49, 229376
s_add_u32 s62, s62, 65536
v_mfma_f32_16x16x32_bf16 v[64:67], v[176:179], v[16:19], v[64:67]
s_add_u32 s59, s59, 229376
ds_read_b128 v[44:47], v11 offset:31744
s_add_u32 s36, s36, 1
v_mfma_f32_16x16x32_bf16 v[68:71], v[240:243], v[16:19], v[68:71]
v_mfma_f32_16x16x32_bf16 v[72:75], v[176:179], v[20:23], v[72:75]
v_mfma_f32_16x16x32_bf16 v[76:79], v[240:243], v[20:23], v[76:79]
s_waitcnt lgkmcnt(4)
v_mfma_f32_16x16x32_bf16 v[64:67], v[180:183], v[24:27], v[64:67]
v_mfma_f32_16x16x32_bf16 v[68:71], v[244:247], v[24:27], v[68:71]
s_cmp_eq_u32 s46, 0
s_cbranch_scc1 Lfs_628
s_waitcnt vmcnt(3) lgkmcnt(0)
s_barrier
v_mfma_f32_16x16x32_bf16 v[72:75], v[180:183], v[28:31], v[72:75]
ds_read_b128 v[16:19], v1 offset:0
ds_read_b128 v[20:23], v1 offset:2048
v_mfma_f32_16x16x32_bf16 v[76:79], v[244:247], v[28:31], v[76:79]
ds_read_b128 v[24:27], v1 offset:4096
v_mfma_f32_16x16x32_bf16 v[64:67], v[184:187], v[32:35], v[64:67]
ds_read_b128 v[28:31], v1 offset:6144
v_mfma_f32_16x16x32_bf16 v[68:71], v[248:251], v[32:35], v[68:71]
v_mfma_f32_16x16x32_bf16 v[72:75], v[184:187], v[36:39], v[72:75]
ds_read_b128 v[32:35], v1 offset:8192
v_mfma_f32_16x16x32_bf16 v[76:79], v[248:251], v[36:39], v[76:79]
v_mfma_f32_16x16x32_bf16 v[64:67], v[188:191], v[40:43], v[64:67]
ds_read_b128 v[36:39], v1 offset:10240
v_mfma_f32_16x16x32_bf16 v[68:71], v[252:255], v[40:43], v[68:71]
v_mfma_f32_16x16x32_bf16 v[72:75], v[188:191], v[44:47], v[72:75]
ds_read_b128 v[40:43], v1 offset:12288
v_mfma_f32_16x16x32_bf16 v[76:79], v[252:255], v[44:47], v[76:79]
s_branch Lfb_624
Lfs_628:
s_waitcnt lgkmcnt(0)
v_mfma_f32_16x16x32_bf16 v[72:75], v[180:183], v[28:31], v[72:75]
v_mfma_f32_16x16x32_bf16 v[76:79], v[244:247], v[28:31], v[76:79]
s_waitcnt lgkmcnt(2)
v_mfma_f32_16x16x32_bf16 v[64:67], v[184:187], v[32:35], v[64:67]
v_mfma_f32_16x16x32_bf16 v[68:71], v[248:251], v[32:35], v[68:71]
v_mfma_f32_16x16x32_bf16 v[72:75], v[184:187], v[36:39], v[72:75]
v_mfma_f32_16x16x32_bf16 v[76:79], v[248:251], v[36:39], v[76:79]
s_waitcnt lgkmcnt(0)
v_mfma_f32_16x16x32_bf16 v[64:67], v[188:191], v[40:43], v[64:67]
v_mfma_f32_16x16x32_bf16 v[68:71], v[252:255], v[40:43], v[68:71]
v_mfma_f32_16x16x32_bf16 v[72:75], v[188:191], v[44:47], v[72:75]
v_mfma_f32_16x16x32_bf16 v[76:79], v[252:255], v[44:47], v[76:79]
s_nop 7
v_cvt_pk_bf16_f32 v80, v64, v65
v_cvt_pk_bf16_f32 v81, v66, v67
v_cvt_pk_bf16_f32 v82, v68, v69
v_cvt_pk_bf16_f32 v83, v70, v71
v_cvt_pk_bf16_f32 v84, v72, v73
v_cvt_pk_bf16_f32 v85, v74, v75
v_cvt_pk_bf16_f32 v86, v76, v77
v_cvt_pk_bf16_f32 v87, v78, v79
s_cmp_eq_u32 s36, 64
s_cbranch_scc1 Lfz_629
buffer_store_dwordx4 v[80:83], v7, s[4:7], s58 offen offset:0 sc1
buffer_store_dwordx4 v[84:87], v7, s[4:7], s58 offen offset:1024 sc1
s_branch Lfw_625
Lfl_626:
Lbw_632:
buffer_load_dword v13, v12, s[4:7], s61 offen sc1
s_waitcnt vmcnt(0)
v_cmp_gt_u32 vcc, s57, v13
s_cbranch_vccz Lbo_633
s_sub_u32 s37, s37, 1
s_cbranch_scc1 Lend_7
s_sleep 2
s_branch Lbw_632
Lbo_633:
s_add_u32 m0, s60, 131072
s_add_u32 s39, s59, 0
buffer_load_dwordx4 v0, s[4:7], s39 offen offset:0 sc1 lds
buffer_load_dwordx4 v0, s[4:7], s39 offen offset:1024 sc1 lds
buffer_load_dwordx4 v0, s[4:7], s39 offen offset:2048 sc1 lds
buffer_load_dwordx4 v0, s[4:7], s39 offen offset:3072 sc1 lds
s_add_u32 m0, s60, 147456
s_add_u32 s39, s59, 16384
buffer_load_dwordx4 v0, s[4:7], s39 offen offset:0 sc1 lds
buffer_load_dwordx4 v0, s[4:7], s39 offen offset:1024 sc1 lds
buffer_load_dwordx4 v0, s[4:7], s39 offen offset:2048 sc1 lds
buffer_load_dwordx4 v0, s[4:7], s39 offen offset:3072 sc1 lds
s_add_u32 m0, s50, 49152
s_add_u32 s39, s45, 49152
s_waitcnt vmcnt(0) lgkmcnt(0)
s_branch Lfg_627
Lfz_629:
s_mov_b32 s57, 63
s_waitcnt vmcnt(0)
v_cmp_gt_u32 vcc, s57, v13
s_barrier
v_min_u32 v100, s36, 64
s_sub_u32 s38, s36, 4
v_max_i32 v101, s38, 0
buffer_store_dwordx2 v[100:101], v4, s[4:7], 0 offen sc1
s_cbranch_vccz Lfh_634
Lbw_637:
buffer_load_dword v13, v12, s[4:7], s61 offen sc1
s_waitcnt vmcnt(0)
v_cmp_gt_u32 vcc, s57, v13
s_cbranch_vccz Lbo_638
s_sub_u32 s37, s37, 1
s_cbranch_scc1 Lend_7
s_sleep 1
s_branch Lbw_637
Lbo_638:
Lfh_634:
s_add_u32 s55, s59, 0
s_add_u32 m0, s60, 65536
s_add_u32 s39, s55, 0
buffer_load_dwordx4 v0, s[4:7], s39 offen offset:0 sc1 lds
buffer_load_dwordx4 v0, s[4:7], s39 offen offset:1024 sc1 lds
buffer_load_dwordx4 v0, s[4:7], s39 offen offset:2048 sc1 lds
buffer_load_dwordx4 v0, s[4:7], s39 offen offset:3072 sc1 lds
s_add_u32 m0, s60, 81920
s_add_u32 s39, s55, 16384
buffer_load_dwordx4 v0, s[4:7], s39 offen offset:0 sc1 lds
buffer_load_dwordx4 v0, s[4:7], s39 offen offset:1024 sc1 lds
buffer_load_dwordx4 v0, s[4:7], s39 offen offset:2048 sc1 lds
buffer_load_dwordx4 v0, s[4:7], s39 offen offset:3072 sc1 lds
s_add_u32 s55, s59, 229376
s_add_u32 m0, s60, 98304
s_add_u32 s39, s55, 0
buffer_load_dwordx4 v0, s[4:7], s39 offen offset:0 sc1 lds
buffer_load_dwordx4 v0, s[4:7], s39 offen offset:1024 sc1 lds
buffer_load_dwordx4 v0, s[4:7], s39 offen offset:2048 sc1 lds
buffer_load_dwordx4 v0, s[4:7], s39 offen offset:3072 sc1 lds
s_add_u32 m0, s60, 114688
s_add_u32 s39, s55, 16384
buffer_load_dwordx4 v0, s[4:7], s39 offen offset:0 sc1 lds
buffer_load_dwordx4 v0, s[4:7], s39 offen offset:1024 sc1 lds
buffer_load_dwordx4 v0, s[4:7], s39 offen offset:2048 sc1 lds
buffer_load_dwordx4 v0, s[4:7], s39 offen offset:3072 sc1 lds
buffer_store_dwordx4 v[80:83], v7, s[4:7], s58 offen offset:0 sc1
buffer_store_dwordx4 v[84:87], v7, s[4:7], s58 offen offset:1024 sc1
s_add_u32 s55, s59, 458752
s_mov_b32 s57, 64
v_add_u32 v11, -0x10000, v11
s_waitcnt vmcnt(10)
s_barrier
ds_read_b128 v[16:19], v11 offset:0
ds_read_b128 v[20:23], v11 offset:1024
ds_read_b128 v[24:27], v11 offset:2048
ds_read_b128 v[28:31], v11 offset:3072
ds_read_b128 v[32:35], v11 offset:4096
ds_read_b128 v[36:39], v11 offset:5120
ds_read_b128 v[40:43], v11 offset:6144
s_waitcnt lgkmcnt(5)
v_mfma_f32_16x16x32_bf16 v[64:67], v[128:131], v[16:19], 0
ds_read_b128 v[44:47], v11 offset:7168
v_mfma_f32_16x16x32_bf16 v[68:71], v[192:195], v[16:19], 0
v_mfma_f32_16x16x32_bf16 v[72:75], v[128:131], v[20:23], 0
ds_read_b128 v[16:19], v11 offset:8192
v_mfma_f32_16x16x32_bf16 v[76:79], v[192:195], v[20:23], 0
s_waitcnt lgkmcnt(5)
v_mfma_f32_16x16x32_bf16 v[64:67], v[132:135], v[24:27], v[64:67]
ds_read_b128 v[20:23], v11 offset:9216
v_mfma_f32_16x16x32_bf16 v[68:71], v[196:199], v[24:27], v[68:71]
v_mfma_f32_16x16x32_bf16 v[72:75], v[132:135], v[28:31], v[72:75]
ds_read_b128 v[24:27], v11 offset:10240
v_mfma_f32_16x16x32_bf16 v[76:79], v[196:199], v[28:31], v[76:79]
s_waitcnt lgkmcnt(5)
v_mfma_f32_16x16x32_bf16 v[64:67], v[136:139], v[32:35], v[64:67]
ds_read_b128 v[28:31], v11 offset:11264
v_mfma_f32_16x16x32_bf16 v[68:71], v[200:203], v[32:35], v[68:71]
v_mfma_f32_16x16x32_bf16 v[72:75], v[136:139], v[36:39], v[72:75]
ds_read_b128 v[32:35], v11 offset:12288
v_mfma_f32_16x16x32_bf16 v[76:79], v[200:203], v[36:39], v[76:79]
s_waitcnt lgkmcnt(5)
v_mfma_f32_16x16x32_bf16 v[64:67], v[140:143], v[40:43], v[64:67]
ds_read_b128 v[36:39], v11 offset:13312
v_mfma_f32_16x16x32_bf16 v[68:71], v[204:207], v[40:43], v[68:71]
v_mfma_f32_16x16x32_bf16 v[72:75], v[140:143], v[44:47], v[72:75]
ds_read_b128 v[40:43], v11 offset:14336
v_mfma_f32_16x16x32_bf16 v[76:79], v[204:207], v[44:47], v[76:79]
s_waitcnt lgkmcnt(5)
v_mfma_f32_16x16x32_bf16 v[64:67], v[144:147], v[16:19], v[64:67]
ds_read_b128 v[44:47], v11 offset:15360
v_mfma_f32_16x16x32_bf16 v[68:71], v[208:211], v[16:19], v[68:71]
v_mfma_f32_16x16x32_bf16 v[72:75], v[144:147], v[20:23], v[72:75]
ds_read_b128 v[16:19], v11 offset:16384
v_mfma_f32_16x16x32_bf16 v[76:79], v[208:211], v[20:23], v[76:79]
s_waitcnt lgkmcnt(5)
v_mfma_f32_16x16x32_bf16 v[64:67], v[148:151], v[24:27], v[64:67]
ds_read_b128 v[20:23], v11 offset:17408
v_mfma_f32_16x16x32_bf16 v[68:71], v[212:215], v[24:27], v[68:71]
v_mfma_f32_16x16x32_bf16 v[72:75], v[148:151], v[28:31], v[72:75]
ds_read_b128 v[24:27], v11 offset:18432
v_mfma_f32_16x16x32_bf16 v[76:79], v[212:215], v[28:31], v[76:79]
s_waitcnt lgkmcnt(5)
v_mfma_f32_16x16x32_bf16 v[64:67], v[152:155], v[32:35], v[64:67]
ds_read_b128 v[28:31], v11 offset:19456
buffer_load_dword v13, v12, s[4:7], s61 offen sc1
v_mfma_f32_16x16x32_bf16 v[68:71], v[216:219], v[32:35], v[68:71]
v_mfma_f32_16x16x32_bf16 v[72:75], v[152:155], v[36:39], v[72:75]
ds_read_b128 v[32:35], v11 offset:20480
v_mfma_f32_16x16x32_bf16 v[76:79], v[216:219], v[36:39], v[76:79]
s_waitcnt lgkmcnt(5)
v_mfma_f32_16x16x32_bf16 v[64:67], v[156:159], v[40:43], v[64:67]
ds_read_b128 v[36:39], v11 offset:21504
v_mfma_f32_16x16x32_bf16 v[68:71], v[220:223], v[40:43], v[68:71]
v_mfma_f32_16x16x32_bf16 v[72:75], v[156:159], v[44:47], v[72:75]
ds_read_b128 v[40:43], v11 offset:22528
v_mfma_f32_16x16x32_bf16 v[76:79], v[220:223], v[44:47], v[76:79]
s_waitcnt lgkmcnt(5)
v_mfma_f32_16x16x32_bf16 v[64:67], v[160:163], v[16:19], v[64:67]
ds_read_b128 v[44:47], v11 offset:23552
v_mfma_f32_16x16x32_bf16 v[68:71], v[224:227], v[16:19], v[68:71]
v_mfma_f32_16x16x32_bf16 v[72:75], v[160:163], v[20:23], v[72:75]
ds_read_b128 v[16:19], v11 offset:24576
v_mfma_f32_16x16x32_bf16 v[76:79], v[224:227], v[20:23], v[76:79]
s_waitcnt lgkmcnt(5)
v_mfma_f32_16x16x32_bf16 v[64:67], v[164:167], v[24:27], v[64:67]
ds_read_b128 v[20:23], v11 offset:25600
v_mfma_f32_16x16x32_bf16 v[68:71], v[228:231], v[24:27], v[68:71]
v_mfma_f32_16x16x32_bf16 v[72:75], v[164:167], v[28:31], v[72:75]
ds_read_b128 v[24:27], v11 offset:26624
v_mfma_f32_16x16x32_bf16 v[76:79], v[228:231], v[28:31], v[76:79]
s_waitcnt lgkmcnt(5)
v_mfma_f32_16x16x32_bf16 v[64:67], v[168:171], v[32:35], v[64:67]
ds_read_b128 v[28:31], v11 offset:27648
v_mfma_f32_16x16x32_bf16 v[68:71], v[232:235], v[32:35], v[68:71]
v_mfma_f32_16x16x32_bf16 v[72:75], v[168:171], v[36:39], v[72:75]
ds_read_b128 v[32:35], v11 offset:28672
v_mfma_f32_16x16x32_bf16 v[76:79], v[232:235], v[36:39], v[76:79]
s_waitcnt lgkmcnt(5)
v_mfma_f32_16x16x32_bf16 v[64:67], v[172:175], v[40:43], v[64:67]
ds_read_b128 v[36:39], v11 offset:29696
v_mfma_f32_16x16x32_bf16 v[68:71], v[236:239], v[40:43], v[68:71]
v_mfma_f32_16x16x32_bf16 v[72:75], v[172:175], v[44:47], v[72:75]
ds_read_b128 v[40:43], v11 offset:30720
v_mfma_f32_16x16x32_bf16 v[76:79], v[236:239], v[44:47], v[76:79]
s_waitcnt lgkmcnt(5)
v_mfma_f32_16x16x32_bf16 v[64:67], v[176:179], v[16:19], v[64:67]
ds_read_b128 v[44:47], v11 offset:31744
v_mfma_f32_16x16x32_bf16 v[68:71], v[240:243], v[16:19], v[68:71]
v_mfma_f32_16x16x32_bf16 v[72:75], v[176:179], v[20:23], v[72:75]
v_mfma_f32_16x16x32_bf16 v[76:79], v[240:243], v[20:23], v[76:79]
s_waitcnt lgkmcnt(4)
v_mfma_f32_16x16x32_bf16 v[64:67], v[180:183], v[24:27], v[64:67]
v_mfma_f32_16x16x32_bf16 v[68:71], v[244:247], v[24:27], v[68:71]
v_mfma_f32_16x16x32_bf16 v[72:75], v[180:183], v[28:31], v[72:75]
v_mfma_f32_16x16x32_bf16 v[76:79], v[244:247], v[28:31], v[76:79]
s_waitcnt lgkmcnt(2)
v_mfma_f32_16x16x32_bf16 v[64:67], v[184:187], v[32:35], v[64:67]
v_mfma_f32_16x16x32_bf16 v[68:71], v[248:251], v[32:35], v[68:71]
v_mfma_f32_16x16x32_bf16 v[72:75], v[184:187], v[36:39], v[72:75]
v_mfma_f32_16x16x32_bf16 v[76:79], v[248:251], v[36:39], v[76:79]
s_waitcnt lgkmcnt(0)
v_mfma_f32_16x16x32_bf16 v[64:67], v[188:191], v[40:43], v[64:67]
v_mfma_f32_16x16x32_bf16 v[68:71], v[252:255], v[40:43], v[68:71]
v_mfma_f32_16x16x32_bf16 v[72:75], v[188:191], v[44:47], v[72:75]
v_mfma_f32_16x16x32_bf16 v[76:79], v[252:255], v[44:47], v[76:79]
s_cmp_ge_u32 s36, 3
s_cselect_b32 s58, s62, 0x70000000
s_add_u32 s49, s49, 229376
s_add_u32 s62, s62, 65536
s_add_u32 s59, s59, 229376
s_add_u32 s36, s36, 1
v_add_u32 v11, 0x8000, v11
s_nop 0
v_cvt_pk_bf16_f32 v80, v64, v65
v_cvt_pk_bf16_f32 v81, v66, v67
v_cvt_pk_bf16_f32 v82, v68, v69
v_cvt_pk_bf16_f32 v83, v70, v71
v_cvt_pk_bf16_f32 v84, v72, v73
v_cvt_pk_bf16_f32 v85, v74, v75
v_cvt_pk_bf16_f32 v86, v76, v77
v_cvt_pk_bf16_f32 v87, v78, v79
s_waitcnt vmcnt(0)
v_cmp_gt_u32 vcc, s57, v13
s_mov_b32 s56, 0
s_cbranch_vccnz Lfn_635
s_mov_b32 s56, 1
s_add_u32 m0, s60, 131072
s_add_u32 s39, s55, 0
buffer_load_dwordx4 v0, s[4:7], s39 offen offset:0 sc1 lds
buffer_load_dwordx4 v0, s[4:7], s39 offen offset:1024 sc1 lds
buffer_load_dwordx4 v0, s[4:7], s39 offen offset:2048 sc1 lds
buffer_load_dwordx4 v0, s[4:7], s39 offen offset:3072 sc1 lds
s_add_u32 m0, s60, 147456
s_add_u32 s39, s55, 16384
buffer_load_dwordx4 v0, s[4:7], s39 offen offset:0 sc1 lds
buffer_load_dwordx4 v0, s[4:7], s39 offen offset:1024 sc1 lds
buffer_load_dwordx4 v0, s[4:7], s39 offen offset:2048 sc1 lds
buffer_load_dwordx4 v0, s[4:7], s39 offen offset:3072 sc1 lds
Lfn_635:
buffer_store_dwordx4 v[80:83], v7, s[4:7], s58 offen offset:0 sc1
buffer_store_dwordx4 v[84:87], v7, s[4:7], s58 offen offset:1024 sc1
s_barrier
ds_read_b128 v[16:19], v11 offset:0
ds_read_b128 v[20:23], v11 offset:1024
ds_read_b128 v[24:27], v11 offset:2048
ds_read_b128 v[28:31], v11 offset:3072
ds_read_b128 v[32:35], v11 offset:4096
ds_read_b128 v[36:39], v11 offset:5120
ds_read_b128 v[40:43], v11 offset:6144
s_waitcnt lgkmcnt(5)
v_mfma_f32_16x16x32_bf16 v[64:67], v[128:131], v[16:19], 0
ds_read_b128 v[44:47], v11 offset:7168
v_mfma_f32_16x16x32_bf16 v[68:71], v[192:195], v[16:19], 0
v_mfma_f32_16x16x32_bf16 v[72:75], v[128:131], v[20:23], 0
ds_read_b128 v[16:19], v11 offset:8192
v_mfma_f32_16x16x32_bf16 v[76:79], v[192:195], v[20:23], 0
s_waitcnt lgkmcnt(5)
v_mfma_f32_16x16x32_bf16 v[64:67], v[132:135], v[24:27], v[64:67]
ds_read_b128 v[20:23], v11 offset:9216
v_mfma_f32_16x16x32_bf16 v[68:71], v[196:199], v[24:27], v[68:71]
v_mfma_f32_16x16x32_bf16 v[72:75], v[132:135], v[28:31], v[72:75]
ds_read_b128 v[24:27], v11 offset:10240
v_mfma_f32_16x16x32_bf16 v[76:79], v[196:199], v[28:31], v[76:79]
s_waitcnt lgkmcnt(5)
v_mfma_f32_16x16x32_bf16 v[64:67], v[136:139], v[32:35], v[64:67]
ds_read_b128 v[28:31], v11 offset:11264
v_mfma_f32_16x16x32_bf16 v[68:71], v[200:203], v[32:35], v[68:71]
v_mfma_f32_16x16x32_bf16 v[72:75], v[136:139], v[36:39], v[72:75]
ds_read_b128 v[32:35], v11 offset:12288
v_mfma_f32_16x16x32_bf16 v[76:79], v[200:203], v[36:39], v[76:79]
s_waitcnt lgkmcnt(5)
v_mfma_f32_16x16x32_bf16 v[64:67], v[140:143], v[40:43], v[64:67]
ds_read_b128 v[36:39], v11 offset:13312
v_mfma_f32_16x16x32_bf16 v[68:71], v[204:207], v[40:43], v[68:71]
v_mfma_f32_16x16x32_bf16 v[72:75], v[140:143], v[44:47], v[72:75]
ds_read_b128 v[40:43], v11 offset:14336
v_mfma_f32_16x16x32_bf16 v[76:79], v[204:207], v[44:47], v[76:79]
s_waitcnt lgkmcnt(5)
v_mfma_f32_16x16x32_bf16 v[64:67], v[144:147], v[16:19], v[64:67]
ds_read_b128 v[44:47], v11 offset:15360
v_mfma_f32_16x16x32_bf16 v[68:71], v[208:211], v[16:19], v[68:71]
v_mfma_f32_16x16x32_bf16 v[72:75], v[144:147], v[20:23], v[72:75]
ds_read_b128 v[16:19], v11 offset:16384
v_mfma_f32_16x16x32_bf16 v[76:79], v[208:211], v[20:23], v[76:79]
s_waitcnt lgkmcnt(5)
v_mfma_f32_16x16x32_bf16 v[64:67], v[148:151], v[24:27], v[64:67]
ds_read_b128 v[20:23], v11 offset:17408
v_mfma_f32_16x16x32_bf16 v[68:71], v[212:215], v[24:27], v[68:71]
v_mfma_f32_16x16x32_bf16 v[72:75], v[148:151], v[28:31], v[72:75]
ds_read_b128 v[24:27], v11 offset:18432
v_mfma_f32_16x16x32_bf16 v[76:79], v[212:215], v[28:31], v[76:79]
s_waitcnt lgkmcnt(5)
v_mfma_f32_16x16x32_bf16 v[64:67], v[152:155], v[32:35], v[64:67]
ds_read_b128 v[28:31], v11 offset:19456
v_mfma_f32_16x16x32_bf16 v[68:71], v[216:219], v[32:35], v[68:71]
v_mfma_f32_16x16x32_bf16 v[72:75], v[152:155], v[36:39], v[72:75]
ds_read_b128 v[32:35], v11 offset:20480
v_mfma_f32_16x16x32_bf16 v[76:79], v[216:219], v[36:39], v[76:79]
s_waitcnt lgkmcnt(5)
v_mfma_f32_16x16x32_bf16 v[64:67], v[156:159], v[40:43], v[64:67]
ds_read_b128 v[36:39], v11 offset:21504
v_mfma_f32_16x16x32_bf16 v[68:71], v[220:223], v[40:43], v[68:71]
v_mfma_f32_16x16x32_bf16 v[72:75], v[156:159], v[44:47], v[72:75]
ds_read_b128 v[40:43], v11 offset:22528
v_mfma_f32_16x16x32_bf16 v[76:79], v[220:223], v[44:47], v[76:79]
s_waitcnt lgkmcnt(5)
v_mfma_f32_16x16x32_bf16 v[64:67], v[160:163], v[16:19], v[64:67]
ds_read_b128 v[44:47], v11 offset:23552
v_mfma_f32_16x16x32_bf16 v[68:71], v[224:227], v[16:19], v[68:71]
v_mfma_f32_16x16x32_bf16 v[72:75], v[160:163], v[20:23], v[72:75]
ds_read_b128 v[16:19], v11 offset:24576
v_mfma_f32_16x16x32_bf16 v[76:79], v[224:227], v[20:23], v[76:79]
s_waitcnt lgkmcnt(5)
v_mfma_f32_16x16x32_bf16 v[64:67], v[164:167], v[24:27], v[64:67]
ds_read_b128 v[20:23], v11 offset:25600
v_mfma_f32_16x16x32_bf16 v[68:71], v[228:231], v[24:27], v[68:71]
v_mfma_f32_16x16x32_bf16 v[72:75], v[164:167], v[28:31], v[72:75]
ds_read_b128 v[24:27], v11 offset:26624
v_mfma_f32_16x16x32_bf16 v[76:79], v[228:231], v[28:31], v[76:79]
s_waitcnt lgkmcnt(5)
v_mfma_f32_16x16x32_bf16 v[64:67], v[168:171], v[32:35], v[64:67]
ds_read_b128 v[28:31], v11 offset:27648
v_mfma_f32_16x16x32_bf16 v[68:71], v[232:235], v[32:35], v[68:71]
v_mfma_f32_16x16x32_bf16 v[72:75], v[168:171], v[36:39], v[72:75]
ds_read_b128 v[32:35], v11 offset:28672
v_mfma_f32_16x16x32_bf16 v[76:79], v[232:235], v[36:39], v[76:79]
s_waitcnt lgkmcnt(5)
v_mfma_f32_16x16x32_bf16 v[64:67], v[172:175], v[40:43], v[64:67]
ds_read_b128 v[36:39], v11 offset:29696
v_mfma_f32_16x16x32_bf16 v[68:71], v[236:239], v[40:43], v[68:71]
v_mfma_f32_16x16x32_bf16 v[72:75], v[172:175], v[44:47], v[72:75]
ds_read_b128 v[40:43], v11 offset:30720
v_mfma_f32_16x16x32_bf16 v[76:79], v[236:239], v[44:47], v[76:79]
s_waitcnt lgkmcnt(5)
v_mfma_f32_16x16x32_bf16 v[64:67], v[176:179], v[16:19], v[64:67]
ds_read_b128 v[44:47], v11 offset:31744
v_mfma_f32_16x16x32_bf16 v[68:71], v[240:243], v[16:19], v[68:71]
v_mfma_f32_16x16x32_bf16 v[72:75], v[176:179], v[20:23], v[72:75]
v_mfma_f32_16x16x32_bf16 v[76:79], v[240:243], v[20:23], v[76:79]
s_waitcnt lgkmcnt(4)
v_mfma_f32_16x16x32_bf16 v[64:67], v[180:183], v[24:27], v[64:67]
v_mfma_f32_16x16x32_bf16 v[68:71], v[244:247], v[24:27], v[68:71]
v_mfma_f32_16x16x32_bf16 v[72:75], v[180:183], v[28:31], v[72:75]
v_mfma_f32_16x16x32_bf16 v[76:79], v[244:247], v[28:31], v[76:79]
s_waitcnt lgkmcnt(2)
v_mfma_f32_16x16x32_bf16 v[64:67], v[184:187], v[32:35], v[64:67]
v_mfma_f32_16x16x32_bf16 v[68:71], v[248:251], v[32:35], v[68:71]
v_mfma_f32_16x16x32_bf16 v[72:75], v[184:187], v[36:39], v[72:75]
v_mfma_f32_16x16x32_bf16 v[76:79], v[248:251], v[36:39], v[76:79]
s_waitcnt lgkmcnt(0)
v_mfma_f32_16x16x32_bf16 v[64:67], v[188:191], v[40:43], v[64:67]
v_mfma_f32_16x16x32_bf16 v[68:71], v[252:255], v[40:43], v[68:71]
v_mfma_f32_16x16x32_bf16 v[72:75], v[188:191], v[44:47], v[72:75]
v_mfma_f32_16x16x32_bf16 v[76:79], v[252:255], v[44:47], v[76:79]
s_cmp_ge_u32 s36, 3
s_cselect_b32 s58, s62, 0x70000000
s_add_u32 s49, s49, 229376
s_add_u32 s62, s62, 65536
s_add_u32 s59, s59, 229376
s_add_u32 s36, s36, 1
v_add_u32 v11, 0x8000, v11
s_nop 0
v_cvt_pk_bf16_f32 v80, v64, v65
v_cvt_pk_bf16_f32 v81, v66, v67
v_cvt_pk_bf16_f32 v82, v68, v69
v_cvt_pk_bf16_f32 v83, v70, v71
v_cvt_pk_bf16_f32 v84, v72, v73
v_cvt_pk_bf16_f32 v85, v74, v75
v_cvt_pk_bf16_f32 v86, v76, v77
v_cvt_pk_bf16_f32 v87, v78, v79
s_cmp_lg_u32 s56, 0
s_cbranch_scc1 Lfy_636
Lbw_639:
buffer_load_dword v13, v12, s[4:7], s61 offen sc1
s_waitcnt vmcnt(0)
v_cmp_gt_u32 vcc, s57, v13
s_cbranch_vccz Lbo_640
s_sub_u32 s37, s37, 1
s_cbranch_scc1 Lend_7
s_sleep 1
s_branch Lbw_639
Lbo_640:
s_add_u32 m0, s60, 131072
s_add_u32 s39, s55, 0
buffer_load_dwordx4 v0, s[4:7], s39 offen offset:0 sc1 lds
buffer_load_dwordx4 v0, s[4:7], s39 offen offset:1024 sc1 lds
buffer_load_dwordx4 v0, s[4:7], s39 offen offset:2048 sc1 lds
buffer_load_dwordx4 v0, s[4:7], s39 offen offset:3072 sc1 lds
s_add_u32 m0, s60, 147456
s_add_u32 s39, s55, 16384
buffer_load_dwordx4 v0, s[4:7], s39 offen offset:0 sc1 lds
buffer_load_dwordx4 v0, s[4:7], s39 offen offset:1024 sc1 lds
buffer_load_dwordx4 v0, s[4:7], s39 offen offset:2048 sc1 lds
buffer_load_dwordx4 v0, s[4:7], s39 offen offset:3072 sc1 lds
Lfy_636:
buffer_store_dwordx4 v[80:83], v7, s[4:7], s58 offen offset:0 sc1
buffer_store_dwordx4 v[84:87], v7, s[4:7], s58 offen offset:1024 sc1
s_waitcnt vmcnt(2)
s_barrier
ds_read_b128 v[16:19], v11 offset:0
ds_read_b128 v[20:23], v11 offset:1024
ds_read_b128 v[24:27], v11 offset:2048
ds_read_b128 v[28:31], v11 offset:3072
ds_read_b128 v[32:35], v11 offset:4096
ds_read_b128 v[36:39], v11 offset:5120
ds_read_b128 v[40:43], v11 offset:6144
s_waitcnt lgkmcnt(5)
v_mfma_f32_16x16x32_bf16 v[64:67], v[128:131], v[16:19], 0
ds_read_b128 v[44:47], v11 offset:7168
v_mfma_f32_16x16x32_bf16 v[68:71], v[192:195], v[16:19], 0
v_mfma_f32_16x16x32_bf16 v[72:75], v[128:131], v[20:23], 0
ds_read_b128 v[16:19], v11 offset:8192
v_mfma_f32_16x16x32_bf16 v[76:79], v[192:195], v[20:23], 0
s_waitcnt lgkmcnt(5)
v_mfma_f32_16x16x32_bf16 v[64:67], v[132:135], v[24:27], v[64:67]
ds_read_b128 v[20:23], v11 offset:9216
v_mfma_f32_16x16x32_bf16 v[68:71], v[196:199], v[24:27], v[68:71]
v_mfma_f32_16x16x32_bf16 v[72:75], v[132:135], v[28:31], v[72:75]
ds_read_b128 v[24:27], v11 offset:10240
v_mfma_f32_16x16x32_bf16 v[76:79], v[196:199], v[28:31], v[76:79]
s_waitcnt lgkmcnt(5)
v_mfma_f32_16x16x32_bf16 v[64:67], v[136:139], v[32:35], v[64:67]
ds_read_b128 v[28:31], v11 offset:11264
v_mfma_f32_16x16x32_bf16 v[68:71], v[200:203], v[32:35], v[68:71]
v_mfma_f32_16x16x32_bf16 v[72:75], v[136:139], v[36:39], v[72:75]
ds_read_b128 v[32:35], v11 offset:12288
v_mfma_f32_16x16x32_bf16 v[76:79], v[200:203], v[36:39], v[76:79]
s_waitcnt lgkmcnt(5)
v_mfma_f32_16x16x32_bf16 v[64:67], v[140:143], v[40:43], v[64:67]
ds_read_b128 v[36:39], v11 offset:13312
v_mfma_f32_16x16x32_bf16 v[68:71], v[204:207], v[40:43], v[68:71]
v_mfma_f32_16x16x32_bf16 v[72:75], v[140:143], v[44:47], v[72:75]
ds_read_b128 v[40:43], v11 offset:14336
v_mfma_f32_16x16x32_bf16 v[76:79], v[204:207], v[44:47], v[76:79]
s_waitcnt lgkmcnt(5)
v_mfma_f32_16x16x32_bf16 v[64:67], v[144:147], v[16:19], v[64:67]
ds_read_b128 v[44:47], v11 offset:15360
v_mfma_f32_16x16x32_bf16 v[68:71], v[208:211], v[16:19], v[68:71]
v_mfma_f32_16x16x32_bf16 v[72:75], v[144:147], v[20:23], v[72:75]
ds_read_b128 v[16:19], v11 offset:16384
v_mfma_f32_16x16x32_bf16 v[76:79], v[208:211], v[20:23], v[76:79]
s_waitcnt lgkmcnt(5)
v_mfma_f32_16x16x32_bf16 v[64:67], v[148:151], v[24:27], v[64:67]
ds_read_b128 v[20:23], v11 offset:17408
v_mfma_f32_16x16x32_bf16 v[68:71], v[212:215], v[24:27], v[68:71]
v_mfma_f32_16x16x32_bf16 v[72:75], v[148:151], v[28:31], v[72:75]
ds_read_b128 v[24:27], v11 offset:18432
v_mfma_f32_16x16x32_bf16 v[76:79], v[212:215], v[28:31], v[76:79]
s_waitcnt lgkmcnt(5)
v_mfma_f32_16x16x32_bf16 v[64:67], v[152:155], v[32:35], v[64:67]
ds_read_b128 v[28:31], v11 offset:19456
v_mfma_f32_16x16x32_bf16 v[68:71], v[216:219], v[32:35], v[68:71]
v_mfma_f32_16x16x32_bf16 v[72:75], v[152:155], v[36:39], v[72:75]
ds_read_b128 v[32:35], v11 offset:20480
v_mfma_f32_16x16x32_bf16 v[76:79], v[216:219], v[36:39], v[76:79]
s_waitcnt lgkmcnt(5)
v_mfma_f32_16x16x32_bf16 v[64:67], v[156:159], v[40:43], v[64:67]
ds_read_b128 v[36:39], v11 offset:21504
v_mfma_f32_16x16x32_bf16 v[68:71], v[220:223], v[40:43], v[68:71]
v_mfma_f32_16x16x32_bf16 v[72:75], v[156:159], v[44:47], v[72:75]
ds_read_b128 v[40:43], v11 offset:22528
v_mfma_f32_16x16x32_bf16 v[76:79], v[220:223], v[44:47], v[76:79]
s_waitcnt lgkmcnt(5)
v_mfma_f32_16x16x32_bf16 v[64:67], v[160:163], v[16:19], v[64:67]
ds_read_b128 v[44:47], v11 offset:23552
v_mfma_f32_16x16x32_bf16 v[68:71], v[224:227], v[16:19], v[68:71]
v_mfma_f32_16x16x32_bf16 v[72:75], v[160:163], v[20:23], v[72:75]
ds_read_b128 v[16:19], v11 offset:24576
v_mfma_f32_16x16x32_bf16 v[76:79], v[224:227], v[20:23], v[76:79]
s_waitcnt lgkmcnt(5)
v_mfma_f32_16x16x32_bf16 v[64:67], v[164:167], v[24:27], v[64:67]
ds_read_b128 v[20:23], v11 offset:25600
v_mfma_f32_16x16x32_bf16 v[68:71], v[228:231], v[24:27], v[68:71]
v_mfma_f32_16x16x32_bf16 v[72:75], v[164:167], v[28:31], v[72:75]
ds_read_b128 v[24:27], v11 offset:26624
v_mfma_f32_16x16x32_bf16 v[76:79], v[228:231], v[28:31], v[76:79]
s_waitcnt lgkmcnt(5)
v_mfma_f32_16x16x32_bf16 v[64:67], v[168:171], v[32:35], v[64:67]
ds_read_b128 v[28:31], v11 offset:27648
v_mfma_f32_16x16x32_bf16 v[68:71], v[232:235], v[32:35], v[68:71]
v_mfma_f32_16x16x32_bf16 v[72:75], v[168:171], v[36:39], v[72:75]
ds_read_b128 v[32:35], v11 offset:28672
v_mfma_f32_16x16x32_bf16 v[76:79], v[232:235], v[36:39], v[76:79]
s_waitcnt lgkmcnt(5)
v_mfma_f32_16x16x32_bf16 v[64:67], v[172:175], v[40:43], v[64:67]
ds_read_b128 v[36:39], v11 offset:29696
v_mfma_f32_16x16x32_bf16 v[68:71], v[236:239], v[40:43], v[68:71]
v_mfma_f32_16x16x32_bf16 v[72:75], v[172:175], v[44:47], v[72:75]
ds_read_b128 v[40:43], v11 offset:30720
v_mfma_f32_16x16x32_bf16 v[76:79], v[236:239], v[44:47], v[76:79]
s_waitcnt lgkmcnt(5)
v_mfma_f32_16x16x32_bf16 v[64:67], v[176:179], v[16:19], v[64:67]
ds_read_b128 v[44:47], v11 offset:31744
v_mfma_f32_16x16x32_bf16 v[68:71], v[240:243], v[16:19], v[68:71]
v_mfma_f32_16x16x32_bf16 v[72:75], v[176:179], v[20:23], v[72:75]
v_mfma_f32_16x16x32_bf16 v[76:79], v[240:243], v[20:23], v[76:79]
s_waitcnt lgkmcnt(4)
v_mfma_f32_16x16x32_bf16 v[64:67], v[180:183], v[24:27], v[64:67]
v_mfma_f32_16x16x32_bf16 v[68:71], v[244:247], v[24:27], v[68:71]
v_mfma_f32_16x16x32_bf16 v[72:75], v[180:183], v[28:31], v[72:75]
v_mfma_f32_16x16x32_bf16 v[76:79], v[244:247], v[28:31], v[76:79]
s_waitcnt lgkmcnt(2)
v_mfma_f32_16x16x32_bf16 v[64:67], v[184:187], v[32:35], v[64:67]
v_mfma_f32_16x16x32_bf16 v[68:71], v[248:251], v[32:35], v[68:71]
v_mfma_f32_16x16x32_bf16 v[72:75], v[184:187], v[36:39], v[72:75]
v_mfma_f32_16x16x32_bf16 v[76:79], v[248:251], v[36:39], v[76:79]
s_waitcnt lgkmcnt(0)
v_mfma_f32_16x16x32_bf16 v[64:67], v[188:191], v[40:43], v[64:67]
v_mfma_f32_16x16x32_bf16 v[68:71], v[252:255], v[40:43], v[68:71]
v_mfma_f32_16x16x32_bf16 v[72:75], v[188:191], v[44:47], v[72:75]
v_mfma_f32_16x16x32_bf16 v[76:79], v[252:255], v[44:47], v[76:79]
s_cmp_ge_u32 s36, 3
s_cselect_b32 s58, s62, 0x70000000
s_add_u32 s49, s49, 229376
s_add_u32 s62, s62, 65536
s_add_u32 s59, s59, 229376
s_add_u32 s36, s36, 1
v_add_u32 v11, 0x8000, v11
s_nop 0
v_cvt_pk_bf16_f32 v80, v64, v65
v_cvt_pk_bf16_f32 v81, v66, v67
v_cvt_pk_bf16_f32 v82, v68, v69
v_cvt_pk_bf16_f32 v83, v70, v71
v_cvt_pk_bf16_f32 v84, v72, v73
v_cvt_pk_bf16_f32 v85, v74, v75
v_cvt_pk_bf16_f32 v86, v76, v77
v_cvt_pk_bf16_f32 v87, v78, v79
buffer_store_dwordx4 v[80:83], v7, s[4:7], s58 offen offset:0 sc1
buffer_store_dwordx4 v[84:87], v7, s[4:7], s58 offen offset:1024 sc1
s_waitcnt vmcnt(0)
s_barrier
v_min_u32 v100, s36, 64
s_sub_u32 s38, s36, 3
v_max_i32 v101, s38, 0
buffer_store_dwordx2 v[100:101], v4, s[4:7], 0 offen sc1
s_endpgm
Lln_6:
s_sub_u32 s26, s44, 56
s_and_b32 s52, s26, 3
s_lshl_b32 s53, s32, 2
v_lshrrev_b32 v80, 3, v9
v_and_b32 v81, 7, v9
s_lshr_b32 s38, s52, 1
s_lshl_b32 s38, s38, 10
s_and_b32 s39, s52, 1
s_lshl_b32 s39, s39, 7
s_add_u32 s38, s38, s39
s_lshl_b32 s39, s53, 12
s_add_u32 s38, s38, s39
v_lshl_add_u32 v6, v81, 4, s38
v_and_b32 v82, 3, v80
v_lshl_add_u32 v6, v82, 8, v6
v_lshrrev_b32 v82, 2, v80
v_lshl_add_u32 v6, v82, 11, v6
s_lshl_b32 s38, s52, 14
s_lshl_b32 s39, s53, 7
s_add_u32 s38, s38, s39
v_lshl_add_u32 v7, v81, 11, s38
v_lshl_add_u32 v7, v80, 4, v7
s_lshl_b32 s38, s53, 8
v_lshl_add_u32 v8, v80, 5, s38
v_and_b32 v12, 7, v9
v_lshlrev_b32 v12, 4, v12
s_lshl_b32 s38, s32, 2
v_add_u32 v11, s38, v12
s_mov_b32 s60, 0x00003f80
s_mov_b32 s61, 0x3f800000
v_min_u32 v2, 31, v9
v_lshlrev_b32 v2, 7, v2
s_lshr_b32 s47, s26, 2
s_xor_b32 s47, s47, 1
s_lshl_b32 s47, s47, 12
s_add_u32 s47, s47, 3440640
Lst_641:
buffer_load_dword v48, off, s[12:15], 0 offset:32 sc1
buffer_load_dword v49, off, s[12:15], 0 offset:160 sc1
s_waitcnt vmcnt(0)
v_add_u32 v48, v48, v49
s_nop 0
v_readfirstlane_b32 s38, v48
s_nop 3
s_and_b32 s39, s38, 0xffff
s_cmp_eq_u32 s39, 0x100
s_cbranch_scc1 Lso_642
s_sub_u32 s37, s37, 1
s_cbranch_scc1 Lend_7
s_sleep 8
s_branch Lst_641
Lso_642:
s_bfe_u32 s35, s38, 0x80010
s_bfe_u32 s46, s38, 0x10018
s_lshl_b32 s46, s46, 13
s_barrier
v_lshlrev_b32 v80, 7, v9
s_mov_b32 s38, 3424256
Lbw_643:
buffer_load_dword v81, v80, s[4:7], s38 offen sc1
s_waitcnt vmcnt(0)
v_cmp_gt_u32 vcc, 4, v81
s_cbranch_vccz Lbo_644
s_sub_u32 s37, s37, 1
s_cbranch_scc1 Lend_7
s_sleep 2
s_branch Lbw_643
Lbo_644:
s_mov_b32 s38, 3153920
buffer_load_dwordx4 v[128:131], v8, s[4:7], s38 offen offset:0 sc1
buffer_load_dwordx4 v[132:135], v8, s[4:7], s38 offen offset:16 sc1
buffer_load_dwordx4 v[136:139], v8, s[4:7], s38 offen offset:256 sc1
buffer_load_dwordx4 v[140:143], v8, s[4:7], s38 offen offset:272 sc1
buffer_load_dwordx4 v[144:147], v8, s[4:7], s38 offen offset:512 sc1
buffer_load_dwordx4 v[148:151], v8, s[4:7], s38 offen offset:528 sc1
buffer_load_dwordx4 v[152:155], v8, s[4:7], s38 offen offset:768 sc1
buffer_load_dwordx4 v[156:159], v8, s[4:7], s38 offen offset:784 sc1
s_mov_b32 s38, 3158016
buffer_load_dwordx4 v[192:195], v8, s[4:7], s38 offen offset:0 sc1
buffer_load_dwordx4 v[196:199], v8, s[4:7], s38 offen offset:16 sc1
buffer_load_dwordx4 v[200:203], v8, s[4:7], s38 offen offset:256 sc1
buffer_load_dwordx4 v[204:207], v8, s[4:7], s38 offen offset:272 sc1
buffer_load_dwordx4 v[208:211], v8, s[4:7], s38 offen offset:512 sc1
buffer_load_dwordx4 v[212:215], v8, s[4:7], s38 offen offset:528 sc1
buffer_load_dwordx4 v[216:219], v8, s[4:7], s38 offen offset:768 sc1
buffer_load_dwordx4 v[220:223], v8, s[4:7], s38 offen offset:784 sc1
s_mov_b32 s38, 3162112
buffer_load_dwordx4 v[160:163], v8, s[4:7], s38 offen offset:0 sc1
buffer_load_dwordx4 v[164:167], v8, s[4:7], s38 offen offset:16 sc1
buffer_load_dwordx4 v[168:171], v8, s[4:7], s38 offen offset:256 sc1
buffer_load_dwordx4 v[172:175], v8, s[4:7], s38 offen offset:272 sc1
buffer_load_dwordx4 v[176:179], v8, s[4:7], s38 offen offset:512 sc1
buffer_load_dwordx4 v[180:183], v8, s[4:7], s38 offen offset:528 sc1
buffer_load_dwordx4 v[184:187], v8, s[4:7], s38 offen offset:768 sc1
buffer_load_dwordx4 v[188:191], v8, s[4:7], s38 offen offset:784 sc1
s_waitcnt vmcnt(0)
v_pk_add_f32 v[160:161], v[160:161], 1.0 op_sel_hi:[1,0]
v_pk_add_f32 v[162:163], v[162:163], 1.0 op_sel_hi:[1,0]
v_pk_add_f32 v[164:165], v[164:165], 1.0 op_sel_hi:[1,0]
v_pk_add_f32 v[166:167], v[166:167], 1.0 op_sel_hi:[1,0]
v_pk_add_f32 v[168:169], v[168:169], 1.0 op_sel_hi:[1,0]
v_pk_add_f32 v[170:171], v[170:171], 1.0 op_sel_hi:[1,0]
v_pk_add_f32 v[172:173], v[172:173], 1.0 op_sel_hi:[1,0]
v_pk_add_f32 v[174:175], v[174:175], 1.0 op_sel_hi:[1,0]
v_pk_add_f32 v[176:177], v[176:177], 1.0 op_sel_hi:[1,0]
v_pk_add_f32 v[178:179], v[178:179], 1.0 op_sel_hi:[1,0]
v_pk_add_f32 v[180:181], v[180:181], 1.0 op_sel_hi:[1,0]
v_pk_add_f32 v[182:183], v[182:183], 1.0 op_sel_hi:[1,0]
v_pk_add_f32 v[184:185], v[184:185], 1.0 op_sel_hi:[1,0]
v_pk_add_f32 v[186:187], v[186:187], 1.0 op_sel_hi:[1,0]
v_pk_add_f32 v[188:189], v[188:189], 1.0 op_sel_hi:[1,0]
v_pk_add_f32 v[190:191], v[190:191], 1.0 op_sel_hi:[1,0]
s_lshr_b32 s36, s26, 2
Lln_645:
s_lshl_b32 s49, s36, 16
buffer_load_dwordx4 v[80:83], v7, s[88:91], s49 offen offset:0
buffer_load_dwordx4 v[84:87], v7, s[88:91], s49 offen offset:128
buffer_load_dwordx4 v[88:91], v7, s[88:91], s49 offen offset:256
buffer_load_dwordx4 v[92:95], v7, s[88:91], s49 offen offset:384
s_add_u32 s48, s36, 1
Lbw_646:
buffer_load_dword v3, v2, s[4:7], s47 offen sc1
s_waitcnt vmcnt(0)
v_cmp_gt_u32 vcc, s48, v3
s_cbranch_vccz Lbo_647
s_sub_u32 s37, s37, 1
s_cbranch_scc1 Lend_7
s_sleep 2
s_branch Lbw_646
Lbo_647:
s_add_u32 s39, s49, 117440512
buffer_load_dwordx4 v[16:19], v6, s[4:7], s39 offen sc1
s_add_u32 s39, s49, 121634816
buffer_load_dwordx4 v[20:23], v6, s[4:7], s39 offen sc1
s_add_u32 s39, s49, 125829120
buffer_load_dwordx4 v[24:27], v6, s[4:7], s39 offen sc1
s_add_u32 s39, s49, 130023424
buffer_load_dwordx4 v[28:31], v6, s[4:7], s39 offen sc1
s_add_u32 s39, s49, 117444608
buffer_load_dwordx4 v[32:35], v6, s[4:7], s39 offen sc1
s_add_u32 s39, s49, 121638912
buffer_load_dwordx4 v[36:39], v6, s[4:7], s39 offen sc1
s_add_u32 s39, s49, 125833216
buffer_load_dwordx4 v[40:43], v6, s[4:7], s39 offen sc1
s_add_u32 s39, s49, 130027520
buffer_load_dwordx4 v[44:47], v6, s[4:7], s39 offen sc1
s_add_u32 s39, s49, 117448704
buffer_load_dwordx4 v[48:51], v6, s[4:7], s39 offen sc1
s_add_u32 s39, s49, 121643008
buffer_load_dwordx4 v[52:55], v6, s[4:7], s39 offen sc1
s_add_u32 s39, s49, 125837312
buffer_load_dwordx4 v[56:59], v6, s[4:7], s39 offen sc1
s_add_u32 s39, s49, 130031616
buffer_load_dwordx4 v[60:63], v6, s[4:7], s39 offen sc1
s_add_u32 s39, s49, 117452800
buffer_load_dwordx4 v[64:67], v6, s[4:7], s39 offen sc1
s_add_u32 s39, s49, 121647104
buffer_load_dwordx4 v[68:71], v6, s[4:7], s39 offen sc1
s_add_u32 s39, s49, 125841408
buffer_load_dwordx4 v[72:75], v6, s[4:7], s39 offen sc1
s_add_u32 s39, s49, 130035712
buffer_load_dwordx4 v[76:79], v6, s[4:7], s39 offen sc1
v_lshlrev_b32 v96, 16, v80
v_and_b32 v97, 0xffff0000, v80
v_lshlrev_b32 v98, 16, v81
v_and_b32 v99, 0xffff0000, v81
v_lshlrev_b32 v100, 16, v82
v_and_b32 v101, 0xffff0000, v82
v_lshlrev_b32 v102, 16, v83
v_and_b32 v103, 0xffff0000, v83
v_lshlrev_b32 v104, 16, v84
v_and_b32 v105, 0xffff0000, v84
v_lshlrev_b32 v106, 16, v85
v_and_b32 v107, 0xffff0000, v85
v_lshlrev_b32 v108, 16, v86
v_and_b32 v109, 0xffff0000, v86
v_lshlrev_b32 v110, 16, v87
v_and_b32 v111, 0xffff0000, v87
v_lshlrev_b32 v112, 16, v88
v_and_b32 v113, 0xffff0000, v88
v_lshlrev_b32 v114, 16, v89
v_and_b32 v115, 0xffff0000, v89
v_lshlrev_b32 v116, 16, v90
v_and_b32 v117, 0xffff0000, v90
v_lshlrev_b32 v118, 16, v91
v_and_b32 v119, 0xffff0000, v91
v_lshlrev_b32 v120, 16, v92
v_and_b32 v121, 0xffff0000, v92
v_lshlrev_b32 v122, 16, v93
v_and_b32 v123, 0xffff0000, v93
v_lshlrev_b32 v124, 16, v94
v_and_b32 v125, 0xffff0000, v94
v_lshlrev_b32 v126, 16, v95
v_and_b32 v127, 0xffff0000, v95
s_waitcnt vmcnt(12)
v_dot2_f32_bf16 v224, v16, s60, 0
v_dot2_f32_bf16 v225, v16, s61, 0
v_dot2_f32_bf16 v226, v17, s60, 0
v_dot2_f32_bf16 v227, v17, s61, 0
v_dot2_f32_bf16 v228, v18, s60, 0
v_dot2_f32_bf16 v229, v18, s61, 0
v_dot2_f32_bf16 v230, v19, s60, 0
v_dot2_f32_bf16 v231, v19, s61, 0
v_dot2_f32_bf16 v224, v20, s60, v224
v_dot2_f32_bf16 v225, v20, s61, v225
v_dot2_f32_bf16 v226, v21, s60, v226
v_dot2_f32_bf16 v227, v21, s61, v227
v_dot2_f32_bf16 v228, v22, s60, v228
v_dot2_f32_bf16 v229, v22, s61, v229
v_dot2_f32_bf16 v230, v23, s60, v230
v_dot2_f32_bf16 v231, v23, s61, v231
v_dot2_f32_bf16 v224, v24, s60, v224
v_dot2_f32_bf16 v225, v24, s61, v225
v_dot2_f32_bf16 v226, v25, s60, v226
v_dot2_f32_bf16 v227, v25, s61, v227
v_dot2_f32_bf16 v228, v26, s60, v228
v_dot2_f32_bf16 v229, v26, s61, v229
v_dot2_f32_bf16 v230, v27, s60, v230
v_dot2_f32_bf16 v231, v27, s61, v231
v_dot2_f32_bf16 v224, v28, s60, v224
v_dot2_f32_bf16 v225, v28, s61, v225
v_dot2_f32_bf16 v226, v29, s60, v226
v_dot2_f32_bf16 v227, v29, s61, v227
v_dot2_f32_bf16 v228, v30, s60, v228
v_dot2_f32_bf16 v229, v30, s61, v229
v_dot2_f32_bf16 v230, v31, s60, v230
v_dot2_f32_bf16 v231, v31, s61, v231
s_nop 1
v_pk_fma_f32 v[96:97], v[224:225], v[128:129], v[96:97]
v_pk_fma_f32 v[98:99], v[226:227], v[130:131], v[98:99]
v_pk_fma_f32 v[100:101], v[228:229], v[132:133], v[100:101]
v_pk_fma_f32 v[102:103], v[230:231], v[134:135], v[102:103]
v_cvt_pk_bf16_f32 v80, v96, v97
v_cvt_pk_bf16_f32 v81, v98, v99
v_cvt_pk_bf16_f32 v82, v100, v101
v_cvt_pk_bf16_f32 v83, v102, v103
s_add_u32 s39, s49, 12582912
buffer_store_dwordx4 v[80:83], v6, s[4:7], s39 offen sc1
v_lshlrev_b32 v96, 16, v80
v_and_b32 v97, 0xffff0000, v80
v_lshlrev_b32 v98, 16, v81
v_and_b32 v99, 0xffff0000, v81
v_lshlrev_b32 v100, 16, v82
v_and_b32 v101, 0xffff0000, v82
v_lshlrev_b32 v102, 16, v83
v_and_b32 v103, 0xffff0000, v83
s_waitcnt vmcnt(9)
v_dot2_f32_bf16 v224, v32, s60, 0
v_dot2_f32_bf16 v225, v32, s61, 0
v_dot2_f32_bf16 v226, v33, s60, 0
v_dot2_f32_bf16 v227, v33, s61, 0
v_dot2_f32_bf16 v228, v34, s60, 0
v_dot2_f32_bf16 v229, v34, s61, 0
v_dot2_f32_bf16 v230, v35, s60, 0
v_dot2_f32_bf16 v231, v35, s61, 0
v_dot2_f32_bf16 v224, v36, s60, v224
v_dot2_f32_bf16 v225, v36, s61, v225
v_dot2_f32_bf16 v226, v37, s60, v226
v_dot2_f32_bf16 v227, v37, s61, v227
v_dot2_f32_bf16 v228, v38, s60, v228
v_dot2_f32_bf16 v229, v38, s61, v229
v_dot2_f32_bf16 v230, v39, s60, v230
v_dot2_f32_bf16 v231, v39, s61, v231
v_dot2_f32_bf16 v224, v40, s60, v224
v_dot2_f32_bf16 v225, v40, s61, v225
v_dot2_f32_bf16 v226, v41, s60, v226
v_dot2_f32_bf16 v227, v41, s61, v227
v_dot2_f32_bf16 v228, v42, s60, v228
v_dot2_f32_bf16 v229, v42, s61, v229
v_dot2_f32_bf16 v230, v43, s60, v230
v_dot2_f32_bf16 v231, v43, s61, v231
v_dot2_f32_bf16 v224, v44, s60, v224
v_dot2_f32_bf16 v225, v44, s61, v225
v_dot2_f32_bf16 v226, v45, s60, v226
v_dot2_f32_bf16 v227, v45, s61, v227
v_dot2_f32_bf16 v228, v46, s60, v228
v_dot2_f32_bf16 v229, v46, s61, v229
v_dot2_f32_bf16 v230, v47, s60, v230
v_dot2_f32_bf16 v231, v47, s61, v231
s_nop 1
v_pk_fma_f32 v[104:105], v[224:225], v[136:137], v[104:105]
v_pk_fma_f32 v[106:107], v[226:227], v[138:139], v[106:107]
v_pk_fma_f32 v[108:109], v[228:229], v[140:141], v[108:109]
v_pk_fma_f32 v[110:111], v[230:231], v[142:143], v[110:111]
v_cvt_pk_bf16_f32 v84, v104, v105
v_cvt_pk_bf16_f32 v85, v106, v107
v_cvt_pk_bf16_f32 v86, v108, v109
v_cvt_pk_bf16_f32 v87, v110, v111
s_add_u32 s39, s49, 12587008
buffer_store_dwordx4 v[84:87], v6, s[4:7], s39 offen sc1
v_lshlrev_b32 v104, 16, v84
v_and_b32 v105, 0xffff0000, v84
v_lshlrev_b32 v106, 16, v85
v_and_b32 v107, 0xffff0000, v85
v_lshlrev_b32 v108, 16, v86
v_and_b32 v109, 0xffff0000, v86
v_lshlrev_b32 v110, 16, v87
v_and_b32 v111, 0xffff0000, v87
s_waitcnt vmcnt(6)
v_dot2_f32_bf16 v224, v48, s60, 0
v_dot2_f32_bf16 v225, v48, s61, 0
v_dot2_f32_bf16 v226, v49, s60, 0
v_dot2_f32_bf16 v227, v49, s61, 0
v_dot2_f32_bf16 v228, v50, s60, 0
v_dot2_f32_bf16 v229, v50, s61, 0
v_dot2_f32_bf16 v230, v51, s60, 0
v_dot2_f32_bf16 v231, v51, s61, 0
v_dot2_f32_bf16 v224, v52, s60, v224
v_dot2_f32_bf16 v225, v52, s61, v225
v_dot2_f32_bf16 v226, v53, s60, v226
v_dot2_f32_bf16 v227, v53, s61, v227
v_dot2_f32_bf16 v228, v54, s60, v228
v_dot2_f32_bf16 v229, v54, s61, v229
v_dot2_f32_bf16 v230, v55, s60, v230
v_dot2_f32_bf16 v231, v55, s61, v231
v_dot2_f32_bf16 v224, v56, s60, v224
v_dot2_f32_bf16 v225, v56, s61, v225
v_dot2_f32_bf16 v226, v57, s60, v226
v_dot2_f32_bf16 v227, v57, s61, v227
v_dot2_f32_bf16 v228, v58, s60, v228
v_dot2_f32_bf16 v229, v58, s61, v229
v_dot2_f32_bf16 v230, v59, s60, v230
v_dot2_f32_bf16 v231, v59, s61, v231
v_dot2_f32_bf16 v224, v60, s60, v224
v_dot2_f32_bf16 v225, v60, s61, v225
v_dot2_f32_bf16 v226, v61, s60, v226
v_dot2_f32_bf16 v227, v61, s61, v227
v_dot2_f32_bf16 v228, v62, s60, v228
v_dot2_f32_bf16 v229, v62, s61, v229
v_dot2_f32_bf16 v230, v63, s60, v230
v_dot2_f32_bf16 v231, v63, s61, v231
s_nop 1
v_pk_fma_f32 v[112:113], v[224:225], v[144:145], v[112:113]
v_pk_fma_f32 v[114:115], v[226:227], v[146:147], v[114:115]
v_pk_fma_f32 v[116:117], v[228:229], v[148:149], v[116:117]
v_pk_fma_f32 v[118:119], v[230:231], v[150:151], v[118:119]
v_cvt_pk_bf16_f32 v88, v112, v113
v_cvt_pk_bf16_f32 v89, v114, v115
v_cvt_pk_bf16_f32 v90, v116, v117
v_cvt_pk_bf16_f32 v91, v118, v119
s_add_u32 s39, s49, 12591104
buffer_store_dwordx4 v[88:91], v6, s[4:7], s39 offen sc1
v_lshlrev_b32 v112, 16, v88
v_and_b32 v113, 0xffff0000, v88
v_lshlrev_b32 v114, 16, v89
v_and_b32 v115, 0xffff0000, v89
v_lshlrev_b32 v116, 16, v90
v_and_b32 v117, 0xffff0000, v90
v_lshlrev_b32 v118, 16, v91
v_and_b32 v119, 0xffff0000, v91
s_waitcnt vmcnt(3)
v_dot2_f32_bf16 v224, v64, s60, 0
v_dot2_f32_bf16 v225, v64, s61, 0
v_dot2_f32_bf16 v226, v65, s60, 0
v_dot2_f32_bf16 v227, v65, s61, 0
v_dot2_f32_bf16 v228, v66, s60, 0
v_dot2_f32_bf16 v229, v66, s61, 0
v_dot2_f32_bf16 v230, v67, s60, 0
v_dot2_f32_bf16 v231, v67, s61, 0
v_dot2_f32_bf16 v224, v68, s60, v224
v_dot2_f32_bf16 v225, v68, s61, v225
v_dot2_f32_bf16 v226, v69, s60, v226
v_dot2_f32_bf16 v227, v69, s61, v227
v_dot2_f32_bf16 v228, v70, s60, v228
v_dot2_f32_bf16 v229, v70, s61, v229
v_dot2_f32_bf16 v230, v71, s60, v230
v_dot2_f32_bf16 v231, v71, s61, v231
v_dot2_f32_bf16 v224, v72, s60, v224
v_dot2_f32_bf16 v225, v72, s61, v225
v_dot2_f32_bf16 v226, v73, s60, v226
v_dot2_f32_bf16 v227, v73, s61, v227
v_dot2_f32_bf16 v228, v74, s60, v228
v_dot2_f32_bf16 v229, v74, s61, v229
v_dot2_f32_bf16 v230, v75, s60, v230
v_dot2_f32_bf16 v231, v75, s61, v231
v_dot2_f32_bf16 v224, v76, s60, v224
v_dot2_f32_bf16 v225, v76, s61, v225
v_dot2_f32_bf16 v226, v77, s60, v226
v_dot2_f32_bf16 v227, v77, s61, v227
v_dot2_f32_bf16 v228, v78, s60, v228
v_dot2_f32_bf16 v229, v78, s61, v229
v_dot2_f32_bf16 v230, v79, s60, v230
v_dot2_f32_bf16 v231, v79, s61, v231
s_nop 1
v_pk_fma_f32 v[120:121], v[224:225], v[152:153], v[120:121]
v_pk_fma_f32 v[122:123], v[226:227], v[154:155], v[122:123]
v_pk_fma_f32 v[124:125], v[228:229], v[156:157], v[124:125]
v_pk_fma_f32 v[126:127], v[230:231], v[158:159], v[126:127]
v_cvt_pk_bf16_f32 v92, v120, v121
v_cvt_pk_bf16_f32 v93, v122, v123
v_cvt_pk_bf16_f32 v94, v124, v125
v_cvt_pk_bf16_f32 v95, v126, v127
s_add_u32 s39, s49, 12595200
buffer_store_dwordx4 v[92:95], v6, s[4:7], s39 offen sc1
v_lshlrev_b32 v120, 16, v92
v_and_b32 v121, 0xffff0000, v92
v_lshlrev_b32 v122, 16, v93
v_and_b32 v123, 0xffff0000, v93
v_lshlrev_b32 v124, 16, v94
v_and_b32 v125, 0xffff0000, v94
v_lshlrev_b32 v126, 16, v95
v_and_b32 v127, 0xffff0000, v95
v_pk_add_f32 v[224:225], v[96:97], v[98:99]
v_pk_add_f32 v[224:225], v[224:225], v[100:101]
v_pk_add_f32 v[224:225], v[224:225], v[102:103]
v_pk_add_f32 v[224:225], v[224:225], v[104:105]
v_pk_add_f32 v[224:225], v[224:225], v[106:107]
v_pk_add_f32 v[224:225], v[224:225], v[108:109]
v_pk_add_f32 v[224:225], v[224:225], v[110:111]
v_pk_add_f32 v[224:225], v[224:225], v[112:113]
v_pk_add_f32 v[224:225], v[224:225], v[114:115]
v_pk_add_f32 v[224:225], v[224:225], v[116:117]
v_pk_add_f32 v[224:225], v[224:225], v[118:119]
v_pk_add_f32 v[224:225], v[224:225], v[120:121]
v_pk_add_f32 v[224:225], v[224:225], v[122:123]
v_pk_add_f32 v[224:225], v[224:225], v[124:125]
v_pk_add_f32 v[224:225], v[224:225], v[126:127]
v_add_f32 v224, v224, v225
s_nop 1
v_add_f32_dpp v224, v224, v224 row_ror:8 row_mask:0xf bank_mask:0xf
v_mov_b32 v225, v224
s_nop 1
v_permlane16_swap_b32 v224, v225
s_nop 0
v_add_f32 v224, v224, v225
v_mov_b32 v225, v224
s_nop 1
v_permlane32_swap_b32 v224, v225
s_nop 0
v_add_f32 v224, v224, v225
ds_write_b32 v11, v224 offset:512
s_waitcnt lgkmcnt(0)
s_barrier
ds_read_b128 v[224:227], v12 offset:512
s_waitcnt lgkmcnt(0)
v_pk_add_f32 v[224:225], v[224:225], v[226:227]
v_add_f32 v224, v224, v225
v_mul_f32 v224, 0x3a800000, v224
v_pk_add_f32 v[96:97], v[96:97], v[224:225] op_sel_hi:[1,0] neg_lo:[0,1] neg_hi:[0,1]
v_pk_add_f32 v[98:99], v[98:99], v[224:225] op_sel_hi:[1,0] neg_lo:[0,1] neg_hi:[0,1]
v_pk_add_f32 v[100:101], v[100:101], v[224:225] op_sel_hi:[1,0] neg_lo:[0,1] neg_hi:[0,1]
v_pk_add_f32 v[102:103], v[102:103], v[224:225] op_sel_hi:[1,0] neg_lo:[0,1] neg_hi:[0,1]
v_pk_add_f32 v[104:105], v[104:105], v[224:225] op_sel_hi:[1,0] neg_lo:[0,1] neg_hi:[0,1]
v_pk_add_f32 v[106:107], v[106:107], v[224:225] op_sel_hi:[1,0] neg_lo:[0,1] neg_hi:[0,1]
v_pk_add_f32 v[108:109], v[108:109], v[224:225] op_sel_hi:[1,0] neg_lo:[0,1] neg_hi:[0,1]
v_pk_add_f32 v[110:111], v[110:111], v[224:225] op_sel_hi:[1,0] neg_lo:[0,1] neg_hi:[0,1]
v_pk_add_f32 v[112:113], v[112:113], v[224:225] op_sel_hi:[1,0] neg_lo:[0,1] neg_hi:[0,1]
v_pk_add_f32 v[114:115], v[114:115], v[224:225] op_sel_hi:[1,0] neg_lo:[0,1] neg_hi:[0,1]
v_pk_add_f32 v[116:117], v[116:117], v[224:225] op_sel_hi:[1,0] neg_lo:[0,1] neg_hi:[0,1]
v_pk_add_f32 v[118:119], v[118:119], v[224:225] op_sel_hi:[1,0] neg_lo:[0,1] neg_hi:[0,1]
v_pk_add_f32 v[120:121], v[120:121], v[224:225] op_sel_hi:[1,0] neg_lo:[0,1] neg_hi:[0,1]
v_pk_add_f32 v[122:123], v[122:123], v[224:225] op_sel_hi:[1,0] neg_lo:[0,1] neg_hi:[0,1]
v_pk_add_f32 v[124:125], v[124:125], v[224:225] op_sel_hi:[1,0] neg_lo:[0,1] neg_hi:[0,1]
v_pk_add_f32 v[126:127], v[126:127], v[224:225] op_sel_hi:[1,0] neg_lo:[0,1] neg_hi:[0,1]
v_pk_mul_f32 v[224:225], v[96:97], v[96:97]
v_pk_fma_f32 v[224:225], v[98:99], v[98:99], v[224:225]
v_pk_fma_f32 v[224:225], v[100:101], v[100:101], v[224:225]
v_pk_fma_f32 v[224:225], v[102:103], v[102:103], v[224:225]
v_pk_fma_f32 v[224:225], v[104:105], v[104:105], v[224:225]
v_pk_fma_f32 v[224:225], v[106:107], v[106:107], v[224:225]
v_pk_fma_f32 v[224:225], v[108:109], v[108:109], v[224:225]
v_pk_fma_f32 v[224:225], v[110:111], v[110:111], v[224:225]
v_pk_fma_f32 v[224:225], v[112:113], v[112:113], v[224:225]
v_pk_fma_f32 v[224:225], v[114:115], v[114:115], v[224:225]
v_pk_fma_f32 v[224:225], v[116:117], v[116:117], v[224:225]
v_pk_fma_f32 v[224:225], v[118:119], v[118:119], v[224:225]
v_pk_fma_f32 v[224:225], v[120:121], v[120:121], v[224:225]
v_pk_fma_f32 v[224:225], v[122:123], v[122:123], v[224:225]
v_pk_fma_f32 v[224:225], v[124:125], v[124:125], v[224:225]
v_pk_fma_f32 v[224:225], v[126:127], v[126:127], v[224:225]
v_add_f32 v224, v224, v225
s_nop 1
v_add_f32_dpp v224, v224, v224 row_ror:8 row_mask:0xf bank_mask:0xf
v_mov_b32 v225, v224
s_nop 1
v_permlane16_swap_b32 v224, v225
s_nop 0
v_add_f32 v224, v224, v225
v_mov_b32 v225, v224
s_nop 1
v_permlane32_swap_b32 v224, v225
s_nop 0
v_add_f32 v224, v224, v225
ds_write_b32 v11, v224 offset:768
s_waitcnt lgkmcnt(0)
s_barrier
ds_read_b128 v[224:227], v12 offset:768
s_waitcnt lgkmcnt(0)
v_pk_add_f32 v[224:225], v[224:225], v[226:227]
v_add_f32 v224, v224, v225
v_mul_f32 v224, 0x3a800000, v224
v_add_f32 v224, 0x3727c5ac, v224
v_rsq_f32 v224, v224
s_nop 0
v_pk_mul_f32 v[96:97], v[96:97], v[224:225] op_sel_hi:[1,0]
v_pk_mul_f32 v[98:99], v[98:99], v[224:225] op_sel_hi:[1,0]
v_pk_mul_f32 v[100:101], v[100:101], v[224:225] op_sel_hi:[1,0]
v_pk_mul_f32 v[102:103], v[102:103], v[224:225] op_sel_hi:[1,0]
v_pk_mul_f32 v[104:105], v[104:105], v[224:225] op_sel_hi:[1,0]
v_pk_mul_f32 v[106:107], v[106:107], v[224:225] op_sel_hi:[1,0]
v_pk_mul_f32 v[108:109], v[108:109], v[224:225] op_sel_hi:[1,0]
v_pk_mul_f32 v[110:111], v[110:111], v[224:225] op_sel_hi:[1,0]
v_pk_mul_f32 v[112:113], v[112:113], v[224:225] op_sel_hi:[1,0]
v_pk_mul_f32 v[114:115], v[114:115], v[224:225] op_sel_hi:[1,0]
v_pk_mul_f32 v[116:117], v[116:117], v[224:225] op_sel_hi:[1,0]
v_pk_mul_f32 v[118:119], v[118:119], v[224:225] op_sel_hi:[1,0]
v_pk_mul_f32 v[120:121], v[120:121], v[224:225] op_sel_hi:[1,0]
v_pk_mul_f32 v[122:123], v[122:123], v[224:225] op_sel_hi:[1,0]
v_pk_mul_f32 v[124:125], v[124:125], v[224:225] op_sel_hi:[1,0]
v_pk_mul_f32 v[126:127], v[126:127], v[224:225] op_sel_hi:[1,0]
v_pk_fma_f32 v[96:97], v[96:97], v[160:161], v[192:193]
v_pk_fma_f32 v[98:99], v[98:99], v[162:163], v[194:195]
v_pk_fma_f32 v[100:101], v[100:101], v[164:165], v[196:197]
v_pk_fma_f32 v[102:103], v[102:103], v[166:167], v[198:199]
v_cvt_pk_bf16_f32 v16, v96, v97
v_cvt_pk_bf16_f32 v17, v98, v99
v_cvt_pk_bf16_f32 v18, v100, v101
v_cvt_pk_bf16_f32 v19, v102, v103
s_add_u32 s39, s49, 16777216
buffer_store_dwordx4 v[16:19], v6, s[4:7], s39 offen sc1
v_pk_fma_f32 v[104:105], v[104:105], v[168:169], v[200:201]
v_pk_fma_f32 v[106:107], v[106:107], v[170:171], v[202:203]
v_pk_fma_f32 v[108:109], v[108:109], v[172:173], v[204:205]
v_pk_fma_f32 v[110:111], v[110:111], v[174:175], v[206:207]
v_cvt_pk_bf16_f32 v20, v104, v105
v_cvt_pk_bf16_f32 v21, v106, v107
v_cvt_pk_bf16_f32 v22, v108, v109
v_cvt_pk_bf16_f32 v23, v110, v111
s_add_u32 s39, s49, 16781312
buffer_store_dwordx4 v[20:23], v6, s[4:7], s39 offen sc1
v_pk_fma_f32 v[112:113], v[112:113], v[176:177], v[208:209]
v_pk_fma_f32 v[114:115], v[114:115], v[178:179], v[210:211]
v_pk_fma_f32 v[116:117], v[116:117], v[180:181], v[212:213]
v_pk_fma_f32 v[118:119], v[118:119], v[182:183], v[214:215]
v_cvt_pk_bf16_f32 v24, v112, v113
v_cvt_pk_bf16_f32 v25, v114, v115
v_cvt_pk_bf16_f32 v26, v116, v117
v_cvt_pk_bf16_f32 v27, v118, v119
s_add_u32 s39, s49, 16785408
buffer_store_dwordx4 v[24:27], v6, s[4:7], s39 offen sc1
v_pk_fma_f32 v[120:121], v[120:121], v[184:185], v[216:217]
v_pk_fma_f32 v[122:123], v[122:123], v[186:187], v[218:219]
v_pk_fma_f32 v[124:125], v[124:125], v[188:189], v[220:221]
v_pk_fma_f32 v[126:127], v[126:127], v[190:191], v[222:223]
v_cvt_pk_bf16_f32 v28, v120, v121
v_cvt_pk_bf16_f32 v29, v122, v123
v_cvt_pk_bf16_f32 v30, v124, v125
v_cvt_pk_bf16_f32 v31, v126, v127
s_add_u32 s39, s49, 16789504
buffer_store_dwordx4 v[28:31], v6, s[4:7], s39 offen sc1
v_mov_b32 v5, s48
s_waitcnt vmcnt(0)
s_barrier
buffer_store_dword v5, v4, s[4:7], 0 offen sc1
s_add_u32 s36, s36, 2
s_cmp_lt_u32 s36, 64
s_cbranch_scc1 Lln_645
s_endpgm
Lcode_end:

.section .rodata,"a"
.p2align 6
.amdhsa_kernel adaLN_cond__memory_aug_recurrent_mem_tr__glu_gated_swiglu__prompt_kernel
  .amdhsa_next_free_vgpr 512
  .amdhsa_next_free_sgpr 102
  .amdhsa_accum_offset 256
  .amdhsa_group_segment_fixed_size 0
  .amdhsa_kernarg_size 128
  .amdhsa_user_sgpr_count 2
  .amdhsa_user_sgpr_kernarg_segment_ptr 1
  .amdhsa_system_sgpr_workgroup_id_x 1
  .amdhsa_float_denorm_mode_32 3
.end_amdhsa_kernel
```

```asm
; @launch grid=(256,1,1) block=(256,1,1) lds=163840
.amdgcn_target "amdgcn-amd-amdhsa--gfx950"
.text
.globl adaLN_cond__memory_aug_recurrent_mem_tr__glu_gated_swiglu__prompt_kernel
.p2align 8
.type adaLN_cond__memory_aug_recurrent_mem_tr__glu_gated_swiglu__prompt_kernel,@function
adaLN_cond__memory_aug_recurrent_mem_tr__glu_gated_swiglu__prompt_kernel:
s_cmp_ge_u32 s2, 256
s_cbranch_scc1 Lend_1
s_load_dwordx8 s[16:23], s[0:1], 8
s_load_dwordx2 s[24:25], s[0:1], 40
s_load_dwordx4 s[28:31], s[0:1], 112
s_getreg_b32 s51, hwreg(HW_REG_XCC_ID, 0, 4)
s_and_b32 s51, s51, 7
v_lshrrev_b32 v1, 6, v0
s_nop 0
v_readfirstlane_b32 s32, v1
v_and_b32 v1, 63, v0
s_waitcnt lgkmcnt(0)
s_mov_b32 s4, s30
s_and_b32 s5, s31, 0xffff
s_mov_b32 s6, 0x10000000
s_mov_b32 s7, 0x20000
s_mov_b32 s12, s28
s_and_b32 s13, s29, 0xffff
s_mov_b32 s14, 0x100
s_mov_b32 s15, 0x20000
s_mov_b32 s37, 200000
s_mov_b32 s80, 0
s_mov_b32 s81, 0
s_mov_b32 s82, 0
s_mov_b32 s83, 0
s_cmp_lg_u32 s32, 0
s_cbranch_scc1 Lrs_10
s_mov_b32 s33, s51
s_mov_b32 s35, 0
s_mov_b64 exec, 1
Lrl_9:
s_and_b32 s38, s33, 4
s_mul_i32 s38, s38, 7
s_add_u32 s38, s38, s33
v_lshlrev_b32 v2, 2, s38
v_mov_b32 v3, 1
buffer_atomic_add v3, v2, s[12:15], 0 offen sc0 sc1
s_waitcnt vmcnt(0)
v_readfirstlane_b32 s34, v3
s_nop 3
s_cmp_lt_u32 s34, 32
s_cbranch_scc1 Lrg_8
s_add_u32 s33, s33, 1
s_and_b32 s33, s33, 7
s_add_u32 s35, s35, 1
s_cmp_lt_u32 s35, 8
s_cbranch_scc1 Lrl_9
Lrg_8:
s_lshl_b32 s38, s33, 8
s_min_u32 s34, s34, 255
s_or_b32 s38, s38, s34
s_lshl_b32 s39, s35, 16
s_or_b32 s38, s38, s39
v_mov_b32 v3, s38
v_mov_b32 v2, 0
ds_write_b32 v2, v3
s_mov_b64 exec, -1
Lrs_10:
s_waitcnt lgkmcnt(0)
s_barrier
v_mov_b32 v2, 0
ds_read_b32 v3, v2
s_waitcnt lgkmcnt(0)
v_readfirstlane_b32 s38, v3
s_barrier
s_and_b32 s34, s38, 255
s_bfe_u32 s33, s38, 0x80008
s_lshr_b32 s35, s38, 16
s_min_u32 s35, s35, 1
s_cmp_ge_u32 s34, 32
s_cbranch_scc1 Lend_1
s_cmp_ge_u32 s33, 4
s_cselect_b32 s38, 16, 24
s_add_u32 s34, s34, s38
s_and_b32 s34, s34, 31
s_getpc_b64 s[40:41]
Lcode_here:
s_lshl_b32 s42, s34, 12
v_lshl_add_u32 v2, v0, 4, s42
v_min_u32 v2, Lcode_end-Lcode_here-16, v2
v_mov_b32 v3, s41
v_add_co_u32 v2, vcc, s40, v2
s_nop 1
v_addc_co_u32 v3, vcc, 0, v3, vcc
global_load_dword v255, v[2:3], off
s_cmp_ge_u32 s33, 4
s_cbranch_scc1 Lhi_4
s_cmp_ge_u32 s34, 24
s_cbranch_scc1 Lg3_3
s_cmp_ge_u32 s34, 8
s_cbranch_scc1 Lkvo_2
v_mov_b32 v48, v0
v_mov_b32 v50, v1
s_lshl_b32 s54, s33, 3
s_add_u32 s54, s54, s34
s_and_b32 s55, s32, 1
s_lshr_b32 s56, s32, 1
s_lshl_b32 s45, s33, 18
s_add_u32 s45, s45, 2097152
s_lshl_b32 s38, s32, 12
v_lshl_add_u32 v10, v50, 4, s38
s_lshl_b32 s38, s34, 11
s_add_u32 s39, s38, 16384
v_lshl_add_u32 v11, v50, 4, s39
s_lshl_b32 s39, s56, 10
s_add_u32 s38, s38, s39
s_lshl_b32 s39, s55, 9
s_add_u32 s39, s39, s38
s_add_u32 s39, s39, 32768
v_lshl_add_u32 v12, v50, 3, s39
v_xor_b32 v13, 512, v12
s_add_u32 s39, s39, 16384
v_mov_b32 v14, s39
v_bfe_u32 v51, v50, 5, 1
v_lshl_add_u32 v14, v51, 8, v14
v_bfe_u32 v51, v50, 1, 2
v_lshl_add_u32 v14, v51, 6, v14
v_bfe_u32 v51, v50, 4, 1
v_lshl_add_u32 v14, v51, 5, v14
v_bfe_u32 v51, v50, 0, 1
v_lshl_add_u32 v14, v51, 4, v14
v_bfe_u32 v51, v50, 3, 1
v_lshl_add_u32 v14, v51, 30, v14
v_bfe_u32 v15, v50, 1, 1
v_mul_u32_u24 v15, 0xaaaa, v15
v_add_u32 v15, 0x4444, v15
v_mov_b32 v200, 0
v_mov_b32 v201, 0
v_mov_b32 v202, 0
v_mov_b32 v203, 0
v_mov_b32 v204, 0
v_mov_b32 v205, 0
v_mov_b32 v206, 0
v_mov_b32 v207, 0
s_xor_b32 s38, s32, 3
s_mul_i32 s38, s38, 3072
s_add_u32 s38, s38, 0
v_lshl_add_u32 v211, v50, 4, s38
s_xor_b32 s38, s32, 2
s_mul_i32 s38, s38, 3072
s_add_u32 s38, s38, 1024
v_lshl_add_u32 v212, v50, 4, s38
s_xor_b32 s38, s32, 1
s_mul_i32 s38, s38, 3072
s_add_u32 s38, s38, 2048
v_lshl_add_u32 v213, v50, 4, s38
s_mul_i32 s38, s32, 3072
v_lshl_add_u32 v18, v50, 4, s38
s_lshl_b32 s38, s32, 9
v_and_b32 v51, 15, v50
v_lshl_add_u32 v19, v51, 4, s38
v_lshrrev_b32 v51, 4, v50
v_lshl_add_u32 v19, v51, 2, v19
v_lshrrev_b32 v51, 2, v50
v_and_b32 v52, 1, v50
v_lshlrev_b32 v52, 3, v52
v_lshl_add_u32 v20, v51, 4, v52
v_lshlrev_b32 v51, 4, v50
s_mul_i32 s38, s32, 6144
v_add_u32 v21, s38, v51
s_add_u32 s57, s38, 32768
v_add_u32 v22, 40960, v51
s_lshl_b32 s38, s55, 12
s_add_u32 s38, s38, 32768
v_add_u32 v23, s38, v51
s_lshl_b32 s38, s32, 11
s_add_u32 s38, s38, 49152
v_add_u32 v24, s38, v51
v_xor_b32 v25, 2048, v24
s_lshl_b32 s59, s33, 12
s_add_u32 s59, s59, 3276800
s_lshl_b32 s38, s32, 8
v_lshl_add_u32 v192, v50, 2, s38
s_lshr_b32 s38, s34, 1
s_lshl_b32 s38, s38, 8
s_and_b32 s39, s34, 1
s_lshl_b32 s39, s39, 2
s_add_u32 s38, s38, s39
s_add_u32 s38, s38, 2048
v_min_u32 v52, 1, v48
v_lshl_add_u32 v193, v52, 30, s38
v_mov_b32 v197, 0
buffer_store_dword v197, v193, s[4:7], s59 offen sc1
s_lshr_b32 s38, s34, 2
s_lshl_b32 s38, s38, 14
s_and_b32 s39, s34, 3
s_lshl_b32 s39, s39, 11
s_add_u32 s38, s38, s39
s_lshl_b32 s39, s33, 16
s_add_u32 s38, s38, s39
v_lshl_add_u32 v198, v48, 3, s38
s_lshl_b32 s38, s54, 2
s_add_u32 s38, s38, s32
s_lshl_b32 s38, s38, 11
s_lshl_b32 s39, s55, 10
s_add_u32 s38, s38, s39
v_add_u32 v26, s38, v51
v_xor_b32 v27, 2048, v26
s_lshl_b32 s38, s54, 5
s_add_u32 s38, s38, s32
s_lshl_b32 s38, s38, 2
s_add_u32 s38, s38, 3432448
v_min_u32 v52, 1, v50
v_lshl_add_u32 v199, v52, 30, s38
buffer_store_dword v197, v199, s[4:7], 0 offen sc1
v_min_u32 v53, 15, v50
v_lshlrev_b32 v53, 7, v53
s_lshr_b32 s38, s54, 2
s_lshl_b32 s38, s38, 10
s_add_u32 s38, s38, 3407872
v_add_u32 v208, s38, v53
s_lshl_b32 s38, s33, 10
s_add_u32 s38, s38, 3435520
v_add_u32 v53, s38, v53
v_cmp_lt_u32 vcc, 7, v50
s_nop 1
v_cndmask_b32 v208, v208, v53, vcc
v_cndmask_b32 v210, 0, 8, vcc
v_mov_b32 v28, -1
v_mov_b32 v32, 0x3f803f80
v_mov_b32 v29, -1
v_mov_b32 v33, 0x3f803f80
v_mov_b32 v30, -1
v_mov_b32 v34, 0x3f803f80
v_mov_b32 v31, -1
v_mov_b32 v35, 0x3f803f80
v_and_b32 v51, 15, v50
s_lshl_b32 s38, s55, 4
v_add_u32 v51, s38, v51
v_lshrrev_b32 v52, 4, v50
v_lshlrev_b32 v52, 2, v52
v_mov_b32 v54, 0xf149f2ca
v_add_u32 v53, 0, v52
v_cmp_gt_u32 vcc, v53, v51
s_nop 1
v_cndmask_b32 v36, 0, v54, vcc
v_add_u32 v53, 1, v52
v_cmp_gt_u32 vcc, v53, v51
s_nop 1
v_cndmask_b32 v37, 0, v54, vcc
v_add_u32 v53, 2, v52
v_cmp_gt_u32 vcc, v53, v51
s_nop 1
v_cndmask_b32 v38, 0, v54, vcc
v_add_u32 v53, 3, v52
v_cmp_gt_u32 vcc, v53, v51
s_nop 1
v_cndmask_b32 v39, 0, v54, vcc
v_add_u32 v53, 16, v52
v_cmp_gt_u32 vcc, v53, v51
s_nop 1
v_cndmask_b32 v40, 0, v54, vcc
v_add_u32 v53, 17, v52
v_cmp_gt_u32 vcc, v53, v51
s_nop 1
v_cndmask_b32 v41, 0, v54, vcc
v_add_u32 v53, 18, v52
v_cmp_gt_u32 vcc, v53, v51
s_nop 1
v_cndmask_b32 v42, 0, v54, vcc
v_add_u32 v53, 19, v52
v_cmp_gt_u32 vcc, v53, v51
s_nop 1
v_cndmask_b32 v43, 0, v54, vcc
v_mov_b32 v0, 0
v_mov_b32 v1, 0
v_mov_b32 v2, 0
v_mov_b32 v3, 0
v_mov_b32 v4, 0
v_mov_b32 v5, 0
v_mov_b32 v6, 0
v_mov_b32 v7, 0
v_mov_b32 v8, 0
v_mov_b32 v9, 0
s_mov_b32 s48, 0x3e0293ee
s_mov_b32 s49, 0xbe0293ee
s_add_u32 s38, s45, 0
buffer_store_dwordx4 v[28:31], v14, s[4:7], s38 offen sc1
s_add_u32 s38, s45, 65536
buffer_store_dwordx4 v[28:31], v14, s[4:7], s38 offen sc1
s_add_u32 s38, s45, 131072
buffer_store_dwordx4 v[28:31], v14, s[4:7], s38 offen sc1
s_add_u32 s38, s45, 196608
buffer_store_dwordx4 v[28:31], v14, s[4:7], s38 offen sc1
s_lshl_b32 s52, s35, 16
s_or_b32 s52, s52, 1
s_waitcnt vmcnt(0)
s_barrier
s_cmp_lg_u32 s32, 0
s_cbranch_scc1 Lar_11
s_mov_b64 exec, 1
v_mov_b32 v48, 32
v_mov_b32 v49, s52
buffer_atomic_add v49, v48, s[12:15], 0 offen sc1
s_mov_b64 exec, -1
Lar_11:
s_xor_b32 s52, s32, 3
s_lshl_b32 s52, s52, 6
v_and_b32 v54, 7, v50
v_lshlrev_b32 v54, 4, v54
v_xor_b32 v54, s52, v54
v_lshrrev_b32 v51, 3, v50
v_lshl_add_u32 v51, v51, 13, v54
s_xor_b32 s52, s32, 1
s_lshl_b32 s52, s52, 6
v_and_b32 v54, 7, v50
v_lshlrev_b32 v54, 4, v54
v_xor_b32 v54, s52, v54
v_lshrrev_b32 v52, 3, v50
v_lshl_add_u32 v52, v52, 13, v54
v_bfe_u32 v53, v50, 2, 2
v_lshrrev_b32 v54, 4, v50
v_lshl_add_u32 v53, v54, 3, v53
s_mul_i32 s38, s32, 40960
v_lshl_add_u32 v53, v53, 7, s38
v_bfe_u32 v54, v50, 0, 1
v_lshl_add_u32 v53, v54, 3, v53
v_bfe_u32 v54, v50, 1, 1
v_lshl_add_u32 v53, v54, 4, v53
s_mov_b32 s8, s18
s_and_b32 s9, s19, 0xffff
s_mov_b32 s10, 0x800000
s_mov_b32 s11, 0x20000
s_lshl_b32 s39, s32, 21
s_lshl_b32 s38, s54, 8
s_add_u32 s39, s39, s38
s_add_u32 s39, s39, 1572864
s_mul_i32 s38, s32, 40960
s_add_u32 m0, s38, 0
s_nop 0
buffer_load_dwordx4 v52, s[8:11], s39 offen lds
s_add_u32 m0, m0, 1024
s_add_u32 s39, s39, 65536
buffer_load_dwordx4 v52, s[8:11], s39 offen lds
s_add_u32 m0, m0, 1024
s_add_u32 s39, s39, 65536
buffer_load_dwordx4 v52, s[8:11], s39 offen lds
s_add_u32 m0, m0, 1024
s_add_u32 s39, s39, 65536
buffer_load_dwordx4 v52, s[8:11], s39 offen lds
s_add_u32 m0, m0, 1024
s_add_u32 s39, s39, 65536
buffer_load_dwordx4 v52, s[8:11], s39 offen lds
s_add_u32 m0, m0, 1024
s_add_u32 s39, s39, 65536
buffer_load_dwordx4 v52, s[8:11], s39 offen lds
s_add_u32 m0, m0, 1024
s_add_u32 s39, s39, 65536
buffer_load_dwordx4 v52, s[8:11], s39 offen lds
s_add_u32 m0, m0, 1024
s_add_u32 s39, s39, 65536
buffer_load_dwordx4 v52, s[8:11], s39 offen lds
s_lshl_b32 s39, s32, 21
s_lshl_b32 s38, s54, 8
s_add_u32 s39, s39, s38
s_add_u32 s39, s39, 1572864
s_mul_i32 s38, s32, 40960
s_add_u32 m0, s38, 8192
s_nop 0
buffer_load_dwordx4 v51, s[8:11], s39 offen lds
s_add_u32 m0, m0, 1024
s_add_u32 s39, s39, 65536
buffer_load_dwordx4 v51, s[8:11], s39 offen lds
s_add_u32 m0, m0, 1024
s_add_u32 s39, s39, 65536
buffer_load_dwordx4 v51, s[8:11], s39 offen lds
s_add_u32 m0, m0, 1024
s_add_u32 s39, s39, 65536
buffer_load_dwordx4 v51, s[8:11], s39 offen lds
s_add_u32 m0, m0, 1024
s_add_u32 s39, s39, 65536
buffer_load_dwordx4 v51, s[8:11], s39 offen lds
s_add_u32 m0, m0, 1024
s_add_u32 s39, s39, 65536
buffer_load_dwordx4 v51, s[8:11], s39 offen lds
s_add_u32 m0, m0, 1024
s_add_u32 s39, s39, 65536
buffer_load_dwordx4 v51, s[8:11], s39 offen lds
s_add_u32 m0, m0, 1024
s_add_u32 s39, s39, 65536
buffer_load_dwordx4 v51, s[8:11], s39 offen lds
s_lshl_b32 s39, s32, 21
s_lshl_b32 s38, s54, 8
s_add_u32 s39, s39, s38
s_add_u32 s39, s39, 1048576
s_mul_i32 s38, s32, 40960
s_add_u32 m0, s38, 16384
s_nop 0
buffer_load_dwordx4 v52, s[8:11], s39 offen lds
s_add_u32 m0, m0, 1024
s_add_u32 s39, s39, 65536
buffer_load_dwordx4 v52, s[8:11], s39 offen lds
s_add_u32 m0, m0, 1024
s_add_u32 s39, s39, 65536
buffer_load_dwordx4 v52, s[8:11], s39 offen lds
s_add_u32 m0, m0, 1024
s_add_u32 s39, s39, 65536
buffer_load_dwordx4 v52, s[8:11], s39 offen lds
s_add_u32 m0, m0, 1024
s_add_u32 s39, s39, 65536
buffer_load_dwordx4 v52, s[8:11], s39 offen lds
s_add_u32 m0, m0, 1024
s_add_u32 s39, s39, 65536
buffer_load_dwordx4 v52, s[8:11], s39 offen lds
s_add_u32 m0, m0, 1024
s_add_u32 s39, s39, 65536
buffer_load_dwordx4 v52, s[8:11], s39 offen lds
s_add_u32 m0, m0, 1024
s_add_u32 s39, s39, 65536
buffer_load_dwordx4 v52, s[8:11], s39 offen lds
s_lshl_b32 s39, s32, 21
s_lshl_b32 s38, s54, 8
s_add_u32 s39, s39, s38
s_add_u32 s39, s39, 1048576
s_mul_i32 s38, s32, 40960
s_add_u32 m0, s38, 24576
s_nop 0
buffer_load_dwordx4 v51, s[8:11], s39 offen lds
s_add_u32 m0, m0, 1024
s_add_u32 s39, s39, 65536
buffer_load_dwordx4 v51, s[8:11], s39 offen lds
s_add_u32 m0, m0, 1024
s_add_u32 s39, s39, 65536
buffer_load_dwordx4 v51, s[8:11], s39 offen lds
s_add_u32 m0, m0, 1024
s_add_u32 s39, s39, 65536
buffer_load_dwordx4 v51, s[8:11], s39 offen lds
s_add_u32 m0, m0, 1024
s_add_u32 s39, s39, 65536
buffer_load_dwordx4 v51, s[8:11], s39 offen lds
s_add_u32 m0, m0, 1024
s_add_u32 s39, s39, 65536
buffer_load_dwordx4 v51, s[8:11], s39 offen lds
s_add_u32 m0, m0, 1024
s_add_u32 s39, s39, 65536
buffer_load_dwordx4 v51, s[8:11], s39 offen lds
s_add_u32 m0, m0, 1024
s_add_u32 s39, s39, 65536
buffer_load_dwordx4 v51, s[8:11], s39 offen lds
s_lshl_b32 s39, s32, 21
s_lshl_b32 s38, s54, 8
s_add_u32 s39, s39, s38
s_add_u32 s39, s39, 524288
s_mul_i32 s38, s32, 40960
s_add_u32 m0, s38, 32768
s_nop 0
buffer_load_dwordx4 v52, s[8:11], s39 offen lds
s_add_u32 m0, m0, 1024
s_add_u32 s39, s39, 65536
buffer_load_dwordx4 v52, s[8:11], s39 offen lds
s_add_u32 m0, m0, 1024
s_add_u32 s39, s39, 65536
buffer_load_dwordx4 v52, s[8:11], s39 offen lds
s_add_u32 m0, m0, 1024
s_add_u32 s39, s39, 65536
buffer_load_dwordx4 v52, s[8:11], s39 offen lds
s_add_u32 m0, m0, 1024
s_add_u32 s39, s39, 65536
buffer_load_dwordx4 v52, s[8:11], s39 offen lds
s_add_u32 m0, m0, 1024
s_add_u32 s39, s39, 65536
buffer_load_dwordx4 v52, s[8:11], s39 offen lds
s_add_u32 m0, m0, 1024
s_add_u32 s39, s39, 65536
buffer_load_dwordx4 v52, s[8:11], s39 offen lds
s_add_u32 m0, m0, 1024
s_add_u32 s39, s39, 65536
buffer_load_dwordx4 v52, s[8:11], s39 offen lds
s_waitcnt vmcnt(32)
ds_read_b64_tr_b16 a[224:225], v53 offset:0
ds_read_b64_tr_b16 a[226:227], v53 offset:512
ds_read_b64_tr_b16 a[228:229], v53 offset:4096
ds_read_b64_tr_b16 a[230:231], v53 offset:4608
ds_read_b64_tr_b16 a[232:233], v53 offset:32
ds_read_b64_tr_b16 a[234:235], v53 offset:544
ds_read_b64_tr_b16 a[236:237], v53 offset:4128
ds_read_b64_tr_b16 a[238:239], v53 offset:4640
ds_read_b64_tr_b16 a[240:241], v53 offset:64
ds_read_b64_tr_b16 a[242:243], v53 offset:576
ds_read_b64_tr_b16 a[244:245], v53 offset:4160
ds_read_b64_tr_b16 a[246:247], v53 offset:4672
ds_read_b64_tr_b16 a[248:249], v53 offset:96
ds_read_b64_tr_b16 a[250:251], v53 offset:608
ds_read_b64_tr_b16 a[252:253], v53 offset:4192
ds_read_b64_tr_b16 a[254:255], v53 offset:4704
s_waitcnt lgkmcnt(0)
s_lshl_b32 s39, s32, 21
s_lshl_b32 s38, s54, 8
s_add_u32 s39, s39, s38
s_add_u32 s39, s39, 524288
s_mul_i32 s38, s32, 40960
s_add_u32 m0, s38, 0
s_nop 0
buffer_load_dwordx4 v51, s[8:11], s39 offen lds
s_add_u32 m0, m0, 1024
s_add_u32 s39, s39, 65536
buffer_load_dwordx4 v51, s[8:11], s39 offen lds
s_add_u32 m0, m0, 1024
s_add_u32 s39, s39, 65536
buffer_load_dwordx4 v51, s[8:11], s39 offen lds
s_add_u32 m0, m0, 1024
s_add_u32 s39, s39, 65536
buffer_load_dwordx4 v51, s[8:11], s39 offen lds
s_add_u32 m0, m0, 1024
s_add_u32 s39, s39, 65536
buffer_load_dwordx4 v51, s[8:11], s39 offen lds
s_add_u32 m0, m0, 1024
s_add_u32 s39, s39, 65536
buffer_load_dwordx4 v51, s[8:11], s39 offen lds
s_add_u32 m0, m0, 1024
s_add_u32 s39, s39, 65536
buffer_load_dwordx4 v51, s[8:11], s39 offen lds
s_add_u32 m0, m0, 1024
s_add_u32 s39, s39, 65536
buffer_load_dwordx4 v51, s[8:11], s39 offen lds
s_waitcnt vmcnt(32)
ds_read_b64_tr_b16 a[192:193], v53 offset:8192
ds_read_b64_tr_b16 a[194:195], v53 offset:8704
ds_read_b64_tr_b16 a[196:197], v53 offset:12288
ds_read_b64_tr_b16 a[198:199], v53 offset:12800
ds_read_b64_tr_b16 a[200:201], v53 offset:8224
ds_read_b64_tr_b16 a[202:203], v53 offset:8736
ds_read_b64_tr_b16 a[204:205], v53 offset:12320
ds_read_b64_tr_b16 a[206:207], v53 offset:12832
ds_read_b64_tr_b16 a[208:209], v53 offset:8256
ds_read_b64_tr_b16 a[210:211], v53 offset:8768
ds_read_b64_tr_b16 a[212:213], v53 offset:12352
ds_read_b64_tr_b16 a[214:215], v53 offset:12864
ds_read_b64_tr_b16 a[216:217], v53 offset:8288
ds_read_b64_tr_b16 a[218:219], v53 offset:8800
ds_read_b64_tr_b16 a[220:221], v53 offset:12384
ds_read_b64_tr_b16 a[222:223], v53 offset:12896
s_waitcnt lgkmcnt(0)
s_lshl_b32 s39, s32, 21
s_lshl_b32 s38, s54, 8
s_add_u32 s39, s39, s38
s_add_u32 s39, s39, 0
s_mul_i32 s38, s32, 40960
s_add_u32 m0, s38, 8192
s_nop 0
buffer_load_dwordx4 v52, s[8:11], s39 offen lds
s_add_u32 m0, m0, 1024
s_add_u32 s39, s39, 65536
buffer_load_dwordx4 v52, s[8:11], s39 offen lds
s_add_u32 m0, m0, 1024
s_add_u32 s39, s39, 65536
buffer_load_dwordx4 v52, s[8:11], s39 offen lds
s_add_u32 m0, m0, 1024
s_add_u32 s39, s39, 65536
buffer_load_dwordx4 v52, s[8:11], s39 offen lds
s_add_u32 m0, m0, 1024
s_add_u32 s39, s39, 65536
buffer_load_dwordx4 v52, s[8:11], s39 offen lds
s_add_u32 m0, m0, 1024
s_add_u32 s39, s39, 65536
buffer_load_dwordx4 v52, s[8:11], s39 offen lds
s_add_u32 m0, m0, 1024
s_add_u32 s39, s39, 65536
buffer_load_dwordx4 v52, s[8:11], s39 offen lds
s_add_u32 m0, m0, 1024
s_add_u32 s39, s39, 65536
buffer_load_dwordx4 v52, s[8:11], s39 offen lds
s_waitcnt vmcnt(32)
ds_read_b64_tr_b16 a[160:161], v53 offset:16384
ds_read_b64_tr_b16 a[162:163], v53 offset:16896
ds_read_b64_tr_b16 a[164:165], v53 offset:20480
ds_read_b64_tr_b16 a[166:167], v53 offset:20992
ds_read_b64_tr_b16 a[168:169], v53 offset:16416
ds_read_b64_tr_b16 a[170:171], v53 offset:16928
ds_read_b64_tr_b16 a[172:173], v53 offset:20512
ds_read_b64_tr_b16 a[174:175], v53 offset:21024
ds_read_b64_tr_b16 a[176:177], v53 offset:16448
ds_read_b64_tr_b16 a[178:179], v53 offset:16960
ds_read_b64_tr_b16 a[180:181], v53 offset:20544
ds_read_b64_tr_b16 a[182:183], v53 offset:21056
ds_read_b64_tr_b16 a[184:185], v53 offset:16480
ds_read_b64_tr_b16 a[186:187], v53 offset:16992
ds_read_b64_tr_b16 a[188:189], v53 offset:20576
ds_read_b64_tr_b16 a[190:191], v53 offset:21088
s_waitcnt lgkmcnt(0)
s_lshl_b32 s39, s32, 21
s_lshl_b32 s38, s54, 8
s_add_u32 s39, s39, s38
s_add_u32 s39, s39, 0
s_mul_i32 s38, s32, 40960
s_add_u32 m0, s38, 16384
s_nop 0
buffer_load_dwordx4 v51, s[8:11], s39 offen lds
s_add_u32 m0, m0, 1024
s_add_u32 s39, s39, 65536
buffer_load_dwordx4 v51, s[8:11], s39 offen lds
s_add_u32 m0, m0, 1024
s_add_u32 s39, s39, 65536
buffer_load_dwordx4 v51, s[8:11], s39 offen lds
s_add_u32 m0, m0, 1024
s_add_u32 s39, s39, 65536
buffer_load_dwordx4 v51, s[8:11], s39 offen lds
s_add_u32 m0, m0, 1024
s_add_u32 s39, s39, 65536
buffer_load_dwordx4 v51, s[8:11], s39 offen lds
s_add_u32 m0, m0, 1024
s_add_u32 s39, s39, 65536
buffer_load_dwordx4 v51, s[8:11], s39 offen lds
s_add_u32 m0, m0, 1024
s_add_u32 s39, s39, 65536
buffer_load_dwordx4 v51, s[8:11], s39 offen lds
s_add_u32 m0, m0, 1024
s_add_u32 s39, s39, 65536
buffer_load_dwordx4 v51, s[8:11], s39 offen lds
s_waitcnt vmcnt(32)
ds_read_b64_tr_b16 a[128:129], v53 offset:24576
ds_read_b64_tr_b16 a[130:131], v53 offset:25088
ds_read_b64_tr_b16 a[132:133], v53 offset:28672
ds_read_b64_tr_b16 a[134:135], v53 offset:29184
ds_read_b64_tr_b16 a[136:137], v53 offset:24608
ds_read_b64_tr_b16 a[138:139], v53 offset:25120
ds_read_b64_tr_b16 a[140:141], v53 offset:28704
ds_read_b64_tr_b16 a[142:143], v53 offset:29216
ds_read_b64_tr_b16 a[144:145], v53 offset:24640
ds_read_b64_tr_b16 a[146:147], v53 offset:25152
ds_read_b64_tr_b16 a[148:149], v53 offset:28736
ds_read_b64_tr_b16 a[150:151], v53 offset:29248
ds_read_b64_tr_b16 a[152:153], v53 offset:24672
ds_read_b64_tr_b16 a[154:155], v53 offset:25184
ds_read_b64_tr_b16 a[156:157], v53 offset:28768
ds_read_b64_tr_b16 a[158:159], v53 offset:29280
s_waitcnt lgkmcnt(0)
s_waitcnt vmcnt(24)
ds_read_b64_tr_b16 a[96:97], v53 offset:32768
ds_read_b64_tr_b16 a[98:99], v53 offset:33280
ds_read_b64_tr_b16 a[100:101], v53 offset:36864
ds_read_b64_tr_b16 a[102:103], v53 offset:37376
ds_read_b64_tr_b16 a[104:105], v53 offset:32800
ds_read_b64_tr_b16 a[106:107], v53 offset:33312
ds_read_b64_tr_b16 a[108:109], v53 offset:36896
ds_read_b64_tr_b16 a[110:111], v53 offset:37408
ds_read_b64_tr_b16 a[112:113], v53 offset:32832
ds_read_b64_tr_b16 a[114:115], v53 offset:33344
ds_read_b64_tr_b16 a[116:117], v53 offset:36928
ds_read_b64_tr_b16 a[118:119], v53 offset:37440
ds_read_b64_tr_b16 a[120:121], v53 offset:32864
ds_read_b64_tr_b16 a[122:123], v53 offset:33376
ds_read_b64_tr_b16 a[124:125], v53 offset:36960
ds_read_b64_tr_b16 a[126:127], v53 offset:37472
s_waitcnt lgkmcnt(0)
s_waitcnt vmcnt(16)
ds_read_b64_tr_b16 a[64:65], v53 offset:0
ds_read_b64_tr_b16 a[66:67], v53 offset:512
ds_read_b64_tr_b16 a[68:69], v53 offset:4096
ds_read_b64_tr_b16 a[70:71], v53 offset:4608
ds_read_b64_tr_b16 a[72:73], v53 offset:32
ds_read_b64_tr_b16 a[74:75], v53 offset:544
ds_read_b64_tr_b16 a[76:77], v53 offset:4128
ds_read_b64_tr_b16 a[78:79], v53 offset:4640
ds_read_b64_tr_b16 a[80:81], v53 offset:64
ds_read_b64_tr_b16 a[82:83], v53 offset:576
ds_read_b64_tr_b16 a[84:85], v53 offset:4160
ds_read_b64_tr_b16 a[86:87], v53 offset:4672
ds_read_b64_tr_b16 a[88:89], v53 offset:96
ds_read_b64_tr_b16 a[90:91], v53 offset:608
ds_read_b64_tr_b16 a[92:93], v53 offset:4192
ds_read_b64_tr_b16 a[94:95], v53 offset:4704
s_waitcnt lgkmcnt(0)
s_waitcnt vmcnt(8)
ds_read_b64_tr_b16 a[32:33], v53 offset:8192
ds_read_b64_tr_b16 a[34:35], v53 offset:8704
ds_read_b64_tr_b16 a[36:37], v53 offset:12288
ds_read_b64_tr_b16 a[38:39], v53 offset:12800
ds_read_b64_tr_b16 a[40:41], v53 offset:8224
ds_read_b64_tr_b16 a[42:43], v53 offset:8736
ds_read_b64_tr_b16 a[44:45], v53 offset:12320
ds_read_b64_tr_b16 a[46:47], v53 offset:12832
ds_read_b64_tr_b16 a[48:49], v53 offset:8256
ds_read_b64_tr_b16 a[50:51], v53 offset:8768
ds_read_b64_tr_b16 a[52:53], v53 offset:12352
ds_read_b64_tr_b16 a[54:55], v53 offset:12864
ds_read_b64_tr_b16 a[56:57], v53 offset:8288
ds_read_b64_tr_b16 a[58:59], v53 offset:8800
ds_read_b64_tr_b16 a[60:61], v53 offset:12384
ds_read_b64_tr_b16 a[62:63], v53 offset:12896
s_waitcnt lgkmcnt(0)
s_waitcnt vmcnt(0)
ds_read_b64_tr_b16 a[0:1], v53 offset:16384
ds_read_b64_tr_b16 a[2:3], v53 offset:16896
ds_read_b64_tr_b16 a[4:5], v53 offset:20480
ds_read_b64_tr_b16 a[6:7], v53 offset:20992
ds_read_b64_tr_b16 a[8:9], v53 offset:16416
ds_read_b64_tr_b16 a[10:11], v53 offset:16928
ds_read_b64_tr_b16 a[12:13], v53 offset:20512
ds_read_b64_tr_b16 a[14:15], v53 offset:21024
ds_read_b64_tr_b16 a[16:17], v53 offset:16448
ds_read_b64_tr_b16 a[18:19], v53 offset:16960
ds_read_b64_tr_b16 a[20:21], v53 offset:20544
ds_read_b64_tr_b16 a[22:23], v53 offset:21056
ds_read_b64_tr_b16 a[24:25], v53 offset:16480
ds_read_b64_tr_b16 a[26:27], v53 offset:16992
ds_read_b64_tr_b16 a[28:29], v53 offset:20576
ds_read_b64_tr_b16 a[30:31], v53 offset:21088
s_waitcnt lgkmcnt(0)
s_cmp_lg_u32 s54, 0
s_cbranch_scc1 Lnp_12
s_barrier
s_mov_b32 s52, 0x2000000
s_cmp_lg_u32 s32, 0
s_cbranch_scc1 Lpb_13
v_lshlrev_b32 v52, 8, v50
v_mov_b32 v53, -1
s_mov_b32 s53, 32768
buffer_store_dword v53, v52, s[4:7], s53 offen sc1
s_waitcnt vmcnt(0)
s_mov_b64 exec, 1
s_mov_b32 s60, -1
s_mov_b32 s61, -1
v_mov_b32 v52, 0
s_mov_b32 s66, 5
Lpl_14:
s_memtime s[62:63]
s_waitcnt lgkmcnt(0)
buffer_load_dword v53, v52, s[4:7], s53 offen sc1
s_waitcnt vmcnt(0)
s_memtime s[64:65]
s_waitcnt lgkmcnt(0)
s_sub_u32 s62, s64, s62
s_min_u32 s60, s60, s62
v_add_u32 v52, 8192, v52
s_memtime s[62:63]
s_waitcnt lgkmcnt(0)
buffer_load_dword v53, v52, s[4:7], s53 offen sc1
s_waitcnt vmcnt(0)
s_memtime s[64:65]
s_waitcnt lgkmcnt(0)
s_sub_u32 s62, s64, s62
s_min_u32 s61, s61, s62
v_add_u32 v52, -6912, v52
s_sub_u32 s66, s66, 1
s_cmp_lg_u32 s66, 0
s_cbranch_scc1 Lpl_14
s_mov_b64 exec, -1
s_cmp_lt_u32 s61, s60
s_cselect_b32 s62, 1, 0
s_lshr_b32 s63, s51, 2
s_xor_b32 s62, s62, s63
s_lshl_b32 s62, s62, 24
s_or_b32 s52, s52, s62
Lpb_13:
s_waitcnt vmcnt(0)
s_barrier
s_cmp_lg_u32 s32, 0
s_cbranch_scc1 Lar_15
s_mov_b64 exec, 1
v_mov_b32 v48, 32
v_mov_b32 v49, s52
buffer_atomic_add v49, v48, s[12:15], 0 offen sc1
s_mov_b64 exec, -1
Lar_15:
Lnp_12:
Lst_16:
buffer_load_dword v48, off, s[12:15], 0 offset:32 sc1
buffer_load_dword v49, off, s[12:15], 0 offset:160 sc1
s_waitcnt vmcnt(0)
v_add_u32 v48, v48, v49
s_nop 0
v_readfirstlane_b32 s38, v48
s_nop 3
s_and_b32 s39, s38, 0xffff
s_cmp_eq_u32 s39, 0x100
s_cbranch_scc1 Lso_17
s_sub_u32 s37, s37, 1
s_cbranch_scc1 Lend_1
s_sleep 8
s_branch Lst_16
Lso_17:
s_bfe_u32 s35, s38, 0x80010
s_bfe_u32 s46, s38, 0x10018
s_lshl_b32 s46, s46, 13
s_barrier
s_lshl_b32 s38, s34, 15
s_add_u32 s38, s38, s45
s_add_u32 s39, s38, 16384
buffer_load_dwordx4 v[64:67], v10, s[4:7], s38 offen offset:0 sc1
buffer_load_dwordx4 v[68:71], v10, s[4:7], s38 offen offset:1024 sc1
buffer_load_dwordx4 v[72:75], v10, s[4:7], s38 offen offset:2048 sc1
buffer_load_dwordx4 v[76:79], v10, s[4:7], s38 offen offset:3072 sc1
buffer_load_dwordx4 v[80:83], v10, s[4:7], s39 offen offset:0 sc1
buffer_load_dwordx4 v[84:87], v10, s[4:7], s39 offen offset:1024 sc1
buffer_load_dwordx4 v[88:91], v10, s[4:7], s39 offen offset:2048 sc1
buffer_load_dwordx4 v[92:95], v10, s[4:7], s39 offen offset:3072 sc1
Lst_18:
buffer_load_dword v48, off, s[12:15], 0 offset:32 sc1
buffer_load_dword v49, off, s[12:15], 0 offset:160 sc1
s_waitcnt vmcnt(0)
v_add_u32 v48, v48, v49
s_nop 0
v_readfirstlane_b32 s38, v48
s_nop 3
s_and_b32 s39, s38, 0x200ffff
s_cmp_eq_u32 s39, 0x2000100
s_cbranch_scc1 Lso_19
s_sub_u32 s37, s37, 1
s_cbranch_scc1 Lend_1
s_sleep 8
s_branch Lst_18
Lso_19:
s_bfe_u32 s35, s38, 0x80010
s_bfe_u32 s46, s38, 0x10018
s_lshl_b32 s46, s46, 13
s_barrier
s_mul_i32 s47, s54, 24576
s_add_u32 s47, s47, 33554432
s_mov_b32 s36, 0
s_mov_b32 s27, 1
Lbw_20:
buffer_load_dword v209, v208, s[4:7], 0 offen sc1
s_waitcnt vmcnt(0)
v_add_u32 v44, v209, v210
v_cmp_gt_u32 vcc, s27, v44
s_cbranch_vccz Lbo_21
s_sub_u32 s37, s37, 1
s_cbranch_scc1 Lend_1
s_sleep 2
s_branch Lbw_20
Lbo_21:
s_mov_b32 m0, s57
s_add_u32 s52, s47, 3072
buffer_load_dwordx4 v21, s[4:7], s47 offen offset:0 sc1 lds
buffer_load_dwordx4 v21, s[4:7], s47 offen offset:1024 sc1 lds
buffer_load_dwordx4 v21, s[4:7], s47 offen offset:2048 sc1 lds
s_add_u32 m0, s57, 3072
s_xor_b32 s57, s57, 98304
buffer_load_dwordx4 v21, s[4:7], s52 offen offset:0 sc1 lds
buffer_load_dwordx4 v21, s[4:7], s52 offen offset:1024 sc1 lds
buffer_load_dwordx4 v21, s[4:7], s52 offen offset:2048 sc1 lds
s_add_u32 s47, s47, 786432
s_cmp_lg_u32 s35, 0
s_cbranch_scc1 Lq_sc1_22
Lq_23:
s_cmp_gt_u32 s36, 7
s_cbranch_scc1 Lqf_24
s_waitcnt vmcnt(0)
s_barrier
Lqf_24:
ds_read_b128 v[128:131], v22 offset:0
ds_read_b128 v[132:135], v22 offset:1024
ds_read_b128 v[136:139], v22 offset:2048
ds_read_b128 v[140:143], v22 offset:3072
ds_read_b128 v[144:147], v22 offset:4096
ds_read_b128 v[148:151], v22 offset:5120
ds_read_b128 v[152:155], v22 offset:6144
ds_read_b128 v[156:159], v22 offset:7168
ds_read_b128 v[160:163], v24 offset:0
ds_read_b128 v[164:167], v24 offset:1024
ds_read_b128 v[168:171], v25 offset:0
ds_read_b128 v[172:175], v25 offset:1024
ds_read_b128 v[176:179], v23 offset:0
ds_read_b128 v[180:183], v23 offset:1024
ds_read_b128 v[184:187], v23 offset:2048
ds_read_b128 v[188:191], v23 offset:3072
v_xor_b32 v22, 98304, v22
v_xor_b32 v24, 98304, v24
v_xor_b32 v25, 98304, v25
v_xor_b32 v23, 98304, v23
s_and_b32 s38, s36, 3
s_lshl_b32 s39, s38, 16
s_add_u32 s40, s39, s45
s_xor_b32 s42, s40, 0x20000
s_add_u32 s26, s36, 1
v_pk_mul_f32 v[64:65], 0, 0
v_pk_mul_f32 v[66:67], 0, 0
v_pk_mul_f32 v[68:69], 0, 0
v_pk_mul_f32 v[70:71], 0, 0
v_pk_mul_f32 v[72:73], 0, 0
v_pk_mul_f32 v[74:75], 0, 0
v_pk_mul_f32 v[76:77], 0, 0
v_pk_mul_f32 v[78:79], 0, 0
v_pk_mul_f32 v[80:81], 0, 0
v_pk_mul_f32 v[82:83], 0, 0
v_pk_mul_f32 v[84:85], 0, 0
v_pk_mul_f32 v[86:87], 0, 0
v_pk_mul_f32 v[88:89], 0, 0
v_pk_mul_f32 v[90:91], 0, 0
v_pk_mul_f32 v[92:93], 0, 0
v_pk_mul_f32 v[94:95], 0, 0
s_waitcnt vmcnt(0)
buffer_store_dword v197, v199, s[4:7], 0 offen
v_add_u32 v197, 1, v197
s_mov_b64 exec, 15
buffer_load_dword v216, v192, s[4:7], s59 offen sc1
s_nop 5
buffer_load_dword v217, v192, s[4:7], s59 offen sc1
s_nop 5
buffer_load_dword v218, v192, s[4:7], s59 offen sc1
s_nop 5
buffer_load_dword v219, v192, s[4:7], s59 offen sc1
Lft_26:
s_waitcnt vmcnt(3)
v_cmp_gt_u32 vcc, s26, v216
buffer_load_dword v216, v192, s[4:7], s59 offen sc1
s_cbranch_vccz Lfg_25
s_waitcnt vmcnt(3)
v_cmp_gt_u32 vcc, s26, v217
buffer_load_dword v217, v192, s[4:7], s59 offen sc1
s_cbranch_vccz Lfg_25
s_waitcnt vmcnt(3)
v_cmp_gt_u32 vcc, s26, v218
buffer_load_dword v218, v192, s[4:7], s59 offen sc1
s_cbranch_vccz Lfg_25
s_waitcnt vmcnt(3)
v_cmp_gt_u32 vcc, s26, v219
buffer_load_dword v219, v192, s[4:7], s59 offen sc1
s_cbranch_vccz Lfg_25
s_sub_u32 s37, s37, 1
s_cbranch_scc1 Lend_1
s_branch Lft_26
Lfg_25:
s_mov_b64 exec, -1
buffer_load_dwordx4 v[48:51], v10, s[4:7], s40 offen offset:0 sc1
v_mfma_f32_16x16x32_bf16 v[200:203], v[204:207], v[204:207], 0
v_mfma_f32_16x16x32_bf16 v[200:203], v[204:207], v[204:207], 0
v_mfma_f32_16x16x32_bf16 v[200:203], v[204:207], v[204:207], 0
buffer_load_dwordx4 v[52:55], v10, s[4:7], s40 offen offset:1024 sc1
v_mfma_f32_16x16x32_bf16 v[200:203], v[204:207], v[204:207], 0
v_mfma_f32_16x16x32_bf16 v[200:203], v[204:207], v[204:207], 0
v_mfma_f32_16x16x32_bf16 v[200:203], v[204:207], v[204:207], 0
buffer_load_dwordx4 v[56:59], v10, s[4:7], s40 offen offset:2048 sc1
v_mfma_f32_16x16x32_bf16 v[200:203], v[204:207], v[204:207], 0
v_mfma_f32_16x16x32_bf16 v[200:203], v[204:207], v[204:207], 0
v_mfma_f32_16x16x32_bf16 v[200:203], v[204:207], v[204:207], 0
buffer_load_dwordx4 v[60:63], v10, s[4:7], s40 offen offset:3072 sc1
v_mfma_f32_16x16x32_bf16 v[200:203], v[204:207], v[204:207], 0
s_waitcnt vmcnt(3)
v_max3_u32 v44, v48, v49, v50
v_max_u32 v44, v44, v51
v_cmp_eq_u32 vcc, -1, v44
s_cbranch_vccnz Lpf_28
v_smfmac_f32_16x16x64_bf16 v[64:67], v[48:51], a[0:7], v15
v_smfmac_f32_16x16x64_bf16 v[68:71], v[48:51], a[8:15], v15
v_smfmac_f32_16x16x64_bf16 v[72:75], v[48:51], a[16:23], v15
s_waitcnt vmcnt(2)
v_max3_u32 v44, v52, v53, v54
v_max_u32 v44, v44, v55
v_cmp_eq_u32 vcc, -1, v44
v_smfmac_f32_16x16x64_bf16 v[76:79], v[48:51], a[24:31], v15
v_smfmac_f32_16x16x64_bf16 v[80:83], v[48:51], a[32:39], v15
v_smfmac_f32_16x16x64_bf16 v[84:87], v[48:51], a[40:47], v15
s_cbranch_vccnz Lpf_29
v_smfmac_f32_16x16x64_bf16 v[64:67], v[52:55], a[64:71], v15
v_smfmac_f32_16x16x64_bf16 v[68:71], v[52:55], a[72:79], v15
v_smfmac_f32_16x16x64_bf16 v[72:75], v[52:55], a[80:87], v15
s_waitcnt vmcnt(0)
v_max3_u32 v44, v56, v57, v58
v_max3_u32 v44, v44, v59, v60
v_max3_u32 v44, v44, v61, v62
v_max_u32 v44, v44, v63
v_cmp_eq_u32 vcc, -1, v44
v_smfmac_f32_16x16x64_bf16 v[76:79], v[52:55], a[88:95], v15
v_smfmac_f32_16x16x64_bf16 v[80:83], v[52:55], a[96:103], v15
v_smfmac_f32_16x16x64_bf16 v[84:87], v[52:55], a[104:111], v15
s_cbranch_vccnz Lpj_30
v_smfmac_f32_16x16x64_bf16 v[64:67], v[56:59], a[128:135], v15
s_nop 1
v_smfmac_f32_16x16x64_bf16 v[64:67], v[60:63], a[192:199], v15
s_nop 1
v_smfmac_f32_16x16x64_bf16 v[68:71], v[56:59], a[136:143], v15
s_nop 1
v_smfmac_f32_16x16x64_bf16 v[68:71], v[60:63], a[200:207], v15
s_nop 1
v_smfmac_f32_16x16x64_bf16 v[72:75], v[56:59], a[144:151], v15
v_add_f32 v96, v64, v66
v_add_f32 v97, v65, v67
v_smfmac_f32_16x16x64_bf16 v[72:75], v[60:63], a[208:215], v15
s_nop 1
v_smfmac_f32_16x16x64_bf16 v[76:79], v[56:59], a[152:159], v15
v_add_f32 v98, v68, v70
v_add_f32 v99, v69, v71
v_smfmac_f32_16x16x64_bf16 v[76:79], v[60:63], a[216:223], v15
ds_write_b128 v211, v[96:99] offset:0
s_nop 0
v_smfmac_f32_16x16x64_bf16 v[80:83], v[56:59], a[160:167], v15
v_add_f32 v100, v72, v74
v_add_f32 v101, v73, v75
v_smfmac_f32_16x16x64_bf16 v[80:83], v[60:63], a[224:231], v15
s_nop 1
v_smfmac_f32_16x16x64_bf16 v[84:87], v[56:59], a[168:175], v15
v_add_f32 v102, v76, v78
v_add_f32 v103, v77, v79
v_smfmac_f32_16x16x64_bf16 v[84:87], v[60:63], a[232:239], v15
ds_write_b128 v212, v[100:103] offset:0
s_nop 0
v_smfmac_f32_16x16x64_bf16 v[88:91], v[48:51], a[48:55], v15
v_add_f32 v104, v80, v82
v_add_f32 v105, v81, v83
v_smfmac_f32_16x16x64_bf16 v[88:91], v[52:55], a[112:119], v15
s_nop 1
v_add_f32 v106, v84, v86
v_add_f32 v107, v85, v87
ds_write_b128 v213, v[104:107] offset:0
Lpd_27:
v_smfmac_f32_16x16x64_bf16 v[88:91], v[56:59], a[176:183], v15
v_smfmac_f32_16x16x64_bf16 v[88:91], v[60:63], a[240:247], v15
v_smfmac_f32_16x16x64_bf16 v[92:95], v[48:51], a[56:63], v15
v_smfmac_f32_16x16x64_bf16 v[92:95], v[52:55], a[120:127], v15
s_waitcnt lgkmcnt(0)
s_barrier
ds_read_b128 v[76:79], v18 offset:0
ds_read_b128 v[80:83], v18 offset:1024
ds_read_b128 v[84:87], v18 offset:2048
v_smfmac_f32_16x16x64_bf16 v[92:95], v[56:59], a[184:191], v15
v_smfmac_f32_16x16x64_bf16 v[92:95], v[60:63], a[248:255], v15
v_mov_b32 v72, 0
v_mov_b32 v73, 0
v_mov_b32 v74, 0
v_mov_b32 v75, 0
v_add_f32 v108, v88, v90
v_add_f32 v109, v89, v91
s_nop 1
v_add_f32 v110, v92, v94
v_add_f32 v111, v93, v95
s_waitcnt lgkmcnt(0)
v_pk_add_f32 v[76:77], v[76:77], v[108:109]
v_pk_add_f32 v[80:81], v[80:81], v[84:85]
v_pk_add_f32 v[78:79], v[78:79], v[110:111]
v_pk_add_f32 v[82:83], v[82:83], v[86:87]
v_pk_add_f32 v[76:77], v[76:77], v[80:81]
v_pk_add_f32 v[78:79], v[78:79], v[82:83]
v_cvt_pk_bf16_f32 v76, v76, v77
v_cvt_pk_bf16_f32 v77, v78, v79
ds_write2st64_b32 v19, v76, v77 offset0:48 offset1:49
buffer_load_dwordx4 v[112:115], v11, s[4:7], s40 offen offset:0 sc1
buffer_load_dwordx4 v[116:119], v11, s[4:7], s40 offen offset:1024 sc1
s_waitcnt lgkmcnt(0)
s_barrier
ds_read_b64_tr_b16 v[96:97], v20 offset:12288
ds_read_b64_tr_b16 v[98:99], v20 offset:12544
ds_read_b64_tr_b16 v[100:101], v20 offset:12800
ds_read_b64_tr_b16 v[102:103], v20 offset:13056
ds_read_b64_tr_b16 v[104:105], v20 offset:13312
ds_read_b64_tr_b16 v[106:107], v20 offset:13568
ds_read_b64_tr_b16 v[108:109], v20 offset:13824
ds_read_b64_tr_b16 v[110:111], v20 offset:14080
s_waitcnt lgkmcnt(6)
v_mfma_f32_16x16x32_bf16 v[64:67], v[128:131], v[96:99], 0
v_mfma_f32_16x16x32_bf16 v[68:71], v[144:147], v[96:99], 0
s_waitcnt lgkmcnt(4)
buffer_load_dwordx4 v[48:51], v11, s[4:7], s40 offen offset:0 sc1
v_mfma_f32_16x16x32_bf16 v[64:67], v[132:135], v[100:103], v[64:67]
v_mfma_f32_16x16x32_bf16 v[68:71], v[148:151], v[100:103], v[68:71]
s_waitcnt lgkmcnt(2)
buffer_load_dwordx4 v[52:55], v11, s[4:7], s40 offen offset:1024 sc1
v_mfma_f32_16x16x32_bf16 v[64:67], v[136:139], v[104:107], v[64:67]
v_mfma_f32_16x16x32_bf16 v[68:71], v[152:155], v[104:107], v[68:71]
s_waitcnt lgkmcnt(0)
s_waitcnt vmcnt(2)
v_max3_u32 v44, v112, v113, v114
v_max3_u32 v44, v44, v115, v116
v_max3_u32 v44, v44, v117, v118
v_max_u32 v44, v44, v119
v_cmp_eq_u32 vcc, -1, v44
v_mfma_f32_16x16x32_bf16 v[64:67], v[140:143], v[108:111], v[64:67]
v_mfma_f32_16x16x32_bf16 v[68:71], v[156:159], v[108:111], v[68:71]
s_cbranch_vccnz Lkr_31
v_smfmac_f32_16x16x64_bf16 v[72:75], v[112:115], v[96:103], v15
v_smfmac_f32_16x16x64_bf16 v[72:75], v[116:119], v[104:111], v15
Lko_32:
s_nop 3
v_max3_f32 v45, v64, v65, v66
v_max3_f32 v45, v45, v67, v68
v_max3_f32 v45, v45, v69, v70
v_max_f32 v45, v45, v71
v_pk_add_f32 v[72:73], v[72:73], v[74:75]
v_max3_f32 v46, v45, v72, v73
v_max3_f32 v47, v45, v72, v73
buffer_load_dwordx2 v[120:121], v12, s[4:7], s40 offen sc1
buffer_load_dwordx2 v[122:123], v13, s[4:7], s40 offen sc1
v_permlane32_swap_b32 v46, v47
v_max_f32 v45, v46, v47
v_max_f32 v46, v46, v47
s_nop 1
v_permlane16_swap_b32 v45, v46
v_max_f32 v45, v45, v46
v_mul_f32 v46, s49, v45
v_pk_fma_f32 v[64:65], v[64:65], s[48:49], v[46:47] op_sel_hi:[1,0,0]
v_pk_fma_f32 v[66:67], v[66:67], s[48:49], v[46:47] op_sel_hi:[1,0,0]
v_pk_fma_f32 v[68:69], v[68:69], s[48:49], v[46:47] op_sel_hi:[1,0,0]
v_pk_fma_f32 v[70:71], v[70:71], s[48:49], v[46:47] op_sel_hi:[1,0,0]
v_pk_fma_f32 v[72:73], v[72:73], s[48:49], v[46:47] op_sel_hi:[1,0,0]
v_exp_f32 v64, v64
v_exp_f32 v65, v65
v_exp_f32 v66, v66
v_exp_f32 v67, v67
v_exp_f32 v68, v68
buffer_store_dword v197, v193, s[4:7], s59 offen
v_exp_f32 v69, v69
v_exp_f32 v70, v70
v_exp_f32 v71, v71
v_exp_f32 v72, v72
v_exp_f32 v73, v73
v_cvt_pk_bf16_f32 v76, v64, v65
v_cvt_pk_bf16_f32 v77, v66, v67
v_cvt_pk_bf16_f32 v78, v68, v69
v_cvt_pk_bf16_f32 v79, v70, v71
v_cvt_pk_bf16_f32 v2, v72, v73
v_cvt_pk_bf16_f32 v7, v72, v73
v_mfma_f32_16x16x32_bf16 v[84:87], v[32:35], v[76:79], 0
v_mfma_f32_16x16x32_bf16 v[84:87], v[32:35], v[2:5], v[84:87]
v_mfma_f32_16x16x32_bf16 v[96:99], v[160:163], v[76:79], 0
s_waitcnt vmcnt(1)
v_max3_u32 v44, v120, v121, v122
v_max_u32 v44, v44, v123
v_cmp_eq_u32 vcc, -1, v44
v_mfma_f32_16x16x32_bf16 v[100:103], v[164:167], v[76:79], 0
s_cbranch_vccnz Lvr_33
Lvo_34:
v_mfma_f32_16x16x32_bf16 v[96:99], v[120:123], v[2:5], v[96:99]
v_mfma_f32_16x16x32_bf16 v[100:103], v[120:123], v[6:9], v[100:103]
v_rcp_f32 v46, v84
s_nop 5
v_pk_mul_f32 v[96:97], v[96:97], v[46:47] op_sel_hi:[1,0]
v_pk_mul_f32 v[98:99], v[98:99], v[46:47] op_sel_hi:[1,0]
v_pk_mul_f32 v[100:101], v[100:101], v[46:47] op_sel_hi:[1,0]
v_pk_mul_f32 v[102:103], v[102:103], v[46:47] op_sel_hi:[1,0]
v_cvt_pk_bf16_f32 v124, v96, v97
v_cvt_pk_bf16_f32 v125, v98, v99
v_cvt_pk_bf16_f32 v126, v100, v101
v_cvt_pk_bf16_f32 v127, v102, v103
buffer_store_dwordx4 v[124:127], v14, s[4:7], s40 offen
s_barrier
buffer_store_dwordx4 v[28:31], v14, s[4:7], s42 offen
s_cmp_eq_u32 s36, 6
s_cbranch_scc1 Lp2_37
Lp1_38:
s_add_u32 s27, s27, 1
s_min_u32 s27, s27, 64
v_add_u32 v44, v209, v210
v_cmp_gt_u32 vcc, s27, v44
v_mov_b32 v72, 0
v_mov_b32 v73, 0
v_mov_b32 v74, 0
v_mov_b32 v75, 0
s_add_u32 s38, s36, 2
s_and_b32 s38, s38, 3
s_lshl_b32 s88, s38, 18
s_add_u32 s88, s88, s46
s_add_u32 s89, s88, 0x100000
s_cmp_lt_u32 s36, 62
s_cselect_b32 s53, s47, 0x70000000
s_cbranch_vccnz Lpw_35
Lpk_36:
buffer_store_dwordx2 v[28:29], v198, s[4:7], s88 offen sc1
buffer_store_dwordx2 v[28:29], v198, s[4:7], s89 offen sc1
v_mfma_f32_16x16x32_bf16 v[64:67], v[128:131], v[176:179], v[36:39]
v_mfma_f32_16x16x32_bf16 v[68:71], v[144:147], v[176:179], v[40:43]
s_mov_b32 m0, s57
s_add_u32 s52, s53, 3072
buffer_load_dwordx4 v21, s[4:7], s53 offen offset:0 sc1 lds
v_mfma_f32_16x16x32_bf16 v[64:67], v[132:135], v[180:183], v[64:67]
v_mfma_f32_16x16x32_bf16 v[68:71], v[148:151], v[180:183], v[68:71]
v_mfma_f32_16x16x32_bf16 v[64:67], v[136:139], v[184:187], v[64:67]
v_mfma_f32_16x16x32_bf16 v[68:71], v[152:155], v[184:187], v[68:71]
buffer_load_dwordx4 v21, s[4:7], s53 offen offset:1024 sc1 lds
v_mfma_f32_16x16x32_bf16 v[64:67], v[140:143], v[188:191], v[64:67]
v_mfma_f32_16x16x32_bf16 v[68:71], v[156:159], v[188:191], v[68:71]
v_smfmac_f32_16x16x64_bf16 v[72:75], v[112:115], v[176:183], v15
v_smfmac_f32_16x16x64_bf16 v[72:75], v[116:119], v[184:191], v15
s_and_b32 s38, s36, 7
s_lshl_b32 s38, s38, 18
s_add_u32 s50, s38, 83886080
buffer_load_dwordx4 v21, s[4:7], s53 offen offset:2048 sc1 lds
s_nop 1
v_max3_f32 v45, v64, v65, v66
v_max3_f32 v45, v45, v67, v68
v_max3_f32 v45, v45, v69, v70
v_max_f32 v45, v45, v71
v_pk_add_f32 v[72:73], v[72:73], v[74:75]
v_max3_f32 v46, v45, v72, v73
v_max3_f32 v47, v45, v72, v73
s_nop 1
v_permlane32_swap_b32 v46, v47
v_max_f32 v45, v46, v47
v_max_f32 v46, v46, v47
s_nop 1
v_permlane16_swap_b32 v45, v46
v_max_f32 v45, v45, v46
v_mul_f32 v46, s49, v45
s_add_u32 m0, s57, 3072
s_xor_b32 s57, s57, 98304
buffer_load_dwordx4 v21, s[4:7], s52 offen offset:0 sc1 lds
v_pk_fma_f32 v[64:65], v[64:65], s[48:49], v[46:47] op_sel_hi:[1,0,0]
v_pk_fma_f32 v[66:67], v[66:67], s[48:49], v[46:47] op_sel_hi:[1,0,0]
v_pk_fma_f32 v[68:69], v[68:69], s[48:49], v[46:47] op_sel_hi:[1,0,0]
v_pk_fma_f32 v[70:71], v[70:71], s[48:49], v[46:47] op_sel_hi:[1,0,0]
v_pk_fma_f32 v[72:73], v[72:73], s[48:49], v[46:47] op_sel_hi:[1,0,0]
v_exp_f32 v64, v64
v_exp_f32 v65, v65
v_exp_f32 v66, v66
v_exp_f32 v67, v67
v_exp_f32 v68, v68
buffer_load_dwordx4 v21, s[4:7], s52 offen offset:1024 sc1 lds
v_exp_f32 v69, v69
v_exp_f32 v70, v70
v_exp_f32 v71, v71
v_exp_f32 v72, v72
v_exp_f32 v73, v73
buffer_load_dwordx4 v21, s[4:7], s52 offen offset:2048 sc1 lds
s_add_u32 s47, s47, 786432
buffer_load_dword v209, v208, s[4:7], 0 offen sc1
v_cvt_pk_bf16_f32 v76, v64, v65
v_cvt_pk_bf16_f32 v77, v66, v67
v_cvt_pk_bf16_f32 v78, v68, v69
v_cvt_pk_bf16_f32 v79, v70, v71
v_cvt_pk_bf16_f32 v2, v72, v73
v_cvt_pk_bf16_f32 v7, v72, v73
v_mfma_f32_16x16x32_bf16 v[84:87], v[32:35], v[76:79], 0
v_mfma_f32_16x16x32_bf16 v[84:87], v[32:35], v[2:5], v[84:87]
v_mfma_f32_16x16x32_bf16 v[96:99], v[160:163], v[76:79], 0
v_mfma_f32_16x16x32_bf16 v[100:103], v[164:167], v[76:79], 0
v_mfma_f32_16x16x32_bf16 v[104:107], v[168:171], v[76:79], 0
v_mfma_f32_16x16x32_bf16 v[108:111], v[172:175], v[76:79], 0
v_mfma_f32_16x16x32_bf16 v[96:99], v[120:123], v[2:5], v[96:99]
v_mfma_f32_16x16x32_bf16 v[100:103], v[120:123], v[6:9], v[100:103]
v_mfma_f32_16x16x32_bf16 v[104:107], v[120:123], v[0:3], v[104:107]
v_mfma_f32_16x16x32_bf16 v[108:111], v[120:123], v[4:7], v[108:111]
v_rcp_f32 v46, v84
s_nop 3
v_pk_mul_f32 v[96:97], v[96:97], v[46:47] op_sel_hi:[1,0]
v_pk_mul_f32 v[98:99], v[98:99], v[46:47] op_sel_hi:[1,0]
v_pk_mul_f32 v[100:101], v[100:101], v[46:47] op_sel_hi:[1,0]
v_pk_mul_f32 v[102:103], v[102:103], v[46:47] op_sel_hi:[1,0]
v_pk_mul_f32 v[104:105], v[104:105], v[46:47] op_sel_hi:[1,0]
v_pk_mul_f32 v[106:107], v[106:107], v[46:47] op_sel_hi:[1,0]
v_pk_mul_f32 v[108:109], v[108:109], v[46:47] op_sel_hi:[1,0]
v_pk_mul_f32 v[110:111], v[110:111], v[46:47] op_sel_hi:[1,0]
v_cvt_pk_bf16_f32 v96, v96, v97
v_cvt_pk_bf16_f32 v97, v98, v99
v_cvt_pk_bf16_f32 v98, v100, v101
v_cvt_pk_bf16_f32 v99, v102, v103
v_cvt_pk_bf16_f32 v100, v104, v105
v_cvt_pk_bf16_f32 v101, v106, v107
v_cvt_pk_bf16_f32 v102, v108, v109
v_cvt_pk_bf16_f32 v103, v110, v111
buffer_store_dwordx4 v[96:99], v26, s[4:7], s50 offen
buffer_store_dwordx4 v[100:103], v27, s[4:7], s50 offen
s_add_u32 s36, s36, 1
s_cmp_lt_u32 s36, 64
s_cbranch_scc1 Lq_23
s_waitcnt vmcnt(0)
buffer_store_dword v197, v199, s[4:7], 0 offen
s_branch Lend_1
Lp2_37:
s_add_u32 s27, s27, 1
Lbw_39:
buffer_load_dword v209, v208, s[4:7], 0 offen sc1
s_waitcnt vmcnt(0)
v_add_u32 v44, v209, v210
v_cmp_gt_u32 vcc, s27, v44
s_cbranch_vccz Lbo_40
s_sub_u32 s37, s37, 1
s_cbranch_scc1 Lend_1
s_sleep 2
s_branch Lbw_39
Lbo_40:
s_mov_b32 m0, s57
s_add_u32 s52, s47, 3072
buffer_load_dwordx4 v21, s[4:7], s47 offen offset:0 sc1 lds
buffer_load_dwordx4 v21, s[4:7], s47 offen offset:1024 sc1 lds
buffer_load_dwordx4 v21, s[4:7], s47 offen offset:2048 sc1 lds
s_add_u32 m0, s57, 3072
s_xor_b32 s57, s57, 98304
buffer_load_dwordx4 v21, s[4:7], s52 offen offset:0 sc1 lds
buffer_load_dwordx4 v21, s[4:7], s52 offen offset:1024 sc1 lds
buffer_load_dwordx4 v21, s[4:7], s52 offen offset:2048 sc1 lds
s_add_u32 s47, s47, 786432
s_branch Lp1_38
Lpw_35:
Lbw_41:
buffer_load_dword v209, v208, s[4:7], 0 offen sc1
s_waitcnt vmcnt(0)
v_add_u32 v44, v209, v210
v_cmp_gt_u32 vcc, s27, v44
s_cbranch_vccz Lbo_42
s_sub_u32 s37, s37, 1
s_cbranch_scc1 Lend_1
s_sleep 2
s_branch Lbw_41
Lbo_42:
s_branch Lpk_36
Lpj_30:
buffer_load_dwordx4 v[56:59], v10, s[4:7], s40 offen offset:2048 sc1
buffer_load_dwordx4 v[60:63], v10, s[4:7], s40 offen offset:3072 sc1
s_sub_u32 s37, s37, 1
s_cbranch_scc1 Lend_1
s_branch Lps_43
Lpf_28:
buffer_load_dwordx4 v[48:51], v10, s[4:7], s40 offen offset:0 sc1
s_sub_u32 s37, s37, 1
s_cbranch_scc1 Lend_1
Lps_44:
s_waitcnt vmcnt(3)
v_max3_u32 v44, v52, v53, v54
v_max_u32 v44, v44, v55
v_cmp_eq_u32 vcc, -1, v44
s_cbranch_vccnz Lpf_45
v_smfmac_f32_16x16x64_bf16 v[64:67], v[52:55], a[64:71], v15
v_smfmac_f32_16x16x64_bf16 v[68:71], v[52:55], a[72:79], v15
v_smfmac_f32_16x16x64_bf16 v[72:75], v[52:55], a[80:87], v15
v_smfmac_f32_16x16x64_bf16 v[76:79], v[52:55], a[88:95], v15
v_smfmac_f32_16x16x64_bf16 v[80:83], v[52:55], a[96:103], v15
v_smfmac_f32_16x16x64_bf16 v[84:87], v[52:55], a[104:111], v15
Lps_46:
s_waitcnt vmcnt(2)
v_max3_u32 v44, v56, v57, v58
v_max_u32 v44, v44, v59
v_cmp_eq_u32 vcc, -1, v44
s_cbranch_vccnz Lpf_47
v_smfmac_f32_16x16x64_bf16 v[64:67], v[56:59], a[128:135], v15
v_smfmac_f32_16x16x64_bf16 v[68:71], v[56:59], a[136:143], v15
v_smfmac_f32_16x16x64_bf16 v[72:75], v[56:59], a[144:151], v15
v_smfmac_f32_16x16x64_bf16 v[76:79], v[56:59], a[152:159], v15
v_smfmac_f32_16x16x64_bf16 v[80:83], v[56:59], a[160:167], v15
v_smfmac_f32_16x16x64_bf16 v[84:87], v[56:59], a[168:175], v15
Lps_48:
s_waitcnt vmcnt(1)
v_max3_u32 v44, v60, v61, v62
v_max_u32 v44, v44, v63
v_cmp_eq_u32 vcc, -1, v44
s_cbranch_vccnz Lpf_49
v_smfmac_f32_16x16x64_bf16 v[64:67], v[60:63], a[192:199], v15
v_smfmac_f32_16x16x64_bf16 v[68:71], v[60:63], a[200:207], v15
v_smfmac_f32_16x16x64_bf16 v[72:75], v[60:63], a[208:215], v15
v_smfmac_f32_16x16x64_bf16 v[76:79], v[60:63], a[216:223], v15
v_smfmac_f32_16x16x64_bf16 v[80:83], v[60:63], a[224:231], v15
v_smfmac_f32_16x16x64_bf16 v[84:87], v[60:63], a[232:239], v15
Lps_50:
s_waitcnt vmcnt(0)
v_max3_u32 v44, v48, v49, v50
v_max_u32 v44, v44, v51
v_cmp_eq_u32 vcc, -1, v44
s_cbranch_vccnz Lpf_51
v_smfmac_f32_16x16x64_bf16 v[64:67], v[48:51], a[0:7], v15
s_nop 1
v_smfmac_f32_16x16x64_bf16 v[68:71], v[48:51], a[8:15], v15
s_nop 1
v_smfmac_f32_16x16x64_bf16 v[72:75], v[48:51], a[16:23], v15
s_nop 1
v_smfmac_f32_16x16x64_bf16 v[76:79], v[48:51], a[24:31], v15
v_add_f32 v96, v64, v66
v_add_f32 v97, v65, v67
v_smfmac_f32_16x16x64_bf16 v[80:83], v[48:51], a[32:39], v15
v_add_f32 v98, v68, v70
v_add_f32 v99, v69, v71
v_smfmac_f32_16x16x64_bf16 v[84:87], v[48:51], a[40:47], v15
v_add_f32 v100, v72, v74
v_add_f32 v101, v73, v75
ds_write_b128 v211, v[96:99] offset:0
v_smfmac_f32_16x16x64_bf16 v[88:91], v[48:51], a[48:55], v15
v_add_f32 v102, v76, v78
v_add_f32 v103, v77, v79
v_add_f32 v104, v80, v82
v_add_f32 v105, v81, v83
ds_write_b128 v212, v[100:103] offset:0
v_smfmac_f32_16x16x64_bf16 v[88:91], v[52:55], a[112:119], v15
v_add_f32 v106, v84, v86
v_add_f32 v107, v85, v87
ds_write_b128 v213, v[104:107] offset:0
s_branch Lpd_27
Lpf_29:
buffer_load_dwordx4 v[52:55], v10, s[4:7], s40 offen offset:1024 sc1
s_sub_u32 s37, s37, 1
s_cbranch_scc1 Lend_1
Lps_52:
s_waitcnt vmcnt(2)
v_max3_u32 v44, v56, v57, v58
v_max_u32 v44, v44, v59
v_cmp_eq_u32 vcc, -1, v44
s_cbranch_vccnz Lpf_53
v_smfmac_f32_16x16x64_bf16 v[64:67], v[56:59], a[128:135], v15
v_smfmac_f32_16x16x64_bf16 v[68:71], v[56:59], a[136:143], v15
v_smfmac_f32_16x16x64_bf16 v[72:75], v[56:59], a[144:151], v15
v_smfmac_f32_16x16x64_bf16 v[76:79], v[56:59], a[152:159], v15
v_smfmac_f32_16x16x64_bf16 v[80:83], v[56:59], a[160:167], v15
v_smfmac_f32_16x16x64_bf16 v[84:87], v[56:59], a[168:175], v15
Lps_54:
s_waitcnt vmcnt(1)
v_max3_u32 v44, v60, v61, v62
v_max_u32 v44, v44, v63
v_cmp_eq_u32 vcc, -1, v44
s_cbranch_vccnz Lpf_55
v_smfmac_f32_16x16x64_bf16 v[64:67], v[60:63], a[192:199], v15
v_smfmac_f32_16x16x64_bf16 v[68:71], v[60:63], a[200:207], v15
v_smfmac_f32_16x16x64_bf16 v[72:75], v[60:63], a[208:215], v15
v_smfmac_f32_16x16x64_bf16 v[76:79], v[60:63], a[216:223], v15
v_smfmac_f32_16x16x64_bf16 v[80:83], v[60:63], a[224:231], v15
v_smfmac_f32_16x16x64_bf16 v[84:87], v[60:63], a[232:239], v15
Lps_56:
s_waitcnt vmcnt(0)
v_max3_u32 v44, v52, v53, v54
v_max_u32 v44, v44, v55
v_cmp_eq_u32 vcc, -1, v44
s_cbranch_vccnz Lpf_57
v_smfmac_f32_16x16x64_bf16 v[64:67], v[52:55], a[64:71], v15
s_nop 1
v_smfmac_f32_16x16x64_bf16 v[68:71], v[52:55], a[72:79], v15
s_nop 1
v_smfmac_f32_16x16x64_bf16 v[72:75], v[52:55], a[80:87], v15
s_nop 1
v_smfmac_f32_16x16x64_bf16 v[76:79], v[52:55], a[88:95], v15
v_add_f32 v96, v64, v66
v_add_f32 v97, v65, v67
v_smfmac_f32_16x16x64_bf16 v[80:83], v[52:55], a[96:103], v15
v_add_f32 v98, v68, v70
v_add_f32 v99, v69, v71
v_smfmac_f32_16x16x64_bf16 v[84:87], v[52:55], a[104:111], v15
v_add_f32 v100, v72, v74
v_add_f32 v101, v73, v75
ds_write_b128 v211, v[96:99] offset:0
v_smfmac_f32_16x16x64_bf16 v[88:91], v[48:51], a[48:55], v15
v_add_f32 v102, v76, v78
v_add_f32 v103, v77, v79
v_add_f32 v104, v80, v82
v_add_f32 v105, v81, v83
ds_write_b128 v212, v[100:103] offset:0
v_smfmac_f32_16x16x64_bf16 v[88:91], v[52:55], a[112:119], v15
v_add_f32 v106, v84, v86
v_add_f32 v107, v85, v87
ds_write_b128 v213, v[104:107] offset:0
s_branch Lpd_27
Lpf_45:
buffer_load_dwordx4 v[52:55], v10, s[4:7], s40 offen offset:1024 sc1
Lps_58:
s_waitcnt vmcnt(3)
v_max3_u32 v44, v56, v57, v58
v_max_u32 v44, v44, v59
v_cmp_eq_u32 vcc, -1, v44
s_cbranch_vccnz Lpf_59
v_smfmac_f32_16x16x64_bf16 v[64:67], v[56:59], a[128:135], v15
v_smfmac_f32_16x16x64_bf16 v[68:71], v[56:59], a[136:143], v15
v_smfmac_f32_16x16x64_bf16 v[72:75], v[56:59], a[144:151], v15
v_smfmac_f32_16x16x64_bf16 v[76:79], v[56:59], a[152:159], v15
v_smfmac_f32_16x16x64_bf16 v[80:83], v[56:59], a[160:167], v15
v_smfmac_f32_16x16x64_bf16 v[84:87], v[56:59], a[168:175], v15
Lps_60:
s_waitcnt vmcnt(2)
v_max3_u32 v44, v60, v61, v62
v_max_u32 v44, v44, v63
v_cmp_eq_u32 vcc, -1, v44
s_cbranch_vccnz Lpf_61
v_smfmac_f32_16x16x64_bf16 v[64:67], v[60:63], a[192:199], v15
v_smfmac_f32_16x16x64_bf16 v[68:71], v[60:63], a[200:207], v15
v_smfmac_f32_16x16x64_bf16 v[72:75], v[60:63], a[208:215], v15
v_smfmac_f32_16x16x64_bf16 v[76:79], v[60:63], a[216:223], v15
v_smfmac_f32_16x16x64_bf16 v[80:83], v[60:63], a[224:231], v15
v_smfmac_f32_16x16x64_bf16 v[84:87], v[60:63], a[232:239], v15
Lps_62:
s_waitcnt vmcnt(1)
v_max3_u32 v44, v48, v49, v50
v_max_u32 v44, v44, v51
v_cmp_eq_u32 vcc, -1, v44
s_cbranch_vccnz Lpf_63
v_smfmac_f32_16x16x64_bf16 v[64:67], v[48:51], a[0:7], v15
v_smfmac_f32_16x16x64_bf16 v[68:71], v[48:51], a[8:15], v15
v_smfmac_f32_16x16x64_bf16 v[72:75], v[48:51], a[16:23], v15
v_smfmac_f32_16x16x64_bf16 v[76:79], v[48:51], a[24:31], v15
v_smfmac_f32_16x16x64_bf16 v[80:83], v[48:51], a[32:39], v15
v_smfmac_f32_16x16x64_bf16 v[84:87], v[48:51], a[40:47], v15
s_branch Lps_56
Lpf_47:
buffer_load_dwordx4 v[56:59], v10, s[4:7], s40 offen offset:2048 sc1
Lps_64:
s_waitcnt vmcnt(2)
v_max3_u32 v44, v60, v61, v62
v_max_u32 v44, v44, v63
v_cmp_eq_u32 vcc, -1, v44
s_cbranch_vccnz Lpf_65
v_smfmac_f32_16x16x64_bf16 v[64:67], v[60:63], a[192:199], v15
v_smfmac_f32_16x16x64_bf16 v[68:71], v[60:63], a[200:207], v15
v_smfmac_f32_16x16x64_bf16 v[72:75], v[60:63], a[208:215], v15
v_smfmac_f32_16x16x64_bf16 v[76:79], v[60:63], a[216:223], v15
v_smfmac_f32_16x16x64_bf16 v[80:83], v[60:63], a[224:231], v15
v_smfmac_f32_16x16x64_bf16 v[84:87], v[60:63], a[232:239], v15
Lps_66:
s_waitcnt vmcnt(1)
v_max3_u32 v44, v48, v49, v50
v_max_u32 v44, v44, v51
v_cmp_eq_u32 vcc, -1, v44
s_cbranch_vccnz Lpf_67
v_smfmac_f32_16x16x64_bf16 v[64:67], v[48:51], a[0:7], v15
v_smfmac_f32_16x16x64_bf16 v[68:71], v[48:51], a[8:15], v15
v_smfmac_f32_16x16x64_bf16 v[72:75], v[48:51], a[16:23], v15
v_smfmac_f32_16x16x64_bf16 v[76:79], v[48:51], a[24:31], v15
v_smfmac_f32_16x16x64_bf16 v[80:83], v[48:51], a[32:39], v15
v_smfmac_f32_16x16x64_bf16 v[84:87], v[48:51], a[40:47], v15
Lps_68:
s_waitcnt vmcnt(0)
v_max3_u32 v44, v56, v57, v58
v_max_u32 v44, v44, v59
v_cmp_eq_u32 vcc, -1, v44
s_cbranch_vccnz Lpf_69
v_smfmac_f32_16x16x64_bf16 v[64:67], v[56:59], a[128:135], v15
s_nop 1
v_smfmac_f32_16x16x64_bf16 v[68:71], v[56:59], a[136:143], v15
s_nop 1
v_smfmac_f32_16x16x64_bf16 v[72:75], v[56:59], a[144:151], v15
s_nop 1
v_smfmac_f32_16x16x64_bf16 v[76:79], v[56:59], a[152:159], v15
v_add_f32 v96, v64, v66
v_add_f32 v97, v65, v67
v_smfmac_f32_16x16x64_bf16 v[80:83], v[56:59], a[160:167], v15
v_add_f32 v98, v68, v70
v_add_f32 v99, v69, v71
v_smfmac_f32_16x16x64_bf16 v[84:87], v[56:59], a[168:175], v15
v_add_f32 v100, v72, v74
v_add_f32 v101, v73, v75
ds_write_b128 v211, v[96:99] offset:0
v_smfmac_f32_16x16x64_bf16 v[88:91], v[48:51], a[48:55], v15
v_add_f32 v102, v76, v78
v_add_f32 v103, v77, v79
v_add_f32 v104, v80, v82
v_add_f32 v105, v81, v83
ds_write_b128 v212, v[100:103] offset:0
v_smfmac_f32_16x16x64_bf16 v[88:91], v[52:55], a[112:119], v15
v_add_f32 v106, v84, v86
v_add_f32 v107, v85, v87
ds_write_b128 v213, v[104:107] offset:0
s_branch Lpd_27
Lpf_49:
buffer_load_dwordx4 v[60:63], v10, s[4:7], s40 offen offset:3072 sc1
Lps_70:
s_waitcnt vmcnt(1)
v_max3_u32 v44, v48, v49, v50
v_max_u32 v44, v44, v51
v_cmp_eq_u32 vcc, -1, v44
s_cbranch_vccnz Lpf_71
v_smfmac_f32_16x16x64_bf16 v[64:67], v[48:51], a[0:7], v15
v_smfmac_f32_16x16x64_bf16 v[68:71], v[48:51], a[8:15], v15
v_smfmac_f32_16x16x64_bf16 v[72:75], v[48:51], a[16:23], v15
v_smfmac_f32_16x16x64_bf16 v[76:79], v[48:51], a[24:31], v15
v_smfmac_f32_16x16x64_bf16 v[80:83], v[48:51], a[32:39], v15
v_smfmac_f32_16x16x64_bf16 v[84:87], v[48:51], a[40:47], v15
Lps_72:
s_waitcnt vmcnt(0)
v_max3_u32 v44, v60, v61, v62
v_max_u32 v44, v44, v63
v_cmp_eq_u32 vcc, -1, v44
s_cbranch_vccnz Lpf_73
v_smfmac_f32_16x16x64_bf16 v[64:67], v[60:63], a[192:199], v15
s_nop 1
v_smfmac_f32_16x16x64_bf16 v[68:71], v[60:63], a[200:207], v15
s_nop 1
v_smfmac_f32_16x16x64_bf16 v[72:75], v[60:63], a[208:215], v15
s_nop 1
v_smfmac_f32_16x16x64_bf16 v[76:79], v[60:63], a[216:223], v15
v_add_f32 v96, v64, v66
v_add_f32 v97, v65, v67
v_smfmac_f32_16x16x64_bf16 v[80:83], v[60:63], a[224:231], v15
v_add_f32 v98, v68, v70
v_add_f32 v99, v69, v71
v_smfmac_f32_16x16x64_bf16 v[84:87], v[60:63], a[232:239], v15
v_add_f32 v100, v72, v74
v_add_f32 v101, v73, v75
ds_write_b128 v211, v[96:99] offset:0
v_smfmac_f32_16x16x64_bf16 v[88:91], v[48:51], a[48:55], v15
v_add_f32 v102, v76, v78
v_add_f32 v103, v77, v79
v_add_f32 v104, v80, v82
v_add_f32 v105, v81, v83
ds_write_b128 v212, v[100:103] offset:0
v_smfmac_f32_16x16x64_bf16 v[88:91], v[52:55], a[112:119], v15
v_add_f32 v106, v84, v86
v_add_f32 v107, v85, v87
ds_write_b128 v213, v[104:107] offset:0
s_branch Lpd_27
Lpf_51:
buffer_load_dwordx4 v[48:51], v10, s[4:7], s40 offen offset:0 sc1
s_sub_u32 s37, s37, 1
s_cbranch_scc1 Lend_1
s_branch Lps_50
Lpf_53:
buffer_load_dwordx4 v[56:59], v10, s[4:7], s40 offen offset:2048 sc1
Lps_74:
s_waitcnt vmcnt(2)
v_max3_u32 v44, v60, v61, v62
v_max_u32 v44, v44, v63
v_cmp_eq_u32 vcc, -1, v44
s_cbranch_vccnz Lpf_75
v_smfmac_f32_16x16x64_bf16 v[64:67], v[60:63], a[192:199], v15
v_smfmac_f32_16x16x64_bf16 v[68:71], v[60:63], a[200:207], v15
v_smfmac_f32_16x16x64_bf16 v[72:75], v[60:63], a[208:215], v15
v_smfmac_f32_16x16x64_bf16 v[76:79], v[60:63], a[216:223], v15
v_smfmac_f32_16x16x64_bf16 v[80:83], v[60:63], a[224:231], v15
v_smfmac_f32_16x16x64_bf16 v[84:87], v[60:63], a[232:239], v15
Lps_76:
s_waitcnt vmcnt(1)
v_max3_u32 v44, v52, v53, v54
v_max_u32 v44, v44, v55
v_cmp_eq_u32 vcc, -1, v44
s_cbranch_vccnz Lpf_77
v_smfmac_f32_16x16x64_bf16 v[64:67], v[52:55], a[64:71], v15
v_smfmac_f32_16x16x64_bf16 v[68:71], v[52:55], a[72:79], v15
v_smfmac_f32_16x16x64_bf16 v[72:75], v[52:55], a[80:87], v15
v_smfmac_f32_16x16x64_bf16 v[76:79], v[52:55], a[88:95], v15
v_smfmac_f32_16x16x64_bf16 v[80:83], v[52:55], a[96:103], v15
v_smfmac_f32_16x16x64_bf16 v[84:87], v[52:55], a[104:111], v15
s_branch Lps_68
Lpf_55:
buffer_load_dwordx4 v[60:63], v10, s[4:7], s40 offen offset:3072 sc1
Lps_78:
s_waitcnt vmcnt(1)
v_max3_u32 v44, v52, v53, v54
v_max_u32 v44, v44, v55
v_cmp_eq_u32 vcc, -1, v44
s_cbranch_vccnz Lpf_79
v_smfmac_f32_16x16x64_bf16 v[64:67], v[52:55], a[64:71], v15
v_smfmac_f32_16x16x64_bf16 v[68:71], v[52:55], a[72:79], v15
v_smfmac_f32_16x16x64_bf16 v[72:75], v[52:55], a[80:87], v15
v_smfmac_f32_16x16x64_bf16 v[76:79], v[52:55], a[88:95], v15
v_smfmac_f32_16x16x64_bf16 v[80:83], v[52:55], a[96:103], v15
v_smfmac_f32_16x16x64_bf16 v[84:87], v[52:55], a[104:111], v15
s_branch Lps_72
Lpf_57:
buffer_load_dwordx4 v[52:55], v10, s[4:7], s40 offen offset:1024 sc1
s_sub_u32 s37, s37, 1
s_cbranch_scc1 Lend_1
s_branch Lps_56
Lpf_59:
buffer_load_dwordx4 v[56:59], v10, s[4:7], s40 offen offset:2048 sc1
Lps_80:
s_waitcnt vmcnt(3)
v_max3_u32 v44, v60, v61, v62
v_max_u32 v44, v44, v63
v_cmp_eq_u32 vcc, -1, v44
s_cbranch_vccnz Lpf_81
v_smfmac_f32_16x16x64_bf16 v[64:67], v[60:63], a[192:199], v15
v_smfmac_f32_16x16x64_bf16 v[68:71], v[60:63], a[200:207], v15
v_smfmac_f32_16x16x64_bf16 v[72:75], v[60:63], a[208:215], v15
v_smfmac_f32_16x16x64_bf16 v[76:79], v[60:63], a[216:223], v15
v_smfmac_f32_16x16x64_bf16 v[80:83], v[60:63], a[224:231], v15
v_smfmac_f32_16x16x64_bf16 v[84:87], v[60:63], a[232:239], v15
Lps_82:
s_waitcnt vmcnt(2)
v_max3_u32 v44, v48, v49, v50
v_max_u32 v44, v44, v51
v_cmp_eq_u32 vcc, -1, v44
s_cbranch_vccnz Lpf_83
v_smfmac_f32_16x16x64_bf16 v[64:67], v[48:51], a[0:7], v15
v_smfmac_f32_16x16x64_bf16 v[68:71], v[48:51], a[8:15], v15
v_smfmac_f32_16x16x64_bf16 v[72:75], v[48:51], a[16:23], v15
v_smfmac_f32_16x16x64_bf16 v[76:79], v[48:51], a[24:31], v15
v_smfmac_f32_16x16x64_bf16 v[80:83], v[48:51], a[32:39], v15
v_smfmac_f32_16x16x64_bf16 v[84:87], v[48:51], a[40:47], v15
s_branch Lps_76
Lpf_61:
buffer_load_dwordx4 v[60:63], v10, s[4:7], s40 offen offset:3072 sc1
Lps_84:
s_waitcnt vmcnt(2)
v_max3_u32 v44, v48, v49, v50
v_max_u32 v44, v44, v51
v_cmp_eq_u32 vcc, -1, v44
s_cbranch_vccnz Lpf_85
v_smfmac_f32_16x16x64_bf16 v[64:67], v[48:51], a[0:7], v15
v_smfmac_f32_16x16x64_bf16 v[68:71], v[48:51], a[8:15], v15
v_smfmac_f32_16x16x64_bf16 v[72:75], v[48:51], a[16:23], v15
v_smfmac_f32_16x16x64_bf16 v[76:79], v[48:51], a[24:31], v15
v_smfmac_f32_16x16x64_bf16 v[80:83], v[48:51], a[32:39], v15
v_smfmac_f32_16x16x64_bf16 v[84:87], v[48:51], a[40:47], v15
s_branch Lps_78
Lpf_63:
buffer_load_dwordx4 v[48:51], v10, s[4:7], s40 offen offset:0 sc1
s_sub_u32 s37, s37, 1
s_cbranch_scc1 Lend_1
Lps_86:
s_waitcnt vmcnt(1)
v_max3_u32 v44, v52, v53, v54
v_max_u32 v44, v44, v55
v_cmp_eq_u32 vcc, -1, v44
s_cbranch_vccnz Lpf_87
v_smfmac_f32_16x16x64_bf16 v[64:67], v[52:55], a[64:71], v15
v_smfmac_f32_16x16x64_bf16 v[68:71], v[52:55], a[72:79], v15
v_smfmac_f32_16x16x64_bf16 v[72:75], v[52:55], a[80:87], v15
v_smfmac_f32_16x16x64_bf16 v[76:79], v[52:55], a[88:95], v15
v_smfmac_f32_16x16x64_bf16 v[80:83], v[52:55], a[96:103], v15
v_smfmac_f32_16x16x64_bf16 v[84:87], v[52:55], a[104:111], v15
s_branch Lps_50
Lpf_65:
buffer_load_dwordx4 v[60:63], v10, s[4:7], s40 offen offset:3072 sc1
Lps_88:
s_waitcnt vmcnt(2)
v_max3_u32 v44, v48, v49, v50
v_max_u32 v44, v44, v51
v_cmp_eq_u32 vcc, -1, v44
s_cbranch_vccnz Lpf_89
v_smfmac_f32_16x16x64_bf16 v[64:67], v[48:51], a[0:7], v15
v_smfmac_f32_16x16x64_bf16 v[68:71], v[48:51], a[8:15], v15
v_smfmac_f32_16x16x64_bf16 v[72:75], v[48:51], a[16:23], v15
v_smfmac_f32_16x16x64_bf16 v[76:79], v[48:51], a[24:31], v15
v_smfmac_f32_16x16x64_bf16 v[80:83], v[48:51], a[32:39], v15
v_smfmac_f32_16x16x64_bf16 v[84:87], v[48:51], a[40:47], v15
Lps_43:
s_waitcnt vmcnt(1)
v_max3_u32 v44, v56, v57, v58
v_max_u32 v44, v44, v59
v_cmp_eq_u32 vcc, -1, v44
s_cbranch_vccnz Lpf_90
v_smfmac_f32_16x16x64_bf16 v[64:67], v[56:59], a[128:135], v15
v_smfmac_f32_16x16x64_bf16 v[68:71], v[56:59], a[136:143], v15
v_smfmac_f32_16x16x64_bf16 v[72:75], v[56:59], a[144:151], v15
v_smfmac_f32_16x16x64_bf16 v[76:79], v[56:59], a[152:159], v15
v_smfmac_f32_16x16x64_bf16 v[80:83], v[56:59], a[160:167], v15
v_smfmac_f32_16x16x64_bf16 v[84:87], v[56:59], a[168:175], v15
s_branch Lps_72
Lpf_67:
buffer_load_dwordx4 v[48:51], v10, s[4:7], s40 offen offset:0 sc1
s_sub_u32 s37, s37, 1
s_cbranch_scc1 Lend_1
Lps_91:
s_waitcnt vmcnt(1)
v_max3_u32 v44, v56, v57, v58
v_max_u32 v44, v44, v59
v_cmp_eq_u32 vcc, -1, v44
s_cbranch_vccnz Lpf_92
v_smfmac_f32_16x16x64_bf16 v[64:67], v[56:59], a[128:135], v15
v_smfmac_f32_16x16x64_bf16 v[68:71], v[56:59], a[136:143], v15
v_smfmac_f32_16x16x64_bf16 v[72:75], v[56:59], a[144:151], v15
v_smfmac_f32_16x16x64_bf16 v[76:79], v[56:59], a[152:159], v15
v_smfmac_f32_16x16x64_bf16 v[80:83], v[56:59], a[160:167], v15
v_smfmac_f32_16x16x64_bf16 v[84:87], v[56:59], a[168:175], v15
s_branch Lps_50
Lpf_69:
buffer_load_dwordx4 v[56:59], v10, s[4:7], s40 offen offset:2048 sc1
s_sub_u32 s37, s37, 1
s_cbranch_scc1 Lend_1
s_branch Lps_68
Lpf_71:
buffer_load_dwordx4 v[48:51], v10, s[4:7], s40 offen offset:0 sc1
s_sub_u32 s37, s37, 1
s_cbranch_scc1 Lend_1
s_branch Lps_48
Lpf_73:
buffer_load_dwordx4 v[60:63], v10, s[4:7], s40 offen offset:3072 sc1
s_sub_u32 s37, s37, 1
s_cbranch_scc1 Lend_1
s_branch Lps_72
Lpf_75:
buffer_load_dwordx4 v[60:63], v10, s[4:7], s40 offen offset:3072 sc1
Lps_93:
s_waitcnt vmcnt(2)
v_max3_u32 v44, v52, v53, v54
v_max_u32 v44, v44, v55
v_cmp_eq_u32 vcc, -1, v44
s_cbranch_vccnz Lpf_94
v_smfmac_f32_16x16x64_bf16 v[64:67], v[52:55], a[64:71], v15
v_smfmac_f32_16x16x64_bf16 v[68:71], v[52:55], a[72:79], v15
v_smfmac_f32_16x16x64_bf16 v[72:75], v[52:55], a[80:87], v15
v_smfmac_f32_16x16x64_bf16 v[76:79], v[52:55], a[88:95], v15
v_smfmac_f32_16x16x64_bf16 v[80:83], v[52:55], a[96:103], v15
v_smfmac_f32_16x16x64_bf16 v[84:87], v[52:55], a[104:111], v15
s_branch Lps_43
Lpf_77:
buffer_load_dwordx4 v[52:55], v10, s[4:7], s40 offen offset:1024 sc1
s_sub_u32 s37, s37, 1
s_cbranch_scc1 Lend_1
Lps_95:
s_waitcnt vmcnt(1)
v_max3_u32 v44, v56, v57, v58
v_max_u32 v44, v44, v59
v_cmp_eq_u32 vcc, -1, v44
s_cbranch_vccnz Lpf_96
v_smfmac_f32_16x16x64_bf16 v[64:67], v[56:59], a[128:135], v15
v_smfmac_f32_16x16x64_bf16 v[68:71], v[56:59], a[136:143], v15
v_smfmac_f32_16x16x64_bf16 v[72:75], v[56:59], a[144:151], v15
v_smfmac_f32_16x16x64_bf16 v[76:79], v[56:59], a[152:159], v15
v_smfmac_f32_16x16x64_bf16 v[80:83], v[56:59], a[160:167], v15
v_smfmac_f32_16x16x64_bf16 v[84:87], v[56:59], a[168:175], v15
s_branch Lps_56
Lpf_79:
buffer_load_dwordx4 v[52:55], v10, s[4:7], s40 offen offset:1024 sc1
s_sub_u32 s37, s37, 1
s_cbranch_scc1 Lend_1
s_branch Lps_54
Lpf_81:
buffer_load_dwordx4 v[60:63], v10, s[4:7], s40 offen offset:3072 sc1
Lps_97:
s_waitcnt vmcnt(3)
v_max3_u32 v44, v48, v49, v50
v_max_u32 v44, v44, v51
v_cmp_eq_u32 vcc, -1, v44
s_cbranch_vccnz Lpf_98
v_smfmac_f32_16x16x64_bf16 v[64:67], v[48:51], a[0:7], v15
v_smfmac_f32_16x16x64_bf16 v[68:71], v[48:51], a[8:15], v15
v_smfmac_f32_16x16x64_bf16 v[72:75], v[48:51], a[16:23], v15
v_smfmac_f32_16x16x64_bf16 v[76:79], v[48:51], a[24:31], v15
v_smfmac_f32_16x16x64_bf16 v[80:83], v[48:51], a[32:39], v15
v_smfmac_f32_16x16x64_bf16 v[84:87], v[48:51], a[40:47], v15
s_branch Lps_93
Lpf_83:
buffer_load_dwordx4 v[48:51], v10, s[4:7], s40 offen offset:0 sc1
s_sub_u32 s37, s37, 1
s_cbranch_scc1 Lend_1
Lps_99:
s_waitcnt vmcnt(2)
v_max3_u32 v44, v52, v53, v54
v_max_u32 v44, v44, v55
v_cmp_eq_u32 vcc, -1, v44
s_cbranch_vccnz Lpf_100
v_smfmac_f32_16x16x64_bf16 v[64:67], v[52:55], a[64:71], v15
v_smfmac_f32_16x16x64_bf16 v[68:71], v[52:55], a[72:79], v15
v_smfmac_f32_16x16x64_bf16 v[72:75], v[52:55], a[80:87], v15
v_smfmac_f32_16x16x64_bf16 v[76:79], v[52:55], a[88:95], v15
v_smfmac_f32_16x16x64_bf16 v[80:83], v[52:55], a[96:103], v15
v_smfmac_f32_16x16x64_bf16 v[84:87], v[52:55], a[104:111], v15
s_branch Lps_91
Lpf_85:
buffer_load_dwordx4 v[48:51], v10, s[4:7], s40 offen offset:0 sc1
s_sub_u32 s37, s37, 1
s_cbranch_scc1 Lend_1
Lps_101:
s_waitcnt vmcnt(2)
v_max3_u32 v44, v52, v53, v54
v_max_u32 v44, v44, v55
v_cmp_eq_u32 vcc, -1, v44
s_cbranch_vccnz Lpf_102
v_smfmac_f32_16x16x64_bf16 v[64:67], v[52:55], a[64:71], v15
v_smfmac_f32_16x16x64_bf16 v[68:71], v[52:55], a[72:79], v15
v_smfmac_f32_16x16x64_bf16 v[72:75], v[52:55], a[80:87], v15
v_smfmac_f32_16x16x64_bf16 v[76:79], v[52:55], a[88:95], v15
v_smfmac_f32_16x16x64_bf16 v[80:83], v[52:55], a[96:103], v15
v_smfmac_f32_16x16x64_bf16 v[84:87], v[52:55], a[104:111], v15
s_branch Lps_48
Lpf_87:
buffer_load_dwordx4 v[52:55], v10, s[4:7], s40 offen offset:1024 sc1
s_branch Lps_62
Lpf_89:
buffer_load_dwordx4 v[48:51], v10, s[4:7], s40 offen offset:0 sc1
s_sub_u32 s37, s37, 1
s_cbranch_scc1 Lend_1
s_branch Lps_46
Lpf_90:
buffer_load_dwordx4 v[56:59], v10, s[4:7], s40 offen offset:2048 sc1
s_sub_u32 s37, s37, 1
s_cbranch_scc1 Lend_1
Lps_103:
s_waitcnt vmcnt(1)
v_max3_u32 v44, v60, v61, v62
v_max_u32 v44, v44, v63
v_cmp_eq_u32 vcc, -1, v44
s_cbranch_vccnz Lpf_104
v_smfmac_f32_16x16x64_bf16 v[64:67], v[60:63], a[192:199], v15
v_smfmac_f32_16x16x64_bf16 v[68:71], v[60:63], a[200:207], v15
v_smfmac_f32_16x16x64_bf16 v[72:75], v[60:63], a[208:215], v15
v_smfmac_f32_16x16x64_bf16 v[76:79], v[60:63], a[216:223], v15
v_smfmac_f32_16x16x64_bf16 v[80:83], v[60:63], a[224:231], v15
v_smfmac_f32_16x16x64_bf16 v[84:87], v[60:63], a[232:239], v15
s_branch Lps_68
Lpf_92:
buffer_load_dwordx4 v[56:59], v10, s[4:7], s40 offen offset:2048 sc1
s_branch Lps_66
Lpf_94:
buffer_load_dwordx4 v[52:55], v10, s[4:7], s40 offen offset:1024 sc1
s_sub_u32 s37, s37, 1
s_cbranch_scc1 Lend_1
s_branch Lps_52
Lpf_96:
buffer_load_dwordx4 v[56:59], v10, s[4:7], s40 offen offset:2048 sc1
s_branch Lps_76
Lpf_98:
buffer_load_dwordx4 v[48:51], v10, s[4:7], s40 offen offset:0 sc1
s_sub_u32 s37, s37, 1
s_cbranch_scc1 Lend_1
s_branch Lps_44
Lpf_100:
buffer_load_dwordx4 v[52:55], v10, s[4:7], s40 offen offset:1024 sc1
Lps_105:
s_waitcnt vmcnt(2)
v_max3_u32 v44, v56, v57, v58
v_max_u32 v44, v44, v59
v_cmp_eq_u32 vcc, -1, v44
s_cbranch_vccnz Lpf_106
v_smfmac_f32_16x16x64_bf16 v[64:67], v[56:59], a[128:135], v15
v_smfmac_f32_16x16x64_bf16 v[68:71], v[56:59], a[136:143], v15
v_smfmac_f32_16x16x64_bf16 v[72:75], v[56:59], a[144:151], v15
v_smfmac_f32_16x16x64_bf16 v[76:79], v[56:59], a[152:159], v15
v_smfmac_f32_16x16x64_bf16 v[80:83], v[56:59], a[160:167], v15
v_smfmac_f32_16x16x64_bf16 v[84:87], v[56:59], a[168:175], v15
s_branch Lps_62
Lpf_102:
buffer_load_dwordx4 v[52:55], v10, s[4:7], s40 offen offset:1024 sc1
s_branch Lps_60
Lpf_104:
buffer_load_dwordx4 v[60:63], v10, s[4:7], s40 offen offset:3072 sc1
s_branch Lps_43
Lpf_106:
buffer_load_dwordx4 v[56:59], v10, s[4:7], s40 offen offset:2048 sc1
s_branch Lps_82
Lkr_31:
buffer_load_dwordx4 v[56:59], v11, s[4:7], s40 offen offset:0 sc1
buffer_load_dwordx4 v[60:63], v11, s[4:7], s40 offen offset:1024 sc1
Lps_108:
s_waitcnt vmcnt(3)
v_max3_u32 v44, v48, v49, v50
v_max_u32 v44, v44, v51
v_cmp_eq_u32 vcc, -1, v44
s_cbranch_vccnz Lpf_109
v_smfmac_f32_16x16x64_bf16 v[72:75], v[48:51], v[96:103], v15
v_mov_b32 v112, v48
v_mov_b32 v113, v49
v_mov_b32 v114, v50
v_mov_b32 v115, v51
Lps_110:
s_waitcnt vmcnt(2)
v_max3_u32 v44, v52, v53, v54
v_max_u32 v44, v44, v55
v_cmp_eq_u32 vcc, -1, v44
s_cbranch_vccnz Lpf_111
v_smfmac_f32_16x16x64_bf16 v[72:75], v[52:55], v[104:111], v15
v_mov_b32 v116, v52
v_mov_b32 v117, v53
v_mov_b32 v118, v54
v_mov_b32 v119, v55
Lpd_107:
s_branch Lko_32
Lpf_109:
buffer_load_dwordx4 v[48:51], v11, s[4:7], s40 offen offset:0 sc1
s_sub_u32 s37, s37, 1
s_cbranch_scc1 Lend_1
Lps_112:
s_waitcnt vmcnt(3)
v_max3_u32 v44, v52, v53, v54
v_max_u32 v44, v44, v55
v_cmp_eq_u32 vcc, -1, v44
s_cbranch_vccnz Lpf_113
v_smfmac_f32_16x16x64_bf16 v[72:75], v[52:55], v[104:111], v15
v_mov_b32 v116, v52
v_mov_b32 v117, v53
v_mov_b32 v118, v54
v_mov_b32 v119, v55
Lps_114:
s_waitcnt vmcnt(2)
v_max3_u32 v44, v56, v57, v58
v_max_u32 v44, v44, v59
v_cmp_eq_u32 vcc, -1, v44
s_cbranch_vccnz Lpf_115
v_smfmac_f32_16x16x64_bf16 v[72:75], v[56:59], v[96:103], v15
v_mov_b32 v112, v56
v_mov_b32 v113, v57
v_mov_b32 v114, v58
v_mov_b32 v115, v59
s_branch Lpd_107
Lpf_111:
buffer_load_dwordx4 v[52:55], v11, s[4:7], s40 offen offset:1024 sc1
s_sub_u32 s37, s37, 1
s_cbranch_scc1 Lend_1
Lps_116:
s_waitcnt vmcnt(2)
v_max3_u32 v44, v56, v57, v58
v_max_u32 v44, v44, v59
v_cmp_eq_u32 vcc, -1, v44
s_cbranch_vccnz Lpf_117
Lps_118:
s_waitcnt vmcnt(1)
v_max3_u32 v44, v60, v61, v62
v_max_u32 v44, v44, v63
v_cmp_eq_u32 vcc, -1, v44
s_cbranch_vccnz Lpf_119
v_smfmac_f32_16x16x64_bf16 v[72:75], v[60:63], v[104:111], v15
v_mov_b32 v116, v60
v_mov_b32 v117, v61
v_mov_b32 v118, v62
v_mov_b32 v119, v63
s_branch Lpd_107
Lpf_113:
buffer_load_dwordx4 v[52:55], v11, s[4:7], s40 offen offset:1024 sc1
Lps_120:
s_waitcnt vmcnt(3)
v_max3_u32 v44, v56, v57, v58
v_max_u32 v44, v44, v59
v_cmp_eq_u32 vcc, -1, v44
s_cbranch_vccnz Lpf_121
v_smfmac_f32_16x16x64_bf16 v[72:75], v[56:59], v[96:103], v15
v_mov_b32 v112, v56
v_mov_b32 v113, v57
v_mov_b32 v114, v58
v_mov_b32 v115, v59
Lps_122:
s_waitcnt vmcnt(2)
v_max3_u32 v44, v60, v61, v62
v_max_u32 v44, v44, v63
v_cmp_eq_u32 vcc, -1, v44
s_cbranch_vccnz Lpf_123
v_smfmac_f32_16x16x64_bf16 v[72:75], v[60:63], v[104:111], v15
v_mov_b32 v116, v60
v_mov_b32 v117, v61
v_mov_b32 v118, v62
v_mov_b32 v119, v63
s_branch Lpd_107
Lpf_115:
buffer_load_dwordx4 v[56:59], v11, s[4:7], s40 offen offset:0 sc1
Lps_124:
s_waitcnt vmcnt(2)
v_max3_u32 v44, v60, v61, v62
v_max_u32 v44, v44, v63
v_cmp_eq_u32 vcc, -1, v44
s_cbranch_vccnz Lpf_125
Lps_126:
s_waitcnt vmcnt(1)
v_max3_u32 v44, v48, v49, v50
v_max_u32 v44, v44, v51
v_cmp_eq_u32 vcc, -1, v44
s_cbranch_vccnz Lpf_127
v_smfmac_f32_16x16x64_bf16 v[72:75], v[48:51], v[96:103], v15
v_mov_b32 v112, v48
v_mov_b32 v113, v49
v_mov_b32 v114, v50
v_mov_b32 v115, v51
s_branch Lpd_107
Lpf_117:
buffer_load_dwordx4 v[56:59], v11, s[4:7], s40 offen offset:0 sc1
Lps_128:
s_waitcnt vmcnt(2)
v_max3_u32 v44, v60, v61, v62
v_max_u32 v44, v44, v63
v_cmp_eq_u32 vcc, -1, v44
s_cbranch_vccnz Lpf_129
v_smfmac_f32_16x16x64_bf16 v[72:75], v[60:63], v[104:111], v15
v_mov_b32 v116, v60
v_mov_b32 v117, v61
v_mov_b32 v118, v62
v_mov_b32 v119, v63
s_branch Lpd_107
Lpf_119:
buffer_load_dwordx4 v[60:63], v11, s[4:7], s40 offen offset:1024 sc1
Lps_130:
s_waitcnt vmcnt(1)
v_max3_u32 v44, v52, v53, v54
v_max_u32 v44, v44, v55
v_cmp_eq_u32 vcc, -1, v44
s_cbranch_vccnz Lpf_131
v_smfmac_f32_16x16x64_bf16 v[72:75], v[52:55], v[104:111], v15
v_mov_b32 v116, v52
v_mov_b32 v117, v53
v_mov_b32 v118, v54
v_mov_b32 v119, v55
s_branch Lpd_107
Lpf_121:
buffer_load_dwordx4 v[56:59], v11, s[4:7], s40 offen offset:0 sc1
Lps_132:
s_waitcnt vmcnt(3)
v_max3_u32 v44, v60, v61, v62
v_max_u32 v44, v44, v63
v_cmp_eq_u32 vcc, -1, v44
s_cbranch_vccnz Lpf_133
v_smfmac_f32_16x16x64_bf16 v[72:75], v[60:63], v[104:111], v15
v_mov_b32 v116, v60
v_mov_b32 v117, v61
v_mov_b32 v118, v62
v_mov_b32 v119, v63
Lps_134:
s_waitcnt vmcnt(2)
v_max3_u32 v44, v48, v49, v50
v_max_u32 v44, v44, v51
v_cmp_eq_u32 vcc, -1, v44
s_cbranch_vccnz Lpf_135
v_smfmac_f32_16x16x64_bf16 v[72:75], v[48:51], v[96:103], v15
v_mov_b32 v112, v48
v_mov_b32 v113, v49
v_mov_b32 v114, v50
v_mov_b32 v115, v51
s_branch Lpd_107
Lpf_123:
buffer_load_dwordx4 v[60:63], v11, s[4:7], s40 offen offset:1024 sc1
Lps_136:
s_waitcnt vmcnt(2)
v_max3_u32 v44, v48, v49, v50
v_max_u32 v44, v44, v51
v_cmp_eq_u32 vcc, -1, v44
s_cbranch_vccnz Lpf_137
s_branch Lps_130
Lpf_125:
buffer_load_dwordx4 v[60:63], v11, s[4:7], s40 offen offset:1024 sc1
Lps_138:
s_waitcnt vmcnt(2)
v_max3_u32 v44, v48, v49, v50
v_max_u32 v44, v44, v51
v_cmp_eq_u32 vcc, -1, v44
s_cbranch_vccnz Lpf_139
v_smfmac_f32_16x16x64_bf16 v[72:75], v[48:51], v[96:103], v15
v_mov_b32 v112, v48
v_mov_b32 v113, v49
v_mov_b32 v114, v50
v_mov_b32 v115, v51
s_branch Lpd_107
Lpf_127:
buffer_load_dwordx4 v[48:51], v11, s[4:7], s40 offen offset:0 sc1
s_sub_u32 s37, s37, 1
s_cbranch_scc1 Lend_1
Lps_140:
s_waitcnt vmcnt(1)
v_max3_u32 v44, v56, v57, v58
v_max_u32 v44, v44, v59
v_cmp_eq_u32 vcc, -1, v44
s_cbranch_vccnz Lpf_141
v_smfmac_f32_16x16x64_bf16 v[72:75], v[56:59], v[96:103], v15
v_mov_b32 v112, v56
v_mov_b32 v113, v57
v_mov_b32 v114, v58
v_mov_b32 v115, v59
s_branch Lpd_107
Lpf_129:
buffer_load_dwordx4 v[60:63], v11, s[4:7], s40 offen offset:1024 sc1
s_branch Lps_110
Lpf_131:
buffer_load_dwordx4 v[52:55], v11, s[4:7], s40 offen offset:1024 sc1
s_sub_u32 s37, s37, 1
s_cbranch_scc1 Lend_1
s_branch Lps_118
Lpf_133:
buffer_load_dwordx4 v[60:63], v11, s[4:7], s40 offen offset:1024 sc1
s_branch Lps_108
Lpf_135:
buffer_load_dwordx4 v[48:51], v11, s[4:7], s40 offen offset:0 sc1
s_sub_u32 s37, s37, 1
s_cbranch_scc1 Lend_1
Lps_142:
s_waitcnt vmcnt(2)
v_max3_u32 v44, v52, v53, v54
v_max_u32 v44, v44, v55
v_cmp_eq_u32 vcc, -1, v44
s_cbranch_vccnz Lpf_143
s_branch Lps_140
Lpf_137:
buffer_load_dwordx4 v[48:51], v11, s[4:7], s40 offen offset:0 sc1
s_sub_u32 s37, s37, 1
s_cbranch_scc1 Lend_1
Lps_144:
s_waitcnt vmcnt(2)
v_max3_u32 v44, v52, v53, v54
v_max_u32 v44, v44, v55
v_cmp_eq_u32 vcc, -1, v44
s_cbranch_vccnz Lpf_145
v_smfmac_f32_16x16x64_bf16 v[72:75], v[52:55], v[104:111], v15
v_mov_b32 v116, v52
v_mov_b32 v117, v53
v_mov_b32 v118, v54
v_mov_b32 v119, v55
s_branch Lpd_107
Lpf_139:
buffer_load_dwordx4 v[48:51], v11, s[4:7], s40 offen offset:0 sc1
s_sub_u32 s37, s37, 1
s_cbranch_scc1 Lend_1
s_branch Lps_114
Lpf_141:
buffer_load_dwordx4 v[56:59], v11, s[4:7], s40 offen offset:0 sc1
s_branch Lps_126
Lpf_143:
buffer_load_dwordx4 v[52:55], v11, s[4:7], s40 offen offset:1024 sc1
Lps_146:
s_waitcnt vmcnt(2)
v_max3_u32 v44, v56, v57, v58
v_max_u32 v44, v44, v59
v_cmp_eq_u32 vcc, -1, v44
s_cbranch_vccnz Lpf_147
v_smfmac_f32_16x16x64_bf16 v[72:75], v[56:59], v[96:103], v15
v_mov_b32 v112, v56
v_mov_b32 v113, v57
v_mov_b32 v114, v58
v_mov_b32 v115, v59
s_branch Lpd_107
Lpf_145:
buffer_load_dwordx4 v[52:55], v11, s[4:7], s40 offen offset:1024 sc1
s_branch Lps_122
Lpf_147:
buffer_load_dwordx4 v[56:59], v11, s[4:7], s40 offen offset:0 sc1
s_branch Lps_134
Lvr_33:
buffer_load_dwordx2 v[120:121], v12, s[4:7], s40 offen sc1
buffer_load_dwordx2 v[122:123], v13, s[4:7], s40 offen sc1
s_sub_u32 s37, s37, 1
s_cbranch_scc1 Lend_1
s_waitcnt vmcnt(0)
v_max3_u32 v44, v120, v121, v122
v_max_u32 v44, v44, v123
v_cmp_eq_u32 vcc, -1, v44
s_cbranch_vccnz Lvr_33
s_branch Lvo_34
Lq_sc1_22:
Lq_148:
s_cmp_gt_u32 s36, 7
s_cbranch_scc1 Lqf_149
s_waitcnt vmcnt(0)
s_barrier
Lqf_149:
ds_read_b128 v[128:131], v22 offset:0
ds_read_b128 v[132:135], v22 offset:1024
ds_read_b128 v[136:139], v22 offset:2048
ds_read_b128 v[140:143], v22 offset:3072
ds_read_b128 v[144:147], v22 offset:4096
ds_read_b128 v[148:151], v22 offset:5120
ds_read_b128 v[152:155], v22 offset:6144
ds_read_b128 v[156:159], v22 offset:7168
ds_read_b128 v[160:163], v24 offset:0
ds_read_b128 v[164:167], v24 offset:1024
ds_read_b128 v[168:171], v25 offset:0
ds_read_b128 v[172:175], v25 offset:1024
ds_read_b128 v[176:179], v23 offset:0
ds_read_b128 v[180:183], v23 offset:1024
ds_read_b128 v[184:187], v23 offset:2048
ds_read_b128 v[188:191], v23 offset:3072
v_xor_b32 v22, 98304, v22
v_xor_b32 v24, 98304, v24
v_xor_b32 v25, 98304, v25
v_xor_b32 v23, 98304, v23
s_and_b32 s38, s36, 3
s_lshl_b32 s39, s38, 16
s_add_u32 s40, s39, s45
s_xor_b32 s42, s40, 0x20000
s_add_u32 s26, s36, 1
v_pk_mul_f32 v[64:65], 0, 0
v_pk_mul_f32 v[66:67], 0, 0
v_pk_mul_f32 v[68:69], 0, 0
v_pk_mul_f32 v[70:71], 0, 0
v_pk_mul_f32 v[72:73], 0, 0
v_pk_mul_f32 v[74:75], 0, 0
v_pk_mul_f32 v[76:77], 0, 0
v_pk_mul_f32 v[78:79], 0, 0
v_pk_mul_f32 v[80:81], 0, 0
v_pk_mul_f32 v[82:83], 0, 0
v_pk_mul_f32 v[84:85], 0, 0
v_pk_mul_f32 v[86:87], 0, 0
v_pk_mul_f32 v[88:89], 0, 0
v_pk_mul_f32 v[90:91], 0, 0
v_pk_mul_f32 v[92:93], 0, 0
v_pk_mul_f32 v[94:95], 0, 0
s_waitcnt vmcnt(0)
buffer_store_dword v197, v199, s[4:7], 0 offen sc1
v_add_u32 v197, 1, v197
s_mov_b64 exec, 15
buffer_load_dword v216, v192, s[4:7], s59 offen sc1
s_nop 5
buffer_load_dword v217, v192, s[4:7], s59 offen sc1
s_nop 5
buffer_load_dword v218, v192, s[4:7], s59 offen sc1
s_nop 5
buffer_load_dword v219, v192, s[4:7], s59 offen sc1
Lft_151:
s_waitcnt vmcnt(3)
v_cmp_gt_u32 vcc, s26, v216
buffer_load_dword v216, v192, s[4:7], s59 offen sc1
s_cbranch_vccz Lfg_150
s_waitcnt vmcnt(3)
v_cmp_gt_u32 vcc, s26, v217
buffer_load_dword v217, v192, s[4:7], s59 offen sc1
s_cbranch_vccz Lfg_150
s_waitcnt vmcnt(3)
v_cmp_gt_u32 vcc, s26, v218
buffer_load_dword v218, v192, s[4:7], s59 offen sc1
s_cbranch_vccz Lfg_150
s_waitcnt vmcnt(3)
v_cmp_gt_u32 vcc, s26, v219
buffer_load_dword v219, v192, s[4:7], s59 offen sc1
s_cbranch_vccz Lfg_150
s_sub_u32 s37, s37, 1
s_cbranch_scc1 Lend_1
s_branch Lft_151
Lfg_150:
s_mov_b64 exec, -1
buffer_load_dwordx4 v[48:51], v10, s[4:7], s40 offen offset:0 sc1
v_mfma_f32_16x16x32_bf16 v[200:203], v[204:207], v[204:207], 0
v_mfma_f32_16x16x32_bf16 v[200:203], v[204:207], v[204:207], 0
v_mfma_f32_16x16x32_bf16 v[200:203], v[204:207], v[204:207], 0
buffer_load_dwordx4 v[52:55], v10, s[4:7], s40 offen offset:1024 sc1
v_mfma_f32_16x16x32_bf16 v[200:203], v[204:207], v[204:207], 0
v_mfma_f32_16x16x32_bf16 v[200:203], v[204:207], v[204:207], 0
v_mfma_f32_16x16x32_bf16 v[200:203], v[204:207], v[204:207], 0
buffer_load_dwordx4 v[56:59], v10, s[4:7], s40 offen offset:2048 sc1
v_mfma_f32_16x16x32_bf16 v[200:203], v[204:207], v[204:207], 0
v_mfma_f32_16x16x32_bf16 v[200:203], v[204:207], v[204:207], 0
v_mfma_f32_16x16x32_bf16 v[200:203], v[204:207], v[204:207], 0
buffer_load_dwordx4 v[60:63], v10, s[4:7], s40 offen offset:3072 sc1
v_mfma_f32_16x16x32_bf16 v[200:203], v[204:207], v[204:207], 0
s_waitcnt vmcnt(3)
v_max3_u32 v44, v48, v49, v50
v_max_u32 v44, v44, v51
v_cmp_eq_u32 vcc, -1, v44
s_cbranch_vccnz Lpf_153
v_smfmac_f32_16x16x64_bf16 v[64:67], v[48:51], a[0:7], v15
v_smfmac_f32_16x16x64_bf16 v[68:71], v[48:51], a[8:15], v15
v_smfmac_f32_16x16x64_bf16 v[72:75], v[48:51], a[16:23], v15
s_waitcnt vmcnt(2)
v_max3_u32 v44, v52, v53, v54
v_max_u32 v44, v44, v55
v_cmp_eq_u32 vcc, -1, v44
v_smfmac_f32_16x16x64_bf16 v[76:79], v[48:51], a[24:31], v15
v_smfmac_f32_16x16x64_bf16 v[80:83], v[48:51], a[32:39], v15
v_smfmac_f32_16x16x64_bf16 v[84:87], v[48:51], a[40:47], v15
s_cbranch_vccnz Lpf_154
v_smfmac_f32_16x16x64_bf16 v[64:67], v[52:55], a[64:71], v15
v_smfmac_f32_16x16x64_bf16 v[68:71], v[52:55], a[72:79], v15
v_smfmac_f32_16x16x64_bf16 v[72:75], v[52:55], a[80:87], v15
s_waitcnt vmcnt(0)
v_max3_u32 v44, v56, v57, v58
v_max3_u32 v44, v44, v59, v60
v_max3_u32 v44, v44, v61, v62
v_max_u32 v44, v44, v63
v_cmp_eq_u32 vcc, -1, v44
v_smfmac_f32_16x16x64_bf16 v[76:79], v[52:55], a[88:95], v15
v_smfmac_f32_16x16x64_bf16 v[80:83], v[52:55], a[96:103], v15
v_smfmac_f32_16x16x64_bf16 v[84:87], v[52:55], a[104:111], v15
s_cbranch_vccnz Lpj_155
v_smfmac_f32_16x16x64_bf16 v[64:67], v[56:59], a[128:135], v15
s_nop 1
v_smfmac_f32_16x16x64_bf16 v[64:67], v[60:63], a[192:199], v15
s_nop 1
v_smfmac_f32_16x16x64_bf16 v[68:71], v[56:59], a[136:143], v15
s_nop 1
v_smfmac_f32_16x16x64_bf16 v[68:71], v[60:63], a[200:207], v15
s_nop 1
v_smfmac_f32_16x16x64_bf16 v[72:75], v[56:59], a[144:151], v15
v_add_f32 v96, v64, v66
v_add_f32 v97, v65, v67
v_smfmac_f32_16x16x64_bf16 v[72:75], v[60:63], a[208:215], v15
s_nop 1
v_smfmac_f32_16x16x64_bf16 v[76:79], v[56:59], a[152:159], v15
v_add_f32 v98, v68, v70
v_add_f32 v99, v69, v71
v_smfmac_f32_16x16x64_bf16 v[76:79], v[60:63], a[216:223], v15
ds_write_b128 v211, v[96:99] offset:0
s_nop 0
v_smfmac_f32_16x16x64_bf16 v[80:83], v[56:59], a[160:167], v15
v_add_f32 v100, v72, v74
v_add_f32 v101, v73, v75
v_smfmac_f32_16x16x64_bf16 v[80:83], v[60:63], a[224:231], v15
s_nop 1
v_smfmac_f32_16x16x64_bf16 v[84:87], v[56:59], a[168:175], v15
v_add_f32 v102, v76, v78
v_add_f32 v103, v77, v79
v_smfmac_f32_16x16x64_bf16 v[84:87], v[60:63], a[232:239], v15
ds_write_b128 v212, v[100:103] offset:0
s_nop 0
v_smfmac_f32_16x16x64_bf16 v[88:91], v[48:51], a[48:55], v15
v_add_f32 v104, v80, v82
v_add_f32 v105, v81, v83
v_smfmac_f32_16x16x64_bf16 v[88:91], v[52:55], a[112:119], v15
s_nop 1
v_add_f32 v106, v84, v86
v_add_f32 v107, v85, v87
ds_write_b128 v213, v[104:107] offset:0
Lpd_152:
v_smfmac_f32_16x16x64_bf16 v[88:91], v[56:59], a[176:183], v15
v_smfmac_f32_16x16x64_bf16 v[88:91], v[60:63], a[240:247], v15
v_smfmac_f32_16x16x64_bf16 v[92:95], v[48:51], a[56:63], v15
v_smfmac_f32_16x16x64_bf16 v[92:95], v[52:55], a[120:127], v15
s_waitcnt lgkmcnt(0)
s_barrier
ds_read_b128 v[76:79], v18 offset:0
ds_read_b128 v[80:83], v18 offset:1024
ds_read_b128 v[84:87], v18 offset:2048
v_smfmac_f32_16x16x64_bf16 v[92:95], v[56:59], a[184:191], v15
v_smfmac_f32_16x16x64_bf16 v[92:95], v[60:63], a[248:255], v15
v_mov_b32 v72, 0
v_mov_b32 v73, 0
v_mov_b32 v74, 0
v_mov_b32 v75, 0
v_add_f32 v108, v88, v90
v_add_f32 v109, v89, v91
s_nop 1
v_add_f32 v110, v92, v94
v_add_f32 v111, v93, v95
s_waitcnt lgkmcnt(0)
v_pk_add_f32 v[76:77], v[76:77], v[108:109]
v_pk_add_f32 v[80:81], v[80:81], v[84:85]
v_pk_add_f32 v[78:79], v[78:79], v[110:111]
v_pk_add_f32 v[82:83], v[82:83], v[86:87]
v_pk_add_f32 v[76:77], v[76:77], v[80:81]
v_pk_add_f32 v[78:79], v[78:79], v[82:83]
v_cvt_pk_bf16_f32 v76, v76, v77
v_cvt_pk_bf16_f32 v77, v78, v79
ds_write2st64_b32 v19, v76, v77 offset0:48 offset1:49
buffer_load_dwordx4 v[112:115], v11, s[4:7], s40 offen offset:0 sc1
buffer_load_dwordx4 v[116:119], v11, s[4:7], s40 offen offset:1024 sc1
s_waitcnt lgkmcnt(0)
s_barrier
ds_read_b64_tr_b16 v[96:97], v20 offset:12288
ds_read_b64_tr_b16 v[98:99], v20 offset:12544
ds_read_b64_tr_b16 v[100:101], v20 offset:12800
ds_read_b64_tr_b16 v[102:103], v20 offset:13056
ds_read_b64_tr_b16 v[104:105], v20 offset:13312
ds_read_b64_tr_b16 v[106:107], v20 offset:13568
ds_read_b64_tr_b16 v[108:109], v20 offset:13824
ds_read_b64_tr_b16 v[110:111], v20 offset:14080
s_waitcnt lgkmcnt(6)
v_mfma_f32_16x16x32_bf16 v[64:67], v[128:131], v[96:99], 0
v_mfma_f32_16x16x32_bf16 v[68:71], v[144:147], v[96:99], 0
s_waitcnt lgkmcnt(4)
buffer_load_dwordx4 v[48:51], v11, s[4:7], s40 offen offset:0 sc1
v_mfma_f32_16x16x32_bf16 v[64:67], v[132:135], v[100:103], v[64:67]
v_mfma_f32_16x16x32_bf16 v[68:71], v[148:151], v[100:103], v[68:71]
s_waitcnt lgkmcnt(2)
buffer_load_dwordx4 v[52:55], v11, s[4:7], s40 offen offset:1024 sc1
v_mfma_f32_16x16x32_bf16 v[64:67], v[136:139], v[104:107], v[64:67]
v_mfma_f32_16x16x32_bf16 v[68:71], v[152:155], v[104:107], v[68:71]
s_waitcnt lgkmcnt(0)
s_waitcnt vmcnt(2)
v_max3_u32 v44, v112, v113, v114
v_max3_u32 v44, v44, v115, v116
v_max3_u32 v44, v44, v117, v118
v_max_u32 v44, v44, v119
v_cmp_eq_u32 vcc, -1, v44
v_mfma_f32_16x16x32_bf16 v[64:67], v[140:143], v[108:111], v[64:67]
v_mfma_f32_16x16x32_bf16 v[68:71], v[156:159], v[108:111], v[68:71]
s_cbranch_vccnz Lkr_156
v_smfmac_f32_16x16x64_bf16 v[72:75], v[112:115], v[96:103], v15
v_smfmac_f32_16x16x64_bf16 v[72:75], v[116:119], v[104:111], v15
Lko_157:
s_nop 3
v_max3_f32 v45, v64, v65, v66
v_max3_f32 v45, v45, v67, v68
v_max3_f32 v45, v45, v69, v70
v_max_f32 v45, v45, v71
v_pk_add_f32 v[72:73], v[72:73], v[74:75]
v_max3_f32 v46, v45, v72, v73
v_max3_f32 v47, v45, v72, v73
buffer_load_dwordx2 v[120:121], v12, s[4:7], s40 offen sc1
buffer_load_dwordx2 v[122:123], v13, s[4:7], s40 offen sc1
v_permlane32_swap_b32 v46, v47
v_max_f32 v45, v46, v47
v_max_f32 v46, v46, v47
s_nop 1
v_permlane16_swap_b32 v45, v46
v_max_f32 v45, v45, v46
v_mul_f32 v46, s49, v45
v_pk_fma_f32 v[64:65], v[64:65], s[48:49], v[46:47] op_sel_hi:[1,0,0]
v_pk_fma_f32 v[66:67], v[66:67], s[48:49], v[46:47] op_sel_hi:[1,0,0]
v_pk_fma_f32 v[68:69], v[68:69], s[48:49], v[46:47] op_sel_hi:[1,0,0]
v_pk_fma_f32 v[70:71], v[70:71], s[48:49], v[46:47] op_sel_hi:[1,0,0]
v_pk_fma_f32 v[72:73], v[72:73], s[48:49], v[46:47] op_sel_hi:[1,0,0]
v_exp_f32 v64, v64
v_exp_f32 v65, v65
v_exp_f32 v66, v66
v_exp_f32 v67, v67
v_exp_f32 v68, v68
buffer_store_dword v197, v193, s[4:7], s59 offen sc1
v_exp_f32 v69, v69
v_exp_f32 v70, v70
v_exp_f32 v71, v71
v_exp_f32 v72, v72
v_exp_f32 v73, v73
v_cvt_pk_bf16_f32 v76, v64, v65
v_cvt_pk_bf16_f32 v77, v66, v67
v_cvt_pk_bf16_f32 v78, v68, v69
v_cvt_pk_bf16_f32 v79, v70, v71
v_cvt_pk_bf16_f32 v2, v72, v73
v_cvt_pk_bf16_f32 v7, v72, v73
v_mfma_f32_16x16x32_bf16 v[84:87], v[32:35], v[76:79], 0
v_mfma_f32_16x16x32_bf16 v[84:87], v[32:35], v[2:5], v[84:87]
v_mfma_f32_16x16x32_bf16 v[96:99], v[160:163], v[76:79], 0
s_waitcnt vmcnt(1)
v_max3_u32 v44, v120, v121, v122
v_max_u32 v44, v44, v123
v_cmp_eq_u32 vcc, -1, v44
v_mfma_f32_16x16x32_bf16 v[100:103], v[164:167], v[76:79], 0
s_cbranch_vccnz Lvr_158
Lvo_159:
v_mfma_f32_16x16x32_bf16 v[96:99], v[120:123], v[2:5], v[96:99]
v_mfma_f32_16x16x32_bf16 v[100:103], v[120:123], v[6:9], v[100:103]
v_rcp_f32 v46, v84
s_nop 5
v_pk_mul_f32 v[96:97], v[96:97], v[46:47] op_sel_hi:[1,0]
v_pk_mul_f32 v[98:99], v[98:99], v[46:47] op_sel_hi:[1,0]
v_pk_mul_f32 v[100:101], v[100:101], v[46:47] op_sel_hi:[1,0]
v_pk_mul_f32 v[102:103], v[102:103], v[46:47] op_sel_hi:[1,0]
v_cvt_pk_bf16_f32 v124, v96, v97
v_cvt_pk_bf16_f32 v125, v98, v99
v_cvt_pk_bf16_f32 v126, v100, v101
v_cvt_pk_bf16_f32 v127, v102, v103
buffer_store_dwordx4 v[124:127], v14, s[4:7], s40 offen sc1
s_barrier
buffer_store_dwordx4 v[28:31], v14, s[4:7], s42 offen sc1
s_cmp_eq_u32 s36, 6
s_cbranch_scc1 Lp2_162
Lp1_163:
s_add_u32 s27, s27, 1
s_min_u32 s27, s27, 64
v_add_u32 v44, v209, v210
v_cmp_gt_u32 vcc, s27, v44
v_mov_b32 v72, 0
v_mov_b32 v73, 0
v_mov_b32 v74, 0
v_mov_b32 v75, 0
s_add_u32 s38, s36, 2
s_and_b32 s38, s38, 3
s_lshl_b32 s88, s38, 18
s_add_u32 s88, s88, s46
s_add_u32 s89, s88, 0x100000
s_cmp_lt_u32 s36, 62
s_cselect_b32 s53, s47, 0x70000000
s_cbranch_vccnz Lpw_160
Lpk_161:
buffer_store_dwordx2 v[28:29], v198, s[4:7], s88 offen sc1
buffer_store_dwordx2 v[28:29], v198, s[4:7], s89 offen sc1
v_mfma_f32_16x16x32_bf16 v[64:67], v[128:131], v[176:179], v[36:39]
v_mfma_f32_16x16x32_bf16 v[68:71], v[144:147], v[176:179], v[40:43]
s_mov_b32 m0, s57
s_add_u32 s52, s53, 3072
buffer_load_dwordx4 v21, s[4:7], s53 offen offset:0 sc1 lds
v_mfma_f32_16x16x32_bf16 v[64:67], v[132:135], v[180:183], v[64:67]
v_mfma_f32_16x16x32_bf16 v[68:71], v[148:151], v[180:183], v[68:71]
v_mfma_f32_16x16x32_bf16 v[64:67], v[136:139], v[184:187], v[64:67]
v_mfma_f32_16x16x32_bf16 v[68:71], v[152:155], v[184:187], v[68:71]
buffer_load_dwordx4 v21, s[4:7], s53 offen offset:1024 sc1 lds
v_mfma_f32_16x16x32_bf16 v[64:67], v[140:143], v[188:191], v[64:67]
v_mfma_f32_16x16x32_bf16 v[68:71], v[156:159], v[188:191], v[68:71]
v_smfmac_f32_16x16x64_bf16 v[72:75], v[112:115], v[176:183], v15
v_smfmac_f32_16x16x64_bf16 v[72:75], v[116:119], v[184:191], v15
s_and_b32 s38, s36, 7
s_lshl_b32 s38, s38, 18
s_add_u32 s50, s38, 83886080
buffer_load_dwordx4 v21, s[4:7], s53 offen offset:2048 sc1 lds
s_nop 1
v_max3_f32 v45, v64, v65, v66
v_max3_f32 v45, v45, v67, v68
v_max3_f32 v45, v45, v69, v70
v_max_f32 v45, v45, v71
v_pk_add_f32 v[72:73], v[72:73], v[74:75]
v_max3_f32 v46, v45, v72, v73
v_max3_f32 v47, v45, v72, v73
s_nop 1
v_permlane32_swap_b32 v46, v47
v_max_f32 v45, v46, v47
v_max_f32 v46, v46, v47
s_nop 1
v_permlane16_swap_b32 v45, v46
v_max_f32 v45, v45, v46
v_mul_f32 v46, s49, v45
s_add_u32 m0, s57, 3072
s_xor_b32 s57, s57, 98304
buffer_load_dwordx4 v21, s[4:7], s52 offen offset:0 sc1 lds
v_pk_fma_f32 v[64:65], v[64:65], s[48:49], v[46:47] op_sel_hi:[1,0,0]
v_pk_fma_f32 v[66:67], v[66:67], s[48:49], v[46:47] op_sel_hi:[1,0,0]
v_pk_fma_f32 v[68:69], v[68:69], s[48:49], v[46:47] op_sel_hi:[1,0,0]
v_pk_fma_f32 v[70:71], v[70:71], s[48:49], v[46:47] op_sel_hi:[1,0,0]
v_pk_fma_f32 v[72:73], v[72:73], s[48:49], v[46:47] op_sel_hi:[1,0,0]
v_exp_f32 v64, v64
v_exp_f32 v65, v65
v_exp_f32 v66, v66
v_exp_f32 v67, v67
v_exp_f32 v68, v68
buffer_load_dwordx4 v21, s[4:7], s52 offen offset:1024 sc1 lds
v_exp_f32 v69, v69
v_exp_f32 v70, v70
v_exp_f32 v71, v71
v_exp_f32 v72, v72
v_exp_f32 v73, v73
buffer_load_dwordx4 v21, s[4:7], s52 offen offset:2048 sc1 lds
s_add_u32 s47, s47, 786432
buffer_load_dword v209, v208, s[4:7], 0 offen sc1
v_cvt_pk_bf16_f32 v76, v64, v65
v_cvt_pk_bf16_f32 v77, v66, v67
v_cvt_pk_bf16_f32 v78, v68, v69
v_cvt_pk_bf16_f32 v79, v70, v71
v_cvt_pk_bf16_f32 v2, v72, v73
v_cvt_pk_bf16_f32 v7, v72, v73
v_mfma_f32_16x16x32_bf16 v[84:87], v[32:35], v[76:79], 0
v_mfma_f32_16x16x32_bf16 v[84:87], v[32:35], v[2:5], v[84:87]
v_mfma_f32_16x16x32_bf16 v[96:99], v[160:163], v[76:79], 0
v_mfma_f32_16x16x32_bf16 v[100:103], v[164:167], v[76:79], 0
v_mfma_f32_16x16x32_bf16 v[104:107], v[168:171], v[76:79], 0
v_mfma_f32_16x16x32_bf16 v[108:111], v[172:175], v[76:79], 0
v_mfma_f32_16x16x32_bf16 v[96:99], v[120:123], v[2:5], v[96:99]
v_mfma_f32_16x16x32_bf16 v[100:103], v[120:123], v[6:9], v[100:103]
v_mfma_f32_16x16x32_bf16 v[104:107], v[120:123], v[0:3], v[104:107]
v_mfma_f32_16x16x32_bf16 v[108:111], v[120:123], v[4:7], v[108:111]
v_rcp_f32 v46, v84
s_nop 3
v_pk_mul_f32 v[96:97], v[96:97], v[46:47] op_sel_hi:[1,0]
v_pk_mul_f32 v[98:99], v[98:99], v[46:47] op_sel_hi:[1,0]
v_pk_mul_f32 v[100:101], v[100:101], v[46:47] op_sel_hi:[1,0]
v_pk_mul_f32 v[102:103], v[102:103], v[46:47] op_sel_hi:[1,0]
v_pk_mul_f32 v[104:105], v[104:105], v[46:47] op_sel_hi:[1,0]
v_pk_mul_f32 v[106:107], v[106:107], v[46:47] op_sel_hi:[1,0]
v_pk_mul_f32 v[108:109], v[108:109], v[46:47] op_sel_hi:[1,0]
v_pk_mul_f32 v[110:111], v[110:111], v[46:47] op_sel_hi:[1,0]
v_cvt_pk_bf16_f32 v96, v96, v97
v_cvt_pk_bf16_f32 v97, v98, v99
v_cvt_pk_bf16_f32 v98, v100, v101
v_cvt_pk_bf16_f32 v99, v102, v103
v_cvt_pk_bf16_f32 v100, v104, v105
v_cvt_pk_bf16_f32 v101, v106, v107
v_cvt_pk_bf16_f32 v102, v108, v109
v_cvt_pk_bf16_f32 v103, v110, v111
buffer_store_dwordx4 v[96:99], v26, s[4:7], s50 offen sc1
buffer_store_dwordx4 v[100:103], v27, s[4:7], s50 offen sc1
s_add_u32 s36, s36, 1
s_cmp_lt_u32 s36, 64
s_cbranch_scc1 Lq_148
s_waitcnt vmcnt(0)
buffer_store_dword v197, v199, s[4:7], 0 offen sc1
s_branch Lend_1
Lp2_162:
s_add_u32 s27, s27, 1
Lbw_164:
buffer_load_dword v209, v208, s[4:7], 0 offen sc1
s_waitcnt vmcnt(0)
v_add_u32 v44, v209, v210
v_cmp_gt_u32 vcc, s27, v44
s_cbranch_vccz Lbo_165
s_sub_u32 s37, s37, 1
s_cbranch_scc1 Lend_1
s_sleep 2
s_branch Lbw_164
Lbo_165:
s_mov_b32 m0, s57
s_add_u32 s52, s47, 3072
buffer_load_dwordx4 v21, s[4:7], s47 offen offset:0 sc1 lds
buffer_load_dwordx4 v21, s[4:7], s47 offen offset:1024 sc1 lds
buffer_load_dwordx4 v21, s[4:7], s47 offen offset:2048 sc1 lds
s_add_u32 m0, s57, 3072
s_xor_b32 s57, s57, 98304
buffer_load_dwordx4 v21, s[4:7], s52 offen offset:0 sc1 lds
buffer_load_dwordx4 v21, s[4:7], s52 offen offset:1024 sc1 lds
buffer_load_dwordx4 v21, s[4:7], s52 offen offset:2048 sc1 lds
s_add_u32 s47, s47, 786432
s_branch Lp1_163
Lpw_160:
Lbw_166:
buffer_load_dword v209, v208, s[4:7], 0 offen sc1
s_waitcnt vmcnt(0)
v_add_u32 v44, v209, v210
v_cmp_gt_u32 vcc, s27, v44
s_cbranch_vccz Lbo_167
s_sub_u32 s37, s37, 1
s_cbranch_scc1 Lend_1
s_sleep 2
s_branch Lbw_166
Lbo_167:
s_branch Lpk_161
Lpj_155:
buffer_load_dwordx4 v[56:59], v10, s[4:7], s40 offen offset:2048 sc1
buffer_load_dwordx4 v[60:63], v10, s[4:7], s40 offen offset:3072 sc1
s_sub_u32 s37, s37, 1
s_cbranch_scc1 Lend_1
s_branch Lps_168
Lpf_153:
buffer_load_dwordx4 v[48:51], v10, s[4:7], s40 offen offset:0 sc1
s_sub_u32 s37, s37, 1
s_cbranch_scc1 Lend_1
Lps_169:
s_waitcnt vmcnt(3)
v_max3_u32 v44, v52, v53, v54
v_max_u32 v44, v44, v55
v_cmp_eq_u32 vcc, -1, v44
s_cbranch_vccnz Lpf_170
v_smfmac_f32_16x16x64_bf16 v[64:67], v[52:55], a[64:71], v15
v_smfmac_f32_16x16x64_bf16 v[68:71], v[52:55], a[72:79], v15
v_smfmac_f32_16x16x64_bf16 v[72:75], v[52:55], a[80:87], v15
v_smfmac_f32_16x16x64_bf16 v[76:79], v[52:55], a[88:95], v15
v_smfmac_f32_16x16x64_bf16 v[80:83], v[52:55], a[96:103], v15
v_smfmac_f32_16x16x64_bf16 v[84:87], v[52:55], a[104:111], v15
Lps_171:
s_waitcnt vmcnt(2)
v_max3_u32 v44, v56, v57, v58
v_max_u32 v44, v44, v59
v_cmp_eq_u32 vcc, -1, v44
s_cbranch_vccnz Lpf_172
v_smfmac_f32_16x16x64_bf16 v[64:67], v[56:59], a[128:135], v15
v_smfmac_f32_16x16x64_bf16 v[68:71], v[56:59], a[136:143], v15
v_smfmac_f32_16x16x64_bf16 v[72:75], v[56:59], a[144:151], v15
v_smfmac_f32_16x16x64_bf16 v[76:79], v[56:59], a[152:159], v15
v_smfmac_f32_16x16x64_bf16 v[80:83], v[56:59], a[160:167], v15
v_smfmac_f32_16x16x64_bf16 v[84:87], v[56:59], a[168:175], v15
Lps_173:
s_waitcnt vmcnt(1)
v_max3_u32 v44, v60, v61, v62
v_max_u32 v44, v44, v63
v_cmp_eq_u32 vcc, -1, v44
s_cbranch_vccnz Lpf_174
v_smfmac_f32_16x16x64_bf16 v[64:67], v[60:63], a[192:199], v15
v_smfmac_f32_16x16x64_bf16 v[68:71], v[60:63], a[200:207], v15
v_smfmac_f32_16x16x64_bf16 v[72:75], v[60:63], a[208:215], v15
v_smfmac_f32_16x16x64_bf16 v[76:79], v[60:63], a[216:223], v15
v_smfmac_f32_16x16x64_bf16 v[80:83], v[60:63], a[224:231], v15
v_smfmac_f32_16x16x64_bf16 v[84:87], v[60:63], a[232:239], v15
Lps_175:
s_waitcnt vmcnt(0)
v_max3_u32 v44, v48, v49, v50
v_max_u32 v44, v44, v51
v_cmp_eq_u32 vcc, -1, v44
s_cbranch_vccnz Lpf_176
v_smfmac_f32_16x16x64_bf16 v[64:67], v[48:51], a[0:7], v15
s_nop 1
v_smfmac_f32_16x16x64_bf16 v[68:71], v[48:51], a[8:15], v15
s_nop 1
v_smfmac_f32_16x16x64_bf16 v[72:75], v[48:51], a[16:23], v15
s_nop 1
v_smfmac_f32_16x16x64_bf16 v[76:79], v[48:51], a[24:31], v15
v_add_f32 v96, v64, v66
v_add_f32 v97, v65, v67
v_smfmac_f32_16x16x64_bf16 v[80:83], v[48:51], a[32:39], v15
v_add_f32 v98, v68, v70
v_add_f32 v99, v69, v71
v_smfmac_f32_16x16x64_bf16 v[84:87], v[48:51], a[40:47], v15
v_add_f32 v100, v72, v74
v_add_f32 v101, v73, v75
ds_write_b128 v211, v[96:99] offset:0
v_smfmac_f32_16x16x64_bf16 v[88:91], v[48:51], a[48:55], v15
v_add_f32 v102, v76, v78
v_add_f32 v103, v77, v79
v_add_f32 v104, v80, v82
v_add_f32 v105, v81, v83
ds_write_b128 v212, v[100:103] offset:0
v_smfmac_f32_16x16x64_bf16 v[88:91], v[52:55], a[112:119], v15
v_add_f32 v106, v84, v86
v_add_f32 v107, v85, v87
ds_write_b128 v213, v[104:107] offset:0
s_branch Lpd_152
Lpf_154:
buffer_load_dwordx4 v[52:55], v10, s[4:7], s40 offen offset:1024 sc1
s_sub_u32 s37, s37, 1
s_cbranch_scc1 Lend_1
Lps_177:
s_waitcnt vmcnt(2)
v_max3_u32 v44, v56, v57, v58
v_max_u32 v44, v44, v59
v_cmp_eq_u32 vcc, -1, v44
s_cbranch_vccnz Lpf_178
v_smfmac_f32_16x16x64_bf16 v[64:67], v[56:59], a[128:135], v15
v_smfmac_f32_16x16x64_bf16 v[68:71], v[56:59], a[136:143], v15
v_smfmac_f32_16x16x64_bf16 v[72:75], v[56:59], a[144:151], v15
v_smfmac_f32_16x16x64_bf16 v[76:79], v[56:59], a[152:159], v15
v_smfmac_f32_16x16x64_bf16 v[80:83], v[56:59], a[160:167], v15
v_smfmac_f32_16x16x64_bf16 v[84:87], v[56:59], a[168:175], v15
Lps_179:
s_waitcnt vmcnt(1)
v_max3_u32 v44, v60, v61, v62
v_max_u32 v44, v44, v63
v_cmp_eq_u32 vcc, -1, v44
s_cbranch_vccnz Lpf_180
v_smfmac_f32_16x16x64_bf16 v[64:67], v[60:63], a[192:199], v15
v_smfmac_f32_16x16x64_bf16 v[68:71], v[60:63], a[200:207], v15
v_smfmac_f32_16x16x64_bf16 v[72:75], v[60:63], a[208:215], v15
v_smfmac_f32_16x16x64_bf16 v[76:79], v[60:63], a[216:223], v15
v_smfmac_f32_16x16x64_bf16 v[80:83], v[60:63], a[224:231], v15
v_smfmac_f32_16x16x64_bf16 v[84:87], v[60:63], a[232:239], v15
Lps_181:
s_waitcnt vmcnt(0)
v_max3_u32 v44, v52, v53, v54
v_max_u32 v44, v44, v55
v_cmp_eq_u32 vcc, -1, v44
s_cbranch_vccnz Lpf_182
v_smfmac_f32_16x16x64_bf16 v[64:67], v[52:55], a[64:71], v15
s_nop 1
v_smfmac_f32_16x16x64_bf16 v[68:71], v[52:55], a[72:79], v15
s_nop 1
v_smfmac_f32_16x16x64_bf16 v[72:75], v[52:55], a[80:87], v15
s_nop 1
v_smfmac_f32_16x16x64_bf16 v[76:79], v[52:55], a[88:95], v15
v_add_f32 v96, v64, v66
v_add_f32 v97, v65, v67
v_smfmac_f32_16x16x64_bf16 v[80:83], v[52:55], a[96:103], v15
v_add_f32 v98, v68, v70
v_add_f32 v99, v69, v71
v_smfmac_f32_16x16x64_bf16 v[84:87], v[52:55], a[104:111], v15
v_add_f32 v100, v72, v74
v_add_f32 v101, v73, v75
ds_write_b128 v211, v[96:99] offset:0
v_smfmac_f32_16x16x64_bf16 v[88:91], v[48:51], a[48:55], v15
v_add_f32 v102, v76, v78
v_add_f32 v103, v77, v79
v_add_f32 v104, v80, v82
v_add_f32 v105, v81, v83
ds_write_b128 v212, v[100:103] offset:0
v_smfmac_f32_16x16x64_bf16 v[88:91], v[52:55], a[112:119], v15
v_add_f32 v106, v84, v86
v_add_f32 v107, v85, v87
ds_write_b128 v213, v[104:107] offset:0
s_branch Lpd_152
Lpf_170:
buffer_load_dwordx4 v[52:55], v10, s[4:7], s40 offen offset:1024 sc1
Lps_183:
s_waitcnt vmcnt(3)
v_max3_u32 v44, v56, v57, v58
v_max_u32 v44, v44, v59
v_cmp_eq_u32 vcc, -1, v44
s_cbranch_vccnz Lpf_184
v_smfmac_f32_16x16x64_bf16 v[64:67], v[56:59], a[128:135], v15
v_smfmac_f32_16x16x64_bf16 v[68:71], v[56:59], a[136:143], v15
v_smfmac_f32_16x16x64_bf16 v[72:75], v[56:59], a[144:151], v15
v_smfmac_f32_16x16x64_bf16 v[76:79], v[56:59], a[152:159], v15
v_smfmac_f32_16x16x64_bf16 v[80:83], v[56:59], a[160:167], v15
v_smfmac_f32_16x16x64_bf16 v[84:87], v[56:59], a[168:175], v15
Lps_185:
s_waitcnt vmcnt(2)
v_max3_u32 v44, v60, v61, v62
v_max_u32 v44, v44, v63
v_cmp_eq_u32 vcc, -1, v44
s_cbranch_vccnz Lpf_186
v_smfmac_f32_16x16x64_bf16 v[64:67], v[60:63], a[192:199], v15
v_smfmac_f32_16x16x64_bf16 v[68:71], v[60:63], a[200:207], v15
v_smfmac_f32_16x16x64_bf16 v[72:75], v[60:63], a[208:215], v15
v_smfmac_f32_16x16x64_bf16 v[76:79], v[60:63], a[216:223], v15
v_smfmac_f32_16x16x64_bf16 v[80:83], v[60:63], a[224:231], v15
v_smfmac_f32_16x16x64_bf16 v[84:87], v[60:63], a[232:239], v15
Lps_187:
s_waitcnt vmcnt(1)
v_max3_u32 v44, v48, v49, v50
v_max_u32 v44, v44, v51
v_cmp_eq_u32 vcc, -1, v44
s_cbranch_vccnz Lpf_188
v_smfmac_f32_16x16x64_bf16 v[64:67], v[48:51], a[0:7], v15
v_smfmac_f32_16x16x64_bf16 v[68:71], v[48:51], a[8:15], v15
v_smfmac_f32_16x16x64_bf16 v[72:75], v[48:51], a[16:23], v15
v_smfmac_f32_16x16x64_bf16 v[76:79], v[48:51], a[24:31], v15
v_smfmac_f32_16x16x64_bf16 v[80:83], v[48:51], a[32:39], v15
v_smfmac_f32_16x16x64_bf16 v[84:87], v[48:51], a[40:47], v15
s_branch Lps_181
Lpf_172:
buffer_load_dwordx4 v[56:59], v10, s[4:7], s40 offen offset:2048 sc1
Lps_189:
s_waitcnt vmcnt(2)
v_max3_u32 v44, v60, v61, v62
v_max_u32 v44, v44, v63
v_cmp_eq_u32 vcc, -1, v44
s_cbranch_vccnz Lpf_190
v_smfmac_f32_16x16x64_bf16 v[64:67], v[60:63], a[192:199], v15
v_smfmac_f32_16x16x64_bf16 v[68:71], v[60:63], a[200:207], v15
v_smfmac_f32_16x16x64_bf16 v[72:75], v[60:63], a[208:215], v15
v_smfmac_f32_16x16x64_bf16 v[76:79], v[60:63], a[216:223], v15
v_smfmac_f32_16x16x64_bf16 v[80:83], v[60:63], a[224:231], v15
v_smfmac_f32_16x16x64_bf16 v[84:87], v[60:63], a[232:239], v15
Lps_191:
s_waitcnt vmcnt(1)
v_max3_u32 v44, v48, v49, v50
v_max_u32 v44, v44, v51
v_cmp_eq_u32 vcc, -1, v44
s_cbranch_vccnz Lpf_192
v_smfmac_f32_16x16x64_bf16 v[64:67], v[48:51], a[0:7], v15
v_smfmac_f32_16x16x64_bf16 v[68:71], v[48:51], a[8:15], v15
v_smfmac_f32_16x16x64_bf16 v[72:75], v[48:51], a[16:23], v15
v_smfmac_f32_16x16x64_bf16 v[76:79], v[48:51], a[24:31], v15
v_smfmac_f32_16x16x64_bf16 v[80:83], v[48:51], a[32:39], v15
v_smfmac_f32_16x16x64_bf16 v[84:87], v[48:51], a[40:47], v15
Lps_193:
s_waitcnt vmcnt(0)
v_max3_u32 v44, v56, v57, v58
v_max_u32 v44, v44, v59
v_cmp_eq_u32 vcc, -1, v44
s_cbranch_vccnz Lpf_194
v_smfmac_f32_16x16x64_bf16 v[64:67], v[56:59], a[128:135], v15
s_nop 1
v_smfmac_f32_16x16x64_bf16 v[68:71], v[56:59], a[136:143], v15
s_nop 1
v_smfmac_f32_16x16x64_bf16 v[72:75], v[56:59], a[144:151], v15
s_nop 1
v_smfmac_f32_16x16x64_bf16 v[76:79], v[56:59], a[152:159], v15
v_add_f32 v96, v64, v66
v_add_f32 v97, v65, v67
v_smfmac_f32_16x16x64_bf16 v[80:83], v[56:59], a[160:167], v15
v_add_f32 v98, v68, v70
v_add_f32 v99, v69, v71
v_smfmac_f32_16x16x64_bf16 v[84:87], v[56:59], a[168:175], v15
v_add_f32 v100, v72, v74
v_add_f32 v101, v73, v75
ds_write_b128 v211, v[96:99] offset:0
v_smfmac_f32_16x16x64_bf16 v[88:91], v[48:51], a[48:55], v15
v_add_f32 v102, v76, v78
v_add_f32 v103, v77, v79
v_add_f32 v104, v80, v82
v_add_f32 v105, v81, v83
ds_write_b128 v212, v[100:103] offset:0
v_smfmac_f32_16x16x64_bf16 v[88:91], v[52:55], a[112:119], v15
v_add_f32 v106, v84, v86
v_add_f32 v107, v85, v87
ds_write_b128 v213, v[104:107] offset:0
s_branch Lpd_152
Lpf_174:
buffer_load_dwordx4 v[60:63], v10, s[4:7], s40 offen offset:3072 sc1
Lps_195:
s_waitcnt vmcnt(1)
v_max3_u32 v44, v48, v49, v50
v_max_u32 v44, v44, v51
v_cmp_eq_u32 vcc, -1, v44
s_cbranch_vccnz Lpf_196
v_smfmac_f32_16x16x64_bf16 v[64:67], v[48:51], a[0:7], v15
v_smfmac_f32_16x16x64_bf16 v[68:71], v[48:51], a[8:15], v15
v_smfmac_f32_16x16x64_bf16 v[72:75], v[48:51], a[16:23], v15
v_smfmac_f32_16x16x64_bf16 v[76:79], v[48:51], a[24:31], v15
v_smfmac_f32_16x16x64_bf16 v[80:83], v[48:51], a[32:39], v15
v_smfmac_f32_16x16x64_bf16 v[84:87], v[48:51], a[40:47], v15
Lps_197:
s_waitcnt vmcnt(0)
v_max3_u32 v44, v60, v61, v62
v_max_u32 v44, v44, v63
v_cmp_eq_u32 vcc, -1, v44
s_cbranch_vccnz Lpf_198
v_smfmac_f32_16x16x64_bf16 v[64:67], v[60:63], a[192:199], v15
s_nop 1
v_smfmac_f32_16x16x64_bf16 v[68:71], v[60:63], a[200:207], v15
s_nop 1
v_smfmac_f32_16x16x64_bf16 v[72:75], v[60:63], a[208:215], v15
s_nop 1
v_smfmac_f32_16x16x64_bf16 v[76:79], v[60:63], a[216:223], v15
v_add_f32 v96, v64, v66
v_add_f32 v97, v65, v67
v_smfmac_f32_16x16x64_bf16 v[80:83], v[60:63], a[224:231], v15
v_add_f32 v98, v68, v70
v_add_f32 v99, v69, v71
v_smfmac_f32_16x16x64_bf16 v[84:87], v[60:63], a[232:239], v15
v_add_f32 v100, v72, v74
v_add_f32 v101, v73, v75
ds_write_b128 v211, v[96:99] offset:0
v_smfmac_f32_16x16x64_bf16 v[88:91], v[48:51], a[48:55], v15
v_add_f32 v102, v76, v78
v_add_f32 v103, v77, v79
v_add_f32 v104, v80, v82
v_add_f32 v105, v81, v83
ds_write_b128 v212, v[100:103] offset:0
v_smfmac_f32_16x16x64_bf16 v[88:91], v[52:55], a[112:119], v15
v_add_f32 v106, v84, v86
v_add_f32 v107, v85, v87
ds_write_b128 v213, v[104:107] offset:0
s_branch Lpd_152
Lpf_176:
buffer_load_dwordx4 v[48:51], v10, s[4:7], s40 offen offset:0 sc1
s_sub_u32 s37, s37, 1
s_cbranch_scc1 Lend_1
s_branch Lps_175
Lpf_178:
buffer_load_dwordx4 v[56:59], v10, s[4:7], s40 offen offset:2048 sc1
Lps_199:
s_waitcnt vmcnt(2)
v_max3_u32 v44, v60, v61, v62
v_max_u32 v44, v44, v63
v_cmp_eq_u32 vcc, -1, v44
s_cbranch_vccnz Lpf_200
v_smfmac_f32_16x16x64_bf16 v[64:67], v[60:63], a[192:199], v15
v_smfmac_f32_16x16x64_bf16 v[68:71], v[60:63], a[200:207], v15
v_smfmac_f32_16x16x64_bf16 v[72:75], v[60:63], a[208:215], v15
v_smfmac_f32_16x16x64_bf16 v[76:79], v[60:63], a[216:223], v15
v_smfmac_f32_16x16x64_bf16 v[80:83], v[60:63], a[224:231], v15
v_smfmac_f32_16x16x64_bf16 v[84:87], v[60:63], a[232:239], v15
Lps_201:
s_waitcnt vmcnt(1)
v_max3_u32 v44, v52, v53, v54
v_max_u32 v44, v44, v55
v_cmp_eq_u32 vcc, -1, v44
s_cbranch_vccnz Lpf_202
v_smfmac_f32_16x16x64_bf16 v[64:67], v[52:55], a[64:71], v15
v_smfmac_f32_16x16x64_bf16 v[68:71], v[52:55], a[72:79], v15
v_smfmac_f32_16x16x64_bf16 v[72:75], v[52:55], a[80:87], v15
v_smfmac_f32_16x16x64_bf16 v[76:79], v[52:55], a[88:95], v15
v_smfmac_f32_16x16x64_bf16 v[80:83], v[52:55], a[96:103], v15
v_smfmac_f32_16x16x64_bf16 v[84:87], v[52:55], a[104:111], v15
s_branch Lps_193
Lpf_180:
buffer_load_dwordx4 v[60:63], v10, s[4:7], s40 offen offset:3072 sc1
Lps_203:
s_waitcnt vmcnt(1)
v_max3_u32 v44, v52, v53, v54
v_max_u32 v44, v44, v55
v_cmp_eq_u32 vcc, -1, v44
s_cbranch_vccnz Lpf_204
v_smfmac_f32_16x16x64_bf16 v[64:67], v[52:55], a[64:71], v15
v_smfmac_f32_16x16x64_bf16 v[68:71], v[52:55], a[72:79], v15
v_smfmac_f32_16x16x64_bf16 v[72:75], v[52:55], a[80:87], v15
v_smfmac_f32_16x16x64_bf16 v[76:79], v[52:55], a[88:95], v15
v_smfmac_f32_16x16x64_bf16 v[80:83], v[52:55], a[96:103], v15
v_smfmac_f32_16x16x64_bf16 v[84:87], v[52:55], a[104:111], v15
s_branch Lps_197
Lpf_182:
buffer_load_dwordx4 v[52:55], v10, s[4:7], s40 offen offset:1024 sc1
s_sub_u32 s37, s37, 1
s_cbranch_scc1 Lend_1
s_branch Lps_181
Lpf_184:
buffer_load_dwordx4 v[56:59], v10, s[4:7], s40 offen offset:2048 sc1
Lps_205:
s_waitcnt vmcnt(3)
v_max3_u32 v44, v60, v61, v62
v_max_u32 v44, v44, v63
v_cmp_eq_u32 vcc, -1, v44
s_cbranch_vccnz Lpf_206
v_smfmac_f32_16x16x64_bf16 v[64:67], v[60:63], a[192:199], v15
v_smfmac_f32_16x16x64_bf16 v[68:71], v[60:63], a[200:207], v15
v_smfmac_f32_16x16x64_bf16 v[72:75], v[60:63], a[208:215], v15
v_smfmac_f32_16x16x64_bf16 v[76:79], v[60:63], a[216:223], v15
v_smfmac_f32_16x16x64_bf16 v[80:83], v[60:63], a[224:231], v15
v_smfmac_f32_16x16x64_bf16 v[84:87], v[60:63], a[232:239], v15
Lps_207:
s_waitcnt vmcnt(2)
v_max3_u32 v44, v48, v49, v50
v_max_u32 v44, v44, v51
v_cmp_eq_u32 vcc, -1, v44
s_cbranch_vccnz Lpf_208
v_smfmac_f32_16x16x64_bf16 v[64:67], v[48:51], a[0:7], v15
v_smfmac_f32_16x16x64_bf16 v[68:71], v[48:51], a[8:15], v15
v_smfmac_f32_16x16x64_bf16 v[72:75], v[48:51], a[16:23], v15
v_smfmac_f32_16x16x64_bf16 v[76:79], v[48:51], a[24:31], v15
v_smfmac_f32_16x16x64_bf16 v[80:83], v[48:51], a[32:39], v15
v_smfmac_f32_16x16x64_bf16 v[84:87], v[48:51], a[40:47], v15
s_branch Lps_201
Lpf_186:
buffer_load_dwordx4 v[60:63], v10, s[4:7], s40 offen offset:3072 sc1
Lps_209:
s_waitcnt vmcnt(2)
v_max3_u32 v44, v48, v49, v50
v_max_u32 v44, v44, v51
v_cmp_eq_u32 vcc, -1, v44
s_cbranch_vccnz Lpf_210
v_smfmac_f32_16x16x64_bf16 v[64:67], v[48:51], a[0:7], v15
v_smfmac_f32_16x16x64_bf16 v[68:71], v[48:51], a[8:15], v15
v_smfmac_f32_16x16x64_bf16 v[72:75], v[48:51], a[16:23], v15
v_smfmac_f32_16x16x64_bf16 v[76:79], v[48:51], a[24:31], v15
v_smfmac_f32_16x16x64_bf16 v[80:83], v[48:51], a[32:39], v15
v_smfmac_f32_16x16x64_bf16 v[84:87], v[48:51], a[40:47], v15
s_branch Lps_203
Lpf_188:
buffer_load_dwordx4 v[48:51], v10, s[4:7], s40 offen offset:0 sc1
s_sub_u32 s37, s37, 1
s_cbranch_scc1 Lend_1
Lps_211:
s_waitcnt vmcnt(1)
v_max3_u32 v44, v52, v53, v54
v_max_u32 v44, v44, v55
v_cmp_eq_u32 vcc, -1, v44
s_cbranch_vccnz Lpf_212
v_smfmac_f32_16x16x64_bf16 v[64:67], v[52:55], a[64:71], v15
v_smfmac_f32_16x16x64_bf16 v[68:71], v[52:55], a[72:79], v15
v_smfmac_f32_16x16x64_bf16 v[72:75], v[52:55], a[80:87], v15
v_smfmac_f32_16x16x64_bf16 v[76:79], v[52:55], a[88:95], v15
v_smfmac_f32_16x16x64_bf16 v[80:83], v[52:55], a[96:103], v15
v_smfmac_f32_16x16x64_bf16 v[84:87], v[52:55], a[104:111], v15
s_branch Lps_175
Lpf_190:
buffer_load_dwordx4 v[60:63], v10, s[4:7], s40 offen offset:3072 sc1
Lps_213:
s_waitcnt vmcnt(2)
v_max3_u32 v44, v48, v49, v50
v_max_u32 v44, v44, v51
v_cmp_eq_u32 vcc, -1, v44
s_cbranch_vccnz Lpf_214
v_smfmac_f32_16x16x64_bf16 v[64:67], v[48:51], a[0:7], v15
v_smfmac_f32_16x16x64_bf16 v[68:71], v[48:51], a[8:15], v15
v_smfmac_f32_16x16x64_bf16 v[72:75], v[48:51], a[16:23], v15
v_smfmac_f32_16x16x64_bf16 v[76:79], v[48:51], a[24:31], v15
v_smfmac_f32_16x16x64_bf16 v[80:83], v[48:51], a[32:39], v15
v_smfmac_f32_16x16x64_bf16 v[84:87], v[48:51], a[40:47], v15
Lps_168:
s_waitcnt vmcnt(1)
v_max3_u32 v44, v56, v57, v58
v_max_u32 v44, v44, v59
v_cmp_eq_u32 vcc, -1, v44
s_cbranch_vccnz Lpf_215
v_smfmac_f32_16x16x64_bf16 v[64:67], v[56:59], a[128:135], v15
v_smfmac_f32_16x16x64_bf16 v[68:71], v[56:59], a[136:143], v15
v_smfmac_f32_16x16x64_bf16 v[72:75], v[56:59], a[144:151], v15
v_smfmac_f32_16x16x64_bf16 v[76:79], v[56:59], a[152:159], v15
v_smfmac_f32_16x16x64_bf16 v[80:83], v[56:59], a[160:167], v15
v_smfmac_f32_16x16x64_bf16 v[84:87], v[56:59], a[168:175], v15
s_branch Lps_197
Lpf_192:
buffer_load_dwordx4 v[48:51], v10, s[4:7], s40 offen offset:0 sc1
s_sub_u32 s37, s37, 1
s_cbranch_scc1 Lend_1
Lps_216:
s_waitcnt vmcnt(1)
v_max3_u32 v44, v56, v57, v58
v_max_u32 v44, v44, v59
v_cmp_eq_u32 vcc, -1, v44
s_cbranch_vccnz Lpf_217
v_smfmac_f32_16x16x64_bf16 v[64:67], v[56:59], a[128:135], v15
v_smfmac_f32_16x16x64_bf16 v[68:71], v[56:59], a[136:143], v15
v_smfmac_f32_16x16x64_bf16 v[72:75], v[56:59], a[144:151], v15
v_smfmac_f32_16x16x64_bf16 v[76:79], v[56:59], a[152:159], v15
v_smfmac_f32_16x16x64_bf16 v[80:83], v[56:59], a[160:167], v15
v_smfmac_f32_16x16x64_bf16 v[84:87], v[56:59], a[168:175], v15
s_branch Lps_175
Lpf_194:
buffer_load_dwordx4 v[56:59], v10, s[4:7], s40 offen offset:2048 sc1
s_sub_u32 s37, s37, 1
s_cbranch_scc1 Lend_1
s_branch Lps_193
Lpf_196:
buffer_load_dwordx4 v[48:51], v10, s[4:7], s40 offen offset:0 sc1
s_sub_u32 s37, s37, 1
s_cbranch_scc1 Lend_1
s_branch Lps_173
Lpf_198:
buffer_load_dwordx4 v[60:63], v10, s[4:7], s40 offen offset:3072 sc1
s_sub_u32 s37, s37, 1
s_cbranch_scc1 Lend_1
s_branch Lps_197
Lpf_200:
buffer_load_dwordx4 v[60:63], v10, s[4:7], s40 offen offset:3072 sc1
Lps_218:
s_waitcnt vmcnt(2)
v_max3_u32 v44, v52, v53, v54
v_max_u32 v44, v44, v55
v_cmp_eq_u32 vcc, -1, v44
s_cbranch_vccnz Lpf_219
v_smfmac_f32_16x16x64_bf16 v[64:67], v[52:55], a[64:71], v15
v_smfmac_f32_16x16x64_bf16 v[68:71], v[52:55], a[72:79], v15
v_smfmac_f32_16x16x64_bf16 v[72:75], v[52:55], a[80:87], v15
v_smfmac_f32_16x16x64_bf16 v[76:79], v[52:55], a[88:95], v15
v_smfmac_f32_16x16x64_bf16 v[80:83], v[52:55], a[96:103], v15
v_smfmac_f32_16x16x64_bf16 v[84:87], v[52:55], a[104:111], v15
s_branch Lps_168
Lpf_202:
buffer_load_dwordx4 v[52:55], v10, s[4:7], s40 offen offset:1024 sc1
s_sub_u32 s37, s37, 1
s_cbranch_scc1 Lend_1
Lps_220:
s_waitcnt vmcnt(1)
v_max3_u32 v44, v56, v57, v58
v_max_u32 v44, v44, v59
v_cmp_eq_u32 vcc, -1, v44
s_cbranch_vccnz Lpf_221
v_smfmac_f32_16x16x64_bf16 v[64:67], v[56:59], a[128:135], v15
v_smfmac_f32_16x16x64_bf16 v[68:71], v[56:59], a[136:143], v15
v_smfmac_f32_16x16x64_bf16 v[72:75], v[56:59], a[144:151], v15
v_smfmac_f32_16x16x64_bf16 v[76:79], v[56:59], a[152:159], v15
v_smfmac_f32_16x16x64_bf16 v[80:83], v[56:59], a[160:167], v15
v_smfmac_f32_16x16x64_bf16 v[84:87], v[56:59], a[168:175], v15
s_branch Lps_181
Lpf_204:
buffer_load_dwordx4 v[52:55], v10, s[4:7], s40 offen offset:1024 sc1
s_sub_u32 s37, s37, 1
s_cbranch_scc1 Lend_1
s_branch Lps_179
Lpf_206:
buffer_load_dwordx4 v[60:63], v10, s[4:7], s40 offen offset:3072 sc1
Lps_222:
s_waitcnt vmcnt(3)
v_max3_u32 v44, v48, v49, v50
v_max_u32 v44, v44, v51
v_cmp_eq_u32 vcc, -1, v44
s_cbranch_vccnz Lpf_223
v_smfmac_f32_16x16x64_bf16 v[64:67], v[48:51], a[0:7], v15
v_smfmac_f32_16x16x64_bf16 v[68:71], v[48:51], a[8:15], v15
v_smfmac_f32_16x16x64_bf16 v[72:75], v[48:51], a[16:23], v15
v_smfmac_f32_16x16x64_bf16 v[76:79], v[48:51], a[24:31], v15
v_smfmac_f32_16x16x64_bf16 v[80:83], v[48:51], a[32:39], v15
v_smfmac_f32_16x16x64_bf16 v[84:87], v[48:51], a[40:47], v15
s_branch Lps_218
Lpf_208:
buffer_load_dwordx4 v[48:51], v10, s[4:7], s40 offen offset:0 sc1
s_sub_u32 s37, s37, 1
s_cbranch_scc1 Lend_1
Lps_224:
s_waitcnt vmcnt(2)
v_max3_u32 v44, v52, v53, v54
v_max_u32 v44, v44, v55
v_cmp_eq_u32 vcc, -1, v44
s_cbranch_vccnz Lpf_225
v_smfmac_f32_16x16x64_bf16 v[64:67], v[52:55], a[64:71], v15
v_smfmac_f32_16x16x64_bf16 v[68:71], v[52:55], a[72:79], v15
v_smfmac_f32_16x16x64_bf16 v[72:75], v[52:55], a[80:87], v15
v_smfmac_f32_16x16x64_bf16 v[76:79], v[52:55], a[88:95], v15
v_smfmac_f32_16x16x64_bf16 v[80:83], v[52:55], a[96:103], v15
v_smfmac_f32_16x16x64_bf16 v[84:87], v[52:55], a[104:111], v15
s_branch Lps_216
Lpf_210:
buffer_load_dwordx4 v[48:51], v10, s[4:7], s40 offen offset:0 sc1
s_sub_u32 s37, s37, 1
s_cbranch_scc1 Lend_1
Lps_226:
s_waitcnt vmcnt(2)
v_max3_u32 v44, v52, v53, v54
v_max_u32 v44, v44, v55
v_cmp_eq_u32 vcc, -1, v44
s_cbranch_vccnz Lpf_227
v_smfmac_f32_16x16x64_bf16 v[64:67], v[52:55], a[64:71], v15
v_smfmac_f32_16x16x64_bf16 v[68:71], v[52:55], a[72:79], v15
v_smfmac_f32_16x16x64_bf16 v[72:75], v[52:55], a[80:87], v15
v_smfmac_f32_16x16x64_bf16 v[76:79], v[52:55], a[88:95], v15
v_smfmac_f32_16x16x64_bf16 v[80:83], v[52:55], a[96:103], v15
v_smfmac_f32_16x16x64_bf16 v[84:87], v[52:55], a[104:111], v15
s_branch Lps_173
Lpf_212:
buffer_load_dwordx4 v[52:55], v10, s[4:7], s40 offen offset:1024 sc1
s_branch Lps_187
Lpf_214:
buffer_load_dwordx4 v[48:51], v10, s[4:7], s40 offen offset:0 sc1
s_sub_u32 s37, s37, 1
s_cbranch_scc1 Lend_1
s_branch Lps_171
Lpf_215:
buffer_load_dwordx4 v[56:59], v10, s[4:7], s40 offen offset:2048 sc1
s_sub_u32 s37, s37, 1
s_cbranch_scc1 Lend_1
Lps_228:
s_waitcnt vmcnt(1)
v_max3_u32 v44, v60, v61, v62
v_max_u32 v44, v44, v63
v_cmp_eq_u32 vcc, -1, v44
s_cbranch_vccnz Lpf_229
v_smfmac_f32_16x16x64_bf16 v[64:67], v[60:63], a[192:199], v15
v_smfmac_f32_16x16x64_bf16 v[68:71], v[60:63], a[200:207], v15
v_smfmac_f32_16x16x64_bf16 v[72:75], v[60:63], a[208:215], v15
v_smfmac_f32_16x16x64_bf16 v[76:79], v[60:63], a[216:223], v15
v_smfmac_f32_16x16x64_bf16 v[80:83], v[60:63], a[224:231], v15
v_smfmac_f32_16x16x64_bf16 v[84:87], v[60:63], a[232:239], v15
s_branch Lps_193
Lpf_217:
buffer_load_dwordx4 v[56:59], v10, s[4:7], s40 offen offset:2048 sc1
s_branch Lps_191
Lpf_219:
buffer_load_dwordx4 v[52:55], v10, s[4:7], s40 offen offset:1024 sc1
s_sub_u32 s37, s37, 1
s_cbranch_scc1 Lend_1
s_branch Lps_177
Lpf_221:
buffer_load_dwordx4 v[56:59], v10, s[4:7], s40 offen offset:2048 sc1
s_branch Lps_201
Lpf_223:
buffer_load_dwordx4 v[48:51], v10, s[4:7], s40 offen offset:0 sc1
s_sub_u32 s37, s37, 1
s_cbranch_scc1 Lend_1
s_branch Lps_169
Lpf_225:
buffer_load_dwordx4 v[52:55], v10, s[4:7], s40 offen offset:1024 sc1
Lps_230:
s_waitcnt vmcnt(2)
v_max3_u32 v44, v56, v57, v58
v_max_u32 v44, v44, v59
v_cmp_eq_u32 vcc, -1, v44
s_cbranch_vccnz Lpf_231
v_smfmac_f32_16x16x64_bf16 v[64:67], v[56:59], a[128:135], v15
v_smfmac_f32_16x16x64_bf16 v[68:71], v[56:59], a[136:143], v15
v_smfmac_f32_16x16x64_bf16 v[72:75], v[56:59], a[144:151], v15
v_smfmac_f32_16x16x64_bf16 v[76:79], v[56:59], a[152:159], v15
v_smfmac_f32_16x16x64_bf16 v[80:83], v[56:59], a[160:167], v15
v_smfmac_f32_16x16x64_bf16 v[84:87], v[56:59], a[168:175], v15
s_branch Lps_187
Lpf_227:
buffer_load_dwordx4 v[52:55], v10, s[4:7], s40 offen offset:1024 sc1
s_branch Lps_185
Lpf_229:
buffer_load_dwordx4 v[60:63], v10, s[4:7], s40 offen offset:3072 sc1
s_branch Lps_168
Lpf_231:
buffer_load_dwordx4 v[56:59], v10, s[4:7], s40 offen offset:2048 sc1
s_branch Lps_207
Lkr_156:
buffer_load_dwordx4 v[56:59], v11, s[4:7], s40 offen offset:0 sc1
buffer_load_dwordx4 v[60:63], v11, s[4:7], s40 offen offset:1024 sc1
Lps_233:
s_waitcnt vmcnt(3)
v_max3_u32 v44, v48, v49, v50
v_max_u32 v44, v44, v51
v_cmp_eq_u32 vcc, -1, v44
s_cbranch_vccnz Lpf_234
v_smfmac_f32_16x16x64_bf16 v[72:75], v[48:51], v[96:103], v15
v_mov_b32 v112, v48
v_mov_b32 v113, v49
v_mov_b32 v114, v50
v_mov_b32 v115, v51
Lps_235:
s_waitcnt vmcnt(2)
v_max3_u32 v44, v52, v53, v54
v_max_u32 v44, v44, v55
v_cmp_eq_u32 vcc, -1, v44
s_cbranch_vccnz Lpf_236
v_smfmac_f32_16x16x64_bf16 v[72:75], v[52:55], v[104:111], v15
v_mov_b32 v116, v52
v_mov_b32 v117, v53
v_mov_b32 v118, v54
v_mov_b32 v119, v55
Lpd_232:
s_branch Lko_157
Lpf_234:
buffer_load_dwordx4 v[48:51], v11, s[4:7], s40 offen offset:0 sc1
s_sub_u32 s37, s37, 1
s_cbranch_scc1 Lend_1
Lps_237:
s_waitcnt vmcnt(3)
v_max3_u32 v44, v52, v53, v54
v_max_u32 v44, v44, v55
v_cmp_eq_u32 vcc, -1, v44
s_cbranch_vccnz Lpf_238
v_smfmac_f32_16x16x64_bf16 v[72:75], v[52:55], v[104:111], v15
v_mov_b32 v116, v52
v_mov_b32 v117, v53
v_mov_b32 v118, v54
v_mov_b32 v119, v55
Lps_239:
s_waitcnt vmcnt(2)
v_max3_u32 v44, v56, v57, v58
v_max_u32 v44, v44, v59
v_cmp_eq_u32 vcc, -1, v44
s_cbranch_vccnz Lpf_240
v_smfmac_f32_16x16x64_bf16 v[72:75], v[56:59], v[96:103], v15
v_mov_b32 v112, v56
v_mov_b32 v113, v57
v_mov_b32 v114, v58
v_mov_b32 v115, v59
s_branch Lpd_232
Lpf_236:
buffer_load_dwordx4 v[52:55], v11, s[4:7], s40 offen offset:1024 sc1
s_sub_u32 s37, s37, 1
s_cbranch_scc1 Lend_1
Lps_241:
s_waitcnt vmcnt(2)
v_max3_u32 v44, v56, v57, v58
v_max_u32 v44, v44, v59
v_cmp_eq_u32 vcc, -1, v44
s_cbranch_vccnz Lpf_242
Lps_243:
s_waitcnt vmcnt(1)
v_max3_u32 v44, v60, v61, v62
v_max_u32 v44, v44, v63
v_cmp_eq_u32 vcc, -1, v44
s_cbranch_vccnz Lpf_244
v_smfmac_f32_16x16x64_bf16 v[72:75], v[60:63], v[104:111], v15
v_mov_b32 v116, v60
v_mov_b32 v117, v61
v_mov_b32 v118, v62
v_mov_b32 v119, v63
s_branch Lpd_232
Lpf_238:
buffer_load_dwordx4 v[52:55], v11, s[4:7], s40 offen offset:1024 sc1
Lps_245:
s_waitcnt vmcnt(3)
v_max3_u32 v44, v56, v57, v58
v_max_u32 v44, v44, v59
v_cmp_eq_u32 vcc, -1, v44
s_cbranch_vccnz Lpf_246
v_smfmac_f32_16x16x64_bf16 v[72:75], v[56:59], v[96:103], v15
v_mov_b32 v112, v56
v_mov_b32 v113, v57
v_mov_b32 v114, v58
v_mov_b32 v115, v59
Lps_247:
s_waitcnt vmcnt(2)
v_max3_u32 v44, v60, v61, v62
v_max_u32 v44, v44, v63
v_cmp_eq_u32 vcc, -1, v44
s_cbranch_vccnz Lpf_248
v_smfmac_f32_16x16x64_bf16 v[72:75], v[60:63], v[104:111], v15
v_mov_b32 v116, v60
v_mov_b32 v117, v61
v_mov_b32 v118, v62
v_mov_b32 v119, v63
s_branch Lpd_232
Lpf_240:
buffer_load_dwordx4 v[56:59], v11, s[4:7], s40 offen offset:0 sc1
Lps_249:
s_waitcnt vmcnt(2)
v_max3_u32 v44, v60, v61, v62
v_max_u32 v44, v44, v63
v_cmp_eq_u32 vcc, -1, v44
s_cbranch_vccnz Lpf_250
Lps_251:
s_waitcnt vmcnt(1)
v_max3_u32 v44, v48, v49, v50
v_max_u32 v44, v44, v51
v_cmp_eq_u32 vcc, -1, v44
s_cbranch_vccnz Lpf_252
v_smfmac_f32_16x16x64_bf16 v[72:75], v[48:51], v[96:103], v15
v_mov_b32 v112, v48
v_mov_b32 v113, v49
v_mov_b32 v114, v50
v_mov_b32 v115, v51
s_branch Lpd_232
Lpf_242:
buffer_load_dwordx4 v[56:59], v11, s[4:7], s40 offen offset:0 sc1
Lps_253:
s_waitcnt vmcnt(2)
v_max3_u32 v44, v60, v61, v62
v_max_u32 v44, v44, v63
v_cmp_eq_u32 vcc, -1, v44
s_cbranch_vccnz Lpf_254
v_smfmac_f32_16x16x64_bf16 v[72:75], v[60:63], v[104:111], v15
v_mov_b32 v116, v60
v_mov_b32 v117, v61
v_mov_b32 v118, v62
v_mov_b32 v119, v63
s_branch Lpd_232
Lpf_244:
buffer_load_dwordx4 v[60:63], v11, s[4:7], s40 offen offset:1024 sc1
Lps_255:
s_waitcnt vmcnt(1)
v_max3_u32 v44, v52, v53, v54
v_max_u32 v44, v44, v55
v_cmp_eq_u32 vcc, -1, v44
s_cbranch_vccnz Lpf_256
v_smfmac_f32_16x16x64_bf16 v[72:75], v[52:55], v[104:111], v15
v_mov_b32 v116, v52
v_mov_b32 v117, v53
v_mov_b32 v118, v54
v_mov_b32 v119, v55
s_branch Lpd_232
Lpf_246:
buffer_load_dwordx4 v[56:59], v11, s[4:7], s40 offen offset:0 sc1
Lps_257:
s_waitcnt vmcnt(3)
v_max3_u32 v44, v60, v61, v62
v_max_u32 v44, v44, v63
v_cmp_eq_u32 vcc, -1, v44
s_cbranch_vccnz Lpf_258
v_smfmac_f32_16x16x64_bf16 v[72:75], v[60:63], v[104:111], v15
v_mov_b32 v116, v60
v_mov_b32 v117, v61
v_mov_b32 v118, v62
v_mov_b32 v119, v63
Lps_259:
s_waitcnt vmcnt(2)
v_max3_u32 v44, v48, v49, v50
v_max_u32 v44, v44, v51
v_cmp_eq_u32 vcc, -1, v44
s_cbranch_vccnz Lpf_260
v_smfmac_f32_16x16x64_bf16 v[72:75], v[48:51], v[96:103], v15
v_mov_b32 v112, v48
v_mov_b32 v113, v49
v_mov_b32 v114, v50
v_mov_b32 v115, v51
s_branch Lpd_232
Lpf_248:
buffer_load_dwordx4 v[60:63], v11, s[4:7], s40 offen offset:1024 sc1
Lps_261:
s_waitcnt vmcnt(2)
v_max3_u32 v44, v48, v49, v50
v_max_u32 v44, v44, v51
v_cmp_eq_u32 vcc, -1, v44
s_cbranch_vccnz Lpf_262
s_branch Lps_255
Lpf_250:
buffer_load_dwordx4 v[60:63], v11, s[4:7], s40 offen offset:1024 sc1
Lps_263:
s_waitcnt vmcnt(2)
v_max3_u32 v44, v48, v49, v50
v_max_u32 v44, v44, v51
v_cmp_eq_u32 vcc, -1, v44
s_cbranch_vccnz Lpf_264
v_smfmac_f32_16x16x64_bf16 v[72:75], v[48:51], v[96:103], v15
v_mov_b32 v112, v48
v_mov_b32 v113, v49
v_mov_b32 v114, v50
v_mov_b32 v115, v51
s_branch Lpd_232
Lpf_252:
buffer_load_dwordx4 v[48:51], v11, s[4:7], s40 offen offset:0 sc1
s_sub_u32 s37, s37, 1
s_cbranch_scc1 Lend_1
Lps_265:
s_waitcnt vmcnt(1)
v_max3_u32 v44, v56, v57, v58
v_max_u32 v44, v44, v59
v_cmp_eq_u32 vcc, -1, v44
s_cbranch_vccnz Lpf_266
v_smfmac_f32_16x16x64_bf16 v[72:75], v[56:59], v[96:103], v15
v_mov_b32 v112, v56
v_mov_b32 v113, v57
v_mov_b32 v114, v58
v_mov_b32 v115, v59
s_branch Lpd_232
Lpf_254:
buffer_load_dwordx4 v[60:63], v11, s[4:7], s40 offen offset:1024 sc1
s_branch Lps_235
Lpf_256:
buffer_load_dwordx4 v[52:55], v11, s[4:7], s40 offen offset:1024 sc1
s_sub_u32 s37, s37, 1
s_cbranch_scc1 Lend_1
s_branch Lps_243
Lpf_258:
buffer_load_dwordx4 v[60:63], v11, s[4:7], s40 offen offset:1024 sc1
s_branch Lps_233
Lpf_260:
buffer_load_dwordx4 v[48:51], v11, s[4:7], s40 offen offset:0 sc1
s_sub_u32 s37, s37, 1
s_cbranch_scc1 Lend_1
Lps_267:
s_waitcnt vmcnt(2)
v_max3_u32 v44, v52, v53, v54
v_max_u32 v44, v44, v55
v_cmp_eq_u32 vcc, -1, v44
s_cbranch_vccnz Lpf_268
s_branch Lps_265
Lpf_262:
buffer_load_dwordx4 v[48:51], v11, s[4:7], s40 offen offset:0 sc1
s_sub_u32 s37, s37, 1
s_cbranch_scc1 Lend_1
Lps_269:
s_waitcnt vmcnt(2)
v_max3_u32 v44, v52, v53, v54
v_max_u32 v44, v44, v55
v_cmp_eq_u32 vcc, -1, v44
s_cbranch_vccnz Lpf_270
v_smfmac_f32_16x16x64_bf16 v[72:75], v[52:55], v[104:111], v15
v_mov_b32 v116, v52
v_mov_b32 v117, v53
v_mov_b32 v118, v54
v_mov_b32 v119, v55
s_branch Lpd_232
Lpf_264:
buffer_load_dwordx4 v[48:51], v11, s[4:7], s40 offen offset:0 sc1
s_sub_u32 s37, s37, 1
s_cbranch_scc1 Lend_1
s_branch Lps_239
Lpf_266:
buffer_load_dwordx4 v[56:59], v11, s[4:7], s40 offen offset:0 sc1
s_branch Lps_251
Lpf_268:
buffer_load_dwordx4 v[52:55], v11, s[4:7], s40 offen offset:1024 sc1
Lps_271:
s_waitcnt vmcnt(2)
v_max3_u32 v44, v56, v57, v58
v_max_u32 v44, v44, v59
v_cmp_eq_u32 vcc, -1, v44
s_cbranch_vccnz Lpf_272
v_smfmac_f32_16x16x64_bf16 v[72:75], v[56:59], v[96:103], v15
v_mov_b32 v112, v56
v_mov_b32 v113, v57
v_mov_b32 v114, v58
v_mov_b32 v115, v59
s_branch Lpd_232
Lpf_270:
buffer_load_dwordx4 v[52:55], v11, s[4:7], s40 offen offset:1024 sc1
s_branch Lps_247
Lpf_272:
buffer_load_dwordx4 v[56:59], v11, s[4:7], s40 offen offset:0 sc1
s_branch Lps_259
Lvr_158:
buffer_load_dwordx2 v[120:121], v12, s[4:7], s40 offen sc1
buffer_load_dwordx2 v[122:123], v13, s[4:7], s40 offen sc1
s_sub_u32 s37, s37, 1
s_cbranch_scc1 Lend_1
s_waitcnt vmcnt(0)
v_max3_u32 v44, v120, v121, v122
v_max_u32 v44, v44, v123
v_cmp_eq_u32 vcc, -1, v44
s_cbranch_vccnz Lvr_158
s_branch Lvo_159
Lend_1:
s_endpgm
Lkvo_2:
v_mov_b32 v44, v0
v_mov_b32 v45, v1
s_sub_u32 s54, s34, 8
s_xor_b32 s57, s32, 3
s_lshl_b32 s45, s33, 18
s_add_u32 s45, s45, 2097152
s_lshl_b32 s59, s33, 12
s_add_u32 s59, s59, 3276800
s_lshl_b32 s38, s32, 12
v_lshl_add_u32 v8, v45, 4, s38
v_add_u32 v9, 49152, v8
s_lshl_b32 s38, s54, 10
v_and_b32 v46, 0xf0, v44
v_lshl_add_u32 v10, v46, 2, s38
v_and_b32 v46, 3, v45
v_lshl_add_u32 v10, v46, 4, v10
v_and_b32 v46, 12, v45
v_add_u32 v10, v10, v46
v_xor_b32 v11, 20480, v10
s_lshr_b32 s39, s32, 1
s_lshl_b32 s39, s39, 9
s_add_u32 s38, s38, s39
s_and_b32 s39, s32, 1
s_lshl_b32 s39, s39, 2
s_add_u32 s38, s38, s39
s_xor_b32 s38, s38, 34816
v_lshl_add_u32 v27, v45, 3, s38
s_lshl_b32 s38, s32, 8
s_add_u32 s38, s38, 2048
v_lshl_add_u32 v1, v45, 2, s38
s_lshr_b32 s38, s54, 2
s_lshl_b32 s38, s38, 8
s_and_b32 s39, s54, 3
s_lshl_b32 s39, s39, 2
s_add_u32 s38, s38, s39
v_min_u32 v46, 1, v44
v_lshl_add_u32 v2, v46, 30, s38
s_lshr_b32 s38, s54, 3
s_lshl_b32 s38, s38, 14
s_and_b32 s39, s54, 7
s_lshl_b32 s39, s39, 10
s_add_u32 s38, s38, s39
s_lshl_b32 s39, s33, 16
s_add_u32 s38, s38, s39
v_lshl_add_u32 v12, v44, 2, s38
v_xor_b32 v13, 0x10000, v12
v_xor_b32 v14, 0x20000, v12
v_xor_b32 v15, 0x30000, v12
s_mov_b32 s55, 0x00003f80
s_mov_b32 s56, 0x3f800000
v_bfe_u32 v126, v45, 1, 1
v_mul_u32_u24 v126, 0xaaaa, v126
v_add_u32 v126, 0x4444, v126
s_xor_b32 s38, s57, 0
s_mul_i32 s38, s38, 1536
s_add_u32 s38, s38, 0
v_lshl_add_u32 v24, v45, 3, s38
s_xor_b32 s38, s57, 1
s_mul_i32 s38, s38, 1536
s_add_u32 s38, s38, 512
v_lshl_add_u32 v25, v45, 3, s38
s_xor_b32 s38, s57, 2
s_mul_i32 s38, s38, 1536
s_add_u32 s38, s38, 1024
v_lshl_add_u32 v26, v45, 3, s38
s_mul_i32 s38, s32, 1536
v_lshl_add_u32 v0, v45, 3, s38
v_and_b32 v46, 1, v45
v_mov_b32 v3, 0x05040100
v_mov_b32 v47, 0x03020706
v_cmp_eq_u32 vcc, 1, v46
s_nop 1
v_cndmask_b32 v3, v3, v47, vcc
v_lshrrev_b32 v47, 4, v45
v_lshl_add_u32 v46, v47, 1, v46
v_and_b32 v47, 14, v45
v_lshlrev_b32 v47, 1, v47
v_lshl_add_u32 v58, v46, 11, v47
s_mov_b32 s8, s16
s_and_b32 s9, s17, 0xffff
s_mov_b32 s10, 0x4000
s_mov_b32 s11, 0x20000
v_mov_b32 v16, 0
v_mov_b32 v17, 0
v_mov_b32 v18, 0
v_mov_b32 v19, 0
v_mov_b32 v20, 0
v_mov_b32 v21, 0
v_mov_b32 v22, 0
v_mov_b32 v23, 0
v_mov_b32 v121, -1
s_add_u32 s38, s45, 0
buffer_store_dword v121, v10, s[4:7], s38 offen sc1
buffer_store_dword v121, v11, s[4:7], s38 offen sc1
buffer_store_dword v121, v27, s[4:7], s38 offen sc1
s_mov_b32 s39, 0
buffer_store_dword v121, v12, s[4:7], s39 offen sc1
s_mov_b32 s39, 8192
buffer_store_dword v121, v12, s[4:7], s39 offen sc1
s_mov_b32 s39, 1048576
buffer_store_dword v121, v12, s[4:7], s39 offen sc1
s_mov_b32 s39, 1056768
buffer_store_dword v121, v12, s[4:7], s39 offen sc1
s_add_u32 s38, s45, 65536
buffer_store_dword v121, v10, s[4:7], s38 offen sc1
buffer_store_dword v121, v11, s[4:7], s38 offen sc1
buffer_store_dword v121, v27, s[4:7], s38 offen sc1
s_mov_b32 s39, 262144
buffer_store_dword v121, v12, s[4:7], s39 offen sc1
s_mov_b32 s39, 270336
buffer_store_dword v121, v12, s[4:7], s39 offen sc1
s_mov_b32 s39, 1310720
buffer_store_dword v121, v12, s[4:7], s39 offen sc1
s_mov_b32 s39, 1318912
buffer_store_dword v121, v12, s[4:7], s39 offen sc1
s_add_u32 s38, s45, 131072
buffer_store_dword v121, v10, s[4:7], s38 offen sc1
buffer_store_dword v121, v11, s[4:7], s38 offen sc1
buffer_store_dword v121, v27, s[4:7], s38 offen sc1
s_mov_b32 s39, 524288
buffer_store_dword v121, v12, s[4:7], s39 offen sc1
s_mov_b32 s39, 532480
buffer_store_dword v121, v12, s[4:7], s39 offen sc1
s_mov_b32 s39, 1572864
buffer_store_dword v121, v12, s[4:7], s39 offen sc1
s_mov_b32 s39, 1581056
buffer_store_dword v121, v12, s[4:7], s39 offen sc1
s_add_u32 s38, s45, 196608
buffer_store_dword v121, v10, s[4:7], s38 offen sc1
buffer_store_dword v121, v11, s[4:7], s38 offen sc1
buffer_store_dword v121, v27, s[4:7], s38 offen sc1
s_mov_b32 s39, 786432
buffer_store_dword v121, v12, s[4:7], s39 offen sc1
s_mov_b32 s39, 794624
buffer_store_dword v121, v12, s[4:7], s39 offen sc1
s_mov_b32 s39, 1835008
buffer_store_dword v121, v12, s[4:7], s39 offen sc1
s_mov_b32 s39, 1843200
buffer_store_dword v121, v12, s[4:7], s39 offen sc1
v_mov_b32 v7, 1
buffer_store_dword v7, v2, s[4:7], s59 offen sc1
s_lshl_b32 s52, s35, 16
s_or_b32 s52, s52, 1
s_waitcnt vmcnt(0)
s_barrier
s_cmp_lg_u32 s32, 0
s_cbranch_scc1 Lar_273
s_mov_b64 exec, 1
v_mov_b32 v48, 32
v_mov_b32 v49, s52
buffer_atomic_add v49, v48, s[12:15], 0 offen sc1
s_mov_b64 exec, -1
Lar_273:
s_lshl_b32 s38, s54, 2
s_add_u32 s38, s38, s32
s_lshl_b32 s38, s38, 5
buffer_load_dword v57, v58, s[8:11], s38 offen
s_lshl_b32 s52, s57, 5
v_and_b32 v46, 7, v45
v_lshlrev_b32 v46, 4, v46
v_xor_b32 v46, s52, v46
v_lshrrev_b32 v52, 3, v45
v_lshl_add_u32 v52, v52, 13, v46
v_and_b32 v46, 7, v45
v_lshlrev_b32 v46, 4, v46
v_xor_b32 v46, s52, v46
v_lshrrev_b32 v53, 3, v45
v_lshl_add_u32 v53, v53, 11, v46
s_and_b32 s53, s52, 32
s_lshr_b32 s53, s53, 1
s_and_b32 s52, s52, 64
s_or_b32 s52, s52, s53
v_and_b32 v46, 7, v45
v_lshlrev_b32 v46, 4, v46
v_xor_b32 v46, s52, v46
v_lshrrev_b32 v51, 3, v45
v_lshl_add_u32 v51, v51, 13, v46
v_bfe_u32 v54, v45, 2, 2
v_lshrrev_b32 v46, 4, v45
v_lshl_add_u32 v54, v46, 3, v54
s_mul_i32 s38, s32, 40960
v_lshl_add_u32 v54, v54, 7, s38
v_bfe_u32 v46, v45, 0, 1
v_lshl_add_u32 v54, v46, 5, v54
v_bfe_u32 v46, v45, 1, 1
v_lshl_add_u32 v54, v46, 3, v54
v_bfe_u32 v55, v45, 2, 2
v_lshrrev_b32 v46, 4, v45
v_lshl_add_u32 v55, v46, 3, v55
s_mul_i32 s38, s32, 40960
v_lshl_add_u32 v55, v55, 7, s38
v_bfe_u32 v46, v45, 0, 1
v_lshl_add_u32 v55, v46, 3, v55
v_bfe_u32 v46, v45, 1, 1
v_lshl_add_u32 v55, v46, 4, v55
v_and_b32 v56, 16, v45
v_bfe_u32 v46, v45, 5, 1
v_lshl_add_u32 v56, v46, 3, v56
v_bfe_u32 v46, v45, 3, 1
v_lshl_add_u32 v56, v46, 2, v56
v_bfe_u32 v46, v45, 2, 1
v_lshl_add_u32 v56, v46, 0, v56
s_mul_i32 s38, s32, 40960
v_lshl_add_u32 v56, v56, 7, s38
v_bfe_u32 v46, v45, 0, 1
v_lshl_add_u32 v56, v46, 3, v56
v_bfe_u32 v46, v45, 1, 1
v_lshl_add_u32 v56, v46, 4, v56
s_mov_b32 s8, s20
s_and_b32 s9, s21, 0xffff
s_mov_b32 s10, 0x800000
s_mov_b32 s11, 0x20000
s_lshl_b32 s39, s32, 21
s_lshl_b32 s38, s33, 4
s_add_u32 s38, s38, s54
s_xor_b32 s38, s38, 4
s_lshl_b32 s38, s38, 7
s_add_u32 s39, s39, s38
s_add_u32 s39, s39, 1572864
s_mul_i32 s38, s32, 40960
s_add_u32 m0, s38, 0
s_nop 0
buffer_load_dwordx4 v51, s[8:11], s39 offen lds
s_add_u32 m0, m0, 1024
s_add_u32 s39, s39, 65536
buffer_load_dwordx4 v51, s[8:11], s39 offen lds
s_add_u32 m0, m0, 1024
s_add_u32 s39, s39, 65536
buffer_load_dwordx4 v51, s[8:11], s39 offen lds
s_add_u32 m0, m0, 1024
s_add_u32 s39, s39, 65536
buffer_load_dwordx4 v51, s[8:11], s39 offen lds
s_add_u32 m0, m0, 1024
s_add_u32 s39, s39, 65536
buffer_load_dwordx4 v51, s[8:11], s39 offen lds
s_add_u32 m0, m0, 1024
s_add_u32 s39, s39, 65536
buffer_load_dwordx4 v51, s[8:11], s39 offen lds
s_add_u32 m0, m0, 1024
s_add_u32 s39, s39, 65536
buffer_load_dwordx4 v51, s[8:11], s39 offen lds
s_add_u32 m0, m0, 1024
s_add_u32 s39, s39, 65536
buffer_load_dwordx4 v51, s[8:11], s39 offen lds
s_mov_b32 s8, s22
s_and_b32 s9, s23, 0xffff
s_mov_b32 s10, 0x800000
s_mov_b32 s11, 0x20000
s_lshl_b32 s39, s32, 21
s_lshl_b32 s38, s33, 4
s_add_u32 s38, s38, s54
s_xor_b32 s38, s38, 2
s_lshl_b32 s38, s38, 7
s_add_u32 s39, s39, s38
s_add_u32 s39, s39, 1572864
s_mul_i32 s38, s32, 40960
s_add_u32 m0, s38, 8192
s_nop 0
buffer_load_dwordx4 v52, s[8:11], s39 offen lds
s_add_u32 m0, m0, 1024
s_add_u32 s39, s39, 65536
buffer_load_dwordx4 v52, s[8:11], s39 offen lds
s_add_u32 m0, m0, 1024
s_add_u32 s39, s39, 65536
buffer_load_dwordx4 v52, s[8:11], s39 offen lds
s_add_u32 m0, m0, 1024
s_add_u32 s39, s39, 65536
buffer_load_dwordx4 v52, s[8:11], s39 offen lds
s_add_u32 m0, m0, 1024
s_add_u32 s39, s39, 65536
buffer_load_dwordx4 v52, s[8:11], s39 offen lds
s_add_u32 m0, m0, 1024
s_add_u32 s39, s39, 65536
buffer_load_dwordx4 v52, s[8:11], s39 offen lds
s_add_u32 m0, m0, 1024
s_add_u32 s39, s39, 65536
buffer_load_dwordx4 v52, s[8:11], s39 offen lds
s_add_u32 m0, m0, 1024
s_add_u32 s39, s39, 65536
buffer_load_dwordx4 v52, s[8:11], s39 offen lds
s_mov_b32 s8, s20
s_and_b32 s9, s21, 0xffff
s_mov_b32 s10, 0x800000
s_mov_b32 s11, 0x20000
s_lshl_b32 s39, s32, 21
s_lshl_b32 s38, s33, 4
s_add_u32 s38, s38, s54
s_xor_b32 s38, s38, 4
s_lshl_b32 s38, s38, 7
s_add_u32 s39, s39, s38
s_add_u32 s39, s39, 1048576
s_mul_i32 s38, s32, 40960
s_add_u32 m0, s38, 16384
s_nop 0
buffer_load_dwordx4 v51, s[8:11], s39 offen lds
s_add_u32 m0, m0, 1024
s_add_u32 s39, s39, 65536
buffer_load_dwordx4 v51, s[8:11], s39 offen lds
s_add_u32 m0, m0, 1024
s_add_u32 s39, s39, 65536
buffer_load_dwordx4 v51, s[8:11], s39 offen lds
s_add_u32 m0, m0, 1024
s_add_u32 s39, s39, 65536
buffer_load_dwordx4 v51, s[8:11], s39 offen lds
s_add_u32 m0, m0, 1024
s_add_u32 s39, s39, 65536
buffer_load_dwordx4 v51, s[8:11], s39 offen lds
s_add_u32 m0, m0, 1024
s_add_u32 s39, s39, 65536
buffer_load_dwordx4 v51, s[8:11], s39 offen lds
s_add_u32 m0, m0, 1024
s_add_u32 s39, s39, 65536
buffer_load_dwordx4 v51, s[8:11], s39 offen lds
s_add_u32 m0, m0, 1024
s_add_u32 s39, s39, 65536
buffer_load_dwordx4 v51, s[8:11], s39 offen lds
s_mov_b32 s8, s22
s_and_b32 s9, s23, 0xffff
s_mov_b32 s10, 0x800000
s_mov_b32 s11, 0x20000
s_lshl_b32 s39, s32, 21
s_lshl_b32 s38, s33, 4
s_add_u32 s38, s38, s54
s_xor_b32 s38, s38, 2
s_lshl_b32 s38, s38, 7
s_add_u32 s39, s39, s38
s_add_u32 s39, s39, 1048576
s_mul_i32 s38, s32, 40960
s_add_u32 m0, s38, 24576
s_nop 0
buffer_load_dwordx4 v52, s[8:11], s39 offen lds
s_add_u32 m0, m0, 1024
s_add_u32 s39, s39, 65536
buffer_load_dwordx4 v52, s[8:11], s39 offen lds
s_add_u32 m0, m0, 1024
s_add_u32 s39, s39, 65536
buffer_load_dwordx4 v52, s[8:11], s39 offen lds
s_add_u32 m0, m0, 1024
s_add_u32 s39, s39, 65536
buffer_load_dwordx4 v52, s[8:11], s39 offen lds
s_add_u32 m0, m0, 1024
s_add_u32 s39, s39, 65536
buffer_load_dwordx4 v52, s[8:11], s39 offen lds
s_add_u32 m0, m0, 1024
s_add_u32 s39, s39, 65536
buffer_load_dwordx4 v52, s[8:11], s39 offen lds
s_add_u32 m0, m0, 1024
s_add_u32 s39, s39, 65536
buffer_load_dwordx4 v52, s[8:11], s39 offen lds
s_add_u32 m0, m0, 1024
s_add_u32 s39, s39, 65536
buffer_load_dwordx4 v52, s[8:11], s39 offen lds
s_mov_b32 s8, s20
s_and_b32 s9, s21, 0xffff
s_mov_b32 s10, 0x800000
s_mov_b32 s11, 0x20000
s_lshl_b32 s39, s32, 21
s_lshl_b32 s38, s33, 4
s_add_u32 s38, s38, s54
s_xor_b32 s38, s38, 4
s_lshl_b32 s38, s38, 7
s_add_u32 s39, s39, s38
s_add_u32 s39, s39, 524288
s_mul_i32 s38, s32, 40960
s_add_u32 m0, s38, 32768
s_nop 0
buffer_load_dwordx4 v51, s[8:11], s39 offen lds
s_add_u32 m0, m0, 1024
s_add_u32 s39, s39, 65536
buffer_load_dwordx4 v51, s[8:11], s39 offen lds
s_add_u32 m0, m0, 1024
s_add_u32 s39, s39, 65536
buffer_load_dwordx4 v51, s[8:11], s39 offen lds
s_add_u32 m0, m0, 1024
s_add_u32 s39, s39, 65536
buffer_load_dwordx4 v51, s[8:11], s39 offen lds
s_add_u32 m0, m0, 1024
s_add_u32 s39, s39, 65536
buffer_load_dwordx4 v51, s[8:11], s39 offen lds
s_add_u32 m0, m0, 1024
s_add_u32 s39, s39, 65536
buffer_load_dwordx4 v51, s[8:11], s39 offen lds
s_add_u32 m0, m0, 1024
s_add_u32 s39, s39, 65536
buffer_load_dwordx4 v51, s[8:11], s39 offen lds
s_add_u32 m0, m0, 1024
s_add_u32 s39, s39, 65536
buffer_load_dwordx4 v51, s[8:11], s39 offen lds
s_waitcnt vmcnt(32)
v_min_u32 v57, -2, v57
buffer_store_dword v57, v10, s[4:7], s45 offen sc1
ds_read_b64_tr_b16 a[96:97], v54 offset:0
ds_read_b64_tr_b16 a[98:99], v54 offset:512
ds_read_b64_tr_b16 a[100:101], v54 offset:4096
ds_read_b64_tr_b16 a[102:103], v54 offset:4608
ds_read_b64_tr_b16 a[104:105], v54 offset:16
ds_read_b64_tr_b16 a[106:107], v54 offset:528
ds_read_b64_tr_b16 a[108:109], v54 offset:4112
ds_read_b64_tr_b16 a[110:111], v54 offset:4624
ds_read_b64_tr_b16 a[112:113], v54 offset:64
ds_read_b64_tr_b16 a[114:115], v54 offset:576
ds_read_b64_tr_b16 a[116:117], v54 offset:4160
ds_read_b64_tr_b16 a[118:119], v54 offset:4672
ds_read_b64_tr_b16 a[120:121], v54 offset:80
ds_read_b64_tr_b16 a[122:123], v54 offset:592
ds_read_b64_tr_b16 a[124:125], v54 offset:4176
ds_read_b64_tr_b16 a[126:127], v54 offset:4688
s_waitcnt lgkmcnt(0)
s_mov_b32 s8, s22
s_and_b32 s9, s23, 0xffff
s_mov_b32 s10, 0x800000
s_mov_b32 s11, 0x20000
s_lshl_b32 s39, s32, 21
s_lshl_b32 s38, s33, 4
s_add_u32 s38, s38, s54
s_xor_b32 s38, s38, 2
s_lshl_b32 s38, s38, 7
s_add_u32 s39, s39, s38
s_add_u32 s39, s39, 524288
s_mul_i32 s38, s32, 40960
s_add_u32 m0, s38, 0
s_nop 0
buffer_load_dwordx4 v52, s[8:11], s39 offen lds
s_add_u32 m0, m0, 1024
s_add_u32 s39, s39, 65536
buffer_load_dwordx4 v52, s[8:11], s39 offen lds
s_add_u32 m0, m0, 1024
s_add_u32 s39, s39, 65536
buffer_load_dwordx4 v52, s[8:11], s39 offen lds
s_add_u32 m0, m0, 1024
s_add_u32 s39, s39, 65536
buffer_load_dwordx4 v52, s[8:11], s39 offen lds
s_add_u32 m0, m0, 1024
s_add_u32 s39, s39, 65536
buffer_load_dwordx4 v52, s[8:11], s39 offen lds
s_add_u32 m0, m0, 1024
s_add_u32 s39, s39, 65536
buffer_load_dwordx4 v52, s[8:11], s39 offen lds
s_add_u32 m0, m0, 1024
s_add_u32 s39, s39, 65536
buffer_load_dwordx4 v52, s[8:11], s39 offen lds
s_add_u32 m0, m0, 1024
s_add_u32 s39, s39, 65536
buffer_load_dwordx4 v52, s[8:11], s39 offen lds
s_waitcnt vmcnt(32)
ds_read_b64_tr_b16 v[224:225], v55 offset:8192
ds_read_b64_tr_b16 v[226:227], v55 offset:8704
ds_read_b64_tr_b16 v[228:229], v55 offset:12288
ds_read_b64_tr_b16 v[230:231], v55 offset:12800
ds_read_b64_tr_b16 v[232:233], v55 offset:8224
ds_read_b64_tr_b16 v[234:235], v55 offset:8736
ds_read_b64_tr_b16 v[236:237], v55 offset:12320
ds_read_b64_tr_b16 v[238:239], v55 offset:12832
ds_read_b64_tr_b16 v[240:241], v55 offset:8256
ds_read_b64_tr_b16 v[242:243], v55 offset:8768
ds_read_b64_tr_b16 v[244:245], v55 offset:12352
ds_read_b64_tr_b16 v[246:247], v55 offset:12864
ds_read_b64_tr_b16 v[248:249], v55 offset:8288
ds_read_b64_tr_b16 v[250:251], v55 offset:8800
ds_read_b64_tr_b16 v[252:253], v55 offset:12384
ds_read_b64_tr_b16 v[254:255], v55 offset:12896
s_waitcnt lgkmcnt(0)
s_mov_b32 s8, s20
s_and_b32 s9, s21, 0xffff
s_mov_b32 s10, 0x800000
s_mov_b32 s11, 0x20000
s_lshl_b32 s39, s32, 21
s_lshl_b32 s38, s33, 4
s_add_u32 s38, s38, s54
s_xor_b32 s38, s38, 4
s_lshl_b32 s38, s38, 7
s_add_u32 s39, s39, s38
s_add_u32 s39, s39, 0
s_mul_i32 s38, s32, 40960
s_add_u32 m0, s38, 8192
s_nop 0
buffer_load_dwordx4 v51, s[8:11], s39 offen lds
s_add_u32 m0, m0, 1024
s_add_u32 s39, s39, 65536
buffer_load_dwordx4 v51, s[8:11], s39 offen lds
s_add_u32 m0, m0, 1024
s_add_u32 s39, s39, 65536
buffer_load_dwordx4 v51, s[8:11], s39 offen lds
s_add_u32 m0, m0, 1024
s_add_u32 s39, s39, 65536
buffer_load_dwordx4 v51, s[8:11], s39 offen lds
s_add_u32 m0, m0, 1024
s_add_u32 s39, s39, 65536
buffer_load_dwordx4 v51, s[8:11], s39 offen lds
s_add_u32 m0, m0, 1024
s_add_u32 s39, s39, 65536
buffer_load_dwordx4 v51, s[8:11], s39 offen lds
s_add_u32 m0, m0, 1024
s_add_u32 s39, s39, 65536
buffer_load_dwordx4 v51, s[8:11], s39 offen lds
s_add_u32 m0, m0, 1024
s_add_u32 s39, s39, 65536
buffer_load_dwordx4 v51, s[8:11], s39 offen lds
s_waitcnt vmcnt(32)
ds_read_b64_tr_b16 a[64:65], v54 offset:16384
ds_read_b64_tr_b16 a[66:67], v54 offset:16896
ds_read_b64_tr_b16 a[68:69], v54 offset:20480
ds_read_b64_tr_b16 a[70:71], v54 offset:20992
ds_read_b64_tr_b16 a[72:73], v54 offset:16400
ds_read_b64_tr_b16 a[74:75], v54 offset:16912
ds_read_b64_tr_b16 a[76:77], v54 offset:20496
ds_read_b64_tr_b16 a[78:79], v54 offset:21008
ds_read_b64_tr_b16 a[80:81], v54 offset:16448
ds_read_b64_tr_b16 a[82:83], v54 offset:16960
ds_read_b64_tr_b16 a[84:85], v54 offset:20544
ds_read_b64_tr_b16 a[86:87], v54 offset:21056
ds_read_b64_tr_b16 a[88:89], v54 offset:16464
ds_read_b64_tr_b16 a[90:91], v54 offset:16976
ds_read_b64_tr_b16 a[92:93], v54 offset:20560
ds_read_b64_tr_b16 a[94:95], v54 offset:21072
s_waitcnt lgkmcnt(0)
s_mov_b32 s8, s22
s_and_b32 s9, s23, 0xffff
s_mov_b32 s10, 0x800000
s_mov_b32 s11, 0x20000
s_lshl_b32 s39, s32, 21
s_lshl_b32 s38, s33, 4
s_add_u32 s38, s38, s54
s_xor_b32 s38, s38, 2
s_lshl_b32 s38, s38, 7
s_add_u32 s39, s39, s38
s_add_u32 s39, s39, 0
s_mul_i32 s38, s32, 40960
s_add_u32 m0, s38, 16384
s_nop 0
buffer_load_dwordx4 v52, s[8:11], s39 offen lds
s_add_u32 m0, m0, 1024
s_add_u32 s39, s39, 65536
buffer_load_dwordx4 v52, s[8:11], s39 offen lds
s_add_u32 m0, m0, 1024
s_add_u32 s39, s39, 65536
buffer_load_dwordx4 v52, s[8:11], s39 offen lds
s_add_u32 m0, m0, 1024
s_add_u32 s39, s39, 65536
buffer_load_dwordx4 v52, s[8:11], s39 offen lds
s_add_u32 m0, m0, 1024
s_add_u32 s39, s39, 65536
buffer_load_dwordx4 v52, s[8:11], s39 offen lds
s_add_u32 m0, m0, 1024
s_add_u32 s39, s39, 65536
buffer_load_dwordx4 v52, s[8:11], s39 offen lds
s_add_u32 m0, m0, 1024
s_add_u32 s39, s39, 65536
buffer_load_dwordx4 v52, s[8:11], s39 offen lds
s_add_u32 m0, m0, 1024
s_add_u32 s39, s39, 65536
buffer_load_dwordx4 v52, s[8:11], s39 offen lds
s_waitcnt vmcnt(32)
ds_read_b64_tr_b16 v[192:193], v55 offset:24576
ds_read_b64_tr_b16 v[194:195], v55 offset:25088
ds_read_b64_tr_b16 v[196:197], v55 offset:28672
ds_read_b64_tr_b16 v[198:199], v55 offset:29184
ds_read_b64_tr_b16 v[200:201], v55 offset:24608
ds_read_b64_tr_b16 v[202:203], v55 offset:25120
ds_read_b64_tr_b16 v[204:205], v55 offset:28704
ds_read_b64_tr_b16 v[206:207], v55 offset:29216
ds_read_b64_tr_b16 v[208:209], v55 offset:24640
ds_read_b64_tr_b16 v[210:211], v55 offset:25152
ds_read_b64_tr_b16 v[212:213], v55 offset:28736
ds_read_b64_tr_b16 v[214:215], v55 offset:29248
ds_read_b64_tr_b16 v[216:217], v55 offset:24672
ds_read_b64_tr_b16 v[218:219], v55 offset:25184
ds_read_b64_tr_b16 v[220:221], v55 offset:28768
ds_read_b64_tr_b16 v[222:223], v55 offset:29280
s_waitcnt lgkmcnt(0)
s_mov_b32 s8, s24
s_and_b32 s9, s25, 0xffff
s_mov_b32 s10, 0x800000
s_mov_b32 s11, 0x20000
s_lshl_b32 s39, s33, 2
s_add_u32 s39, s39, s32
s_lshl_b32 s39, s39, 19
s_lshl_b32 s38, s54, 7
s_add_u32 s39, s39, s38
s_add_u32 s39, s39, 0
s_mul_i32 s38, s32, 40960
s_add_u32 m0, s38, 24576
s_nop 0
buffer_load_dwordx4 v53, s[8:11], s39 offen lds
s_add_u32 m0, m0, 1024
s_add_u32 s39, s39, 16384
buffer_load_dwordx4 v53, s[8:11], s39 offen lds
s_add_u32 m0, m0, 1024
s_add_u32 s39, s39, 16384
buffer_load_dwordx4 v53, s[8:11], s39 offen lds
s_add_u32 m0, m0, 1024
s_add_u32 s39, s39, 16384
buffer_load_dwordx4 v53, s[8:11], s39 offen lds
s_add_u32 m0, m0, 1024
s_add_u32 s39, s39, 16384
buffer_load_dwordx4 v53, s[8:11], s39 offen lds
s_add_u32 m0, m0, 1024
s_add_u32 s39, s39, 16384
buffer_load_dwordx4 v53, s[8:11], s39 offen lds
s_add_u32 m0, m0, 1024
s_add_u32 s39, s39, 16384
buffer_load_dwordx4 v53, s[8:11], s39 offen lds
s_add_u32 m0, m0, 1024
s_add_u32 s39, s39, 16384
buffer_load_dwordx4 v53, s[8:11], s39 offen lds
s_waitcnt vmcnt(32)
ds_read_b64_tr_b16 a[32:33], v54 offset:32768
ds_read_b64_tr_b16 a[34:35], v54 offset:33280
ds_read_b64_tr_b16 a[36:37], v54 offset:36864
ds_read_b64_tr_b16 a[38:39], v54 offset:37376
ds_read_b64_tr_b16 a[40:41], v54 offset:32784
ds_read_b64_tr_b16 a[42:43], v54 offset:33296
ds_read_b64_tr_b16 a[44:45], v54 offset:36880
ds_read_b64_tr_b16 a[46:47], v54 offset:37392
ds_read_b64_tr_b16 a[48:49], v54 offset:32832
ds_read_b64_tr_b16 a[50:51], v54 offset:33344
ds_read_b64_tr_b16 a[52:53], v54 offset:36928
ds_read_b64_tr_b16 a[54:55], v54 offset:37440
ds_read_b64_tr_b16 a[56:57], v54 offset:32848
ds_read_b64_tr_b16 a[58:59], v54 offset:33360
ds_read_b64_tr_b16 a[60:61], v54 offset:36944
ds_read_b64_tr_b16 a[62:63], v54 offset:37456
s_waitcnt lgkmcnt(0)
s_mov_b32 s8, s24
s_and_b32 s9, s25, 0xffff
s_mov_b32 s10, 0x800000
s_mov_b32 s11, 0x20000
s_lshl_b32 s39, s33, 2
s_add_u32 s39, s39, s32
s_lshl_b32 s39, s39, 19
s_lshl_b32 s38, s54, 7
s_add_u32 s39, s39, s38
s_add_u32 s39, s39, 131072
s_mul_i32 s38, s32, 40960
s_add_u32 m0, s38, 32768
s_nop 0
buffer_load_dwordx4 v53, s[8:11], s39 offen lds
s_add_u32 m0, m0, 1024
s_add_u32 s39, s39, 16384
buffer_load_dwordx4 v53, s[8:11], s39 offen lds
s_add_u32 m0, m0, 1024
s_add_u32 s39, s39, 16384
buffer_load_dwordx4 v53, s[8:11], s39 offen lds
s_add_u32 m0, m0, 1024
s_add_u32 s39, s39, 16384
buffer_load_dwordx4 v53, s[8:11], s39 offen lds
s_add_u32 m0, m0, 1024
s_add_u32 s39, s39, 16384
buffer_load_dwordx4 v53, s[8:11], s39 offen lds
s_add_u32 m0, m0, 1024
s_add_u32 s39, s39, 16384
buffer_load_dwordx4 v53, s[8:11], s39 offen lds
s_add_u32 m0, m0, 1024
s_add_u32 s39, s39, 16384
buffer_load_dwordx4 v53, s[8:11], s39 offen lds
s_add_u32 m0, m0, 1024
s_add_u32 s39, s39, 16384
buffer_load_dwordx4 v53, s[8:11], s39 offen lds
s_waitcnt vmcnt(32)
ds_read_b64_tr_b16 v[160:161], v55 offset:0
ds_read_b64_tr_b16 v[162:163], v55 offset:512
ds_read_b64_tr_b16 v[164:165], v55 offset:4096
ds_read_b64_tr_b16 v[166:167], v55 offset:4608
ds_read_b64_tr_b16 v[168:169], v55 offset:32
ds_read_b64_tr_b16 v[170:171], v55 offset:544
ds_read_b64_tr_b16 v[172:173], v55 offset:4128
ds_read_b64_tr_b16 v[174:175], v55 offset:4640
ds_read_b64_tr_b16 v[176:177], v55 offset:64
ds_read_b64_tr_b16 v[178:179], v55 offset:576
ds_read_b64_tr_b16 v[180:181], v55 offset:4160
ds_read_b64_tr_b16 v[182:183], v55 offset:4672
ds_read_b64_tr_b16 v[184:185], v55 offset:96
ds_read_b64_tr_b16 v[186:187], v55 offset:608
ds_read_b64_tr_b16 v[188:189], v55 offset:4192
ds_read_b64_tr_b16 v[190:191], v55 offset:4704
s_waitcnt lgkmcnt(0)
s_mov_b32 s8, s24
s_and_b32 s9, s25, 0xffff
s_mov_b32 s10, 0x800000
s_mov_b32 s11, 0x20000
s_lshl_b32 s39, s33, 2
s_add_u32 s39, s39, s32
s_lshl_b32 s39, s39, 19
s_lshl_b32 s38, s54, 7
s_add_u32 s39, s39, s38
s_add_u32 s39, s39, 262144
s_mul_i32 s38, s32, 40960
s_add_u32 m0, s38, 0
s_nop 0
buffer_load_dwordx4 v53, s[8:11], s39 offen lds
s_add_u32 m0, m0, 1024
s_add_u32 s39, s39, 16384
buffer_load_dwordx4 v53, s[8:11], s39 offen lds
s_add_u32 m0, m0, 1024
s_add_u32 s39, s39, 16384
buffer_load_dwordx4 v53, s[8:11], s39 offen lds
s_add_u32 m0, m0, 1024
s_add_u32 s39, s39, 16384
buffer_load_dwordx4 v53, s[8:11], s39 offen lds
s_add_u32 m0, m0, 1024
s_add_u32 s39, s39, 16384
buffer_load_dwordx4 v53, s[8:11], s39 offen lds
s_add_u32 m0, m0, 1024
s_add_u32 s39, s39, 16384
buffer_load_dwordx4 v53, s[8:11], s39 offen lds
s_add_u32 m0, m0, 1024
s_add_u32 s39, s39, 16384
buffer_load_dwordx4 v53, s[8:11], s39 offen lds
s_add_u32 m0, m0, 1024
s_add_u32 s39, s39, 16384
buffer_load_dwordx4 v53, s[8:11], s39 offen lds
s_waitcnt vmcnt(32)
ds_read_b64_tr_b16 a[0:1], v54 offset:8192
ds_read_b64_tr_b16 a[2:3], v54 offset:8704
ds_read_b64_tr_b16 a[4:5], v54 offset:12288
ds_read_b64_tr_b16 a[6:7], v54 offset:12800
ds_read_b64_tr_b16 a[8:9], v54 offset:8208
ds_read_b64_tr_b16 a[10:11], v54 offset:8720
ds_read_b64_tr_b16 a[12:13], v54 offset:12304
ds_read_b64_tr_b16 a[14:15], v54 offset:12816
ds_read_b64_tr_b16 a[16:17], v54 offset:8256
ds_read_b64_tr_b16 a[18:19], v54 offset:8768
ds_read_b64_tr_b16 a[20:21], v54 offset:12352
ds_read_b64_tr_b16 a[22:23], v54 offset:12864
ds_read_b64_tr_b16 a[24:25], v54 offset:8272
ds_read_b64_tr_b16 a[26:27], v54 offset:8784
ds_read_b64_tr_b16 a[28:29], v54 offset:12368
ds_read_b64_tr_b16 a[30:31], v54 offset:12880
s_waitcnt lgkmcnt(0)
s_mov_b32 s8, s24
s_and_b32 s9, s25, 0xffff
s_mov_b32 s10, 0x800000
s_mov_b32 s11, 0x20000
s_lshl_b32 s39, s33, 2
s_add_u32 s39, s39, s32
s_lshl_b32 s39, s39, 19
s_lshl_b32 s38, s54, 7
s_add_u32 s39, s39, s38
s_add_u32 s39, s39, 393216
s_mul_i32 s38, s32, 40960
s_add_u32 m0, s38, 8192
s_nop 0
buffer_load_dwordx4 v53, s[8:11], s39 offen lds
s_add_u32 m0, m0, 1024
s_add_u32 s39, s39, 16384
buffer_load_dwordx4 v53, s[8:11], s39 offen lds
s_add_u32 m0, m0, 1024
s_add_u32 s39, s39, 16384
buffer_load_dwordx4 v53, s[8:11], s39 offen lds
s_add_u32 m0, m0, 1024
s_add_u32 s39, s39, 16384
buffer_load_dwordx4 v53, s[8:11], s39 offen lds
s_add_u32 m0, m0, 1024
s_add_u32 s39, s39, 16384
buffer_load_dwordx4 v53, s[8:11], s39 offen lds
s_add_u32 m0, m0, 1024
s_add_u32 s39, s39, 16384
buffer_load_dwordx4 v53, s[8:11], s39 offen lds
s_add_u32 m0, m0, 1024
s_add_u32 s39, s39, 16384
buffer_load_dwordx4 v53, s[8:11], s39 offen lds
s_add_u32 m0, m0, 1024
s_add_u32 s39, s39, 16384
buffer_load_dwordx4 v53, s[8:11], s39 offen lds
s_waitcnt vmcnt(32)
ds_read_b64_tr_b16 v[128:129], v55 offset:16384
ds_read_b64_tr_b16 v[130:131], v55 offset:16896
ds_read_b64_tr_b16 v[132:133], v55 offset:20480
ds_read_b64_tr_b16 v[134:135], v55 offset:20992
ds_read_b64_tr_b16 v[136:137], v55 offset:16416
ds_read_b64_tr_b16 v[138:139], v55 offset:16928
ds_read_b64_tr_b16 v[140:141], v55 offset:20512
ds_read_b64_tr_b16 v[142:143], v55 offset:21024
ds_read_b64_tr_b16 v[144:145], v55 offset:16448
ds_read_b64_tr_b16 v[146:147], v55 offset:16960
ds_read_b64_tr_b16 v[148:149], v55 offset:20544
ds_read_b64_tr_b16 v[150:151], v55 offset:21056
ds_read_b64_tr_b16 v[152:153], v55 offset:16480
ds_read_b64_tr_b16 v[154:155], v55 offset:16992
ds_read_b64_tr_b16 v[156:157], v55 offset:20576
ds_read_b64_tr_b16 v[158:159], v55 offset:21088
s_waitcnt lgkmcnt(0)
s_waitcnt vmcnt(24)
ds_read_b64_tr_b16 a[128:129], v56 offset:24576
ds_read_b64_tr_b16 a[130:131], v56 offset:24832
ds_read_b64_tr_b16 a[132:133], v56 offset:28672
ds_read_b64_tr_b16 a[134:135], v56 offset:28928
ds_read_b64_tr_b16 a[136:137], v56 offset:24608
ds_read_b64_tr_b16 a[138:139], v56 offset:24864
ds_read_b64_tr_b16 a[140:141], v56 offset:28704
ds_read_b64_tr_b16 a[142:143], v56 offset:28960
ds_read_b64_tr_b16 a[144:145], v56 offset:24640
ds_read_b64_tr_b16 a[146:147], v56 offset:24896
ds_read_b64_tr_b16 a[148:149], v56 offset:28736
ds_read_b64_tr_b16 a[150:151], v56 offset:28992
ds_read_b64_tr_b16 a[152:153], v56 offset:24672
ds_read_b64_tr_b16 a[154:155], v56 offset:24928
ds_read_b64_tr_b16 a[156:157], v56 offset:28768
ds_read_b64_tr_b16 a[158:159], v56 offset:29024
s_waitcnt lgkmcnt(0)
s_waitcnt vmcnt(16)
ds_read_b64_tr_b16 a[160:161], v56 offset:32768
ds_read_b64_tr_b16 a[162:163], v56 offset:33024
ds_read_b64_tr_b16 a[164:165], v56 offset:36864
ds_read_b64_tr_b16 a[166:167], v56 offset:37120
ds_read_b64_tr_b16 a[168:169], v56 offset:32800
ds_read_b64_tr_b16 a[170:171], v56 offset:33056
ds_read_b64_tr_b16 a[172:173], v56 offset:36896
ds_read_b64_tr_b16 a[174:175], v56 offset:37152
ds_read_b64_tr_b16 a[176:177], v56 offset:32832
ds_read_b64_tr_b16 a[178:179], v56 offset:33088
ds_read_b64_tr_b16 a[180:181], v56 offset:36928
ds_read_b64_tr_b16 a[182:183], v56 offset:37184
ds_read_b64_tr_b16 a[184:185], v56 offset:32864
ds_read_b64_tr_b16 a[186:187], v56 offset:33120
ds_read_b64_tr_b16 a[188:189], v56 offset:36960
ds_read_b64_tr_b16 a[190:191], v56 offset:37216
s_waitcnt lgkmcnt(0)
s_waitcnt vmcnt(8)
ds_read_b64_tr_b16 a[192:193], v56 offset:0
ds_read_b64_tr_b16 a[194:195], v56 offset:256
ds_read_b64_tr_b16 a[196:197], v56 offset:4096
ds_read_b64_tr_b16 a[198:199], v56 offset:4352
ds_read_b64_tr_b16 a[200:201], v56 offset:32
ds_read_b64_tr_b16 a[202:203], v56 offset:288
ds_read_b64_tr_b16 a[204:205], v56 offset:4128
ds_read_b64_tr_b16 a[206:207], v56 offset:4384
ds_read_b64_tr_b16 a[208:209], v56 offset:64
ds_read_b64_tr_b16 a[210:211], v56 offset:320
ds_read_b64_tr_b16 a[212:213], v56 offset:4160
ds_read_b64_tr_b16 a[214:215], v56 offset:4416
ds_read_b64_tr_b16 a[216:217], v56 offset:96
ds_read_b64_tr_b16 a[218:219], v56 offset:352
ds_read_b64_tr_b16 a[220:221], v56 offset:4192
ds_read_b64_tr_b16 a[222:223], v56 offset:4448
s_waitcnt lgkmcnt(0)
s_waitcnt vmcnt(0)
ds_read_b64_tr_b16 a[224:225], v56 offset:8192
ds_read_b64_tr_b16 a[226:227], v56 offset:8448
ds_read_b64_tr_b16 a[228:229], v56 offset:12288
ds_read_b64_tr_b16 a[230:231], v56 offset:12544
ds_read_b64_tr_b16 a[232:233], v56 offset:8224
ds_read_b64_tr_b16 a[234:235], v56 offset:8480
ds_read_b64_tr_b16 a[236:237], v56 offset:12320
ds_read_b64_tr_b16 a[238:239], v56 offset:12576
ds_read_b64_tr_b16 a[240:241], v56 offset:8256
ds_read_b64_tr_b16 a[242:243], v56 offset:8512
ds_read_b64_tr_b16 a[244:245], v56 offset:12352
ds_read_b64_tr_b16 a[246:247], v56 offset:12608
ds_read_b64_tr_b16 a[248:249], v56 offset:8288
ds_read_b64_tr_b16 a[250:251], v56 offset:8544
ds_read_b64_tr_b16 a[252:253], v56 offset:12384
ds_read_b64_tr_b16 a[254:255], v56 offset:12640
s_waitcnt lgkmcnt(0)
Lst_274:
buffer_load_dword v48, off, s[12:15], 0 offset:32 sc1
buffer_load_dword v49, off, s[12:15], 0 offset:160 sc1
s_waitcnt vmcnt(0)
v_add_u32 v48, v48, v49
s_nop 0
v_readfirstlane_b32 s38, v48
s_nop 3
s_and_b32 s39, s38, 0x200ffff
s_cmp_eq_u32 s39, 0x2000100
s_cbranch_scc1 Lso_275
s_sub_u32 s37, s37, 1
s_cbranch_scc1 Lend_1
s_sleep 8
s_branch Lst_274
Lso_275:
s_bfe_u32 s35, s38, 0x80010
s_bfe_u32 s46, s38, 0x10018
s_lshl_b32 s46, s46, 13
s_barrier
v_mov_b32 v44, 0
v_mov_b32 v45, 0
v_mov_b32 v46, 0
v_mov_b32 v47, 0
v_mov_b32 v48, 0
v_mov_b32 v49, 0
v_mov_b32 v50, 0
v_mov_b32 v51, 0
v_mov_b32 v52, 0
v_mov_b32 v53, 0
v_mov_b32 v54, 0
v_mov_b32 v55, 0
v_mov_b32 v56, 0
v_mov_b32 v57, 0
v_mov_b32 v58, 0
v_mov_b32 v59, 0
v_mov_b32 v60, 0
v_mov_b32 v61, 0
v_mov_b32 v62, 0
v_mov_b32 v63, 0
v_mov_b32 v64, 0
v_mov_b32 v65, 0
v_mov_b32 v66, 0
v_mov_b32 v67, 0
v_mov_b32 v68, 0
v_mov_b32 v69, 0
v_mov_b32 v70, 0
v_mov_b32 v71, 0
v_mov_b32 v72, 0
v_mov_b32 v73, 0
v_mov_b32 v74, 0
v_mov_b32 v75, 0
v_mov_b32 v76, 0
v_mov_b32 v77, 0
v_mov_b32 v78, 0
v_mov_b32 v79, 0
v_mov_b32 v80, 0
v_mov_b32 v81, 0
v_mov_b32 v82, 0
v_mov_b32 v83, 0
v_mov_b32 v84, 0
v_mov_b32 v85, 0
v_mov_b32 v86, 0
v_mov_b32 v87, 0
v_mov_b32 v88, 0
v_mov_b32 v89, 0
v_mov_b32 v90, 0
v_mov_b32 v91, 0
s_mov_b32 s36, 0
s_and_b32 s38, s36, 3
s_lshl_b32 s39, s38, 16
s_add_u32 s40, s39, s45
s_xor_b32 s42, s40, 0x20000
s_add_u32 s26, s36, 1
s_cmp_lg_u32 s35, 0
s_cbranch_scc1 Lkvo_sc1_276
Lkvo_277:
buffer_load_dwordx4 v[28:31], v8, s[4:7], s40 offen offset:0 sc1
v_mfma_f32_16x16x32_bf16 v[16:19], v[20:23], v[20:23], 0
v_mfma_f32_16x16x32_bf16 v[16:19], v[20:23], v[20:23], 0
v_mfma_f32_16x16x32_bf16 v[16:19], v[20:23], v[20:23], 0
buffer_load_dwordx4 v[32:35], v8, s[4:7], s40 offen offset:1024 sc1
v_mfma_f32_16x16x32_bf16 v[16:19], v[20:23], v[20:23], 0
v_mfma_f32_16x16x32_bf16 v[16:19], v[20:23], v[20:23], 0
v_mfma_f32_16x16x32_bf16 v[16:19], v[20:23], v[20:23], 0
buffer_load_dwordx4 v[36:39], v8, s[4:7], s40 offen offset:2048 sc1
v_mfma_f32_16x16x32_bf16 v[16:19], v[20:23], v[20:23], 0
v_mfma_f32_16x16x32_bf16 v[16:19], v[20:23], v[20:23], 0
v_mfma_f32_16x16x32_bf16 v[16:19], v[20:23], v[20:23], 0
buffer_load_dwordx4 v[40:43], v8, s[4:7], s40 offen offset:3072 sc1
v_mfma_f32_16x16x32_bf16 v[16:19], v[20:23], v[20:23], 0
s_waitcnt vmcnt(3)
v_max3_u32 v110, v28, v29, v30
v_max_u32 v110, v110, v31
v_cmp_eq_u32 vcc, -1, v110
s_cbranch_vccnz Lpf_279
v_smfmac_f32_16x16x64_bf16 v[44:47], v[28:31], a[0:7], v126
v_smfmac_f32_16x16x64_bf16 v[48:51], v[28:31], a[8:15], v126
s_waitcnt vmcnt(2)
v_max3_u32 v110, v32, v33, v34
v_max_u32 v110, v110, v35
v_cmp_eq_u32 vcc, -1, v110
v_smfmac_f32_16x16x64_bf16 v[52:55], v[28:31], a[16:23], v126
v_smfmac_f32_16x16x64_bf16 v[60:63], v[28:31], v[128:135], v126
s_cbranch_vccnz Lpf_280
v_smfmac_f32_16x16x64_bf16 v[44:47], v[32:35], a[32:39], v126
v_smfmac_f32_16x16x64_bf16 v[48:51], v[32:35], a[40:47], v126
s_waitcnt vmcnt(1)
v_max3_u32 v110, v36, v37, v38
v_max_u32 v110, v110, v39
v_cmp_eq_u32 vcc, -1, v110
v_smfmac_f32_16x16x64_bf16 v[52:55], v[32:35], a[48:55], v126
v_smfmac_f32_16x16x64_bf16 v[60:63], v[32:35], v[160:167], v126
s_cbranch_vccnz Lpf_281
v_smfmac_f32_16x16x64_bf16 v[44:47], v[36:39], a[64:71], v126
v_smfmac_f32_16x16x64_bf16 v[48:51], v[36:39], a[72:79], v126
s_waitcnt vmcnt(0)
v_max3_u32 v110, v40, v41, v42
v_max_u32 v110, v110, v43
v_cmp_eq_u32 vcc, -1, v110
v_smfmac_f32_16x16x64_bf16 v[52:55], v[36:39], a[80:87], v126
v_smfmac_f32_16x16x64_bf16 v[60:63], v[36:39], v[192:199], v126
s_cbranch_vccnz Lpf_282
v_smfmac_f32_16x16x64_bf16 v[44:47], v[40:43], a[96:103], v126
s_nop 1
v_smfmac_f32_16x16x64_bf16 v[48:51], v[40:43], a[104:111], v126
s_nop 1
v_smfmac_f32_16x16x64_bf16 v[52:55], v[40:43], a[112:119], v126
s_nop 1
v_add_f32 v92, v44, v46
v_add_f32 v93, v45, v47
v_smfmac_f32_16x16x64_bf16 v[56:59], v[28:31], a[24:31], v126
v_add_f32 v94, v48, v50
v_add_f32 v95, v49, v51
ds_write_b64 v24, v[92:93] offset:0
v_add_f32 v96, v52, v54
v_add_f32 v97, v53, v55
ds_write_b64 v25, v[94:95] offset:0
v_smfmac_f32_16x16x64_bf16 v[56:59], v[32:35], a[56:63], v126
ds_write_b64 v26, v[96:97] offset:0
v_smfmac_f32_16x16x64_bf16 v[56:59], v[36:39], a[88:95], v126
v_smfmac_f32_16x16x64_bf16 v[56:59], v[40:43], a[120:127], v126
v_smfmac_f32_16x16x64_bf16 v[60:63], v[40:43], v[224:231], v126
Lpd_278:
v_smfmac_f32_16x16x64_bf16 v[64:67], v[28:31], v[136:143], v126
v_smfmac_f32_16x16x64_bf16 v[64:67], v[32:35], v[168:175], v126
s_waitcnt lgkmcnt(0)
s_barrier
ds_read_b64 v[100:101], v0 offset:0
ds_read_b64 v[102:103], v0 offset:512
ds_read_b64 v[104:105], v0 offset:1024
s_nop 2
v_add_f32 v98, v56, v58
v_add_f32 v99, v57, v59
v_smfmac_f32_16x16x64_bf16 v[64:67], v[36:39], v[200:207], v126
v_smfmac_f32_16x16x64_bf16 v[64:67], v[40:43], v[232:239], v126
v_smfmac_f32_16x16x64_bf16 v[68:71], v[28:31], v[144:151], v126
v_smfmac_f32_16x16x64_bf16 v[68:71], v[32:35], v[176:183], v126
s_waitcnt lgkmcnt(0)
v_add_f32 v100, v100, v98
v_add_f32 v102, v102, v104
v_add_f32 v101, v101, v99
v_add_f32 v103, v103, v105
v_add_f32 v100, v100, v102
v_add_f32 v101, v101, v103
v_cvt_pk_bf16_f32 v108, v100, v101
s_nop 1
v_mov_b32_dpp v109, v108 quad_perm:[1,0,3,2] row_mask:0xf bank_mask:0xf
v_perm_b32 v109, v109, v108, v3
buffer_store_dword v109, v11, s[4:7], s40 offen
v_smfmac_f32_16x16x64_bf16 v[68:71], v[36:39], v[208:215], v126
v_smfmac_f32_16x16x64_bf16 v[68:71], v[40:43], v[240:247], v126
s_nop 3
v_smfmac_f32_16x16x64_bf16 v[72:75], v[28:31], v[152:159], v126
v_add_f32 v92, v60, v62
v_add_f32 v93, v61, v63
v_smfmac_f32_16x16x64_bf16 v[72:75], v[32:35], v[184:191], v126
v_add_f32 v94, v64, v66
v_add_f32 v95, v65, v67
ds_write_b64 v24, v[92:93] offset:6144
v_smfmac_f32_16x16x64_bf16 v[72:75], v[36:39], v[216:223], v126
v_add_f32 v96, v68, v70
v_add_f32 v97, v69, v71
ds_write_b64 v25, v[94:95] offset:6144
ds_write_b64 v26, v[96:97] offset:6144
v_smfmac_f32_16x16x64_bf16 v[72:75], v[40:43], v[248:255], v126
s_waitcnt lgkmcnt(0)
s_barrier
ds_read_b64 v[100:101], v0 offset:6144
ds_read_b64 v[102:103], v0 offset:6656
ds_read_b64 v[104:105], v0 offset:7168
s_nop 2
v_add_f32 v98, v72, v74
v_add_f32 v99, v73, v75
s_waitcnt lgkmcnt(0)
v_pk_add_f32 v[100:101], v[100:101], v[98:99]
v_pk_add_f32 v[102:103], v[102:103], v[104:105]
v_pk_add_f32 v[100:101], v[100:101], v[102:103]
v_cvt_pk_bf16_f32 v108, v100, v101
buffer_store_dword v108, v27, s[4:7], s40 offen
s_cmp_eq_u32 s36, 63
s_cbranch_scc1 Lend_1
v_add_u32 v7, 1, v7
s_and_b32 s38, s36, 3
s_lshl_b32 s84, s38, 18
s_add_u32 s84, s84, s46
s_add_u32 s85, s84, 0x100000
s_mov_b64 exec, 3
buffer_load_dword v112, v1, s[4:7], s59 offen sc1
s_nop 5
buffer_load_dword v113, v1, s[4:7], s59 offen sc1
s_nop 5
buffer_load_dword v114, v1, s[4:7], s59 offen sc1
s_nop 5
buffer_load_dword v115, v1, s[4:7], s59 offen sc1
Lft_284:
s_waitcnt vmcnt(3)
v_cmp_gt_u32 vcc, s26, v112
buffer_load_dword v112, v1, s[4:7], s59 offen sc1
s_cbranch_vccz Lfg_283
s_waitcnt vmcnt(3)
v_cmp_gt_u32 vcc, s26, v113
buffer_load_dword v113, v1, s[4:7], s59 offen sc1
s_cbranch_vccz Lfg_283
s_waitcnt vmcnt(3)
v_cmp_gt_u32 vcc, s26, v114
buffer_load_dword v114, v1, s[4:7], s59 offen sc1
s_cbranch_vccz Lfg_283
s_waitcnt vmcnt(3)
v_cmp_gt_u32 vcc, s26, v115
buffer_load_dword v115, v1, s[4:7], s59 offen sc1
s_cbranch_vccz Lfg_283
s_sub_u32 s37, s37, 1
s_cbranch_scc1 Lend_1
s_branch Lft_284
Lfg_283:
s_mov_b64 exec, -1
buffer_load_dwordx4 v[28:31], v9, s[4:7], s40 offen offset:0 sc1
v_mfma_f32_16x16x32_bf16 v[16:19], v[20:23], v[20:23], 0
v_mfma_f32_16x16x32_bf16 v[16:19], v[20:23], v[20:23], 0
v_mfma_f32_16x16x32_bf16 v[16:19], v[20:23], v[20:23], 0
buffer_load_dwordx4 v[32:35], v9, s[4:7], s40 offen offset:1024 sc1
v_mfma_f32_16x16x32_bf16 v[16:19], v[20:23], v[20:23], 0
v_mfma_f32_16x16x32_bf16 v[16:19], v[20:23], v[20:23], 0
v_mfma_f32_16x16x32_bf16 v[16:19], v[20:23], v[20:23], 0
buffer_load_dwordx4 v[36:39], v9, s[4:7], s40 offen offset:2048 sc1
v_mfma_f32_16x16x32_bf16 v[16:19], v[20:23], v[20:23], 0
v_mfma_f32_16x16x32_bf16 v[16:19], v[20:23], v[20:23], 0
v_mfma_f32_16x16x32_bf16 v[16:19], v[20:23], v[20:23], 0
buffer_load_dwordx4 v[40:43], v9, s[4:7], s40 offen offset:3072 sc1
v_mfma_f32_16x16x32_bf16 v[16:19], v[20:23], v[20:23], 0
s_waitcnt vmcnt(3)
v_max3_u32 v110, v28, v29, v30
v_max_u32 v110, v110, v31
v_cmp_eq_u32 vcc, -1, v110
s_cbranch_vccnz Lpf_286
v_smfmac_f32_16x16x64_bf16 v[76:79], v[28:31], a[128:135], v126
s_waitcnt vmcnt(2)
v_max3_u32 v110, v32, v33, v34
v_max_u32 v110, v110, v35
v_cmp_eq_u32 vcc, -1, v110
v_smfmac_f32_16x16x64_bf16 v[80:83], v[28:31], a[136:143], v126
v_smfmac_f32_16x16x64_bf16 v[84:87], v[28:31], a[144:151], v126
s_cbranch_vccnz Lpf_287
v_smfmac_f32_16x16x64_bf16 v[76:79], v[32:35], a[160:167], v126
s_waitcnt vmcnt(1)
v_max3_u32 v110, v36, v37, v38
v_max_u32 v110, v110, v39
v_cmp_eq_u32 vcc, -1, v110
v_smfmac_f32_16x16x64_bf16 v[80:83], v[32:35], a[168:175], v126
v_smfmac_f32_16x16x64_bf16 v[84:87], v[32:35], a[176:183], v126
s_cbranch_vccnz Lpf_288
v_smfmac_f32_16x16x64_bf16 v[76:79], v[36:39], a[192:199], v126
s_waitcnt vmcnt(0)
v_max3_u32 v110, v40, v41, v42
v_max_u32 v110, v110, v43
v_cmp_eq_u32 vcc, -1, v110
v_smfmac_f32_16x16x64_bf16 v[80:83], v[36:39], a[200:207], v126
v_smfmac_f32_16x16x64_bf16 v[84:87], v[36:39], a[208:215], v126
s_cbranch_vccnz Lpf_289
v_smfmac_f32_16x16x64_bf16 v[76:79], v[40:43], a[224:231], v126
s_nop 1
v_smfmac_f32_16x16x64_bf16 v[80:83], v[40:43], a[232:239], v126
s_nop 1
v_smfmac_f32_16x16x64_bf16 v[84:87], v[40:43], a[240:247], v126
s_nop 1
v_add_f32 v92, v76, v78
v_add_f32 v93, v77, v79
v_smfmac_f32_16x16x64_bf16 v[88:91], v[28:31], a[152:159], v126
v_add_f32 v94, v80, v82
v_add_f32 v95, v81, v83
ds_write_b64 v24, v[92:93] offset:12288
v_add_f32 v96, v84, v86
v_add_f32 v97, v85, v87
ds_write_b64 v25, v[94:95] offset:12288
v_smfmac_f32_16x16x64_bf16 v[88:91], v[32:35], a[184:191], v126
ds_write_b64 v26, v[96:97] offset:12288
v_smfmac_f32_16x16x64_bf16 v[88:91], v[36:39], a[216:223], v126
v_smfmac_f32_16x16x64_bf16 v[88:91], v[40:43], a[248:255], v126
Lpd_285:
s_waitcnt lgkmcnt(0)
s_barrier
ds_read_b64 v[100:101], v0 offset:12288
ds_read_b64 v[102:103], v0 offset:12800
ds_read_b64 v[104:105], v0 offset:13312
s_nop 2
v_add_f32 v98, v88, v90
v_add_f32 v99, v89, v91
s_waitcnt lgkmcnt(0)
v_pk_add_f32 v[100:101], v[100:101], v[98:99]
v_pk_add_f32 v[102:103], v[102:103], v[104:105]
v_pk_add_f32 v[100:101], v[100:101], v[102:103]
v_cvt_pk_bf16_f32 v108, v100, v101
buffer_store_dword v108, v12, s[4:7], s84 offen sc1
buffer_store_dword v108, v12, s[4:7], s85 offen sc1
buffer_store_dword v121, v11, s[4:7], s42 offen
buffer_store_dword v121, v27, s[4:7], s42 offen
buffer_store_dword v121, v10, s[4:7], s42 offen
v_lshlrev_b32 v106, 16, v108
v_and_b32 v107, 0xffff0000, v108
s_add_u32 s36, s36, 1
s_and_b32 s38, s36, 3
s_lshl_b32 s39, s38, 16
s_add_u32 s40, s39, s45
s_xor_b32 s42, s40, 0x20000
s_add_u32 s26, s36, 1
s_nop 15
s_nop 15
s_nop 15
s_nop 15
buffer_load_dword v112, v13, s[4:7], s84 offen sc1
buffer_load_dword v113, v14, s[4:7], s84 offen sc1
buffer_load_dword v114, v15, s[4:7], s84 offen sc1
v_pk_mul_f32 v[44:45], 0, 0
v_pk_mul_f32 v[46:47], 0, 0
v_pk_mul_f32 v[48:49], 0, 0
v_pk_mul_f32 v[50:51], 0, 0
v_pk_mul_f32 v[52:53], 0, 0
v_pk_mul_f32 v[54:55], 0, 0
v_pk_mul_f32 v[56:57], 0, 0
v_pk_mul_f32 v[58:59], 0, 0
v_pk_mul_f32 v[60:61], 0, 0
v_pk_mul_f32 v[62:63], 0, 0
v_pk_mul_f32 v[64:65], 0, 0
v_pk_mul_f32 v[66:67], 0, 0
v_pk_mul_f32 v[68:69], 0, 0
v_pk_mul_f32 v[70:71], 0, 0
v_pk_mul_f32 v[72:73], 0, 0
v_pk_mul_f32 v[74:75], 0, 0
v_pk_mul_f32 v[76:77], 0, 0
v_pk_mul_f32 v[78:79], 0, 0
v_pk_mul_f32 v[80:81], 0, 0
v_pk_mul_f32 v[82:83], 0, 0
v_pk_mul_f32 v[84:85], 0, 0
v_pk_mul_f32 v[86:87], 0, 0
v_pk_mul_f32 v[88:89], 0, 0
v_pk_mul_f32 v[90:91], 0, 0
buffer_store_dword v7, v2, s[4:7], s59 offen
buffer_load_dword v115, v13, s[4:7], s85 offen sc1
buffer_load_dword v116, v14, s[4:7], s85 offen sc1
buffer_load_dword v117, v15, s[4:7], s85 offen sc1
s_nop 15
s_nop 15
s_nop 15
buffer_load_dword v118, v13, s[4:7], s84 offen sc1
buffer_load_dword v119, v14, s[4:7], s84 offen sc1
buffer_load_dword v120, v15, s[4:7], s84 offen sc1
v_mfma_f32_16x16x32_bf16 v[16:19], v[20:23], v[20:23], 0
v_mfma_f32_16x16x32_bf16 v[16:19], v[20:23], v[20:23], 0
v_mfma_f32_16x16x32_bf16 v[16:19], v[20:23], v[20:23], 0
v_mfma_f32_16x16x32_bf16 v[16:19], v[20:23], v[20:23], 0
s_waitcnt vmcnt(7)
v_dot2_f32_bf16 v100, v112, s55, v106
v_dot2_f32_bf16 v101, v112, s56, v107
v_dot2_f32_bf16 v100, v113, s55, v100
v_dot2_f32_bf16 v101, v113, s56, v101
v_dot2_f32_bf16 v100, v114, s55, v100
v_dot2_f32_bf16 v101, v114, s56, v101
v_max3_u32 v110, v112, v113, v114
v_cmp_eq_u32 vcc, -1, v110
s_nop 0
v_cvt_pk_bf16_f32 v100, v100, v101
s_nop 1
v_mov_b32_dpp v109, v100 quad_perm:[1,0,3,2] row_mask:0xf bank_mask:0xf
v_perm_b32 v109, v109, v100, v3
s_cbranch_vccnz Lx2_290
Lxs_291:
buffer_store_dword v109, v10, s[4:7], s40 offen
s_nop 15
s_nop 15
s_nop 11
s_branch Lkvo_277
Lx2_290:
buffer_load_dword v112, v13, s[4:7], s85 offen sc1
buffer_load_dword v113, v14, s[4:7], s85 offen sc1
buffer_load_dword v114, v15, s[4:7], s85 offen sc1
s_waitcnt vmcnt(6)
v_dot2_f32_bf16 v100, v115, s55, v106
v_dot2_f32_bf16 v101, v115, s56, v107
v_dot2_f32_bf16 v100, v116, s55, v100
v_dot2_f32_bf16 v101, v116, s56, v101
v_dot2_f32_bf16 v100, v117, s55, v100
v_dot2_f32_bf16 v101, v117, s56, v101
v_max3_u32 v110, v115, v116, v117
v_cmp_eq_u32 vcc, -1, v110
s_nop 0
v_cvt_pk_bf16_f32 v100, v100, v101
s_nop 1
v_mov_b32_dpp v109, v100 quad_perm:[1,0,3,2] row_mask:0xf bank_mask:0xf
v_perm_b32 v109, v109, v100, v3
s_cbranch_vccz Lxs_291
buffer_load_dword v115, v13, s[4:7], s84 offen sc1
buffer_load_dword v116, v14, s[4:7], s84 offen sc1
buffer_load_dword v117, v15, s[4:7], s84 offen sc1
s_waitcnt vmcnt(6)
v_dot2_f32_bf16 v100, v118, s55, v106
v_dot2_f32_bf16 v101, v118, s56, v107
v_dot2_f32_bf16 v100, v119, s55, v100
v_dot2_f32_bf16 v101, v119, s56, v101
v_dot2_f32_bf16 v100, v120, s55, v100
v_dot2_f32_bf16 v101, v120, s56, v101
v_max3_u32 v110, v118, v119, v120
v_cmp_eq_u32 vcc, -1, v110
s_nop 0
v_cvt_pk_bf16_f32 v100, v100, v101
s_nop 1
v_mov_b32_dpp v109, v100 quad_perm:[1,0,3,2] row_mask:0xf bank_mask:0xf
v_perm_b32 v109, v109, v100, v3
s_cbranch_vccz Lxs_291
buffer_load_dword v118, v13, s[4:7], s85 offen sc1
buffer_load_dword v119, v14, s[4:7], s85 offen sc1
buffer_load_dword v120, v15, s[4:7], s85 offen sc1
s_waitcnt vmcnt(6)
v_dot2_f32_bf16 v100, v112, s55, v106
v_dot2_f32_bf16 v101, v112, s56, v107
v_dot2_f32_bf16 v100, v113, s55, v100
v_dot2_f32_bf16 v101, v113, s56, v101
v_dot2_f32_bf16 v100, v114, s55, v100
v_dot2_f32_bf16 v101, v114, s56, v101
v_max3_u32 v110, v112, v113, v114
v_cmp_eq_u32 vcc, -1, v110
s_nop 0
v_cvt_pk_bf16_f32 v100, v100, v101
s_nop 1
v_mov_b32_dpp v109, v100 quad_perm:[1,0,3,2] row_mask:0xf bank_mask:0xf
v_perm_b32 v109, v109, v100, v3
s_cbranch_vccz Lxs_291
buffer_load_dword v112, v13, s[4:7], s84 offen sc1
buffer_load_dword v113, v14, s[4:7], s84 offen sc1
buffer_load_dword v114, v15, s[4:7], s84 offen sc1
s_waitcnt vmcnt(6)
v_dot2_f32_bf16 v100, v115, s55, v106
v_dot2_f32_bf16 v101, v115, s56, v107
v_dot2_f32_bf16 v100, v116, s55, v100
v_dot2_f32_bf16 v101, v116, s56, v101
v_dot2_f32_bf16 v100, v117, s55, v100
v_dot2_f32_bf16 v101, v117, s56, v101
v_max3_u32 v110, v115, v116, v117
v_cmp_eq_u32 vcc, -1, v110
s_nop 0
v_cvt_pk_bf16_f32 v100, v100, v101
s_nop 1
v_mov_b32_dpp v109, v100 quad_perm:[1,0,3,2] row_mask:0xf bank_mask:0xf
v_perm_b32 v109, v109, v100, v3
s_cbranch_vccz Lxs_291
buffer_load_dword v115, v13, s[4:7], s85 offen sc1
buffer_load_dword v116, v14, s[4:7], s85 offen sc1
buffer_load_dword v117, v15, s[4:7], s85 offen sc1
s_waitcnt vmcnt(6)
v_dot2_f32_bf16 v100, v118, s55, v106
v_dot2_f32_bf16 v101, v118, s56, v107
v_dot2_f32_bf16 v100, v119, s55, v100
v_dot2_f32_bf16 v101, v119, s56, v101
v_dot2_f32_bf16 v100, v120, s55, v100
v_dot2_f32_bf16 v101, v120, s56, v101
v_max3_u32 v110, v118, v119, v120
v_cmp_eq_u32 vcc, -1, v110
s_nop 0
v_cvt_pk_bf16_f32 v100, v100, v101
s_nop 1
v_mov_b32_dpp v109, v100 quad_perm:[1,0,3,2] row_mask:0xf bank_mask:0xf
v_perm_b32 v109, v109, v100, v3
s_cbranch_vccz Lxs_291
buffer_load_dword v118, v13, s[4:7], s84 offen sc1
buffer_load_dword v119, v14, s[4:7], s84 offen sc1
buffer_load_dword v120, v15, s[4:7], s84 offen sc1
s_waitcnt vmcnt(6)
v_dot2_f32_bf16 v100, v112, s55, v106
v_dot2_f32_bf16 v101, v112, s56, v107
v_dot2_f32_bf16 v100, v113, s55, v100
v_dot2_f32_bf16 v101, v113, s56, v101
v_dot2_f32_bf16 v100, v114, s55, v100
v_dot2_f32_bf16 v101, v114, s56, v101
v_max3_u32 v110, v112, v113, v114
v_cmp_eq_u32 vcc, -1, v110
s_nop 0
v_cvt_pk_bf16_f32 v100, v100, v101
s_nop 1
v_mov_b32_dpp v109, v100 quad_perm:[1,0,3,2] row_mask:0xf bank_mask:0xf
v_perm_b32 v109, v109, v100, v3
s_cbranch_vccz Lxs_291
s_sub_u32 s37, s37, 1
s_cbranch_scc1 Lend_1
s_branch Lx2_290
Lpf_279:
buffer_load_dwordx4 v[28:31], v8, s[4:7], s40 offen offset:0 sc1
s_sub_u32 s37, s37, 1
s_cbranch_scc1 Lend_1
Lps_292:
s_waitcnt vmcnt(3)
v_max3_u32 v110, v32, v33, v34
v_max_u32 v110, v110, v35
v_cmp_eq_u32 vcc, -1, v110
s_cbranch_vccnz Lpf_293
v_smfmac_f32_16x16x64_bf16 v[44:47], v[32:35], a[32:39], v126
v_smfmac_f32_16x16x64_bf16 v[48:51], v[32:35], a[40:47], v126
v_smfmac_f32_16x16x64_bf16 v[52:55], v[32:35], a[48:55], v126
v_smfmac_f32_16x16x64_bf16 v[60:63], v[32:35], v[160:167], v126
Lps_294:
s_waitcnt vmcnt(2)
v_max3_u32 v110, v36, v37, v38
v_max_u32 v110, v110, v39
v_cmp_eq_u32 vcc, -1, v110
s_cbranch_vccnz Lpf_295
v_smfmac_f32_16x16x64_bf16 v[44:47], v[36:39], a[64:71], v126
v_smfmac_f32_16x16x64_bf16 v[48:51], v[36:39], a[72:79], v126
v_smfmac_f32_16x16x64_bf16 v[52:55], v[36:39], a[80:87], v126
v_smfmac_f32_16x16x64_bf16 v[60:63], v[36:39], v[192:199], v126
Lps_296:
s_waitcnt vmcnt(1)
v_max3_u32 v110, v40, v41, v42
v_max_u32 v110, v110, v43
v_cmp_eq_u32 vcc, -1, v110
s_cbranch_vccnz Lpf_297
v_smfmac_f32_16x16x64_bf16 v[44:47], v[40:43], a[96:103], v126
v_smfmac_f32_16x16x64_bf16 v[48:51], v[40:43], a[104:111], v126
v_smfmac_f32_16x16x64_bf16 v[52:55], v[40:43], a[112:119], v126
v_smfmac_f32_16x16x64_bf16 v[60:63], v[40:43], v[224:231], v126
Lps_298:
s_waitcnt vmcnt(0)
v_max3_u32 v110, v28, v29, v30
v_max_u32 v110, v110, v31
v_cmp_eq_u32 vcc, -1, v110
s_cbranch_vccnz Lpf_299
v_smfmac_f32_16x16x64_bf16 v[44:47], v[28:31], a[0:7], v126
s_nop 1
v_smfmac_f32_16x16x64_bf16 v[48:51], v[28:31], a[8:15], v126
s_nop 1
v_smfmac_f32_16x16x64_bf16 v[52:55], v[28:31], a[16:23], v126
s_nop 1
v_add_f32 v92, v44, v46
v_add_f32 v93, v45, v47
v_smfmac_f32_16x16x64_bf16 v[56:59], v[28:31], a[24:31], v126
v_add_f32 v94, v48, v50
v_add_f32 v95, v49, v51
ds_write_b64 v24, v[92:93] offset:0
v_add_f32 v96, v52, v54
v_add_f32 v97, v53, v55
ds_write_b64 v25, v[94:95] offset:0
v_smfmac_f32_16x16x64_bf16 v[56:59], v[32:35], a[56:63], v126
ds_write_b64 v26, v[96:97] offset:0
v_smfmac_f32_16x16x64_bf16 v[56:59], v[36:39], a[88:95], v126
v_smfmac_f32_16x16x64_bf16 v[56:59], v[40:43], a[120:127], v126
v_smfmac_f32_16x16x64_bf16 v[60:63], v[28:31], v[128:135], v126
s_branch Lpd_278
Lpf_280:
buffer_load_dwordx4 v[32:35], v8, s[4:7], s40 offen offset:1024 sc1
s_sub_u32 s37, s37, 1
s_cbranch_scc1 Lend_1
Lps_300:
s_waitcnt vmcnt(2)
v_max3_u32 v110, v36, v37, v38
v_max_u32 v110, v110, v39
v_cmp_eq_u32 vcc, -1, v110
s_cbranch_vccnz Lpf_301
v_smfmac_f32_16x16x64_bf16 v[44:47], v[36:39], a[64:71], v126
v_smfmac_f32_16x16x64_bf16 v[48:51], v[36:39], a[72:79], v126
v_smfmac_f32_16x16x64_bf16 v[52:55], v[36:39], a[80:87], v126
v_smfmac_f32_16x16x64_bf16 v[60:63], v[36:39], v[192:199], v126
Lps_302:
s_waitcnt vmcnt(1)
v_max3_u32 v110, v40, v41, v42
v_max_u32 v110, v110, v43
v_cmp_eq_u32 vcc, -1, v110
s_cbranch_vccnz Lpf_303
v_smfmac_f32_16x16x64_bf16 v[44:47], v[40:43], a[96:103], v126
v_smfmac_f32_16x16x64_bf16 v[48:51], v[40:43], a[104:111], v126
v_smfmac_f32_16x16x64_bf16 v[52:55], v[40:43], a[112:119], v126
v_smfmac_f32_16x16x64_bf16 v[60:63], v[40:43], v[224:231], v126
Lps_304:
s_waitcnt vmcnt(0)
v_max3_u32 v110, v32, v33, v34
v_max_u32 v110, v110, v35
v_cmp_eq_u32 vcc, -1, v110
s_cbranch_vccnz Lpf_305
v_smfmac_f32_16x16x64_bf16 v[44:47], v[32:35], a[32:39], v126
s_nop 1
v_smfmac_f32_16x16x64_bf16 v[48:51], v[32:35], a[40:47], v126
s_nop 1
v_smfmac_f32_16x16x64_bf16 v[52:55], v[32:35], a[48:55], v126
s_nop 1
v_add_f32 v92, v44, v46
v_add_f32 v93, v45, v47
v_smfmac_f32_16x16x64_bf16 v[56:59], v[28:31], a[24:31], v126
v_add_f32 v94, v48, v50
v_add_f32 v95, v49, v51
ds_write_b64 v24, v[92:93] offset:0
v_add_f32 v96, v52, v54
v_add_f32 v97, v53, v55
ds_write_b64 v25, v[94:95] offset:0
v_smfmac_f32_16x16x64_bf16 v[56:59], v[32:35], a[56:63], v126
ds_write_b64 v26, v[96:97] offset:0
v_smfmac_f32_16x16x64_bf16 v[56:59], v[36:39], a[88:95], v126
v_smfmac_f32_16x16x64_bf16 v[56:59], v[40:43], a[120:127], v126
v_smfmac_f32_16x16x64_bf16 v[60:63], v[32:35], v[160:167], v126
s_branch Lpd_278
Lpf_281:
buffer_load_dwordx4 v[36:39], v8, s[4:7], s40 offen offset:2048 sc1
s_sub_u32 s37, s37, 1
s_cbranch_scc1 Lend_1
Lps_306:
s_waitcnt vmcnt(1)
v_max3_u32 v110, v40, v41, v42
v_max_u32 v110, v110, v43
v_cmp_eq_u32 vcc, -1, v110
s_cbranch_vccnz Lpf_307
v_smfmac_f32_16x16x64_bf16 v[44:47], v[40:43], a[96:103], v126
v_smfmac_f32_16x16x64_bf16 v[48:51], v[40:43], a[104:111], v126
v_smfmac_f32_16x16x64_bf16 v[52:55], v[40:43], a[112:119], v126
v_smfmac_f32_16x16x64_bf16 v[60:63], v[40:43], v[224:231], v126
Lps_308:
s_waitcnt vmcnt(0)
v_max3_u32 v110, v36, v37, v38
v_max_u32 v110, v110, v39
v_cmp_eq_u32 vcc, -1, v110
s_cbranch_vccnz Lpf_309
v_smfmac_f32_16x16x64_bf16 v[44:47], v[36:39], a[64:71], v126
s_nop 1
v_smfmac_f32_16x16x64_bf16 v[48:51], v[36:39], a[72:79], v126
s_nop 1
v_smfmac_f32_16x16x64_bf16 v[52:55], v[36:39], a[80:87], v126
s_nop 1
v_add_f32 v92, v44, v46
v_add_f32 v93, v45, v47
v_smfmac_f32_16x16x64_bf16 v[56:59], v[28:31], a[24:31], v126
v_add_f32 v94, v48, v50
v_add_f32 v95, v49, v51
ds_write_b64 v24, v[92:93] offset:0
v_add_f32 v96, v52, v54
v_add_f32 v97, v53, v55
ds_write_b64 v25, v[94:95] offset:0
v_smfmac_f32_16x16x64_bf16 v[56:59], v[32:35], a[56:63], v126
ds_write_b64 v26, v[96:97] offset:0
v_smfmac_f32_16x16x64_bf16 v[56:59], v[36:39], a[88:95], v126
v_smfmac_f32_16x16x64_bf16 v[56:59], v[40:43], a[120:127], v126
v_smfmac_f32_16x16x64_bf16 v[60:63], v[36:39], v[192:199], v126
s_branch Lpd_278
Lpf_282:
buffer_load_dwordx4 v[40:43], v8, s[4:7], s40 offen offset:3072 sc1
s_sub_u32 s37, s37, 1
s_cbranch_scc1 Lend_1
Lps_310:
s_waitcnt vmcnt(0)
v_max3_u32 v110, v40, v41, v42
v_max_u32 v110, v110, v43
v_cmp_eq_u32 vcc, -1, v110
s_cbranch_vccnz Lpf_311
v_smfmac_f32_16x16x64_bf16 v[44:47], v[40:43], a[96:103], v126
s_nop 1
v_smfmac_f32_16x16x64_bf16 v[48:51], v[40:43], a[104:111], v126
s_nop 1
v_smfmac_f32_16x16x64_bf16 v[52:55], v[40:43], a[112:119], v126
s_nop 1
v_add_f32 v92, v44, v46
v_add_f32 v93, v45, v47
v_smfmac_f32_16x16x64_bf16 v[56:59], v[28:31], a[24:31], v126
v_add_f32 v94, v48, v50
v_add_f32 v95, v49, v51
ds_write_b64 v24, v[92:93] offset:0
v_add_f32 v96, v52, v54
v_add_f32 v97, v53, v55
ds_write_b64 v25, v[94:95] offset:0
v_smfmac_f32_16x16x64_bf16 v[56:59], v[32:35], a[56:63], v126
ds_write_b64 v26, v[96:97] offset:0
v_smfmac_f32_16x16x64_bf16 v[56:59], v[36:39], a[88:95], v126
v_smfmac_f32_16x16x64_bf16 v[56:59], v[40:43], a[120:127], v126
v_smfmac_f32_16x16x64_bf16 v[60:63], v[40:43], v[224:231], v126
s_branch Lpd_278
Lpf_293:
buffer_load_dwordx4 v[32:35], v8, s[4:7], s40 offen offset:1024 sc1
Lps_312:
s_waitcnt vmcnt(3)
v_max3_u32 v110, v36, v37, v38
v_max_u32 v110, v110, v39
v_cmp_eq_u32 vcc, -1, v110
s_cbranch_vccnz Lpf_313
v_smfmac_f32_16x16x64_bf16 v[44:47], v[36:39], a[64:71], v126
v_smfmac_f32_16x16x64_bf16 v[48:51], v[36:39], a[72:79], v126
v_smfmac_f32_16x16x64_bf16 v[52:55], v[36:39], a[80:87], v126
v_smfmac_f32_16x16x64_bf16 v[60:63], v[36:39], v[192:199], v126
Lps_314:
s_waitcnt vmcnt(2)
v_max3_u32 v110, v40, v41, v42
v_max_u32 v110, v110, v43
v_cmp_eq_u32 vcc, -1, v110
s_cbranch_vccnz Lpf_315
v_smfmac_f32_16x16x64_bf16 v[44:47], v[40:43], a[96:103], v126
v_smfmac_f32_16x16x64_bf16 v[48:51], v[40:43], a[104:111], v126
v_smfmac_f32_16x16x64_bf16 v[52:55], v[40:43], a[112:119], v126
v_smfmac_f32_16x16x64_bf16 v[60:63], v[40:43], v[224:231], v126
Lps_316:
s_waitcnt vmcnt(1)
v_max3_u32 v110, v28, v29, v30
v_max_u32 v110, v110, v31
v_cmp_eq_u32 vcc, -1, v110
s_cbranch_vccnz Lpf_317
v_smfmac_f32_16x16x64_bf16 v[44:47], v[28:31], a[0:7], v126
v_smfmac_f32_16x16x64_bf16 v[48:51], v[28:31], a[8:15], v126
v_smfmac_f32_16x16x64_bf16 v[52:55], v[28:31], a[16:23], v126
v_smfmac_f32_16x16x64_bf16 v[60:63], v[28:31], v[128:135], v126
s_branch Lps_304
Lpf_295:
buffer_load_dwordx4 v[36:39], v8, s[4:7], s40 offen offset:2048 sc1
Lps_318:
s_waitcnt vmcnt(2)
v_max3_u32 v110, v40, v41, v42
v_max_u32 v110, v110, v43
v_cmp_eq_u32 vcc, -1, v110
s_cbranch_vccnz Lpf_319
v_smfmac_f32_16x16x64_bf16 v[44:47], v[40:43], a[96:103], v126
v_smfmac_f32_16x16x64_bf16 v[48:51], v[40:43], a[104:111], v126
v_smfmac_f32_16x16x64_bf16 v[52:55], v[40:43], a[112:119], v126
v_smfmac_f32_16x16x64_bf16 v[60:63], v[40:43], v[224:231], v126
Lps_320:
s_waitcnt vmcnt(1)
v_max3_u32 v110, v28, v29, v30
v_max_u32 v110, v110, v31
v_cmp_eq_u32 vcc, -1, v110
s_cbranch_vccnz Lpf_321
v_smfmac_f32_16x16x64_bf16 v[44:47], v[28:31], a[0:7], v126
v_smfmac_f32_16x16x64_bf16 v[48:51], v[28:31], a[8:15], v126
v_smfmac_f32_16x16x64_bf16 v[52:55], v[28:31], a[16:23], v126
v_smfmac_f32_16x16x64_bf16 v[60:63], v[28:31], v[128:135], v126
s_branch Lps_308
Lpf_297:
buffer_load_dwordx4 v[40:43], v8, s[4:7], s40 offen offset:3072 sc1
Lps_322:
s_waitcnt vmcnt(1)
v_max3_u32 v110, v28, v29, v30
v_max_u32 v110, v110, v31
v_cmp_eq_u32 vcc, -1, v110
s_cbranch_vccnz Lpf_323
v_smfmac_f32_16x16x64_bf16 v[44:47], v[28:31], a[0:7], v126
v_smfmac_f32_16x16x64_bf16 v[48:51], v[28:31], a[8:15], v126
v_smfmac_f32_16x16x64_bf16 v[52:55], v[28:31], a[16:23], v126
v_smfmac_f32_16x16x64_bf16 v[60:63], v[28:31], v[128:135], v126
s_branch Lps_310
Lpf_299:
buffer_load_dwordx4 v[28:31], v8, s[4:7], s40 offen offset:0 sc1
s_sub_u32 s37, s37, 1
s_cbranch_scc1 Lend_1
s_branch Lps_298
Lpf_301:
buffer_load_dwordx4 v[36:39], v8, s[4:7], s40 offen offset:2048 sc1
Lps_324:
s_waitcnt vmcnt(2)
v_max3_u32 v110, v40, v41, v42
v_max_u32 v110, v110, v43
v_cmp_eq_u32 vcc, -1, v110
s_cbranch_vccnz Lpf_325
v_smfmac_f32_16x16x64_bf16 v[44:47], v[40:43], a[96:103], v126
v_smfmac_f32_16x16x64_bf16 v[48:51], v[40:43], a[104:111], v126
v_smfmac_f32_16x16x64_bf16 v[52:55], v[40:43], a[112:119], v126
v_smfmac_f32_16x16x64_bf16 v[60:63], v[40:43], v[224:231], v126
Lps_326:
s_waitcnt vmcnt(1)
v_max3_u32 v110, v32, v33, v34
v_max_u32 v110, v110, v35
v_cmp_eq_u32 vcc, -1, v110
s_cbranch_vccnz Lpf_327
v_smfmac_f32_16x16x64_bf16 v[44:47], v[32:35], a[32:39], v126
v_smfmac_f32_16x16x64_bf16 v[48:51], v[32:35], a[40:47], v126
v_smfmac_f32_16x16x64_bf16 v[52:55], v[32:35], a[48:55], v126
v_smfmac_f32_16x16x64_bf16 v[60:63], v[32:35], v[160:167], v126
s_branch Lps_308
Lpf_303:
buffer_load_dwordx4 v[40:43], v8, s[4:7], s40 offen offset:3072 sc1
Lps_328:
s_waitcnt vmcnt(1)
v_max3_u32 v110, v32, v33, v34
v_max_u32 v110, v110, v35
v_cmp_eq_u32 vcc, -1, v110
s_cbranch_vccnz Lpf_329
v_smfmac_f32_16x16x64_bf16 v[44:47], v[32:35], a[32:39], v126
v_smfmac_f32_16x16x64_bf16 v[48:51], v[32:35], a[40:47], v126
v_smfmac_f32_16x16x64_bf16 v[52:55], v[32:35], a[48:55], v126
v_smfmac_f32_16x16x64_bf16 v[60:63], v[32:35], v[160:167], v126
s_branch Lps_310
Lpf_305:
buffer_load_dwordx4 v[32:35], v8, s[4:7], s40 offen offset:1024 sc1
s_sub_u32 s37, s37, 1
s_cbranch_scc1 Lend_1
s_branch Lps_304
Lpf_307:
buffer_load_dwordx4 v[40:43], v8, s[4:7], s40 offen offset:3072 sc1
Lps_330:
s_waitcnt vmcnt(1)
v_max3_u32 v110, v36, v37, v38
v_max_u32 v110, v110, v39
v_cmp_eq_u32 vcc, -1, v110
s_cbranch_vccnz Lpf_331
v_smfmac_f32_16x16x64_bf16 v[44:47], v[36:39], a[64:71], v126
v_smfmac_f32_16x16x64_bf16 v[48:51], v[36:39], a[72:79], v126
v_smfmac_f32_16x16x64_bf16 v[52:55], v[36:39], a[80:87], v126
v_smfmac_f32_16x16x64_bf16 v[60:63], v[36:39], v[192:199], v126
s_branch Lps_310
Lpf_309:
buffer_load_dwordx4 v[36:39], v8, s[4:7], s40 offen offset:2048 sc1
s_sub_u32 s37, s37, 1
s_cbranch_scc1 Lend_1
s_branch Lps_308
Lpf_311:
buffer_load_dwordx4 v[40:43], v8, s[4:7], s40 offen offset:3072 sc1
s_sub_u32 s37, s37, 1
s_cbranch_scc1 Lend_1
s_branch Lps_310
Lpf_313:
buffer_load_dwordx4 v[36:39], v8, s[4:7], s40 offen offset:2048 sc1
Lps_332:
s_waitcnt vmcnt(3)
v_max3_u32 v110, v40, v41, v42
v_max_u32 v110, v110, v43
v_cmp_eq_u32 vcc, -1, v110
s_cbranch_vccnz Lpf_333
v_smfmac_f32_16x16x64_bf16 v[44:47], v[40:43], a[96:103], v126
v_smfmac_f32_16x16x64_bf16 v[48:51], v[40:43], a[104:111], v126
v_smfmac_f32_16x16x64_bf16 v[52:55], v[40:43], a[112:119], v126
v_smfmac_f32_16x16x64_bf16 v[60:63], v[40:43], v[224:231], v126
Lps_334:
s_waitcnt vmcnt(2)
v_max3_u32 v110, v28, v29, v30
v_max_u32 v110, v110, v31
v_cmp_eq_u32 vcc, -1, v110
s_cbranch_vccnz Lpf_335
v_smfmac_f32_16x16x64_bf16 v[44:47], v[28:31], a[0:7], v126
v_smfmac_f32_16x16x64_bf16 v[48:51], v[28:31], a[8:15], v126
v_smfmac_f32_16x16x64_bf16 v[52:55], v[28:31], a[16:23], v126
v_smfmac_f32_16x16x64_bf16 v[60:63], v[28:31], v[128:135], v126
s_branch Lps_326
Lpf_315:
buffer_load_dwordx4 v[40:43], v8, s[4:7], s40 offen offset:3072 sc1
Lps_336:
s_waitcnt vmcnt(2)
v_max3_u32 v110, v28, v29, v30
v_max_u32 v110, v110, v31
v_cmp_eq_u32 vcc, -1, v110
s_cbranch_vccnz Lpf_337
v_smfmac_f32_16x16x64_bf16 v[44:47], v[28:31], a[0:7], v126
v_smfmac_f32_16x16x64_bf16 v[48:51], v[28:31], a[8:15], v126
v_smfmac_f32_16x16x64_bf16 v[52:55], v[28:31], a[16:23], v126
v_smfmac_f32_16x16x64_bf16 v[60:63], v[28:31], v[128:135], v126
s_branch Lps_328
Lpf_317:
buffer_load_dwordx4 v[28:31], v8, s[4:7], s40 offen offset:0 sc1
s_sub_u32 s37, s37, 1
s_cbranch_scc1 Lend_1
Lps_338:
s_waitcnt vmcnt(1)
v_max3_u32 v110, v32, v33, v34
v_max_u32 v110, v110, v35
v_cmp_eq_u32 vcc, -1, v110
s_cbranch_vccnz Lpf_339
v_smfmac_f32_16x16x64_bf16 v[44:47], v[32:35], a[32:39], v126
v_smfmac_f32_16x16x64_bf16 v[48:51], v[32:35], a[40:47], v126
v_smfmac_f32_16x16x64_bf16 v[52:55], v[32:35], a[48:55], v126
v_smfmac_f32_16x16x64_bf16 v[60:63], v[32:35], v[160:167], v126
s_branch Lps_298
Lpf_319:
buffer_load_dwordx4 v[40:43], v8, s[4:7], s40 offen offset:3072 sc1
Lps_340:
s_waitcnt vmcnt(2)
v_max3_u32 v110, v28, v29, v30
v_max_u32 v110, v110, v31
v_cmp_eq_u32 vcc, -1, v110
s_cbranch_vccnz Lpf_341
v_smfmac_f32_16x16x64_bf16 v[44:47], v[28:31], a[0:7], v126
v_smfmac_f32_16x16x64_bf16 v[48:51], v[28:31], a[8:15], v126
v_smfmac_f32_16x16x64_bf16 v[52:55], v[28:31], a[16:23], v126
v_smfmac_f32_16x16x64_bf16 v[60:63], v[28:31], v[128:135], v126
s_branch Lps_330
Lpf_321:
buffer_load_dwordx4 v[28:31], v8, s[4:7], s40 offen offset:0 sc1
s_sub_u32 s37, s37, 1
s_cbranch_scc1 Lend_1
Lps_342:
s_waitcnt vmcnt(1)
v_max3_u32 v110, v36, v37, v38
v_max_u32 v110, v110, v39
v_cmp_eq_u32 vcc, -1, v110
s_cbranch_vccnz Lpf_343
v_smfmac_f32_16x16x64_bf16 v[44:47], v[36:39], a[64:71], v126
v_smfmac_f32_16x16x64_bf16 v[48:51], v[36:39], a[72:79], v126
v_smfmac_f32_16x16x64_bf16 v[52:55], v[36:39], a[80:87], v126
v_smfmac_f32_16x16x64_bf16 v[60:63], v[36:39], v[192:199], v126
s_branch Lps_298
Lpf_323:
buffer_load_dwordx4 v[28:31], v8, s[4:7], s40 offen offset:0 sc1
s_sub_u32 s37, s37, 1
s_cbranch_scc1 Lend_1
s_branch Lps_296
Lpf_325:
buffer_load_dwordx4 v[40:43], v8, s[4:7], s40 offen offset:3072 sc1
Lps_344:
s_waitcnt vmcnt(2)
v_max3_u32 v110, v32, v33, v34
v_max_u32 v110, v110, v35
v_cmp_eq_u32 vcc, -1, v110
s_cbranch_vccnz Lpf_345
v_smfmac_f32_16x16x64_bf16 v[44:47], v[32:35], a[32:39], v126
v_smfmac_f32_16x16x64_bf16 v[48:51], v[32:35], a[40:47], v126
v_smfmac_f32_16x16x64_bf16 v[52:55], v[32:35], a[48:55], v126
v_smfmac_f32_16x16x64_bf16 v[60:63], v[32:35], v[160:167], v126
s_branch Lps_330
Lpf_327:
buffer_load_dwordx4 v[32:35], v8, s[4:7], s40 offen offset:1024 sc1
s_sub_u32 s37, s37, 1
s_cbranch_scc1 Lend_1
Lps_346:
s_waitcnt vmcnt(1)
v_max3_u32 v110, v36, v37, v38
v_max_u32 v110, v110, v39
v_cmp_eq_u32 vcc, -1, v110
s_cbranch_vccnz Lpf_347
v_smfmac_f32_16x16x64_bf16 v[44:47], v[36:39], a[64:71], v126
v_smfmac_f32_16x16x64_bf16 v[48:51], v[36:39], a[72:79], v126
v_smfmac_f32_16x16x64_bf16 v[52:55], v[36:39], a[80:87], v126
v_smfmac_f32_16x16x64_bf16 v[60:63], v[36:39], v[192:199], v126
s_branch Lps_304
Lpf_329:
buffer_load_dwordx4 v[32:35], v8, s[4:7], s40 offen offset:1024 sc1
s_sub_u32 s37, s37, 1
s_cbranch_scc1 Lend_1
s_branch Lps_302
Lpf_331:
buffer_load_dwordx4 v[36:39], v8, s[4:7], s40 offen offset:2048 sc1
s_sub_u32 s37, s37, 1
s_cbranch_scc1 Lend_1
s_branch Lps_306
Lpf_333:
buffer_load_dwordx4 v[40:43], v8, s[4:7], s40 offen offset:3072 sc1
Lps_348:
s_waitcnt vmcnt(3)
v_max3_u32 v110, v28, v29, v30
v_max_u32 v110, v110, v31
v_cmp_eq_u32 vcc, -1, v110
s_cbranch_vccnz Lpf_349
v_smfmac_f32_16x16x64_bf16 v[44:47], v[28:31], a[0:7], v126
v_smfmac_f32_16x16x64_bf16 v[48:51], v[28:31], a[8:15], v126
v_smfmac_f32_16x16x64_bf16 v[52:55], v[28:31], a[16:23], v126
v_smfmac_f32_16x16x64_bf16 v[60:63], v[28:31], v[128:135], v126
s_branch Lps_344
Lpf_335:
buffer_load_dwordx4 v[28:31], v8, s[4:7], s40 offen offset:0 sc1
s_sub_u32 s37, s37, 1
s_cbranch_scc1 Lend_1
Lps_350:
s_waitcnt vmcnt(2)
v_max3_u32 v110, v32, v33, v34
v_max_u32 v110, v110, v35
v_cmp_eq_u32 vcc, -1, v110
s_cbranch_vccnz Lpf_351
v_smfmac_f32_16x16x64_bf16 v[44:47], v[32:35], a[32:39], v126
v_smfmac_f32_16x16x64_bf16 v[48:51], v[32:35], a[40:47], v126
v_smfmac_f32_16x16x64_bf16 v[52:55], v[32:35], a[48:55], v126
v_smfmac_f32_16x16x64_bf16 v[60:63], v[32:35], v[160:167], v126
s_branch Lps_342
Lpf_337:
buffer_load_dwordx4 v[28:31], v8, s[4:7], s40 offen offset:0 sc1
s_sub_u32 s37, s37, 1
s_cbranch_scc1 Lend_1
Lps_352:
s_waitcnt vmcnt(2)
v_max3_u32 v110, v32, v33, v34
v_max_u32 v110, v110, v35
v_cmp_eq_u32 vcc, -1, v110
s_cbranch_vccnz Lpf_353
v_smfmac_f32_16x16x64_bf16 v[44:47], v[32:35], a[32:39], v126
v_smfmac_f32_16x16x64_bf16 v[48:51], v[32:35], a[40:47], v126
v_smfmac_f32_16x16x64_bf16 v[52:55], v[32:35], a[48:55], v126
v_smfmac_f32_16x16x64_bf16 v[60:63], v[32:35], v[160:167], v126
s_branch Lps_296
Lpf_339:
buffer_load_dwordx4 v[32:35], v8, s[4:7], s40 offen offset:1024 sc1
s_branch Lps_316
Lpf_341:
buffer_load_dwordx4 v[28:31], v8, s[4:7], s40 offen offset:0 sc1
s_sub_u32 s37, s37, 1
s_cbranch_scc1 Lend_1
s_branch Lps_294
Lpf_343:
buffer_load_dwordx4 v[36:39], v8, s[4:7], s40 offen offset:2048 sc1
s_branch Lps_320
Lpf_345:
buffer_load_dwordx4 v[32:35], v8, s[4:7], s40 offen offset:1024 sc1
s_sub_u32 s37, s37, 1
s_cbranch_scc1 Lend_1
s_branch Lps_300
Lpf_347:
buffer_load_dwordx4 v[36:39], v8, s[4:7], s40 offen offset:2048 sc1
s_branch Lps_326
Lpf_349:
buffer_load_dwordx4 v[28:31], v8, s[4:7], s40 offen offset:0 sc1
s_sub_u32 s37, s37, 1
s_cbranch_scc1 Lend_1
s_branch Lps_292
Lpf_351:
buffer_load_dwordx4 v[32:35], v8, s[4:7], s40 offen offset:1024 sc1
Lps_354:
s_waitcnt vmcnt(2)
v_max3_u32 v110, v36, v37, v38
v_max_u32 v110, v110, v39
v_cmp_eq_u32 vcc, -1, v110
s_cbranch_vccnz Lpf_355
v_smfmac_f32_16x16x64_bf16 v[44:47], v[36:39], a[64:71], v126
v_smfmac_f32_16x16x64_bf16 v[48:51], v[36:39], a[72:79], v126
v_smfmac_f32_16x16x64_bf16 v[52:55], v[36:39], a[80:87], v126
v_smfmac_f32_16x16x64_bf16 v[60:63], v[36:39], v[192:199], v126
s_branch Lps_316
Lpf_353:
buffer_load_dwordx4 v[32:35], v8, s[4:7], s40 offen offset:1024 sc1
s_branch Lps_314
Lpf_355:
buffer_load_dwordx4 v[36:39], v8, s[4:7], s40 offen offset:2048 sc1
s_branch Lps_334
Lpf_286:
buffer_load_dwordx4 v[28:31], v9, s[4:7], s40 offen offset:0 sc1
s_sub_u32 s37, s37, 1
s_cbranch_scc1 Lend_1
Lps_356:
s_waitcnt vmcnt(3)
v_max3_u32 v110, v32, v33, v34
v_max_u32 v110, v110, v35
v_cmp_eq_u32 vcc, -1, v110
s_cbranch_vccnz Lpf_357
v_smfmac_f32_16x16x64_bf16 v[76:79], v[32:35], a[160:167], v126
v_smfmac_f32_16x16x64_bf16 v[80:83], v[32:35], a[168:175], v126
v_smfmac_f32_16x16x64_bf16 v[84:87], v[32:35], a[176:183], v126
Lps_358:
s_waitcnt vmcnt(2)
v_max3_u32 v110, v36, v37, v38
v_max_u32 v110, v110, v39
v_cmp_eq_u32 vcc, -1, v110
s_cbranch_vccnz Lpf_359
v_smfmac_f32_16x16x64_bf16 v[76:79], v[36:39], a[192:199], v126
v_smfmac_f32_16x16x64_bf16 v[80:83], v[36:39], a[200:207], v126
v_smfmac_f32_16x16x64_bf16 v[84:87], v[36:39], a[208:215], v126
Lps_360:
s_waitcnt vmcnt(1)
v_max3_u32 v110, v40, v41, v42
v_max_u32 v110, v110, v43
v_cmp_eq_u32 vcc, -1, v110
s_cbranch_vccnz Lpf_361
v_smfmac_f32_16x16x64_bf16 v[76:79], v[40:43], a[224:231], v126
v_smfmac_f32_16x16x64_bf16 v[80:83], v[40:43], a[232:239], v126
v_smfmac_f32_16x16x64_bf16 v[84:87], v[40:43], a[240:247], v126
Lps_362:
s_waitcnt vmcnt(0)
v_max3_u32 v110, v28, v29, v30
v_max_u32 v110, v110, v31
v_cmp_eq_u32 vcc, -1, v110
s_cbranch_vccnz Lpf_363
v_smfmac_f32_16x16x64_bf16 v[76:79], v[28:31], a[128:135], v126
s_nop 1
v_smfmac_f32_16x16x64_bf16 v[80:83], v[28:31], a[136:143], v126
s_nop 1
v_smfmac_f32_16x16x64_bf16 v[84:87], v[28:31], a[144:151], v126
s_nop 1
v_add_f32 v92, v76, v78
v_add_f32 v93, v77, v79
v_smfmac_f32_16x16x64_bf16 v[88:91], v[28:31], a[152:159], v126
v_add_f32 v94, v80, v82
v_add_f32 v95, v81, v83
ds_write_b64 v24, v[92:93] offset:12288
v_add_f32 v96, v84, v86
v_add_f32 v97, v85, v87
ds_write_b64 v25, v[94:95] offset:12288
v_smfmac_f32_16x16x64_bf16 v[88:91], v[32:35], a[184:191], v126
ds_write_b64 v26, v[96:97] offset:12288
v_smfmac_f32_16x16x64_bf16 v[88:91], v[36:39], a[216:223], v126
v_smfmac_f32_16x16x64_bf16 v[88:91], v[40:43], a[248:255], v126
s_branch Lpd_285
Lpf_287:
buffer_load_dwordx4 v[32:35], v9, s[4:7], s40 offen offset:1024 sc1
s_sub_u32 s37, s37, 1
s_cbranch_scc1 Lend_1
Lps_364:
s_waitcnt vmcnt(2)
v_max3_u32 v110, v36, v37, v38
v_max_u32 v110, v110, v39
v_cmp_eq_u32 vcc, -1, v110
s_cbranch_vccnz Lpf_365
v_smfmac_f32_16x16x64_bf16 v[76:79], v[36:39], a[192:199], v126
v_smfmac_f32_16x16x64_bf16 v[80:83], v[36:39], a[200:207], v126
v_smfmac_f32_16x16x64_bf16 v[84:87], v[36:39], a[208:215], v126
Lps_366:
s_waitcnt vmcnt(1)
v_max3_u32 v110, v40, v41, v42
v_max_u32 v110, v110, v43
v_cmp_eq_u32 vcc, -1, v110
s_cbranch_vccnz Lpf_367
v_smfmac_f32_16x16x64_bf16 v[76:79], v[40:43], a[224:231], v126
v_smfmac_f32_16x16x64_bf16 v[80:83], v[40:43], a[232:239], v126
v_smfmac_f32_16x16x64_bf16 v[84:87], v[40:43], a[240:247], v126
Lps_368:
s_waitcnt vmcnt(0)
v_max3_u32 v110, v32, v33, v34
v_max_u32 v110, v110, v35
v_cmp_eq_u32 vcc, -1, v110
s_cbranch_vccnz Lpf_369
v_smfmac_f32_16x16x64_bf16 v[76:79], v[32:35], a[160:167], v126
s_nop 1
v_smfmac_f32_16x16x64_bf16 v[80:83], v[32:35], a[168:175], v126
s_nop 1
v_smfmac_f32_16x16x64_bf16 v[84:87], v[32:35], a[176:183], v126
s_nop 1
v_add_f32 v92, v76, v78
v_add_f32 v93, v77, v79
v_smfmac_f32_16x16x64_bf16 v[88:91], v[28:31], a[152:159], v126
v_add_f32 v94, v80, v82
v_add_f32 v95, v81, v83
ds_write_b64 v24, v[92:93] offset:12288
v_add_f32 v96, v84, v86
v_add_f32 v97, v85, v87
ds_write_b64 v25, v[94:95] offset:12288
v_smfmac_f32_16x16x64_bf16 v[88:91], v[32:35], a[184:191], v126
ds_write_b64 v26, v[96:97] offset:12288
v_smfmac_f32_16x16x64_bf16 v[88:91], v[36:39], a[216:223], v126
v_smfmac_f32_16x16x64_bf16 v[88:91], v[40:43], a[248:255], v126
s_branch Lpd_285
Lpf_288:
buffer_load_dwordx4 v[36:39], v9, s[4:7], s40 offen offset:2048 sc1
s_sub_u32 s37, s37, 1
s_cbranch_scc1 Lend_1
Lps_370:
s_waitcnt vmcnt(1)
v_max3_u32 v110, v40, v41, v42
v_max_u32 v110, v110, v43
v_cmp_eq_u32 vcc, -1, v110
s_cbranch_vccnz Lpf_371
v_smfmac_f32_16x16x64_bf16 v[76:79], v[40:43], a[224:231], v126
v_smfmac_f32_16x16x64_bf16 v[80:83], v[40:43], a[232:239], v126
v_smfmac_f32_16x16x64_bf16 v[84:87], v[40:43], a[240:247], v126
Lps_372:
s_waitcnt vmcnt(0)
v_max3_u32 v110, v36, v37, v38
v_max_u32 v110, v110, v39
v_cmp_eq_u32 vcc, -1, v110
s_cbranch_vccnz Lpf_373
v_smfmac_f32_16x16x64_bf16 v[76:79], v[36:39], a[192:199], v126
s_nop 1
v_smfmac_f32_16x16x64_bf16 v[80:83], v[36:39], a[200:207], v126
s_nop 1
v_smfmac_f32_16x16x64_bf16 v[84:87], v[36:39], a[208:215], v126
s_nop 1
v_add_f32 v92, v76, v78
v_add_f32 v93, v77, v79
v_smfmac_f32_16x16x64_bf16 v[88:91], v[28:31], a[152:159], v126
v_add_f32 v94, v80, v82
v_add_f32 v95, v81, v83
ds_write_b64 v24, v[92:93] offset:12288
v_add_f32 v96, v84, v86
v_add_f32 v97, v85, v87
ds_write_b64 v25, v[94:95] offset:12288
v_smfmac_f32_16x16x64_bf16 v[88:91], v[32:35], a[184:191], v126
ds_write_b64 v26, v[96:97] offset:12288
v_smfmac_f32_16x16x64_bf16 v[88:91], v[36:39], a[216:223], v126
v_smfmac_f32_16x16x64_bf16 v[88:91], v[40:43], a[248:255], v126
s_branch Lpd_285
Lpf_289:
buffer_load_dwordx4 v[40:43], v9, s[4:7], s40 offen offset:3072 sc1
s_sub_u32 s37, s37, 1
s_cbranch_scc1 Lend_1
Lps_374:
s_waitcnt vmcnt(0)
v_max3_u32 v110, v40, v41, v42
v_max_u32 v110, v110, v43
v_cmp_eq_u32 vcc, -1, v110
s_cbranch_vccnz Lpf_375
v_smfmac_f32_16x16x64_bf16 v[76:79], v[40:43], a[224:231], v126
s_nop 1
v_smfmac_f32_16x16x64_bf16 v[80:83], v[40:43], a[232:239], v126
s_nop 1
v_smfmac_f32_16x16x64_bf16 v[84:87], v[40:43], a[240:247], v126
s_nop 1
v_add_f32 v92, v76, v78
v_add_f32 v93, v77, v79
v_smfmac_f32_16x16x64_bf16 v[88:91], v[28:31], a[152:159], v126
v_add_f32 v94, v80, v82
v_add_f32 v95, v81, v83
ds_write_b64 v24, v[92:93] offset:12288
v_add_f32 v96, v84, v86
v_add_f32 v97, v85, v87
ds_write_b64 v25, v[94:95] offset:12288
v_smfmac_f32_16x16x64_bf16 v[88:91], v[32:35], a[184:191], v126
ds_write_b64 v26, v[96:97] offset:12288
v_smfmac_f32_16x16x64_bf16 v[88:91], v[36:39], a[216:223], v126
v_smfmac_f32_16x16x64_bf16 v[88:91], v[40:43], a[248:255], v126
s_branch Lpd_285
Lpf_357:
buffer_load_dwordx4 v[32:35], v9, s[4:7], s40 offen offset:1024 sc1
Lps_376:
s_waitcnt vmcnt(3)
v_max3_u32 v110, v36, v37, v38
v_max_u32 v110, v110, v39
v_cmp_eq_u32 vcc, -1, v110
s_cbranch_vccnz Lpf_377
v_smfmac_f32_16x16x64_bf16 v[76:79], v[36:39], a[192:199], v126
v_smfmac_f32_16x16x64_bf16 v[80:83], v[36:39], a[200:207], v126
v_smfmac_f32_16x16x64_bf16 v[84:87], v[36:39], a[208:215], v126
Lps_378:
s_waitcnt vmcnt(2)
v_max3_u32 v110, v40, v41, v42
v_max_u32 v110, v110, v43
v_cmp_eq_u32 vcc, -1, v110
s_cbranch_vccnz Lpf_379
v_smfmac_f32_16x16x64_bf16 v[76:79], v[40:43], a[224:231], v126
v_smfmac_f32_16x16x64_bf16 v[80:83], v[40:43], a[232:239], v126
v_smfmac_f32_16x16x64_bf16 v[84:87], v[40:43], a[240:247], v126
Lps_380:
s_waitcnt vmcnt(1)
v_max3_u32 v110, v28, v29, v30
v_max_u32 v110, v110, v31
v_cmp_eq_u32 vcc, -1, v110
s_cbranch_vccnz Lpf_381
v_smfmac_f32_16x16x64_bf16 v[76:79], v[28:31], a[128:135], v126
v_smfmac_f32_16x16x64_bf16 v[80:83], v[28:31], a[136:143], v126
v_smfmac_f32_16x16x64_bf16 v[84:87], v[28:31], a[144:151], v126
s_branch Lps_368
Lpf_359:
buffer_load_dwordx4 v[36:39], v9, s[4:7], s40 offen offset:2048 sc1
Lps_382:
s_waitcnt vmcnt(2)
v_max3_u32 v110, v40, v41, v42
v_max_u32 v110, v110, v43
v_cmp_eq_u32 vcc, -1, v110
s_cbranch_vccnz Lpf_383
v_smfmac_f32_16x16x64_bf16 v[76:79], v[40:43], a[224:231], v126
v_smfmac_f32_16x16x64_bf16 v[80:83], v[40:43], a[232:239], v126
v_smfmac_f32_16x16x64_bf16 v[84:87], v[40:43], a[240:247], v126
Lps_384:
s_waitcnt vmcnt(1)
v_max3_u32 v110, v28, v29, v30
v_max_u32 v110, v110, v31
v_cmp_eq_u32 vcc, -1, v110
s_cbranch_vccnz Lpf_385
v_smfmac_f32_16x16x64_bf16 v[76:79], v[28:31], a[128:135], v126
v_smfmac_f32_16x16x64_bf16 v[80:83], v[28:31], a[136:143], v126
v_smfmac_f32_16x16x64_bf16 v[84:87], v[28:31], a[144:151], v126
s_branch Lps_372
Lpf_361:
buffer_load_dwordx4 v[40:43], v9, s[4:7], s40 offen offset:3072 sc1
Lps_386:
s_waitcnt vmcnt(1)
v_max3_u32 v110, v28, v29, v30
v_max_u32 v110, v110, v31
v_cmp_eq_u32 vcc, -1, v110
s_cbranch_vccnz Lpf_387
v_smfmac_f32_16x16x64_bf16 v[76:79], v[28:31], a[128:135], v126
v_smfmac_f32_16x16x64_bf16 v[80:83], v[28:31], a[136:143], v126
v_smfmac_f32_16x16x64_bf16 v[84:87], v[28:31], a[144:151], v126
s_branch Lps_374
Lpf_363:
buffer_load_dwordx4 v[28:31], v9, s[4:7], s40 offen offset:0 sc1
s_sub_u32 s37, s37, 1
s_cbranch_scc1 Lend_1
s_branch Lps_362
Lpf_365:
buffer_load_dwordx4 v[36:39], v9, s[4:7], s40 offen offset:2048 sc1
Lps_388:
s_waitcnt vmcnt(2)
v_max3_u32 v110, v40, v41, v42
v_max_u32 v110, v110, v43
v_cmp_eq_u32 vcc, -1, v110
s_cbranch_vccnz Lpf_389
v_smfmac_f32_16x16x64_bf16 v[76:79], v[40:43], a[224:231], v126
v_smfmac_f32_16x16x64_bf16 v[80:83], v[40:43], a[232:239], v126
v_smfmac_f32_16x16x64_bf16 v[84:87], v[40:43], a[240:247], v126
Lps_390:
s_waitcnt vmcnt(1)
v_max3_u32 v110, v32, v33, v34
v_max_u32 v110, v110, v35
v_cmp_eq_u32 vcc, -1, v110
s_cbranch_vccnz Lpf_391
v_smfmac_f32_16x16x64_bf16 v[76:79], v[32:35], a[160:167], v126
v_smfmac_f32_16x16x64_bf16 v[80:83], v[32:35], a[168:175], v126
v_smfmac_f32_16x16x64_bf16 v[84:87], v[32:35], a[176:183], v126
s_branch Lps_372
Lpf_367:
buffer_load_dwordx4 v[40:43], v9, s[4:7], s40 offen offset:3072 sc1
Lps_392:
s_waitcnt vmcnt(1)
v_max3_u32 v110, v32, v33, v34
v_max_u32 v110, v110, v35
v_cmp_eq_u32 vcc, -1, v110
s_cbranch_vccnz Lpf_393
v_smfmac_f32_16x16x64_bf16 v[76:79], v[32:35], a[160:167], v126
v_smfmac_f32_16x16x64_bf16 v[80:83], v[32:35], a[168:175], v126
v_smfmac_f32_16x16x64_bf16 v[84:87], v[32:35], a[176:183], v126
s_branch Lps_374
Lpf_369:
buffer_load_dwordx4 v[32:35], v9, s[4:7], s40 offen offset:1024 sc1
s_sub_u32 s37, s37, 1
s_cbranch_scc1 Lend_1
s_branch Lps_368
Lpf_371:
buffer_load_dwordx4 v[40:43], v9, s[4:7], s40 offen offset:3072 sc1
Lps_394:
s_waitcnt vmcnt(1)
v_max3_u32 v110, v36, v37, v38
v_max_u32 v110, v110, v39
v_cmp_eq_u32 vcc, -1, v110
s_cbranch_vccnz Lpf_395
v_smfmac_f32_16x16x64_bf16 v[76:79], v[36:39], a[192:199], v126
v_smfmac_f32_16x16x64_bf16 v[80:83], v[36:39], a[200:207], v126
v_smfmac_f32_16x16x64_bf16 v[84:87], v[36:39], a[208:215], v126
s_branch Lps_374
Lpf_373:
buffer_load_dwordx4 v[36:39], v9, s[4:7], s40 offen offset:2048 sc1
s_sub_u32 s37, s37, 1
s_cbranch_scc1 Lend_1
s_branch Lps_372
Lpf_375:
buffer_load_dwordx4 v[40:43], v9, s[4:7], s40 offen offset:3072 sc1
s_sub_u32 s37, s37, 1
s_cbranch_scc1 Lend_1
s_branch Lps_374
Lpf_377:
buffer_load_dwordx4 v[36:39], v9, s[4:7], s40 offen offset:2048 sc1
Lps_396:
s_waitcnt vmcnt(3)
v_max3_u32 v110, v40, v41, v42
v_max_u32 v110, v110, v43
v_cmp_eq_u32 vcc, -1, v110
s_cbranch_vccnz Lpf_397
v_smfmac_f32_16x16x64_bf16 v[76:79], v[40:43], a[224:231], v126
v_smfmac_f32_16x16x64_bf16 v[80:83], v[40:43], a[232:239], v126
v_smfmac_f32_16x16x64_bf16 v[84:87], v[40:43], a[240:247], v126
Lps_398:
s_waitcnt vmcnt(2)
v_max3_u32 v110, v28, v29, v30
v_max_u32 v110, v110, v31
v_cmp_eq_u32 vcc, -1, v110
s_cbranch_vccnz Lpf_399
v_smfmac_f32_16x16x64_bf16 v[76:79], v[28:31], a[128:135], v126
v_smfmac_f32_16x16x64_bf16 v[80:83], v[28:31], a[136:143], v126
v_smfmac_f32_16x16x64_bf16 v[84:87], v[28:31], a[144:151], v126
s_branch Lps_390
Lpf_379:
buffer_load_dwordx4 v[40:43], v9, s[4:7], s40 offen offset:3072 sc1
Lps_400:
s_waitcnt vmcnt(2)
v_max3_u32 v110, v28, v29, v30
v_max_u32 v110, v110, v31
v_cmp_eq_u32 vcc, -1, v110
s_cbranch_vccnz Lpf_401
v_smfmac_f32_16x16x64_bf16 v[76:79], v[28:31], a[128:135], v126
v_smfmac_f32_16x16x64_bf16 v[80:83], v[28:31], a[136:143], v126
v_smfmac_f32_16x16x64_bf16 v[84:87], v[28:31], a[144:151], v126
s_branch Lps_392
Lpf_381:
buffer_load_dwordx4 v[28:31], v9, s[4:7], s40 offen offset:0 sc1
s_sub_u32 s37, s37, 1
s_cbranch_scc1 Lend_1
Lps_402:
s_waitcnt vmcnt(1)
v_max3_u32 v110, v32, v33, v34
v_max_u32 v110, v110, v35
v_cmp_eq_u32 vcc, -1, v110
s_cbranch_vccnz Lpf_403
v_smfmac_f32_16x16x64_bf16 v[76:79], v[32:35], a[160:167], v126
v_smfmac_f32_16x16x64_bf16 v[80:83], v[32:35], a[168:175], v126
v_smfmac_f32_16x16x64_bf16 v[84:87], v[32:35], a[176:183], v126
s_branch Lps_362
Lpf_383:
buffer_load_dwordx4 v[40:43], v9, s[4:7], s40 offen offset:3072 sc1
Lps_404:
s_waitcnt vmcnt(2)
v_max3_u32 v110, v28, v29, v30
v_max_u32 v110, v110, v31
v_cmp_eq_u32 vcc, -1, v110
s_cbranch_vccnz Lpf_405
v_smfmac_f32_16x16x64_bf16 v[76:79], v[28:31], a[128:135], v126
v_smfmac_f32_16x16x64_bf16 v[80:83], v[28:31], a[136:143], v126
v_smfmac_f32_16x16x64_bf16 v[84:87], v[28:31], a[144:151], v126
s_branch Lps_394
Lpf_385:
buffer_load_dwordx4 v[28:31], v9, s[4:7], s40 offen offset:0 sc1
s_sub_u32 s37, s37, 1
s_cbranch_scc1 Lend_1
Lps_406:
s_waitcnt vmcnt(1)
v_max3_u32 v110, v36, v37, v38
v_max_u32 v110, v110, v39
v_cmp_eq_u32 vcc, -1, v110
s_cbranch_vccnz Lpf_407
v_smfmac_f32_16x16x64_bf16 v[76:79], v[36:39], a[192:199], v126
v_smfmac_f32_16x16x64_bf16 v[80:83], v[36:39], a[200:207], v126
v_smfmac_f32_16x16x64_bf16 v[84:87], v[36:39], a[208:215], v126
s_branch Lps_362
Lpf_387:
buffer_load_dwordx4 v[28:31], v9, s[4:7], s40 offen offset:0 sc1
s_sub_u32 s37, s37, 1
s_cbranch_scc1 Lend_1
s_branch Lps_360
Lpf_389:
buffer_load_dwordx4 v[40:43], v9, s[4:7], s40 offen offset:3072 sc1
Lps_408:
s_waitcnt vmcnt(2)
v_max3_u32 v110, v32, v33, v34
v_max_u32 v110, v110, v35
v_cmp_eq_u32 vcc, -1, v110
s_cbranch_vccnz Lpf_409
v_smfmac_f32_16x16x64_bf16 v[76:79], v[32:35], a[160:167], v126
v_smfmac_f32_16x16x64_bf16 v[80:83], v[32:35], a[168:175], v126
v_smfmac_f32_16x16x64_bf16 v[84:87], v[32:35], a[176:183], v126
s_branch Lps_394
Lpf_391:
buffer_load_dwordx4 v[32:35], v9, s[4:7], s40 offen offset:1024 sc1
s_sub_u32 s37, s37, 1
s_cbranch_scc1 Lend_1
Lps_410:
s_waitcnt vmcnt(1)
v_max3_u32 v110, v36, v37, v38
v_max_u32 v110, v110, v39
v_cmp_eq_u32 vcc, -1, v110
s_cbranch_vccnz Lpf_411
v_smfmac_f32_16x16x64_bf16 v[76:79], v[36:39], a[192:199], v126
v_smfmac_f32_16x16x64_bf16 v[80:83], v[36:39], a[200:207], v126
v_smfmac_f32_16x16x64_bf16 v[84:87], v[36:39], a[208:215], v126
s_branch Lps_368
Lpf_393:
buffer_load_dwordx4 v[32:35], v9, s[4:7], s40 offen offset:1024 sc1
s_sub_u32 s37, s37, 1
s_cbranch_scc1 Lend_1
s_branch Lps_366
Lpf_395:
buffer_load_dwordx4 v[36:39], v9, s[4:7], s40 offen offset:2048 sc1
s_sub_u32 s37, s37, 1
s_cbranch_scc1 Lend_1
s_branch Lps_370
Lpf_397:
buffer_load_dwordx4 v[40:43], v9, s[4:7], s40 offen offset:3072 sc1
Lps_412:
s_waitcnt vmcnt(3)
v_max3_u32 v110, v28, v29, v30
v_max_u32 v110, v110, v31
v_cmp_eq_u32 vcc, -1, v110
s_cbranch_vccnz Lpf_413
v_smfmac_f32_16x16x64_bf16 v[76:79], v[28:31], a[128:135], v126
v_smfmac_f32_16x16x64_bf16 v[80:83], v[28:31], a[136:143], v126
v_smfmac_f32_16x16x64_bf16 v[84:87], v[28:31], a[144:151], v126
s_branch Lps_408
Lpf_399:
buffer_load_dwordx4 v[28:31], v9, s[4:7], s40 offen offset:0 sc1
s_sub_u32 s37, s37, 1
s_cbranch_scc1 Lend_1
Lps_414:
s_waitcnt vmcnt(2)
v_max3_u32 v110, v32, v33, v34
v_max_u32 v110, v110, v35
v_cmp_eq_u32 vcc, -1, v110
s_cbranch_vccnz Lpf_415
v_smfmac_f32_16x16x64_bf16 v[76:79], v[32:35], a[160:167], v126
v_smfmac_f32_16x16x64_bf16 v[80:83], v[32:35], a[168:175], v126
v_smfmac_f32_16x16x64_bf16 v[84:87], v[32:35], a[176:183], v126
s_branch Lps_406
Lpf_401:
buffer_load_dwordx4 v[28:31], v9, s[4:7], s40 offen offset:0 sc1
s_sub_u32 s37, s37, 1
s_cbranch_scc1 Lend_1
Lps_416:
s_waitcnt vmcnt(2)
v_max3_u32 v110, v32, v33, v34
v_max_u32 v110, v110, v35
v_cmp_eq_u32 vcc, -1, v110
s_cbranch_vccnz Lpf_417
v_smfmac_f32_16x16x64_bf16 v[76:79], v[32:35], a[160:167], v126
v_smfmac_f32_16x16x64_bf16 v[80:83], v[32:35], a[168:175], v126
v_smfmac_f32_16x16x64_bf16 v[84:87], v[32:35], a[176:183], v126
s_branch Lps_360
Lpf_403:
buffer_load_dwordx4 v[32:35], v9, s[4:7], s40 offen offset:1024 sc1
s_branch Lps_380
Lpf_405:
buffer_load_dwordx4 v[28:31], v9, s[4:7], s40 offen offset:0 sc1
s_sub_u32 s37, s37, 1
s_cbranch_scc1 Lend_1
s_branch Lps_358
Lpf_407:
buffer_load_dwordx4 v[36:39], v9, s[4:7], s40 offen offset:2048 sc1
s_branch Lps_384
Lpf_409:
buffer_load_dwordx4 v[32:35], v9, s[4:7], s40 offen offset:1024 sc1
s_sub_u32 s37, s37, 1
s_cbranch_scc1 Lend_1
s_branch Lps_364
Lpf_411:
buffer_load_dwordx4 v[36:39], v9, s[4:7], s40 offen offset:2048 sc1
s_branch Lps_390
Lpf_413:
buffer_load_dwordx4 v[28:31], v9, s[4:7], s40 offen offset:0 sc1
s_sub_u32 s37, s37, 1
s_cbranch_scc1 Lend_1
s_branch Lps_356
Lpf_415:
buffer_load_dwordx4 v[32:35], v9, s[4:7], s40 offen offset:1024 sc1
Lps_418:
s_waitcnt vmcnt(2)
v_max3_u32 v110, v36, v37, v38
v_max_u32 v110, v110, v39
v_cmp_eq_u32 vcc, -1, v110
s_cbranch_vccnz Lpf_419
v_smfmac_f32_16x16x64_bf16 v[76:79], v[36:39], a[192:199], v126
v_smfmac_f32_16x16x64_bf16 v[80:83], v[36:39], a[200:207], v126
v_smfmac_f32_16x16x64_bf16 v[84:87], v[36:39], a[208:215], v126
s_branch Lps_380
Lpf_417:
buffer_load_dwordx4 v[32:35], v9, s[4:7], s40 offen offset:1024 sc1
s_branch Lps_378
Lpf_419:
buffer_load_dwordx4 v[36:39], v9, s[4:7], s40 offen offset:2048 sc1
s_branch Lps_398
Lkvo_sc1_276:
Lkvo_420:
buffer_load_dwordx4 v[28:31], v8, s[4:7], s40 offen offset:0 sc1
v_mfma_f32_16x16x32_bf16 v[16:19], v[20:23], v[20:23], 0
v_mfma_f32_16x16x32_bf16 v[16:19], v[20:23], v[20:23], 0
v_mfma_f32_16x16x32_bf16 v[16:19], v[20:23], v[20:23], 0
buffer_load_dwordx4 v[32:35], v8, s[4:7], s40 offen offset:1024 sc1
v_mfma_f32_16x16x32_bf16 v[16:19], v[20:23], v[20:23], 0
v_mfma_f32_16x16x32_bf16 v[16:19], v[20:23], v[20:23], 0
v_mfma_f32_16x16x32_bf16 v[16:19], v[20:23], v[20:23], 0
buffer_load_dwordx4 v[36:39], v8, s[4:7], s40 offen offset:2048 sc1
v_mfma_f32_16x16x32_bf16 v[16:19], v[20:23], v[20:23], 0
v_mfma_f32_16x16x32_bf16 v[16:19], v[20:23], v[20:23], 0
v_mfma_f32_16x16x32_bf16 v[16:19], v[20:23], v[20:23], 0
buffer_load_dwordx4 v[40:43], v8, s[4:7], s40 offen offset:3072 sc1
v_mfma_f32_16x16x32_bf16 v[16:19], v[20:23], v[20:23], 0
s_waitcnt vmcnt(3)
v_max3_u32 v110, v28, v29, v30
v_max_u32 v110, v110, v31
v_cmp_eq_u32 vcc, -1, v110
s_cbranch_vccnz Lpf_422
v_smfmac_f32_16x16x64_bf16 v[44:47], v[28:31], a[0:7], v126
v_smfmac_f32_16x16x64_bf16 v[48:51], v[28:31], a[8:15], v126
s_waitcnt vmcnt(2)
v_max3_u32 v110, v32, v33, v34
v_max_u32 v110, v110, v35
v_cmp_eq_u32 vcc, -1, v110
v_smfmac_f32_16x16x64_bf16 v[52:55], v[28:31], a[16:23], v126
v_smfmac_f32_16x16x64_bf16 v[60:63], v[28:31], v[128:135], v126
s_cbranch_vccnz Lpf_423
v_smfmac_f32_16x16x64_bf16 v[44:47], v[32:35], a[32:39], v126
v_smfmac_f32_16x16x64_bf16 v[48:51], v[32:35], a[40:47], v126
s_waitcnt vmcnt(1)
v_max3_u32 v110, v36, v37, v38
v_max_u32 v110, v110, v39
v_cmp_eq_u32 vcc, -1, v110
v_smfmac_f32_16x16x64_bf16 v[52:55], v[32:35], a[48:55], v126
v_smfmac_f32_16x16x64_bf16 v[60:63], v[32:35], v[160:167], v126
s_cbranch_vccnz Lpf_424
v_smfmac_f32_16x16x64_bf16 v[44:47], v[36:39], a[64:71], v126
v_smfmac_f32_16x16x64_bf16 v[48:51], v[36:39], a[72:79], v126
s_waitcnt vmcnt(0)
v_max3_u32 v110, v40, v41, v42
v_max_u32 v110, v110, v43
v_cmp_eq_u32 vcc, -1, v110
v_smfmac_f32_16x16x64_bf16 v[52:55], v[36:39], a[80:87], v126
v_smfmac_f32_16x16x64_bf16 v[60:63], v[36:39], v[192:199], v126
s_cbranch_vccnz Lpf_425
v_smfmac_f32_16x16x64_bf16 v[44:47], v[40:43], a[96:103], v126
s_nop 1
v_smfmac_f32_16x16x64_bf16 v[48:51], v[40:43], a[104:111], v126
s_nop 1
v_smfmac_f32_16x16x64_bf16 v[52:55], v[40:43], a[112:119], v126
s_nop 1
v_add_f32 v92, v44, v46
v_add_f32 v93, v45, v47
v_smfmac_f32_16x16x64_bf16 v[56:59], v[28:31], a[24:31], v126
v_add_f32 v94, v48, v50
v_add_f32 v95, v49, v51
ds_write_b64 v24, v[92:93] offset:0
v_add_f32 v96, v52, v54
v_add_f32 v97, v53, v55
ds_write_b64 v25, v[94:95] offset:0
v_smfmac_f32_16x16x64_bf16 v[56:59], v[32:35], a[56:63], v126
ds_write_b64 v26, v[96:97] offset:0
v_smfmac_f32_16x16x64_bf16 v[56:59], v[36:39], a[88:95], v126
v_smfmac_f32_16x16x64_bf16 v[56:59], v[40:43], a[120:127], v126
v_smfmac_f32_16x16x64_bf16 v[60:63], v[40:43], v[224:231], v126
Lpd_421:
v_smfmac_f32_16x16x64_bf16 v[64:67], v[28:31], v[136:143], v126
v_smfmac_f32_16x16x64_bf16 v[64:67], v[32:35], v[168:175], v126
s_waitcnt lgkmcnt(0)
s_barrier
ds_read_b64 v[100:101], v0 offset:0
ds_read_b64 v[102:103], v0 offset:512
ds_read_b64 v[104:105], v0 offset:1024
s_nop 2
v_add_f32 v98, v56, v58
v_add_f32 v99, v57, v59
v_smfmac_f32_16x16x64_bf16 v[64:67], v[36:39], v[200:207], v126
v_smfmac_f32_16x16x64_bf16 v[64:67], v[40:43], v[232:239], v126
v_smfmac_f32_16x16x64_bf16 v[68:71], v[28:31], v[144:151], v126
v_smfmac_f32_16x16x64_bf16 v[68:71], v[32:35], v[176:183], v126
s_waitcnt lgkmcnt(0)
v_add_f32 v100, v100, v98
v_add_f32 v102, v102, v104
v_add_f32 v101, v101, v99
v_add_f32 v103, v103, v105
v_add_f32 v100, v100, v102
v_add_f32 v101, v101, v103
v_cvt_pk_bf16_f32 v108, v100, v101
s_nop 1
v_mov_b32_dpp v109, v108 quad_perm:[1,0,3,2] row_mask:0xf bank_mask:0xf
v_perm_b32 v109, v109, v108, v3
buffer_store_dword v109, v11, s[4:7], s40 offen sc1
v_smfmac_f32_16x16x64_bf16 v[68:71], v[36:39], v[208:215], v126
v_smfmac_f32_16x16x64_bf16 v[68:71], v[40:43], v[240:247], v126
s_nop 3
v_smfmac_f32_16x16x64_bf16 v[72:75], v[28:31], v[152:159], v126
v_add_f32 v92, v60, v62
v_add_f32 v93, v61, v63
v_smfmac_f32_16x16x64_bf16 v[72:75], v[32:35], v[184:191], v126
v_add_f32 v94, v64, v66
v_add_f32 v95, v65, v67
ds_write_b64 v24, v[92:93] offset:6144
v_smfmac_f32_16x16x64_bf16 v[72:75], v[36:39], v[216:223], v126
v_add_f32 v96, v68, v70
v_add_f32 v97, v69, v71
ds_write_b64 v25, v[94:95] offset:6144
ds_write_b64 v26, v[96:97] offset:6144
v_smfmac_f32_16x16x64_bf16 v[72:75], v[40:43], v[248:255], v126
s_waitcnt lgkmcnt(0)
s_barrier
ds_read_b64 v[100:101], v0 offset:6144
ds_read_b64 v[102:103], v0 offset:6656
ds_read_b64 v[104:105], v0 offset:7168
s_nop 2
v_add_f32 v98, v72, v74
v_add_f32 v99, v73, v75
s_waitcnt lgkmcnt(0)
v_pk_add_f32 v[100:101], v[100:101], v[98:99]
v_pk_add_f32 v[102:103], v[102:103], v[104:105]
v_pk_add_f32 v[100:101], v[100:101], v[102:103]
v_cvt_pk_bf16_f32 v108, v100, v101
buffer_store_dword v108, v27, s[4:7], s40 offen sc1
s_cmp_eq_u32 s36, 63
s_cbranch_scc1 Lend_1
v_add_u32 v7, 1, v7
s_and_b32 s38, s36, 3
s_lshl_b32 s84, s38, 18
s_add_u32 s84, s84, s46
s_add_u32 s85, s84, 0x100000
s_mov_b64 exec, 3
buffer_load_dword v112, v1, s[4:7], s59 offen sc1
s_nop 5
buffer_load_dword v113, v1, s[4:7], s59 offen sc1
s_nop 5
buffer_load_dword v114, v1, s[4:7], s59 offen sc1
s_nop 5
buffer_load_dword v115, v1, s[4:7], s59 offen sc1
Lft_427:
s_waitcnt vmcnt(3)
v_cmp_gt_u32 vcc, s26, v112
buffer_load_dword v112, v1, s[4:7], s59 offen sc1
s_cbranch_vccz Lfg_426
s_waitcnt vmcnt(3)
v_cmp_gt_u32 vcc, s26, v113
buffer_load_dword v113, v1, s[4:7], s59 offen sc1
s_cbranch_vccz Lfg_426
s_waitcnt vmcnt(3)
v_cmp_gt_u32 vcc, s26, v114
buffer_load_dword v114, v1, s[4:7], s59 offen sc1
s_cbranch_vccz Lfg_426
s_waitcnt vmcnt(3)
v_cmp_gt_u32 vcc, s26, v115
buffer_load_dword v115, v1, s[4:7], s59 offen sc1
s_cbranch_vccz Lfg_426
s_sub_u32 s37, s37, 1
s_cbranch_scc1 Lend_1
s_branch Lft_427
Lfg_426:
s_mov_b64 exec, -1
buffer_load_dwordx4 v[28:31], v9, s[4:7], s40 offen offset:0 sc1
v_mfma_f32_16x16x32_bf16 v[16:19], v[20:23], v[20:23], 0
v_mfma_f32_16x16x32_bf16 v[16:19], v[20:23], v[20:23], 0
v_mfma_f32_16x16x32_bf16 v[16:19], v[20:23], v[20:23], 0
buffer_load_dwordx4 v[32:35], v9, s[4:7], s40 offen offset:1024 sc1
v_mfma_f32_16x16x32_bf16 v[16:19], v[20:23], v[20:23], 0
v_mfma_f32_16x16x32_bf16 v[16:19], v[20:23], v[20:23], 0
v_mfma_f32_16x16x32_bf16 v[16:19], v[20:23], v[20:23], 0
buffer_load_dwordx4 v[36:39], v9, s[4:7], s40 offen offset:2048 sc1
v_mfma_f32_16x16x32_bf16 v[16:19], v[20:23], v[20:23], 0
v_mfma_f32_16x16x32_bf16 v[16:19], v[20:23], v[20:23], 0
v_mfma_f32_16x16x32_bf16 v[16:19], v[20:23], v[20:23], 0
buffer_load_dwordx4 v[40:43], v9, s[4:7], s40 offen offset:3072 sc1
v_mfma_f32_16x16x32_bf16 v[16:19], v[20:23], v[20:23], 0
s_waitcnt vmcnt(3)
v_max3_u32 v110, v28, v29, v30
v_max_u32 v110, v110, v31
v_cmp_eq_u32 vcc, -1, v110
s_cbranch_vccnz Lpf_429
v_smfmac_f32_16x16x64_bf16 v[76:79], v[28:31], a[128:135], v126
s_waitcnt vmcnt(2)
v_max3_u32 v110, v32, v33, v34
v_max_u32 v110, v110, v35
v_cmp_eq_u32 vcc, -1, v110
v_smfmac_f32_16x16x64_bf16 v[80:83], v[28:31], a[136:143], v126
v_smfmac_f32_16x16x64_bf16 v[84:87], v[28:31], a[144:151], v126
s_cbranch_vccnz Lpf_430
v_smfmac_f32_16x16x64_bf16 v[76:79], v[32:35], a[160:167], v126
s_waitcnt vmcnt(1)
v_max3_u32 v110, v36, v37, v38
v_max_u32 v110, v110, v39
v_cmp_eq_u32 vcc, -1, v110
v_smfmac_f32_16x16x64_bf16 v[80:83], v[32:35], a[168:175], v126
v_smfmac_f32_16x16x64_bf16 v[84:87], v[32:35], a[176:183], v126
s_cbranch_vccnz Lpf_431
v_smfmac_f32_16x16x64_bf16 v[76:79], v[36:39], a[192:199], v126
s_waitcnt vmcnt(0)
v_max3_u32 v110, v40, v41, v42
v_max_u32 v110, v110, v43
v_cmp_eq_u32 vcc, -1, v110
v_smfmac_f32_16x16x64_bf16 v[80:83], v[36:39], a[200:207], v126
v_smfmac_f32_16x16x64_bf16 v[84:87], v[36:39], a[208:215], v126
s_cbranch_vccnz Lpf_432
v_smfmac_f32_16x16x64_bf16 v[76:79], v[40:43], a[224:231], v126
s_nop 1
v_smfmac_f32_16x16x64_bf16 v[80:83], v[40:43], a[232:239], v126
s_nop 1
v_smfmac_f32_16x16x64_bf16 v[84:87], v[40:43], a[240:247], v126
s_nop 1
v_add_f32 v92, v76, v78
v_add_f32 v93, v77, v79
v_smfmac_f32_16x16x64_bf16 v[88:91], v[28:31], a[152:159], v126
v_add_f32 v94, v80, v82
v_add_f32 v95, v81, v83
ds_write_b64 v24, v[92:93] offset:12288
v_add_f32 v96, v84, v86
v_add_f32 v97, v85, v87
ds_write_b64 v25, v[94:95] offset:12288
v_smfmac_f32_16x16x64_bf16 v[88:91], v[32:35], a[184:191], v126
ds_write_b64 v26, v[96:97] offset:12288
v_smfmac_f32_16x16x64_bf16 v[88:91], v[36:39], a[216:223], v126
v_smfmac_f32_16x16x64_bf16 v[88:91], v[40:43], a[248:255], v126
Lpd_428:
s_waitcnt lgkmcnt(0)
s_barrier
ds_read_b64 v[100:101], v0 offset:12288
ds_read_b64 v[102:103], v0 offset:12800
ds_read_b64 v[104:105], v0 offset:13312
s_nop 2
v_add_f32 v98, v88, v90
v_add_f32 v99, v89, v91
s_waitcnt lgkmcnt(0)
v_pk_add_f32 v[100:101], v[100:101], v[98:99]
v_pk_add_f32 v[102:103], v[102:103], v[104:105]
v_pk_add_f32 v[100:101], v[100:101], v[102:103]
v_cvt_pk_bf16_f32 v108, v100, v101
buffer_store_dword v108, v12, s[4:7], s84 offen sc1
buffer_store_dword v108, v12, s[4:7], s85 offen sc1
buffer_store_dword v121, v11, s[4:7], s42 offen sc1
buffer_store_dword v121, v27, s[4:7], s42 offen sc1
buffer_store_dword v121, v10, s[4:7], s42 offen sc1
v_lshlrev_b32 v106, 16, v108
v_and_b32 v107, 0xffff0000, v108
s_add_u32 s36, s36, 1
s_and_b32 s38, s36, 3
s_lshl_b32 s39, s38, 16
s_add_u32 s40, s39, s45
s_xor_b32 s42, s40, 0x20000
s_add_u32 s26, s36, 1
s_nop 15
s_nop 15
s_nop 15
s_nop 15
buffer_load_dword v112, v13, s[4:7], s84 offen sc1
buffer_load_dword v113, v14, s[4:7], s84 offen sc1
buffer_load_dword v114, v15, s[4:7], s84 offen sc1
v_pk_mul_f32 v[44:45], 0, 0
v_pk_mul_f32 v[46:47], 0, 0
v_pk_mul_f32 v[48:49], 0, 0
v_pk_mul_f32 v[50:51], 0, 0
v_pk_mul_f32 v[52:53], 0, 0
v_pk_mul_f32 v[54:55], 0, 0
v_pk_mul_f32 v[56:57], 0, 0
v_pk_mul_f32 v[58:59], 0, 0
v_pk_mul_f32 v[60:61], 0, 0
v_pk_mul_f32 v[62:63], 0, 0
v_pk_mul_f32 v[64:65], 0, 0
v_pk_mul_f32 v[66:67], 0, 0
v_pk_mul_f32 v[68:69], 0, 0
v_pk_mul_f32 v[70:71], 0, 0
v_pk_mul_f32 v[72:73], 0, 0
v_pk_mul_f32 v[74:75], 0, 0
v_pk_mul_f32 v[76:77], 0, 0
v_pk_mul_f32 v[78:79], 0, 0
v_pk_mul_f32 v[80:81], 0, 0
v_pk_mul_f32 v[82:83], 0, 0
v_pk_mul_f32 v[84:85], 0, 0
v_pk_mul_f32 v[86:87], 0, 0
v_pk_mul_f32 v[88:89], 0, 0
v_pk_mul_f32 v[90:91], 0, 0
buffer_store_dword v7, v2, s[4:7], s59 offen sc1
buffer_load_dword v115, v13, s[4:7], s85 offen sc1
buffer_load_dword v116, v14, s[4:7], s85 offen sc1
buffer_load_dword v117, v15, s[4:7], s85 offen sc1
s_nop 15
s_nop 15
s_nop 15
buffer_load_dword v118, v13, s[4:7], s84 offen sc1
buffer_load_dword v119, v14, s[4:7], s84 offen sc1
buffer_load_dword v120, v15, s[4:7], s84 offen sc1
v_mfma_f32_16x16x32_bf16 v[16:19], v[20:23], v[20:23], 0
v_mfma_f32_16x16x32_bf16 v[16:19], v[20:23], v[20:23], 0
v_mfma_f32_16x16x32_bf16 v[16:19], v[20:23], v[20:23], 0
v_mfma_f32_16x16x32_bf16 v[16:19], v[20:23], v[20:23], 0
s_waitcnt vmcnt(7)
v_dot2_f32_bf16 v100, v112, s55, v106
v_dot2_f32_bf16 v101, v112, s56, v107
v_dot2_f32_bf16 v100, v113, s55, v100
v_dot2_f32_bf16 v101, v113, s56, v101
v_dot2_f32_bf16 v100, v114, s55, v100
v_dot2_f32_bf16 v101, v114, s56, v101
v_max3_u32 v110, v112, v113, v114
v_cmp_eq_u32 vcc, -1, v110
s_nop 0
v_cvt_pk_bf16_f32 v100, v100, v101
s_nop 1
v_mov_b32_dpp v109, v100 quad_perm:[1,0,3,2] row_mask:0xf bank_mask:0xf
v_perm_b32 v109, v109, v100, v3
s_cbranch_vccnz Lx2_433
Lxs_434:
buffer_store_dword v109, v10, s[4:7], s40 offen sc1
s_nop 15
s_nop 15
s_nop 11
s_branch Lkvo_420
Lx2_433:
buffer_load_dword v112, v13, s[4:7], s85 offen sc1
buffer_load_dword v113, v14, s[4:7], s85 offen sc1
buffer_load_dword v114, v15, s[4:7], s85 offen sc1
s_waitcnt vmcnt(6)
v_dot2_f32_bf16 v100, v115, s55, v106
v_dot2_f32_bf16 v101, v115, s56, v107
v_dot2_f32_bf16 v100, v116, s55, v100
v_dot2_f32_bf16 v101, v116, s56, v101
v_dot2_f32_bf16 v100, v117, s55, v100
v_dot2_f32_bf16 v101, v117, s56, v101
v_max3_u32 v110, v115, v116, v117
v_cmp_eq_u32 vcc, -1, v110
s_nop 0
v_cvt_pk_bf16_f32 v100, v100, v101
s_nop 1
v_mov_b32_dpp v109, v100 quad_perm:[1,0,3,2] row_mask:0xf bank_mask:0xf
v_perm_b32 v109, v109, v100, v3
s_cbranch_vccz Lxs_434
buffer_load_dword v115, v13, s[4:7], s84 offen sc1
buffer_load_dword v116, v14, s[4:7], s84 offen sc1
buffer_load_dword v117, v15, s[4:7], s84 offen sc1
s_waitcnt vmcnt(6)
v_dot2_f32_bf16 v100, v118, s55, v106
v_dot2_f32_bf16 v101, v118, s56, v107
v_dot2_f32_bf16 v100, v119, s55, v100
v_dot2_f32_bf16 v101, v119, s56, v101
v_dot2_f32_bf16 v100, v120, s55, v100
v_dot2_f32_bf16 v101, v120, s56, v101
v_max3_u32 v110, v118, v119, v120
v_cmp_eq_u32 vcc, -1, v110
s_nop 0
v_cvt_pk_bf16_f32 v100, v100, v101
s_nop 1
v_mov_b32_dpp v109, v100 quad_perm:[1,0,3,2] row_mask:0xf bank_mask:0xf
v_perm_b32 v109, v109, v100, v3
s_cbranch_vccz Lxs_434
buffer_load_dword v118, v13, s[4:7], s85 offen sc1
buffer_load_dword v119, v14, s[4:7], s85 offen sc1
buffer_load_dword v120, v15, s[4:7], s85 offen sc1
s_waitcnt vmcnt(6)
v_dot2_f32_bf16 v100, v112, s55, v106
v_dot2_f32_bf16 v101, v112, s56, v107
v_dot2_f32_bf16 v100, v113, s55, v100
v_dot2_f32_bf16 v101, v113, s56, v101
v_dot2_f32_bf16 v100, v114, s55, v100
v_dot2_f32_bf16 v101, v114, s56, v101
v_max3_u32 v110, v112, v113, v114
v_cmp_eq_u32 vcc, -1, v110
s_nop 0
v_cvt_pk_bf16_f32 v100, v100, v101
s_nop 1
v_mov_b32_dpp v109, v100 quad_perm:[1,0,3,2] row_mask:0xf bank_mask:0xf
v_perm_b32 v109, v109, v100, v3
s_cbranch_vccz Lxs_434
buffer_load_dword v112, v13, s[4:7], s84 offen sc1
buffer_load_dword v113, v14, s[4:7], s84 offen sc1
buffer_load_dword v114, v15, s[4:7], s84 offen sc1
s_waitcnt vmcnt(6)
v_dot2_f32_bf16 v100, v115, s55, v106
v_dot2_f32_bf16 v101, v115, s56, v107
v_dot2_f32_bf16 v100, v116, s55, v100
v_dot2_f32_bf16 v101, v116, s56, v101
v_dot2_f32_bf16 v100, v117, s55, v100
v_dot2_f32_bf16 v101, v117, s56, v101
v_max3_u32 v110, v115, v116, v117
v_cmp_eq_u32 vcc, -1, v110
s_nop 0
v_cvt_pk_bf16_f32 v100, v100, v101
s_nop 1
v_mov_b32_dpp v109, v100 quad_perm:[1,0,3,2] row_mask:0xf bank_mask:0xf
v_perm_b32 v109, v109, v100, v3
s_cbranch_vccz Lxs_434
buffer_load_dword v115, v13, s[4:7], s85 offen sc1
buffer_load_dword v116, v14, s[4:7], s85 offen sc1
buffer_load_dword v117, v15, s[4:7], s85 offen sc1
s_waitcnt vmcnt(6)
v_dot2_f32_bf16 v100, v118, s55, v106
v_dot2_f32_bf16 v101, v118, s56, v107
v_dot2_f32_bf16 v100, v119, s55, v100
v_dot2_f32_bf16 v101, v119, s56, v101
v_dot2_f32_bf16 v100, v120, s55, v100
v_dot2_f32_bf16 v101, v120, s56, v101
v_max3_u32 v110, v118, v119, v120
v_cmp_eq_u32 vcc, -1, v110
s_nop 0
v_cvt_pk_bf16_f32 v100, v100, v101
s_nop 1
v_mov_b32_dpp v109, v100 quad_perm:[1,0,3,2] row_mask:0xf bank_mask:0xf
v_perm_b32 v109, v109, v100, v3
s_cbranch_vccz Lxs_434
buffer_load_dword v118, v13, s[4:7], s84 offen sc1
buffer_load_dword v119, v14, s[4:7], s84 offen sc1
buffer_load_dword v120, v15, s[4:7], s84 offen sc1
s_waitcnt vmcnt(6)
v_dot2_f32_bf16 v100, v112, s55, v106
v_dot2_f32_bf16 v101, v112, s56, v107
v_dot2_f32_bf16 v100, v113, s55, v100
v_dot2_f32_bf16 v101, v113, s56, v101
v_dot2_f32_bf16 v100, v114, s55, v100
v_dot2_f32_bf16 v101, v114, s56, v101
v_max3_u32 v110, v112, v113, v114
v_cmp_eq_u32 vcc, -1, v110
s_nop 0
v_cvt_pk_bf16_f32 v100, v100, v101
s_nop 1
v_mov_b32_dpp v109, v100 quad_perm:[1,0,3,2] row_mask:0xf bank_mask:0xf
v_perm_b32 v109, v109, v100, v3
s_cbranch_vccz Lxs_434
s_sub_u32 s37, s37, 1
s_cbranch_scc1 Lend_1
s_branch Lx2_433
Lpf_422:
buffer_load_dwordx4 v[28:31], v8, s[4:7], s40 offen offset:0 sc1
s_sub_u32 s37, s37, 1
s_cbranch_scc1 Lend_1
Lps_435:
s_waitcnt vmcnt(3)
v_max3_u32 v110, v32, v33, v34
v_max_u32 v110, v110, v35
v_cmp_eq_u32 vcc, -1, v110
s_cbranch_vccnz Lpf_436
v_smfmac_f32_16x16x64_bf16 v[44:47], v[32:35], a[32:39], v126
v_smfmac_f32_16x16x64_bf16 v[48:51], v[32:35], a[40:47], v126
v_smfmac_f32_16x16x64_bf16 v[52:55], v[32:35], a[48:55], v126
v_smfmac_f32_16x16x64_bf16 v[60:63], v[32:35], v[160:167], v126
Lps_437:
s_waitcnt vmcnt(2)
v_max3_u32 v110, v36, v37, v38
v_max_u32 v110, v110, v39
v_cmp_eq_u32 vcc, -1, v110
s_cbranch_vccnz Lpf_438
v_smfmac_f32_16x16x64_bf16 v[44:47], v[36:39], a[64:71], v126
v_smfmac_f32_16x16x64_bf16 v[48:51], v[36:39], a[72:79], v126
v_smfmac_f32_16x16x64_bf16 v[52:55], v[36:39], a[80:87], v126
v_smfmac_f32_16x16x64_bf16 v[60:63], v[36:39], v[192:199], v126
Lps_439:
s_waitcnt vmcnt(1)
v_max3_u32 v110, v40, v41, v42
v_max_u32 v110, v110, v43
v_cmp_eq_u32 vcc, -1, v110
s_cbranch_vccnz Lpf_440
v_smfmac_f32_16x16x64_bf16 v[44:47], v[40:43], a[96:103], v126
v_smfmac_f32_16x16x64_bf16 v[48:51], v[40:43], a[104:111], v126
v_smfmac_f32_16x16x64_bf16 v[52:55], v[40:43], a[112:119], v126
v_smfmac_f32_16x16x64_bf16 v[60:63], v[40:43], v[224:231], v126
Lps_441:
s_waitcnt vmcnt(0)
v_max3_u32 v110, v28, v29, v30
v_max_u32 v110, v110, v31
v_cmp_eq_u32 vcc, -1, v110
s_cbranch_vccnz Lpf_442
v_smfmac_f32_16x16x64_bf16 v[44:47], v[28:31], a[0:7], v126
s_nop 1
v_smfmac_f32_16x16x64_bf16 v[48:51], v[28:31], a[8:15], v126
s_nop 1
v_smfmac_f32_16x16x64_bf16 v[52:55], v[28:31], a[16:23], v126
s_nop 1
v_add_f32 v92, v44, v46
v_add_f32 v93, v45, v47
v_smfmac_f32_16x16x64_bf16 v[56:59], v[28:31], a[24:31], v126
v_add_f32 v94, v48, v50
v_add_f32 v95, v49, v51
ds_write_b64 v24, v[92:93] offset:0
v_add_f32 v96, v52, v54
v_add_f32 v97, v53, v55
ds_write_b64 v25, v[94:95] offset:0
v_smfmac_f32_16x16x64_bf16 v[56:59], v[32:35], a[56:63], v126
ds_write_b64 v26, v[96:97] offset:0
v_smfmac_f32_16x16x64_bf16 v[56:59], v[36:39], a[88:95], v126
v_smfmac_f32_16x16x64_bf16 v[56:59], v[40:43], a[120:127], v126
v_smfmac_f32_16x16x64_bf16 v[60:63], v[28:31], v[128:135], v126
s_branch Lpd_421
Lpf_423:
buffer_load_dwordx4 v[32:35], v8, s[4:7], s40 offen offset:1024 sc1
s_sub_u32 s37, s37, 1
s_cbranch_scc1 Lend_1
Lps_443:
s_waitcnt vmcnt(2)
v_max3_u32 v110, v36, v37, v38
v_max_u32 v110, v110, v39
v_cmp_eq_u32 vcc, -1, v110
s_cbranch_vccnz Lpf_444
v_smfmac_f32_16x16x64_bf16 v[44:47], v[36:39], a[64:71], v126
v_smfmac_f32_16x16x64_bf16 v[48:51], v[36:39], a[72:79], v126
v_smfmac_f32_16x16x64_bf16 v[52:55], v[36:39], a[80:87], v126
v_smfmac_f32_16x16x64_bf16 v[60:63], v[36:39], v[192:199], v126
Lps_445:
s_waitcnt vmcnt(1)
v_max3_u32 v110, v40, v41, v42
v_max_u32 v110, v110, v43
v_cmp_eq_u32 vcc, -1, v110
s_cbranch_vccnz Lpf_446
v_smfmac_f32_16x16x64_bf16 v[44:47], v[40:43], a[96:103], v126
v_smfmac_f32_16x16x64_bf16 v[48:51], v[40:43], a[104:111], v126
v_smfmac_f32_16x16x64_bf16 v[52:55], v[40:43], a[112:119], v126
v_smfmac_f32_16x16x64_bf16 v[60:63], v[40:43], v[224:231], v126
Lps_447:
s_waitcnt vmcnt(0)
v_max3_u32 v110, v32, v33, v34
v_max_u32 v110, v110, v35
v_cmp_eq_u32 vcc, -1, v110
s_cbranch_vccnz Lpf_448
v_smfmac_f32_16x16x64_bf16 v[44:47], v[32:35], a[32:39], v126
s_nop 1
v_smfmac_f32_16x16x64_bf16 v[48:51], v[32:35], a[40:47], v126
s_nop 1
v_smfmac_f32_16x16x64_bf16 v[52:55], v[32:35], a[48:55], v126
s_nop 1
v_add_f32 v92, v44, v46
v_add_f32 v93, v45, v47
v_smfmac_f32_16x16x64_bf16 v[56:59], v[28:31], a[24:31], v126
v_add_f32 v94, v48, v50
v_add_f32 v95, v49, v51
ds_write_b64 v24, v[92:93] offset:0
v_add_f32 v96, v52, v54
v_add_f32 v97, v53, v55
ds_write_b64 v25, v[94:95] offset:0
v_smfmac_f32_16x16x64_bf16 v[56:59], v[32:35], a[56:63], v126
ds_write_b64 v26, v[96:97] offset:0
v_smfmac_f32_16x16x64_bf16 v[56:59], v[36:39], a[88:95], v126
v_smfmac_f32_16x16x64_bf16 v[56:59], v[40:43], a[120:127], v126
v_smfmac_f32_16x16x64_bf16 v[60:63], v[32:35], v[160:167], v126
s_branch Lpd_421
Lpf_424:
buffer_load_dwordx4 v[36:39], v8, s[4:7], s40 offen offset:2048 sc1
s_sub_u32 s37, s37, 1
s_cbranch_scc1 Lend_1
Lps_449:
s_waitcnt vmcnt(1)
v_max3_u32 v110, v40, v41, v42
v_max_u32 v110, v110, v43
v_cmp_eq_u32 vcc, -1, v110
s_cbranch_vccnz Lpf_450
v_smfmac_f32_16x16x64_bf16 v[44:47], v[40:43], a[96:103], v126
v_smfmac_f32_16x16x64_bf16 v[48:51], v[40:43], a[104:111], v126
v_smfmac_f32_16x16x64_bf16 v[52:55], v[40:43], a[112:119], v126
v_smfmac_f32_16x16x64_bf16 v[60:63], v[40:43], v[224:231], v126
Lps_451:
s_waitcnt vmcnt(0)
v_max3_u32 v110, v36, v37, v38
v_max_u32 v110, v110, v39
v_cmp_eq_u32 vcc, -1, v110
s_cbranch_vccnz Lpf_452
v_smfmac_f32_16x16x64_bf16 v[44:47], v[36:39], a[64:71], v126
s_nop 1
v_smfmac_f32_16x16x64_bf16 v[48:51], v[36:39], a[72:79], v126
s_nop 1
v_smfmac_f32_16x16x64_bf16 v[52:55], v[36:39], a[80:87], v126
s_nop 1
v_add_f32 v92, v44, v46
v_add_f32 v93, v45, v47
v_smfmac_f32_16x16x64_bf16 v[56:59], v[28:31], a[24:31], v126
v_add_f32 v94, v48, v50
v_add_f32 v95, v49, v51
ds_write_b64 v24, v[92:93] offset:0
v_add_f32 v96, v52, v54
v_add_f32 v97, v53, v55
ds_write_b64 v25, v[94:95] offset:0
v_smfmac_f32_16x16x64_bf16 v[56:59], v[32:35], a[56:63], v126
ds_write_b64 v26, v[96:97] offset:0
v_smfmac_f32_16x16x64_bf16 v[56:59], v[36:39], a[88:95], v126
v_smfmac_f32_16x16x64_bf16 v[56:59], v[40:43], a[120:127], v126
v_smfmac_f32_16x16x64_bf16 v[60:63], v[36:39], v[192:199], v126
s_branch Lpd_421
Lpf_425:
buffer_load_dwordx4 v[40:43], v8, s[4:7], s40 offen offset:3072 sc1
s_sub_u32 s37, s37, 1
s_cbranch_scc1 Lend_1
Lps_453:
s_waitcnt vmcnt(0)
v_max3_u32 v110, v40, v41, v42
v_max_u32 v110, v110, v43
v_cmp_eq_u32 vcc, -1, v110
s_cbranch_vccnz Lpf_454
v_smfmac_f32_16x16x64_bf16 v[44:47], v[40:43], a[96:103], v126
s_nop 1
v_smfmac_f32_16x16x64_bf16 v[48:51], v[40:43], a[104:111], v126
s_nop 1
v_smfmac_f32_16x16x64_bf16 v[52:55], v[40:43], a[112:119], v126
s_nop 1
v_add_f32 v92, v44, v46
v_add_f32 v93, v45, v47
v_smfmac_f32_16x16x64_bf16 v[56:59], v[28:31], a[24:31], v126
v_add_f32 v94, v48, v50
v_add_f32 v95, v49, v51
ds_write_b64 v24, v[92:93] offset:0
v_add_f32 v96, v52, v54
v_add_f32 v97, v53, v55
ds_write_b64 v25, v[94:95] offset:0
v_smfmac_f32_16x16x64_bf16 v[56:59], v[32:35], a[56:63], v126
ds_write_b64 v26, v[96:97] offset:0
v_smfmac_f32_16x16x64_bf16 v[56:59], v[36:39], a[88:95], v126
v_smfmac_f32_16x16x64_bf16 v[56:59], v[40:43], a[120:127], v126
v_smfmac_f32_16x16x64_bf16 v[60:63], v[40:43], v[224:231], v126
s_branch Lpd_421
Lpf_436:
buffer_load_dwordx4 v[32:35], v8, s[4:7], s40 offen offset:1024 sc1
Lps_455:
s_waitcnt vmcnt(3)
v_max3_u32 v110, v36, v37, v38
v_max_u32 v110, v110, v39
v_cmp_eq_u32 vcc, -1, v110
s_cbranch_vccnz Lpf_456
v_smfmac_f32_16x16x64_bf16 v[44:47], v[36:39], a[64:71], v126
v_smfmac_f32_16x16x64_bf16 v[48:51], v[36:39], a[72:79], v126
v_smfmac_f32_16x16x64_bf16 v[52:55], v[36:39], a[80:87], v126
v_smfmac_f32_16x16x64_bf16 v[60:63], v[36:39], v[192:199], v126
Lps_457:
s_waitcnt vmcnt(2)
v_max3_u32 v110, v40, v41, v42
v_max_u32 v110, v110, v43
v_cmp_eq_u32 vcc, -1, v110
s_cbranch_vccnz Lpf_458
v_smfmac_f32_16x16x64_bf16 v[44:47], v[40:43], a[96:103], v126
v_smfmac_f32_16x16x64_bf16 v[48:51], v[40:43], a[104:111], v126
v_smfmac_f32_16x16x64_bf16 v[52:55], v[40:43], a[112:119], v126
v_smfmac_f32_16x16x64_bf16 v[60:63], v[40:43], v[224:231], v126
Lps_459:
s_waitcnt vmcnt(1)
v_max3_u32 v110, v28, v29, v30
v_max_u32 v110, v110, v31
v_cmp_eq_u32 vcc, -1, v110
s_cbranch_vccnz Lpf_460
v_smfmac_f32_16x16x64_bf16 v[44:47], v[28:31], a[0:7], v126
v_smfmac_f32_16x16x64_bf16 v[48:51], v[28:31], a[8:15], v126
v_smfmac_f32_16x16x64_bf16 v[52:55], v[28:31], a[16:23], v126
v_smfmac_f32_16x16x64_bf16 v[60:63], v[28:31], v[128:135], v126
s_branch Lps_447
Lpf_438:
buffer_load_dwordx4 v[36:39], v8, s[4:7], s40 offen offset:2048 sc1
Lps_461:
s_waitcnt vmcnt(2)
v_max3_u32 v110, v40, v41, v42
v_max_u32 v110, v110, v43
v_cmp_eq_u32 vcc, -1, v110
s_cbranch_vccnz Lpf_462
v_smfmac_f32_16x16x64_bf16 v[44:47], v[40:43], a[96:103], v126
v_smfmac_f32_16x16x64_bf16 v[48:51], v[40:43], a[104:111], v126
v_smfmac_f32_16x16x64_bf16 v[52:55], v[40:43], a[112:119], v126
v_smfmac_f32_16x16x64_bf16 v[60:63], v[40:43], v[224:231], v126
Lps_463:
s_waitcnt vmcnt(1)
v_max3_u32 v110, v28, v29, v30
v_max_u32 v110, v110, v31
v_cmp_eq_u32 vcc, -1, v110
s_cbranch_vccnz Lpf_464
v_smfmac_f32_16x16x64_bf16 v[44:47], v[28:31], a[0:7], v126
v_smfmac_f32_16x16x64_bf16 v[48:51], v[28:31], a[8:15], v126
v_smfmac_f32_16x16x64_bf16 v[52:55], v[28:31], a[16:23], v126
v_smfmac_f32_16x16x64_bf16 v[60:63], v[28:31], v[128:135], v126
s_branch Lps_451
Lpf_440:
buffer_load_dwordx4 v[40:43], v8, s[4:7], s40 offen offset:3072 sc1
Lps_465:
s_waitcnt vmcnt(1)
v_max3_u32 v110, v28, v29, v30
v_max_u32 v110, v110, v31
v_cmp_eq_u32 vcc, -1, v110
s_cbranch_vccnz Lpf_466
v_smfmac_f32_16x16x64_bf16 v[44:47], v[28:31], a[0:7], v126
v_smfmac_f32_16x16x64_bf16 v[48:51], v[28:31], a[8:15], v126
v_smfmac_f32_16x16x64_bf16 v[52:55], v[28:31], a[16:23], v126
v_smfmac_f32_16x16x64_bf16 v[60:63], v[28:31], v[128:135], v126
s_branch Lps_453
Lpf_442:
buffer_load_dwordx4 v[28:31], v8, s[4:7], s40 offen offset:0 sc1
s_sub_u32 s37, s37, 1
s_cbranch_scc1 Lend_1
s_branch Lps_441
Lpf_444:
buffer_load_dwordx4 v[36:39], v8, s[4:7], s40 offen offset:2048 sc1
Lps_467:
s_waitcnt vmcnt(2)
v_max3_u32 v110, v40, v41, v42
v_max_u32 v110, v110, v43
v_cmp_eq_u32 vcc, -1, v110
s_cbranch_vccnz Lpf_468
v_smfmac_f32_16x16x64_bf16 v[44:47], v[40:43], a[96:103], v126
v_smfmac_f32_16x16x64_bf16 v[48:51], v[40:43], a[104:111], v126
v_smfmac_f32_16x16x64_bf16 v[52:55], v[40:43], a[112:119], v126
v_smfmac_f32_16x16x64_bf16 v[60:63], v[40:43], v[224:231], v126
Lps_469:
s_waitcnt vmcnt(1)
v_max3_u32 v110, v32, v33, v34
v_max_u32 v110, v110, v35
v_cmp_eq_u32 vcc, -1, v110
s_cbranch_vccnz Lpf_470
v_smfmac_f32_16x16x64_bf16 v[44:47], v[32:35], a[32:39], v126
v_smfmac_f32_16x16x64_bf16 v[48:51], v[32:35], a[40:47], v126
v_smfmac_f32_16x16x64_bf16 v[52:55], v[32:35], a[48:55], v126
v_smfmac_f32_16x16x64_bf16 v[60:63], v[32:35], v[160:167], v126
s_branch Lps_451
Lpf_446:
buffer_load_dwordx4 v[40:43], v8, s[4:7], s40 offen offset:3072 sc1
Lps_471:
s_waitcnt vmcnt(1)
v_max3_u32 v110, v32, v33, v34
v_max_u32 v110, v110, v35
v_cmp_eq_u32 vcc, -1, v110
s_cbranch_vccnz Lpf_472
v_smfmac_f32_16x16x64_bf16 v[44:47], v[32:35], a[32:39], v126
v_smfmac_f32_16x16x64_bf16 v[48:51], v[32:35], a[40:47], v126
v_smfmac_f32_16x16x64_bf16 v[52:55], v[32:35], a[48:55], v126
v_smfmac_f32_16x16x64_bf16 v[60:63], v[32:35], v[160:167], v126
s_branch Lps_453
Lpf_448:
buffer_load_dwordx4 v[32:35], v8, s[4:7], s40 offen offset:1024 sc1
s_sub_u32 s37, s37, 1
s_cbranch_scc1 Lend_1
s_branch Lps_447
Lpf_450:
buffer_load_dwordx4 v[40:43], v8, s[4:7], s40 offen offset:3072 sc1
Lps_473:
s_waitcnt vmcnt(1)
v_max3_u32 v110, v36, v37, v38
v_max_u32 v110, v110, v39
v_cmp_eq_u32 vcc, -1, v110
s_cbranch_vccnz Lpf_474
v_smfmac_f32_16x16x64_bf16 v[44:47], v[36:39], a[64:71], v126
v_smfmac_f32_16x16x64_bf16 v[48:51], v[36:39], a[72:79], v126
v_smfmac_f32_16x16x64_bf16 v[52:55], v[36:39], a[80:87], v126
v_smfmac_f32_16x16x64_bf16 v[60:63], v[36:39], v[192:199], v126
s_branch Lps_453
Lpf_452:
buffer_load_dwordx4 v[36:39], v8, s[4:7], s40 offen offset:2048 sc1
s_sub_u32 s37, s37, 1
s_cbranch_scc1 Lend_1
s_branch Lps_451
Lpf_454:
buffer_load_dwordx4 v[40:43], v8, s[4:7], s40 offen offset:3072 sc1
s_sub_u32 s37, s37, 1
s_cbranch_scc1 Lend_1
s_branch Lps_453
Lpf_456:
buffer_load_dwordx4 v[36:39], v8, s[4:7], s40 offen offset:2048 sc1
Lps_475:
s_waitcnt vmcnt(3)
v_max3_u32 v110, v40, v41, v42
v_max_u32 v110, v110, v43
v_cmp_eq_u32 vcc, -1, v110
s_cbranch_vccnz Lpf_476
v_smfmac_f32_16x16x64_bf16 v[44:47], v[40:43], a[96:103], v126
v_smfmac_f32_16x16x64_bf16 v[48:51], v[40:43], a[104:111], v126
v_smfmac_f32_16x16x64_bf16 v[52:55], v[40:43], a[112:119], v126
v_smfmac_f32_16x16x64_bf16 v[60:63], v[40:43], v[224:231], v126
Lps_477:
s_waitcnt vmcnt(2)
v_max3_u32 v110, v28, v29, v30
v_max_u32 v110, v110, v31
v_cmp_eq_u32 vcc, -1, v110
s_cbranch_vccnz Lpf_478
v_smfmac_f32_16x16x64_bf16 v[44:47], v[28:31], a[0:7], v126
v_smfmac_f32_16x16x64_bf16 v[48:51], v[28:31], a[8:15], v126
v_smfmac_f32_16x16x64_bf16 v[52:55], v[28:31], a[16:23], v126
v_smfmac_f32_16x16x64_bf16 v[60:63], v[28:31], v[128:135], v126
s_branch Lps_469
Lpf_458:
buffer_load_dwordx4 v[40:43], v8, s[4:7], s40 offen offset:3072 sc1
Lps_479:
s_waitcnt vmcnt(2)
v_max3_u32 v110, v28, v29, v30
v_max_u32 v110, v110, v31
v_cmp_eq_u32 vcc, -1, v110
s_cbranch_vccnz Lpf_480
v_smfmac_f32_16x16x64_bf16 v[44:47], v[28:31], a[0:7], v126
v_smfmac_f32_16x16x64_bf16 v[48:51], v[28:31], a[8:15], v126
v_smfmac_f32_16x16x64_bf16 v[52:55], v[28:31], a[16:23], v126
v_smfmac_f32_16x16x64_bf16 v[60:63], v[28:31], v[128:135], v126
s_branch Lps_471
Lpf_460:
buffer_load_dwordx4 v[28:31], v8, s[4:7], s40 offen offset:0 sc1
s_sub_u32 s37, s37, 1
s_cbranch_scc1 Lend_1
Lps_481:
s_waitcnt vmcnt(1)
v_max3_u32 v110, v32, v33, v34
v_max_u32 v110, v110, v35
v_cmp_eq_u32 vcc, -1, v110
s_cbranch_vccnz Lpf_482
v_smfmac_f32_16x16x64_bf16 v[44:47], v[32:35], a[32:39], v126
v_smfmac_f32_16x16x64_bf16 v[48:51], v[32:35], a[40:47], v126
v_smfmac_f32_16x16x64_bf16 v[52:55], v[32:35], a[48:55], v126
v_smfmac_f32_16x16x64_bf16 v[60:63], v[32:35], v[160:167], v126
s_branch Lps_441
Lpf_462:
buffer_load_dwordx4 v[40:43], v8, s[4:7], s40 offen offset:3072 sc1
Lps_483:
s_waitcnt vmcnt(2)
v_max3_u32 v110, v28, v29, v30
v_max_u32 v110, v110, v31
v_cmp_eq_u32 vcc, -1, v110
s_cbranch_vccnz Lpf_484
v_smfmac_f32_16x16x64_bf16 v[44:47], v[28:31], a[0:7], v126
v_smfmac_f32_16x16x64_bf16 v[48:51], v[28:31], a[8:15], v126
v_smfmac_f32_16x16x64_bf16 v[52:55], v[28:31], a[16:23], v126
v_smfmac_f32_16x16x64_bf16 v[60:63], v[28:31], v[128:135], v126
s_branch Lps_473
Lpf_464:
buffer_load_dwordx4 v[28:31], v8, s[4:7], s40 offen offset:0 sc1
s_sub_u32 s37, s37, 1
s_cbranch_scc1 Lend_1
Lps_485:
s_waitcnt vmcnt(1)
v_max3_u32 v110, v36, v37, v38
v_max_u32 v110, v110, v39
v_cmp_eq_u32 vcc, -1, v110
s_cbranch_vccnz Lpf_486
v_smfmac_f32_16x16x64_bf16 v[44:47], v[36:39], a[64:71], v126
v_smfmac_f32_16x16x64_bf16 v[48:51], v[36:39], a[72:79], v126
v_smfmac_f32_16x16x64_bf16 v[52:55], v[36:39], a[80:87], v126
v_smfmac_f32_16x16x64_bf16 v[60:63], v[36:39], v[192:199], v126
s_branch Lps_441
Lpf_466:
buffer_load_dwordx4 v[28:31], v8, s[4:7], s40 offen offset:0 sc1
s_sub_u32 s37, s37, 1
s_cbranch_scc1 Lend_1
s_branch Lps_439
Lpf_468:
buffer_load_dwordx4 v[40:43], v8, s[4:7], s40 offen offset:3072 sc1
Lps_487:
s_waitcnt vmcnt(2)
v_max3_u32 v110, v32, v33, v34
v_max_u32 v110, v110, v35
v_cmp_eq_u32 vcc, -1, v110
s_cbranch_vccnz Lpf_488
v_smfmac_f32_16x16x64_bf16 v[44:47], v[32:35], a[32:39], v126
v_smfmac_f32_16x16x64_bf16 v[48:51], v[32:35], a[40:47], v126
v_smfmac_f32_16x16x64_bf16 v[52:55], v[32:35], a[48:55], v126
v_smfmac_f32_16x16x64_bf16 v[60:63], v[32:35], v[160:167], v126
s_branch Lps_473
Lpf_470:
buffer_load_dwordx4 v[32:35], v8, s[4:7], s40 offen offset:1024 sc1
s_sub_u32 s37, s37, 1
s_cbranch_scc1 Lend_1
Lps_489:
s_waitcnt vmcnt(1)
v_max3_u32 v110, v36, v37, v38
v_max_u32 v110, v110, v39
v_cmp_eq_u32 vcc, -1, v110
s_cbranch_vccnz Lpf_490
v_smfmac_f32_16x16x64_bf16 v[44:47], v[36:39], a[64:71], v126
v_smfmac_f32_16x16x64_bf16 v[48:51], v[36:39], a[72:79], v126
v_smfmac_f32_16x16x64_bf16 v[52:55], v[36:39], a[80:87], v126
v_smfmac_f32_16x16x64_bf16 v[60:63], v[36:39], v[192:199], v126
s_branch Lps_447
Lpf_472:
buffer_load_dwordx4 v[32:35], v8, s[4:7], s40 offen offset:1024 sc1
s_sub_u32 s37, s37, 1
s_cbranch_scc1 Lend_1
s_branch Lps_445
Lpf_474:
buffer_load_dwordx4 v[36:39], v8, s[4:7], s40 offen offset:2048 sc1
s_sub_u32 s37, s37, 1
s_cbranch_scc1 Lend_1
s_branch Lps_449
Lpf_476:
buffer_load_dwordx4 v[40:43], v8, s[4:7], s40 offen offset:3072 sc1
Lps_491:
s_waitcnt vmcnt(3)
v_max3_u32 v110, v28, v29, v30
v_max_u32 v110, v110, v31
v_cmp_eq_u32 vcc, -1, v110
s_cbranch_vccnz Lpf_492
v_smfmac_f32_16x16x64_bf16 v[44:47], v[28:31], a[0:7], v126
v_smfmac_f32_16x16x64_bf16 v[48:51], v[28:31], a[8:15], v126
v_smfmac_f32_16x16x64_bf16 v[52:55], v[28:31], a[16:23], v126
v_smfmac_f32_16x16x64_bf16 v[60:63], v[28:31], v[128:135], v126
s_branch Lps_487
Lpf_478:
buffer_load_dwordx4 v[28:31], v8, s[4:7], s40 offen offset:0 sc1
s_sub_u32 s37, s37, 1
s_cbranch_scc1 Lend_1
Lps_493:
s_waitcnt vmcnt(2)
v_max3_u32 v110, v32, v33, v34
v_max_u32 v110, v110, v35
v_cmp_eq_u32 vcc, -1, v110
s_cbranch_vccnz Lpf_494
v_smfmac_f32_16x16x64_bf16 v[44:47], v[32:35], a[32:39], v126
v_smfmac_f32_16x16x64_bf16 v[48:51], v[32:35], a[40:47], v126
v_smfmac_f32_16x16x64_bf16 v[52:55], v[32:35], a[48:55], v126
v_smfmac_f32_16x16x64_bf16 v[60:63], v[32:35], v[160:167], v126
s_branch Lps_485
Lpf_480:
buffer_load_dwordx4 v[28:31], v8, s[4:7], s40 offen offset:0 sc1
s_sub_u32 s37, s37, 1
s_cbranch_scc1 Lend_1
Lps_495:
s_waitcnt vmcnt(2)
v_max3_u32 v110, v32, v33, v34
v_max_u32 v110, v110, v35
v_cmp_eq_u32 vcc, -1, v110
s_cbranch_vccnz Lpf_496
v_smfmac_f32_16x16x64_bf16 v[44:47], v[32:35], a[32:39], v126
v_smfmac_f32_16x16x64_bf16 v[48:51], v[32:35], a[40:47], v126
v_smfmac_f32_16x16x64_bf16 v[52:55], v[32:35], a[48:55], v126
v_smfmac_f32_16x16x64_bf16 v[60:63], v[32:35], v[160:167], v126
s_branch Lps_439
Lpf_482:
buffer_load_dwordx4 v[32:35], v8, s[4:7], s40 offen offset:1024 sc1
s_branch Lps_459
Lpf_484:
buffer_load_dwordx4 v[28:31], v8, s[4:7], s40 offen offset:0 sc1
s_sub_u32 s37, s37, 1
s_cbranch_scc1 Lend_1
s_branch Lps_437
Lpf_486:
buffer_load_dwordx4 v[36:39], v8, s[4:7], s40 offen offset:2048 sc1
s_branch Lps_463
Lpf_488:
buffer_load_dwordx4 v[32:35], v8, s[4:7], s40 offen offset:1024 sc1
s_sub_u32 s37, s37, 1
s_cbranch_scc1 Lend_1
s_branch Lps_443
Lpf_490:
buffer_load_dwordx4 v[36:39], v8, s[4:7], s40 offen offset:2048 sc1
s_branch Lps_469
Lpf_492:
buffer_load_dwordx4 v[28:31], v8, s[4:7], s40 offen offset:0 sc1
s_sub_u32 s37, s37, 1
s_cbranch_scc1 Lend_1
s_branch Lps_435
Lpf_494:
buffer_load_dwordx4 v[32:35], v8, s[4:7], s40 offen offset:1024 sc1
Lps_497:
s_waitcnt vmcnt(2)
v_max3_u32 v110, v36, v37, v38
v_max_u32 v110, v110, v39
v_cmp_eq_u32 vcc, -1, v110
s_cbranch_vccnz Lpf_498
v_smfmac_f32_16x16x64_bf16 v[44:47], v[36:39], a[64:71], v126
v_smfmac_f32_16x16x64_bf16 v[48:51], v[36:39], a[72:79], v126
v_smfmac_f32_16x16x64_bf16 v[52:55], v[36:39], a[80:87], v126
v_smfmac_f32_16x16x64_bf16 v[60:63], v[36:39], v[192:199], v126
s_branch Lps_459
Lpf_496:
buffer_load_dwordx4 v[32:35], v8, s[4:7], s40 offen offset:1024 sc1
s_branch Lps_457
Lpf_498:
buffer_load_dwordx4 v[36:39], v8, s[4:7], s40 offen offset:2048 sc1
s_branch Lps_477
Lpf_429:
buffer_load_dwordx4 v[28:31], v9, s[4:7], s40 offen offset:0 sc1
s_sub_u32 s37, s37, 1
s_cbranch_scc1 Lend_1
Lps_499:
s_waitcnt vmcnt(3)
v_max3_u32 v110, v32, v33, v34
v_max_u32 v110, v110, v35
v_cmp_eq_u32 vcc, -1, v110
s_cbranch_vccnz Lpf_500
v_smfmac_f32_16x16x64_bf16 v[76:79], v[32:35], a[160:167], v126
v_smfmac_f32_16x16x64_bf16 v[80:83], v[32:35], a[168:175], v126
v_smfmac_f32_16x16x64_bf16 v[84:87], v[32:35], a[176:183], v126
Lps_501:
s_waitcnt vmcnt(2)
v_max3_u32 v110, v36, v37, v38
v_max_u32 v110, v110, v39
v_cmp_eq_u32 vcc, -1, v110
s_cbranch_vccnz Lpf_502
v_smfmac_f32_16x16x64_bf16 v[76:79], v[36:39], a[192:199], v126
v_smfmac_f32_16x16x64_bf16 v[80:83], v[36:39], a[200:207], v126
v_smfmac_f32_16x16x64_bf16 v[84:87], v[36:39], a[208:215], v126
Lps_503:
s_waitcnt vmcnt(1)
v_max3_u32 v110, v40, v41, v42
v_max_u32 v110, v110, v43
v_cmp_eq_u32 vcc, -1, v110
s_cbranch_vccnz Lpf_504
v_smfmac_f32_16x16x64_bf16 v[76:79], v[40:43], a[224:231], v126
v_smfmac_f32_16x16x64_bf16 v[80:83], v[40:43], a[232:239], v126
v_smfmac_f32_16x16x64_bf16 v[84:87], v[40:43], a[240:247], v126
Lps_505:
s_waitcnt vmcnt(0)
v_max3_u32 v110, v28, v29, v30
v_max_u32 v110, v110, v31
v_cmp_eq_u32 vcc, -1, v110
s_cbranch_vccnz Lpf_506
v_smfmac_f32_16x16x64_bf16 v[76:79], v[28:31], a[128:135], v126
s_nop 1
v_smfmac_f32_16x16x64_bf16 v[80:83], v[28:31], a[136:143], v126
s_nop 1
v_smfmac_f32_16x16x64_bf16 v[84:87], v[28:31], a[144:151], v126
s_nop 1
v_add_f32 v92, v76, v78
v_add_f32 v93, v77, v79
v_smfmac_f32_16x16x64_bf16 v[88:91], v[28:31], a[152:159], v126
v_add_f32 v94, v80, v82
v_add_f32 v95, v81, v83
ds_write_b64 v24, v[92:93] offset:12288
v_add_f32 v96, v84, v86
v_add_f32 v97, v85, v87
ds_write_b64 v25, v[94:95] offset:12288
v_smfmac_f32_16x16x64_bf16 v[88:91], v[32:35], a[184:191], v126
ds_write_b64 v26, v[96:97] offset:12288
v_smfmac_f32_16x16x64_bf16 v[88:91], v[36:39], a[216:223], v126
v_smfmac_f32_16x16x64_bf16 v[88:91], v[40:43], a[248:255], v126
s_branch Lpd_428
Lpf_430:
buffer_load_dwordx4 v[32:35], v9, s[4:7], s40 offen offset:1024 sc1
s_sub_u32 s37, s37, 1
s_cbranch_scc1 Lend_1
Lps_507:
s_waitcnt vmcnt(2)
v_max3_u32 v110, v36, v37, v38
v_max_u32 v110, v110, v39
v_cmp_eq_u32 vcc, -1, v110
s_cbranch_vccnz Lpf_508
v_smfmac_f32_16x16x64_bf16 v[76:79], v[36:39], a[192:199], v126
v_smfmac_f32_16x16x64_bf16 v[80:83], v[36:39], a[200:207], v126
v_smfmac_f32_16x16x64_bf16 v[84:87], v[36:39], a[208:215], v126
Lps_509:
s_waitcnt vmcnt(1)
v_max3_u32 v110, v40, v41, v42
v_max_u32 v110, v110, v43
v_cmp_eq_u32 vcc, -1, v110
s_cbranch_vccnz Lpf_510
v_smfmac_f32_16x16x64_bf16 v[76:79], v[40:43], a[224:231], v126
v_smfmac_f32_16x16x64_bf16 v[80:83], v[40:43], a[232:239], v126
v_smfmac_f32_16x16x64_bf16 v[84:87], v[40:43], a[240:247], v126
Lps_511:
s_waitcnt vmcnt(0)
v_max3_u32 v110, v32, v33, v34
v_max_u32 v110, v110, v35
v_cmp_eq_u32 vcc, -1, v110
s_cbranch_vccnz Lpf_512
v_smfmac_f32_16x16x64_bf16 v[76:79], v[32:35], a[160:167], v126
s_nop 1
v_smfmac_f32_16x16x64_bf16 v[80:83], v[32:35], a[168:175], v126
s_nop 1
v_smfmac_f32_16x16x64_bf16 v[84:87], v[32:35], a[176:183], v126
s_nop 1
v_add_f32 v92, v76, v78
v_add_f32 v93, v77, v79
v_smfmac_f32_16x16x64_bf16 v[88:91], v[28:31], a[152:159], v126
v_add_f32 v94, v80, v82
v_add_f32 v95, v81, v83
ds_write_b64 v24, v[92:93] offset:12288
v_add_f32 v96, v84, v86
v_add_f32 v97, v85, v87
ds_write_b64 v25, v[94:95] offset:12288
v_smfmac_f32_16x16x64_bf16 v[88:91], v[32:35], a[184:191], v126
ds_write_b64 v26, v[96:97] offset:12288
v_smfmac_f32_16x16x64_bf16 v[88:91], v[36:39], a[216:223], v126
v_smfmac_f32_16x16x64_bf16 v[88:91], v[40:43], a[248:255], v126
s_branch Lpd_428
Lpf_431:
buffer_load_dwordx4 v[36:39], v9, s[4:7], s40 offen offset:2048 sc1
s_sub_u32 s37, s37, 1
s_cbranch_scc1 Lend_1
Lps_513:
s_waitcnt vmcnt(1)
v_max3_u32 v110, v40, v41, v42
v_max_u32 v110, v110, v43
v_cmp_eq_u32 vcc, -1, v110
s_cbranch_vccnz Lpf_514
v_smfmac_f32_16x16x64_bf16 v[76:79], v[40:43], a[224:231], v126
v_smfmac_f32_16x16x64_bf16 v[80:83], v[40:43], a[232:239], v126
v_smfmac_f32_16x16x64_bf16 v[84:87], v[40:43], a[240:247], v126
Lps_515:
s_waitcnt vmcnt(0)
v_max3_u32 v110, v36, v37, v38
v_max_u32 v110, v110, v39
v_cmp_eq_u32 vcc, -1, v110
s_cbranch_vccnz Lpf_516
v_smfmac_f32_16x16x64_bf16 v[76:79], v[36:39], a[192:199], v126
s_nop 1
v_smfmac_f32_16x16x64_bf16 v[80:83], v[36:39], a[200:207], v126
s_nop 1
v_smfmac_f32_16x16x64_bf16 v[84:87], v[36:39], a[208:215], v126
s_nop 1
v_add_f32 v92, v76, v78
v_add_f32 v93, v77, v79
v_smfmac_f32_16x16x64_bf16 v[88:91], v[28:31], a[152:159], v126
v_add_f32 v94, v80, v82
v_add_f32 v95, v81, v83
ds_write_b64 v24, v[92:93] offset:12288
v_add_f32 v96, v84, v86
v_add_f32 v97, v85, v87
ds_write_b64 v25, v[94:95] offset:12288
v_smfmac_f32_16x16x64_bf16 v[88:91], v[32:35], a[184:191], v126
ds_write_b64 v26, v[96:97] offset:12288
v_smfmac_f32_16x16x64_bf16 v[88:91], v[36:39], a[216:223], v126
v_smfmac_f32_16x16x64_bf16 v[88:91], v[40:43], a[248:255], v126
s_branch Lpd_428
Lpf_432:
buffer_load_dwordx4 v[40:43], v9, s[4:7], s40 offen offset:3072 sc1
s_sub_u32 s37, s37, 1
s_cbranch_scc1 Lend_1
Lps_517:
s_waitcnt vmcnt(0)
v_max3_u32 v110, v40, v41, v42
v_max_u32 v110, v110, v43
v_cmp_eq_u32 vcc, -1, v110
s_cbranch_vccnz Lpf_518
v_smfmac_f32_16x16x64_bf16 v[76:79], v[40:43], a[224:231], v126
s_nop 1
v_smfmac_f32_16x16x64_bf16 v[80:83], v[40:43], a[232:239], v126
s_nop 1
v_smfmac_f32_16x16x64_bf16 v[84:87], v[40:43], a[240:247], v126
s_nop 1
v_add_f32 v92, v76, v78
v_add_f32 v93, v77, v79
v_smfmac_f32_16x16x64_bf16 v[88:91], v[28:31], a[152:159], v126
v_add_f32 v94, v80, v82
v_add_f32 v95, v81, v83
ds_write_b64 v24, v[92:93] offset:12288
v_add_f32 v96, v84, v86
v_add_f32 v97, v85, v87
ds_write_b64 v25, v[94:95] offset:12288
v_smfmac_f32_16x16x64_bf16 v[88:91], v[32:35], a[184:191], v126
ds_write_b64 v26, v[96:97] offset:12288
v_smfmac_f32_16x16x64_bf16 v[88:91], v[36:39], a[216:223], v126
v_smfmac_f32_16x16x64_bf16 v[88:91], v[40:43], a[248:255], v126
s_branch Lpd_428
Lpf_500:
buffer_load_dwordx4 v[32:35], v9, s[4:7], s40 offen offset:1024 sc1
Lps_519:
s_waitcnt vmcnt(3)
v_max3_u32 v110, v36, v37, v38
v_max_u32 v110, v110, v39
v_cmp_eq_u32 vcc, -1, v110
s_cbranch_vccnz Lpf_520
v_smfmac_f32_16x16x64_bf16 v[76:79], v[36:39], a[192:199], v126
v_smfmac_f32_16x16x64_bf16 v[80:83], v[36:39], a[200:207], v126
v_smfmac_f32_16x16x64_bf16 v[84:87], v[36:39], a[208:215], v126
Lps_521:
s_waitcnt vmcnt(2)
v_max3_u32 v110, v40, v41, v42
v_max_u32 v110, v110, v43
v_cmp_eq_u32 vcc, -1, v110
s_cbranch_vccnz Lpf_522
v_smfmac_f32_16x16x64_bf16 v[76:79], v[40:43], a[224:231], v126
v_smfmac_f32_16x16x64_bf16 v[80:83], v[40:43], a[232:239], v126
v_smfmac_f32_16x16x64_bf16 v[84:87], v[40:43], a[240:247], v126
Lps_523:
s_waitcnt vmcnt(1)
v_max3_u32 v110, v28, v29, v30
v_max_u32 v110, v110, v31
v_cmp_eq_u32 vcc, -1, v110
s_cbranch_vccnz Lpf_524
v_smfmac_f32_16x16x64_bf16 v[76:79], v[28:31], a[128:135], v126
v_smfmac_f32_16x16x64_bf16 v[80:83], v[28:31], a[136:143], v126
v_smfmac_f32_16x16x64_bf16 v[84:87], v[28:31], a[144:151], v126
s_branch Lps_511
Lpf_502:
buffer_load_dwordx4 v[36:39], v9, s[4:7], s40 offen offset:2048 sc1
Lps_525:
s_waitcnt vmcnt(2)
v_max3_u32 v110, v40, v41, v42
v_max_u32 v110, v110, v43
v_cmp_eq_u32 vcc, -1, v110
s_cbranch_vccnz Lpf_526
v_smfmac_f32_16x16x64_bf16 v[76:79], v[40:43], a[224:231], v126
v_smfmac_f32_16x16x64_bf16 v[80:83], v[40:43], a[232:239], v126
v_smfmac_f32_16x16x64_bf16 v[84:87], v[40:43], a[240:247], v126
Lps_527:
s_waitcnt vmcnt(1)
v_max3_u32 v110, v28, v29, v30
v_max_u32 v110, v110, v31
v_cmp_eq_u32 vcc, -1, v110
s_cbranch_vccnz Lpf_528
v_smfmac_f32_16x16x64_bf16 v[76:79], v[28:31], a[128:135], v126
v_smfmac_f32_16x16x64_bf16 v[80:83], v[28:31], a[136:143], v126
v_smfmac_f32_16x16x64_bf16 v[84:87], v[28:31], a[144:151], v126
s_branch Lps_515
Lpf_504:
buffer_load_dwordx4 v[40:43], v9, s[4:7], s40 offen offset:3072 sc1
Lps_529:
s_waitcnt vmcnt(1)
v_max3_u32 v110, v28, v29, v30
v_max_u32 v110, v110, v31
v_cmp_eq_u32 vcc, -1, v110
s_cbranch_vccnz Lpf_530
v_smfmac_f32_16x16x64_bf16 v[76:79], v[28:31], a[128:135], v126
v_smfmac_f32_16x16x64_bf16 v[80:83], v[28:31], a[136:143], v126
v_smfmac_f32_16x16x64_bf16 v[84:87], v[28:31], a[144:151], v126
s_branch Lps_517
Lpf_506:
buffer_load_dwordx4 v[28:31], v9, s[4:7], s40 offen offset:0 sc1
s_sub_u32 s37, s37, 1
s_cbranch_scc1 Lend_1
s_branch Lps_505
Lpf_508:
buffer_load_dwordx4 v[36:39], v9, s[4:7], s40 offen offset:2048 sc1
Lps_531:
s_waitcnt vmcnt(2)
v_max3_u32 v110, v40, v41, v42
v_max_u32 v110, v110, v43
v_cmp_eq_u32 vcc, -1, v110
s_cbranch_vccnz Lpf_532
v_smfmac_f32_16x16x64_bf16 v[76:79], v[40:43], a[224:231], v126
v_smfmac_f32_16x16x64_bf16 v[80:83], v[40:43], a[232:239], v126
v_smfmac_f32_16x16x64_bf16 v[84:87], v[40:43], a[240:247], v126
Lps_533:
s_waitcnt vmcnt(1)
v_max3_u32 v110, v32, v33, v34
v_max_u32 v110, v110, v35
v_cmp_eq_u32 vcc, -1, v110
s_cbranch_vccnz Lpf_534
v_smfmac_f32_16x16x64_bf16 v[76:79], v[32:35], a[160:167], v126
v_smfmac_f32_16x16x64_bf16 v[80:83], v[32:35], a[168:175], v126
v_smfmac_f32_16x16x64_bf16 v[84:87], v[32:35], a[176:183], v126
s_branch Lps_515
Lpf_510:
buffer_load_dwordx4 v[40:43], v9, s[4:7], s40 offen offset:3072 sc1
Lps_535:
s_waitcnt vmcnt(1)
v_max3_u32 v110, v32, v33, v34
v_max_u32 v110, v110, v35
v_cmp_eq_u32 vcc, -1, v110
s_cbranch_vccnz Lpf_536
v_smfmac_f32_16x16x64_bf16 v[76:79], v[32:35], a[160:167], v126
v_smfmac_f32_16x16x64_bf16 v[80:83], v[32:35], a[168:175], v126
v_smfmac_f32_16x16x64_bf16 v[84:87], v[32:35], a[176:183], v126
s_branch Lps_517
Lpf_512:
buffer_load_dwordx4 v[32:35], v9, s[4:7], s40 offen offset:1024 sc1
s_sub_u32 s37, s37, 1
s_cbranch_scc1 Lend_1
s_branch Lps_511
Lpf_514:
buffer_load_dwordx4 v[40:43], v9, s[4:7], s40 offen offset:3072 sc1
Lps_537:
s_waitcnt vmcnt(1)
v_max3_u32 v110, v36, v37, v38
v_max_u32 v110, v110, v39
v_cmp_eq_u32 vcc, -1, v110
s_cbranch_vccnz Lpf_538
v_smfmac_f32_16x16x64_bf16 v[76:79], v[36:39], a[192:199], v126
v_smfmac_f32_16x16x64_bf16 v[80:83], v[36:39], a[200:207], v126
v_smfmac_f32_16x16x64_bf16 v[84:87], v[36:39], a[208:215], v126
s_branch Lps_517
Lpf_516:
buffer_load_dwordx4 v[36:39], v9, s[4:7], s40 offen offset:2048 sc1
s_sub_u32 s37, s37, 1
s_cbranch_scc1 Lend_1
s_branch Lps_515
Lpf_518:
buffer_load_dwordx4 v[40:43], v9, s[4:7], s40 offen offset:3072 sc1
s_sub_u32 s37, s37, 1
s_cbranch_scc1 Lend_1
s_branch Lps_517
Lpf_520:
buffer_load_dwordx4 v[36:39], v9, s[4:7], s40 offen offset:2048 sc1
Lps_539:
s_waitcnt vmcnt(3)
v_max3_u32 v110, v40, v41, v42
v_max_u32 v110, v110, v43
v_cmp_eq_u32 vcc, -1, v110
s_cbranch_vccnz Lpf_540
v_smfmac_f32_16x16x64_bf16 v[76:79], v[40:43], a[224:231], v126
v_smfmac_f32_16x16x64_bf16 v[80:83], v[40:43], a[232:239], v126
v_smfmac_f32_16x16x64_bf16 v[84:87], v[40:43], a[240:247], v126
Lps_541:
s_waitcnt vmcnt(2)
v_max3_u32 v110, v28, v29, v30
v_max_u32 v110, v110, v31
v_cmp_eq_u32 vcc, -1, v110
s_cbranch_vccnz Lpf_542
v_smfmac_f32_16x16x64_bf16 v[76:79], v[28:31], a[128:135], v126
v_smfmac_f32_16x16x64_bf16 v[80:83], v[28:31], a[136:143], v126
v_smfmac_f32_16x16x64_bf16 v[84:87], v[28:31], a[144:151], v126
s_branch Lps_533
Lpf_522:
buffer_load_dwordx4 v[40:43], v9, s[4:7], s40 offen offset:3072 sc1
Lps_543:
s_waitcnt vmcnt(2)
v_max3_u32 v110, v28, v29, v30
v_max_u32 v110, v110, v31
v_cmp_eq_u32 vcc, -1, v110
s_cbranch_vccnz Lpf_544
v_smfmac_f32_16x16x64_bf16 v[76:79], v[28:31], a[128:135], v126
v_smfmac_f32_16x16x64_bf16 v[80:83], v[28:31], a[136:143], v126
v_smfmac_f32_16x16x64_bf16 v[84:87], v[28:31], a[144:151], v126
s_branch Lps_535
Lpf_524:
buffer_load_dwordx4 v[28:31], v9, s[4:7], s40 offen offset:0 sc1
s_sub_u32 s37, s37, 1
s_cbranch_scc1 Lend_1
Lps_545:
s_waitcnt vmcnt(1)
v_max3_u32 v110, v32, v33, v34
v_max_u32 v110, v110, v35
v_cmp_eq_u32 vcc, -1, v110
s_cbranch_vccnz Lpf_546
v_smfmac_f32_16x16x64_bf16 v[76:79], v[32:35], a[160:167], v126
v_smfmac_f32_16x16x64_bf16 v[80:83], v[32:35], a[168:175], v126
v_smfmac_f32_16x16x64_bf16 v[84:87], v[32:35], a[176:183], v126
s_branch Lps_505
Lpf_526:
buffer_load_dwordx4 v[40:43], v9, s[4:7], s40 offen offset:3072 sc1
Lps_547:
s_waitcnt vmcnt(2)
v_max3_u32 v110, v28, v29, v30
v_max_u32 v110, v110, v31
v_cmp_eq_u32 vcc, -1, v110
s_cbranch_vccnz Lpf_548
v_smfmac_f32_16x16x64_bf16 v[76:79], v[28:31], a[128:135], v126
v_smfmac_f32_16x16x64_bf16 v[80:83], v[28:31], a[136:143], v126
v_smfmac_f32_16x16x64_bf16 v[84:87], v[28:31], a[144:151], v126
s_branch Lps_537
Lpf_528:
buffer_load_dwordx4 v[28:31], v9, s[4:7], s40 offen offset:0 sc1
s_sub_u32 s37, s37, 1
s_cbranch_scc1 Lend_1
Lps_549:
s_waitcnt vmcnt(1)
v_max3_u32 v110, v36, v37, v38
v_max_u32 v110, v110, v39
v_cmp_eq_u32 vcc, -1, v110
s_cbranch_vccnz Lpf_550
v_smfmac_f32_16x16x64_bf16 v[76:79], v[36:39], a[192:199], v126
v_smfmac_f32_16x16x64_bf16 v[80:83], v[36:39], a[200:207], v126
v_smfmac_f32_16x16x64_bf16 v[84:87], v[36:39], a[208:215], v126
s_branch Lps_505
Lpf_530:
buffer_load_dwordx4 v[28:31], v9, s[4:7], s40 offen offset:0 sc1
s_sub_u32 s37, s37, 1
s_cbranch_scc1 Lend_1
s_branch Lps_503
Lpf_532:
buffer_load_dwordx4 v[40:43], v9, s[4:7], s40 offen offset:3072 sc1
Lps_551:
s_waitcnt vmcnt(2)
v_max3_u32 v110, v32, v33, v34
v_max_u32 v110, v110, v35
v_cmp_eq_u32 vcc, -1, v110
s_cbranch_vccnz Lpf_552
v_smfmac_f32_16x16x64_bf16 v[76:79], v[32:35], a[160:167], v126
v_smfmac_f32_16x16x64_bf16 v[80:83], v[32:35], a[168:175], v126
v_smfmac_f32_16x16x64_bf16 v[84:87], v[32:35], a[176:183], v126
s_branch Lps_537
Lpf_534:
buffer_load_dwordx4 v[32:35], v9, s[4:7], s40 offen offset:1024 sc1
s_sub_u32 s37, s37, 1
s_cbranch_scc1 Lend_1
Lps_553:
s_waitcnt vmcnt(1)
v_max3_u32 v110, v36, v37, v38
v_max_u32 v110, v110, v39
v_cmp_eq_u32 vcc, -1, v110
s_cbranch_vccnz Lpf_554
v_smfmac_f32_16x16x64_bf16 v[76:79], v[36:39], a[192:199], v126
v_smfmac_f32_16x16x64_bf16 v[80:83], v[36:39], a[200:207], v126
v_smfmac_f32_16x16x64_bf16 v[84:87], v[36:39], a[208:215], v126
s_branch Lps_511
Lpf_536:
buffer_load_dwordx4 v[32:35], v9, s[4:7], s40 offen offset:1024 sc1
s_sub_u32 s37, s37, 1
s_cbranch_scc1 Lend_1
s_branch Lps_509
Lpf_538:
buffer_load_dwordx4 v[36:39], v9, s[4:7], s40 offen offset:2048 sc1
s_sub_u32 s37, s37, 1
s_cbranch_scc1 Lend_1
s_branch Lps_513
Lpf_540:
buffer_load_dwordx4 v[40:43], v9, s[4:7], s40 offen offset:3072 sc1
Lps_555:
s_waitcnt vmcnt(3)
v_max3_u32 v110, v28, v29, v30
v_max_u32 v110, v110, v31
v_cmp_eq_u32 vcc, -1, v110
s_cbranch_vccnz Lpf_556
v_smfmac_f32_16x16x64_bf16 v[76:79], v[28:31], a[128:135], v126
v_smfmac_f32_16x16x64_bf16 v[80:83], v[28:31], a[136:143], v126
v_smfmac_f32_16x16x64_bf16 v[84:87], v[28:31], a[144:151], v126
s_branch Lps_551
Lpf_542:
buffer_load_dwordx4 v[28:31], v9, s[4:7], s40 offen offset:0 sc1
s_sub_u32 s37, s37, 1
s_cbranch_scc1 Lend_1
Lps_557:
s_waitcnt vmcnt(2)
v_max3_u32 v110, v32, v33, v34
v_max_u32 v110, v110, v35
v_cmp_eq_u32 vcc, -1, v110
s_cbranch_vccnz Lpf_558
v_smfmac_f32_16x16x64_bf16 v[76:79], v[32:35], a[160:167], v126
v_smfmac_f32_16x16x64_bf16 v[80:83], v[32:35], a[168:175], v126
v_smfmac_f32_16x16x64_bf16 v[84:87], v[32:35], a[176:183], v126
s_branch Lps_549
Lpf_544:
buffer_load_dwordx4 v[28:31], v9, s[4:7], s40 offen offset:0 sc1
s_sub_u32 s37, s37, 1
s_cbranch_scc1 Lend_1
Lps_559:
s_waitcnt vmcnt(2)
v_max3_u32 v110, v32, v33, v34
v_max_u32 v110, v110, v35
v_cmp_eq_u32 vcc, -1, v110
s_cbranch_vccnz Lpf_560
v_smfmac_f32_16x16x64_bf16 v[76:79], v[32:35], a[160:167], v126
v_smfmac_f32_16x16x64_bf16 v[80:83], v[32:35], a[168:175], v126
v_smfmac_f32_16x16x64_bf16 v[84:87], v[32:35], a[176:183], v126
s_branch Lps_503
Lpf_546:
buffer_load_dwordx4 v[32:35], v9, s[4:7], s40 offen offset:1024 sc1
s_branch Lps_523
Lpf_548:
buffer_load_dwordx4 v[28:31], v9, s[4:7], s40 offen offset:0 sc1
s_sub_u32 s37, s37, 1
s_cbranch_scc1 Lend_1
s_branch Lps_501
Lpf_550:
buffer_load_dwordx4 v[36:39], v9, s[4:7], s40 offen offset:2048 sc1
s_branch Lps_527
Lpf_552:
buffer_load_dwordx4 v[32:35], v9, s[4:7], s40 offen offset:1024 sc1
s_sub_u32 s37, s37, 1
s_cbranch_scc1 Lend_1
s_branch Lps_507
Lpf_554:
buffer_load_dwordx4 v[36:39], v9, s[4:7], s40 offen offset:2048 sc1
s_branch Lps_533
Lpf_556:
buffer_load_dwordx4 v[28:31], v9, s[4:7], s40 offen offset:0 sc1
s_sub_u32 s37, s37, 1
s_cbranch_scc1 Lend_1
s_branch Lps_499
Lpf_558:
buffer_load_dwordx4 v[32:35], v9, s[4:7], s40 offen offset:1024 sc1
Lps_561:
s_waitcnt vmcnt(2)
v_max3_u32 v110, v36, v37, v38
v_max_u32 v110, v110, v39
v_cmp_eq_u32 vcc, -1, v110
s_cbranch_vccnz Lpf_562
v_smfmac_f32_16x16x64_bf16 v[76:79], v[36:39], a[192:199], v126
v_smfmac_f32_16x16x64_bf16 v[80:83], v[36:39], a[200:207], v126
v_smfmac_f32_16x16x64_bf16 v[84:87], v[36:39], a[208:215], v126
s_branch Lps_523
Lpf_560:
buffer_load_dwordx4 v[32:35], v9, s[4:7], s40 offen offset:1024 sc1
s_branch Lps_521
Lpf_562:
buffer_load_dwordx4 v[36:39], v9, s[4:7], s40 offen offset:2048 sc1
s_branch Lps_541
Lg3_3:
v_mov_b32 v9, v1
s_sub_u32 s26, s34, 24
s_lshl_b32 s44, s33, 3
s_add_u32 s44, s44, s26
s_lshl_b32 s38, s44, 7
s_add_u32 s38, s38, 3440640
v_min_u32 v80, 1, v0
v_lshl_add_u32 v4, v80, 30, s38
v_mov_b32 v5, 0
buffer_store_dword v5, v4, s[4:7], 0 offen sc1
s_mov_b32 s52, 1
s_mov_b32 s38, 4096
buffer_store_dword v5, v4, s[4:7], s38 offen sc1
s_lshl_b32 s38, s44, 7
s_add_u32 s38, s38, 3436544
v_min_u32 v80, 1, v0
v_lshl_add_u32 v7, v80, 30, s38
buffer_store_dword v5, v7, s[4:7], 0 offen sc1
s_lshl_b32 s38, s35, 16
s_or_b32 s52, s52, s38
s_waitcnt vmcnt(0)
s_cmp_lg_u32 s32, 0
s_cbranch_scc1 Lar_564
s_mov_b64 exec, 1
v_mov_b32 v48, 32
v_mov_b32 v49, s52
buffer_atomic_add v49, v48, s[12:15], 0 offen sc1
s_mov_b64 exec, -1
Lar_564:
s_mov_b32 s8, s24
s_and_b32 s9, s25, 0xffff
s_mov_b32 s10, 0x800000
s_mov_b32 s11, 0x20000
s_lshl_b32 s60, s33, 21
s_lshl_b32 s38, s26, 8
s_add_u32 s60, s60, s38
s_add_u32 s61, s60, 128
s_lshr_b32 s52, s32, 1
s_lshl_b32 s52, s52, 14
s_and_b32 s53, s32, 1
s_lshl_b32 s53, s53, 6
s_add_u32 s52, s52, s53
v_bfe_u32 v84, v9, 2, 2
v_lshrrev_b32 v85, 4, v9
v_lshl_add_u32 v84, v85, 2, v84
v_lshl_add_u32 v84, v84, 7, s52
v_and_b32 v85, 3, v9
v_lshl_add_u32 v84, v85, 4, v84
v_add_u32 v80, 0, v84
v_bfe_u32 v84, v9, 2, 2
v_lshrrev_b32 v85, 4, v9
v_lshl_add_u32 v84, v85, 2, v84
v_lshl_add_u32 v84, v84, 7, s52
v_and_b32 v85, 3, v9
v_lshl_add_u32 v84, v85, 4, v84
v_add_u32 v81, 8, v84
v_lshrrev_b32 v84, 3, v9
s_mul_i32 s38, s32, 256
v_add_u32 v84, s38, v84
v_mul_u32_u24 v84, 2048, v84
v_and_b32 v85, 7, v9
v_lshl_add_u32 v84, v85, 4, v84
s_lshl_b32 s38, s32, 12
s_barrier
s_add_u32 m0, s38, 0
s_add_u32 s39, s60, 0
buffer_load_dwordx4 v84, s[8:11], s39 offen lds
s_add_u32 m0, s38, 1024
s_add_u32 s39, s60, 16384
buffer_load_dwordx4 v84, s[8:11], s39 offen lds
s_add_u32 m0, s38, 2048
s_add_u32 s39, s60, 32768
buffer_load_dwordx4 v84, s[8:11], s39 offen lds
s_add_u32 m0, s38, 3072
s_add_u32 s39, s60, 49152
buffer_load_dwordx4 v84, s[8:11], s39 offen lds
s_add_u32 m0, s38, 16384
s_add_u32 s39, s61, 0
buffer_load_dwordx4 v84, s[8:11], s39 offen lds
s_add_u32 m0, s38, 17408
s_add_u32 s39, s61, 16384
buffer_load_dwordx4 v84, s[8:11], s39 offen lds
s_add_u32 m0, s38, 18432
s_add_u32 s39, s61, 32768
buffer_load_dwordx4 v84, s[8:11], s39 offen lds
s_add_u32 m0, s38, 19456
s_add_u32 s39, s61, 49152
buffer_load_dwordx4 v84, s[8:11], s39 offen lds
s_add_u32 m0, s38, 32768
s_add_u32 s39, s60, 65536
buffer_load_dwordx4 v84, s[8:11], s39 offen lds
s_add_u32 m0, s38, 33792
s_add_u32 s39, s60, 81920
buffer_load_dwordx4 v84, s[8:11], s39 offen lds
s_add_u32 m0, s38, 34816
s_add_u32 s39, s60, 98304
buffer_load_dwordx4 v84, s[8:11], s39 offen lds
s_add_u32 m0, s38, 35840
s_add_u32 s39, s60, 114688
buffer_load_dwordx4 v84, s[8:11], s39 offen lds
s_add_u32 m0, s38, 49152
s_add_u32 s39, s61, 65536
buffer_load_dwordx4 v84, s[8:11], s39 offen lds
s_add_u32 m0, s38, 50176
s_add_u32 s39, s61, 81920
buffer_load_dwordx4 v84, s[8:11], s39 offen lds
s_add_u32 m0, s38, 51200
s_add_u32 s39, s61, 98304
buffer_load_dwordx4 v84, s[8:11], s39 offen lds
s_add_u32 m0, s38, 52224
s_add_u32 s39, s61, 114688
buffer_load_dwordx4 v84, s[8:11], s39 offen lds
s_add_u32 m0, s38, 65536
s_add_u32 s39, s60, 131072
buffer_load_dwordx4 v84, s[8:11], s39 offen lds
s_add_u32 m0, s38, 66560
s_add_u32 s39, s60, 147456
buffer_load_dwordx4 v84, s[8:11], s39 offen lds
s_add_u32 m0, s38, 67584
s_add_u32 s39, s60, 163840
buffer_load_dwordx4 v84, s[8:11], s39 offen lds
s_add_u32 m0, s38, 68608
s_add_u32 s39, s60, 180224
buffer_load_dwordx4 v84, s[8:11], s39 offen lds
s_add_u32 m0, s38, 81920
s_add_u32 s39, s61, 131072
buffer_load_dwordx4 v84, s[8:11], s39 offen lds
s_add_u32 m0, s38, 82944
s_add_u32 s39, s61, 147456
buffer_load_dwordx4 v84, s[8:11], s39 offen lds
s_add_u32 m0, s38, 83968
s_add_u32 s39, s61, 163840
buffer_load_dwordx4 v84, s[8:11], s39 offen lds
s_add_u32 m0, s38, 84992
s_add_u32 s39, s61, 180224
buffer_load_dwordx4 v84, s[8:11], s39 offen lds
s_add_u32 m0, s38, 98304
s_add_u32 s39, s60, 196608
buffer_load_dwordx4 v84, s[8:11], s39 offen lds
s_add_u32 m0, s38, 99328
s_add_u32 s39, s60, 212992
buffer_load_dwordx4 v84, s[8:11], s39 offen lds
s_add_u32 m0, s38, 100352
s_add_u32 s39, s60, 229376
buffer_load_dwordx4 v84, s[8:11], s39 offen lds
s_add_u32 m0, s38, 101376
s_add_u32 s39, s60, 245760
buffer_load_dwordx4 v84, s[8:11], s39 offen lds
s_add_u32 m0, s38, 114688
s_add_u32 s39, s61, 196608
buffer_load_dwordx4 v84, s[8:11], s39 offen lds
s_add_u32 m0, s38, 115712
s_add_u32 s39, s61, 212992
buffer_load_dwordx4 v84, s[8:11], s39 offen lds
s_add_u32 m0, s38, 116736
s_add_u32 s39, s61, 229376
buffer_load_dwordx4 v84, s[8:11], s39 offen lds
s_add_u32 m0, s38, 117760
s_add_u32 s39, s61, 245760
buffer_load_dwordx4 v84, s[8:11], s39 offen lds
s_add_u32 m0, s38, 131072
s_add_u32 s39, s60, 262144
buffer_load_dwordx4 v84, s[8:11], s39 offen lds
s_add_u32 m0, s38, 132096
s_add_u32 s39, s60, 278528
buffer_load_dwordx4 v84, s[8:11], s39 offen lds
s_add_u32 m0, s38, 133120
s_add_u32 s39, s60, 294912
buffer_load_dwordx4 v84, s[8:11], s39 offen lds
s_add_u32 m0, s38, 134144
s_add_u32 s39, s60, 311296
buffer_load_dwordx4 v84, s[8:11], s39 offen lds
s_add_u32 m0, s38, 147456
s_add_u32 s39, s61, 262144
buffer_load_dwordx4 v84, s[8:11], s39 offen lds
s_add_u32 m0, s38, 148480
s_add_u32 s39, s61, 278528
buffer_load_dwordx4 v84, s[8:11], s39 offen lds
s_add_u32 m0, s38, 149504
s_add_u32 s39, s61, 294912
buffer_load_dwordx4 v84, s[8:11], s39 offen lds
s_add_u32 m0, s38, 150528
s_add_u32 s39, s61, 311296
buffer_load_dwordx4 v84, s[8:11], s39 offen lds
s_waitcnt vmcnt(32)
s_barrier
ds_read_b64_tr_b16 a[0:1], v80 offset:0
ds_read_b64_tr_b16 a[2:3], v80 offset:2048
ds_read_b64_tr_b16 a[32:33], v80 offset:4096
ds_read_b64_tr_b16 a[34:35], v80 offset:6144
ds_read_b64_tr_b16 a[64:65], v80 offset:8192
ds_read_b64_tr_b16 a[66:67], v80 offset:10240
ds_read_b64_tr_b16 a[96:97], v80 offset:12288
ds_read_b64_tr_b16 a[98:99], v80 offset:14336
ds_read_b64_tr_b16 a[128:129], v81 offset:0
ds_read_b64_tr_b16 a[130:131], v81 offset:2048
ds_read_b64_tr_b16 a[160:161], v81 offset:4096
ds_read_b64_tr_b16 a[162:163], v81 offset:6144
ds_read_b64_tr_b16 a[192:193], v81 offset:8192
ds_read_b64_tr_b16 a[194:195], v81 offset:10240
ds_read_b64_tr_b16 a[224:225], v81 offset:12288
ds_read_b64_tr_b16 a[226:227], v81 offset:14336
v_add_u32 v80, 32768, v80
v_add_u32 v81, 32768, v81
s_waitcnt lgkmcnt(0)
s_barrier
s_add_u32 m0, s38, 0
s_add_u32 s39, s60, 327680
buffer_load_dwordx4 v84, s[8:11], s39 offen lds
s_add_u32 m0, s38, 1024
s_add_u32 s39, s60, 344064
buffer_load_dwordx4 v84, s[8:11], s39 offen lds
s_add_u32 m0, s38, 2048
s_add_u32 s39, s60, 360448
buffer_load_dwordx4 v84, s[8:11], s39 offen lds
s_add_u32 m0, s38, 3072
s_add_u32 s39, s60, 376832
buffer_load_dwordx4 v84, s[8:11], s39 offen lds
s_add_u32 m0, s38, 16384
s_add_u32 s39, s61, 327680
buffer_load_dwordx4 v84, s[8:11], s39 offen lds
s_add_u32 m0, s38, 17408
s_add_u32 s39, s61, 344064
buffer_load_dwordx4 v84, s[8:11], s39 offen lds
s_add_u32 m0, s38, 18432
s_add_u32 s39, s61, 360448
buffer_load_dwordx4 v84, s[8:11], s39 offen lds
s_add_u32 m0, s38, 19456
s_add_u32 s39, s61, 376832
buffer_load_dwordx4 v84, s[8:11], s39 offen lds
s_waitcnt vmcnt(32)
s_barrier
ds_read_b64_tr_b16 a[4:5], v80 offset:0
ds_read_b64_tr_b16 a[6:7], v80 offset:2048
ds_read_b64_tr_b16 a[36:37], v80 offset:4096
ds_read_b64_tr_b16 a[38:39], v80 offset:6144
ds_read_b64_tr_b16 a[68:69], v80 offset:8192
ds_read_b64_tr_b16 a[70:71], v80 offset:10240
ds_read_b64_tr_b16 a[100:101], v80 offset:12288
ds_read_b64_tr_b16 a[102:103], v80 offset:14336
ds_read_b64_tr_b16 a[132:133], v81 offset:0
ds_read_b64_tr_b16 a[134:135], v81 offset:2048
ds_read_b64_tr_b16 a[164:165], v81 offset:4096
ds_read_b64_tr_b16 a[166:167], v81 offset:6144
ds_read_b64_tr_b16 a[196:197], v81 offset:8192
ds_read_b64_tr_b16 a[198:199], v81 offset:10240
ds_read_b64_tr_b16 a[228:229], v81 offset:12288
ds_read_b64_tr_b16 a[230:231], v81 offset:14336
v_add_u32 v80, 32768, v80
v_add_u32 v81, 32768, v81
s_waitcnt lgkmcnt(0)
s_barrier
s_add_u32 m0, s38, 32768
s_add_u32 s39, s60, 393216
buffer_load_dwordx4 v84, s[8:11], s39 offen lds
s_add_u32 m0, s38, 33792
s_add_u32 s39, s60, 409600
buffer_load_dwordx4 v84, s[8:11], s39 offen lds
s_add_u32 m0, s38, 34816
s_add_u32 s39, s60, 425984
buffer_load_dwordx4 v84, s[8:11], s39 offen lds
s_add_u32 m0, s38, 35840
s_add_u32 s39, s60, 442368
buffer_load_dwordx4 v84, s[8:11], s39 offen lds
s_add_u32 m0, s38, 49152
s_add_u32 s39, s61, 393216
buffer_load_dwordx4 v84, s[8:11], s39 offen lds
s_add_u32 m0, s38, 50176
s_add_u32 s39, s61, 409600
buffer_load_dwordx4 v84, s[8:11], s39 offen lds
s_add_u32 m0, s38, 51200
s_add_u32 s39, s61, 425984
buffer_load_dwordx4 v84, s[8:11], s39 offen lds
s_add_u32 m0, s38, 52224
s_add_u32 s39, s61, 442368
buffer_load_dwordx4 v84, s[8:11], s39 offen lds
s_waitcnt vmcnt(32)
s_barrier
ds_read_b64_tr_b16 a[8:9], v80 offset:0
ds_read_b64_tr_b16 a[10:11], v80 offset:2048
ds_read_b64_tr_b16 a[40:41], v80 offset:4096
ds_read_b64_tr_b16 a[42:43], v80 offset:6144
ds_read_b64_tr_b16 a[72:73], v80 offset:8192
ds_read_b64_tr_b16 a[74:75], v80 offset:10240
ds_read_b64_tr_b16 a[104:105], v80 offset:12288
ds_read_b64_tr_b16 a[106:107], v80 offset:14336
ds_read_b64_tr_b16 a[136:137], v81 offset:0
ds_read_b64_tr_b16 a[138:139], v81 offset:2048
ds_read_b64_tr_b16 a[168:169], v81 offset:4096
ds_read_b64_tr_b16 a[170:171], v81 offset:6144
ds_read_b64_tr_b16 a[200:201], v81 offset:8192
ds_read_b64_tr_b16 a[202:203], v81 offset:10240
ds_read_b64_tr_b16 a[232:233], v81 offset:12288
ds_read_b64_tr_b16 a[234:235], v81 offset:14336
v_add_u32 v80, 32768, v80
v_add_u32 v81, 32768, v81
s_waitcnt lgkmcnt(0)
s_barrier
s_add_u32 m0, s38, 65536
s_add_u32 s39, s60, 458752
buffer_load_dwordx4 v84, s[8:11], s39 offen lds
s_add_u32 m0, s38, 66560
s_add_u32 s39, s60, 475136
buffer_load_dwordx4 v84, s[8:11], s39 offen lds
s_add_u32 m0, s38, 67584
s_add_u32 s39, s60, 491520
buffer_load_dwordx4 v84, s[8:11], s39 offen lds
s_add_u32 m0, s38, 68608
s_add_u32 s39, s60, 507904
buffer_load_dwordx4 v84, s[8:11], s39 offen lds
s_add_u32 m0, s38, 81920
s_add_u32 s39, s61, 458752
buffer_load_dwordx4 v84, s[8:11], s39 offen lds
s_add_u32 m0, s38, 82944
s_add_u32 s39, s61, 475136
buffer_load_dwordx4 v84, s[8:11], s39 offen lds
s_add_u32 m0, s38, 83968
s_add_u32 s39, s61, 491520
buffer_load_dwordx4 v84, s[8:11], s39 offen lds
s_add_u32 m0, s38, 84992
s_add_u32 s39, s61, 507904
buffer_load_dwordx4 v84, s[8:11], s39 offen lds
s_waitcnt vmcnt(32)
s_barrier
ds_read_b64_tr_b16 a[12:13], v80 offset:0
ds_read_b64_tr_b16 a[14:15], v80 offset:2048
ds_read_b64_tr_b16 a[44:45], v80 offset:4096
ds_read_b64_tr_b16 a[46:47], v80 offset:6144
ds_read_b64_tr_b16 a[76:77], v80 offset:8192
ds_read_b64_tr_b16 a[78:79], v80 offset:10240
ds_read_b64_tr_b16 a[108:109], v80 offset:12288
ds_read_b64_tr_b16 a[110:111], v80 offset:14336
ds_read_b64_tr_b16 a[140:141], v81 offset:0
ds_read_b64_tr_b16 a[142:143], v81 offset:2048
ds_read_b64_tr_b16 a[172:173], v81 offset:4096
ds_read_b64_tr_b16 a[174:175], v81 offset:6144
ds_read_b64_tr_b16 a[204:205], v81 offset:8192
ds_read_b64_tr_b16 a[206:207], v81 offset:10240
ds_read_b64_tr_b16 a[236:237], v81 offset:12288
ds_read_b64_tr_b16 a[238:239], v81 offset:14336
v_add_u32 v80, 32768, v80
v_add_u32 v81, 32768, v81
s_waitcnt lgkmcnt(0)
s_barrier
s_waitcnt vmcnt(24)
s_barrier
ds_read_b64_tr_b16 a[16:17], v80 offset:0
ds_read_b64_tr_b16 a[18:19], v80 offset:2048
ds_read_b64_tr_b16 a[48:49], v80 offset:4096
ds_read_b64_tr_b16 a[50:51], v80 offset:6144
ds_read_b64_tr_b16 a[80:81], v80 offset:8192
ds_read_b64_tr_b16 a[82:83], v80 offset:10240
ds_read_b64_tr_b16 a[112:113], v80 offset:12288
ds_read_b64_tr_b16 a[114:115], v80 offset:14336
ds_read_b64_tr_b16 a[144:145], v81 offset:0
ds_read_b64_tr_b16 a[146:147], v81 offset:2048
ds_read_b64_tr_b16 a[176:177], v81 offset:4096
ds_read_b64_tr_b16 a[178:179], v81 offset:6144
ds_read_b64_tr_b16 a[208:209], v81 offset:8192
ds_read_b64_tr_b16 a[210:211], v81 offset:10240
ds_read_b64_tr_b16 a[240:241], v81 offset:12288
ds_read_b64_tr_b16 a[242:243], v81 offset:14336
v_add_u32 v80, -131072, v80
v_add_u32 v81, -131072, v81
s_waitcnt lgkmcnt(0)
s_barrier
s_waitcnt vmcnt(16)
s_barrier
ds_read_b64_tr_b16 a[20:21], v80 offset:0
ds_read_b64_tr_b16 a[22:23], v80 offset:2048
ds_read_b64_tr_b16 a[52:53], v80 offset:4096
ds_read_b64_tr_b16 a[54:55], v80 offset:6144
ds_read_b64_tr_b16 a[84:85], v80 offset:8192
ds_read_b64_tr_b16 a[86:87], v80 offset:10240
ds_read_b64_tr_b16 a[116:117], v80 offset:12288
ds_read_b64_tr_b16 a[118:119], v80 offset:14336
ds_read_b64_tr_b16 a[148:149], v81 offset:0
ds_read_b64_tr_b16 a[150:151], v81 offset:2048
ds_read_b64_tr_b16 a[180:181], v81 offset:4096
ds_read_b64_tr_b16 a[182:183], v81 offset:6144
ds_read_b64_tr_b16 a[212:213], v81 offset:8192
ds_read_b64_tr_b16 a[214:215], v81 offset:10240
ds_read_b64_tr_b16 a[244:245], v81 offset:12288
ds_read_b64_tr_b16 a[246:247], v81 offset:14336
v_add_u32 v80, 32768, v80
v_add_u32 v81, 32768, v81
s_waitcnt lgkmcnt(0)
s_barrier
s_waitcnt vmcnt(8)
s_barrier
ds_read_b64_tr_b16 a[24:25], v80 offset:0
ds_read_b64_tr_b16 a[26:27], v80 offset:2048
ds_read_b64_tr_b16 a[56:57], v80 offset:4096
ds_read_b64_tr_b16 a[58:59], v80 offset:6144
ds_read_b64_tr_b16 a[88:89], v80 offset:8192
ds_read_b64_tr_b16 a[90:91], v80 offset:10240
ds_read_b64_tr_b16 a[120:121], v80 offset:12288
ds_read_b64_tr_b16 a[122:123], v80 offset:14336
ds_read_b64_tr_b16 a[152:153], v81 offset:0
ds_read_b64_tr_b16 a[154:155], v81 offset:2048
ds_read_b64_tr_b16 a[184:185], v81 offset:4096
ds_read_b64_tr_b16 a[186:187], v81 offset:6144
ds_read_b64_tr_b16 a[216:217], v81 offset:8192
ds_read_b64_tr_b16 a[218:219], v81 offset:10240
ds_read_b64_tr_b16 a[248:249], v81 offset:12288
ds_read_b64_tr_b16 a[250:251], v81 offset:14336
v_add_u32 v80, 32768, v80
v_add_u32 v81, 32768, v81
s_waitcnt lgkmcnt(0)
s_barrier
s_waitcnt vmcnt(0)
s_barrier
ds_read_b64_tr_b16 a[28:29], v80 offset:0
ds_read_b64_tr_b16 a[30:31], v80 offset:2048
ds_read_b64_tr_b16 a[60:61], v80 offset:4096
ds_read_b64_tr_b16 a[62:63], v80 offset:6144
ds_read_b64_tr_b16 a[92:93], v80 offset:8192
ds_read_b64_tr_b16 a[94:95], v80 offset:10240
ds_read_b64_tr_b16 a[124:125], v80 offset:12288
ds_read_b64_tr_b16 a[126:127], v80 offset:14336
ds_read_b64_tr_b16 a[156:157], v81 offset:0
ds_read_b64_tr_b16 a[158:159], v81 offset:2048
ds_read_b64_tr_b16 a[188:189], v81 offset:4096
ds_read_b64_tr_b16 a[190:191], v81 offset:6144
ds_read_b64_tr_b16 a[220:221], v81 offset:8192
ds_read_b64_tr_b16 a[222:223], v81 offset:10240
ds_read_b64_tr_b16 a[252:253], v81 offset:12288
ds_read_b64_tr_b16 a[254:255], v81 offset:14336
v_add_u32 v80, 32768, v80
v_add_u32 v81, 32768, v81
s_waitcnt lgkmcnt(0)
s_barrier
Lst_565:
buffer_load_dword v48, off, s[12:15], 0 offset:32 sc1
buffer_load_dword v49, off, s[12:15], 0 offset:160 sc1
s_waitcnt vmcnt(0)
v_add_u32 v48, v48, v49
s_nop 0
v_readfirstlane_b32 s38, v48
s_nop 3
s_and_b32 s39, s38, 0xffff
s_cmp_eq_u32 s39, 0x100
s_cbranch_scc1 Lso_566
s_sub_u32 s37, s37, 1
s_cbranch_scc1 Lend_7
s_sleep 8
s_branch Lst_565
Lso_566:
s_bfe_u32 s35, s38, 0x80010
s_bfe_u32 s46, s38, 0x10018
s_lshl_b32 s46, s46, 13
s_barrier
s_mul_i32 s50, s32, 4096
v_lshlrev_b32 v1, 4, v9
v_add_u32 v0, s50, v1
v_lshrrev_b32 v80, 2, v9
v_min_u32 v80, 7, v80
v_lshlrev_b32 v80, 7, v80
v_and_b32 v2, 3, v9
v_lshl_add_u32 v2, v2, 2, v80
s_lshl_b32 s47, s33, 10
s_add_u32 s47, s47, 3432448
v_mov_b32 v6, v1
s_lshl_b32 s38, s26, 2
s_add_u32 s38, s38, s32
s_lshl_b32 s38, s38, 11
s_lshl_b32 s49, s33, 22
s_add_u32 s49, s49, s38
s_add_u32 s49, s49, 117374976
s_lshl_b32 s54, s33, 16
s_add_u32 s54, s54, 83886080
s_lshl_b32 s45, s26, 18
s_add_u32 s45, s45, s54
s_add_u32 m0, s50, 0
s_add_u32 s39, s45, 0
buffer_load_dwordx4 v0, s[4:7], s39 offen offset:0 sc1 lds
buffer_load_dwordx4 v0, s[4:7], s39 offen offset:1024 sc1 lds
buffer_load_dwordx4 v0, s[4:7], s39 offen offset:2048 sc1 lds
buffer_load_dwordx4 v0, s[4:7], s39 offen offset:3072 sc1 lds
s_add_u32 m0, s50, 16384
s_add_u32 s39, s45, 16384
buffer_load_dwordx4 v0, s[4:7], s39 offen offset:0 sc1 lds
buffer_load_dwordx4 v0, s[4:7], s39 offen offset:1024 sc1 lds
buffer_load_dwordx4 v0, s[4:7], s39 offen offset:2048 sc1 lds
buffer_load_dwordx4 v0, s[4:7], s39 offen offset:3072 sc1 lds
s_add_u32 m0, s50, 32768
s_add_u32 s39, s45, 32768
buffer_load_dwordx4 v0, s[4:7], s39 offen offset:0 sc1 lds
buffer_load_dwordx4 v0, s[4:7], s39 offen offset:1024 sc1 lds
buffer_load_dwordx4 v0, s[4:7], s39 offen offset:2048 sc1 lds
buffer_load_dwordx4 v0, s[4:7], s39 offen offset:3072 sc1 lds
s_add_u32 m0, s50, 49152
s_add_u32 s39, s45, 49152
buffer_load_dwordx4 v0, s[4:7], s39 offen offset:0 sc1 lds
buffer_load_dwordx4 v0, s[4:7], s39 offen offset:1024 sc1 lds
buffer_load_dwordx4 v0, s[4:7], s39 offen offset:2048 sc1 lds
buffer_load_dwordx4 v0, s[4:7], s39 offen offset:3072 sc1 lds
v_mov_b32 v8, 0
s_mov_b32 s36, 0
s_add_u32 s48, s36, 1
Lsw_567:
Lbw_572:
buffer_load_dword v3, v2, s[4:7], s47 offen sc1
s_waitcnt vmcnt(0)
v_cmp_gt_u32 vcc, s48, v3
s_cbranch_vccz Lbo_573
s_sub_u32 s37, s37, 1
s_cbranch_scc1 Lend_7
s_sleep 1
s_branch Lbw_572
Lbo_573:
s_add_u32 m0, s50, 0
s_add_u32 s39, s54, 0
buffer_load_dwordx4 v0, s[4:7], s39 offen offset:0 sc1 lds
buffer_load_dwordx4 v0, s[4:7], s39 offen offset:1024 sc1 lds
buffer_load_dwordx4 v0, s[4:7], s39 offen offset:2048 sc1 lds
buffer_load_dwordx4 v0, s[4:7], s39 offen offset:3072 sc1 lds
s_add_u32 m0, s50, 16384
s_add_u32 s39, s54, 16384
buffer_load_dwordx4 v0, s[4:7], s39 offen offset:0 sc1 lds
buffer_load_dwordx4 v0, s[4:7], s39 offen offset:1024 sc1 lds
buffer_load_dwordx4 v0, s[4:7], s39 offen offset:2048 sc1 lds
buffer_load_dwordx4 v0, s[4:7], s39 offen offset:3072 sc1 lds
s_add_u32 m0, s50, 32768
s_add_u32 s39, s54, 32768
buffer_load_dwordx4 v0, s[4:7], s39 offen offset:0 sc1 lds
buffer_load_dwordx4 v0, s[4:7], s39 offen offset:1024 sc1 lds
buffer_load_dwordx4 v0, s[4:7], s39 offen offset:2048 sc1 lds
buffer_load_dwordx4 v0, s[4:7], s39 offen offset:3072 sc1 lds
s_add_u32 m0, s50, 49152
s_add_u32 s39, s54, 49152
buffer_load_dwordx4 v0, s[4:7], s39 offen offset:0 sc1 lds
buffer_load_dwordx4 v0, s[4:7], s39 offen offset:1024 sc1 lds
buffer_load_dwordx4 v0, s[4:7], s39 offen offset:2048 sc1 lds
buffer_load_dwordx4 v0, s[4:7], s39 offen offset:3072 sc1 lds
buffer_load_dword v3, v2, s[4:7], s47 offen sc1
Lse_568:
s_waitcnt vmcnt(13)
s_barrier
ds_read_b128 v[16:19], v1 offset:0
ds_read_b128 v[20:23], v1 offset:1024
ds_read_b128 v[24:27], v1 offset:2048
ds_read_b128 v[28:31], v1 offset:3072
ds_read_b128 v[32:35], v1 offset:4096
ds_read_b128 v[36:39], v1 offset:5120
ds_read_b128 v[40:43], v1 offset:6144
s_add_u32 s54, s54, 262144
s_bitset0_b32 s54, 21
s_xor_b32 s50, s50, 0x10000
s_add_u32 s49, s49, 65536
s_add_u32 s36, s36, 1
s_add_u32 s48, s36, 1
s_waitcnt lgkmcnt(5)
v_mfma_f32_16x16x32_bf16 v[48:51], a[0:3], v[16:19], 0
ds_read_b128 v[44:47], v1 offset:7168
v_mfma_f32_16x16x32_bf16 v[52:55], a[128:131], v[16:19], 0
v_mfma_f32_16x16x32_bf16 v[56:59], a[0:3], v[20:23], 0
ds_read_b128 v[16:19], v1 offset:8192
v_mfma_f32_16x16x32_bf16 v[60:63], a[128:131], v[20:23], 0
s_waitcnt lgkmcnt(5)
v_mfma_f32_16x16x32_bf16 v[48:51], a[4:7], v[24:27], v[48:51]
ds_read_b128 v[20:23], v1 offset:9216
v_mfma_f32_16x16x32_bf16 v[52:55], a[132:135], v[24:27], v[52:55]
v_mfma_f32_16x16x32_bf16 v[56:59], a[4:7], v[28:31], v[56:59]
ds_read_b128 v[24:27], v1 offset:10240
v_mfma_f32_16x16x32_bf16 v[60:63], a[132:135], v[28:31], v[60:63]
s_waitcnt lgkmcnt(5)
v_mfma_f32_16x16x32_bf16 v[48:51], a[8:11], v[32:35], v[48:51]
ds_read_b128 v[28:31], v1 offset:11264
v_mfma_f32_16x16x32_bf16 v[52:55], a[136:139], v[32:35], v[52:55]
v_mfma_f32_16x16x32_bf16 v[56:59], a[8:11], v[36:39], v[56:59]
ds_read_b128 v[32:35], v1 offset:12288
v_mfma_f32_16x16x32_bf16 v[60:63], a[136:139], v[36:39], v[60:63]
s_waitcnt lgkmcnt(5)
v_mfma_f32_16x16x32_bf16 v[48:51], a[12:15], v[40:43], v[48:51]
ds_read_b128 v[36:39], v1 offset:13312
v_mfma_f32_16x16x32_bf16 v[52:55], a[140:143], v[40:43], v[52:55]
v_mfma_f32_16x16x32_bf16 v[56:59], a[12:15], v[44:47], v[56:59]
ds_read_b128 v[40:43], v1 offset:14336
v_mfma_f32_16x16x32_bf16 v[60:63], a[140:143], v[44:47], v[60:63]
s_waitcnt lgkmcnt(5)
v_mfma_f32_16x16x32_bf16 v[48:51], a[16:19], v[16:19], v[48:51]
ds_read_b128 v[44:47], v1 offset:15360
v_mfma_f32_16x16x32_bf16 v[52:55], a[144:147], v[16:19], v[52:55]
v_mfma_f32_16x16x32_bf16 v[56:59], a[16:19], v[20:23], v[56:59]
s_waitcnt vmcnt(9)
s_barrier
ds_read_b128 v[16:19], v1 offset:16384
v_mfma_f32_16x16x32_bf16 v[60:63], a[144:147], v[20:23], v[60:63]
s_waitcnt lgkmcnt(5)
v_mfma_f32_16x16x32_bf16 v[48:51], a[20:23], v[24:27], v[48:51]
ds_read_b128 v[20:23], v1 offset:17408
v_mfma_f32_16x16x32_bf16 v[52:55], a[148:151], v[24:27], v[52:55]
v_mfma_f32_16x16x32_bf16 v[56:59], a[20:23], v[28:31], v[56:59]
ds_read_b128 v[24:27], v1 offset:18432
v_mfma_f32_16x16x32_bf16 v[60:63], a[148:151], v[28:31], v[60:63]
s_waitcnt lgkmcnt(5)
v_mfma_f32_16x16x32_bf16 v[48:51], a[24:27], v[32:35], v[48:51]
ds_read_b128 v[28:31], v1 offset:19456
v_mfma_f32_16x16x32_bf16 v[52:55], a[152:155], v[32:35], v[52:55]
v_mfma_f32_16x16x32_bf16 v[56:59], a[24:27], v[36:39], v[56:59]
ds_read_b128 v[32:35], v1 offset:20480
v_mfma_f32_16x16x32_bf16 v[60:63], a[152:155], v[36:39], v[60:63]
s_waitcnt lgkmcnt(5)
v_mfma_f32_16x16x32_bf16 v[48:51], a[28:31], v[40:43], v[48:51]
ds_read_b128 v[36:39], v1 offset:21504
v_mfma_f32_16x16x32_bf16 v[52:55], a[156:159], v[40:43], v[52:55]
v_mfma_f32_16x16x32_bf16 v[56:59], a[28:31], v[44:47], v[56:59]
ds_read_b128 v[40:43], v1 offset:22528
v_mfma_f32_16x16x32_bf16 v[60:63], a[156:159], v[44:47], v[60:63]
s_waitcnt lgkmcnt(5)
v_mfma_f32_16x16x32_bf16 v[48:51], a[32:35], v[16:19], v[48:51]
ds_read_b128 v[44:47], v1 offset:23552
v_mfma_f32_16x16x32_bf16 v[52:55], a[160:163], v[16:19], v[52:55]
v_mfma_f32_16x16x32_bf16 v[56:59], a[32:35], v[20:23], v[56:59]
ds_read_b128 v[16:19], v1 offset:24576
v_mfma_f32_16x16x32_bf16 v[60:63], a[160:163], v[20:23], v[60:63]
s_waitcnt lgkmcnt(5)
v_mfma_f32_16x16x32_bf16 v[48:51], a[36:39], v[24:27], v[48:51]
ds_read_b128 v[20:23], v1 offset:25600
v_mfma_f32_16x16x32_bf16 v[52:55], a[164:167], v[24:27], v[52:55]
v_mfma_f32_16x16x32_bf16 v[56:59], a[36:39], v[28:31], v[56:59]
ds_read_b128 v[24:27], v1 offset:26624
v_mfma_f32_16x16x32_bf16 v[60:63], a[164:167], v[28:31], v[60:63]
s_waitcnt lgkmcnt(5)
v_mfma_f32_16x16x32_bf16 v[48:51], a[40:43], v[32:35], v[48:51]
ds_read_b128 v[28:31], v1 offset:27648
v_mfma_f32_16x16x32_bf16 v[52:55], a[168:171], v[32:35], v[52:55]
v_mfma_f32_16x16x32_bf16 v[56:59], a[40:43], v[36:39], v[56:59]
ds_read_b128 v[32:35], v1 offset:28672
v_mfma_f32_16x16x32_bf16 v[60:63], a[168:171], v[36:39], v[60:63]
s_waitcnt lgkmcnt(5)
v_mfma_f32_16x16x32_bf16 v[48:51], a[44:47], v[40:43], v[48:51]
ds_read_b128 v[36:39], v1 offset:29696
v_mfma_f32_16x16x32_bf16 v[52:55], a[172:175], v[40:43], v[52:55]
v_mfma_f32_16x16x32_bf16 v[56:59], a[44:47], v[44:47], v[56:59]
ds_read_b128 v[40:43], v1 offset:30720
v_mfma_f32_16x16x32_bf16 v[60:63], a[172:175], v[44:47], v[60:63]
s_waitcnt lgkmcnt(5)
v_mfma_f32_16x16x32_bf16 v[48:51], a[48:51], v[16:19], v[48:51]
ds_read_b128 v[44:47], v1 offset:31744
v_mfma_f32_16x16x32_bf16 v[52:55], a[176:179], v[16:19], v[52:55]
v_mfma_f32_16x16x32_bf16 v[56:59], a[48:51], v[20:23], v[56:59]
s_waitcnt vmcnt(5)
s_barrier
ds_read_b128 v[16:19], v1 offset:32768
v_mfma_f32_16x16x32_bf16 v[60:63], a[176:179], v[20:23], v[60:63]
s_waitcnt lgkmcnt(5)
v_mfma_f32_16x16x32_bf16 v[48:51], a[52:55], v[24:27], v[48:51]
ds_read_b128 v[20:23], v1 offset:33792
v_mfma_f32_16x16x32_bf16 v[52:55], a[180:183], v[24:27], v[52:55]
v_mfma_f32_16x16x32_bf16 v[56:59], a[52:55], v[28:31], v[56:59]
ds_read_b128 v[24:27], v1 offset:34816
v_mfma_f32_16x16x32_bf16 v[60:63], a[180:183], v[28:31], v[60:63]
s_waitcnt lgkmcnt(5)
v_mfma_f32_16x16x32_bf16 v[48:51], a[56:59], v[32:35], v[48:51]
ds_read_b128 v[28:31], v1 offset:35840
v_mfma_f32_16x16x32_bf16 v[52:55], a[184:187], v[32:35], v[52:55]
v_mfma_f32_16x16x32_bf16 v[56:59], a[56:59], v[36:39], v[56:59]
ds_read_b128 v[32:35], v1 offset:36864
v_mfma_f32_16x16x32_bf16 v[60:63], a[184:187], v[36:39], v[60:63]
s_waitcnt lgkmcnt(5)
v_mfma_f32_16x16x32_bf16 v[48:51], a[60:63], v[40:43], v[48:51]
ds_read_b128 v[36:39], v1 offset:37888
v_mfma_f32_16x16x32_bf16 v[52:55], a[188:191], v[40:43], v[52:55]
v_mfma_f32_16x16x32_bf16 v[56:59], a[60:63], v[44:47], v[56:59]
ds_read_b128 v[40:43], v1 offset:38912
v_mfma_f32_16x16x32_bf16 v[60:63], a[188:191], v[44:47], v[60:63]
s_waitcnt lgkmcnt(5)
v_mfma_f32_16x16x32_bf16 v[48:51], a[64:67], v[16:19], v[48:51]
ds_read_b128 v[44:47], v1 offset:39936
v_mfma_f32_16x16x32_bf16 v[52:55], a[192:195], v[16:19], v[52:55]
v_mfma_f32_16x16x32_bf16 v[56:59], a[64:67], v[20:23], v[56:59]
ds_read_b128 v[16:19], v1 offset:40960
v_mfma_f32_16x16x32_bf16 v[60:63], a[192:195], v[20:23], v[60:63]
s_waitcnt lgkmcnt(5)
v_mfma_f32_16x16x32_bf16 v[48:51], a[68:71], v[24:27], v[48:51]
ds_read_b128 v[20:23], v1 offset:41984
v_mfma_f32_16x16x32_bf16 v[52:55], a[196:199], v[24:27], v[52:55]
v_mfma_f32_16x16x32_bf16 v[56:59], a[68:71], v[28:31], v[56:59]
ds_read_b128 v[24:27], v1 offset:43008
v_mfma_f32_16x16x32_bf16 v[60:63], a[196:199], v[28:31], v[60:63]
s_waitcnt lgkmcnt(5)
v_mfma_f32_16x16x32_bf16 v[48:51], a[72:75], v[32:35], v[48:51]
ds_read_b128 v[28:31], v1 offset:44032
v_mfma_f32_16x16x32_bf16 v[52:55], a[200:203], v[32:35], v[52:55]
v_mfma_f32_16x16x32_bf16 v[56:59], a[72:75], v[36:39], v[56:59]
ds_read_b128 v[32:35], v1 offset:45056
v_mfma_f32_16x16x32_bf16 v[60:63], a[200:203], v[36:39], v[60:63]
s_waitcnt lgkmcnt(5)
v_mfma_f32_16x16x32_bf16 v[48:51], a[76:79], v[40:43], v[48:51]
ds_read_b128 v[36:39], v1 offset:46080
v_mfma_f32_16x16x32_bf16 v[52:55], a[204:207], v[40:43], v[52:55]
v_mfma_f32_16x16x32_bf16 v[56:59], a[76:79], v[44:47], v[56:59]
ds_read_b128 v[40:43], v1 offset:47104
v_mfma_f32_16x16x32_bf16 v[60:63], a[204:207], v[44:47], v[60:63]
s_waitcnt lgkmcnt(5)
v_mfma_f32_16x16x32_bf16 v[48:51], a[80:83], v[16:19], v[48:51]
ds_read_b128 v[44:47], v1 offset:48128
v_mfma_f32_16x16x32_bf16 v[52:55], a[208:211], v[16:19], v[52:55]
v_mfma_f32_16x16x32_bf16 v[56:59], a[80:83], v[20:23], v[56:59]
s_waitcnt vmcnt(1)
s_barrier
ds_read_b128 v[16:19], v1 offset:49152
v_mfma_f32_16x16x32_bf16 v[60:63], a[208:211], v[20:23], v[60:63]
s_waitcnt lgkmcnt(5)
v_mfma_f32_16x16x32_bf16 v[48:51], a[84:87], v[24:27], v[48:51]
ds_read_b128 v[20:23], v1 offset:50176
v_mfma_f32_16x16x32_bf16 v[52:55], a[212:215], v[24:27], v[52:55]
v_mfma_f32_16x16x32_bf16 v[56:59], a[84:87], v[28:31], v[56:59]
ds_read_b128 v[24:27], v1 offset:51200
v_mfma_f32_16x16x32_bf16 v[60:63], a[212:215], v[28:31], v[60:63]
s_waitcnt lgkmcnt(5)
v_mfma_f32_16x16x32_bf16 v[48:51], a[88:91], v[32:35], v[48:51]
ds_read_b128 v[28:31], v1 offset:52224
v_mfma_f32_16x16x32_bf16 v[52:55], a[216:219], v[32:35], v[52:55]
v_mfma_f32_16x16x32_bf16 v[56:59], a[88:91], v[36:39], v[56:59]
ds_read_b128 v[32:35], v1 offset:53248
v_mfma_f32_16x16x32_bf16 v[60:63], a[216:219], v[36:39], v[60:63]
s_waitcnt lgkmcnt(5)
v_mfma_f32_16x16x32_bf16 v[48:51], a[92:95], v[40:43], v[48:51]
ds_read_b128 v[36:39], v1 offset:54272
buffer_load_dword v3, v2, s[4:7], s47 offen sc1
v_mfma_f32_16x16x32_bf16 v[52:55], a[220:223], v[40:43], v[52:55]
v_mfma_f32_16x16x32_bf16 v[56:59], a[92:95], v[44:47], v[56:59]
ds_read_b128 v[40:43], v1 offset:55296
v_mfma_f32_16x16x32_bf16 v[60:63], a[220:223], v[44:47], v[60:63]
s_waitcnt lgkmcnt(5)
v_mfma_f32_16x16x32_bf16 v[48:51], a[96:99], v[16:19], v[48:51]
ds_read_b128 v[44:47], v1 offset:56320
v_mfma_f32_16x16x32_bf16 v[52:55], a[224:227], v[16:19], v[52:55]
v_mfma_f32_16x16x32_bf16 v[56:59], a[96:99], v[20:23], v[56:59]
ds_read_b128 v[16:19], v1 offset:57344
v_mfma_f32_16x16x32_bf16 v[60:63], a[224:227], v[20:23], v[60:63]
s_waitcnt lgkmcnt(5)
v_mfma_f32_16x16x32_bf16 v[48:51], a[100:103], v[24:27], v[48:51]
ds_read_b128 v[20:23], v1 offset:58368
v_mfma_f32_16x16x32_bf16 v[52:55], a[228:231], v[24:27], v[52:55]
v_mfma_f32_16x16x32_bf16 v[56:59], a[100:103], v[28:31], v[56:59]
ds_read_b128 v[24:27], v1 offset:59392
v_mfma_f32_16x16x32_bf16 v[60:63], a[228:231], v[28:31], v[60:63]
s_waitcnt lgkmcnt(5)
v_mfma_f32_16x16x32_bf16 v[48:51], a[104:107], v[32:35], v[48:51]
ds_read_b128 v[28:31], v1 offset:60416
v_mfma_f32_16x16x32_bf16 v[52:55], a[232:235], v[32:35], v[52:55]
v_mfma_f32_16x16x32_bf16 v[56:59], a[104:107], v[36:39], v[56:59]
ds_read_b128 v[32:35], v1 offset:61440
v_mfma_f32_16x16x32_bf16 v[60:63], a[232:235], v[36:39], v[60:63]
s_waitcnt lgkmcnt(5)
v_mfma_f32_16x16x32_bf16 v[48:51], a[108:111], v[40:43], v[48:51]
ds_read_b128 v[36:39], v1 offset:62464
v_mfma_f32_16x16x32_bf16 v[52:55], a[236:239], v[40:43], v[52:55]
v_mfma_f32_16x16x32_bf16 v[56:59], a[108:111], v[44:47], v[56:59]
ds_read_b128 v[40:43], v1 offset:63488
v_mfma_f32_16x16x32_bf16 v[60:63], a[236:239], v[44:47], v[60:63]
s_waitcnt lgkmcnt(5)
v_mfma_f32_16x16x32_bf16 v[48:51], a[112:115], v[16:19], v[48:51]
ds_read_b128 v[44:47], v1 offset:64512
v_mfma_f32_16x16x32_bf16 v[52:55], a[240:243], v[16:19], v[52:55]
v_mfma_f32_16x16x32_bf16 v[56:59], a[112:115], v[20:23], v[56:59]
v_mfma_f32_16x16x32_bf16 v[60:63], a[240:243], v[20:23], v[60:63]
s_waitcnt lgkmcnt(4)
v_mfma_f32_16x16x32_bf16 v[48:51], a[116:119], v[24:27], v[48:51]
v_mfma_f32_16x16x32_bf16 v[52:55], a[244:247], v[24:27], v[52:55]
v_mfma_f32_16x16x32_bf16 v[56:59], a[116:119], v[28:31], v[56:59]
v_mfma_f32_16x16x32_bf16 v[60:63], a[244:247], v[28:31], v[60:63]
s_waitcnt lgkmcnt(2)
v_mfma_f32_16x16x32_bf16 v[48:51], a[120:123], v[32:35], v[48:51]
v_mfma_f32_16x16x32_bf16 v[52:55], a[248:251], v[32:35], v[52:55]
v_mfma_f32_16x16x32_bf16 v[56:59], a[120:123], v[36:39], v[56:59]
v_mfma_f32_16x16x32_bf16 v[60:63], a[248:251], v[36:39], v[60:63]
s_waitcnt lgkmcnt(0)
v_mfma_f32_16x16x32_bf16 v[48:51], a[124:127], v[40:43], v[48:51]
v_mfma_f32_16x16x32_bf16 v[52:55], a[252:255], v[40:43], v[52:55]
v_mfma_f32_16x16x32_bf16 v[56:59], a[124:127], v[44:47], v[56:59]
v_mfma_f32_16x16x32_bf16 v[60:63], a[252:255], v[44:47], v[60:63]
v_xor_b32 v1, 0x10000, v1
v_mov_b32 v5, s36
s_waitcnt vmcnt(0)
v_cmp_gt_u32 vcc, s48, v3
v_add_u32 v8, 1, v8
s_cmp_lg_u32 s35, 0
s_cbranch_scc1 Llf_574
buffer_store_dword v8, v7, s[4:7], 0 offen
s_branch Llo_575
Llf_574:
buffer_store_dword v8, v7, s[4:7], 0 offen sc1
Llo_575:
s_nop 3
v_cvt_pk_bf16_f32 v80, v48, v49
v_cvt_pk_bf16_f32 v81, v50, v51
v_cvt_pk_bf16_f32 v82, v52, v53
v_cvt_pk_bf16_f32 v83, v54, v55
buffer_store_dwordx4 v[80:83], v6, s[4:7], s49 offen offset:0 sc1
v_cvt_pk_bf16_f32 v84, v56, v57
v_cvt_pk_bf16_f32 v85, v58, v59
v_cvt_pk_bf16_f32 v86, v60, v61
v_cvt_pk_bf16_f32 v87, v62, v63
buffer_store_dwordx4 v[84:87], v6, s[4:7], s49 offen offset:1024 sc1
s_mov_b32 s46, 0
s_cbranch_vccnz Lsk_570
s_mov_b32 s46, 1
s_add_u32 m0, s50, 0
s_add_u32 s39, s54, 0
buffer_load_dwordx4 v0, s[4:7], s39 offen offset:0 sc1 lds
buffer_load_dwordx4 v0, s[4:7], s39 offen offset:1024 sc1 lds
buffer_load_dwordx4 v0, s[4:7], s39 offen offset:2048 sc1 lds
buffer_load_dwordx4 v0, s[4:7], s39 offen offset:3072 sc1 lds
s_add_u32 m0, s50, 16384
s_add_u32 s39, s54, 16384
buffer_load_dwordx4 v0, s[4:7], s39 offen offset:0 sc1 lds
buffer_load_dwordx4 v0, s[4:7], s39 offen offset:1024 sc1 lds
buffer_load_dwordx4 v0, s[4:7], s39 offen offset:2048 sc1 lds
buffer_load_dwordx4 v0, s[4:7], s39 offen offset:3072 sc1 lds
s_add_u32 m0, s50, 32768
s_add_u32 s39, s54, 32768
buffer_load_dwordx4 v0, s[4:7], s39 offen offset:0 sc1 lds
buffer_load_dwordx4 v0, s[4:7], s39 offen offset:1024 sc1 lds
buffer_load_dwordx4 v0, s[4:7], s39 offen offset:2048 sc1 lds
buffer_load_dwordx4 v0, s[4:7], s39 offen offset:3072 sc1 lds
s_add_u32 m0, s50, 49152
s_add_u32 s39, s54, 49152
buffer_load_dwordx4 v0, s[4:7], s39 offen offset:0 sc1 lds
buffer_load_dwordx4 v0, s[4:7], s39 offen offset:1024 sc1 lds
buffer_load_dwordx4 v0, s[4:7], s39 offen offset:2048 sc1 lds
buffer_load_dwordx4 v0, s[4:7], s39 offen offset:3072 sc1 lds
s_waitcnt vmcnt(16)
s_branch Lsj_571
Lsk_570:
s_waitcnt vmcnt(0)
Lsj_571:
s_barrier
s_and_b32 s38, s36, 1
s_lshl_b32 s38, s38, 12
buffer_store_dword v5, v4, s[4:7], s38 offen sc1
s_cmp_eq_u32 s36, 64
s_cbranch_scc1 Lso_569
s_cmp_lg_u32 s46, 0
s_cbranch_scc1 Lse_568
s_branch Lsw_567
Lso_569:
s_endpgm
Lhi_4:
s_cmp_ge_u32 s34, 16
s_cbranch_scc1 Lhelper_5
v_mov_b32 v9, v1
s_sub_u32 s44, s33, 4
s_lshl_b32 s44, s44, 4
s_add_u32 s44, s44, s34
s_lshl_b32 s38, s44, 7
s_add_u32 s38, s38, 3407872
v_min_u32 v80, 1, v0
v_lshl_add_u32 v4, v80, 30, s38
v_mov_b32 v5, 0
buffer_store_dword v5, v4, s[4:7], 0 offen sc1
s_mov_b32 s52, 1
s_waitcnt vmcnt(0)
s_cmp_lg_u32 s32, 0
s_cbranch_scc1 Lar_576
s_mov_b64 exec, 1
v_mov_b32 v48, 160
v_mov_b32 v49, s52
buffer_atomic_add v49, v48, s[12:15], 0 offen sc1
s_mov_b64 exec, -1
Lar_576:
s_mov_b32 s8, s18
s_and_b32 s9, s19, 0xffff
s_mov_b32 s10, 0x800000
s_mov_b32 s11, 0x20000
s_mov_b32 s84, s20
s_and_b32 s85, s21, 0xffff
s_mov_b32 s86, 0x800000
s_mov_b32 s87, 0x20000
s_mov_b32 s88, s22
s_and_b32 s89, s23, 0xffff
s_mov_b32 s90, 0x800000
s_mov_b32 s91, 0x20000
s_lshl_b32 s60, s44, 7
s_xor_b32 s61, s60, 512
s_xor_b32 s62, s60, 256
s_lshr_b32 s52, s32, 1
s_lshl_b32 s52, s52, 14
s_and_b32 s53, s32, 1
s_lshl_b32 s53, s53, 6
s_add_u32 s52, s52, s53
v_bfe_u32 v84, v9, 2, 2
v_lshrrev_b32 v85, 4, v9
v_lshl_add_u32 v84, v85, 3, v84
v_lshl_add_u32 v84, v84, 7, s52
v_and_b32 v85, 3, v9
v_lshl_add_u32 v84, v85, 3, v84
v_add_u32 v80, 0, v84
v_bfe_u32 v84, v9, 2, 2
v_lshrrev_b32 v85, 4, v9
v_lshl_add_u32 v84, v85, 3, v84
v_lshl_add_u32 v84, v84, 7, s52
v_and_b32 v85, 3, v9
v_lshl_add_u32 v84, v85, 3, v84
v_add_u32 v81, 32, v84
s_lshl_b32 s52, s32, 5
v_bfe_u32 v84, v9, 2, 2
v_lshrrev_b32 v85, 4, v9
v_lshl_add_u32 v84, v85, 3, v84
v_lshl_add_u32 v84, v84, 7, s52
v_and_b32 v85, 3, v9
v_lshl_add_u32 v84, v85, 3, v84
v_add_u32 v82, 32768, v84
v_lshrrev_b32 v84, 3, v9
s_mul_i32 s38, s32, 256
v_add_u32 v84, s38, v84
v_mul_u32_u24 v84, 8192, v84
v_and_b32 v85, 7, v9
v_lshl_add_u32 v84, v85, 4, v84
s_lshl_b32 s38, s32, 12
s_barrier
s_add_u32 m0, s38, 0
s_add_u32 s39, s60, 0
buffer_load_dwordx4 v84, s[8:11], s39 offen lds
s_add_u32 m0, s38, 1024
s_add_u32 s39, s60, 65536
buffer_load_dwordx4 v84, s[8:11], s39 offen lds
s_add_u32 m0, s38, 2048
s_add_u32 s39, s60, 131072
buffer_load_dwordx4 v84, s[8:11], s39 offen lds
s_add_u32 m0, s38, 3072
s_add_u32 s39, s60, 196608
buffer_load_dwordx4 v84, s[8:11], s39 offen lds
s_add_u32 m0, s38, 16384
s_add_u32 s39, s61, 0
buffer_load_dwordx4 v84, s[84:87], s39 offen lds
s_add_u32 m0, s38, 17408
s_add_u32 s39, s61, 65536
buffer_load_dwordx4 v84, s[84:87], s39 offen lds
s_add_u32 m0, s38, 18432
s_add_u32 s39, s61, 131072
buffer_load_dwordx4 v84, s[84:87], s39 offen lds
s_add_u32 m0, s38, 19456
s_add_u32 s39, s61, 196608
buffer_load_dwordx4 v84, s[84:87], s39 offen lds
s_add_u32 m0, s38, 32768
s_add_u32 s39, s62, 0
buffer_load_dwordx4 v84, s[88:91], s39 offen lds
s_add_u32 m0, s38, 33792
s_add_u32 s39, s62, 65536
buffer_load_dwordx4 v84, s[88:91], s39 offen lds
s_add_u32 m0, s38, 34816
s_add_u32 s39, s62, 131072
buffer_load_dwordx4 v84, s[88:91], s39 offen lds
s_add_u32 m0, s38, 35840
s_add_u32 s39, s62, 196608
buffer_load_dwordx4 v84, s[88:91], s39 offen lds
s_add_u32 m0, s38, 49152
s_add_u32 s39, s60, 262144
buffer_load_dwordx4 v84, s[8:11], s39 offen lds
s_add_u32 m0, s38, 50176
s_add_u32 s39, s60, 327680
buffer_load_dwordx4 v84, s[8:11], s39 offen lds
s_add_u32 m0, s38, 51200
s_add_u32 s39, s60, 393216
buffer_load_dwordx4 v84, s[8:11], s39 offen lds
s_add_u32 m0, s38, 52224
s_add_u32 s39, s60, 458752
buffer_load_dwordx4 v84, s[8:11], s39 offen lds
s_add_u32 m0, s38, 65536
s_add_u32 s39, s61, 262144
buffer_load_dwordx4 v84, s[84:87], s39 offen lds
s_add_u32 m0, s38, 66560
s_add_u32 s39, s61, 327680
buffer_load_dwordx4 v84, s[84:87], s39 offen lds
s_add_u32 m0, s38, 67584
s_add_u32 s39, s61, 393216
buffer_load_dwordx4 v84, s[84:87], s39 offen lds
s_add_u32 m0, s38, 68608
s_add_u32 s39, s61, 458752
buffer_load_dwordx4 v84, s[84:87], s39 offen lds
s_add_u32 m0, s38, 81920
s_add_u32 s39, s62, 262144
buffer_load_dwordx4 v84, s[88:91], s39 offen lds
s_add_u32 m0, s38, 82944
s_add_u32 s39, s62, 327680
buffer_load_dwordx4 v84, s[88:91], s39 offen lds
s_add_u32 m0, s38, 83968
s_add_u32 s39, s62, 393216
buffer_load_dwordx4 v84, s[88:91], s39 offen lds
s_add_u32 m0, s38, 84992
s_add_u32 s39, s62, 458752
buffer_load_dwordx4 v84, s[88:91], s39 offen lds
s_add_u32 m0, s38, 98304
s_add_u32 s39, s60, 524288
buffer_load_dwordx4 v84, s[8:11], s39 offen lds
s_add_u32 m0, s38, 99328
s_add_u32 s39, s60, 589824
buffer_load_dwordx4 v84, s[8:11], s39 offen lds
s_add_u32 m0, s38, 100352
s_add_u32 s39, s60, 655360
buffer_load_dwordx4 v84, s[8:11], s39 offen lds
s_add_u32 m0, s38, 101376
s_add_u32 s39, s60, 720896
buffer_load_dwordx4 v84, s[8:11], s39 offen lds
s_add_u32 m0, s38, 114688
s_add_u32 s39, s61, 524288
buffer_load_dwordx4 v84, s[84:87], s39 offen lds
s_add_u32 m0, s38, 115712
s_add_u32 s39, s61, 589824
buffer_load_dwordx4 v84, s[84:87], s39 offen lds
s_add_u32 m0, s38, 116736
s_add_u32 s39, s61, 655360
buffer_load_dwordx4 v84, s[84:87], s39 offen lds
s_add_u32 m0, s38, 117760
s_add_u32 s39, s61, 720896
buffer_load_dwordx4 v84, s[84:87], s39 offen lds
s_add_u32 m0, s38, 131072
s_add_u32 s39, s62, 524288
buffer_load_dwordx4 v84, s[88:91], s39 offen lds
s_add_u32 m0, s38, 132096
s_add_u32 s39, s62, 589824
buffer_load_dwordx4 v84, s[88:91], s39 offen lds
s_add_u32 m0, s38, 133120
s_add_u32 s39, s62, 655360
buffer_load_dwordx4 v84, s[88:91], s39 offen lds
s_add_u32 m0, s38, 134144
s_add_u32 s39, s62, 720896
buffer_load_dwordx4 v84, s[88:91], s39 offen lds
s_waitcnt vmcnt(24)
s_barrier
ds_read_b64_tr_b16 a[0:1], v80 offset:0
ds_read_b64_tr_b16 a[2:3], v80 offset:512
ds_read_b64_tr_b16 a[32:33], v80 offset:4096
ds_read_b64_tr_b16 a[34:35], v80 offset:4608
ds_read_b64_tr_b16 a[64:65], v80 offset:8192
ds_read_b64_tr_b16 a[66:67], v80 offset:8704
ds_read_b64_tr_b16 a[96:97], v80 offset:12288
ds_read_b64_tr_b16 a[98:99], v80 offset:12800
ds_read_b64_tr_b16 a[128:129], v81 offset:0
ds_read_b64_tr_b16 a[130:131], v81 offset:512
ds_read_b64_tr_b16 a[160:161], v81 offset:4096
ds_read_b64_tr_b16 a[162:163], v81 offset:4608
ds_read_b64_tr_b16 a[192:193], v81 offset:8192
ds_read_b64_tr_b16 a[194:195], v81 offset:8704
ds_read_b64_tr_b16 a[224:225], v81 offset:12288
ds_read_b64_tr_b16 a[226:227], v81 offset:12800
ds_read_b64_tr_b16 v[128:129], v82 offset:0
ds_read_b64_tr_b16 v[130:131], v82 offset:512
ds_read_b64_tr_b16 v[160:161], v82 offset:4096
ds_read_b64_tr_b16 v[162:163], v82 offset:4608
ds_read_b64_tr_b16 v[192:193], v82 offset:8192
ds_read_b64_tr_b16 v[194:195], v82 offset:8704
ds_read_b64_tr_b16 v[224:225], v82 offset:12288
ds_read_b64_tr_b16 v[226:227], v82 offset:12800
v_add_u32 v80, 49152, v80
v_add_u32 v81, 49152, v81
v_add_u32 v82, 49152, v82
s_waitcnt lgkmcnt(0)
s_barrier
s_add_u32 m0, s38, 0
s_add_u32 s39, s60, 786432
buffer_load_dwordx4 v84, s[8:11], s39 offen lds
s_add_u32 m0, s38, 1024
s_add_u32 s39, s60, 851968
buffer_load_dwordx4 v84, s[8:11], s39 offen lds
s_add_u32 m0, s38, 2048
s_add_u32 s39, s60, 917504
buffer_load_dwordx4 v84, s[8:11], s39 offen lds
s_add_u32 m0, s38, 3072
s_add_u32 s39, s60, 983040
buffer_load_dwordx4 v84, s[8:11], s39 offen lds
s_add_u32 m0, s38, 16384
s_add_u32 s39, s61, 786432
buffer_load_dwordx4 v84, s[84:87], s39 offen lds
s_add_u32 m0, s38, 17408
s_add_u32 s39, s61, 851968
buffer_load_dwordx4 v84, s[84:87], s39 offen lds
s_add_u32 m0, s38, 18432
s_add_u32 s39, s61, 917504
buffer_load_dwordx4 v84, s[84:87], s39 offen lds
s_add_u32 m0, s38, 19456
s_add_u32 s39, s61, 983040
buffer_load_dwordx4 v84, s[84:87], s39 offen lds
s_add_u32 m0, s38, 32768
s_add_u32 s39, s62, 786432
buffer_load_dwordx4 v84, s[88:91], s39 offen lds
s_add_u32 m0, s38, 33792
s_add_u32 s39, s62, 851968
buffer_load_dwordx4 v84, s[88:91], s39 offen lds
s_add_u32 m0, s38, 34816
s_add_u32 s39, s62, 917504
buffer_load_dwordx4 v84, s[88:91], s39 offen lds
s_add_u32 m0, s38, 35840
s_add_u32 s39, s62, 983040
buffer_load_dwordx4 v84, s[88:91], s39 offen lds
s_waitcnt vmcnt(24)
s_barrier
ds_read_b64_tr_b16 a[4:5], v80 offset:0
ds_read_b64_tr_b16 a[6:7], v80 offset:512
ds_read_b64_tr_b16 a[36:37], v80 offset:4096
ds_read_b64_tr_b16 a[38:39], v80 offset:4608
ds_read_b64_tr_b16 a[68:69], v80 offset:8192
ds_read_b64_tr_b16 a[70:71], v80 offset:8704
ds_read_b64_tr_b16 a[100:101], v80 offset:12288
ds_read_b64_tr_b16 a[102:103], v80 offset:12800
ds_read_b64_tr_b16 a[132:133], v81 offset:0
ds_read_b64_tr_b16 a[134:135], v81 offset:512
ds_read_b64_tr_b16 a[164:165], v81 offset:4096
ds_read_b64_tr_b16 a[166:167], v81 offset:4608
ds_read_b64_tr_b16 a[196:197], v81 offset:8192
ds_read_b64_tr_b16 a[198:199], v81 offset:8704
ds_read_b64_tr_b16 a[228:229], v81 offset:12288
ds_read_b64_tr_b16 a[230:231], v81 offset:12800
ds_read_b64_tr_b16 v[132:133], v82 offset:0
ds_read_b64_tr_b16 v[134:135], v82 offset:512
ds_read_b64_tr_b16 v[164:165], v82 offset:4096
ds_read_b64_tr_b16 v[166:167], v82 offset:4608
ds_read_b64_tr_b16 v[196:197], v82 offset:8192
ds_read_b64_tr_b16 v[198:199], v82 offset:8704
ds_read_b64_tr_b16 v[228:229], v82 offset:12288
ds_read_b64_tr_b16 v[230:231], v82 offset:12800
v_add_u32 v80, 49152, v80
v_add_u32 v81, 49152, v81
v_add_u32 v82, 49152, v82
s_waitcnt lgkmcnt(0)
s_barrier
s_add_u32 m0, s38, 49152
s_add_u32 s39, s60, 1048576
buffer_load_dwordx4 v84, s[8:11], s39 offen lds
s_add_u32 m0, s38, 50176
s_add_u32 s39, s60, 1114112
buffer_load_dwordx4 v84, s[8:11], s39 offen lds
s_add_u32 m0, s38, 51200
s_add_u32 s39, s60, 1179648
buffer_load_dwordx4 v84, s[8:11], s39 offen lds
s_add_u32 m0, s38, 52224
s_add_u32 s39, s60, 1245184
buffer_load_dwordx4 v84, s[8:11], s39 offen lds
s_add_u32 m0, s38, 65536
s_add_u32 s39, s61, 1048576
buffer_load_dwordx4 v84, s[84:87], s39 offen lds
s_add_u32 m0, s38, 66560
s_add_u32 s39, s61, 1114112
buffer_load_dwordx4 v84, s[84:87], s39 offen lds
s_add_u32 m0, s38, 67584
s_add_u32 s39, s61, 1179648
buffer_load_dwordx4 v84, s[84:87], s39 offen lds
s_add_u32 m0, s38, 68608
s_add_u32 s39, s61, 1245184
buffer_load_dwordx4 v84, s[84:87], s39 offen lds
s_add_u32 m0, s38, 81920
s_add_u32 s39, s62, 1048576
buffer_load_dwordx4 v84, s[88:91], s39 offen lds
s_add_u32 m0, s38, 82944
s_add_u32 s39, s62, 1114112
buffer_load_dwordx4 v84, s[88:91], s39 offen lds
s_add_u32 m0, s38, 83968
s_add_u32 s39, s62, 1179648
buffer_load_dwordx4 v84, s[88:91], s39 offen lds
s_add_u32 m0, s38, 84992
s_add_u32 s39, s62, 1245184
buffer_load_dwordx4 v84, s[88:91], s39 offen lds
s_waitcnt vmcnt(24)
s_barrier
ds_read_b64_tr_b16 a[8:9], v80 offset:0
ds_read_b64_tr_b16 a[10:11], v80 offset:512
ds_read_b64_tr_b16 a[40:41], v80 offset:4096
ds_read_b64_tr_b16 a[42:43], v80 offset:4608
ds_read_b64_tr_b16 a[72:73], v80 offset:8192
ds_read_b64_tr_b16 a[74:75], v80 offset:8704
ds_read_b64_tr_b16 a[104:105], v80 offset:12288
ds_read_b64_tr_b16 a[106:107], v80 offset:12800
ds_read_b64_tr_b16 a[136:137], v81 offset:0
ds_read_b64_tr_b16 a[138:139], v81 offset:512
ds_read_b64_tr_b16 a[168:169], v81 offset:4096
ds_read_b64_tr_b16 a[170:171], v81 offset:4608
ds_read_b64_tr_b16 a[200:201], v81 offset:8192
ds_read_b64_tr_b16 a[202:203], v81 offset:8704
ds_read_b64_tr_b16 a[232:233], v81 offset:12288
ds_read_b64_tr_b16 a[234:235], v81 offset:12800
ds_read_b64_tr_b16 v[136:137], v82 offset:0
ds_read_b64_tr_b16 v[138:139], v82 offset:512
ds_read_b64_tr_b16 v[168:169], v82 offset:4096
ds_read_b64_tr_b16 v[170:171], v82 offset:4608
ds_read_b64_tr_b16 v[200:201], v82 offset:8192
ds_read_b64_tr_b16 v[202:203], v82 offset:8704
ds_read_b64_tr_b16 v[232:233], v82 offset:12288
ds_read_b64_tr_b16 v[234:235], v82 offset:12800
v_add_u32 v80, -98304, v80
v_add_u32 v81, -98304, v81
v_add_u32 v82, -98304, v82
s_waitcnt lgkmcnt(0)
s_barrier
s_add_u32 m0, s38, 98304
s_add_u32 s39, s60, 1310720
buffer_load_dwordx4 v84, s[8:11], s39 offen lds
s_add_u32 m0, s38, 99328
s_add_u32 s39, s60, 1376256
buffer_load_dwordx4 v84, s[8:11], s39 offen lds
s_add_u32 m0, s38, 100352
s_add_u32 s39, s60, 1441792
buffer_load_dwordx4 v84, s[8:11], s39 offen lds
s_add_u32 m0, s38, 101376
s_add_u32 s39, s60, 1507328
buffer_load_dwordx4 v84, s[8:11], s39 offen lds
s_add_u32 m0, s38, 114688
s_add_u32 s39, s61, 1310720
buffer_load_dwordx4 v84, s[84:87], s39 offen lds
s_add_u32 m0, s38, 115712
s_add_u32 s39, s61, 1376256
buffer_load_dwordx4 v84, s[84:87], s39 offen lds
s_add_u32 m0, s38, 116736
s_add_u32 s39, s61, 1441792
buffer_load_dwordx4 v84, s[84:87], s39 offen lds
s_add_u32 m0, s38, 117760
s_add_u32 s39, s61, 1507328
buffer_load_dwordx4 v84, s[84:87], s39 offen lds
s_add_u32 m0, s38, 131072
s_add_u32 s39, s62, 1310720
buffer_load_dwordx4 v84, s[88:91], s39 offen lds
s_add_u32 m0, s38, 132096
s_add_u32 s39, s62, 1376256
buffer_load_dwordx4 v84, s[88:91], s39 offen lds
s_add_u32 m0, s38, 133120
s_add_u32 s39, s62, 1441792
buffer_load_dwordx4 v84, s[88:91], s39 offen lds
s_add_u32 m0, s38, 134144
s_add_u32 s39, s62, 1507328
buffer_load_dwordx4 v84, s[88:91], s39 offen lds
s_waitcnt vmcnt(24)
s_barrier
ds_read_b64_tr_b16 a[12:13], v80 offset:0
ds_read_b64_tr_b16 a[14:15], v80 offset:512
ds_read_b64_tr_b16 a[44:45], v80 offset:4096
ds_read_b64_tr_b16 a[46:47], v80 offset:4608
ds_read_b64_tr_b16 a[76:77], v80 offset:8192
ds_read_b64_tr_b16 a[78:79], v80 offset:8704
ds_read_b64_tr_b16 a[108:109], v80 offset:12288
ds_read_b64_tr_b16 a[110:111], v80 offset:12800
ds_read_b64_tr_b16 a[140:141], v81 offset:0
ds_read_b64_tr_b16 a[142:143], v81 offset:512
ds_read_b64_tr_b16 a[172:173], v81 offset:4096
ds_read_b64_tr_b16 a[174:175], v81 offset:4608
ds_read_b64_tr_b16 a[204:205], v81 offset:8192
ds_read_b64_tr_b16 a[206:207], v81 offset:8704
ds_read_b64_tr_b16 a[236:237], v81 offset:12288
ds_read_b64_tr_b16 a[238:239], v81 offset:12800
ds_read_b64_tr_b16 v[140:141], v82 offset:0
ds_read_b64_tr_b16 v[142:143], v82 offset:512
ds_read_b64_tr_b16 v[172:173], v82 offset:4096
ds_read_b64_tr_b16 v[174:175], v82 offset:4608
ds_read_b64_tr_b16 v[204:205], v82 offset:8192
ds_read_b64_tr_b16 v[206:207], v82 offset:8704
ds_read_b64_tr_b16 v[236:237], v82 offset:12288
ds_read_b64_tr_b16 v[238:239], v82 offset:12800
v_add_u32 v80, 49152, v80
v_add_u32 v81, 49152, v81
v_add_u32 v82, 49152, v82
s_waitcnt lgkmcnt(0)
s_barrier
s_add_u32 m0, s38, 0
s_add_u32 s39, s60, 1572864
buffer_load_dwordx4 v84, s[8:11], s39 offen lds
s_add_u32 m0, s38, 1024
s_add_u32 s39, s60, 1638400
buffer_load_dwordx4 v84, s[8:11], s39 offen lds
s_add_u32 m0, s38, 2048
s_add_u32 s39, s60, 1703936
buffer_load_dwordx4 v84, s[8:11], s39 offen lds
s_add_u32 m0, s38, 3072
s_add_u32 s39, s60, 1769472
buffer_load_dwordx4 v84, s[8:11], s39 offen lds
s_add_u32 m0, s38, 16384
s_add_u32 s39, s61, 1572864
buffer_load_dwordx4 v84, s[84:87], s39 offen lds
s_add_u32 m0, s38, 17408
s_add_u32 s39, s61, 1638400
buffer_load_dwordx4 v84, s[84:87], s39 offen lds
s_add_u32 m0, s38, 18432
s_add_u32 s39, s61, 1703936
buffer_load_dwordx4 v84, s[84:87], s39 offen lds
s_add_u32 m0, s38, 19456
s_add_u32 s39, s61, 1769472
buffer_load_dwordx4 v84, s[84:87], s39 offen lds
s_add_u32 m0, s38, 32768
s_add_u32 s39, s62, 1572864
buffer_load_dwordx4 v84, s[88:91], s39 offen lds
s_add_u32 m0, s38, 33792
s_add_u32 s39, s62, 1638400
buffer_load_dwordx4 v84, s[88:91], s39 offen lds
s_add_u32 m0, s38, 34816
s_add_u32 s39, s62, 1703936
buffer_load_dwordx4 v84, s[88:91], s39 offen lds
s_add_u32 m0, s38, 35840
s_add_u32 s39, s62, 1769472
buffer_load_dwordx4 v84, s[88:91], s39 offen lds
s_waitcnt vmcnt(24)
s_barrier
ds_read_b64_tr_b16 a[16:17], v80 offset:0
ds_read_b64_tr_b16 a[18:19], v80 offset:512
ds_read_b64_tr_b16 a[48:49], v80 offset:4096
ds_read_b64_tr_b16 a[50:51], v80 offset:4608
ds_read_b64_tr_b16 a[80:81], v80 offset:8192
ds_read_b64_tr_b16 a[82:83], v80 offset:8704
ds_read_b64_tr_b16 a[112:113], v80 offset:12288
ds_read_b64_tr_b16 a[114:115], v80 offset:12800
ds_read_b64_tr_b16 a[144:145], v81 offset:0
ds_read_b64_tr_b16 a[146:147], v81 offset:512
ds_read_b64_tr_b16 a[176:177], v81 offset:4096
ds_read_b64_tr_b16 a[178:179], v81 offset:4608
ds_read_b64_tr_b16 a[208:209], v81 offset:8192
ds_read_b64_tr_b16 a[210:211], v81 offset:8704
ds_read_b64_tr_b16 a[240:241], v81 offset:12288
ds_read_b64_tr_b16 a[242:243], v81 offset:12800
ds_read_b64_tr_b16 v[144:145], v82 offset:0
ds_read_b64_tr_b16 v[146:147], v82 offset:512
ds_read_b64_tr_b16 v[176:177], v82 offset:4096
ds_read_b64_tr_b16 v[178:179], v82 offset:4608
ds_read_b64_tr_b16 v[208:209], v82 offset:8192
ds_read_b64_tr_b16 v[210:211], v82 offset:8704
ds_read_b64_tr_b16 v[240:241], v82 offset:12288
ds_read_b64_tr_b16 v[242:243], v82 offset:12800
v_add_u32 v80, 49152, v80
v_add_u32 v81, 49152, v81
v_add_u32 v82, 49152, v82
s_waitcnt lgkmcnt(0)
s_barrier
s_add_u32 m0, s38, 49152
s_add_u32 s39, s60, 1835008
buffer_load_dwordx4 v84, s[8:11], s39 offen lds
s_add_u32 m0, s38, 50176
s_add_u32 s39, s60, 1900544
buffer_load_dwordx4 v84, s[8:11], s39 offen lds
s_add_u32 m0, s38, 51200
s_add_u32 s39, s60, 1966080
buffer_load_dwordx4 v84, s[8:11], s39 offen lds
s_add_u32 m0, s38, 52224
s_add_u32 s39, s60, 2031616
buffer_load_dwordx4 v84, s[8:11], s39 offen lds
s_add_u32 m0, s38, 65536
s_add_u32 s39, s61, 1835008
buffer_load_dwordx4 v84, s[84:87], s39 offen lds
s_add_u32 m0, s38, 66560
s_add_u32 s39, s61, 1900544
buffer_load_dwordx4 v84, s[84:87], s39 offen lds
s_add_u32 m0, s38, 67584
s_add_u32 s39, s61, 1966080
buffer_load_dwordx4 v84, s[84:87], s39 offen lds
s_add_u32 m0, s38, 68608
s_add_u32 s39, s61, 2031616
buffer_load_dwordx4 v84, s[84:87], s39 offen lds
s_add_u32 m0, s38, 81920
s_add_u32 s39, s62, 1835008
buffer_load_dwordx4 v84, s[88:91], s39 offen lds
s_add_u32 m0, s38, 82944
s_add_u32 s39, s62, 1900544
buffer_load_dwordx4 v84, s[88:91], s39 offen lds
s_add_u32 m0, s38, 83968
s_add_u32 s39, s62, 1966080
buffer_load_dwordx4 v84, s[88:91], s39 offen lds
s_add_u32 m0, s38, 84992
s_add_u32 s39, s62, 2031616
buffer_load_dwordx4 v84, s[88:91], s39 offen lds
s_waitcnt vmcnt(24)
s_barrier
ds_read_b64_tr_b16 a[20:21], v80 offset:0
ds_read_b64_tr_b16 a[22:23], v80 offset:512
ds_read_b64_tr_b16 a[52:53], v80 offset:4096
ds_read_b64_tr_b16 a[54:55], v80 offset:4608
ds_read_b64_tr_b16 a[84:85], v80 offset:8192
ds_read_b64_tr_b16 a[86:87], v80 offset:8704
ds_read_b64_tr_b16 a[116:117], v80 offset:12288
ds_read_b64_tr_b16 a[118:119], v80 offset:12800
ds_read_b64_tr_b16 a[148:149], v81 offset:0
ds_read_b64_tr_b16 a[150:151], v81 offset:512
ds_read_b64_tr_b16 a[180:181], v81 offset:4096
ds_read_b64_tr_b16 a[182:183], v81 offset:4608
ds_read_b64_tr_b16 a[212:213], v81 offset:8192
ds_read_b64_tr_b16 a[214:215], v81 offset:8704
ds_read_b64_tr_b16 a[244:245], v81 offset:12288
ds_read_b64_tr_b16 a[246:247], v81 offset:12800
ds_read_b64_tr_b16 v[148:149], v82 offset:0
ds_read_b64_tr_b16 v[150:151], v82 offset:512
ds_read_b64_tr_b16 v[180:181], v82 offset:4096
ds_read_b64_tr_b16 v[182:183], v82 offset:4608
ds_read_b64_tr_b16 v[212:213], v82 offset:8192
ds_read_b64_tr_b16 v[214:215], v82 offset:8704
ds_read_b64_tr_b16 v[244:245], v82 offset:12288
ds_read_b64_tr_b16 v[246:247], v82 offset:12800
v_add_u32 v80, -98304, v80
v_add_u32 v81, -98304, v81
v_add_u32 v82, -98304, v82
s_waitcnt lgkmcnt(0)
s_barrier
s_waitcnt vmcnt(12)
s_barrier
ds_read_b64_tr_b16 a[24:25], v80 offset:0
ds_read_b64_tr_b16 a[26:27], v80 offset:512
ds_read_b64_tr_b16 a[56:57], v80 offset:4096
ds_read_b64_tr_b16 a[58:59], v80 offset:4608
ds_read_b64_tr_b16 a[88:89], v80 offset:8192
ds_read_b64_tr_b16 a[90:91], v80 offset:8704
ds_read_b64_tr_b16 a[120:121], v80 offset:12288
ds_read_b64_tr_b16 a[122:123], v80 offset:12800
ds_read_b64_tr_b16 a[152:153], v81 offset:0
ds_read_b64_tr_b16 a[154:155], v81 offset:512
ds_read_b64_tr_b16 a[184:185], v81 offset:4096
ds_read_b64_tr_b16 a[186:187], v81 offset:4608
ds_read_b64_tr_b16 a[216:217], v81 offset:8192
ds_read_b64_tr_b16 a[218:219], v81 offset:8704
ds_read_b64_tr_b16 a[248:249], v81 offset:12288
ds_read_b64_tr_b16 a[250:251], v81 offset:12800
ds_read_b64_tr_b16 v[152:153], v82 offset:0
ds_read_b64_tr_b16 v[154:155], v82 offset:512
ds_read_b64_tr_b16 v[184:185], v82 offset:4096
ds_read_b64_tr_b16 v[186:187], v82 offset:4608
ds_read_b64_tr_b16 v[216:217], v82 offset:8192
ds_read_b64_tr_b16 v[218:219], v82 offset:8704
ds_read_b64_tr_b16 v[248:249], v82 offset:12288
ds_read_b64_tr_b16 v[250:251], v82 offset:12800
v_add_u32 v80, 49152, v80
v_add_u32 v81, 49152, v81
v_add_u32 v82, 49152, v82
s_waitcnt lgkmcnt(0)
s_barrier
s_waitcnt vmcnt(0)
s_barrier
ds_read_b64_tr_b16 a[28:29], v80 offset:0
ds_read_b64_tr_b16 a[30:31], v80 offset:512
ds_read_b64_tr_b16 a[60:61], v80 offset:4096
ds_read_b64_tr_b16 a[62:63], v80 offset:4608
ds_read_b64_tr_b16 a[92:93], v80 offset:8192
ds_read_b64_tr_b16 a[94:95], v80 offset:8704
ds_read_b64_tr_b16 a[124:125], v80 offset:12288
ds_read_b64_tr_b16 a[126:127], v80 offset:12800
ds_read_b64_tr_b16 a[156:157], v81 offset:0
ds_read_b64_tr_b16 a[158:159], v81 offset:512
ds_read_b64_tr_b16 a[188:189], v81 offset:4096
ds_read_b64_tr_b16 a[190:191], v81 offset:4608
ds_read_b64_tr_b16 a[220:221], v81 offset:8192
ds_read_b64_tr_b16 a[222:223], v81 offset:8704
ds_read_b64_tr_b16 a[252:253], v81 offset:12288
ds_read_b64_tr_b16 a[254:255], v81 offset:12800
ds_read_b64_tr_b16 v[156:157], v82 offset:0
ds_read_b64_tr_b16 v[158:159], v82 offset:512
ds_read_b64_tr_b16 v[188:189], v82 offset:4096
ds_read_b64_tr_b16 v[190:191], v82 offset:4608
ds_read_b64_tr_b16 v[220:221], v82 offset:8192
ds_read_b64_tr_b16 v[222:223], v82 offset:8704
ds_read_b64_tr_b16 v[252:253], v82 offset:12288
ds_read_b64_tr_b16 v[254:255], v82 offset:12800
v_add_u32 v80, 49152, v80
v_add_u32 v81, 49152, v81
v_add_u32 v82, 49152, v82
s_waitcnt lgkmcnt(0)
s_barrier
Lst_577:
buffer_load_dword v48, off, s[12:15], 0 offset:160 sc1
buffer_load_dword v49, off, s[12:15], 0 offset:160 sc1
s_waitcnt vmcnt(0)
v_add_u32 v48, v48, v49
s_nop 0
v_readfirstlane_b32 s38, v48
s_nop 3
s_and_b32 s39, s38, 0xffff
s_cmp_eq_u32 s39, 0x100
s_cbranch_scc1 Lso_578
s_sub_u32 s37, s37, 1
s_cbranch_scc1 Lend_7
s_sleep 8
s_branch Lst_577
Lso_578:
s_bfe_u32 s35, s38, 0x80010
s_bfe_u32 s46, s38, 0x10018
s_lshl_b32 s46, s46, 13
s_barrier
s_mul_i32 s50, s32, 4096
v_lshlrev_b32 v1, 4, v9
v_add_u32 v0, s50, v1
v_min_u32 v2, 1, v9
v_lshlrev_b32 v2, 7, v2
s_and_b32 s52, s44, 1
s_lshr_b32 s38, s32, 1
s_lshl_b32 s38, s38, 3
s_and_b32 s39, s32, 1
s_add_u32 s38, s38, s39
s_lshl_b32 s39, s52, 1
s_add_u32 s38, s38, s39
s_lshl_b32 s38, s38, 10
s_lshr_b32 s53, s44, 1
s_and_b32 s39, s32, 2
s_xor_b32 s39, s39, s53
s_mul_i32 s39, s39, 24576
s_add_u32 s38, s38, s39
v_add_u32 v6, s38, v1
v_add_u32 v7, 4096, v6
s_lshl_b32 s38, s52, 2
s_add_u32 s38, s38, s32
s_add_u32 s38, s38, 16
s_lshl_b32 s38, s38, 10
s_xor_b32 s39, s53, 1
s_mul_i32 s39, s39, 24576
s_add_u32 s38, s38, s39
v_add_u32 v8, s38, v1
s_mov_b32 s49, 32768000
s_mov_b32 s54, 8388608
s_mov_b32 s36, 0
s_add_u32 s48, s36, 0
s_and_b32 s47, s48, 31
s_lshl_b32 s47, s47, 8
s_add_u32 s47, s47, 3424256
s_lshr_b32 s48, s48, 5
s_lshl_b32 s48, 1, s48
s_add_u32 s48, s48, 1
Lsw_579:
Lbw_584:
buffer_load_dword v3, v2, s[4:7], s47 offen sc1
s_waitcnt vmcnt(0)
v_cmp_gt_u32 vcc, s48, v3
s_cbranch_vccz Lbo_585
s_sub_u32 s37, s37, 1
s_cbranch_scc1 Lend_7
s_sleep 1
s_branch Lbw_584
Lbo_585:
s_add_u32 m0, s50, 0
s_add_u32 s39, s54, 0
buffer_load_dwordx4 v0, s[4:7], s39 offen offset:0 sc1 lds
buffer_load_dwordx4 v0, s[4:7], s39 offen offset:1024 sc1 lds
buffer_load_dwordx4 v0, s[4:7], s39 offen offset:2048 sc1 lds
buffer_load_dwordx4 v0, s[4:7], s39 offen offset:3072 sc1 lds
s_add_u32 m0, s50, 16384
s_add_u32 s39, s54, 16384
buffer_load_dwordx4 v0, s[4:7], s39 offen offset:0 sc1 lds
buffer_load_dwordx4 v0, s[4:7], s39 offen offset:1024 sc1 lds
buffer_load_dwordx4 v0, s[4:7], s39 offen offset:2048 sc1 lds
buffer_load_dwordx4 v0, s[4:7], s39 offen offset:3072 sc1 lds
s_add_u32 m0, s50, 32768
s_add_u32 s39, s54, 32768
buffer_load_dwordx4 v0, s[4:7], s39 offen offset:0 sc1 lds
buffer_load_dwordx4 v0, s[4:7], s39 offen offset:1024 sc1 lds
buffer_load_dwordx4 v0, s[4:7], s39 offen offset:2048 sc1 lds
buffer_load_dwordx4 v0, s[4:7], s39 offen offset:3072 sc1 lds
s_add_u32 m0, s50, 49152
s_add_u32 s39, s54, 49152
buffer_load_dwordx4 v0, s[4:7], s39 offen offset:0 sc1 lds
buffer_load_dwordx4 v0, s[4:7], s39 offen offset:1024 sc1 lds
buffer_load_dwordx4 v0, s[4:7], s39 offen offset:2048 sc1 lds
buffer_load_dwordx4 v0, s[4:7], s39 offen offset:3072 sc1 lds
buffer_load_dword v3, v2, s[4:7], s47 offen sc1
Lse_580:
s_waitcnt vmcnt(13)
s_barrier
ds_read_b128 v[16:19], v1 offset:0
ds_read_b128 v[20:23], v1 offset:1024
ds_read_b128 v[24:27], v1 offset:2048
ds_read_b128 v[28:31], v1 offset:3072
ds_read_b128 v[32:35], v1 offset:4096
ds_read_b128 v[36:39], v1 offset:5120
ds_read_b128 v[40:43], v1 offset:6144
s_add_u32 s54, s54, 65536
s_xor_b32 s50, s50, 0x10000
s_add_u32 s49, s49, 786432
s_add_u32 s36, s36, 1
s_add_u32 s48, s36, 0
s_and_b32 s47, s48, 31
s_lshl_b32 s47, s47, 8
s_add_u32 s47, s47, 3424256
s_lshr_b32 s48, s48, 5
s_lshl_b32 s48, 1, s48
s_add_u32 s48, s48, 1
s_waitcnt lgkmcnt(5)
v_mfma_f32_16x16x32_bf16 v[48:51], a[0:3], v[16:19], 0
ds_read_b128 v[44:47], v1 offset:7168
v_mfma_f32_16x16x32_bf16 v[52:55], a[128:131], v[16:19], 0
v_mfma_f32_16x16x32_bf16 v[64:67], v[16:19], v[128:131], 0
v_mfma_f32_16x16x32_bf16 v[56:59], a[0:3], v[20:23], 0
ds_read_b128 v[16:19], v1 offset:8192
v_mfma_f32_16x16x32_bf16 v[60:63], a[128:131], v[20:23], 0
v_mfma_f32_16x16x32_bf16 v[68:71], v[20:23], v[128:131], 0
s_waitcnt lgkmcnt(5)
v_mfma_f32_16x16x32_bf16 v[48:51], a[4:7], v[24:27], v[48:51]
ds_read_b128 v[20:23], v1 offset:9216
v_mfma_f32_16x16x32_bf16 v[52:55], a[132:135], v[24:27], v[52:55]
v_mfma_f32_16x16x32_bf16 v[64:67], v[24:27], v[132:135], v[64:67]
v_mfma_f32_16x16x32_bf16 v[56:59], a[4:7], v[28:31], v[56:59]
ds_read_b128 v[24:27], v1 offset:10240
v_mfma_f32_16x16x32_bf16 v[60:63], a[132:135], v[28:31], v[60:63]
v_mfma_f32_16x16x32_bf16 v[68:71], v[28:31], v[132:135], v[68:71]
s_waitcnt lgkmcnt(5)
v_mfma_f32_16x16x32_bf16 v[48:51], a[8:11], v[32:35], v[48:51]
ds_read_b128 v[28:31], v1 offset:11264
v_mfma_f32_16x16x32_bf16 v[52:55], a[136:139], v[32:35], v[52:55]
v_mfma_f32_16x16x32_bf16 v[64:67], v[32:35], v[136:139], v[64:67]
v_mfma_f32_16x16x32_bf16 v[56:59], a[8:11], v[36:39], v[56:59]
ds_read_b128 v[32:35], v1 offset:12288
v_mfma_f32_16x16x32_bf16 v[60:63], a[136:139], v[36:39], v[60:63]
v_mfma_f32_16x16x32_bf16 v[68:71], v[36:39], v[136:139], v[68:71]
s_waitcnt lgkmcnt(5)
v_mfma_f32_16x16x32_bf16 v[48:51], a[12:15], v[40:43], v[48:51]
ds_read_b128 v[36:39], v1 offset:13312
v_mfma_f32_16x16x32_bf16 v[52:55], a[140:143], v[40:43], v[52:55]
v_mfma_f32_16x16x32_bf16 v[64:67], v[40:43], v[140:143], v[64:67]
v_mfma_f32_16x16x32_bf16 v[56:59], a[12:15], v[44:47], v[56:59]
ds_read_b128 v[40:43], v1 offset:14336
v_mfma_f32_16x16x32_bf16 v[60:63], a[140:143], v[44:47], v[60:63]
v_mfma_f32_16x16x32_bf16 v[68:71], v[44:47], v[140:143], v[68:71]
s_waitcnt lgkmcnt(5)
v_mfma_f32_16x16x32_bf16 v[48:51], a[16:19], v[16:19], v[48:51]
ds_read_b128 v[44:47], v1 offset:15360
v_mfma_f32_16x16x32_bf16 v[52:55], a[144:147], v[16:19], v[52:55]
v_mfma_f32_16x16x32_bf16 v[64:67], v[16:19], v[144:147], v[64:67]
v_mfma_f32_16x16x32_bf16 v[56:59], a[16:19], v[20:23], v[56:59]
s_waitcnt vmcnt(9)
s_barrier
ds_read_b128 v[16:19], v1 offset:16384
v_mfma_f32_16x16x32_bf16 v[60:63], a[144:147], v[20:23], v[60:63]
v_mfma_f32_16x16x32_bf16 v[68:71], v[20:23], v[144:147], v[68:71]
s_waitcnt lgkmcnt(5)
v_mfma_f32_16x16x32_bf16 v[48:51], a[20:23], v[24:27], v[48:51]
ds_read_b128 v[20:23], v1 offset:17408
v_mfma_f32_16x16x32_bf16 v[52:55], a[148:151], v[24:27], v[52:55]
v_mfma_f32_16x16x32_bf16 v[64:67], v[24:27], v[148:151], v[64:67]
v_mfma_f32_16x16x32_bf16 v[56:59], a[20:23], v[28:31], v[56:59]
ds_read_b128 v[24:27], v1 offset:18432
v_mfma_f32_16x16x32_bf16 v[60:63], a[148:151], v[28:31], v[60:63]
v_mfma_f32_16x16x32_bf16 v[68:71], v[28:31], v[148:151], v[68:71]
s_waitcnt lgkmcnt(5)
v_mfma_f32_16x16x32_bf16 v[48:51], a[24:27], v[32:35], v[48:51]
ds_read_b128 v[28:31], v1 offset:19456
v_mfma_f32_16x16x32_bf16 v[52:55], a[152:155], v[32:35], v[52:55]
v_mfma_f32_16x16x32_bf16 v[64:67], v[32:35], v[152:155], v[64:67]
v_mfma_f32_16x16x32_bf16 v[56:59], a[24:27], v[36:39], v[56:59]
ds_read_b128 v[32:35], v1 offset:20480
v_mfma_f32_16x16x32_bf16 v[60:63], a[152:155], v[36:39], v[60:63]
v_mfma_f32_16x16x32_bf16 v[68:71], v[36:39], v[152:155], v[68:71]
s_waitcnt lgkmcnt(5)
v_mfma_f32_16x16x32_bf16 v[48:51], a[28:31], v[40:43], v[48:51]
ds_read_b128 v[36:39], v1 offset:21504
v_mfma_f32_16x16x32_bf16 v[52:55], a[156:159], v[40:43], v[52:55]
v_mfma_f32_16x16x32_bf16 v[64:67], v[40:43], v[156:159], v[64:67]
v_mfma_f32_16x16x32_bf16 v[56:59], a[28:31], v[44:47], v[56:59]
ds_read_b128 v[40:43], v1 offset:22528
v_mfma_f32_16x16x32_bf16 v[60:63], a[156:159], v[44:47], v[60:63]
v_mfma_f32_16x16x32_bf16 v[68:71], v[44:47], v[156:159], v[68:71]
s_waitcnt lgkmcnt(5)
v_mfma_f32_16x16x32_bf16 v[48:51], a[32:35], v[16:19], v[48:51]
ds_read_b128 v[44:47], v1 offset:23552
v_mfma_f32_16x16x32_bf16 v[52:55], a[160:163], v[16:19], v[52:55]
v_mfma_f32_16x16x32_bf16 v[64:67], v[16:19], v[160:163], v[64:67]
v_mfma_f32_16x16x32_bf16 v[56:59], a[32:35], v[20:23], v[56:59]
ds_read_b128 v[16:19], v1 offset:24576
v_mfma_f32_16x16x32_bf16 v[60:63], a[160:163], v[20:23], v[60:63]
v_mfma_f32_16x16x32_bf16 v[68:71], v[20:23], v[160:163], v[68:71]
s_waitcnt lgkmcnt(5)
v_mfma_f32_16x16x32_bf16 v[48:51], a[36:39], v[24:27], v[48:51]
ds_read_b128 v[20:23], v1 offset:25600
v_mfma_f32_16x16x32_bf16 v[52:55], a[164:167], v[24:27], v[52:55]
v_mfma_f32_16x16x32_bf16 v[64:67], v[24:27], v[164:167], v[64:67]
v_mfma_f32_16x16x32_bf16 v[56:59], a[36:39], v[28:31], v[56:59]
ds_read_b128 v[24:27], v1 offset:26624
v_mfma_f32_16x16x32_bf16 v[60:63], a[164:167], v[28:31], v[60:63]
v_mfma_f32_16x16x32_bf16 v[68:71], v[28:31], v[164:167], v[68:71]
s_waitcnt lgkmcnt(5)
v_mfma_f32_16x16x32_bf16 v[48:51], a[40:43], v[32:35], v[48:51]
ds_read_b128 v[28:31], v1 offset:27648
v_mfma_f32_16x16x32_bf16 v[52:55], a[168:171], v[32:35], v[52:55]
v_mfma_f32_16x16x32_bf16 v[64:67], v[32:35], v[168:171], v[64:67]
v_mfma_f32_16x16x32_bf16 v[56:59], a[40:43], v[36:39], v[56:59]
ds_read_b128 v[32:35], v1 offset:28672
v_mfma_f32_16x16x32_bf16 v[60:63], a[168:171], v[36:39], v[60:63]
v_mfma_f32_16x16x32_bf16 v[68:71], v[36:39], v[168:171], v[68:71]
s_waitcnt lgkmcnt(5)
v_mfma_f32_16x16x32_bf16 v[48:51], a[44:47], v[40:43], v[48:51]
ds_read_b128 v[36:39], v1 offset:29696
v_mfma_f32_16x16x32_bf16 v[52:55], a[172:175], v[40:43], v[52:55]
v_mfma_f32_16x16x32_bf16 v[64:67], v[40:43], v[172:175], v[64:67]
v_mfma_f32_16x16x32_bf16 v[56:59], a[44:47], v[44:47], v[56:59]
ds_read_b128 v[40:43], v1 offset:30720
v_mfma_f32_16x16x32_bf16 v[60:63], a[172:175], v[44:47], v[60:63]
v_mfma_f32_16x16x32_bf16 v[68:71], v[44:47], v[172:175], v[68:71]
s_waitcnt lgkmcnt(5)
v_mfma_f32_16x16x32_bf16 v[48:51], a[48:51], v[16:19], v[48:51]
ds_read_b128 v[44:47], v1 offset:31744
v_mfma_f32_16x16x32_bf16 v[52:55], a[176:179], v[16:19], v[52:55]
v_mfma_f32_16x16x32_bf16 v[64:67], v[16:19], v[176:179], v[64:67]
v_mfma_f32_16x16x32_bf16 v[56:59], a[48:51], v[20:23], v[56:59]
s_waitcnt vmcnt(5)
s_barrier
ds_read_b128 v[16:19], v1 offset:32768
v_mfma_f32_16x16x32_bf16 v[60:63], a[176:179], v[20:23], v[60:63]
v_mfma_f32_16x16x32_bf16 v[68:71], v[20:23], v[176:179], v[68:71]
s_waitcnt lgkmcnt(5)
v_mfma_f32_16x16x32_bf16 v[48:51], a[52:55], v[24:27], v[48:51]
ds_read_b128 v[20:23], v1 offset:33792
v_mfma_f32_16x16x32_bf16 v[52:55], a[180:183], v[24:27], v[52:55]
v_mfma_f32_16x16x32_bf16 v[64:67], v[24:27], v[180:183], v[64:67]
v_mfma_f32_16x16x32_bf16 v[56:59], a[52:55], v[28:31], v[56:59]
ds_read_b128 v[24:27], v1 offset:34816
v_mfma_f32_16x16x32_bf16 v[60:63], a[180:183], v[28:31], v[60:63]
v_mfma_f32_16x16x32_bf16 v[68:71], v[28:31], v[180:183], v[68:71]
s_waitcnt lgkmcnt(5)
v_mfma_f32_16x16x32_bf16 v[48:51], a[56:59], v[32:35], v[48:51]
ds_read_b128 v[28:31], v1 offset:35840
v_mfma_f32_16x16x32_bf16 v[52:55], a[184:187], v[32:35], v[52:55]
v_mfma_f32_16x16x32_bf16 v[64:67], v[32:35], v[184:187], v[64:67]
v_mfma_f32_16x16x32_bf16 v[56:59], a[56:59], v[36:39], v[56:59]
ds_read_b128 v[32:35], v1 offset:36864
v_mfma_f32_16x16x32_bf16 v[60:63], a[184:187], v[36:39], v[60:63]
v_mfma_f32_16x16x32_bf16 v[68:71], v[36:39], v[184:187], v[68:71]
s_waitcnt lgkmcnt(5)
v_mfma_f32_16x16x32_bf16 v[48:51], a[60:63], v[40:43], v[48:51]
ds_read_b128 v[36:39], v1 offset:37888
v_mfma_f32_16x16x32_bf16 v[52:55], a[188:191], v[40:43], v[52:55]
v_mfma_f32_16x16x32_bf16 v[64:67], v[40:43], v[188:191], v[64:67]
v_mfma_f32_16x16x32_bf16 v[56:59], a[60:63], v[44:47], v[56:59]
ds_read_b128 v[40:43], v1 offset:38912
v_mfma_f32_16x16x32_bf16 v[60:63], a[188:191], v[44:47], v[60:63]
v_mfma_f32_16x16x32_bf16 v[68:71], v[44:47], v[188:191], v[68:71]
s_waitcnt lgkmcnt(5)
v_mfma_f32_16x16x32_bf16 v[48:51], a[64:67], v[16:19], v[48:51]
ds_read_b128 v[44:47], v1 offset:39936
v_mfma_f32_16x16x32_bf16 v[52:55], a[192:195], v[16:19], v[52:55]
v_mfma_f32_16x16x32_bf16 v[64:67], v[16:19], v[192:195], v[64:67]
v_mfma_f32_16x16x32_bf16 v[56:59], a[64:67], v[20:23], v[56:59]
ds_read_b128 v[16:19], v1 offset:40960
v_mfma_f32_16x16x32_bf16 v[60:63], a[192:195], v[20:23], v[60:63]
v_mfma_f32_16x16x32_bf16 v[68:71], v[20:23], v[192:195], v[68:71]
s_waitcnt lgkmcnt(5)
v_mfma_f32_16x16x32_bf16 v[48:51], a[68:71], v[24:27], v[48:51]
ds_read_b128 v[20:23], v1 offset:41984
v_mfma_f32_16x16x32_bf16 v[52:55], a[196:199], v[24:27], v[52:55]
v_mfma_f32_16x16x32_bf16 v[64:67], v[24:27], v[196:199], v[64:67]
v_mfma_f32_16x16x32_bf16 v[56:59], a[68:71], v[28:31], v[56:59]
ds_read_b128 v[24:27], v1 offset:43008
v_mfma_f32_16x16x32_bf16 v[60:63], a[196:199], v[28:31], v[60:63]
v_mfma_f32_16x16x32_bf16 v[68:71], v[28:31], v[196:199], v[68:71]
s_waitcnt lgkmcnt(5)
v_mfma_f32_16x16x32_bf16 v[48:51], a[72:75], v[32:35], v[48:51]
ds_read_b128 v[28:31], v1 offset:44032
v_mfma_f32_16x16x32_bf16 v[52:55], a[200:203], v[32:35], v[52:55]
v_mfma_f32_16x16x32_bf16 v[64:67], v[32:35], v[200:203], v[64:67]
v_mfma_f32_16x16x32_bf16 v[56:59], a[72:75], v[36:39], v[56:59]
ds_read_b128 v[32:35], v1 offset:45056
v_mfma_f32_16x16x32_bf16 v[60:63], a[200:203], v[36:39], v[60:63]
v_mfma_f32_16x16x32_bf16 v[68:71], v[36:39], v[200:203], v[68:71]
s_waitcnt lgkmcnt(5)
v_mfma_f32_16x16x32_bf16 v[48:51], a[76:79], v[40:43], v[48:51]
ds_read_b128 v[36:39], v1 offset:46080
v_mfma_f32_16x16x32_bf16 v[52:55], a[204:207], v[40:43], v[52:55]
v_mfma_f32_16x16x32_bf16 v[64:67], v[40:43], v[204:207], v[64:67]
v_mfma_f32_16x16x32_bf16 v[56:59], a[76:79], v[44:47], v[56:59]
ds_read_b128 v[40:43], v1 offset:47104
v_mfma_f32_16x16x32_bf16 v[60:63], a[204:207], v[44:47], v[60:63]
v_mfma_f32_16x16x32_bf16 v[68:71], v[44:47], v[204:207], v[68:71]
s_waitcnt lgkmcnt(5)
v_mfma_f32_16x16x32_bf16 v[48:51], a[80:83], v[16:19], v[48:51]
ds_read_b128 v[44:47], v1 offset:48128
v_mfma_f32_16x16x32_bf16 v[52:55], a[208:211], v[16:19], v[52:55]
v_mfma_f32_16x16x32_bf16 v[64:67], v[16:19], v[208:211], v[64:67]
v_mfma_f32_16x16x32_bf16 v[56:59], a[80:83], v[20:23], v[56:59]
s_waitcnt vmcnt(1)
s_barrier
ds_read_b128 v[16:19], v1 offset:49152
v_mfma_f32_16x16x32_bf16 v[60:63], a[208:211], v[20:23], v[60:63]
v_mfma_f32_16x16x32_bf16 v[68:71], v[20:23], v[208:211], v[68:71]
s_waitcnt lgkmcnt(5)
v_mfma_f32_16x16x32_bf16 v[48:51], a[84:87], v[24:27], v[48:51]
ds_read_b128 v[20:23], v1 offset:50176
v_mfma_f32_16x16x32_bf16 v[52:55], a[212:215], v[24:27], v[52:55]
v_mfma_f32_16x16x32_bf16 v[64:67], v[24:27], v[212:215], v[64:67]
v_mfma_f32_16x16x32_bf16 v[56:59], a[84:87], v[28:31], v[56:59]
ds_read_b128 v[24:27], v1 offset:51200
v_mfma_f32_16x16x32_bf16 v[60:63], a[212:215], v[28:31], v[60:63]
v_mfma_f32_16x16x32_bf16 v[68:71], v[28:31], v[212:215], v[68:71]
s_waitcnt lgkmcnt(5)
v_mfma_f32_16x16x32_bf16 v[48:51], a[88:91], v[32:35], v[48:51]
ds_read_b128 v[28:31], v1 offset:52224
v_mfma_f32_16x16x32_bf16 v[52:55], a[216:219], v[32:35], v[52:55]
v_mfma_f32_16x16x32_bf16 v[64:67], v[32:35], v[216:219], v[64:67]
v_mfma_f32_16x16x32_bf16 v[56:59], a[88:91], v[36:39], v[56:59]
ds_read_b128 v[32:35], v1 offset:53248
v_mfma_f32_16x16x32_bf16 v[60:63], a[216:219], v[36:39], v[60:63]
v_mfma_f32_16x16x32_bf16 v[68:71], v[36:39], v[216:219], v[68:71]
s_waitcnt lgkmcnt(5)
v_mfma_f32_16x16x32_bf16 v[48:51], a[92:95], v[40:43], v[48:51]
ds_read_b128 v[36:39], v1 offset:54272
v_mfma_f32_16x16x32_bf16 v[52:55], a[220:223], v[40:43], v[52:55]
v_mfma_f32_16x16x32_bf16 v[64:67], v[40:43], v[220:223], v[64:67]
v_mfma_f32_16x16x32_bf16 v[56:59], a[92:95], v[44:47], v[56:59]
ds_read_b128 v[40:43], v1 offset:55296
v_mfma_f32_16x16x32_bf16 v[60:63], a[220:223], v[44:47], v[60:63]
v_mfma_f32_16x16x32_bf16 v[68:71], v[44:47], v[220:223], v[68:71]
s_waitcnt lgkmcnt(5)
v_mfma_f32_16x16x32_bf16 v[48:51], a[96:99], v[16:19], v[48:51]
ds_read_b128 v[44:47], v1 offset:56320
v_mfma_f32_16x16x32_bf16 v[52:55], a[224:227], v[16:19], v[52:55]
v_mfma_f32_16x16x32_bf16 v[64:67], v[16:19], v[224:227], v[64:67]
v_mfma_f32_16x16x32_bf16 v[56:59], a[96:99], v[20:23], v[56:59]
ds_read_b128 v[16:19], v1 offset:57344
v_mfma_f32_16x16x32_bf16 v[60:63], a[224:227], v[20:23], v[60:63]
v_mfma_f32_16x16x32_bf16 v[68:71], v[20:23], v[224:227], v[68:71]
s_waitcnt lgkmcnt(5)
v_mfma_f32_16x16x32_bf16 v[48:51], a[100:103], v[24:27], v[48:51]
ds_read_b128 v[20:23], v1 offset:58368
v_mfma_f32_16x16x32_bf16 v[52:55], a[228:231], v[24:27], v[52:55]
v_mfma_f32_16x16x32_bf16 v[64:67], v[24:27], v[228:231], v[64:67]
v_mfma_f32_16x16x32_bf16 v[56:59], a[100:103], v[28:31], v[56:59]
ds_read_b128 v[24:27], v1 offset:59392
v_mfma_f32_16x16x32_bf16 v[60:63], a[228:231], v[28:31], v[60:63]
v_mfma_f32_16x16x32_bf16 v[68:71], v[28:31], v[228:231], v[68:71]
s_waitcnt lgkmcnt(5)
v_mfma_f32_16x16x32_bf16 v[48:51], a[104:107], v[32:35], v[48:51]
ds_read_b128 v[28:31], v1 offset:60416
buffer_load_dword v3, v2, s[4:7], s47 offen sc1
v_mfma_f32_16x16x32_bf16 v[52:55], a[232:235], v[32:35], v[52:55]
v_mfma_f32_16x16x32_bf16 v[64:67], v[32:35], v[232:235], v[64:67]
v_mfma_f32_16x16x32_bf16 v[56:59], a[104:107], v[36:39], v[56:59]
ds_read_b128 v[32:35], v1 offset:61440
v_mfma_f32_16x16x32_bf16 v[60:63], a[232:235], v[36:39], v[60:63]
v_mfma_f32_16x16x32_bf16 v[68:71], v[36:39], v[232:235], v[68:71]
s_waitcnt lgkmcnt(5)
v_mfma_f32_16x16x32_bf16 v[48:51], a[108:111], v[40:43], v[48:51]
ds_read_b128 v[36:39], v1 offset:62464
v_mfma_f32_16x16x32_bf16 v[52:55], a[236:239], v[40:43], v[52:55]
v_mfma_f32_16x16x32_bf16 v[64:67], v[40:43], v[236:239], v[64:67]
v_mfma_f32_16x16x32_bf16 v[56:59], a[108:111], v[44:47], v[56:59]
ds_read_b128 v[40:43], v1 offset:63488
v_mfma_f32_16x16x32_bf16 v[60:63], a[236:239], v[44:47], v[60:63]
v_mfma_f32_16x16x32_bf16 v[68:71], v[44:47], v[236:239], v[68:71]
s_waitcnt lgkmcnt(5)
v_mfma_f32_16x16x32_bf16 v[48:51], a[112:115], v[16:19], v[48:51]
ds_read_b128 v[44:47], v1 offset:64512
v_mfma_f32_16x16x32_bf16 v[52:55], a[240:243], v[16:19], v[52:55]
v_mfma_f32_16x16x32_bf16 v[64:67], v[16:19], v[240:243], v[64:67]
v_mfma_f32_16x16x32_bf16 v[56:59], a[112:115], v[20:23], v[56:59]
v_mfma_f32_16x16x32_bf16 v[60:63], a[240:243], v[20:23], v[60:63]
v_mfma_f32_16x16x32_bf16 v[68:71], v[20:23], v[240:243], v[68:71]
s_waitcnt lgkmcnt(4)
v_mfma_f32_16x16x32_bf16 v[48:51], a[116:119], v[24:27], v[48:51]
v_mfma_f32_16x16x32_bf16 v[52:55], a[244:247], v[24:27], v[52:55]
v_mfma_f32_16x16x32_bf16 v[64:67], v[24:27], v[244:247], v[64:67]
v_mfma_f32_16x16x32_bf16 v[56:59], a[116:119], v[28:31], v[56:59]
v_mfma_f32_16x16x32_bf16 v[60:63], a[244:247], v[28:31], v[60:63]
v_mfma_f32_16x16x32_bf16 v[68:71], v[28:31], v[244:247], v[68:71]
s_waitcnt lgkmcnt(2)
v_mfma_f32_16x16x32_bf16 v[48:51], a[120:123], v[32:35], v[48:51]
v_mfma_f32_16x16x32_bf16 v[52:55], a[248:251], v[32:35], v[52:55]
v_mfma_f32_16x16x32_bf16 v[64:67], v[32:35], v[248:251], v[64:67]
v_mfma_f32_16x16x32_bf16 v[56:59], a[120:123], v[36:39], v[56:59]
v_mfma_f32_16x16x32_bf16 v[60:63], a[248:251], v[36:39], v[60:63]
v_mfma_f32_16x16x32_bf16 v[68:71], v[36:39], v[248:251], v[68:71]
s_waitcnt lgkmcnt(0)
v_mfma_f32_16x16x32_bf16 v[48:51], a[124:127], v[40:43], v[48:51]
v_mfma_f32_16x16x32_bf16 v[52:55], a[252:255], v[40:43], v[52:55]
v_mfma_f32_16x16x32_bf16 v[64:67], v[40:43], v[252:255], v[64:67]
v_mfma_f32_16x16x32_bf16 v[56:59], a[124:127], v[44:47], v[56:59]
v_mfma_f32_16x16x32_bf16 v[60:63], a[252:255], v[44:47], v[60:63]
v_mfma_f32_16x16x32_bf16 v[68:71], v[44:47], v[252:255], v[68:71]
v_xor_b32 v1, 0x10000, v1
v_mov_b32 v5, s36
s_waitcnt vmcnt(0)
v_cmp_gt_u32 vcc, s48, v3
s_nop 3
v_cvt_pk_bf16_f32 v80, v48, v49
v_cvt_pk_bf16_f32 v81, v50, v51
v_cvt_pk_bf16_f32 v82, v52, v53
v_cvt_pk_bf16_f32 v83, v54, v55
buffer_store_dwordx4 v[80:83], v6, s[4:7], s49 offen sc1
v_cvt_pk_bf16_f32 v84, v56, v57
v_cvt_pk_bf16_f32 v85, v58, v59
v_cvt_pk_bf16_f32 v86, v60, v61
v_cvt_pk_bf16_f32 v87, v62, v63
buffer_store_dwordx4 v[84:87], v7, s[4:7], s49 offen sc1
v_cvt_pk_bf16_f32 v88, v64, v65
v_cvt_pk_bf16_f32 v89, v66, v67
v_cvt_pk_bf16_f32 v90, v68, v69
v_cvt_pk_bf16_f32 v91, v70, v71
buffer_store_dwordx4 v[88:91], v8, s[4:7], s49 offen sc1
s_mov_b32 s46, 0
s_cbranch_vccnz Lsk_582
s_mov_b32 s46, 1
s_add_u32 m0, s50, 0
s_add_u32 s39, s54, 0
buffer_load_dwordx4 v0, s[4:7], s39 offen offset:0 sc1 lds
buffer_load_dwordx4 v0, s[4:7], s39 offen offset:1024 sc1 lds
buffer_load_dwordx4 v0, s[4:7], s39 offen offset:2048 sc1 lds
buffer_load_dwordx4 v0, s[4:7], s39 offen offset:3072 sc1 lds
s_add_u32 m0, s50, 16384
s_add_u32 s39, s54, 16384
buffer_load_dwordx4 v0, s[4:7], s39 offen offset:0 sc1 lds
buffer_load_dwordx4 v0, s[4:7], s39 offen offset:1024 sc1 lds
buffer_load_dwordx4 v0, s[4:7], s39 offen offset:2048 sc1 lds
buffer_load_dwordx4 v0, s[4:7], s39 offen offset:3072 sc1 lds
s_add_u32 m0, s50, 32768
s_add_u32 s39, s54, 32768
buffer_load_dwordx4 v0, s[4:7], s39 offen offset:0 sc1 lds
buffer_load_dwordx4 v0, s[4:7], s39 offen offset:1024 sc1 lds
buffer_load_dwordx4 v0, s[4:7], s39 offen offset:2048 sc1 lds
buffer_load_dwordx4 v0, s[4:7], s39 offen offset:3072 sc1 lds
s_add_u32 m0, s50, 49152
s_add_u32 s39, s54, 49152
buffer_load_dwordx4 v0, s[4:7], s39 offen offset:0 sc1 lds
buffer_load_dwordx4 v0, s[4:7], s39 offen offset:1024 sc1 lds
buffer_load_dwordx4 v0, s[4:7], s39 offen offset:2048 sc1 lds
buffer_load_dwordx4 v0, s[4:7], s39 offen offset:3072 sc1 lds
s_waitcnt vmcnt(16)
s_branch Lsj_583
Lsk_582:
s_waitcnt vmcnt(0)
Lsj_583:
s_barrier
buffer_store_dword v5, v4, s[4:7], 0 offen sc1
s_cmp_eq_u32 s36, 3
s_cbranch_scc1 Lso_581
s_cmp_lg_u32 s46, 0
s_cbranch_scc1 Lse_580
s_branch Lsw_579
Lso_581:
v_lshlrev_b32 v80, 7, v9
s_mov_b32 s38, 3424256
Lbw_588:
buffer_load_dword v81, v80, s[4:7], s38 offen sc1
s_waitcnt vmcnt(0)
v_cmp_gt_u32 vcc, 3, v81
s_cbranch_vccz Lbo_589
s_sub_u32 s37, s37, 1
s_cbranch_scc1 Lend_7
s_sleep 2
s_branch Lbw_588
Lbo_589:
s_cmp_lg_u32 s46, 0
s_cbranch_scc1 Lqh_586
s_add_u32 m0, s50, 0
s_add_u32 s39, s54, 0
buffer_load_dwordx4 v0, s[4:7], s39 offen offset:0 sc1 lds
buffer_load_dwordx4 v0, s[4:7], s39 offen offset:1024 sc1 lds
buffer_load_dwordx4 v0, s[4:7], s39 offen offset:2048 sc1 lds
buffer_load_dwordx4 v0, s[4:7], s39 offen offset:3072 sc1 lds
s_add_u32 m0, s50, 16384
s_add_u32 s39, s54, 16384
buffer_load_dwordx4 v0, s[4:7], s39 offen offset:0 sc1 lds
buffer_load_dwordx4 v0, s[4:7], s39 offen offset:1024 sc1 lds
buffer_load_dwordx4 v0, s[4:7], s39 offen offset:2048 sc1 lds
buffer_load_dwordx4 v0, s[4:7], s39 offen offset:3072 sc1 lds
s_add_u32 m0, s50, 32768
s_add_u32 s39, s54, 32768
buffer_load_dwordx4 v0, s[4:7], s39 offen offset:0 sc1 lds
buffer_load_dwordx4 v0, s[4:7], s39 offen offset:1024 sc1 lds
buffer_load_dwordx4 v0, s[4:7], s39 offen offset:2048 sc1 lds
buffer_load_dwordx4 v0, s[4:7], s39 offen offset:3072 sc1 lds
s_add_u32 m0, s50, 49152
s_add_u32 s39, s54, 49152
buffer_load_dwordx4 v0, s[4:7], s39 offen offset:0 sc1 lds
buffer_load_dwordx4 v0, s[4:7], s39 offen offset:1024 sc1 lds
buffer_load_dwordx4 v0, s[4:7], s39 offen offset:2048 sc1 lds
buffer_load_dwordx4 v0, s[4:7], s39 offen offset:3072 sc1 lds
s_waitcnt vmcnt(0)
Lqh_586:
s_barrier
ds_read_b128 v[16:19], v1 offset:0
ds_read_b128 v[20:23], v1 offset:2048
ds_read_b128 v[24:27], v1 offset:4096
ds_read_b128 v[28:31], v1 offset:6144
ds_read_b128 v[32:35], v1 offset:8192
ds_read_b128 v[36:39], v1 offset:10240
ds_read_b128 v[40:43], v1 offset:12288
s_mov_b32 s55, 0x70000000
Lql_587:
s_waitcnt lgkmcnt(5)
v_mfma_f32_16x16x32_bf16 v[48:51], a[0:3], v[16:19], 0
s_add_u32 s54, s54, 65536
ds_read_b128 v[44:47], v1 offset:14336
s_xor_b32 s50, s50, 0x10000
v_mfma_f32_16x16x32_bf16 v[52:55], a[128:131], v[16:19], 0
s_cmp_lt_u32 s36, 63
s_cselect_b32 s45, s54, 0x70000000
v_mfma_f32_16x16x32_bf16 v[64:67], v[16:19], v[128:131], 0
v_mfma_f32_16x16x32_bf16 v[48:51], a[4:7], v[20:23], v[48:51]
ds_read_b128 v[16:19], v1 offset:16384
v_mfma_f32_16x16x32_bf16 v[52:55], a[132:135], v[20:23], v[52:55]
v_mfma_f32_16x16x32_bf16 v[64:67], v[20:23], v[132:135], v[64:67]
s_waitcnt lgkmcnt(5)
v_mfma_f32_16x16x32_bf16 v[48:51], a[8:11], v[24:27], v[48:51]
ds_read_b128 v[20:23], v1 offset:18432
v_mfma_f32_16x16x32_bf16 v[52:55], a[136:139], v[24:27], v[52:55]
v_mfma_f32_16x16x32_bf16 v[64:67], v[24:27], v[136:139], v[64:67]
v_cvt_pk_bf16_f32 v84, v56, v57
v_cvt_pk_bf16_f32 v85, v58, v59
v_mfma_f32_16x16x32_bf16 v[48:51], a[12:15], v[28:31], v[48:51]
ds_read_b128 v[24:27], v1 offset:20480
v_cvt_pk_bf16_f32 v86, v60, v61
v_mfma_f32_16x16x32_bf16 v[52:55], a[140:143], v[28:31], v[52:55]
v_cvt_pk_bf16_f32 v87, v62, v63
v_cvt_pk_bf16_f32 v90, v68, v69
v_mfma_f32_16x16x32_bf16 v[64:67], v[28:31], v[140:143], v[64:67]
s_waitcnt lgkmcnt(5)
v_cvt_pk_bf16_f32 v91, v70, v71
v_mfma_f32_16x16x32_bf16 v[48:51], a[16:19], v[32:35], v[48:51]
ds_read_b128 v[28:31], v1 offset:22528
v_mfma_f32_16x16x32_bf16 v[52:55], a[144:147], v[32:35], v[52:55]
buffer_store_dwordx4 v[80:83], v6, s[4:7], s55 offen sc1
v_mfma_f32_16x16x32_bf16 v[64:67], v[32:35], v[144:147], v[64:67]
v_mfma_f32_16x16x32_bf16 v[48:51], a[20:23], v[36:39], v[48:51]
ds_read_b128 v[32:35], v1 offset:24576
v_mfma_f32_16x16x32_bf16 v[52:55], a[148:151], v[36:39], v[52:55]
v_mfma_f32_16x16x32_bf16 v[64:67], v[36:39], v[148:151], v[64:67]
s_waitcnt lgkmcnt(5)
buffer_store_dwordx4 v[84:87], v7, s[4:7], s55 offen sc1
v_mfma_f32_16x16x32_bf16 v[48:51], a[24:27], v[40:43], v[48:51]
ds_read_b128 v[36:39], v1 offset:26624
v_mfma_f32_16x16x32_bf16 v[52:55], a[152:155], v[40:43], v[52:55]
v_mfma_f32_16x16x32_bf16 v[64:67], v[40:43], v[152:155], v[64:67]
v_mfma_f32_16x16x32_bf16 v[48:51], a[28:31], v[44:47], v[48:51]
ds_read_b128 v[40:43], v1 offset:28672
v_mfma_f32_16x16x32_bf16 v[52:55], a[156:159], v[44:47], v[52:55]
buffer_store_dwordx4 v[88:91], v8, s[4:7], s55 offen sc1
v_mfma_f32_16x16x32_bf16 v[64:67], v[44:47], v[156:159], v[64:67]
s_waitcnt lgkmcnt(5)
v_mfma_f32_16x16x32_bf16 v[48:51], a[32:35], v[16:19], v[48:51]
ds_read_b128 v[44:47], v1 offset:30720
v_mfma_f32_16x16x32_bf16 v[52:55], a[160:163], v[16:19], v[52:55]
v_mfma_f32_16x16x32_bf16 v[64:67], v[16:19], v[160:163], v[64:67]
v_mov_b32 v5, s36
s_add_u32 m0, s50, 0
v_mfma_f32_16x16x32_bf16 v[48:51], a[36:39], v[20:23], v[48:51]
s_add_u32 s39, s45, 0
ds_read_b128 v[16:19], v1 offset:32768
buffer_load_dwordx4 v0, s[4:7], s39 offen offset:0 sc1 lds
v_mfma_f32_16x16x32_bf16 v[52:55], a[164:167], v[20:23], v[52:55]
v_mfma_f32_16x16x32_bf16 v[64:67], v[20:23], v[164:167], v[64:67]
s_waitcnt lgkmcnt(5)
v_mfma_f32_16x16x32_bf16 v[48:51], a[40:43], v[24:27], v[48:51]
ds_read_b128 v[20:23], v1 offset:34816
v_mfma_f32_16x16x32_bf16 v[52:55], a[168:171], v[24:27], v[52:55]
v_mfma_f32_16x16x32_bf16 v[64:67], v[24:27], v[168:171], v[64:67]
buffer_load_dwordx4 v0, s[4:7], s39 offen offset:1024 sc1 lds
v_mfma_f32_16x16x32_bf16 v[48:51], a[44:47], v[28:31], v[48:51]
ds_read_b128 v[24:27], v1 offset:36864
v_mfma_f32_16x16x32_bf16 v[52:55], a[172:175], v[28:31], v[52:55]
v_mfma_f32_16x16x32_bf16 v[64:67], v[28:31], v[172:175], v[64:67]
s_waitcnt lgkmcnt(5)
v_mfma_f32_16x16x32_bf16 v[48:51], a[48:51], v[32:35], v[48:51]
ds_read_b128 v[28:31], v1 offset:38912
v_mfma_f32_16x16x32_bf16 v[52:55], a[176:179], v[32:35], v[52:55]
buffer_load_dwordx4 v0, s[4:7], s39 offen offset:2048 sc1 lds
v_mfma_f32_16x16x32_bf16 v[64:67], v[32:35], v[176:179], v[64:67]
v_mfma_f32_16x16x32_bf16 v[48:51], a[52:55], v[36:39], v[48:51]
ds_read_b128 v[32:35], v1 offset:40960
v_mfma_f32_16x16x32_bf16 v[52:55], a[180:183], v[36:39], v[52:55]
v_mfma_f32_16x16x32_bf16 v[64:67], v[36:39], v[180:183], v[64:67]
s_waitcnt lgkmcnt(5)
v_mfma_f32_16x16x32_bf16 v[48:51], a[56:59], v[40:43], v[48:51]
ds_read_b128 v[36:39], v1 offset:43008
buffer_load_dwordx4 v0, s[4:7], s39 offen offset:3072 sc1 lds
v_mfma_f32_16x16x32_bf16 v[52:55], a[184:187], v[40:43], v[52:55]
v_mfma_f32_16x16x32_bf16 v[64:67], v[40:43], v[184:187], v[64:67]
v_mfma_f32_16x16x32_bf16 v[48:51], a[60:63], v[44:47], v[48:51]
ds_read_b128 v[40:43], v1 offset:45056
v_mfma_f32_16x16x32_bf16 v[52:55], a[188:191], v[44:47], v[52:55]
v_mfma_f32_16x16x32_bf16 v[64:67], v[44:47], v[188:191], v[64:67]
s_waitcnt lgkmcnt(5)
s_add_u32 m0, s50, 16384
s_add_u32 s39, s45, 16384
v_mfma_f32_16x16x32_bf16 v[48:51], a[64:67], v[16:19], v[48:51]
ds_read_b128 v[44:47], v1 offset:47104
buffer_load_dwordx4 v0, s[4:7], s39 offen offset:0 sc1 lds
v_mfma_f32_16x16x32_bf16 v[52:55], a[192:195], v[16:19], v[52:55]
v_mfma_f32_16x16x32_bf16 v[64:67], v[16:19], v[192:195], v[64:67]
v_mfma_f32_16x16x32_bf16 v[48:51], a[68:71], v[20:23], v[48:51]
ds_read_b128 v[16:19], v1 offset:49152
v_mfma_f32_16x16x32_bf16 v[52:55], a[196:199], v[20:23], v[52:55]
v_mfma_f32_16x16x32_bf16 v[64:67], v[20:23], v[196:199], v[64:67]
s_waitcnt lgkmcnt(5)
buffer_load_dwordx4 v0, s[4:7], s39 offen offset:1024 sc1 lds
v_mfma_f32_16x16x32_bf16 v[48:51], a[72:75], v[24:27], v[48:51]
ds_read_b128 v[20:23], v1 offset:51200
v_mfma_f32_16x16x32_bf16 v[52:55], a[200:203], v[24:27], v[52:55]
v_mfma_f32_16x16x32_bf16 v[64:67], v[24:27], v[200:203], v[64:67]
v_mfma_f32_16x16x32_bf16 v[48:51], a[76:79], v[28:31], v[48:51]
ds_read_b128 v[24:27], v1 offset:53248
v_mfma_f32_16x16x32_bf16 v[52:55], a[204:207], v[28:31], v[52:55]
buffer_load_dwordx4 v0, s[4:7], s39 offen offset:2048 sc1 lds
v_mfma_f32_16x16x32_bf16 v[64:67], v[28:31], v[204:207], v[64:67]
s_waitcnt lgkmcnt(5)
v_mfma_f32_16x16x32_bf16 v[48:51], a[80:83], v[32:35], v[48:51]
ds_read_b128 v[28:31], v1 offset:55296
v_mfma_f32_16x16x32_bf16 v[52:55], a[208:211], v[32:35], v[52:55]
v_mfma_f32_16x16x32_bf16 v[64:67], v[32:35], v[208:211], v[64:67]
v_mfma_f32_16x16x32_bf16 v[48:51], a[84:87], v[36:39], v[48:51]
ds_read_b128 v[32:35], v1 offset:57344
buffer_load_dwordx4 v0, s[4:7], s39 offen offset:3072 sc1 lds
v_mfma_f32_16x16x32_bf16 v[52:55], a[212:215], v[36:39], v[52:55]
v_mfma_f32_16x16x32_bf16 v[64:67], v[36:39], v[212:215], v[64:67]
s_waitcnt lgkmcnt(5)
v_mfma_f32_16x16x32_bf16 v[48:51], a[88:91], v[40:43], v[48:51]
ds_read_b128 v[36:39], v1 offset:59392
v_mfma_f32_16x16x32_bf16 v[52:55], a[216:219], v[40:43], v[52:55]
v_mfma_f32_16x16x32_bf16 v[64:67], v[40:43], v[216:219], v[64:67]
v_mfma_f32_16x16x32_bf16 v[48:51], a[92:95], v[44:47], v[48:51]
ds_read_b128 v[40:43], v1 offset:61440
v_mfma_f32_16x16x32_bf16 v[52:55], a[220:223], v[44:47], v[52:55]
s_waitcnt vmcnt(8)
s_barrier
buffer_store_dword v5, v4, s[4:7], 0 offen sc1
v_mfma_f32_16x16x32_bf16 v[64:67], v[44:47], v[220:223], v[64:67]
s_waitcnt lgkmcnt(5)
v_mfma_f32_16x16x32_bf16 v[48:51], a[96:99], v[16:19], v[48:51]
ds_read_b128 v[44:47], v1 offset:63488
v_mfma_f32_16x16x32_bf16 v[52:55], a[224:227], v[16:19], v[52:55]
s_add_u32 m0, s50, 32768
s_add_u32 s39, s45, 32768
buffer_load_dwordx4 v0, s[4:7], s39 offen offset:0 sc1 lds
v_mfma_f32_16x16x32_bf16 v[64:67], v[16:19], v[224:227], v[64:67]
v_mfma_f32_16x16x32_bf16 v[48:51], a[100:103], v[20:23], v[48:51]
ds_read_b128 v[16:19], v1 offset:1024
v_mfma_f32_16x16x32_bf16 v[52:55], a[228:231], v[20:23], v[52:55]
v_mfma_f32_16x16x32_bf16 v[64:67], v[20:23], v[228:231], v[64:67]
s_waitcnt lgkmcnt(5)
v_mfma_f32_16x16x32_bf16 v[48:51], a[104:107], v[24:27], v[48:51]
ds_read_b128 v[20:23], v1 offset:3072
buffer_load_dwordx4 v0, s[4:7], s39 offen offset:1024 sc1 lds
v_mfma_f32_16x16x32_bf16 v[52:55], a[232:235], v[24:27], v[52:55]
v_mfma_f32_16x16x32_bf16 v[64:67], v[24:27], v[232:235], v[64:67]
v_mfma_f32_16x16x32_bf16 v[48:51], a[108:111], v[28:31], v[48:51]
ds_read_b128 v[24:27], v1 offset:5120
v_mfma_f32_16x16x32_bf16 v[52:55], a[236:239], v[28:31], v[52:55]
v_mfma_f32_16x16x32_bf16 v[64:67], v[28:31], v[236:239], v[64:67]
s_waitcnt lgkmcnt(5)
buffer_load_dwordx4 v0, s[4:7], s39 offen offset:2048 sc1 lds
v_mfma_f32_16x16x32_bf16 v[48:51], a[112:115], v[32:35], v[48:51]
ds_read_b128 v[28:31], v1 offset:7168
v_mfma_f32_16x16x32_bf16 v[52:55], a[240:243], v[32:35], v[52:55]
v_mfma_f32_16x16x32_bf16 v[64:67], v[32:35], v[240:243], v[64:67]
v_mfma_f32_16x16x32_bf16 v[48:51], a[116:119], v[36:39], v[48:51]
ds_read_b128 v[32:35], v1 offset:9216
v_mfma_f32_16x16x32_bf16 v[52:55], a[244:247], v[36:39], v[52:55]
buffer_load_dwordx4 v0, s[4:7], s39 offen offset:3072 sc1 lds
v_mfma_f32_16x16x32_bf16 v[64:67], v[36:39], v[244:247], v[64:67]
s_waitcnt lgkmcnt(5)
v_mfma_f32_16x16x32_bf16 v[48:51], a[120:123], v[40:43], v[48:51]
ds_read_b128 v[36:39], v1 offset:11264
v_mfma_f32_16x16x32_bf16 v[52:55], a[248:251], v[40:43], v[52:55]
v_mfma_f32_16x16x32_bf16 v[64:67], v[40:43], v[248:251], v[64:67]
v_mfma_f32_16x16x32_bf16 v[48:51], a[124:127], v[44:47], v[48:51]
s_add_u32 m0, s50, 49152
ds_read_b128 v[40:43], v1 offset:13312
s_add_u32 s39, s45, 49152
v_mfma_f32_16x16x32_bf16 v[52:55], a[252:255], v[44:47], v[52:55]
buffer_load_dwordx4 v0, s[4:7], s39 offen offset:0 sc1 lds
v_mfma_f32_16x16x32_bf16 v[64:67], v[44:47], v[252:255], v[64:67]
s_waitcnt lgkmcnt(5)
v_mfma_f32_16x16x32_bf16 v[56:59], a[0:3], v[16:19], 0
ds_read_b128 v[44:47], v1 offset:15360
v_mfma_f32_16x16x32_bf16 v[60:63], a[128:131], v[16:19], 0
v_mfma_f32_16x16x32_bf16 v[68:71], v[16:19], v[128:131], 0
v_mfma_f32_16x16x32_bf16 v[56:59], a[4:7], v[20:23], v[56:59]
ds_read_b128 v[16:19], v1 offset:17408
buffer_load_dwordx4 v0, s[4:7], s39 offen offset:1024 sc1 lds
v_mfma_f32_16x16x32_bf16 v[60:63], a[132:135], v[20:23], v[60:63]
v_mfma_f32_16x16x32_bf16 v[68:71], v[20:23], v[132:135], v[68:71]
s_waitcnt lgkmcnt(5)
v_mfma_f32_16x16x32_bf16 v[56:59], a[8:11], v[24:27], v[56:59]
ds_read_b128 v[20:23], v1 offset:19456
v_mfma_f32_16x16x32_bf16 v[60:63], a[136:139], v[24:27], v[60:63]
v_mfma_f32_16x16x32_bf16 v[68:71], v[24:27], v[136:139], v[68:71]
buffer_load_dwordx4 v0, s[4:7], s39 offen offset:2048 sc1 lds
v_mfma_f32_16x16x32_bf16 v[56:59], a[12:15], v[28:31], v[56:59]
ds_read_b128 v[24:27], v1 offset:21504
v_cvt_pk_bf16_f32 v80, v48, v49
v_mfma_f32_16x16x32_bf16 v[60:63], a[140:143], v[28:31], v[60:63]
v_cvt_pk_bf16_f32 v81, v50, v51
v_cvt_pk_bf16_f32 v82, v52, v53
v_mfma_f32_16x16x32_bf16 v[68:71], v[28:31], v[140:143], v[68:71]
s_waitcnt lgkmcnt(5)
v_cvt_pk_bf16_f32 v83, v54, v55
v_cvt_pk_bf16_f32 v88, v64, v65
v_mfma_f32_16x16x32_bf16 v[56:59], a[16:19], v[32:35], v[56:59]
ds_read_b128 v[28:31], v1 offset:23552
v_cvt_pk_bf16_f32 v89, v66, v67
v_mfma_f32_16x16x32_bf16 v[60:63], a[144:147], v[32:35], v[60:63]
buffer_load_dwordx4 v0, s[4:7], s39 offen offset:3072 sc1 lds
s_add_u32 s49, s49, 786432
v_mfma_f32_16x16x32_bf16 v[68:71], v[32:35], v[144:147], v[68:71]
s_mov_b32 s55, s49
s_add_u32 s36, s36, 1
v_mfma_f32_16x16x32_bf16 v[56:59], a[20:23], v[36:39], v[56:59]
ds_read_b128 v[32:35], v1 offset:25600
v_mfma_f32_16x16x32_bf16 v[60:63], a[148:151], v[36:39], v[60:63]
v_mfma_f32_16x16x32_bf16 v[68:71], v[36:39], v[148:151], v[68:71]
s_waitcnt lgkmcnt(5)
v_mfma_f32_16x16x32_bf16 v[56:59], a[24:27], v[40:43], v[56:59]
ds_read_b128 v[36:39], v1 offset:27648
v_mfma_f32_16x16x32_bf16 v[60:63], a[152:155], v[40:43], v[60:63]
v_mfma_f32_16x16x32_bf16 v[68:71], v[40:43], v[152:155], v[68:71]
v_mfma_f32_16x16x32_bf16 v[56:59], a[28:31], v[44:47], v[56:59]
ds_read_b128 v[40:43], v1 offset:29696
v_mfma_f32_16x16x32_bf16 v[60:63], a[156:159], v[44:47], v[60:63]
v_mfma_f32_16x16x32_bf16 v[68:71], v[44:47], v[156:159], v[68:71]
s_waitcnt lgkmcnt(5)
v_mfma_f32_16x16x32_bf16 v[56:59], a[32:35], v[16:19], v[56:59]
ds_read_b128 v[44:47], v1 offset:31744
v_mfma_f32_16x16x32_bf16 v[60:63], a[160:163], v[16:19], v[60:63]
v_mfma_f32_16x16x32_bf16 v[68:71], v[16:19], v[160:163], v[68:71]
v_mfma_f32_16x16x32_bf16 v[56:59], a[36:39], v[20:23], v[56:59]
ds_read_b128 v[16:19], v1 offset:33792
v_mfma_f32_16x16x32_bf16 v[60:63], a[164:167], v[20:23], v[60:63]
v_mfma_f32_16x16x32_bf16 v[68:71], v[20:23], v[164:167], v[68:71]
s_waitcnt lgkmcnt(5)
v_mfma_f32_16x16x32_bf16 v[56:59], a[40:43], v[24:27], v[56:59]
ds_read_b128 v[20:23], v1 offset:35840
v_mfma_f32_16x16x32_bf16 v[60:63], a[168:171], v[24:27], v[60:63]
v_mfma_f32_16x16x32_bf16 v[68:71], v[24:27], v[168:171], v[68:71]
v_mfma_f32_16x16x32_bf16 v[56:59], a[44:47], v[28:31], v[56:59]
ds_read_b128 v[24:27], v1 offset:37888
v_mfma_f32_16x16x32_bf16 v[60:63], a[172:175], v[28:31], v[60:63]
v_mfma_f32_16x16x32_bf16 v[68:71], v[28:31], v[172:175], v[68:71]
s_waitcnt lgkmcnt(5)
v_mfma_f32_16x16x32_bf16 v[56:59], a[48:51], v[32:35], v[56:59]
ds_read_b128 v[28:31], v1 offset:39936
v_mfma_f32_16x16x32_bf16 v[60:63], a[176:179], v[32:35], v[60:63]
v_mfma_f32_16x16x32_bf16 v[68:71], v[32:35], v[176:179], v[68:71]
v_mfma_f32_16x16x32_bf16 v[56:59], a[52:55], v[36:39], v[56:59]
ds_read_b128 v[32:35], v1 offset:41984
v_mfma_f32_16x16x32_bf16 v[60:63], a[180:183], v[36:39], v[60:63]
v_mfma_f32_16x16x32_bf16 v[68:71], v[36:39], v[180:183], v[68:71]
s_waitcnt lgkmcnt(5)
v_mfma_f32_16x16x32_bf16 v[56:59], a[56:59], v[40:43], v[56:59]
ds_read_b128 v[36:39], v1 offset:44032
v_mfma_f32_16x16x32_bf16 v[60:63], a[184:187], v[40:43], v[60:63]
v_mfma_f32_16x16x32_bf16 v[68:71], v[40:43], v[184:187], v[68:71]
v_mfma_f32_16x16x32_bf16 v[56:59], a[60:63], v[44:47], v[56:59]
ds_read_b128 v[40:43], v1 offset:46080
v_mfma_f32_16x16x32_bf16 v[60:63], a[188:191], v[44:47], v[60:63]
v_mfma_f32_16x16x32_bf16 v[68:71], v[44:47], v[188:191], v[68:71]
s_waitcnt lgkmcnt(5)
v_mfma_f32_16x16x32_bf16 v[56:59], a[64:67], v[16:19], v[56:59]
ds_read_b128 v[44:47], v1 offset:48128
v_mfma_f32_16x16x32_bf16 v[60:63], a[192:195], v[16:19], v[60:63]
v_mfma_f32_16x16x32_bf16 v[68:71], v[16:19], v[192:195], v[68:71]
v_mfma_f32_16x16x32_bf16 v[56:59], a[68:71], v[20:23], v[56:59]
ds_read_b128 v[16:19], v1 offset:50176
v_mfma_f32_16x16x32_bf16 v[60:63], a[196:199], v[20:23], v[60:63]
v_mfma_f32_16x16x32_bf16 v[68:71], v[20:23], v[196:199], v[68:71]
s_waitcnt lgkmcnt(5)
v_mfma_f32_16x16x32_bf16 v[56:59], a[72:75], v[24:27], v[56:59]
ds_read_b128 v[20:23], v1 offset:52224
v_mfma_f32_16x16x32_bf16 v[60:63], a[200:203], v[24:27], v[60:63]
v_mfma_f32_16x16x32_bf16 v[68:71], v[24:27], v[200:203], v[68:71]
v_mfma_f32_16x16x32_bf16 v[56:59], a[76:79], v[28:31], v[56:59]
ds_read_b128 v[24:27], v1 offset:54272
v_mfma_f32_16x16x32_bf16 v[60:63], a[204:207], v[28:31], v[60:63]
v_mfma_f32_16x16x32_bf16 v[68:71], v[28:31], v[204:207], v[68:71]
s_waitcnt lgkmcnt(5)
v_mfma_f32_16x16x32_bf16 v[56:59], a[80:83], v[32:35], v[56:59]
ds_read_b128 v[28:31], v1 offset:56320
v_mfma_f32_16x16x32_bf16 v[60:63], a[208:211], v[32:35], v[60:63]
v_mfma_f32_16x16x32_bf16 v[68:71], v[32:35], v[208:211], v[68:71]
v_mfma_f32_16x16x32_bf16 v[56:59], a[84:87], v[36:39], v[56:59]
ds_read_b128 v[32:35], v1 offset:58368
v_mfma_f32_16x16x32_bf16 v[60:63], a[212:215], v[36:39], v[60:63]
v_mfma_f32_16x16x32_bf16 v[68:71], v[36:39], v[212:215], v[68:71]
s_waitcnt lgkmcnt(5)
v_mfma_f32_16x16x32_bf16 v[56:59], a[88:91], v[40:43], v[56:59]
ds_read_b128 v[36:39], v1 offset:60416
v_mfma_f32_16x16x32_bf16 v[60:63], a[216:219], v[40:43], v[60:63]
v_mfma_f32_16x16x32_bf16 v[68:71], v[40:43], v[216:219], v[68:71]
v_mfma_f32_16x16x32_bf16 v[56:59], a[92:95], v[44:47], v[56:59]
ds_read_b128 v[40:43], v1 offset:62464
v_mfma_f32_16x16x32_bf16 v[60:63], a[220:223], v[44:47], v[60:63]
v_mfma_f32_16x16x32_bf16 v[68:71], v[44:47], v[220:223], v[68:71]
s_waitcnt lgkmcnt(5)
v_mfma_f32_16x16x32_bf16 v[56:59], a[96:99], v[16:19], v[56:59]
ds_read_b128 v[44:47], v1 offset:64512
v_mfma_f32_16x16x32_bf16 v[60:63], a[224:227], v[16:19], v[60:63]
v_mfma_f32_16x16x32_bf16 v[68:71], v[16:19], v[224:227], v[68:71]
v_mfma_f32_16x16x32_bf16 v[56:59], a[100:103], v[20:23], v[56:59]
v_mfma_f32_16x16x32_bf16 v[60:63], a[228:231], v[20:23], v[60:63]
v_mfma_f32_16x16x32_bf16 v[68:71], v[20:23], v[228:231], v[68:71]
s_waitcnt lgkmcnt(4)
v_mfma_f32_16x16x32_bf16 v[56:59], a[104:107], v[24:27], v[56:59]
v_mfma_f32_16x16x32_bf16 v[60:63], a[232:235], v[24:27], v[60:63]
v_mfma_f32_16x16x32_bf16 v[68:71], v[24:27], v[232:235], v[68:71]
v_xor_b32 v1, 0x10000, v1
s_waitcnt vmcnt(0) lgkmcnt(0)
s_barrier
v_mfma_f32_16x16x32_bf16 v[56:59], a[108:111], v[28:31], v[56:59]
ds_read_b128 v[16:19], v1 offset:0
ds_read_b128 v[20:23], v1 offset:2048
v_mfma_f32_16x16x32_bf16 v[60:63], a[236:239], v[28:31], v[60:63]
ds_read_b128 v[24:27], v1 offset:4096
v_mfma_f32_16x16x32_bf16 v[68:71], v[28:31], v[236:239], v[68:71]
v_mfma_f32_16x16x32_bf16 v[56:59], a[112:115], v[32:35], v[56:59]
ds_read_b128 v[28:31], v1 offset:6144
v_mfma_f32_16x16x32_bf16 v[60:63], a[240:243], v[32:35], v[60:63]
v_mfma_f32_16x16x32_bf16 v[68:71], v[32:35], v[240:243], v[68:71]
v_mfma_f32_16x16x32_bf16 v[56:59], a[116:119], v[36:39], v[56:59]
ds_read_b128 v[32:35], v1 offset:8192
v_mfma_f32_16x16x32_bf16 v[60:63], a[244:247], v[36:39], v[60:63]
v_mfma_f32_16x16x32_bf16 v[68:71], v[36:39], v[244:247], v[68:71]
v_mfma_f32_16x16x32_bf16 v[56:59], a[120:123], v[40:43], v[56:59]
ds_read_b128 v[36:39], v1 offset:10240
v_mfma_f32_16x16x32_bf16 v[60:63], a[248:251], v[40:43], v[60:63]
v_mfma_f32_16x16x32_bf16 v[68:71], v[40:43], v[248:251], v[68:71]
s_cmp_lt_u32 s36, 64
v_mfma_f32_16x16x32_bf16 v[56:59], a[124:127], v[44:47], v[56:59]
ds_read_b128 v[40:43], v1 offset:12288
v_mfma_f32_16x16x32_bf16 v[60:63], a[252:255], v[44:47], v[60:63]
v_mfma_f32_16x16x32_bf16 v[68:71], v[44:47], v[252:255], v[68:71]
s_cbranch_scc1 Lql_587
s_nop 7
v_cvt_pk_bf16_f32 v84, v56, v57
v_cvt_pk_bf16_f32 v85, v58, v59
v_cvt_pk_bf16_f32 v86, v60, v61
v_cvt_pk_bf16_f32 v87, v62, v63
v_cvt_pk_bf16_f32 v90, v68, v69
v_cvt_pk_bf16_f32 v91, v70, v71
buffer_store_dwordx4 v[80:83], v6, s[4:7], s55 offen sc1
buffer_store_dwordx4 v[84:87], v7, s[4:7], s55 offen sc1
buffer_store_dwordx4 v[88:91], v8, s[4:7], s55 offen sc1
v_mov_b32 v5, 64
s_waitcnt vmcnt(0) lgkmcnt(0)
s_barrier
buffer_store_dword v5, v4, s[4:7], 0 offen sc1
s_load_dwordx2 s[16:17], s[0:1], 104
s_and_b32 s52, s44, 3
s_lshr_b32 s53, s44, 2
v_lshrrev_b32 v80, 3, v9
v_and_b32 v81, 7, v9
s_lshr_b32 s38, s52, 1
s_lshl_b32 s38, s38, 10
s_and_b32 s39, s52, 1
s_lshl_b32 s39, s39, 7
s_add_u32 s38, s38, s39
s_lshl_b32 s39, s53, 12
s_add_u32 s38, s38, s39
v_lshl_add_u32 v6, v81, 4, s38
v_and_b32 v82, 3, v80
v_lshl_add_u32 v6, v82, 8, v6
v_lshrrev_b32 v82, 2, v80
v_lshl_add_u32 v6, v82, 11, v6
s_lshl_b32 s38, s52, 14
s_lshl_b32 s39, s53, 7
s_add_u32 s38, s38, s39
v_lshl_add_u32 v7, v81, 11, s38
v_lshl_add_u32 v7, v80, 4, v7
s_lshl_b32 s38, s53, 8
v_lshl_add_u32 v8, v80, 5, s38
v_min_u32 v2, 6, v9
v_lshlrev_b32 v2, 10, v2
s_lshr_b32 s47, s44, 3
s_lshl_b32 s47, s47, 7
s_add_u32 s47, s47, 3416068
s_mov_b32 s60, 0x00003f80
s_mov_b32 s61, 0x3f800000
s_waitcnt lgkmcnt(0)
s_mov_b32 s8, s16
s_and_b32 s9, s17, 0xffff
s_mov_b32 s10, 0x400000
s_mov_b32 s11, 0x20000
v_lshlrev_b32 v80, 7, v9
s_mov_b32 s38, 3424256
Lbw_590:
buffer_load_dword v81, v80, s[4:7], s38 offen sc1
s_waitcnt vmcnt(0)
v_cmp_gt_u32 vcc, 4, v81
s_cbranch_vccz Lbo_591
s_sub_u32 s37, s37, 1
s_cbranch_scc1 Lend_7
s_sleep 2
s_branch Lbw_590
Lbo_591:
s_mov_b32 s38, 3166208
buffer_load_dwordx4 v[16:19], v8, s[4:7], s38 offen offset:0 sc1
buffer_load_dwordx4 v[20:23], v8, s[4:7], s38 offen offset:16 sc1
s_mov_b32 s36, s32
Lfin_592:
s_add_u32 s48, s36, 13
Lbw_593:
buffer_load_dword v3, v2, s[4:7], s47 offen sc1
s_waitcnt vmcnt(0)
v_cmp_gt_u32 vcc, s48, v3
s_cbranch_vccz Lbo_594
s_sub_u32 s37, s37, 1
s_cbranch_scc1 Lend_7
s_sleep 32
s_branch Lbw_593
Lbo_594:
s_lshl_b32 s49, s36, 16
s_add_u32 s39, s49, 134217728
buffer_load_dwordx4 v[64:67], v6, s[4:7], s39 offen sc1
s_add_u32 s39, s49, 138412032
buffer_load_dwordx4 v[68:71], v6, s[4:7], s39 offen sc1
s_add_u32 s39, s49, 142606336
buffer_load_dwordx4 v[72:75], v6, s[4:7], s39 offen sc1
s_add_u32 s39, s49, 146800640
buffer_load_dwordx4 v[76:79], v6, s[4:7], s39 offen sc1
s_add_u32 s39, s49, 150994944
buffer_load_dwordx4 v[80:83], v6, s[4:7], s39 offen sc1
s_add_u32 s39, s49, 155189248
buffer_load_dwordx4 v[84:87], v6, s[4:7], s39 offen sc1
s_add_u32 s39, s49, 159383552
buffer_load_dwordx4 v[88:91], v6, s[4:7], s39 offen sc1
s_add_u32 s39, s49, 12582912
buffer_load_dwordx4 v[92:95], v6, s[4:7], s39 offen sc1
s_add_u32 s39, s49, 134479872
buffer_load_dwordx4 v[96:99], v6, s[4:7], s39 offen sc1
s_add_u32 s39, s49, 138674176
buffer_load_dwordx4 v[100:103], v6, s[4:7], s39 offen sc1
s_add_u32 s39, s49, 142868480
buffer_load_dwordx4 v[104:107], v6, s[4:7], s39 offen sc1
s_add_u32 s39, s49, 147062784
buffer_load_dwordx4 v[108:111], v6, s[4:7], s39 offen sc1
s_add_u32 s39, s49, 151257088
buffer_load_dwordx4 v[112:115], v6, s[4:7], s39 offen sc1
s_add_u32 s39, s49, 155451392
buffer_load_dwordx4 v[116:119], v6, s[4:7], s39 offen sc1
s_add_u32 s39, s49, 159645696
buffer_load_dwordx4 v[120:123], v6, s[4:7], s39 offen sc1
s_add_u32 s39, s49, 12845056
buffer_load_dwordx4 v[124:127], v6, s[4:7], s39 offen sc1
s_add_u32 s39, s49, 134742016
buffer_load_dwordx4 v[128:131], v6, s[4:7], s39 offen sc1
s_add_u32 s39, s49, 138936320
buffer_load_dwordx4 v[132:135], v6, s[4:7], s39 offen sc1
s_add_u32 s39, s49, 143130624
buffer_load_dwordx4 v[136:139], v6, s[4:7], s39 offen sc1
s_add_u32 s39, s49, 147324928
buffer_load_dwordx4 v[140:143], v6, s[4:7], s39 offen sc1
s_add_u32 s39, s49, 151519232
buffer_load_dwordx4 v[144:147], v6, s[4:7], s39 offen sc1
s_add_u32 s39, s49, 155713536
buffer_load_dwordx4 v[148:151], v6, s[4:7], s39 offen sc1
s_add_u32 s39, s49, 159907840
buffer_load_dwordx4 v[152:155], v6, s[4:7], s39 offen sc1
s_add_u32 s39, s49, 13107200
buffer_load_dwordx4 v[156:159], v6, s[4:7], s39 offen sc1
s_add_u32 s39, s49, 135004160
buffer_load_dwordx4 v[160:163], v6, s[4:7], s39 offen sc1
s_add_u32 s39, s49, 139198464
buffer_load_dwordx4 v[164:167], v6, s[4:7], s39 offen sc1
s_add_u32 s39, s49, 143392768
buffer_load_dwordx4 v[168:171], v6, s[4:7], s39 offen sc1
s_add_u32 s39, s49, 147587072
buffer_load_dwordx4 v[172:175], v6, s[4:7], s39 offen sc1
s_add_u32 s39, s49, 151781376
buffer_load_dwordx4 v[176:179], v6, s[4:7], s39 offen sc1
s_add_u32 s39, s49, 155975680
buffer_load_dwordx4 v[180:183], v6, s[4:7], s39 offen sc1
s_add_u32 s39, s49, 160169984
buffer_load_dwordx4 v[184:187], v6, s[4:7], s39 offen sc1
s_add_u32 s39, s49, 13369344
buffer_load_dwordx4 v[188:191], v6, s[4:7], s39 offen sc1
s_waitcnt vmcnt(24)
v_dot2_f32_bf16 v24, v64, s60, 0
v_dot2_f32_bf16 v25, v64, s61, 0
v_dot2_f32_bf16 v26, v65, s60, 0
v_dot2_f32_bf16 v27, v65, s61, 0
v_dot2_f32_bf16 v28, v66, s60, 0
v_dot2_f32_bf16 v29, v66, s61, 0
v_dot2_f32_bf16 v30, v67, s60, 0
v_dot2_f32_bf16 v31, v67, s61, 0
v_dot2_f32_bf16 v24, v68, s60, v24
v_dot2_f32_bf16 v25, v68, s61, v25
v_dot2_f32_bf16 v26, v69, s60, v26
v_dot2_f32_bf16 v27, v69, s61, v27
v_dot2_f32_bf16 v28, v70, s60, v28
v_dot2_f32_bf16 v29, v70, s61, v29
v_dot2_f32_bf16 v30, v71, s60, v30
v_dot2_f32_bf16 v31, v71, s61, v31
v_dot2_f32_bf16 v24, v72, s60, v24
v_dot2_f32_bf16 v25, v72, s61, v25
v_dot2_f32_bf16 v26, v73, s60, v26
v_dot2_f32_bf16 v27, v73, s61, v27
v_dot2_f32_bf16 v28, v74, s60, v28
v_dot2_f32_bf16 v29, v74, s61, v29
v_dot2_f32_bf16 v30, v75, s60, v30
v_dot2_f32_bf16 v31, v75, s61, v31
v_dot2_f32_bf16 v24, v76, s60, v24
v_dot2_f32_bf16 v25, v76, s61, v25
v_dot2_f32_bf16 v26, v77, s60, v26
v_dot2_f32_bf16 v27, v77, s61, v27
v_dot2_f32_bf16 v28, v78, s60, v28
v_dot2_f32_bf16 v29, v78, s61, v29
v_dot2_f32_bf16 v30, v79, s60, v30
v_dot2_f32_bf16 v31, v79, s61, v31
v_dot2_f32_bf16 v24, v80, s60, v24
v_dot2_f32_bf16 v25, v80, s61, v25
v_dot2_f32_bf16 v26, v81, s60, v26
v_dot2_f32_bf16 v27, v81, s61, v27
v_dot2_f32_bf16 v28, v82, s60, v28
v_dot2_f32_bf16 v29, v82, s61, v29
v_dot2_f32_bf16 v30, v83, s60, v30
v_dot2_f32_bf16 v31, v83, s61, v31
v_dot2_f32_bf16 v24, v84, s60, v24
v_dot2_f32_bf16 v25, v84, s61, v25
v_dot2_f32_bf16 v26, v85, s60, v26
v_dot2_f32_bf16 v27, v85, s61, v27
v_dot2_f32_bf16 v28, v86, s60, v28
v_dot2_f32_bf16 v29, v86, s61, v29
v_dot2_f32_bf16 v30, v87, s60, v30
v_dot2_f32_bf16 v31, v87, s61, v31
v_dot2_f32_bf16 v24, v88, s60, v24
v_dot2_f32_bf16 v25, v88, s61, v25
v_dot2_f32_bf16 v26, v89, s60, v26
v_dot2_f32_bf16 v27, v89, s61, v27
v_dot2_f32_bf16 v28, v90, s60, v28
v_dot2_f32_bf16 v29, v90, s61, v29
v_dot2_f32_bf16 v30, v91, s60, v30
v_dot2_f32_bf16 v31, v91, s61, v31
v_lshlrev_b32 v32, 16, v92
v_and_b32 v33, 0xffff0000, v92
v_lshlrev_b32 v34, 16, v93
v_and_b32 v35, 0xffff0000, v93
v_lshlrev_b32 v36, 16, v94
v_and_b32 v37, 0xffff0000, v94
v_lshlrev_b32 v38, 16, v95
v_and_b32 v39, 0xffff0000, v95
v_pk_fma_f32 v[32:33], v[24:25], v[16:17], v[32:33]
v_pk_fma_f32 v[34:35], v[26:27], v[18:19], v[34:35]
v_pk_fma_f32 v[36:37], v[28:29], v[20:21], v[36:37]
v_pk_fma_f32 v[38:39], v[30:31], v[22:23], v[38:39]
v_cvt_pk_bf16_f32 v40, v32, v33
v_cvt_pk_bf16_f32 v41, v34, v35
v_cvt_pk_bf16_f32 v42, v36, v37
v_cvt_pk_bf16_f32 v43, v38, v39
s_add_u32 s39, s49, 0
buffer_store_dwordx4 v[40:43], v7, s[8:11], s39 offen sc1
s_waitcnt vmcnt(17)
v_dot2_f32_bf16 v24, v96, s60, 0
v_dot2_f32_bf16 v25, v96, s61, 0
v_dot2_f32_bf16 v26, v97, s60, 0
v_dot2_f32_bf16 v27, v97, s61, 0
v_dot2_f32_bf16 v28, v98, s60, 0
v_dot2_f32_bf16 v29, v98, s61, 0
v_dot2_f32_bf16 v30, v99, s60, 0
v_dot2_f32_bf16 v31, v99, s61, 0
v_dot2_f32_bf16 v24, v100, s60, v24
v_dot2_f32_bf16 v25, v100, s61, v25
v_dot2_f32_bf16 v26, v101, s60, v26
v_dot2_f32_bf16 v27, v101, s61, v27
v_dot2_f32_bf16 v28, v102, s60, v28
v_dot2_f32_bf16 v29, v102, s61, v29
v_dot2_f32_bf16 v30, v103, s60, v30
v_dot2_f32_bf16 v31, v103, s61, v31
v_dot2_f32_bf16 v24, v104, s60, v24
v_dot2_f32_bf16 v25, v104, s61, v25
v_dot2_f32_bf16 v26, v105, s60, v26
v_dot2_f32_bf16 v27, v105, s61, v27
v_dot2_f32_bf16 v28, v106, s60, v28
v_dot2_f32_bf16 v29, v106, s61, v29
v_dot2_f32_bf16 v30, v107, s60, v30
v_dot2_f32_bf16 v31, v107, s61, v31
v_dot2_f32_bf16 v24, v108, s60, v24
v_dot2_f32_bf16 v25, v108, s61, v25
v_dot2_f32_bf16 v26, v109, s60, v26
v_dot2_f32_bf16 v27, v109, s61, v27
v_dot2_f32_bf16 v28, v110, s60, v28
v_dot2_f32_bf16 v29, v110, s61, v29
v_dot2_f32_bf16 v30, v111, s60, v30
v_dot2_f32_bf16 v31, v111, s61, v31
v_dot2_f32_bf16 v24, v112, s60, v24
v_dot2_f32_bf16 v25, v112, s61, v25
v_dot2_f32_bf16 v26, v113, s60, v26
v_dot2_f32_bf16 v27, v113, s61, v27
v_dot2_f32_bf16 v28, v114, s60, v28
v_dot2_f32_bf16 v29, v114, s61, v29
v_dot2_f32_bf16 v30, v115, s60, v30
v_dot2_f32_bf16 v31, v115, s61, v31
v_dot2_f32_bf16 v24, v116, s60, v24
v_dot2_f32_bf16 v25, v116, s61, v25
v_dot2_f32_bf16 v26, v117, s60, v26
v_dot2_f32_bf16 v27, v117, s61, v27
v_dot2_f32_bf16 v28, v118, s60, v28
v_dot2_f32_bf16 v29, v118, s61, v29
v_dot2_f32_bf16 v30, v119, s60, v30
v_dot2_f32_bf16 v31, v119, s61, v31
v_dot2_f32_bf16 v24, v120, s60, v24
v_dot2_f32_bf16 v25, v120, s61, v25
v_dot2_f32_bf16 v26, v121, s60, v26
v_dot2_f32_bf16 v27, v121, s61, v27
v_dot2_f32_bf16 v28, v122, s60, v28
v_dot2_f32_bf16 v29, v122, s61, v29
v_dot2_f32_bf16 v30, v123, s60, v30
v_dot2_f32_bf16 v31, v123, s61, v31
v_lshlrev_b32 v32, 16, v124
v_and_b32 v33, 0xffff0000, v124
v_lshlrev_b32 v34, 16, v125
v_and_b32 v35, 0xffff0000, v125
v_lshlrev_b32 v36, 16, v126
v_and_b32 v37, 0xffff0000, v126
v_lshlrev_b32 v38, 16, v127
v_and_b32 v39, 0xffff0000, v127
v_pk_fma_f32 v[32:33], v[24:25], v[16:17], v[32:33]
v_pk_fma_f32 v[34:35], v[26:27], v[18:19], v[34:35]
v_pk_fma_f32 v[36:37], v[28:29], v[20:21], v[36:37]
v_pk_fma_f32 v[38:39], v[30:31], v[22:23], v[38:39]
v_cvt_pk_bf16_f32 v44, v32, v33
v_cvt_pk_bf16_f32 v45, v34, v35
v_cvt_pk_bf16_f32 v46, v36, v37
v_cvt_pk_bf16_f32 v47, v38, v39
s_add_u32 s39, s49, 262144
buffer_store_dwordx4 v[44:47], v7, s[8:11], s39 offen sc1
s_waitcnt vmcnt(10)
v_dot2_f32_bf16 v24, v128, s60, 0
v_dot2_f32_bf16 v25, v128, s61, 0
v_dot2_f32_bf16 v26, v129, s60, 0
v_dot2_f32_bf16 v27, v129, s61, 0
v_dot2_f32_bf16 v28, v130, s60, 0
v_dot2_f32_bf16 v29, v130, s61, 0
v_dot2_f32_bf16 v30, v131, s60, 0
v_dot2_f32_bf16 v31, v131, s61, 0
v_dot2_f32_bf16 v24, v132, s60, v24
v_dot2_f32_bf16 v25, v132, s61, v25
v_dot2_f32_bf16 v26, v133, s60, v26
v_dot2_f32_bf16 v27, v133, s61, v27
v_dot2_f32_bf16 v28, v134, s60, v28
v_dot2_f32_bf16 v29, v134, s61, v29
v_dot2_f32_bf16 v30, v135, s60, v30
v_dot2_f32_bf16 v31, v135, s61, v31
v_dot2_f32_bf16 v24, v136, s60, v24
v_dot2_f32_bf16 v25, v136, s61, v25
v_dot2_f32_bf16 v26, v137, s60, v26
v_dot2_f32_bf16 v27, v137, s61, v27
v_dot2_f32_bf16 v28, v138, s60, v28
v_dot2_f32_bf16 v29, v138, s61, v29
v_dot2_f32_bf16 v30, v139, s60, v30
v_dot2_f32_bf16 v31, v139, s61, v31
v_dot2_f32_bf16 v24, v140, s60, v24
v_dot2_f32_bf16 v25, v140, s61, v25
v_dot2_f32_bf16 v26, v141, s60, v26
v_dot2_f32_bf16 v27, v141, s61, v27
v_dot2_f32_bf16 v28, v142, s60, v28
v_dot2_f32_bf16 v29, v142, s61, v29
v_dot2_f32_bf16 v30, v143, s60, v30
v_dot2_f32_bf16 v31, v143, s61, v31
v_dot2_f32_bf16 v24, v144, s60, v24
v_dot2_f32_bf16 v25, v144, s61, v25
v_dot2_f32_bf16 v26, v145, s60, v26
v_dot2_f32_bf16 v27, v145, s61, v27
v_dot2_f32_bf16 v28, v146, s60, v28
v_dot2_f32_bf16 v29, v146, s61, v29
v_dot2_f32_bf16 v30, v147, s60, v30
v_dot2_f32_bf16 v31, v147, s61, v31
v_dot2_f32_bf16 v24, v148, s60, v24
v_dot2_f32_bf16 v25, v148, s61, v25
v_dot2_f32_bf16 v26, v149, s60, v26
v_dot2_f32_bf16 v27, v149, s61, v27
v_dot2_f32_bf16 v28, v150, s60, v28
v_dot2_f32_bf16 v29, v150, s61, v29
v_dot2_f32_bf16 v30, v151, s60, v30
v_dot2_f32_bf16 v31, v151, s61, v31
v_dot2_f32_bf16 v24, v152, s60, v24
v_dot2_f32_bf16 v25, v152, s61, v25
v_dot2_f32_bf16 v26, v153, s60, v26
v_dot2_f32_bf16 v27, v153, s61, v27
v_dot2_f32_bf16 v28, v154, s60, v28
v_dot2_f32_bf16 v29, v154, s61, v29
v_dot2_f32_bf16 v30, v155, s60, v30
v_dot2_f32_bf16 v31, v155, s61, v31
v_lshlrev_b32 v32, 16, v156
v_and_b32 v33, 0xffff0000, v156
v_lshlrev_b32 v34, 16, v157
v_and_b32 v35, 0xffff0000, v157
v_lshlrev_b32 v36, 16, v158
v_and_b32 v37, 0xffff0000, v158
v_lshlrev_b32 v38, 16, v159
v_and_b32 v39, 0xffff0000, v159
v_pk_fma_f32 v[32:33], v[24:25], v[16:17], v[32:33]
v_pk_fma_f32 v[34:35], v[26:27], v[18:19], v[34:35]
v_pk_fma_f32 v[36:37], v[28:29], v[20:21], v[36:37]
v_pk_fma_f32 v[38:39], v[30:31], v[22:23], v[38:39]
v_cvt_pk_bf16_f32 v48, v32, v33
v_cvt_pk_bf16_f32 v49, v34, v35
v_cvt_pk_bf16_f32 v50, v36, v37
v_cvt_pk_bf16_f32 v51, v38, v39
s_add_u32 s39, s49, 524288
buffer_store_dwordx4 v[48:51], v7, s[8:11], s39 offen sc1
s_waitcnt vmcnt(3)
v_dot2_f32_bf16 v24, v160, s60, 0
v_dot2_f32_bf16 v25, v160, s61, 0
v_dot2_f32_bf16 v26, v161, s60, 0
v_dot2_f32_bf16 v27, v161, s61, 0
v_dot2_f32_bf16 v28, v162, s60, 0
v_dot2_f32_bf16 v29, v162, s61, 0
v_dot2_f32_bf16 v30, v163, s60, 0
v_dot2_f32_bf16 v31, v163, s61, 0
v_dot2_f32_bf16 v24, v164, s60, v24
v_dot2_f32_bf16 v25, v164, s61, v25
v_dot2_f32_bf16 v26, v165, s60, v26
v_dot2_f32_bf16 v27, v165, s61, v27
v_dot2_f32_bf16 v28, v166, s60, v28
v_dot2_f32_bf16 v29, v166, s61, v29
v_dot2_f32_bf16 v30, v167, s60, v30
v_dot2_f32_bf16 v31, v167, s61, v31
v_dot2_f32_bf16 v24, v168, s60, v24
v_dot2_f32_bf16 v25, v168, s61, v25
v_dot2_f32_bf16 v26, v169, s60, v26
v_dot2_f32_bf16 v27, v169, s61, v27
v_dot2_f32_bf16 v28, v170, s60, v28
v_dot2_f32_bf16 v29, v170, s61, v29
v_dot2_f32_bf16 v30, v171, s60, v30
v_dot2_f32_bf16 v31, v171, s61, v31
v_dot2_f32_bf16 v24, v172, s60, v24
v_dot2_f32_bf16 v25, v172, s61, v25
v_dot2_f32_bf16 v26, v173, s60, v26
v_dot2_f32_bf16 v27, v173, s61, v27
v_dot2_f32_bf16 v28, v174, s60, v28
v_dot2_f32_bf16 v29, v174, s61, v29
v_dot2_f32_bf16 v30, v175, s60, v30
v_dot2_f32_bf16 v31, v175, s61, v31
v_dot2_f32_bf16 v24, v176, s60, v24
v_dot2_f32_bf16 v25, v176, s61, v25
v_dot2_f32_bf16 v26, v177, s60, v26
v_dot2_f32_bf16 v27, v177, s61, v27
v_dot2_f32_bf16 v28, v178, s60, v28
v_dot2_f32_bf16 v29, v178, s61, v29
v_dot2_f32_bf16 v30, v179, s60, v30
v_dot2_f32_bf16 v31, v179, s61, v31
v_dot2_f32_bf16 v24, v180, s60, v24
v_dot2_f32_bf16 v25, v180, s61, v25
v_dot2_f32_bf16 v26, v181, s60, v26
v_dot2_f32_bf16 v27, v181, s61, v27
v_dot2_f32_bf16 v28, v182, s60, v28
v_dot2_f32_bf16 v29, v182, s61, v29
v_dot2_f32_bf16 v30, v183, s60, v30
v_dot2_f32_bf16 v31, v183, s61, v31
v_dot2_f32_bf16 v24, v184, s60, v24
v_dot2_f32_bf16 v25, v184, s61, v25
v_dot2_f32_bf16 v26, v185, s60, v26
v_dot2_f32_bf16 v27, v185, s61, v27
v_dot2_f32_bf16 v28, v186, s60, v28
v_dot2_f32_bf16 v29, v186, s61, v29
v_dot2_f32_bf16 v30, v187, s60, v30
v_dot2_f32_bf16 v31, v187, s61, v31
v_lshlrev_b32 v32, 16, v188
v_and_b32 v33, 0xffff0000, v188
v_lshlrev_b32 v34, 16, v189
v_and_b32 v35, 0xffff0000, v189
v_lshlrev_b32 v36, 16, v190
v_and_b32 v37, 0xffff0000, v190
v_lshlrev_b32 v38, 16, v191
v_and_b32 v39, 0xffff0000, v191
v_pk_fma_f32 v[32:33], v[24:25], v[16:17], v[32:33]
v_pk_fma_f32 v[34:35], v[26:27], v[18:19], v[34:35]
v_pk_fma_f32 v[36:37], v[28:29], v[20:21], v[36:37]
v_pk_fma_f32 v[38:39], v[30:31], v[22:23], v[38:39]
v_cvt_pk_bf16_f32 v52, v32, v33
v_cvt_pk_bf16_f32 v53, v34, v35
v_cvt_pk_bf16_f32 v54, v36, v37
v_cvt_pk_bf16_f32 v55, v38, v39
s_add_u32 s39, s49, 786432
buffer_store_dwordx4 v[52:55], v7, s[8:11], s39 offen sc1
s_add_u32 s36, s36, 16
s_cmp_lt_u32 s36, 48
s_cbranch_scc1 Lfin_592
Lfin_595:
s_add_u32 s48, s36, 1
Lbw_596:
buffer_load_dword v3, v2, s[4:7], s47 offen sc1
s_waitcnt vmcnt(0)
v_cmp_gt_u32 vcc, s48, v3
s_cbranch_vccz Lbo_597
s_sub_u32 s37, s37, 1
s_cbranch_scc1 Lend_7
s_sleep 4
s_branch Lbw_596
Lbo_597:
s_lshl_b32 s49, s36, 16
s_add_u32 s39, s49, 134217728
buffer_load_dwordx4 v[64:67], v6, s[4:7], s39 offen sc1
s_add_u32 s39, s49, 138412032
buffer_load_dwordx4 v[68:71], v6, s[4:7], s39 offen sc1
s_add_u32 s39, s49, 142606336
buffer_load_dwordx4 v[72:75], v6, s[4:7], s39 offen sc1
s_add_u32 s39, s49, 146800640
buffer_load_dwordx4 v[76:79], v6, s[4:7], s39 offen sc1
s_add_u32 s39, s49, 150994944
buffer_load_dwordx4 v[80:83], v6, s[4:7], s39 offen sc1
s_add_u32 s39, s49, 155189248
buffer_load_dwordx4 v[84:87], v6, s[4:7], s39 offen sc1
s_add_u32 s39, s49, 159383552
buffer_load_dwordx4 v[88:91], v6, s[4:7], s39 offen sc1
s_add_u32 s39, s49, 12582912
buffer_load_dwordx4 v[92:95], v6, s[4:7], s39 offen sc1
s_waitcnt vmcnt(0)
v_dot2_f32_bf16 v24, v64, s60, 0
v_dot2_f32_bf16 v25, v64, s61, 0
v_dot2_f32_bf16 v26, v65, s60, 0
v_dot2_f32_bf16 v27, v65, s61, 0
v_dot2_f32_bf16 v28, v66, s60, 0
v_dot2_f32_bf16 v29, v66, s61, 0
v_dot2_f32_bf16 v30, v67, s60, 0
v_dot2_f32_bf16 v31, v67, s61, 0
v_dot2_f32_bf16 v24, v68, s60, v24
v_dot2_f32_bf16 v25, v68, s61, v25
v_dot2_f32_bf16 v26, v69, s60, v26
v_dot2_f32_bf16 v27, v69, s61, v27
v_dot2_f32_bf16 v28, v70, s60, v28
v_dot2_f32_bf16 v29, v70, s61, v29
v_dot2_f32_bf16 v30, v71, s60, v30
v_dot2_f32_bf16 v31, v71, s61, v31
v_dot2_f32_bf16 v24, v72, s60, v24
v_dot2_f32_bf16 v25, v72, s61, v25
v_dot2_f32_bf16 v26, v73, s60, v26
v_dot2_f32_bf16 v27, v73, s61, v27
v_dot2_f32_bf16 v28, v74, s60, v28
v_dot2_f32_bf16 v29, v74, s61, v29
v_dot2_f32_bf16 v30, v75, s60, v30
v_dot2_f32_bf16 v31, v75, s61, v31
v_dot2_f32_bf16 v24, v76, s60, v24
v_dot2_f32_bf16 v25, v76, s61, v25
v_dot2_f32_bf16 v26, v77, s60, v26
v_dot2_f32_bf16 v27, v77, s61, v27
v_dot2_f32_bf16 v28, v78, s60, v28
v_dot2_f32_bf16 v29, v78, s61, v29
v_dot2_f32_bf16 v30, v79, s60, v30
v_dot2_f32_bf16 v31, v79, s61, v31
v_dot2_f32_bf16 v24, v80, s60, v24
v_dot2_f32_bf16 v25, v80, s61, v25
v_dot2_f32_bf16 v26, v81, s60, v26
v_dot2_f32_bf16 v27, v81, s61, v27
v_dot2_f32_bf16 v28, v82, s60, v28
v_dot2_f32_bf16 v29, v82, s61, v29
v_dot2_f32_bf16 v30, v83, s60, v30
v_dot2_f32_bf16 v31, v83, s61, v31
v_dot2_f32_bf16 v24, v84, s60, v24
v_dot2_f32_bf16 v25, v84, s61, v25
v_dot2_f32_bf16 v26, v85, s60, v26
v_dot2_f32_bf16 v27, v85, s61, v27
v_dot2_f32_bf16 v28, v86, s60, v28
v_dot2_f32_bf16 v29, v86, s61, v29
v_dot2_f32_bf16 v30, v87, s60, v30
v_dot2_f32_bf16 v31, v87, s61, v31
v_dot2_f32_bf16 v24, v88, s60, v24
v_dot2_f32_bf16 v25, v88, s61, v25
v_dot2_f32_bf16 v26, v89, s60, v26
v_dot2_f32_bf16 v27, v89, s61, v27
v_dot2_f32_bf16 v28, v90, s60, v28
v_dot2_f32_bf16 v29, v90, s61, v29
v_dot2_f32_bf16 v30, v91, s60, v30
v_dot2_f32_bf16 v31, v91, s61, v31
v_lshlrev_b32 v32, 16, v92
v_and_b32 v33, 0xffff0000, v92
v_lshlrev_b32 v34, 16, v93
v_and_b32 v35, 0xffff0000, v93
v_lshlrev_b32 v36, 16, v94
v_and_b32 v37, 0xffff0000, v94
v_lshlrev_b32 v38, 16, v95
v_and_b32 v39, 0xffff0000, v95
v_pk_fma_f32 v[32:33], v[24:25], v[16:17], v[32:33]
v_pk_fma_f32 v[34:35], v[26:27], v[18:19], v[34:35]
v_pk_fma_f32 v[36:37], v[28:29], v[20:21], v[36:37]
v_pk_fma_f32 v[38:39], v[30:31], v[22:23], v[38:39]
v_cvt_pk_bf16_f32 v40, v32, v33
v_cvt_pk_bf16_f32 v41, v34, v35
v_cvt_pk_bf16_f32 v42, v36, v37
v_cvt_pk_bf16_f32 v43, v38, v39
s_add_u32 s39, s49, 0
buffer_store_dwordx4 v[40:43], v7, s[8:11], s39 offen sc1
s_add_u32 s36, s36, 4
s_cmp_lt_u32 s36, 64
s_cbranch_scc1 Lfin_595
s_endpgm
Lend_7:
s_endpgm
Lhelper_5:
v_mov_b32 v9, v1
s_sub_u32 s52, s33, 4
s_lshl_b32 s26, s34, 2
s_add_u32 s26, s26, s52
s_sub_u32 s26, s26, 64
s_mul_i32 s44, s52, 14
s_add_u32 s44, s44, s34
s_sub_u32 s44, s44, 16
s_lshl_b32 s53, s52, 1
s_add_u32 s53, s53, s34
s_add_u32 s53, s53, 26
s_cmp_ge_u32 s34, 30
s_cselect_b32 s44, s53, s44
s_load_dwordx2 s[16:17], s[0:1], 96
s_load_dwordx2 s[18:19], s[0:1], 88
s_load_dwordx2 s[20:21], s[0:1], 0
s_lshl_b32 s38, s26, 7
s_add_u32 s38, s38, 3424256
v_min_u32 v80, 1, v0
v_lshl_add_u32 v10, v80, 30, s38
s_lshl_b32 s38, s44, 7
s_add_u32 s38, s38, 3416064
v_min_u32 v80, 1, v0
v_lshl_add_u32 v8, v80, 30, s38
v_mov_b32 v14, 0
v_mov_b32 v15, 0
buffer_store_dword v14, v10, s[4:7], 0 offen sc1
buffer_store_dwordx2 v[14:15], v8, s[4:7], 0 offen sc1
s_waitcnt lgkmcnt(0)
s_mov_b32 s8, s16
s_and_b32 s9, s17, 0xffff
s_mov_b32 s10, 0xc00000
s_mov_b32 s11, 0x20000
s_mov_b32 s84, s18
s_and_b32 s85, s19, 0xffff
s_mov_b32 s86, 0x800
s_mov_b32 s87, 0x20000
s_mov_b32 s88, s20
s_and_b32 s89, s21, 0xffff
s_mov_b32 s90, 0x400000
s_mov_b32 s91, 0x20000
v_and_b32 v12, 15, v9
v_lshlrev_b32 v12, 4, v12
s_lshl_b32 s38, s32, 2
v_add_u32 v11, s38, v12
v_lshlrev_b32 v13, 4, v9
v_lshrrev_b32 v7, 4, v9
v_lshlrev_b32 v6, 7, v12
v_lshl_add_u32 v6, v7, 4, v6
v_lshlrev_b32 v7, 5, v7
s_lshr_b32 s60, s26, 1
s_and_b32 s61, s26, 1
s_lshl_b32 s62, s60, 8
s_lshl_b32 s38, s61, 13
s_add_u32 s62, s62, s38
s_add_u32 s62, s62, 3178496
s_min_u32 s38, s32, 1
s_lshl_b32 s38, s38, 30
s_add_u32 s38, s38, s62
v_lshlrev_b32 v2, 2, v9
v_mov_b32 v3, -1
buffer_store_dword v3, v2, s[4:7], s38 offen sc1
s_mov_b32 s52, 1
s_waitcnt vmcnt(0)
s_cmp_lg_u32 s32, 0
s_cbranch_scc1 Lar_598
s_mov_b64 exec, 1
v_mov_b32 v14, 160
v_mov_b32 v15, s52
buffer_atomic_add v15, v14, s[12:15], 0 offen sc1
s_mov_b64 exec, -1
Lar_598:
v_lshrrev_b32 v2, 3, v0
v_and_b32 v3, 7, v0
v_mul_u32_u24 v4, 12288, v2
v_lshl_add_u32 v4, v3, 4, v4
v_lshlrev_b32 v5, 1, v2
v_mov_b32 v96, 0
v_mov_b32 v97, 0
v_mov_b32 v98, 0
v_mov_b32 v99, 0
v_mov_b32 v100, 0
v_mov_b32 v101, 0
v_mov_b32 v102, 0
v_mov_b32 v103, 0
s_lshl_b32 s41, s61, 10
s_mul_i32 s40, s61, 6291456
s_lshl_b32 s42, s60, 7
s_add_u32 s40, s40, s42
buffer_load_ushort v80, v5, s[84:87], s41 offen offset:0
buffer_load_ushort v81, v5, s[84:87], s41 offen offset:64
buffer_load_ushort v82, v5, s[84:87], s41 offen offset:128
buffer_load_ushort v83, v5, s[84:87], s41 offen offset:192
buffer_load_ushort v84, v5, s[84:87], s41 offen offset:256
buffer_load_ushort v85, v5, s[84:87], s41 offen offset:320
buffer_load_ushort v86, v5, s[84:87], s41 offen offset:384
buffer_load_ushort v87, v5, s[84:87], s41 offen offset:448
buffer_load_ushort v88, v5, s[84:87], s41 offen offset:512
buffer_load_ushort v89, v5, s[84:87], s41 offen offset:576
buffer_load_ushort v90, v5, s[84:87], s41 offen offset:640
buffer_load_ushort v91, v5, s[84:87], s41 offen offset:704
buffer_load_ushort v92, v5, s[84:87], s41 offen offset:768
buffer_load_ushort v93, v5, s[84:87], s41 offen offset:832
buffer_load_ushort v94, v5, s[84:87], s41 offen offset:896
buffer_load_ushort v95, v5, s[84:87], s41 offen offset:960
buffer_load_dwordx4 v[16:19], v4, s[8:11], s40 offen
s_add_u32 s40, s40, 393216
buffer_load_dwordx4 v[20:23], v4, s[8:11], s40 offen
s_add_u32 s40, s40, 393216
buffer_load_dwordx4 v[24:27], v4, s[8:11], s40 offen
s_add_u32 s40, s40, 393216
buffer_load_dwordx4 v[28:31], v4, s[8:11], s40 offen
s_add_u32 s40, s40, 393216
buffer_load_dwordx4 v[32:35], v4, s[8:11], s40 offen
s_add_u32 s40, s40, 393216
buffer_load_dwordx4 v[36:39], v4, s[8:11], s40 offen
s_add_u32 s40, s40, 393216
buffer_load_dwordx4 v[40:43], v4, s[8:11], s40 offen
s_add_u32 s40, s40, 393216
buffer_load_dwordx4 v[44:47], v4, s[8:11], s40 offen
s_add_u32 s40, s40, 393216
buffer_load_dwordx4 v[48:51], v4, s[8:11], s40 offen
s_add_u32 s40, s40, 393216
buffer_load_dwordx4 v[52:55], v4, s[8:11], s40 offen
s_add_u32 s40, s40, 393216
buffer_load_dwordx4 v[56:59], v4, s[8:11], s40 offen
s_add_u32 s40, s40, 393216
buffer_load_dwordx4 v[60:63], v4, s[8:11], s40 offen
s_add_u32 s40, s40, 393216
buffer_load_dwordx4 v[64:67], v4, s[8:11], s40 offen
s_add_u32 s40, s40, 393216
buffer_load_dwordx4 v[68:71], v4, s[8:11], s40 offen
s_add_u32 s40, s40, 393216
buffer_load_dwordx4 v[72:75], v4, s[8:11], s40 offen
s_add_u32 s40, s40, 393216
buffer_load_dwordx4 v[76:79], v4, s[8:11], s40 offen
s_add_u32 s40, s40, 393216
s_add_u32 s52, s26, 0
s_lshl_b32 s41, s52, 15
s_lshl_b32 s42, s32, 9
s_add_u32 s41, s41, s42
buffer_load_dwordx4 a[0:3], v6, s[88:91], s41 offen offset:0
buffer_load_dwordx4 a[4:7], v6, s[88:91], s41 offen offset:64
buffer_load_dwordx4 a[8:11], v6, s[88:91], s41 offen offset:128
buffer_load_dwordx4 a[12:15], v6, s[88:91], s41 offen offset:192
buffer_load_dwordx4 a[16:19], v6, s[88:91], s41 offen offset:256
buffer_load_dwordx4 a[20:23], v6, s[88:91], s41 offen offset:320
buffer_load_dwordx4 a[24:27], v6, s[88:91], s41 offen offset:384
buffer_load_dwordx4 a[28:31], v6, s[88:91], s41 offen offset:448
s_add_u32 s52, s26, 64
s_lshl_b32 s41, s52, 15
s_lshl_b32 s42, s32, 9
s_add_u32 s41, s41, s42
buffer_load_dwordx4 a[32:35], v6, s[88:91], s41 offen offset:0
buffer_load_dwordx4 a[36:39], v6, s[88:91], s41 offen offset:64
buffer_load_dwordx4 a[40:43], v6, s[88:91], s41 offen offset:128
buffer_load_dwordx4 a[44:47], v6, s[88:91], s41 offen offset:192
buffer_load_dwordx4 a[48:51], v6, s[88:91], s41 offen offset:256
buffer_load_dwordx4 a[52:55], v6, s[88:91], s41 offen offset:320
buffer_load_dwordx4 a[56:59], v6, s[88:91], s41 offen offset:384
buffer_load_dwordx4 a[60:63], v6, s[88:91], s41 offen offset:448
s_waitcnt vmcnt(32)
v_lshlrev_b32 v80, 16, v80
v_mul_f32 v104, 0xbfb8aa3b, v80
v_exp_f32 v104, v104
s_nop 0
v_add_f32 v104, 1.0, v104
v_rcp_f32 v104, v104
s_nop 0
v_mul_f32 v104, v104, v80
v_cvt_pk_bf16_f32 v80, 0, v104
v_lshlrev_b32 v81, 16, v81
v_mul_f32 v104, 0xbfb8aa3b, v81
v_exp_f32 v104, v104
s_nop 0
v_add_f32 v104, 1.0, v104
v_rcp_f32 v104, v104
s_nop 0
v_mul_f32 v104, v104, v81
v_cvt_pk_bf16_f32 v81, 0, v104
v_lshlrev_b32 v82, 16, v82
v_mul_f32 v104, 0xbfb8aa3b, v82
v_exp_f32 v104, v104
s_nop 0
v_add_f32 v104, 1.0, v104
v_rcp_f32 v104, v104
s_nop 0
v_mul_f32 v104, v104, v82
v_cvt_pk_bf16_f32 v82, 0, v104
v_lshlrev_b32 v83, 16, v83
v_mul_f32 v104, 0xbfb8aa3b, v83
v_exp_f32 v104, v104
s_nop 0
v_add_f32 v104, 1.0, v104
v_rcp_f32 v104, v104
s_nop 0
v_mul_f32 v104, v104, v83
v_cvt_pk_bf16_f32 v83, 0, v104
v_lshlrev_b32 v84, 16, v84
v_mul_f32 v104, 0xbfb8aa3b, v84
v_exp_f32 v104, v104
s_nop 0
v_add_f32 v104, 1.0, v104
v_rcp_f32 v104, v104
s_nop 0
v_mul_f32 v104, v104, v84
v_cvt_pk_bf16_f32 v84, 0, v104
v_lshlrev_b32 v85, 16, v85
v_mul_f32 v104, 0xbfb8aa3b, v85
v_exp_f32 v104, v104
s_nop 0
v_add_f32 v104, 1.0, v104
v_rcp_f32 v104, v104
s_nop 0
v_mul_f32 v104, v104, v85
v_cvt_pk_bf16_f32 v85, 0, v104
v_lshlrev_b32 v86, 16, v86
v_mul_f32 v104, 0xbfb8aa3b, v86
v_exp_f32 v104, v104
s_nop 0
v_add_f32 v104, 1.0, v104
v_rcp_f32 v104, v104
s_nop 0
v_mul_f32 v104, v104, v86
v_cvt_pk_bf16_f32 v86, 0, v104
v_lshlrev_b32 v87, 16, v87
v_mul_f32 v104, 0xbfb8aa3b, v87
v_exp_f32 v104, v104
s_nop 0
v_add_f32 v104, 1.0, v104
v_rcp_f32 v104, v104
s_nop 0
v_mul_f32 v104, v104, v87
v_cvt_pk_bf16_f32 v87, 0, v104
v_lshlrev_b32 v88, 16, v88
v_mul_f32 v104, 0xbfb8aa3b, v88
v_exp_f32 v104, v104
s_nop 0
v_add_f32 v104, 1.0, v104
v_rcp_f32 v104, v104
s_nop 0
v_mul_f32 v104, v104, v88
v_cvt_pk_bf16_f32 v88, 0, v104
v_lshlrev_b32 v89, 16, v89
v_mul_f32 v104, 0xbfb8aa3b, v89
v_exp_f32 v104, v104
s_nop 0
v_add_f32 v104, 1.0, v104
v_rcp_f32 v104, v104
s_nop 0
v_mul_f32 v104, v104, v89
v_cvt_pk_bf16_f32 v89, 0, v104
v_lshlrev_b32 v90, 16, v90
v_mul_f32 v104, 0xbfb8aa3b, v90
v_exp_f32 v104, v104
s_nop 0
v_add_f32 v104, 1.0, v104
v_rcp_f32 v104, v104
s_nop 0
v_mul_f32 v104, v104, v90
v_cvt_pk_bf16_f32 v90, 0, v104
v_lshlrev_b32 v91, 16, v91
v_mul_f32 v104, 0xbfb8aa3b, v91
v_exp_f32 v104, v104
s_nop 0
v_add_f32 v104, 1.0, v104
v_rcp_f32 v104, v104
s_nop 0
v_mul_f32 v104, v104, v91
v_cvt_pk_bf16_f32 v91, 0, v104
v_lshlrev_b32 v92, 16, v92
v_mul_f32 v104, 0xbfb8aa3b, v92
v_exp_f32 v104, v104
s_nop 0
v_add_f32 v104, 1.0, v104
v_rcp_f32 v104, v104
s_nop 0
v_mul_f32 v104, v104, v92
v_cvt_pk_bf16_f32 v92, 0, v104
v_lshlrev_b32 v93, 16, v93
v_mul_f32 v104, 0xbfb8aa3b, v93
v_exp_f32 v104, v104
s_nop 0
v_add_f32 v104, 1.0, v104
v_rcp_f32 v104, v104
s_nop 0
v_mul_f32 v104, v104, v93
v_cvt_pk_bf16_f32 v93, 0, v104
v_lshlrev_b32 v94, 16, v94
v_mul_f32 v104, 0xbfb8aa3b, v94
v_exp_f32 v104, v104
s_nop 0
v_add_f32 v104, 1.0, v104
v_rcp_f32 v104, v104
s_nop 0
v_mul_f32 v104, v104, v94
v_cvt_pk_bf16_f32 v94, 0, v104
v_lshlrev_b32 v95, 16, v95
v_mul_f32 v104, 0xbfb8aa3b, v95
v_exp_f32 v104, v104
s_nop 0
v_add_f32 v104, 1.0, v104
v_rcp_f32 v104, v104
s_nop 0
v_mul_f32 v104, v104, v95
v_cvt_pk_bf16_f32 v95, 0, v104
s_waitcnt vmcnt(31)
v_lshlrev_b32 v104, 16, v16
v_and_b32 v105, 0xffff0000, v16
v_fmac_f32 v96, v104, v80
v_fmac_f32 v97, v105, v80
v_lshlrev_b32 v104, 16, v17
v_and_b32 v105, 0xffff0000, v17
v_fmac_f32 v98, v104, v80
v_fmac_f32 v99, v105, v80
v_lshlrev_b32 v104, 16, v18
v_and_b32 v105, 0xffff0000, v18
v_fmac_f32 v100, v104, v80
v_fmac_f32 v101, v105, v80
v_lshlrev_b32 v104, 16, v19
v_and_b32 v105, 0xffff0000, v19
v_fmac_f32 v102, v104, v80
v_fmac_f32 v103, v105, v80
s_waitcnt vmcnt(30)
v_lshlrev_b32 v104, 16, v20
v_and_b32 v105, 0xffff0000, v20
v_fmac_f32 v96, v104, v81
v_fmac_f32 v97, v105, v81
v_lshlrev_b32 v104, 16, v21
v_and_b32 v105, 0xffff0000, v21
v_fmac_f32 v98, v104, v81
v_fmac_f32 v99, v105, v81
v_lshlrev_b32 v104, 16, v22
v_and_b32 v105, 0xffff0000, v22
v_fmac_f32 v100, v104, v81
v_fmac_f32 v101, v105, v81
v_lshlrev_b32 v104, 16, v23
v_and_b32 v105, 0xffff0000, v23
v_fmac_f32 v102, v104, v81
v_fmac_f32 v103, v105, v81
s_waitcnt vmcnt(29)
v_lshlrev_b32 v104, 16, v24
v_and_b32 v105, 0xffff0000, v24
v_fmac_f32 v96, v104, v82
v_fmac_f32 v97, v105, v82
v_lshlrev_b32 v104, 16, v25
v_and_b32 v105, 0xffff0000, v25
v_fmac_f32 v98, v104, v82
v_fmac_f32 v99, v105, v82
v_lshlrev_b32 v104, 16, v26
v_and_b32 v105, 0xffff0000, v26
v_fmac_f32 v100, v104, v82
v_fmac_f32 v101, v105, v82
v_lshlrev_b32 v104, 16, v27
v_and_b32 v105, 0xffff0000, v27
v_fmac_f32 v102, v104, v82
v_fmac_f32 v103, v105, v82
s_waitcnt vmcnt(28)
v_lshlrev_b32 v104, 16, v28
v_and_b32 v105, 0xffff0000, v28
v_fmac_f32 v96, v104, v83
v_fmac_f32 v97, v105, v83
v_lshlrev_b32 v104, 16, v29
v_and_b32 v105, 0xffff0000, v29
v_fmac_f32 v98, v104, v83
v_fmac_f32 v99, v105, v83
v_lshlrev_b32 v104, 16, v30
v_and_b32 v105, 0xffff0000, v30
v_fmac_f32 v100, v104, v83
v_fmac_f32 v101, v105, v83
v_lshlrev_b32 v104, 16, v31
v_and_b32 v105, 0xffff0000, v31
v_fmac_f32 v102, v104, v83
v_fmac_f32 v103, v105, v83
s_waitcnt vmcnt(27)
v_lshlrev_b32 v104, 16, v32
v_and_b32 v105, 0xffff0000, v32
v_fmac_f32 v96, v104, v84
v_fmac_f32 v97, v105, v84
v_lshlrev_b32 v104, 16, v33
v_and_b32 v105, 0xffff0000, v33
v_fmac_f32 v98, v104, v84
v_fmac_f32 v99, v105, v84
v_lshlrev_b32 v104, 16, v34
v_and_b32 v105, 0xffff0000, v34
v_fmac_f32 v100, v104, v84
v_fmac_f32 v101, v105, v84
v_lshlrev_b32 v104, 16, v35
v_and_b32 v105, 0xffff0000, v35
v_fmac_f32 v102, v104, v84
v_fmac_f32 v103, v105, v84
s_waitcnt vmcnt(26)
v_lshlrev_b32 v104, 16, v36
v_and_b32 v105, 0xffff0000, v36
v_fmac_f32 v96, v104, v85
v_fmac_f32 v97, v105, v85
v_lshlrev_b32 v104, 16, v37
v_and_b32 v105, 0xffff0000, v37
v_fmac_f32 v98, v104, v85
v_fmac_f32 v99, v105, v85
v_lshlrev_b32 v104, 16, v38
v_and_b32 v105, 0xffff0000, v38
v_fmac_f32 v100, v104, v85
v_fmac_f32 v101, v105, v85
v_lshlrev_b32 v104, 16, v39
v_and_b32 v105, 0xffff0000, v39
v_fmac_f32 v102, v104, v85
v_fmac_f32 v103, v105, v85
s_waitcnt vmcnt(25)
v_lshlrev_b32 v104, 16, v40
v_and_b32 v105, 0xffff0000, v40
v_fmac_f32 v96, v104, v86
v_fmac_f32 v97, v105, v86
v_lshlrev_b32 v104, 16, v41
v_and_b32 v105, 0xffff0000, v41
v_fmac_f32 v98, v104, v86
v_fmac_f32 v99, v105, v86
v_lshlrev_b32 v104, 16, v42
v_and_b32 v105, 0xffff0000, v42
v_fmac_f32 v100, v104, v86
v_fmac_f32 v101, v105, v86
v_lshlrev_b32 v104, 16, v43
v_and_b32 v105, 0xffff0000, v43
v_fmac_f32 v102, v104, v86
v_fmac_f32 v103, v105, v86
s_waitcnt vmcnt(24)
v_lshlrev_b32 v104, 16, v44
v_and_b32 v105, 0xffff0000, v44
v_fmac_f32 v96, v104, v87
v_fmac_f32 v97, v105, v87
v_lshlrev_b32 v104, 16, v45
v_and_b32 v105, 0xffff0000, v45
v_fmac_f32 v98, v104, v87
v_fmac_f32 v99, v105, v87
v_lshlrev_b32 v104, 16, v46
v_and_b32 v105, 0xffff0000, v46
v_fmac_f32 v100, v104, v87
v_fmac_f32 v101, v105, v87
v_lshlrev_b32 v104, 16, v47
v_and_b32 v105, 0xffff0000, v47
v_fmac_f32 v102, v104, v87
v_fmac_f32 v103, v105, v87
s_waitcnt vmcnt(23)
v_lshlrev_b32 v104, 16, v48
v_and_b32 v105, 0xffff0000, v48
v_fmac_f32 v96, v104, v88
v_fmac_f32 v97, v105, v88
v_lshlrev_b32 v104, 16, v49
v_and_b32 v105, 0xffff0000, v49
v_fmac_f32 v98, v104, v88
v_fmac_f32 v99, v105, v88
v_lshlrev_b32 v104, 16, v50
v_and_b32 v105, 0xffff0000, v50
v_fmac_f32 v100, v104, v88
v_fmac_f32 v101, v105, v88
v_lshlrev_b32 v104, 16, v51
v_and_b32 v105, 0xffff0000, v51
v_fmac_f32 v102, v104, v88
v_fmac_f32 v103, v105, v88
s_waitcnt vmcnt(22)
v_lshlrev_b32 v104, 16, v52
v_and_b32 v105, 0xffff0000, v52
v_fmac_f32 v96, v104, v89
v_fmac_f32 v97, v105, v89
v_lshlrev_b32 v104, 16, v53
v_and_b32 v105, 0xffff0000, v53
v_fmac_f32 v98, v104, v89
v_fmac_f32 v99, v105, v89
v_lshlrev_b32 v104, 16, v54
v_and_b32 v105, 0xffff0000, v54
v_fmac_f32 v100, v104, v89
v_fmac_f32 v101, v105, v89
v_lshlrev_b32 v104, 16, v55
v_and_b32 v105, 0xffff0000, v55
v_fmac_f32 v102, v104, v89
v_fmac_f32 v103, v105, v89
s_waitcnt vmcnt(21)
v_lshlrev_b32 v104, 16, v56
v_and_b32 v105, 0xffff0000, v56
v_fmac_f32 v96, v104, v90
v_fmac_f32 v97, v105, v90
v_lshlrev_b32 v104, 16, v57
v_and_b32 v105, 0xffff0000, v57
v_fmac_f32 v98, v104, v90
v_fmac_f32 v99, v105, v90
v_lshlrev_b32 v104, 16, v58
v_and_b32 v105, 0xffff0000, v58
v_fmac_f32 v100, v104, v90
v_fmac_f32 v101, v105, v90
v_lshlrev_b32 v104, 16, v59
v_and_b32 v105, 0xffff0000, v59
v_fmac_f32 v102, v104, v90
v_fmac_f32 v103, v105, v90
s_waitcnt vmcnt(20)
v_lshlrev_b32 v104, 16, v60
v_and_b32 v105, 0xffff0000, v60
v_fmac_f32 v96, v104, v91
v_fmac_f32 v97, v105, v91
v_lshlrev_b32 v104, 16, v61
v_and_b32 v105, 0xffff0000, v61
v_fmac_f32 v98, v104, v91
v_fmac_f32 v99, v105, v91
v_lshlrev_b32 v104, 16, v62
v_and_b32 v105, 0xffff0000, v62
v_fmac_f32 v100, v104, v91
v_fmac_f32 v101, v105, v91
v_lshlrev_b32 v104, 16, v63
v_and_b32 v105, 0xffff0000, v63
v_fmac_f32 v102, v104, v91
v_fmac_f32 v103, v105, v91
s_waitcnt vmcnt(19)
v_lshlrev_b32 v104, 16, v64
v_and_b32 v105, 0xffff0000, v64
v_fmac_f32 v96, v104, v92
v_fmac_f32 v97, v105, v92
v_lshlrev_b32 v104, 16, v65
v_and_b32 v105, 0xffff0000, v65
v_fmac_f32 v98, v104, v92
v_fmac_f32 v99, v105, v92
v_lshlrev_b32 v104, 16, v66
v_and_b32 v105, 0xffff0000, v66
v_fmac_f32 v100, v104, v92
v_fmac_f32 v101, v105, v92
v_lshlrev_b32 v104, 16, v67
v_and_b32 v105, 0xffff0000, v67
v_fmac_f32 v102, v104, v92
v_fmac_f32 v103, v105, v92
s_waitcnt vmcnt(18)
v_lshlrev_b32 v104, 16, v68
v_and_b32 v105, 0xffff0000, v68
v_fmac_f32 v96, v104, v93
v_fmac_f32 v97, v105, v93
v_lshlrev_b32 v104, 16, v69
v_and_b32 v105, 0xffff0000, v69
v_fmac_f32 v98, v104, v93
v_fmac_f32 v99, v105, v93
v_lshlrev_b32 v104, 16, v70
v_and_b32 v105, 0xffff0000, v70
v_fmac_f32 v100, v104, v93
v_fmac_f32 v101, v105, v93
v_lshlrev_b32 v104, 16, v71
v_and_b32 v105, 0xffff0000, v71
v_fmac_f32 v102, v104, v93
v_fmac_f32 v103, v105, v93
s_waitcnt vmcnt(17)
v_lshlrev_b32 v104, 16, v72
v_and_b32 v105, 0xffff0000, v72
v_fmac_f32 v96, v104, v94
v_fmac_f32 v97, v105, v94
v_lshlrev_b32 v104, 16, v73
v_and_b32 v105, 0xffff0000, v73
v_fmac_f32 v98, v104, v94
v_fmac_f32 v99, v105, v94
v_lshlrev_b32 v104, 16, v74
v_and_b32 v105, 0xffff0000, v74
v_fmac_f32 v100, v104, v94
v_fmac_f32 v101, v105, v94
v_lshlrev_b32 v104, 16, v75
v_and_b32 v105, 0xffff0000, v75
v_fmac_f32 v102, v104, v94
v_fmac_f32 v103, v105, v94
s_waitcnt vmcnt(16)
v_lshlrev_b32 v104, 16, v76
v_and_b32 v105, 0xffff0000, v76
v_fmac_f32 v96, v104, v95
v_fmac_f32 v97, v105, v95
v_lshlrev_b32 v104, 16, v77
v_and_b32 v105, 0xffff0000, v77
v_fmac_f32 v98, v104, v95
v_fmac_f32 v99, v105, v95
v_lshlrev_b32 v104, 16, v78
v_and_b32 v105, 0xffff0000, v78
v_fmac_f32 v100, v104, v95
v_fmac_f32 v101, v105, v95
v_lshlrev_b32 v104, 16, v79
v_and_b32 v105, 0xffff0000, v79
v_fmac_f32 v102, v104, v95
v_fmac_f32 v103, v105, v95
s_nop 1
v_add_f32_dpp v96, v96, v96 row_ror:8 row_mask:0xf bank_mask:0xf
v_add_f32_dpp v97, v97, v97 row_ror:8 row_mask:0xf bank_mask:0xf
v_add_f32_dpp v98, v98, v98 row_ror:8 row_mask:0xf bank_mask:0xf
v_add_f32_dpp v99, v99, v99 row_ror:8 row_mask:0xf bank_mask:0xf
v_add_f32_dpp v100, v100, v100 row_ror:8 row_mask:0xf bank_mask:0xf
v_add_f32_dpp v101, v101, v101 row_ror:8 row_mask:0xf bank_mask:0xf
v_add_f32_dpp v102, v102, v102 row_ror:8 row_mask:0xf bank_mask:0xf
v_add_f32_dpp v103, v103, v103 row_ror:8 row_mask:0xf bank_mask:0xf
v_mov_b32 v16, v96
v_mov_b32 v17, v97
v_mov_b32 v18, v98
v_mov_b32 v19, v99
v_mov_b32 v20, v100
v_mov_b32 v21, v101
v_mov_b32 v22, v102
v_mov_b32 v23, v103
v_permlane16_swap_b32 v96, v16
v_permlane16_swap_b32 v97, v17
v_permlane16_swap_b32 v98, v18
v_permlane16_swap_b32 v99, v19
v_permlane16_swap_b32 v100, v20
v_permlane16_swap_b32 v101, v21
v_permlane16_swap_b32 v102, v22
v_permlane16_swap_b32 v103, v23
v_add_f32 v96, v96, v16
v_add_f32 v97, v97, v17
v_add_f32 v98, v98, v18
v_add_f32 v99, v99, v19
v_add_f32 v100, v100, v20
v_add_f32 v101, v101, v21
v_add_f32 v102, v102, v22
v_add_f32 v103, v103, v23
v_mov_b32 v16, v96
v_mov_b32 v17, v97
v_mov_b32 v18, v98
v_mov_b32 v19, v99
v_mov_b32 v20, v100
v_mov_b32 v21, v101
v_mov_b32 v22, v102
v_mov_b32 v23, v103
v_permlane32_swap_b32 v96, v16
v_permlane32_swap_b32 v97, v17
v_permlane32_swap_b32 v98, v18
v_permlane32_swap_b32 v99, v19
v_permlane32_swap_b32 v100, v20
v_permlane32_swap_b32 v101, v21
v_permlane32_swap_b32 v102, v22
v_permlane32_swap_b32 v103, v23
v_add_f32 v96, v96, v16
v_add_f32 v97, v97, v17
v_add_f32 v98, v98, v18
v_add_f32 v99, v99, v19
v_add_f32 v100, v100, v20
v_add_f32 v101, v101, v21
v_add_f32 v102, v102, v22
v_add_f32 v103, v103, v23
s_lshl_b32 s40, s32, 8
v_lshl_add_u32 v2, v3, 5, s40
ds_write_b128 v2, v[96:99] offset:1024
ds_write_b128 v2, v[100:103] offset:1040
s_waitcnt lgkmcnt(0)
s_barrier
v_and_b32 v2, 63, v0
v_lshlrev_b32 v2, 2, v2
ds_read_b32 v96, v2 offset:1024
ds_read_b32 v97, v2 offset:1280
ds_read_b32 v98, v2 offset:1536
ds_read_b32 v99, v2 offset:1792
s_min_u32 s40, s32, 1
s_lshl_b32 s40, s40, 30
s_add_u32 s40, s40, s62
s_waitcnt lgkmcnt(0)
v_add_f32 v96, v96, v97
v_add_f32 v98, v98, v99
v_add_f32 v96, v96, v98
v_min_u32 v96, -2, v96
buffer_store_dword v96, v2, s[4:7], s40 offen sc1
Lst_599:
buffer_load_dword v14, off, s[12:15], 0 offset:160 sc1
buffer_load_dword v15, off, s[12:15], 0 offset:160 sc1
s_waitcnt vmcnt(0)
v_add_u32 v14, v14, v15
s_nop 0
v_readfirstlane_b32 s38, v14
s_nop 3
s_and_b32 s39, s38, 0xffff
s_cmp_eq_u32 s39, 0x100
s_cbranch_scc1 Lso_600
s_sub_u32 s37, s37, 1
s_cbranch_scc1 Lend_7
s_sleep 8
s_branch Lst_599
Lso_600:
s_bfe_u32 s35, s38, 0x80010
s_bfe_u32 s46, s38, 0x10018
s_lshl_b32 s46, s46, 13
s_barrier
s_add_u32 s52, s26, 0
v_accvgpr_read_b32 v16, a0
v_accvgpr_read_b32 v17, a1
v_accvgpr_read_b32 v18, a2
v_accvgpr_read_b32 v19, a3
v_accvgpr_read_b32 v20, a4
v_accvgpr_read_b32 v21, a5
v_accvgpr_read_b32 v22, a6
v_accvgpr_read_b32 v23, a7
v_accvgpr_read_b32 v24, a8
v_accvgpr_read_b32 v25, a9
v_accvgpr_read_b32 v26, a10
v_accvgpr_read_b32 v27, a11
v_accvgpr_read_b32 v28, a12
v_accvgpr_read_b32 v29, a13
v_accvgpr_read_b32 v30, a14
v_accvgpr_read_b32 v31, a15
v_accvgpr_read_b32 v32, a16
v_accvgpr_read_b32 v33, a17
v_accvgpr_read_b32 v34, a18
v_accvgpr_read_b32 v35, a19
v_accvgpr_read_b32 v36, a20
v_accvgpr_read_b32 v37, a21
v_accvgpr_read_b32 v38, a22
v_accvgpr_read_b32 v39, a23
v_accvgpr_read_b32 v40, a24
v_accvgpr_read_b32 v41, a25
v_accvgpr_read_b32 v42, a26
v_accvgpr_read_b32 v43, a27
v_accvgpr_read_b32 v44, a28
v_accvgpr_read_b32 v45, a29
v_accvgpr_read_b32 v46, a30
v_accvgpr_read_b32 v47, a31
s_lshr_b32 s40, s52, 1
s_lshl_b32 s40, s40, 2
s_add_u32 s40, s40, s32
s_lshl_b32 s40, s40, 14
s_and_b32 s41, s52, 1
s_lshl_b32 s41, s41, 10
s_add_u32 s40, s40, s41
v_lshlrev_b32 v48, 16, v16
v_and_b32 v49, 0xffff0000, v16
v_lshlrev_b32 v50, 16, v17
v_and_b32 v51, 0xffff0000, v17
v_lshlrev_b32 v52, 16, v18
v_and_b32 v53, 0xffff0000, v18
v_lshlrev_b32 v54, 16, v19
v_and_b32 v55, 0xffff0000, v19
v_lshlrev_b32 v56, 16, v20
v_and_b32 v57, 0xffff0000, v20
v_lshlrev_b32 v58, 16, v21
v_and_b32 v59, 0xffff0000, v21
v_lshlrev_b32 v60, 16, v22
v_and_b32 v61, 0xffff0000, v22
v_lshlrev_b32 v62, 16, v23
v_and_b32 v63, 0xffff0000, v23
v_lshlrev_b32 v64, 16, v24
v_and_b32 v65, 0xffff0000, v24
v_lshlrev_b32 v66, 16, v25
v_and_b32 v67, 0xffff0000, v25
v_lshlrev_b32 v68, 16, v26
v_and_b32 v69, 0xffff0000, v26
v_lshlrev_b32 v70, 16, v27
v_and_b32 v71, 0xffff0000, v27
v_lshlrev_b32 v72, 16, v28
v_and_b32 v73, 0xffff0000, v28
v_lshlrev_b32 v74, 16, v29
v_and_b32 v75, 0xffff0000, v29
v_lshlrev_b32 v76, 16, v30
v_and_b32 v77, 0xffff0000, v30
v_lshlrev_b32 v78, 16, v31
v_and_b32 v79, 0xffff0000, v31
v_lshlrev_b32 v80, 16, v32
v_and_b32 v81, 0xffff0000, v32
v_lshlrev_b32 v82, 16, v33
v_and_b32 v83, 0xffff0000, v33
v_lshlrev_b32 v84, 16, v34
v_and_b32 v85, 0xffff0000, v34
v_lshlrev_b32 v86, 16, v35
v_and_b32 v87, 0xffff0000, v35
v_lshlrev_b32 v88, 16, v36
v_and_b32 v89, 0xffff0000, v36
v_lshlrev_b32 v90, 16, v37
v_and_b32 v91, 0xffff0000, v37
v_lshlrev_b32 v92, 16, v38
v_and_b32 v93, 0xffff0000, v38
v_lshlrev_b32 v94, 16, v39
v_and_b32 v95, 0xffff0000, v39
v_lshlrev_b32 v96, 16, v40
v_and_b32 v97, 0xffff0000, v40
v_lshlrev_b32 v98, 16, v41
v_and_b32 v99, 0xffff0000, v41
v_lshlrev_b32 v100, 16, v42
v_and_b32 v101, 0xffff0000, v42
v_lshlrev_b32 v102, 16, v43
v_and_b32 v103, 0xffff0000, v43
v_lshlrev_b32 v104, 16, v44
v_and_b32 v105, 0xffff0000, v44
v_lshlrev_b32 v106, 16, v45
v_and_b32 v107, 0xffff0000, v45
v_lshlrev_b32 v108, 16, v46
v_and_b32 v109, 0xffff0000, v46
v_lshlrev_b32 v110, 16, v47
v_and_b32 v111, 0xffff0000, v47
v_pk_add_f32 v[240:241], v[48:49], v[50:51]
v_pk_add_f32 v[240:241], v[240:241], v[52:53]
v_pk_add_f32 v[240:241], v[240:241], v[54:55]
v_pk_add_f32 v[240:241], v[240:241], v[56:57]
v_pk_add_f32 v[240:241], v[240:241], v[58:59]
v_pk_add_f32 v[240:241], v[240:241], v[60:61]
v_pk_add_f32 v[240:241], v[240:241], v[62:63]
v_pk_add_f32 v[240:241], v[240:241], v[64:65]
v_pk_add_f32 v[240:241], v[240:241], v[66:67]
v_pk_add_f32 v[240:241], v[240:241], v[68:69]
v_pk_add_f32 v[240:241], v[240:241], v[70:71]
v_pk_add_f32 v[240:241], v[240:241], v[72:73]
v_pk_add_f32 v[240:241], v[240:241], v[74:75]
v_pk_add_f32 v[240:241], v[240:241], v[76:77]
v_pk_add_f32 v[240:241], v[240:241], v[78:79]
v_pk_add_f32 v[240:241], v[240:241], v[80:81]
v_pk_add_f32 v[240:241], v[240:241], v[82:83]
v_pk_add_f32 v[240:241], v[240:241], v[84:85]
v_pk_add_f32 v[240:241], v[240:241], v[86:87]
v_pk_add_f32 v[240:241], v[240:241], v[88:89]
v_pk_add_f32 v[240:241], v[240:241], v[90:91]
v_pk_add_f32 v[240:241], v[240:241], v[92:93]
v_pk_add_f32 v[240:241], v[240:241], v[94:95]
v_pk_add_f32 v[240:241], v[240:241], v[96:97]
v_pk_add_f32 v[240:241], v[240:241], v[98:99]
v_pk_add_f32 v[240:241], v[240:241], v[100:101]
v_pk_add_f32 v[240:241], v[240:241], v[102:103]
v_pk_add_f32 v[240:241], v[240:241], v[104:105]
v_pk_add_f32 v[240:241], v[240:241], v[106:107]
v_pk_add_f32 v[240:241], v[240:241], v[108:109]
v_pk_add_f32 v[240:241], v[240:241], v[110:111]
v_add_f32 v240, v240, v241
v_mov_b32 v241, v240
s_nop 1
v_permlane16_swap_b32 v240, v241
s_nop 0
v_add_f32 v240, v240, v241
v_mov_b32 v241, v240
s_nop 1
v_permlane32_swap_b32 v240, v241
s_nop 0
v_add_f32 v240, v240, v241
ds_write_b32 v11, v240 offset:512
s_waitcnt lgkmcnt(0)
s_barrier
ds_read_b128 v[240:243], v12 offset:512
s_waitcnt lgkmcnt(0)
v_pk_add_f32 v[240:241], v[240:241], v[242:243]
v_add_f32 v240, v240, v241
v_mul_f32 v240, 0x3a800000, v240
v_pk_add_f32 v[48:49], v[48:49], v[240:241] op_sel_hi:[1,0] neg_lo:[0,1] neg_hi:[0,1]
v_pk_add_f32 v[50:51], v[50:51], v[240:241] op_sel_hi:[1,0] neg_lo:[0,1] neg_hi:[0,1]
v_pk_add_f32 v[52:53], v[52:53], v[240:241] op_sel_hi:[1,0] neg_lo:[0,1] neg_hi:[0,1]
v_pk_add_f32 v[54:55], v[54:55], v[240:241] op_sel_hi:[1,0] neg_lo:[0,1] neg_hi:[0,1]
v_pk_add_f32 v[56:57], v[56:57], v[240:241] op_sel_hi:[1,0] neg_lo:[0,1] neg_hi:[0,1]
v_pk_add_f32 v[58:59], v[58:59], v[240:241] op_sel_hi:[1,0] neg_lo:[0,1] neg_hi:[0,1]
v_pk_add_f32 v[60:61], v[60:61], v[240:241] op_sel_hi:[1,0] neg_lo:[0,1] neg_hi:[0,1]
v_pk_add_f32 v[62:63], v[62:63], v[240:241] op_sel_hi:[1,0] neg_lo:[0,1] neg_hi:[0,1]
v_pk_add_f32 v[64:65], v[64:65], v[240:241] op_sel_hi:[1,0] neg_lo:[0,1] neg_hi:[0,1]
v_pk_add_f32 v[66:67], v[66:67], v[240:241] op_sel_hi:[1,0] neg_lo:[0,1] neg_hi:[0,1]
v_pk_add_f32 v[68:69], v[68:69], v[240:241] op_sel_hi:[1,0] neg_lo:[0,1] neg_hi:[0,1]
v_pk_add_f32 v[70:71], v[70:71], v[240:241] op_sel_hi:[1,0] neg_lo:[0,1] neg_hi:[0,1]
v_pk_add_f32 v[72:73], v[72:73], v[240:241] op_sel_hi:[1,0] neg_lo:[0,1] neg_hi:[0,1]
v_pk_add_f32 v[74:75], v[74:75], v[240:241] op_sel_hi:[1,0] neg_lo:[0,1] neg_hi:[0,1]
v_pk_add_f32 v[76:77], v[76:77], v[240:241] op_sel_hi:[1,0] neg_lo:[0,1] neg_hi:[0,1]
v_pk_add_f32 v[78:79], v[78:79], v[240:241] op_sel_hi:[1,0] neg_lo:[0,1] neg_hi:[0,1]
v_pk_add_f32 v[80:81], v[80:81], v[240:241] op_sel_hi:[1,0] neg_lo:[0,1] neg_hi:[0,1]
v_pk_add_f32 v[82:83], v[82:83], v[240:241] op_sel_hi:[1,0] neg_lo:[0,1] neg_hi:[0,1]
v_pk_add_f32 v[84:85], v[84:85], v[240:241] op_sel_hi:[1,0] neg_lo:[0,1] neg_hi:[0,1]
v_pk_add_f32 v[86:87], v[86:87], v[240:241] op_sel_hi:[1,0] neg_lo:[0,1] neg_hi:[0,1]
v_pk_add_f32 v[88:89], v[88:89], v[240:241] op_sel_hi:[1,0] neg_lo:[0,1] neg_hi:[0,1]
v_pk_add_f32 v[90:91], v[90:91], v[240:241] op_sel_hi:[1,0] neg_lo:[0,1] neg_hi:[0,1]
v_pk_add_f32 v[92:93], v[92:93], v[240:241] op_sel_hi:[1,0] neg_lo:[0,1] neg_hi:[0,1]
v_pk_add_f32 v[94:95], v[94:95], v[240:241] op_sel_hi:[1,0] neg_lo:[0,1] neg_hi:[0,1]
v_pk_add_f32 v[96:97], v[96:97], v[240:241] op_sel_hi:[1,0] neg_lo:[0,1] neg_hi:[0,1]
v_pk_add_f32 v[98:99], v[98:99], v[240:241] op_sel_hi:[1,0] neg_lo:[0,1] neg_hi:[0,1]
v_pk_add_f32 v[100:101], v[100:101], v[240:241] op_sel_hi:[1,0] neg_lo:[0,1] neg_hi:[0,1]
v_pk_add_f32 v[102:103], v[102:103], v[240:241] op_sel_hi:[1,0] neg_lo:[0,1] neg_hi:[0,1]
v_pk_add_f32 v[104:105], v[104:105], v[240:241] op_sel_hi:[1,0] neg_lo:[0,1] neg_hi:[0,1]
v_pk_add_f32 v[106:107], v[106:107], v[240:241] op_sel_hi:[1,0] neg_lo:[0,1] neg_hi:[0,1]
v_pk_add_f32 v[108:109], v[108:109], v[240:241] op_sel_hi:[1,0] neg_lo:[0,1] neg_hi:[0,1]
v_pk_add_f32 v[110:111], v[110:111], v[240:241] op_sel_hi:[1,0] neg_lo:[0,1] neg_hi:[0,1]
v_pk_mul_f32 v[240:241], v[48:49], v[48:49]
v_pk_fma_f32 v[240:241], v[50:51], v[50:51], v[240:241]
v_pk_fma_f32 v[240:241], v[52:53], v[52:53], v[240:241]
v_pk_fma_f32 v[240:241], v[54:55], v[54:55], v[240:241]
v_pk_fma_f32 v[240:241], v[56:57], v[56:57], v[240:241]
v_pk_fma_f32 v[240:241], v[58:59], v[58:59], v[240:241]
v_pk_fma_f32 v[240:241], v[60:61], v[60:61], v[240:241]
v_pk_fma_f32 v[240:241], v[62:63], v[62:63], v[240:241]
v_pk_fma_f32 v[240:241], v[64:65], v[64:65], v[240:241]
v_pk_fma_f32 v[240:241], v[66:67], v[66:67], v[240:241]
v_pk_fma_f32 v[240:241], v[68:69], v[68:69], v[240:241]
v_pk_fma_f32 v[240:241], v[70:71], v[70:71], v[240:241]
v_pk_fma_f32 v[240:241], v[72:73], v[72:73], v[240:241]
v_pk_fma_f32 v[240:241], v[74:75], v[74:75], v[240:241]
v_pk_fma_f32 v[240:241], v[76:77], v[76:77], v[240:241]
v_pk_fma_f32 v[240:241], v[78:79], v[78:79], v[240:241]
v_pk_fma_f32 v[240:241], v[80:81], v[80:81], v[240:241]
v_pk_fma_f32 v[240:241], v[82:83], v[82:83], v[240:241]
v_pk_fma_f32 v[240:241], v[84:85], v[84:85], v[240:241]
v_pk_fma_f32 v[240:241], v[86:87], v[86:87], v[240:241]
v_pk_fma_f32 v[240:241], v[88:89], v[88:89], v[240:241]
v_pk_fma_f32 v[240:241], v[90:91], v[90:91], v[240:241]
v_pk_fma_f32 v[240:241], v[92:93], v[92:93], v[240:241]
v_pk_fma_f32 v[240:241], v[94:95], v[94:95], v[240:241]
v_pk_fma_f32 v[240:241], v[96:97], v[96:97], v[240:241]
v_pk_fma_f32 v[240:241], v[98:99], v[98:99], v[240:241]
v_pk_fma_f32 v[240:241], v[100:101], v[100:101], v[240:241]
v_pk_fma_f32 v[240:241], v[102:103], v[102:103], v[240:241]
v_pk_fma_f32 v[240:241], v[104:105], v[104:105], v[240:241]
v_pk_fma_f32 v[240:241], v[106:107], v[106:107], v[240:241]
v_pk_fma_f32 v[240:241], v[108:109], v[108:109], v[240:241]
v_pk_fma_f32 v[240:241], v[110:111], v[110:111], v[240:241]
v_add_f32 v240, v240, v241
v_mov_b32 v241, v240
s_nop 1
v_permlane16_swap_b32 v240, v241
s_nop 0
v_add_f32 v240, v240, v241
v_mov_b32 v241, v240
s_nop 1
v_permlane32_swap_b32 v240, v241
s_nop 0
v_add_f32 v240, v240, v241
ds_write_b32 v11, v240 offset:768
s_waitcnt lgkmcnt(0)
s_barrier
ds_read_b128 v[240:243], v12 offset:768
s_waitcnt lgkmcnt(0)
v_pk_add_f32 v[240:241], v[240:241], v[242:243]
v_add_f32 v240, v240, v241
v_mul_f32 v240, 0x3a800000, v240
v_add_f32 v240, 0x3727c5ac, v240
v_rsq_f32 v240, v240
s_nop 0
v_pk_mul_f32 v[48:49], v[48:49], v[240:241] op_sel_hi:[1,0]
v_pk_mul_f32 v[50:51], v[50:51], v[240:241] op_sel_hi:[1,0]
v_pk_mul_f32 v[52:53], v[52:53], v[240:241] op_sel_hi:[1,0]
v_pk_mul_f32 v[54:55], v[54:55], v[240:241] op_sel_hi:[1,0]
v_pk_mul_f32 v[56:57], v[56:57], v[240:241] op_sel_hi:[1,0]
v_pk_mul_f32 v[58:59], v[58:59], v[240:241] op_sel_hi:[1,0]
v_pk_mul_f32 v[60:61], v[60:61], v[240:241] op_sel_hi:[1,0]
v_pk_mul_f32 v[62:63], v[62:63], v[240:241] op_sel_hi:[1,0]
v_pk_mul_f32 v[64:65], v[64:65], v[240:241] op_sel_hi:[1,0]
v_pk_mul_f32 v[66:67], v[66:67], v[240:241] op_sel_hi:[1,0]
v_pk_mul_f32 v[68:69], v[68:69], v[240:241] op_sel_hi:[1,0]
v_pk_mul_f32 v[70:71], v[70:71], v[240:241] op_sel_hi:[1,0]
v_pk_mul_f32 v[72:73], v[72:73], v[240:241] op_sel_hi:[1,0]
v_pk_mul_f32 v[74:75], v[74:75], v[240:241] op_sel_hi:[1,0]
v_pk_mul_f32 v[76:77], v[76:77], v[240:241] op_sel_hi:[1,0]
v_pk_mul_f32 v[78:79], v[78:79], v[240:241] op_sel_hi:[1,0]
v_pk_mul_f32 v[80:81], v[80:81], v[240:241] op_sel_hi:[1,0]
v_pk_mul_f32 v[82:83], v[82:83], v[240:241] op_sel_hi:[1,0]
v_pk_mul_f32 v[84:85], v[84:85], v[240:241] op_sel_hi:[1,0]
v_pk_mul_f32 v[86:87], v[86:87], v[240:241] op_sel_hi:[1,0]
v_pk_mul_f32 v[88:89], v[88:89], v[240:241] op_sel_hi:[1,0]
v_pk_mul_f32 v[90:91], v[90:91], v[240:241] op_sel_hi:[1,0]
v_pk_mul_f32 v[92:93], v[92:93], v[240:241] op_sel_hi:[1,0]
v_pk_mul_f32 v[94:95], v[94:95], v[240:241] op_sel_hi:[1,0]
v_pk_mul_f32 v[96:97], v[96:97], v[240:241] op_sel_hi:[1,0]
v_pk_mul_f32 v[98:99], v[98:99], v[240:241] op_sel_hi:[1,0]
v_pk_mul_f32 v[100:101], v[100:101], v[240:241] op_sel_hi:[1,0]
v_pk_mul_f32 v[102:103], v[102:103], v[240:241] op_sel_hi:[1,0]
v_pk_mul_f32 v[104:105], v[104:105], v[240:241] op_sel_hi:[1,0]
v_pk_mul_f32 v[106:107], v[106:107], v[240:241] op_sel_hi:[1,0]
v_pk_mul_f32 v[108:109], v[108:109], v[240:241] op_sel_hi:[1,0]
v_pk_mul_f32 v[110:111], v[110:111], v[240:241] op_sel_hi:[1,0]
v_lshlrev_b32 v14, 5, v0
Lbw_601:
s_mov_b32 s42, 3178496
buffer_load_dwordx4 v[16:19], v14, s[4:7], s42 offen offset:0 sc1
buffer_load_dwordx4 v[20:23], v14, s[4:7], s42 offen offset:16 sc1
s_mov_b32 s42, 3186688
buffer_load_dwordx4 v[24:27], v14, s[4:7], s42 offen offset:0 sc1
buffer_load_dwordx4 v[28:31], v14, s[4:7], s42 offen offset:16 sc1
s_waitcnt vmcnt(0)
v_max3_u32 v15, v16, v17, v18
v_max3_u32 v15, v15, v19, v20
v_max3_u32 v15, v15, v21, v22
v_max3_u32 v15, v15, v23, v24
v_max3_u32 v15, v15, v25, v26
v_max3_u32 v15, v15, v27, v28
v_max3_u32 v15, v15, v29, v30
v_max_u32 v15, v15, v31
v_cmp_eq_u32 vcc, -1, v15
s_cbranch_vccz Lbo_602
s_sub_u32 s37, s37, 1
s_cbranch_scc1 Lend_7
s_sleep 4
s_branch Lbw_601
Lbo_602:
s_cmp_ge_u32 s32, 2
s_cselect_b32 s42, 1.0, 0
s_lshl_b32 s43, s32, 10
v_add_u32 v7, s43, v7
s_waitcnt vmcnt(0)
v_add_f32 v16, v16, v24
v_add_f32 v17, v17, v25
v_add_f32 v18, v18, v26
v_add_f32 v19, v19, v27
v_add_f32 v20, v20, v28
v_add_f32 v21, v21, v29
v_add_f32 v22, v22, v30
v_add_f32 v23, v23, v31
v_cvt_pk_bf16_f32 v16, 0, v16
v_cvt_pk_bf16_f32 v17, 0, v17
v_cvt_pk_bf16_f32 v18, 0, v18
v_cvt_pk_bf16_f32 v19, 0, v19
v_cvt_pk_bf16_f32 v20, 0, v20
v_cvt_pk_bf16_f32 v21, 0, v21
v_cvt_pk_bf16_f32 v22, 0, v22
v_cvt_pk_bf16_f32 v23, 0, v23
v_add_f32 v16, s42, v16
v_add_f32 v17, s42, v17
v_add_f32 v18, s42, v18
v_add_f32 v19, s42, v19
v_add_f32 v20, s42, v20
v_add_f32 v21, s42, v21
v_add_f32 v22, s42, v22
v_add_f32 v23, s42, v23
ds_write_b128 v14, v[16:19] offset:4096
ds_write_b128 v14, v[20:23] offset:4112
s_waitcnt lgkmcnt(0)
s_barrier
ds_read_b128 v[112:115], v7 offset:4096
ds_read_b128 v[176:179], v7 offset:8192
ds_read_b128 v[116:119], v7 offset:4112
ds_read_b128 v[180:183], v7 offset:8208
ds_read_b128 v[120:123], v7 offset:4224
ds_read_b128 v[184:187], v7 offset:8320
ds_read_b128 v[124:127], v7 offset:4240
ds_read_b128 v[188:191], v7 offset:8336
ds_read_b128 v[128:131], v7 offset:4352
ds_read_b128 v[192:195], v7 offset:8448
ds_read_b128 v[132:135], v7 offset:4368
ds_read_b128 v[196:199], v7 offset:8464
ds_read_b128 v[136:139], v7 offset:4480
ds_read_b128 v[200:203], v7 offset:8576
ds_read_b128 v[140:143], v7 offset:4496
ds_read_b128 v[204:207], v7 offset:8592
ds_read_b128 v[144:147], v7 offset:4608
ds_read_b128 v[208:211], v7 offset:8704
ds_read_b128 v[148:151], v7 offset:4624
ds_read_b128 v[212:215], v7 offset:8720
ds_read_b128 v[152:155], v7 offset:4736
ds_read_b128 v[216:219], v7 offset:8832
ds_read_b128 v[156:159], v7 offset:4752
ds_read_b128 v[220:223], v7 offset:8848
ds_read_b128 v[160:163], v7 offset:4864
ds_read_b128 v[224:227], v7 offset:8960
ds_read_b128 v[164:167], v7 offset:4880
ds_read_b128 v[228:231], v7 offset:8976
ds_read_b128 v[168:171], v7 offset:4992
ds_read_b128 v[232:235], v7 offset:9088
ds_read_b128 v[172:175], v7 offset:5008
ds_read_b128 v[236:239], v7 offset:9104
s_waitcnt lgkmcnt(0)
v_pk_fma_f32 v[48:49], v[48:49], v[176:177], v[112:113]
v_pk_fma_f32 v[50:51], v[50:51], v[178:179], v[114:115]
v_pk_fma_f32 v[52:53], v[52:53], v[180:181], v[116:117]
v_pk_fma_f32 v[54:55], v[54:55], v[182:183], v[118:119]
v_cvt_pk_bf16_f32 v16, v48, v49
v_cvt_pk_bf16_f32 v17, v50, v51
v_cvt_pk_bf16_f32 v18, v52, v53
v_cvt_pk_bf16_f32 v19, v54, v55
s_add_u32 s41, s40, 8388608
buffer_store_dwordx4 v[16:19], v13, s[4:7], s41 offen sc1
v_pk_fma_f32 v[56:57], v[56:57], v[184:185], v[120:121]
v_pk_fma_f32 v[58:59], v[58:59], v[186:187], v[122:123]
v_pk_fma_f32 v[60:61], v[60:61], v[188:189], v[124:125]
v_pk_fma_f32 v[62:63], v[62:63], v[190:191], v[126:127]
v_cvt_pk_bf16_f32 v20, v56, v57
v_cvt_pk_bf16_f32 v21, v58, v59
v_cvt_pk_bf16_f32 v22, v60, v61
v_cvt_pk_bf16_f32 v23, v62, v63
s_add_u32 s41, s40, 8390656
buffer_store_dwordx4 v[20:23], v13, s[4:7], s41 offen sc1
v_pk_fma_f32 v[64:65], v[64:65], v[192:193], v[128:129]
v_pk_fma_f32 v[66:67], v[66:67], v[194:195], v[130:131]
v_pk_fma_f32 v[68:69], v[68:69], v[196:197], v[132:133]
v_pk_fma_f32 v[70:71], v[70:71], v[198:199], v[134:135]
v_cvt_pk_bf16_f32 v24, v64, v65
v_cvt_pk_bf16_f32 v25, v66, v67
v_cvt_pk_bf16_f32 v26, v68, v69
v_cvt_pk_bf16_f32 v27, v70, v71
s_add_u32 s41, s40, 8392704
buffer_store_dwordx4 v[24:27], v13, s[4:7], s41 offen sc1
v_pk_fma_f32 v[72:73], v[72:73], v[200:201], v[136:137]
v_pk_fma_f32 v[74:75], v[74:75], v[202:203], v[138:139]
v_pk_fma_f32 v[76:77], v[76:77], v[204:205], v[140:141]
v_pk_fma_f32 v[78:79], v[78:79], v[206:207], v[142:143]
v_cvt_pk_bf16_f32 v28, v72, v73
v_cvt_pk_bf16_f32 v29, v74, v75
v_cvt_pk_bf16_f32 v30, v76, v77
v_cvt_pk_bf16_f32 v31, v78, v79
s_add_u32 s41, s40, 8394752
buffer_store_dwordx4 v[28:31], v13, s[4:7], s41 offen sc1
v_pk_fma_f32 v[80:81], v[80:81], v[208:209], v[144:145]
v_pk_fma_f32 v[82:83], v[82:83], v[210:211], v[146:147]
v_pk_fma_f32 v[84:85], v[84:85], v[212:213], v[148:149]
v_pk_fma_f32 v[86:87], v[86:87], v[214:215], v[150:151]
v_cvt_pk_bf16_f32 v32, v80, v81
v_cvt_pk_bf16_f32 v33, v82, v83
v_cvt_pk_bf16_f32 v34, v84, v85
v_cvt_pk_bf16_f32 v35, v86, v87
s_add_u32 s41, s40, 8396800
buffer_store_dwordx4 v[32:35], v13, s[4:7], s41 offen sc1
v_pk_fma_f32 v[88:89], v[88:89], v[216:217], v[152:153]
v_pk_fma_f32 v[90:91], v[90:91], v[218:219], v[154:155]
v_pk_fma_f32 v[92:93], v[92:93], v[220:221], v[156:157]
v_pk_fma_f32 v[94:95], v[94:95], v[222:223], v[158:159]
v_cvt_pk_bf16_f32 v36, v88, v89
v_cvt_pk_bf16_f32 v37, v90, v91
v_cvt_pk_bf16_f32 v38, v92, v93
v_cvt_pk_bf16_f32 v39, v94, v95
s_add_u32 s41, s40, 8398848
buffer_store_dwordx4 v[36:39], v13, s[4:7], s41 offen sc1
v_pk_fma_f32 v[96:97], v[96:97], v[224:225], v[160:161]
v_pk_fma_f32 v[98:99], v[98:99], v[226:227], v[162:163]
v_pk_fma_f32 v[100:101], v[100:101], v[228:229], v[164:165]
v_pk_fma_f32 v[102:103], v[102:103], v[230:231], v[166:167]
v_cvt_pk_bf16_f32 v40, v96, v97
v_cvt_pk_bf16_f32 v41, v98, v99
v_cvt_pk_bf16_f32 v42, v100, v101
v_cvt_pk_bf16_f32 v43, v102, v103
s_add_u32 s41, s40, 8400896
buffer_store_dwordx4 v[40:43], v13, s[4:7], s41 offen sc1
v_pk_fma_f32 v[104:105], v[104:105], v[232:233], v[168:169]
v_pk_fma_f32 v[106:107], v[106:107], v[234:235], v[170:171]
v_pk_fma_f32 v[108:109], v[108:109], v[236:237], v[172:173]
v_pk_fma_f32 v[110:111], v[110:111], v[238:239], v[174:175]
v_cvt_pk_bf16_f32 v44, v104, v105
v_cvt_pk_bf16_f32 v45, v106, v107
v_cvt_pk_bf16_f32 v46, v108, v109
v_cvt_pk_bf16_f32 v47, v110, v111
s_add_u32 s41, s40, 8402944
buffer_store_dwordx4 v[44:47], v13, s[4:7], s41 offen sc1
v_mov_b32 v14, 2
s_waitcnt vmcnt(0)
s_barrier
buffer_store_dword v14, v10, s[4:7], 0 offen sc1
s_add_u32 s52, s26, 64
v_accvgpr_read_b32 v16, a32
v_accvgpr_read_b32 v17, a33
v_accvgpr_read_b32 v18, a34
v_accvgpr_read_b32 v19, a35
v_accvgpr_read_b32 v20, a36
v_accvgpr_read_b32 v21, a37
v_accvgpr_read_b32 v22, a38
v_accvgpr_read_b32 v23, a39
v_accvgpr_read_b32 v24, a40
v_accvgpr_read_b32 v25, a41
v_accvgpr_read_b32 v26, a42
v_accvgpr_read_b32 v27, a43
v_accvgpr_read_b32 v28, a44
v_accvgpr_read_b32 v29, a45
v_accvgpr_read_b32 v30, a46
v_accvgpr_read_b32 v31, a47
v_accvgpr_read_b32 v32, a48
v_accvgpr_read_b32 v33, a49
v_accvgpr_read_b32 v34, a50
v_accvgpr_read_b32 v35, a51
v_accvgpr_read_b32 v36, a52
v_accvgpr_read_b32 v37, a53
v_accvgpr_read_b32 v38, a54
v_accvgpr_read_b32 v39, a55
v_accvgpr_read_b32 v40, a56
v_accvgpr_read_b32 v41, a57
v_accvgpr_read_b32 v42, a58
v_accvgpr_read_b32 v43, a59
v_accvgpr_read_b32 v44, a60
v_accvgpr_read_b32 v45, a61
v_accvgpr_read_b32 v46, a62
v_accvgpr_read_b32 v47, a63
s_lshr_b32 s40, s52, 1
s_lshl_b32 s40, s40, 2
s_add_u32 s40, s40, s32
s_lshl_b32 s40, s40, 14
s_and_b32 s41, s52, 1
s_lshl_b32 s41, s41, 10
s_add_u32 s40, s40, s41
v_lshlrev_b32 v48, 16, v16
v_and_b32 v49, 0xffff0000, v16
v_lshlrev_b32 v50, 16, v17
v_and_b32 v51, 0xffff0000, v17
v_lshlrev_b32 v52, 16, v18
v_and_b32 v53, 0xffff0000, v18
v_lshlrev_b32 v54, 16, v19
v_and_b32 v55, 0xffff0000, v19
v_lshlrev_b32 v56, 16, v20
v_and_b32 v57, 0xffff0000, v20
v_lshlrev_b32 v58, 16, v21
v_and_b32 v59, 0xffff0000, v21
v_lshlrev_b32 v60, 16, v22
v_and_b32 v61, 0xffff0000, v22
v_lshlrev_b32 v62, 16, v23
v_and_b32 v63, 0xffff0000, v23
v_lshlrev_b32 v64, 16, v24
v_and_b32 v65, 0xffff0000, v24
v_lshlrev_b32 v66, 16, v25
v_and_b32 v67, 0xffff0000, v25
v_lshlrev_b32 v68, 16, v26
v_and_b32 v69, 0xffff0000, v26
v_lshlrev_b32 v70, 16, v27
v_and_b32 v71, 0xffff0000, v27
v_lshlrev_b32 v72, 16, v28
v_and_b32 v73, 0xffff0000, v28
v_lshlrev_b32 v74, 16, v29
v_and_b32 v75, 0xffff0000, v29
v_lshlrev_b32 v76, 16, v30
v_and_b32 v77, 0xffff0000, v30
v_lshlrev_b32 v78, 16, v31
v_and_b32 v79, 0xffff0000, v31
v_lshlrev_b32 v80, 16, v32
v_and_b32 v81, 0xffff0000, v32
v_lshlrev_b32 v82, 16, v33
v_and_b32 v83, 0xffff0000, v33
v_lshlrev_b32 v84, 16, v34
v_and_b32 v85, 0xffff0000, v34
v_lshlrev_b32 v86, 16, v35
v_and_b32 v87, 0xffff0000, v35
v_lshlrev_b32 v88, 16, v36
v_and_b32 v89, 0xffff0000, v36
v_lshlrev_b32 v90, 16, v37
v_and_b32 v91, 0xffff0000, v37
v_lshlrev_b32 v92, 16, v38
v_and_b32 v93, 0xffff0000, v38
v_lshlrev_b32 v94, 16, v39
v_and_b32 v95, 0xffff0000, v39
v_lshlrev_b32 v96, 16, v40
v_and_b32 v97, 0xffff0000, v40
v_lshlrev_b32 v98, 16, v41
v_and_b32 v99, 0xffff0000, v41
v_lshlrev_b32 v100, 16, v42
v_and_b32 v101, 0xffff0000, v42
v_lshlrev_b32 v102, 16, v43
v_and_b32 v103, 0xffff0000, v43
v_lshlrev_b32 v104, 16, v44
v_and_b32 v105, 0xffff0000, v44
v_lshlrev_b32 v106, 16, v45
v_and_b32 v107, 0xffff0000, v45
v_lshlrev_b32 v108, 16, v46
v_and_b32 v109, 0xffff0000, v46
v_lshlrev_b32 v110, 16, v47
v_and_b32 v111, 0xffff0000, v47
v_pk_add_f32 v[240:241], v[48:49], v[50:51]
v_pk_add_f32 v[240:241], v[240:241], v[52:53]
v_pk_add_f32 v[240:241], v[240:241], v[54:55]
v_pk_add_f32 v[240:241], v[240:241], v[56:57]
v_pk_add_f32 v[240:241], v[240:241], v[58:59]
v_pk_add_f32 v[240:241], v[240:241], v[60:61]
v_pk_add_f32 v[240:241], v[240:241], v[62:63]
v_pk_add_f32 v[240:241], v[240:241], v[64:65]
v_pk_add_f32 v[240:241], v[240:241], v[66:67]
v_pk_add_f32 v[240:241], v[240:241], v[68:69]
v_pk_add_f32 v[240:241], v[240:241], v[70:71]
v_pk_add_f32 v[240:241], v[240:241], v[72:73]
v_pk_add_f32 v[240:241], v[240:241], v[74:75]
v_pk_add_f32 v[240:241], v[240:241], v[76:77]
v_pk_add_f32 v[240:241], v[240:241], v[78:79]
v_pk_add_f32 v[240:241], v[240:241], v[80:81]
v_pk_add_f32 v[240:241], v[240:241], v[82:83]
v_pk_add_f32 v[240:241], v[240:241], v[84:85]
v_pk_add_f32 v[240:241], v[240:241], v[86:87]
v_pk_add_f32 v[240:241], v[240:241], v[88:89]
v_pk_add_f32 v[240:241], v[240:241], v[90:91]
v_pk_add_f32 v[240:241], v[240:241], v[92:93]
v_pk_add_f32 v[240:241], v[240:241], v[94:95]
v_pk_add_f32 v[240:241], v[240:241], v[96:97]
v_pk_add_f32 v[240:241], v[240:241], v[98:99]
v_pk_add_f32 v[240:241], v[240:241], v[100:101]
v_pk_add_f32 v[240:241], v[240:241], v[102:103]
v_pk_add_f32 v[240:241], v[240:241], v[104:105]
v_pk_add_f32 v[240:241], v[240:241], v[106:107]
v_pk_add_f32 v[240:241], v[240:241], v[108:109]
v_pk_add_f32 v[240:241], v[240:241], v[110:111]
v_add_f32 v240, v240, v241
v_mov_b32 v241, v240
s_nop 1
v_permlane16_swap_b32 v240, v241
s_nop 0
v_add_f32 v240, v240, v241
v_mov_b32 v241, v240
s_nop 1
v_permlane32_swap_b32 v240, v241
s_nop 0
v_add_f32 v240, v240, v241
ds_write_b32 v11, v240 offset:512
s_waitcnt lgkmcnt(0)
s_barrier
ds_read_b128 v[240:243], v12 offset:512
s_waitcnt lgkmcnt(0)
v_pk_add_f32 v[240:241], v[240:241], v[242:243]
v_add_f32 v240, v240, v241
v_mul_f32 v240, 0x3a800000, v240
v_pk_add_f32 v[48:49], v[48:49], v[240:241] op_sel_hi:[1,0] neg_lo:[0,1] neg_hi:[0,1]
v_pk_add_f32 v[50:51], v[50:51], v[240:241] op_sel_hi:[1,0] neg_lo:[0,1] neg_hi:[0,1]
v_pk_add_f32 v[52:53], v[52:53], v[240:241] op_sel_hi:[1,0] neg_lo:[0,1] neg_hi:[0,1]
v_pk_add_f32 v[54:55], v[54:55], v[240:241] op_sel_hi:[1,0] neg_lo:[0,1] neg_hi:[0,1]
v_pk_add_f32 v[56:57], v[56:57], v[240:241] op_sel_hi:[1,0] neg_lo:[0,1] neg_hi:[0,1]
v_pk_add_f32 v[58:59], v[58:59], v[240:241] op_sel_hi:[1,0] neg_lo:[0,1] neg_hi:[0,1]
v_pk_add_f32 v[60:61], v[60:61], v[240:241] op_sel_hi:[1,0] neg_lo:[0,1] neg_hi:[0,1]
v_pk_add_f32 v[62:63], v[62:63], v[240:241] op_sel_hi:[1,0] neg_lo:[0,1] neg_hi:[0,1]
v_pk_add_f32 v[64:65], v[64:65], v[240:241] op_sel_hi:[1,0] neg_lo:[0,1] neg_hi:[0,1]
v_pk_add_f32 v[66:67], v[66:67], v[240:241] op_sel_hi:[1,0] neg_lo:[0,1] neg_hi:[0,1]
v_pk_add_f32 v[68:69], v[68:69], v[240:241] op_sel_hi:[1,0] neg_lo:[0,1] neg_hi:[0,1]
v_pk_add_f32 v[70:71], v[70:71], v[240:241] op_sel_hi:[1,0] neg_lo:[0,1] neg_hi:[0,1]
v_pk_add_f32 v[72:73], v[72:73], v[240:241] op_sel_hi:[1,0] neg_lo:[0,1] neg_hi:[0,1]
v_pk_add_f32 v[74:75], v[74:75], v[240:241] op_sel_hi:[1,0] neg_lo:[0,1] neg_hi:[0,1]
v_pk_add_f32 v[76:77], v[76:77], v[240:241] op_sel_hi:[1,0] neg_lo:[0,1] neg_hi:[0,1]
v_pk_add_f32 v[78:79], v[78:79], v[240:241] op_sel_hi:[1,0] neg_lo:[0,1] neg_hi:[0,1]
v_pk_add_f32 v[80:81], v[80:81], v[240:241] op_sel_hi:[1,0] neg_lo:[0,1] neg_hi:[0,1]
v_pk_add_f32 v[82:83], v[82:83], v[240:241] op_sel_hi:[1,0] neg_lo:[0,1] neg_hi:[0,1]
v_pk_add_f32 v[84:85], v[84:85], v[240:241] op_sel_hi:[1,0] neg_lo:[0,1] neg_hi:[0,1]
v_pk_add_f32 v[86:87], v[86:87], v[240:241] op_sel_hi:[1,0] neg_lo:[0,1] neg_hi:[0,1]
v_pk_add_f32 v[88:89], v[88:89], v[240:241] op_sel_hi:[1,0] neg_lo:[0,1] neg_hi:[0,1]
v_pk_add_f32 v[90:91], v[90:91], v[240:241] op_sel_hi:[1,0] neg_lo:[0,1] neg_hi:[0,1]
v_pk_add_f32 v[92:93], v[92:93], v[240:241] op_sel_hi:[1,0] neg_lo:[0,1] neg_hi:[0,1]
v_pk_add_f32 v[94:95], v[94:95], v[240:241] op_sel_hi:[1,0] neg_lo:[0,1] neg_hi:[0,1]
v_pk_add_f32 v[96:97], v[96:97], v[240:241] op_sel_hi:[1,0] neg_lo:[0,1] neg_hi:[0,1]
v_pk_add_f32 v[98:99], v[98:99], v[240:241] op_sel_hi:[1,0] neg_lo:[0,1] neg_hi:[0,1]
v_pk_add_f32 v[100:101], v[100:101], v[240:241] op_sel_hi:[1,0] neg_lo:[0,1] neg_hi:[0,1]
v_pk_add_f32 v[102:103], v[102:103], v[240:241] op_sel_hi:[1,0] neg_lo:[0,1] neg_hi:[0,1]
v_pk_add_f32 v[104:105], v[104:105], v[240:241] op_sel_hi:[1,0] neg_lo:[0,1] neg_hi:[0,1]
v_pk_add_f32 v[106:107], v[106:107], v[240:241] op_sel_hi:[1,0] neg_lo:[0,1] neg_hi:[0,1]
v_pk_add_f32 v[108:109], v[108:109], v[240:241] op_sel_hi:[1,0] neg_lo:[0,1] neg_hi:[0,1]
v_pk_add_f32 v[110:111], v[110:111], v[240:241] op_sel_hi:[1,0] neg_lo:[0,1] neg_hi:[0,1]
v_pk_mul_f32 v[240:241], v[48:49], v[48:49]
v_pk_fma_f32 v[240:241], v[50:51], v[50:51], v[240:241]
v_pk_fma_f32 v[240:241], v[52:53], v[52:53], v[240:241]
v_pk_fma_f32 v[240:241], v[54:55], v[54:55], v[240:241]
v_pk_fma_f32 v[240:241], v[56:57], v[56:57], v[240:241]
v_pk_fma_f32 v[240:241], v[58:59], v[58:59], v[240:241]
v_pk_fma_f32 v[240:241], v[60:61], v[60:61], v[240:241]
v_pk_fma_f32 v[240:241], v[62:63], v[62:63], v[240:241]
v_pk_fma_f32 v[240:241], v[64:65], v[64:65], v[240:241]
v_pk_fma_f32 v[240:241], v[66:67], v[66:67], v[240:241]
v_pk_fma_f32 v[240:241], v[68:69], v[68:69], v[240:241]
v_pk_fma_f32 v[240:241], v[70:71], v[70:71], v[240:241]
v_pk_fma_f32 v[240:241], v[72:73], v[72:73], v[240:241]
v_pk_fma_f32 v[240:241], v[74:75], v[74:75], v[240:241]
v_pk_fma_f32 v[240:241], v[76:77], v[76:77], v[240:241]
v_pk_fma_f32 v[240:241], v[78:79], v[78:79], v[240:241]
v_pk_fma_f32 v[240:241], v[80:81], v[80:81], v[240:241]
v_pk_fma_f32 v[240:241], v[82:83], v[82:83], v[240:241]
v_pk_fma_f32 v[240:241], v[84:85], v[84:85], v[240:241]
v_pk_fma_f32 v[240:241], v[86:87], v[86:87], v[240:241]
v_pk_fma_f32 v[240:241], v[88:89], v[88:89], v[240:241]
v_pk_fma_f32 v[240:241], v[90:91], v[90:91], v[240:241]
v_pk_fma_f32 v[240:241], v[92:93], v[92:93], v[240:241]
v_pk_fma_f32 v[240:241], v[94:95], v[94:95], v[240:241]
v_pk_fma_f32 v[240:241], v[96:97], v[96:97], v[240:241]
v_pk_fma_f32 v[240:241], v[98:99], v[98:99], v[240:241]
v_pk_fma_f32 v[240:241], v[100:101], v[100:101], v[240:241]
v_pk_fma_f32 v[240:241], v[102:103], v[102:103], v[240:241]
v_pk_fma_f32 v[240:241], v[104:105], v[104:105], v[240:241]
v_pk_fma_f32 v[240:241], v[106:107], v[106:107], v[240:241]
v_pk_fma_f32 v[240:241], v[108:109], v[108:109], v[240:241]
v_pk_fma_f32 v[240:241], v[110:111], v[110:111], v[240:241]
v_add_f32 v240, v240, v241
v_mov_b32 v241, v240
s_nop 1
v_permlane16_swap_b32 v240, v241
s_nop 0
v_add_f32 v240, v240, v241
v_mov_b32 v241, v240
s_nop 1
v_permlane32_swap_b32 v240, v241
s_nop 0
v_add_f32 v240, v240, v241
ds_write_b32 v11, v240 offset:768
s_waitcnt lgkmcnt(0)
s_barrier
ds_read_b128 v[240:243], v12 offset:768
s_waitcnt lgkmcnt(0)
v_pk_add_f32 v[240:241], v[240:241], v[242:243]
v_add_f32 v240, v240, v241
v_mul_f32 v240, 0x3a800000, v240
v_add_f32 v240, 0x3727c5ac, v240
v_rsq_f32 v240, v240
s_nop 0
v_pk_mul_f32 v[48:49], v[48:49], v[240:241] op_sel_hi:[1,0]
v_pk_mul_f32 v[50:51], v[50:51], v[240:241] op_sel_hi:[1,0]
v_pk_mul_f32 v[52:53], v[52:53], v[240:241] op_sel_hi:[1,0]
v_pk_mul_f32 v[54:55], v[54:55], v[240:241] op_sel_hi:[1,0]
v_pk_mul_f32 v[56:57], v[56:57], v[240:241] op_sel_hi:[1,0]
v_pk_mul_f32 v[58:59], v[58:59], v[240:241] op_sel_hi:[1,0]
v_pk_mul_f32 v[60:61], v[60:61], v[240:241] op_sel_hi:[1,0]
v_pk_mul_f32 v[62:63], v[62:63], v[240:241] op_sel_hi:[1,0]
v_pk_mul_f32 v[64:65], v[64:65], v[240:241] op_sel_hi:[1,0]
v_pk_mul_f32 v[66:67], v[66:67], v[240:241] op_sel_hi:[1,0]
v_pk_mul_f32 v[68:69], v[68:69], v[240:241] op_sel_hi:[1,0]
v_pk_mul_f32 v[70:71], v[70:71], v[240:241] op_sel_hi:[1,0]
v_pk_mul_f32 v[72:73], v[72:73], v[240:241] op_sel_hi:[1,0]
v_pk_mul_f32 v[74:75], v[74:75], v[240:241] op_sel_hi:[1,0]
v_pk_mul_f32 v[76:77], v[76:77], v[240:241] op_sel_hi:[1,0]
v_pk_mul_f32 v[78:79], v[78:79], v[240:241] op_sel_hi:[1,0]
v_pk_mul_f32 v[80:81], v[80:81], v[240:241] op_sel_hi:[1,0]
v_pk_mul_f32 v[82:83], v[82:83], v[240:241] op_sel_hi:[1,0]
v_pk_mul_f32 v[84:85], v[84:85], v[240:241] op_sel_hi:[1,0]
v_pk_mul_f32 v[86:87], v[86:87], v[240:241] op_sel_hi:[1,0]
v_pk_mul_f32 v[88:89], v[88:89], v[240:241] op_sel_hi:[1,0]
v_pk_mul_f32 v[90:91], v[90:91], v[240:241] op_sel_hi:[1,0]
v_pk_mul_f32 v[92:93], v[92:93], v[240:241] op_sel_hi:[1,0]
v_pk_mul_f32 v[94:95], v[94:95], v[240:241] op_sel_hi:[1,0]
v_pk_mul_f32 v[96:97], v[96:97], v[240:241] op_sel_hi:[1,0]
v_pk_mul_f32 v[98:99], v[98:99], v[240:241] op_sel_hi:[1,0]
v_pk_mul_f32 v[100:101], v[100:101], v[240:241] op_sel_hi:[1,0]
v_pk_mul_f32 v[102:103], v[102:103], v[240:241] op_sel_hi:[1,0]
v_pk_mul_f32 v[104:105], v[104:105], v[240:241] op_sel_hi:[1,0]
v_pk_mul_f32 v[106:107], v[106:107], v[240:241] op_sel_hi:[1,0]
v_pk_mul_f32 v[108:109], v[108:109], v[240:241] op_sel_hi:[1,0]
v_pk_mul_f32 v[110:111], v[110:111], v[240:241] op_sel_hi:[1,0]
v_pk_fma_f32 v[48:49], v[48:49], v[176:177], v[112:113]
v_pk_fma_f32 v[50:51], v[50:51], v[178:179], v[114:115]
v_pk_fma_f32 v[52:53], v[52:53], v[180:181], v[116:117]
v_pk_fma_f32 v[54:55], v[54:55], v[182:183], v[118:119]
v_cvt_pk_bf16_f32 v16, v48, v49
v_cvt_pk_bf16_f32 v17, v50, v51
v_cvt_pk_bf16_f32 v18, v52, v53
v_cvt_pk_bf16_f32 v19, v54, v55
s_add_u32 s41, s40, 8388608
buffer_store_dwordx4 v[16:19], v13, s[4:7], s41 offen sc1
v_pk_fma_f32 v[56:57], v[56:57], v[184:185], v[120:121]
v_pk_fma_f32 v[58:59], v[58:59], v[186:187], v[122:123]
v_pk_fma_f32 v[60:61], v[60:61], v[188:189], v[124:125]
v_pk_fma_f32 v[62:63], v[62:63], v[190:191], v[126:127]
v_cvt_pk_bf16_f32 v20, v56, v57
v_cvt_pk_bf16_f32 v21, v58, v59
v_cvt_pk_bf16_f32 v22, v60, v61
v_cvt_pk_bf16_f32 v23, v62, v63
s_add_u32 s41, s40, 8390656
buffer_store_dwordx4 v[20:23], v13, s[4:7], s41 offen sc1
v_pk_fma_f32 v[64:65], v[64:65], v[192:193], v[128:129]
v_pk_fma_f32 v[66:67], v[66:67], v[194:195], v[130:131]
v_pk_fma_f32 v[68:69], v[68:69], v[196:197], v[132:133]
v_pk_fma_f32 v[70:71], v[70:71], v[198:199], v[134:135]
v_cvt_pk_bf16_f32 v24, v64, v65
v_cvt_pk_bf16_f32 v25, v66, v67
v_cvt_pk_bf16_f32 v26, v68, v69
v_cvt_pk_bf16_f32 v27, v70, v71
s_add_u32 s41, s40, 8392704
buffer_store_dwordx4 v[24:27], v13, s[4:7], s41 offen sc1
v_pk_fma_f32 v[72:73], v[72:73], v[200:201], v[136:137]
v_pk_fma_f32 v[74:75], v[74:75], v[202:203], v[138:139]
v_pk_fma_f32 v[76:77], v[76:77], v[204:205], v[140:141]
v_pk_fma_f32 v[78:79], v[78:79], v[206:207], v[142:143]
v_cvt_pk_bf16_f32 v28, v72, v73
v_cvt_pk_bf16_f32 v29, v74, v75
v_cvt_pk_bf16_f32 v30, v76, v77
v_cvt_pk_bf16_f32 v31, v78, v79
s_add_u32 s41, s40, 8394752
buffer_store_dwordx4 v[28:31], v13, s[4:7], s41 offen sc1
v_pk_fma_f32 v[80:81], v[80:81], v[208:209], v[144:145]
v_pk_fma_f32 v[82:83], v[82:83], v[210:211], v[146:147]
v_pk_fma_f32 v[84:85], v[84:85], v[212:213], v[148:149]
v_pk_fma_f32 v[86:87], v[86:87], v[214:215], v[150:151]
v_cvt_pk_bf16_f32 v32, v80, v81
v_cvt_pk_bf16_f32 v33, v82, v83
v_cvt_pk_bf16_f32 v34, v84, v85
v_cvt_pk_bf16_f32 v35, v86, v87
s_add_u32 s41, s40, 8396800
buffer_store_dwordx4 v[32:35], v13, s[4:7], s41 offen sc1
v_pk_fma_f32 v[88:89], v[88:89], v[216:217], v[152:153]
v_pk_fma_f32 v[90:91], v[90:91], v[218:219], v[154:155]
v_pk_fma_f32 v[92:93], v[92:93], v[220:221], v[156:157]
v_pk_fma_f32 v[94:95], v[94:95], v[222:223], v[158:159]
v_cvt_pk_bf16_f32 v36, v88, v89
v_cvt_pk_bf16_f32 v37, v90, v91
v_cvt_pk_bf16_f32 v38, v92, v93
v_cvt_pk_bf16_f32 v39, v94, v95
s_add_u32 s41, s40, 8398848
buffer_store_dwordx4 v[36:39], v13, s[4:7], s41 offen sc1
v_pk_fma_f32 v[96:97], v[96:97], v[224:225], v[160:161]
v_pk_fma_f32 v[98:99], v[98:99], v[226:227], v[162:163]
v_pk_fma_f32 v[100:101], v[100:101], v[228:229], v[164:165]
v_pk_fma_f32 v[102:103], v[102:103], v[230:231], v[166:167]
v_cvt_pk_bf16_f32 v40, v96, v97
v_cvt_pk_bf16_f32 v41, v98, v99
v_cvt_pk_bf16_f32 v42, v100, v101
v_cvt_pk_bf16_f32 v43, v102, v103
s_add_u32 s41, s40, 8400896
buffer_store_dwordx4 v[40:43], v13, s[4:7], s41 offen sc1
v_pk_fma_f32 v[104:105], v[104:105], v[232:233], v[168:169]
v_pk_fma_f32 v[106:107], v[106:107], v[234:235], v[170:171]
v_pk_fma_f32 v[108:109], v[108:109], v[236:237], v[172:173]
v_pk_fma_f32 v[110:111], v[110:111], v[238:239], v[174:175]
v_cvt_pk_bf16_f32 v44, v104, v105
v_cvt_pk_bf16_f32 v45, v106, v107
v_cvt_pk_bf16_f32 v46, v108, v109
v_cvt_pk_bf16_f32 v47, v110, v111
s_add_u32 s41, s40, 8402944
buffer_store_dwordx4 v[44:47], v13, s[4:7], s41 offen sc1
v_mov_b32 v14, 3
s_waitcnt vmcnt(0)
s_barrier
buffer_store_dword v14, v10, s[4:7], 0 offen sc1
s_add_u32 s60, s26, 32
s_mov_b32 s61, 0
v_lshrrev_b32 v2, 3, v0
v_and_b32 v3, 7, v0
v_mul_u32_u24 v4, 12288, v2
v_lshl_add_u32 v4, v3, 4, v4
v_lshlrev_b32 v5, 1, v2
v_mov_b32 v96, 0
v_mov_b32 v97, 0
v_mov_b32 v98, 0
v_mov_b32 v99, 0
v_mov_b32 v100, 0
v_mov_b32 v101, 0
v_mov_b32 v102, 0
v_mov_b32 v103, 0
Lmd_603:
s_lshl_b32 s41, s61, 10
s_mul_i32 s40, s61, 6291456
s_lshl_b32 s42, s60, 7
s_add_u32 s40, s40, s42
buffer_load_ushort v80, v5, s[84:87], s41 offen offset:0
buffer_load_ushort v81, v5, s[84:87], s41 offen offset:64
buffer_load_ushort v82, v5, s[84:87], s41 offen offset:128
buffer_load_ushort v83, v5, s[84:87], s41 offen offset:192
buffer_load_ushort v84, v5, s[84:87], s41 offen offset:256
buffer_load_ushort v85, v5, s[84:87], s41 offen offset:320
buffer_load_ushort v86, v5, s[84:87], s41 offen offset:384
buffer_load_ushort v87, v5, s[84:87], s41 offen offset:448
buffer_load_ushort v88, v5, s[84:87], s41 offen offset:512
buffer_load_ushort v89, v5, s[84:87], s41 offen offset:576
buffer_load_ushort v90, v5, s[84:87], s41 offen offset:640
buffer_load_ushort v91, v5, s[84:87], s41 offen offset:704
buffer_load_ushort v92, v5, s[84:87], s41 offen offset:768
buffer_load_ushort v93, v5, s[84:87], s41 offen offset:832
buffer_load_ushort v94, v5, s[84:87], s41 offen offset:896
buffer_load_ushort v95, v5, s[84:87], s41 offen offset:960
buffer_load_dwordx4 v[16:19], v4, s[8:11], s40 offen
s_add_u32 s40, s40, 393216
buffer_load_dwordx4 v[20:23], v4, s[8:11], s40 offen
s_add_u32 s40, s40, 393216
buffer_load_dwordx4 v[24:27], v4, s[8:11], s40 offen
s_add_u32 s40, s40, 393216
buffer_load_dwordx4 v[28:31], v4, s[8:11], s40 offen
s_add_u32 s40, s40, 393216
buffer_load_dwordx4 v[32:35], v4, s[8:11], s40 offen
s_add_u32 s40, s40, 393216
buffer_load_dwordx4 v[36:39], v4, s[8:11], s40 offen
s_add_u32 s40, s40, 393216
buffer_load_dwordx4 v[40:43], v4, s[8:11], s40 offen
s_add_u32 s40, s40, 393216
buffer_load_dwordx4 v[44:47], v4, s[8:11], s40 offen
s_add_u32 s40, s40, 393216
buffer_load_dwordx4 v[48:51], v4, s[8:11], s40 offen
s_add_u32 s40, s40, 393216
buffer_load_dwordx4 v[52:55], v4, s[8:11], s40 offen
s_add_u32 s40, s40, 393216
buffer_load_dwordx4 v[56:59], v4, s[8:11], s40 offen
s_add_u32 s40, s40, 393216
buffer_load_dwordx4 v[60:63], v4, s[8:11], s40 offen
s_add_u32 s40, s40, 393216
buffer_load_dwordx4 v[64:67], v4, s[8:11], s40 offen
s_add_u32 s40, s40, 393216
buffer_load_dwordx4 v[68:71], v4, s[8:11], s40 offen
s_add_u32 s40, s40, 393216
buffer_load_dwordx4 v[72:75], v4, s[8:11], s40 offen
s_add_u32 s40, s40, 393216
buffer_load_dwordx4 v[76:79], v4, s[8:11], s40 offen
s_add_u32 s40, s40, 393216
s_waitcnt vmcnt(16)
v_lshlrev_b32 v80, 16, v80
v_mul_f32 v104, 0xbfb8aa3b, v80
v_exp_f32 v104, v104
s_nop 0
v_add_f32 v104, 1.0, v104
v_rcp_f32 v104, v104
s_nop 0
v_mul_f32 v104, v104, v80
v_cvt_pk_bf16_f32 v80, 0, v104
v_lshlrev_b32 v81, 16, v81
v_mul_f32 v104, 0xbfb8aa3b, v81
v_exp_f32 v104, v104
s_nop 0
v_add_f32 v104, 1.0, v104
v_rcp_f32 v104, v104
s_nop 0
v_mul_f32 v104, v104, v81
v_cvt_pk_bf16_f32 v81, 0, v104
v_lshlrev_b32 v82, 16, v82
v_mul_f32 v104, 0xbfb8aa3b, v82
v_exp_f32 v104, v104
s_nop 0
v_add_f32 v104, 1.0, v104
v_rcp_f32 v104, v104
s_nop 0
v_mul_f32 v104, v104, v82
v_cvt_pk_bf16_f32 v82, 0, v104
v_lshlrev_b32 v83, 16, v83
v_mul_f32 v104, 0xbfb8aa3b, v83
v_exp_f32 v104, v104
s_nop 0
v_add_f32 v104, 1.0, v104
v_rcp_f32 v104, v104
s_nop 0
v_mul_f32 v104, v104, v83
v_cvt_pk_bf16_f32 v83, 0, v104
v_lshlrev_b32 v84, 16, v84
v_mul_f32 v104, 0xbfb8aa3b, v84
v_exp_f32 v104, v104
s_nop 0
v_add_f32 v104, 1.0, v104
v_rcp_f32 v104, v104
s_nop 0
v_mul_f32 v104, v104, v84
v_cvt_pk_bf16_f32 v84, 0, v104
v_lshlrev_b32 v85, 16, v85
v_mul_f32 v104, 0xbfb8aa3b, v85
v_exp_f32 v104, v104
s_nop 0
v_add_f32 v104, 1.0, v104
v_rcp_f32 v104, v104
s_nop 0
v_mul_f32 v104, v104, v85
v_cvt_pk_bf16_f32 v85, 0, v104
v_lshlrev_b32 v86, 16, v86
v_mul_f32 v104, 0xbfb8aa3b, v86
v_exp_f32 v104, v104
s_nop 0
v_add_f32 v104, 1.0, v104
v_rcp_f32 v104, v104
s_nop 0
v_mul_f32 v104, v104, v86
v_cvt_pk_bf16_f32 v86, 0, v104
v_lshlrev_b32 v87, 16, v87
v_mul_f32 v104, 0xbfb8aa3b, v87
v_exp_f32 v104, v104
s_nop 0
v_add_f32 v104, 1.0, v104
v_rcp_f32 v104, v104
s_nop 0
v_mul_f32 v104, v104, v87
v_cvt_pk_bf16_f32 v87, 0, v104
v_lshlrev_b32 v88, 16, v88
v_mul_f32 v104, 0xbfb8aa3b, v88
v_exp_f32 v104, v104
s_nop 0
v_add_f32 v104, 1.0, v104
v_rcp_f32 v104, v104
s_nop 0
v_mul_f32 v104, v104, v88
v_cvt_pk_bf16_f32 v88, 0, v104
v_lshlrev_b32 v89, 16, v89
v_mul_f32 v104, 0xbfb8aa3b, v89
v_exp_f32 v104, v104
s_nop 0
v_add_f32 v104, 1.0, v104
v_rcp_f32 v104, v104
s_nop 0
v_mul_f32 v104, v104, v89
v_cvt_pk_bf16_f32 v89, 0, v104
v_lshlrev_b32 v90, 16, v90
v_mul_f32 v104, 0xbfb8aa3b, v90
v_exp_f32 v104, v104
s_nop 0
v_add_f32 v104, 1.0, v104
v_rcp_f32 v104, v104
s_nop 0
v_mul_f32 v104, v104, v90
v_cvt_pk_bf16_f32 v90, 0, v104
v_lshlrev_b32 v91, 16, v91
v_mul_f32 v104, 0xbfb8aa3b, v91
v_exp_f32 v104, v104
s_nop 0
v_add_f32 v104, 1.0, v104
v_rcp_f32 v104, v104
s_nop 0
v_mul_f32 v104, v104, v91
v_cvt_pk_bf16_f32 v91, 0, v104
v_lshlrev_b32 v92, 16, v92
v_mul_f32 v104, 0xbfb8aa3b, v92
v_exp_f32 v104, v104
s_nop 0
v_add_f32 v104, 1.0, v104
v_rcp_f32 v104, v104
s_nop 0
v_mul_f32 v104, v104, v92
v_cvt_pk_bf16_f32 v92, 0, v104
v_lshlrev_b32 v93, 16, v93
v_mul_f32 v104, 0xbfb8aa3b, v93
v_exp_f32 v104, v104
s_nop 0
v_add_f32 v104, 1.0, v104
v_rcp_f32 v104, v104
s_nop 0
v_mul_f32 v104, v104, v93
v_cvt_pk_bf16_f32 v93, 0, v104
v_lshlrev_b32 v94, 16, v94
v_mul_f32 v104, 0xbfb8aa3b, v94
v_exp_f32 v104, v104
s_nop 0
v_add_f32 v104, 1.0, v104
v_rcp_f32 v104, v104
s_nop 0
v_mul_f32 v104, v104, v94
v_cvt_pk_bf16_f32 v94, 0, v104
v_lshlrev_b32 v95, 16, v95
v_mul_f32 v104, 0xbfb8aa3b, v95
v_exp_f32 v104, v104
s_nop 0
v_add_f32 v104, 1.0, v104
v_rcp_f32 v104, v104
s_nop 0
v_mul_f32 v104, v104, v95
v_cvt_pk_bf16_f32 v95, 0, v104
s_waitcnt vmcnt(15)
v_lshlrev_b32 v104, 16, v16
v_and_b32 v105, 0xffff0000, v16
v_fmac_f32 v96, v104, v80
v_fmac_f32 v97, v105, v80
v_lshlrev_b32 v104, 16, v17
v_and_b32 v105, 0xffff0000, v17
v_fmac_f32 v98, v104, v80
v_fmac_f32 v99, v105, v80
v_lshlrev_b32 v104, 16, v18
v_and_b32 v105, 0xffff0000, v18
v_fmac_f32 v100, v104, v80
v_fmac_f32 v101, v105, v80
v_lshlrev_b32 v104, 16, v19
v_and_b32 v105, 0xffff0000, v19
v_fmac_f32 v102, v104, v80
v_fmac_f32 v103, v105, v80
s_waitcnt vmcnt(14)
v_lshlrev_b32 v104, 16, v20
v_and_b32 v105, 0xffff0000, v20
v_fmac_f32 v96, v104, v81
v_fmac_f32 v97, v105, v81
v_lshlrev_b32 v104, 16, v21
v_and_b32 v105, 0xffff0000, v21
v_fmac_f32 v98, v104, v81
v_fmac_f32 v99, v105, v81
v_lshlrev_b32 v104, 16, v22
v_and_b32 v105, 0xffff0000, v22
v_fmac_f32 v100, v104, v81
v_fmac_f32 v101, v105, v81
v_lshlrev_b32 v104, 16, v23
v_and_b32 v105, 0xffff0000, v23
v_fmac_f32 v102, v104, v81
v_fmac_f32 v103, v105, v81
s_waitcnt vmcnt(13)
v_lshlrev_b32 v104, 16, v24
v_and_b32 v105, 0xffff0000, v24
v_fmac_f32 v96, v104, v82
v_fmac_f32 v97, v105, v82
v_lshlrev_b32 v104, 16, v25
v_and_b32 v105, 0xffff0000, v25
v_fmac_f32 v98, v104, v82
v_fmac_f32 v99, v105, v82
v_lshlrev_b32 v104, 16, v26
v_and_b32 v105, 0xffff0000, v26
v_fmac_f32 v100, v104, v82
v_fmac_f32 v101, v105, v82
v_lshlrev_b32 v104, 16, v27
v_and_b32 v105, 0xffff0000, v27
v_fmac_f32 v102, v104, v82
v_fmac_f32 v103, v105, v82
s_waitcnt vmcnt(12)
v_lshlrev_b32 v104, 16, v28
v_and_b32 v105, 0xffff0000, v28
v_fmac_f32 v96, v104, v83
v_fmac_f32 v97, v105, v83
v_lshlrev_b32 v104, 16, v29
v_and_b32 v105, 0xffff0000, v29
v_fmac_f32 v98, v104, v83
v_fmac_f32 v99, v105, v83
v_lshlrev_b32 v104, 16, v30
v_and_b32 v105, 0xffff0000, v30
v_fmac_f32 v100, v104, v83
v_fmac_f32 v101, v105, v83
v_lshlrev_b32 v104, 16, v31
v_and_b32 v105, 0xffff0000, v31
v_fmac_f32 v102, v104, v83
v_fmac_f32 v103, v105, v83
s_waitcnt vmcnt(11)
v_lshlrev_b32 v104, 16, v32
v_and_b32 v105, 0xffff0000, v32
v_fmac_f32 v96, v104, v84
v_fmac_f32 v97, v105, v84
v_lshlrev_b32 v104, 16, v33
v_and_b32 v105, 0xffff0000, v33
v_fmac_f32 v98, v104, v84
v_fmac_f32 v99, v105, v84
v_lshlrev_b32 v104, 16, v34
v_and_b32 v105, 0xffff0000, v34
v_fmac_f32 v100, v104, v84
v_fmac_f32 v101, v105, v84
v_lshlrev_b32 v104, 16, v35
v_and_b32 v105, 0xffff0000, v35
v_fmac_f32 v102, v104, v84
v_fmac_f32 v103, v105, v84
s_waitcnt vmcnt(10)
v_lshlrev_b32 v104, 16, v36
v_and_b32 v105, 0xffff0000, v36
v_fmac_f32 v96, v104, v85
v_fmac_f32 v97, v105, v85
v_lshlrev_b32 v104, 16, v37
v_and_b32 v105, 0xffff0000, v37
v_fmac_f32 v98, v104, v85
v_fmac_f32 v99, v105, v85
v_lshlrev_b32 v104, 16, v38
v_and_b32 v105, 0xffff0000, v38
v_fmac_f32 v100, v104, v85
v_fmac_f32 v101, v105, v85
v_lshlrev_b32 v104, 16, v39
v_and_b32 v105, 0xffff0000, v39
v_fmac_f32 v102, v104, v85
v_fmac_f32 v103, v105, v85
s_waitcnt vmcnt(9)
v_lshlrev_b32 v104, 16, v40
v_and_b32 v105, 0xffff0000, v40
v_fmac_f32 v96, v104, v86
v_fmac_f32 v97, v105, v86
v_lshlrev_b32 v104, 16, v41
v_and_b32 v105, 0xffff0000, v41
v_fmac_f32 v98, v104, v86
v_fmac_f32 v99, v105, v86
v_lshlrev_b32 v104, 16, v42
v_and_b32 v105, 0xffff0000, v42
v_fmac_f32 v100, v104, v86
v_fmac_f32 v101, v105, v86
v_lshlrev_b32 v104, 16, v43
v_and_b32 v105, 0xffff0000, v43
v_fmac_f32 v102, v104, v86
v_fmac_f32 v103, v105, v86
s_waitcnt vmcnt(8)
v_lshlrev_b32 v104, 16, v44
v_and_b32 v105, 0xffff0000, v44
v_fmac_f32 v96, v104, v87
v_fmac_f32 v97, v105, v87
v_lshlrev_b32 v104, 16, v45
v_and_b32 v105, 0xffff0000, v45
v_fmac_f32 v98, v104, v87
v_fmac_f32 v99, v105, v87
v_lshlrev_b32 v104, 16, v46
v_and_b32 v105, 0xffff0000, v46
v_fmac_f32 v100, v104, v87
v_fmac_f32 v101, v105, v87
v_lshlrev_b32 v104, 16, v47
v_and_b32 v105, 0xffff0000, v47
v_fmac_f32 v102, v104, v87
v_fmac_f32 v103, v105, v87
s_waitcnt vmcnt(7)
v_lshlrev_b32 v104, 16, v48
v_and_b32 v105, 0xffff0000, v48
v_fmac_f32 v96, v104, v88
v_fmac_f32 v97, v105, v88
v_lshlrev_b32 v104, 16, v49
v_and_b32 v105, 0xffff0000, v49
v_fmac_f32 v98, v104, v88
v_fmac_f32 v99, v105, v88
v_lshlrev_b32 v104, 16, v50
v_and_b32 v105, 0xffff0000, v50
v_fmac_f32 v100, v104, v88
v_fmac_f32 v101, v105, v88
v_lshlrev_b32 v104, 16, v51
v_and_b32 v105, 0xffff0000, v51
v_fmac_f32 v102, v104, v88
v_fmac_f32 v103, v105, v88
s_waitcnt vmcnt(6)
v_lshlrev_b32 v104, 16, v52
v_and_b32 v105, 0xffff0000, v52
v_fmac_f32 v96, v104, v89
v_fmac_f32 v97, v105, v89
v_lshlrev_b32 v104, 16, v53
v_and_b32 v105, 0xffff0000, v53
v_fmac_f32 v98, v104, v89
v_fmac_f32 v99, v105, v89
v_lshlrev_b32 v104, 16, v54
v_and_b32 v105, 0xffff0000, v54
v_fmac_f32 v100, v104, v89
v_fmac_f32 v101, v105, v89
v_lshlrev_b32 v104, 16, v55
v_and_b32 v105, 0xffff0000, v55
v_fmac_f32 v102, v104, v89
v_fmac_f32 v103, v105, v89
s_waitcnt vmcnt(5)
v_lshlrev_b32 v104, 16, v56
v_and_b32 v105, 0xffff0000, v56
v_fmac_f32 v96, v104, v90
v_fmac_f32 v97, v105, v90
v_lshlrev_b32 v104, 16, v57
v_and_b32 v105, 0xffff0000, v57
v_fmac_f32 v98, v104, v90
v_fmac_f32 v99, v105, v90
v_lshlrev_b32 v104, 16, v58
v_and_b32 v105, 0xffff0000, v58
v_fmac_f32 v100, v104, v90
v_fmac_f32 v101, v105, v90
v_lshlrev_b32 v104, 16, v59
v_and_b32 v105, 0xffff0000, v59
v_fmac_f32 v102, v104, v90
v_fmac_f32 v103, v105, v90
s_waitcnt vmcnt(4)
v_lshlrev_b32 v104, 16, v60
v_and_b32 v105, 0xffff0000, v60
v_fmac_f32 v96, v104, v91
v_fmac_f32 v97, v105, v91
v_lshlrev_b32 v104, 16, v61
v_and_b32 v105, 0xffff0000, v61
v_fmac_f32 v98, v104, v91
v_fmac_f32 v99, v105, v91
v_lshlrev_b32 v104, 16, v62
v_and_b32 v105, 0xffff0000, v62
v_fmac_f32 v100, v104, v91
v_fmac_f32 v101, v105, v91
v_lshlrev_b32 v104, 16, v63
v_and_b32 v105, 0xffff0000, v63
v_fmac_f32 v102, v104, v91
v_fmac_f32 v103, v105, v91
s_waitcnt vmcnt(3)
v_lshlrev_b32 v104, 16, v64
v_and_b32 v105, 0xffff0000, v64
v_fmac_f32 v96, v104, v92
v_fmac_f32 v97, v105, v92
v_lshlrev_b32 v104, 16, v65
v_and_b32 v105, 0xffff0000, v65
v_fmac_f32 v98, v104, v92
v_fmac_f32 v99, v105, v92
v_lshlrev_b32 v104, 16, v66
v_and_b32 v105, 0xffff0000, v66
v_fmac_f32 v100, v104, v92
v_fmac_f32 v101, v105, v92
v_lshlrev_b32 v104, 16, v67
v_and_b32 v105, 0xffff0000, v67
v_fmac_f32 v102, v104, v92
v_fmac_f32 v103, v105, v92
s_waitcnt vmcnt(2)
v_lshlrev_b32 v104, 16, v68
v_and_b32 v105, 0xffff0000, v68
v_fmac_f32 v96, v104, v93
v_fmac_f32 v97, v105, v93
v_lshlrev_b32 v104, 16, v69
v_and_b32 v105, 0xffff0000, v69
v_fmac_f32 v98, v104, v93
v_fmac_f32 v99, v105, v93
v_lshlrev_b32 v104, 16, v70
v_and_b32 v105, 0xffff0000, v70
v_fmac_f32 v100, v104, v93
v_fmac_f32 v101, v105, v93
v_lshlrev_b32 v104, 16, v71
v_and_b32 v105, 0xffff0000, v71
v_fmac_f32 v102, v104, v93
v_fmac_f32 v103, v105, v93
s_waitcnt vmcnt(1)
v_lshlrev_b32 v104, 16, v72
v_and_b32 v105, 0xffff0000, v72
v_fmac_f32 v96, v104, v94
v_fmac_f32 v97, v105, v94
v_lshlrev_b32 v104, 16, v73
v_and_b32 v105, 0xffff0000, v73
v_fmac_f32 v98, v104, v94
v_fmac_f32 v99, v105, v94
v_lshlrev_b32 v104, 16, v74
v_and_b32 v105, 0xffff0000, v74
v_fmac_f32 v100, v104, v94
v_fmac_f32 v101, v105, v94
v_lshlrev_b32 v104, 16, v75
v_and_b32 v105, 0xffff0000, v75
v_fmac_f32 v102, v104, v94
v_fmac_f32 v103, v105, v94
s_waitcnt vmcnt(0)
v_lshlrev_b32 v104, 16, v76
v_and_b32 v105, 0xffff0000, v76
v_fmac_f32 v96, v104, v95
v_fmac_f32 v97, v105, v95
v_lshlrev_b32 v104, 16, v77
v_and_b32 v105, 0xffff0000, v77
v_fmac_f32 v98, v104, v95
v_fmac_f32 v99, v105, v95
v_lshlrev_b32 v104, 16, v78
v_and_b32 v105, 0xffff0000, v78
v_fmac_f32 v100, v104, v95
v_fmac_f32 v101, v105, v95
v_lshlrev_b32 v104, 16, v79
v_and_b32 v105, 0xffff0000, v79
v_fmac_f32 v102, v104, v95
v_fmac_f32 v103, v105, v95
s_add_u32 s61, s61, 1
s_cmp_lt_u32 s61, 2
s_cbranch_scc1 Lmd_603
s_lshl_b32 s60, s60, 8
s_add_u32 s60, s60, 3145728
s_nop 1
v_add_f32_dpp v96, v96, v96 row_ror:8 row_mask:0xf bank_mask:0xf
v_add_f32_dpp v97, v97, v97 row_ror:8 row_mask:0xf bank_mask:0xf
v_add_f32_dpp v98, v98, v98 row_ror:8 row_mask:0xf bank_mask:0xf
v_add_f32_dpp v99, v99, v99 row_ror:8 row_mask:0xf bank_mask:0xf
v_add_f32_dpp v100, v100, v100 row_ror:8 row_mask:0xf bank_mask:0xf
v_add_f32_dpp v101, v101, v101 row_ror:8 row_mask:0xf bank_mask:0xf
v_add_f32_dpp v102, v102, v102 row_ror:8 row_mask:0xf bank_mask:0xf
v_add_f32_dpp v103, v103, v103 row_ror:8 row_mask:0xf bank_mask:0xf
v_mov_b32 v16, v96
v_mov_b32 v17, v97
v_mov_b32 v18, v98
v_mov_b32 v19, v99
v_mov_b32 v20, v100
v_mov_b32 v21, v101
v_mov_b32 v22, v102
v_mov_b32 v23, v103
v_permlane16_swap_b32 v96, v16
v_permlane16_swap_b32 v97, v17
v_permlane16_swap_b32 v98, v18
v_permlane16_swap_b32 v99, v19
v_permlane16_swap_b32 v100, v20
v_permlane16_swap_b32 v101, v21
v_permlane16_swap_b32 v102, v22
v_permlane16_swap_b32 v103, v23
v_add_f32 v96, v96, v16
v_add_f32 v97, v97, v17
v_add_f32 v98, v98, v18
v_add_f32 v99, v99, v19
v_add_f32 v100, v100, v20
v_add_f32 v101, v101, v21
v_add_f32 v102, v102, v22
v_add_f32 v103, v103, v23
v_mov_b32 v16, v96
v_mov_b32 v17, v97
v_mov_b32 v18, v98
v_mov_b32 v19, v99
v_mov_b32 v20, v100
v_mov_b32 v21, v101
v_mov_b32 v22, v102
v_mov_b32 v23, v103
v_permlane32_swap_b32 v96, v16
v_permlane32_swap_b32 v97, v17
v_permlane32_swap_b32 v98, v18
v_permlane32_swap_b32 v99, v19
v_permlane32_swap_b32 v100, v20
v_permlane32_swap_b32 v101, v21
v_permlane32_swap_b32 v102, v22
v_permlane32_swap_b32 v103, v23
v_add_f32 v96, v96, v16
v_add_f32 v97, v97, v17
v_add_f32 v98, v98, v18
v_add_f32 v99, v99, v19
v_add_f32 v100, v100, v20
v_add_f32 v101, v101, v21
v_add_f32 v102, v102, v22
v_add_f32 v103, v103, v23
s_lshl_b32 s40, s32, 8
v_lshl_add_u32 v2, v3, 5, s40
ds_write_b128 v2, v[96:99] offset:1024
ds_write_b128 v2, v[100:103] offset:1040
s_waitcnt lgkmcnt(0)
s_barrier
v_and_b32 v2, 63, v0
v_lshlrev_b32 v2, 2, v2
ds_read_b32 v96, v2 offset:1024
ds_read_b32 v97, v2 offset:1280
ds_read_b32 v98, v2 offset:1536
ds_read_b32 v99, v2 offset:1792
s_min_u32 s40, s32, 1
s_lshl_b32 s40, s40, 30
s_add_u32 s40, s40, s60
s_waitcnt lgkmcnt(0)
v_add_f32 v96, v96, v97
v_add_f32 v98, v98, v99
v_add_f32 v96, v96, v98
v_cvt_pk_bf16_f32 v96, 0, v96
buffer_store_dword v96, v2, s[4:7], s40 offen sc1
v_mov_b32 v14, 4
s_waitcnt vmcnt(0)
buffer_store_dword v14, v10, s[4:7], 0 offen sc1
v_mov_b32 v4, v8
v_mov_b32 v5, 0
s_cmp_ge_u32 s34, 30
s_cbranch_scc1 Lln_6
s_load_dwordx2 s[16:17], s[0:1], 64
s_load_dwordx2 s[18:19], s[0:1], 72
s_load_dwordx2 s[20:21], s[0:1], 80
s_waitcnt lgkmcnt(0)
s_mov_b32 s8, s16
s_and_b32 s9, s17, 0xffff
s_mov_b32 s10, 0x700000
s_mov_b32 s11, 0x20000
s_mov_b32 s84, s18
s_and_b32 s85, s19, 0xffff
s_mov_b32 s86, 0x700000
s_mov_b32 s87, 0x20000
s_mov_b32 s88, s20
s_and_b32 s89, s21, 0xffff
s_mov_b32 s90, 0x700000
s_mov_b32 s91, 0x20000
s_lshl_b32 s60, s44, 7
s_lshl_b32 s52, s32, 5
v_bfe_u32 v84, v9, 2, 2
v_lshrrev_b32 v85, 4, v9
v_lshl_add_u32 v84, v85, 3, v84
v_lshl_add_u32 v84, v84, 7, s52
v_and_b32 v85, 3, v9
v_lshl_add_u32 v84, v85, 3, v84
v_add_u32 v80, 0, v84
v_bfe_u32 v84, v9, 2, 2
v_lshrrev_b32 v85, 4, v9
v_lshl_add_u32 v84, v85, 3, v84
v_lshl_add_u32 v84, v84, 7, s52
v_and_b32 v85, 3, v9
v_lshl_add_u32 v84, v85, 3, v84
v_add_u32 v81, 16384, v84
v_lshrrev_b32 v84, 3, v9
s_mul_i32 s38, s32, 256
v_add_u32 v84, s38, v84
v_mul_u32_u24 v84, 7168, v84
v_and_b32 v85, 7, v9
v_lshl_add_u32 v84, v85, 4, v84
s_lshl_b32 s38, s32, 12
s_barrier
s_add_u32 m0, s38, 0
s_add_u32 s39, s60, 0
buffer_load_dwordx4 v84, s[8:11], s39 offen lds
s_add_u32 m0, s38, 1024
s_add_u32 s39, s60, 57344
buffer_load_dwordx4 v84, s[8:11], s39 offen lds
s_add_u32 m0, s38, 2048
s_add_u32 s39, s60, 114688
buffer_load_dwordx4 v84, s[8:11], s39 offen lds
s_add_u32 m0, s38, 3072
s_add_u32 s39, s60, 172032
buffer_load_dwordx4 v84, s[8:11], s39 offen lds
s_add_u32 m0, s38, 16384
s_add_u32 s39, s60, 0
buffer_load_dwordx4 v84, s[84:87], s39 offen lds
s_add_u32 m0, s38, 17408
s_add_u32 s39, s60, 57344
buffer_load_dwordx4 v84, s[84:87], s39 offen lds
s_add_u32 m0, s38, 18432
s_add_u32 s39, s60, 114688
buffer_load_dwordx4 v84, s[84:87], s39 offen lds
s_add_u32 m0, s38, 19456
s_add_u32 s39, s60, 172032
buffer_load_dwordx4 v84, s[84:87], s39 offen lds
s_add_u32 m0, s38, 32768
s_add_u32 s39, s60, 229376
buffer_load_dwordx4 v84, s[8:11], s39 offen lds
s_add_u32 m0, s38, 33792
s_add_u32 s39, s60, 286720
buffer_load_dwordx4 v84, s[8:11], s39 offen lds
s_add_u32 m0, s38, 34816
s_add_u32 s39, s60, 344064
buffer_load_dwordx4 v84, s[8:11], s39 offen lds
s_add_u32 m0, s38, 35840
s_add_u32 s39, s60, 401408
buffer_load_dwordx4 v84, s[8:11], s39 offen lds
s_add_u32 m0, s38, 49152
s_add_u32 s39, s60, 229376
buffer_load_dwordx4 v84, s[84:87], s39 offen lds
s_add_u32 m0, s38, 50176
s_add_u32 s39, s60, 286720
buffer_load_dwordx4 v84, s[84:87], s39 offen lds
s_add_u32 m0, s38, 51200
s_add_u32 s39, s60, 344064
buffer_load_dwordx4 v84, s[84:87], s39 offen lds
s_add_u32 m0, s38, 52224
s_add_u32 s39, s60, 401408
buffer_load_dwordx4 v84, s[84:87], s39 offen lds
s_add_u32 m0, s38, 65536
s_add_u32 s39, s60, 458752
buffer_load_dwordx4 v84, s[8:11], s39 offen lds
s_add_u32 m0, s38, 66560
s_add_u32 s39, s60, 516096
buffer_load_dwordx4 v84, s[8:11], s39 offen lds
s_add_u32 m0, s38, 67584
s_add_u32 s39, s60, 573440
buffer_load_dwordx4 v84, s[8:11], s39 offen lds
s_add_u32 m0, s38, 68608
s_add_u32 s39, s60, 630784
buffer_load_dwordx4 v84, s[8:11], s39 offen lds
s_add_u32 m0, s38, 81920
s_add_u32 s39, s60, 458752
buffer_load_dwordx4 v84, s[84:87], s39 offen lds
s_add_u32 m0, s38, 82944
s_add_u32 s39, s60, 516096
buffer_load_dwordx4 v84, s[84:87], s39 offen lds
s_add_u32 m0, s38, 83968
s_add_u32 s39, s60, 573440
buffer_load_dwordx4 v84, s[84:87], s39 offen lds
s_add_u32 m0, s38, 84992
s_add_u32 s39, s60, 630784
buffer_load_dwordx4 v84, s[84:87], s39 offen lds
s_add_u32 m0, s38, 98304
s_add_u32 s39, s60, 688128
buffer_load_dwordx4 v84, s[8:11], s39 offen lds
s_add_u32 m0, s38, 99328
s_add_u32 s39, s60, 745472
buffer_load_dwordx4 v84, s[8:11], s39 offen lds
s_add_u32 m0, s38, 100352
s_add_u32 s39, s60, 802816
buffer_load_dwordx4 v84, s[8:11], s39 offen lds
s_add_u32 m0, s38, 101376
s_add_u32 s39, s60, 860160
buffer_load_dwordx4 v84, s[8:11], s39 offen lds
s_add_u32 m0, s38, 114688
s_add_u32 s39, s60, 688128
buffer_load_dwordx4 v84, s[84:87], s39 offen lds
s_add_u32 m0, s38, 115712
s_add_u32 s39, s60, 745472
buffer_load_dwordx4 v84, s[84:87], s39 offen lds
s_add_u32 m0, s38, 116736
s_add_u32 s39, s60, 802816
buffer_load_dwordx4 v84, s[84:87], s39 offen lds
s_add_u32 m0, s38, 117760
s_add_u32 s39, s60, 860160
buffer_load_dwordx4 v84, s[84:87], s39 offen lds
s_add_u32 m0, s38, 131072
s_add_u32 s39, s60, 917504
buffer_load_dwordx4 v84, s[8:11], s39 offen lds
s_add_u32 m0, s38, 132096
s_add_u32 s39, s60, 974848
buffer_load_dwordx4 v84, s[8:11], s39 offen lds
s_add_u32 m0, s38, 133120
s_add_u32 s39, s60, 1032192
buffer_load_dwordx4 v84, s[8:11], s39 offen lds
s_add_u32 m0, s38, 134144
s_add_u32 s39, s60, 1089536
buffer_load_dwordx4 v84, s[8:11], s39 offen lds
s_add_u32 m0, s38, 147456
s_add_u32 s39, s60, 917504
buffer_load_dwordx4 v84, s[84:87], s39 offen lds
s_add_u32 m0, s38, 148480
s_add_u32 s39, s60, 974848
buffer_load_dwordx4 v84, s[84:87], s39 offen lds
s_add_u32 m0, s38, 149504
s_add_u32 s39, s60, 1032192
buffer_load_dwordx4 v84, s[84:87], s39 offen lds
s_add_u32 m0, s38, 150528
s_add_u32 s39, s60, 1089536
buffer_load_dwordx4 v84, s[84:87], s39 offen lds
s_waitcnt vmcnt(32)
s_barrier
ds_read_b64_tr_b16 a[0:1], v80 offset:0
ds_read_b64_tr_b16 a[2:3], v80 offset:512
ds_read_b64_tr_b16 a[32:33], v80 offset:4096
ds_read_b64_tr_b16 a[34:35], v80 offset:4608
ds_read_b64_tr_b16 a[64:65], v80 offset:8192
ds_read_b64_tr_b16 a[66:67], v80 offset:8704
ds_read_b64_tr_b16 a[96:97], v80 offset:12288
ds_read_b64_tr_b16 a[98:99], v80 offset:12800
ds_read_b64_tr_b16 a[128:129], v81 offset:0
ds_read_b64_tr_b16 a[130:131], v81 offset:512
ds_read_b64_tr_b16 a[160:161], v81 offset:4096
ds_read_b64_tr_b16 a[162:163], v81 offset:4608
ds_read_b64_tr_b16 a[192:193], v81 offset:8192
ds_read_b64_tr_b16 a[194:195], v81 offset:8704
ds_read_b64_tr_b16 a[224:225], v81 offset:12288
ds_read_b64_tr_b16 a[226:227], v81 offset:12800
v_add_u32 v80, 32768, v80
v_add_u32 v81, 32768, v81
s_waitcnt lgkmcnt(0)
s_barrier
s_add_u32 m0, s38, 0
s_add_u32 s39, s60, 1146880
buffer_load_dwordx4 v84, s[8:11], s39 offen lds
s_add_u32 m0, s38, 1024
s_add_u32 s39, s60, 1204224
buffer_load_dwordx4 v84, s[8:11], s39 offen lds
s_add_u32 m0, s38, 2048
s_add_u32 s39, s60, 1261568
buffer_load_dwordx4 v84, s[8:11], s39 offen lds
s_add_u32 m0, s38, 3072
s_add_u32 s39, s60, 1318912
buffer_load_dwordx4 v84, s[8:11], s39 offen lds
s_add_u32 m0, s38, 16384
s_add_u32 s39, s60, 1146880
buffer_load_dwordx4 v84, s[84:87], s39 offen lds
s_add_u32 m0, s38, 17408
s_add_u32 s39, s60, 1204224
buffer_load_dwordx4 v84, s[84:87], s39 offen lds
s_add_u32 m0, s38, 18432
s_add_u32 s39, s60, 1261568
buffer_load_dwordx4 v84, s[84:87], s39 offen lds
s_add_u32 m0, s38, 19456
s_add_u32 s39, s60, 1318912
buffer_load_dwordx4 v84, s[84:87], s39 offen lds
s_waitcnt vmcnt(32)
s_barrier
ds_read_b64_tr_b16 a[4:5], v80 offset:0
ds_read_b64_tr_b16 a[6:7], v80 offset:512
ds_read_b64_tr_b16 a[36:37], v80 offset:4096
ds_read_b64_tr_b16 a[38:39], v80 offset:4608
ds_read_b64_tr_b16 a[68:69], v80 offset:8192
ds_read_b64_tr_b16 a[70:71], v80 offset:8704
ds_read_b64_tr_b16 a[100:101], v80 offset:12288
ds_read_b64_tr_b16 a[102:103], v80 offset:12800
ds_read_b64_tr_b16 a[132:133], v81 offset:0
ds_read_b64_tr_b16 a[134:135], v81 offset:512
ds_read_b64_tr_b16 a[164:165], v81 offset:4096
ds_read_b64_tr_b16 a[166:167], v81 offset:4608
ds_read_b64_tr_b16 a[196:197], v81 offset:8192
ds_read_b64_tr_b16 a[198:199], v81 offset:8704
ds_read_b64_tr_b16 a[228:229], v81 offset:12288
ds_read_b64_tr_b16 a[230:231], v81 offset:12800
v_add_u32 v80, 32768, v80
v_add_u32 v81, 32768, v81
s_waitcnt lgkmcnt(0)
s_barrier
s_add_u32 m0, s38, 32768
s_add_u32 s39, s60, 1376256
buffer_load_dwordx4 v84, s[8:11], s39 offen lds
s_add_u32 m0, s38, 33792
s_add_u32 s39, s60, 1433600
buffer_load_dwordx4 v84, s[8:11], s39 offen lds
s_add_u32 m0, s38, 34816
s_add_u32 s39, s60, 1490944
buffer_load_dwordx4 v84, s[8:11], s39 offen lds
s_add_u32 m0, s38, 35840
s_add_u32 s39, s60, 1548288
buffer_load_dwordx4 v84, s[8:11], s39 offen lds
s_add_u32 m0, s38, 49152
s_add_u32 s39, s60, 1376256
buffer_load_dwordx4 v84, s[84:87], s39 offen lds
s_add_u32 m0, s38, 50176
s_add_u32 s39, s60, 1433600
buffer_load_dwordx4 v84, s[84:87], s39 offen lds
s_add_u32 m0, s38, 51200
s_add_u32 s39, s60, 1490944
buffer_load_dwordx4 v84, s[84:87], s39 offen lds
s_add_u32 m0, s38, 52224
s_add_u32 s39, s60, 1548288
buffer_load_dwordx4 v84, s[84:87], s39 offen lds
s_waitcnt vmcnt(32)
s_barrier
ds_read_b64_tr_b16 a[8:9], v80 offset:0
ds_read_b64_tr_b16 a[10:11], v80 offset:512
ds_read_b64_tr_b16 a[40:41], v80 offset:4096
ds_read_b64_tr_b16 a[42:43], v80 offset:4608
ds_read_b64_tr_b16 a[72:73], v80 offset:8192
ds_read_b64_tr_b16 a[74:75], v80 offset:8704
ds_read_b64_tr_b16 a[104:105], v80 offset:12288
ds_read_b64_tr_b16 a[106:107], v80 offset:12800
ds_read_b64_tr_b16 a[136:137], v81 offset:0
ds_read_b64_tr_b16 a[138:139], v81 offset:512
ds_read_b64_tr_b16 a[168:169], v81 offset:4096
ds_read_b64_tr_b16 a[170:171], v81 offset:4608
ds_read_b64_tr_b16 a[200:201], v81 offset:8192
ds_read_b64_tr_b16 a[202:203], v81 offset:8704
ds_read_b64_tr_b16 a[232:233], v81 offset:12288
ds_read_b64_tr_b16 a[234:235], v81 offset:12800
v_add_u32 v80, 32768, v80
v_add_u32 v81, 32768, v81
s_waitcnt lgkmcnt(0)
s_barrier
s_add_u32 m0, s38, 65536
s_add_u32 s39, s60, 1605632
buffer_load_dwordx4 v84, s[8:11], s39 offen lds
s_add_u32 m0, s38, 66560
s_add_u32 s39, s60, 1662976
buffer_load_dwordx4 v84, s[8:11], s39 offen lds
s_add_u32 m0, s38, 67584
s_add_u32 s39, s60, 1720320
buffer_load_dwordx4 v84, s[8:11], s39 offen lds
s_add_u32 m0, s38, 68608
s_add_u32 s39, s60, 1777664
buffer_load_dwordx4 v84, s[8:11], s39 offen lds
s_add_u32 m0, s38, 81920
s_add_u32 s39, s60, 1605632
buffer_load_dwordx4 v84, s[84:87], s39 offen lds
s_add_u32 m0, s38, 82944
s_add_u32 s39, s60, 1662976
buffer_load_dwordx4 v84, s[84:87], s39 offen lds
s_add_u32 m0, s38, 83968
s_add_u32 s39, s60, 1720320
buffer_load_dwordx4 v84, s[84:87], s39 offen lds
s_add_u32 m0, s38, 84992
s_add_u32 s39, s60, 1777664
buffer_load_dwordx4 v84, s[84:87], s39 offen lds
s_waitcnt vmcnt(32)
s_barrier
ds_read_b64_tr_b16 a[12:13], v80 offset:0
ds_read_b64_tr_b16 a[14:15], v80 offset:512
ds_read_b64_tr_b16 a[44:45], v80 offset:4096
ds_read_b64_tr_b16 a[46:47], v80 offset:4608
ds_read_b64_tr_b16 a[76:77], v80 offset:8192
ds_read_b64_tr_b16 a[78:79], v80 offset:8704
ds_read_b64_tr_b16 a[108:109], v80 offset:12288
ds_read_b64_tr_b16 a[110:111], v80 offset:12800
ds_read_b64_tr_b16 a[140:141], v81 offset:0
ds_read_b64_tr_b16 a[142:143], v81 offset:512
ds_read_b64_tr_b16 a[172:173], v81 offset:4096
ds_read_b64_tr_b16 a[174:175], v81 offset:4608
ds_read_b64_tr_b16 a[204:205], v81 offset:8192
ds_read_b64_tr_b16 a[206:207], v81 offset:8704
ds_read_b64_tr_b16 a[236:237], v81 offset:12288
ds_read_b64_tr_b16 a[238:239], v81 offset:12800
v_add_u32 v80, 32768, v80
v_add_u32 v81, 32768, v81
s_waitcnt lgkmcnt(0)
s_barrier
s_waitcnt vmcnt(24)
s_barrier
ds_read_b64_tr_b16 a[16:17], v80 offset:0
ds_read_b64_tr_b16 a[18:19], v80 offset:512
ds_read_b64_tr_b16 a[48:49], v80 offset:4096
ds_read_b64_tr_b16 a[50:51], v80 offset:4608
ds_read_b64_tr_b16 a[80:81], v80 offset:8192
ds_read_b64_tr_b16 a[82:83], v80 offset:8704
ds_read_b64_tr_b16 a[112:113], v80 offset:12288
ds_read_b64_tr_b16 a[114:115], v80 offset:12800
ds_read_b64_tr_b16 a[144:145], v81 offset:0
ds_read_b64_tr_b16 a[146:147], v81 offset:512
ds_read_b64_tr_b16 a[176:177], v81 offset:4096
ds_read_b64_tr_b16 a[178:179], v81 offset:4608
ds_read_b64_tr_b16 a[208:209], v81 offset:8192
ds_read_b64_tr_b16 a[210:211], v81 offset:8704
ds_read_b64_tr_b16 a[240:241], v81 offset:12288
ds_read_b64_tr_b16 a[242:243], v81 offset:12800
v_add_u32 v80, -131072, v80
v_add_u32 v81, -131072, v81
s_waitcnt lgkmcnt(0)
s_barrier
s_waitcnt vmcnt(16)
s_barrier
ds_read_b64_tr_b16 a[20:21], v80 offset:0
ds_read_b64_tr_b16 a[22:23], v80 offset:512
ds_read_b64_tr_b16 a[52:53], v80 offset:4096
ds_read_b64_tr_b16 a[54:55], v80 offset:4608
ds_read_b64_tr_b16 a[84:85], v80 offset:8192
ds_read_b64_tr_b16 a[86:87], v80 offset:8704
ds_read_b64_tr_b16 a[116:117], v80 offset:12288
ds_read_b64_tr_b16 a[118:119], v80 offset:12800
ds_read_b64_tr_b16 a[148:149], v81 offset:0
ds_read_b64_tr_b16 a[150:151], v81 offset:512
ds_read_b64_tr_b16 a[180:181], v81 offset:4096
ds_read_b64_tr_b16 a[182:183], v81 offset:4608
ds_read_b64_tr_b16 a[212:213], v81 offset:8192
ds_read_b64_tr_b16 a[214:215], v81 offset:8704
ds_read_b64_tr_b16 a[244:245], v81 offset:12288
ds_read_b64_tr_b16 a[246:247], v81 offset:12800
v_add_u32 v80, 32768, v80
v_add_u32 v81, 32768, v81
s_waitcnt lgkmcnt(0)
s_barrier
s_waitcnt vmcnt(8)
s_barrier
ds_read_b64_tr_b16 a[24:25], v80 offset:0
ds_read_b64_tr_b16 a[26:27], v80 offset:512
ds_read_b64_tr_b16 a[56:57], v80 offset:4096
ds_read_b64_tr_b16 a[58:59], v80 offset:4608
ds_read_b64_tr_b16 a[88:89], v80 offset:8192
ds_read_b64_tr_b16 a[90:91], v80 offset:8704
ds_read_b64_tr_b16 a[120:121], v80 offset:12288
ds_read_b64_tr_b16 a[122:123], v80 offset:12800
ds_read_b64_tr_b16 a[152:153], v81 offset:0
ds_read_b64_tr_b16 a[154:155], v81 offset:512
ds_read_b64_tr_b16 a[184:185], v81 offset:4096
ds_read_b64_tr_b16 a[186:187], v81 offset:4608
ds_read_b64_tr_b16 a[216:217], v81 offset:8192
ds_read_b64_tr_b16 a[218:219], v81 offset:8704
ds_read_b64_tr_b16 a[248:249], v81 offset:12288
ds_read_b64_tr_b16 a[250:251], v81 offset:12800
v_add_u32 v80, 32768, v80
v_add_u32 v81, 32768, v81
s_waitcnt lgkmcnt(0)
s_barrier
s_waitcnt vmcnt(0)
s_barrier
ds_read_b64_tr_b16 a[28:29], v80 offset:0
ds_read_b64_tr_b16 a[30:31], v80 offset:512
ds_read_b64_tr_b16 a[60:61], v80 offset:4096
ds_read_b64_tr_b16 a[62:63], v80 offset:4608
ds_read_b64_tr_b16 a[92:93], v80 offset:8192
ds_read_b64_tr_b16 a[94:95], v80 offset:8704
ds_read_b64_tr_b16 a[124:125], v80 offset:12288
ds_read_b64_tr_b16 a[126:127], v80 offset:12800
ds_read_b64_tr_b16 a[156:157], v81 offset:0
ds_read_b64_tr_b16 a[158:159], v81 offset:512
ds_read_b64_tr_b16 a[188:189], v81 offset:4096
ds_read_b64_tr_b16 a[190:191], v81 offset:4608
ds_read_b64_tr_b16 a[220:221], v81 offset:8192
ds_read_b64_tr_b16 a[222:223], v81 offset:8704
ds_read_b64_tr_b16 a[252:253], v81 offset:12288
ds_read_b64_tr_b16 a[254:255], v81 offset:12800
v_add_u32 v80, 32768, v80
v_add_u32 v81, 32768, v81
s_waitcnt lgkmcnt(0)
s_barrier
s_lshr_b32 s26, s44, 3
s_and_b32 s62, s44, 7
s_lshl_b32 s60, s26, 20
s_lshl_b32 s38, s62, 8
s_add_u32 s60, s60, s38
s_add_u32 s61, s60, 128
s_lshr_b32 s52, s32, 1
s_lshl_b32 s52, s52, 14
s_and_b32 s53, s32, 1
s_lshl_b32 s53, s53, 6
s_add_u32 s52, s52, s53
v_bfe_u32 v84, v9, 2, 2
v_lshrrev_b32 v85, 4, v9
v_lshl_add_u32 v84, v85, 3, v84
v_lshl_add_u32 v84, v84, 7, s52
v_and_b32 v85, 3, v9
v_lshl_add_u32 v84, v85, 4, v84
v_add_u32 v80, 0, v84
v_bfe_u32 v84, v9, 2, 2
v_lshrrev_b32 v85, 4, v9
v_lshl_add_u32 v84, v85, 3, v84
v_lshl_add_u32 v84, v84, 7, s52
v_and_b32 v85, 3, v9
v_lshl_add_u32 v84, v85, 4, v84
v_add_u32 v81, 8, v84
v_lshrrev_b32 v84, 3, v9
s_mul_i32 s38, s32, 128
v_add_u32 v84, s38, v84
v_mul_u32_u24 v84, 2048, v84
v_and_b32 v85, 7, v9
v_lshl_add_u32 v84, v85, 4, v84
s_lshl_b32 s38, s32, 12
s_barrier
s_add_u32 m0, s38, 0
s_add_u32 s39, s60, 0
buffer_load_dwordx4 v84, s[88:91], s39 offen lds
s_add_u32 m0, s38, 1024
s_add_u32 s39, s60, 16384
buffer_load_dwordx4 v84, s[88:91], s39 offen lds
s_add_u32 m0, s38, 2048
s_add_u32 s39, s60, 32768
buffer_load_dwordx4 v84, s[88:91], s39 offen lds
s_add_u32 m0, s38, 3072
s_add_u32 s39, s60, 49152
buffer_load_dwordx4 v84, s[88:91], s39 offen lds
s_add_u32 m0, s38, 16384
s_add_u32 s39, s61, 0
buffer_load_dwordx4 v84, s[88:91], s39 offen lds
s_add_u32 m0, s38, 17408
s_add_u32 s39, s61, 16384
buffer_load_dwordx4 v84, s[88:91], s39 offen lds
s_add_u32 m0, s38, 18432
s_add_u32 s39, s61, 32768
buffer_load_dwordx4 v84, s[88:91], s39 offen lds
s_add_u32 m0, s38, 19456
s_add_u32 s39, s61, 49152
buffer_load_dwordx4 v84, s[88:91], s39 offen lds
s_add_u32 m0, s38, 32768
s_add_u32 s39, s60, 65536
buffer_load_dwordx4 v84, s[88:91], s39 offen lds
s_add_u32 m0, s38, 33792
s_add_u32 s39, s60, 81920
buffer_load_dwordx4 v84, s[88:91], s39 offen lds
s_add_u32 m0, s38, 34816
s_add_u32 s39, s60, 98304
buffer_load_dwordx4 v84, s[88:91], s39 offen lds
s_add_u32 m0, s38, 35840
s_add_u32 s39, s60, 114688
buffer_load_dwordx4 v84, s[88:91], s39 offen lds
s_add_u32 m0, s38, 49152
s_add_u32 s39, s61, 65536
buffer_load_dwordx4 v84, s[88:91], s39 offen lds
s_add_u32 m0, s38, 50176
s_add_u32 s39, s61, 81920
buffer_load_dwordx4 v84, s[88:91], s39 offen lds
s_add_u32 m0, s38, 51200
s_add_u32 s39, s61, 98304
buffer_load_dwordx4 v84, s[88:91], s39 offen lds
s_add_u32 m0, s38, 52224
s_add_u32 s39, s61, 114688
buffer_load_dwordx4 v84, s[88:91], s39 offen lds
s_add_u32 m0, s38, 65536
s_add_u32 s39, s60, 131072
buffer_load_dwordx4 v84, s[88:91], s39 offen lds
s_add_u32 m0, s38, 66560
s_add_u32 s39, s60, 147456
buffer_load_dwordx4 v84, s[88:91], s39 offen lds
s_add_u32 m0, s38, 67584
s_add_u32 s39, s60, 163840
buffer_load_dwordx4 v84, s[88:91], s39 offen lds
s_add_u32 m0, s38, 68608
s_add_u32 s39, s60, 180224
buffer_load_dwordx4 v84, s[88:91], s39 offen lds
s_add_u32 m0, s38, 81920
s_add_u32 s39, s61, 131072
buffer_load_dwordx4 v84, s[88:91], s39 offen lds
s_add_u32 m0, s38, 82944
s_add_u32 s39, s61, 147456
buffer_load_dwordx4 v84, s[88:91], s39 offen lds
s_add_u32 m0, s38, 83968
s_add_u32 s39, s61, 163840
buffer_load_dwordx4 v84, s[88:91], s39 offen lds
s_add_u32 m0, s38, 84992
s_add_u32 s39, s61, 180224
buffer_load_dwordx4 v84, s[88:91], s39 offen lds
s_add_u32 m0, s38, 98304
s_add_u32 s39, s60, 196608
buffer_load_dwordx4 v84, s[88:91], s39 offen lds
s_add_u32 m0, s38, 99328
s_add_u32 s39, s60, 212992
buffer_load_dwordx4 v84, s[88:91], s39 offen lds
s_add_u32 m0, s38, 100352
s_add_u32 s39, s60, 229376
buffer_load_dwordx4 v84, s[88:91], s39 offen lds
s_add_u32 m0, s38, 101376
s_add_u32 s39, s60, 245760
buffer_load_dwordx4 v84, s[88:91], s39 offen lds
s_add_u32 m0, s38, 114688
s_add_u32 s39, s61, 196608
buffer_load_dwordx4 v84, s[88:91], s39 offen lds
s_add_u32 m0, s38, 115712
s_add_u32 s39, s61, 212992
buffer_load_dwordx4 v84, s[88:91], s39 offen lds
s_add_u32 m0, s38, 116736
s_add_u32 s39, s61, 229376
buffer_load_dwordx4 v84, s[88:91], s39 offen lds
s_add_u32 m0, s38, 117760
s_add_u32 s39, s61, 245760
buffer_load_dwordx4 v84, s[88:91], s39 offen lds
s_waitcnt vmcnt(24)
s_barrier
ds_read_b64_tr_b16 v[128:129], v80 offset:0
ds_read_b64_tr_b16 v[130:131], v80 offset:512
ds_read_b64_tr_b16 v[144:145], v80 offset:4096
ds_read_b64_tr_b16 v[146:147], v80 offset:4608
ds_read_b64_tr_b16 v[160:161], v80 offset:8192
ds_read_b64_tr_b16 v[162:163], v80 offset:8704
ds_read_b64_tr_b16 v[176:177], v80 offset:12288
ds_read_b64_tr_b16 v[178:179], v80 offset:12800
ds_read_b64_tr_b16 v[192:193], v81 offset:0
ds_read_b64_tr_b16 v[194:195], v81 offset:512
ds_read_b64_tr_b16 v[208:209], v81 offset:4096
ds_read_b64_tr_b16 v[210:211], v81 offset:4608
ds_read_b64_tr_b16 v[224:225], v81 offset:8192
ds_read_b64_tr_b16 v[226:227], v81 offset:8704
ds_read_b64_tr_b16 v[240:241], v81 offset:12288
ds_read_b64_tr_b16 v[242:243], v81 offset:12800
v_add_u32 v80, 32768, v80
v_add_u32 v81, 32768, v81
s_waitcnt lgkmcnt(0)
s_barrier
s_waitcnt vmcnt(16)
s_barrier
ds_read_b64_tr_b16 v[132:133], v80 offset:0
ds_read_b64_tr_b16 v[134:135], v80 offset:512
ds_read_b64_tr_b16 v[148:149], v80 offset:4096
ds_read_b64_tr_b16 v[150:151], v80 offset:4608
ds_read_b64_tr_b16 v[164:165], v80 offset:8192
ds_read_b64_tr_b16 v[166:167], v80 offset:8704
ds_read_b64_tr_b16 v[180:181], v80 offset:12288
ds_read_b64_tr_b16 v[182:183], v80 offset:12800
ds_read_b64_tr_b16 v[196:197], v81 offset:0
ds_read_b64_tr_b16 v[198:199], v81 offset:512
ds_read_b64_tr_b16 v[212:213], v81 offset:4096
ds_read_b64_tr_b16 v[214:215], v81 offset:4608
ds_read_b64_tr_b16 v[228:229], v81 offset:8192
ds_read_b64_tr_b16 v[230:231], v81 offset:8704
ds_read_b64_tr_b16 v[244:245], v81 offset:12288
ds_read_b64_tr_b16 v[246:247], v81 offset:12800
v_add_u32 v80, 32768, v80
v_add_u32 v81, 32768, v81
s_waitcnt lgkmcnt(0)
s_barrier
s_waitcnt vmcnt(8)
s_barrier
ds_read_b64_tr_b16 v[136:137], v80 offset:0
ds_read_b64_tr_b16 v[138:139], v80 offset:512
ds_read_b64_tr_b16 v[152:153], v80 offset:4096
ds_read_b64_tr_b16 v[154:155], v80 offset:4608
ds_read_b64_tr_b16 v[168:169], v80 offset:8192
ds_read_b64_tr_b16 v[170:171], v80 offset:8704
ds_read_b64_tr_b16 v[184:185], v80 offset:12288
ds_read_b64_tr_b16 v[186:187], v80 offset:12800
ds_read_b64_tr_b16 v[200:201], v81 offset:0
ds_read_b64_tr_b16 v[202:203], v81 offset:512
ds_read_b64_tr_b16 v[216:217], v81 offset:4096
ds_read_b64_tr_b16 v[218:219], v81 offset:4608
ds_read_b64_tr_b16 v[232:233], v81 offset:8192
ds_read_b64_tr_b16 v[234:235], v81 offset:8704
ds_read_b64_tr_b16 v[248:249], v81 offset:12288
ds_read_b64_tr_b16 v[250:251], v81 offset:12800
v_add_u32 v80, 32768, v80
v_add_u32 v81, 32768, v81
s_waitcnt lgkmcnt(0)
s_barrier
s_waitcnt vmcnt(0)
s_barrier
ds_read_b64_tr_b16 v[140:141], v80 offset:0
ds_read_b64_tr_b16 v[142:143], v80 offset:512
ds_read_b64_tr_b16 v[156:157], v80 offset:4096
ds_read_b64_tr_b16 v[158:159], v80 offset:4608
ds_read_b64_tr_b16 v[172:173], v80 offset:8192
ds_read_b64_tr_b16 v[174:175], v80 offset:8704
ds_read_b64_tr_b16 v[188:189], v80 offset:12288
ds_read_b64_tr_b16 v[190:191], v80 offset:12800
ds_read_b64_tr_b16 v[204:205], v81 offset:0
ds_read_b64_tr_b16 v[206:207], v81 offset:512
ds_read_b64_tr_b16 v[220:221], v81 offset:4096
ds_read_b64_tr_b16 v[222:223], v81 offset:4608
ds_read_b64_tr_b16 v[236:237], v81 offset:8192
ds_read_b64_tr_b16 v[238:239], v81 offset:8704
ds_read_b64_tr_b16 v[252:253], v81 offset:12288
ds_read_b64_tr_b16 v[254:255], v81 offset:12800
v_add_u32 v80, -98304, v80
v_add_u32 v81, -98304, v81
s_waitcnt lgkmcnt(0)
s_barrier
s_mul_i32 s50, s32, 4096
v_lshlrev_b32 v1, 4, v9
v_add_u32 v0, s50, v1
s_mov_b32 s60, s50
v_add_u32 v11, 0x20000, v1
v_mov_b32 v7, v1
v_min_u32 v2, 3, v9
v_lshlrev_b32 v2, 7, v2
v_min_u32 v12, 7, v9
v_lshlrev_b32 v12, 7, v12
s_lshl_b32 s61, s26, 10
s_add_u32 s61, s61, 3416064
s_lshl_b32 s38, s44, 1
s_lshr_b32 s39, s32, 1
s_add_u32 s38, s38, s39
s_lshl_b32 s38, s38, 11
s_and_b32 s39, s32, 1
s_lshl_b32 s39, s39, 9
s_add_u32 s38, s38, s39
v_and_b32 v80, 15, v9
v_lshl_add_u32 v6, v80, 4, s38
v_bfe_u32 v80, v9, 4, 1
v_lshl_add_u32 v6, v80, 10, v6
v_lshrrev_b32 v80, 5, v9
v_lshl_add_u32 v6, v80, 8, v6
s_mov_b32 s49, 100663296
s_mov_b32 s54, 16777216
s_lshl_b32 s59, s26, 15
s_add_u32 s59, s59, 99975168
s_lshl_b32 s38, s62, 2
s_add_u32 s38, s38, s32
s_lshl_b32 s38, s38, 11
s_lshl_b32 s62, s26, 22
s_add_u32 s62, s62, s38
s_add_u32 s62, s62, 134021120
s_mov_b32 s64, 0xbfb8aa3b
v_mov_b32 v100, 0
v_mov_b32 v101, 0
s_mov_b32 s36, 0
Lfw_605:
s_add_u32 s48, s36, 0
s_and_b32 s47, s48, 1
s_lshl_b32 s47, s47, 9
s_add_u32 s47, s47, 3423232
s_add_u32 s48, s48, 1
Lbw_610:
buffer_load_dword v3, v2, s[4:7], s47 offen sc1
s_waitcnt vmcnt(0)
v_cmp_gt_u32 vcc, s48, v3
s_cbranch_vccz Lbo_611
s_sub_u32 s37, s37, 1
s_cbranch_scc1 Lend_7
s_sleep 4
s_branch Lbw_610
Lbo_611:
s_add_u32 m0, s50, 0
s_add_u32 s39, s54, 0
buffer_load_dwordx4 v0, s[4:7], s39 offen offset:0 sc1 lds
buffer_load_dwordx4 v0, s[4:7], s39 offen offset:2048 sc1 lds
s_add_u32 m0, s50, 16384
s_add_u32 s39, s54, 16384
buffer_load_dwordx4 v0, s[4:7], s39 offen offset:0 sc1 lds
buffer_load_dwordx4 v0, s[4:7], s39 offen offset:2048 sc1 lds
s_add_u32 m0, s50, 32768
s_add_u32 s39, s54, 32768
buffer_load_dwordx4 v0, s[4:7], s39 offen offset:0 sc1 lds
buffer_load_dwordx4 v0, s[4:7], s39 offen offset:2048 sc1 lds
s_add_u32 m0, s50, 49152
s_add_u32 s39, s54, 49152
buffer_load_dwordx4 v0, s[4:7], s39 offen offset:0 sc1 lds
buffer_load_dwordx4 v0, s[4:7], s39 offen offset:2048 sc1 lds
s_add_u32 s48, s36, 1
s_and_b32 s47, s48, 1
s_lshl_b32 s47, s47, 9
s_add_u32 s47, s47, 3423232
s_add_u32 s48, s48, 1
buffer_load_dword v3, v2, s[4:7], s47 offen sc1
buffer_load_dword v13, v12, s[4:7], s61 offen sc1
s_add_u32 m0, s50, 0
s_add_u32 s39, s54, 0
buffer_load_dwordx4 v0, s[4:7], s39 offen offset:1024 sc1 lds
buffer_load_dwordx4 v0, s[4:7], s39 offen offset:3072 sc1 lds
s_add_u32 m0, s50, 16384
s_add_u32 s39, s54, 16384
buffer_load_dwordx4 v0, s[4:7], s39 offen offset:1024 sc1 lds
buffer_load_dwordx4 v0, s[4:7], s39 offen offset:3072 sc1 lds
s_add_u32 m0, s50, 32768
s_add_u32 s39, s54, 32768
buffer_load_dwordx4 v0, s[4:7], s39 offen offset:1024 sc1 lds
buffer_load_dwordx4 v0, s[4:7], s39 offen offset:3072 sc1 lds
s_add_u32 m0, s50, 49152
s_add_u32 s39, s54, 49152
buffer_load_dwordx4 v0, s[4:7], s39 offen offset:1024 sc1 lds
buffer_load_dwordx4 v0, s[4:7], s39 offen offset:3072 sc1 lds
s_mov_b32 s58, 0x70000000
s_waitcnt vmcnt(8)
s_barrier
ds_read_b128 v[16:19], v1 offset:0
ds_read_b128 v[20:23], v1 offset:2048
ds_read_b128 v[24:27], v1 offset:4096
ds_read_b128 v[28:31], v1 offset:6144
ds_read_b128 v[32:35], v1 offset:8192
ds_read_b128 v[36:39], v1 offset:10240
ds_read_b128 v[40:43], v1 offset:12288
Lfb_604:
s_waitcnt lgkmcnt(5)
v_mfma_f32_16x16x32_bf16 v[48:51], a[0:3], v[16:19], 0
s_add_u32 s54, s54, 65536
ds_read_b128 v[44:47], v1 offset:14336
s_xor_b32 s50, s50, 0x10000
v_mfma_f32_16x16x32_bf16 v[56:59], a[128:131], v[16:19], 0
s_sub_u32 s57, s36, 2
s_max_i32 s57, s57, 0
v_cmp_gt_u32 vcc, s48, v3
v_mfma_f32_16x16x32_bf16 v[48:51], a[4:7], v[20:23], v[48:51]
ds_read_b128 v[16:19], v1 offset:16384
v_mfma_f32_16x16x32_bf16 v[56:59], a[132:135], v[20:23], v[56:59]
s_waitcnt lgkmcnt(5)
s_cmp_eq_u64 vcc, 0
s_cselect_b32 s46, 1, 0
v_mfma_f32_16x16x32_bf16 v[48:51], a[8:11], v[24:27], v[48:51]
s_cselect_b32 s45, s54, 0x70000000
ds_read_b128 v[20:23], v1 offset:18432
v_cmp_gt_u32 vcc, s57, v13
v_mfma_f32_16x16x32_bf16 v[56:59], a[136:139], v[24:27], v[56:59]
v_mfma_f32_16x16x32_bf16 v[48:51], a[12:15], v[28:31], v[48:51]
s_cmp_eq_u64 vcc, 0
ds_read_b128 v[24:27], v1 offset:20480
s_cselect_b32 s56, 1, 0
v_mfma_f32_16x16x32_bf16 v[56:59], a[140:143], v[28:31], v[56:59]
s_waitcnt lgkmcnt(5)
s_cselect_b32 s55, s59, 0x70000000
s_add_u32 m0, s60, 131072
v_mfma_f32_16x16x32_bf16 v[48:51], a[16:19], v[32:35], v[48:51]
s_add_u32 s39, s55, 0
ds_read_b128 v[28:31], v1 offset:22528
buffer_load_dwordx4 v0, s[4:7], s39 offen offset:0 sc1 lds
v_mfma_f32_16x16x32_bf16 v[56:59], a[144:147], v[32:35], v[56:59]
v_mfma_f32_16x16x32_bf16 v[48:51], a[20:23], v[36:39], v[48:51]
ds_read_b128 v[32:35], v1 offset:24576
v_cvt_pk_bf16_f32 v80, v64, v65
v_mfma_f32_16x16x32_bf16 v[56:59], a[148:151], v[36:39], v[56:59]
s_waitcnt lgkmcnt(5)
v_cvt_pk_bf16_f32 v81, v66, v67
v_cvt_pk_bf16_f32 v82, v68, v69
v_mfma_f32_16x16x32_bf16 v[48:51], a[24:27], v[40:43], v[48:51]
ds_read_b128 v[36:39], v1 offset:26624
v_cvt_pk_bf16_f32 v83, v70, v71
v_mfma_f32_16x16x32_bf16 v[56:59], a[152:155], v[40:43], v[56:59]
buffer_load_dwordx4 v0, s[4:7], s39 offen offset:1024 sc1 lds
v_cvt_pk_bf16_f32 v84, v72, v73
v_mfma_f32_16x16x32_bf16 v[48:51], a[28:31], v[44:47], v[48:51]
ds_read_b128 v[40:43], v1 offset:28672
v_cvt_pk_bf16_f32 v85, v74, v75
v_mfma_f32_16x16x32_bf16 v[56:59], a[156:159], v[44:47], v[56:59]
s_waitcnt lgkmcnt(5)
v_cvt_pk_bf16_f32 v86, v76, v77
v_cvt_pk_bf16_f32 v87, v78, v79
v_mfma_f32_16x16x32_bf16 v[48:51], a[32:35], v[16:19], v[48:51]
ds_read_b128 v[44:47], v1 offset:30720
v_mfma_f32_16x16x32_bf16 v[56:59], a[160:163], v[16:19], v[56:59]
v_mfma_f32_16x16x32_bf16 v[48:51], a[36:39], v[20:23], v[48:51]
ds_read_b128 v[16:19], v1 offset:32768
buffer_load_dwordx4 v0, s[4:7], s39 offen offset:2048 sc1 lds
v_mfma_f32_16x16x32_bf16 v[56:59], a[164:167], v[20:23], v[56:59]
s_waitcnt lgkmcnt(5)
v_mfma_f32_16x16x32_bf16 v[48:51], a[40:43], v[24:27], v[48:51]
ds_read_b128 v[20:23], v1 offset:34816
v_mfma_f32_16x16x32_bf16 v[56:59], a[168:171], v[24:27], v[56:59]
v_mfma_f32_16x16x32_bf16 v[48:51], a[44:47], v[28:31], v[48:51]
ds_read_b128 v[24:27], v1 offset:36864
v_mfma_f32_16x16x32_bf16 v[56:59], a[172:175], v[28:31], v[56:59]
s_waitcnt lgkmcnt(5)
buffer_load_dwordx4 v0, s[4:7], s39 offen offset:3072 sc1 lds
v_mfma_f32_16x16x32_bf16 v[48:51], a[48:51], v[32:35], v[48:51]
ds_read_b128 v[28:31], v1 offset:38912
v_mfma_f32_16x16x32_bf16 v[56:59], a[176:179], v[32:35], v[56:59]
v_mfma_f32_16x16x32_bf16 v[48:51], a[52:55], v[36:39], v[48:51]
ds_read_b128 v[32:35], v1 offset:40960
v_mfma_f32_16x16x32_bf16 v[56:59], a[180:183], v[36:39], v[56:59]
s_waitcnt lgkmcnt(5)
v_mfma_f32_16x16x32_bf16 v[48:51], a[56:59], v[40:43], v[48:51]
s_add_u32 m0, s60, 147456
ds_read_b128 v[36:39], v1 offset:43008
s_add_u32 s39, s55, 16384
v_mfma_f32_16x16x32_bf16 v[56:59], a[184:187], v[40:43], v[56:59]
buffer_load_dwordx4 v0, s[4:7], s39 offen offset:0 sc1 lds
v_mfma_f32_16x16x32_bf16 v[48:51], a[60:63], v[44:47], v[48:51]
ds_read_b128 v[40:43], v1 offset:45056
v_mfma_f32_16x16x32_bf16 v[56:59], a[188:191], v[44:47], v[56:59]
s_waitcnt lgkmcnt(5)
v_mfma_f32_16x16x32_bf16 v[48:51], a[64:67], v[16:19], v[48:51]
ds_read_b128 v[44:47], v1 offset:47104
v_mfma_f32_16x16x32_bf16 v[56:59], a[192:195], v[16:19], v[56:59]
v_mfma_f32_16x16x32_bf16 v[48:51], a[68:71], v[20:23], v[48:51]
ds_read_b128 v[16:19], v1 offset:49152
buffer_load_dwordx4 v0, s[4:7], s39 offen offset:1024 sc1 lds
v_mfma_f32_16x16x32_bf16 v[56:59], a[196:199], v[20:23], v[56:59]
s_waitcnt lgkmcnt(5)
v_mfma_f32_16x16x32_bf16 v[48:51], a[72:75], v[24:27], v[48:51]
ds_read_b128 v[20:23], v1 offset:51200
v_mfma_f32_16x16x32_bf16 v[56:59], a[200:203], v[24:27], v[56:59]
v_mfma_f32_16x16x32_bf16 v[48:51], a[76:79], v[28:31], v[48:51]
ds_read_b128 v[24:27], v1 offset:53248
v_mfma_f32_16x16x32_bf16 v[56:59], a[204:207], v[28:31], v[56:59]
s_waitcnt lgkmcnt(5)
buffer_load_dwordx4 v0, s[4:7], s39 offen offset:2048 sc1 lds
v_mfma_f32_16x16x32_bf16 v[48:51], a[80:83], v[32:35], v[48:51]
ds_read_b128 v[28:31], v1 offset:55296
v_mfma_f32_16x16x32_bf16 v[56:59], a[208:211], v[32:35], v[56:59]
v_mfma_f32_16x16x32_bf16 v[48:51], a[84:87], v[36:39], v[48:51]
ds_read_b128 v[32:35], v1 offset:57344
v_mfma_f32_16x16x32_bf16 v[56:59], a[212:215], v[36:39], v[56:59]
s_waitcnt lgkmcnt(5)
v_mfma_f32_16x16x32_bf16 v[48:51], a[88:91], v[40:43], v[48:51]
ds_read_b128 v[36:39], v1 offset:59392
buffer_load_dwordx4 v0, s[4:7], s39 offen offset:3072 sc1 lds
v_mfma_f32_16x16x32_bf16 v[56:59], a[216:219], v[40:43], v[56:59]
v_mfma_f32_16x16x32_bf16 v[48:51], a[92:95], v[44:47], v[48:51]
ds_read_b128 v[40:43], v1 offset:61440
v_mfma_f32_16x16x32_bf16 v[56:59], a[220:223], v[44:47], v[56:59]
s_waitcnt lgkmcnt(5)
v_mfma_f32_16x16x32_bf16 v[48:51], a[96:99], v[16:19], v[48:51]
ds_read_b128 v[44:47], v1 offset:63488
v_mfma_f32_16x16x32_bf16 v[56:59], a[224:227], v[16:19], v[56:59]
v_mfma_f32_16x16x32_bf16 v[48:51], a[100:103], v[20:23], v[48:51]
s_waitcnt vmcnt(8)
s_barrier
ds_read_b128 v[16:19], v1 offset:1024
v_mfma_f32_16x16x32_bf16 v[56:59], a[228:231], v[20:23], v[56:59]
s_waitcnt lgkmcnt(5)
v_min_u32 v100, s36, 64
s_sub_u32 s38, s36, 4
v_mfma_f32_16x16x32_bf16 v[48:51], a[104:107], v[24:27], v[48:51]
ds_read_b128 v[20:23], v1 offset:3072
v_max_i32 v101, s38, 0
v_mfma_f32_16x16x32_bf16 v[56:59], a[232:235], v[24:27], v[56:59]
buffer_store_dwordx2 v[100:101], v4, s[4:7], 0 offen sc1
v_mfma_f32_16x16x32_bf16 v[48:51], a[108:111], v[28:31], v[48:51]
ds_read_b128 v[24:27], v1 offset:5120
v_mfma_f32_16x16x32_bf16 v[56:59], a[236:239], v[28:31], v[56:59]
s_waitcnt lgkmcnt(5)
s_add_u32 m0, s50, 0
s_add_u32 s39, s45, 0
v_mfma_f32_16x16x32_bf16 v[48:51], a[112:115], v[32:35], v[48:51]
ds_read_b128 v[28:31], v1 offset:7168
buffer_load_dwordx4 v0, s[4:7], s39 offen offset:0 sc1 lds
v_mfma_f32_16x16x32_bf16 v[56:59], a[240:243], v[32:35], v[56:59]
v_mfma_f32_16x16x32_bf16 v[48:51], a[116:119], v[36:39], v[48:51]
ds_read_b128 v[32:35], v1 offset:9216
v_mfma_f32_16x16x32_bf16 v[56:59], a[244:247], v[36:39], v[56:59]
s_waitcnt lgkmcnt(5)
v_mfma_f32_16x16x32_bf16 v[48:51], a[120:123], v[40:43], v[48:51]
ds_read_b128 v[36:39], v1 offset:11264
v_mfma_f32_16x16x32_bf16 v[56:59], a[248:251], v[40:43], v[56:59]
buffer_load_dwordx4 v0, s[4:7], s39 offen offset:1024 sc1 lds
v_mfma_f32_16x16x32_bf16 v[48:51], a[124:127], v[44:47], v[48:51]
ds_read_b128 v[40:43], v1 offset:13312
v_mfma_f32_16x16x32_bf16 v[56:59], a[252:255], v[44:47], v[56:59]
s_waitcnt lgkmcnt(5)
v_mfma_f32_16x16x32_bf16 v[52:55], a[0:3], v[16:19], 0
ds_read_b128 v[44:47], v1 offset:15360
v_mfma_f32_16x16x32_bf16 v[60:63], a[128:131], v[16:19], 0
v_mfma_f32_16x16x32_bf16 v[52:55], a[4:7], v[20:23], v[52:55]
ds_read_b128 v[16:19], v1 offset:17408
buffer_load_dwordx4 v0, s[4:7], s39 offen offset:2048 sc1 lds
v_mfma_f32_16x16x32_bf16 v[60:63], a[132:135], v[20:23], v[60:63]
s_waitcnt lgkmcnt(5)
v_mfma_f32_16x16x32_bf16 v[52:55], a[8:11], v[24:27], v[52:55]
ds_read_b128 v[20:23], v1 offset:19456
v_mfma_f32_16x16x32_bf16 v[60:63], a[136:139], v[24:27], v[60:63]
v_mfma_f32_16x16x32_bf16 v[52:55], a[12:15], v[28:31], v[52:55]
ds_read_b128 v[24:27], v1 offset:21504
v_mfma_f32_16x16x32_bf16 v[60:63], a[140:143], v[28:31], v[60:63]
s_waitcnt lgkmcnt(5)
buffer_load_dwordx4 v0, s[4:7], s39 offen offset:3072 sc1 lds
v_mfma_f32_16x16x32_bf16 v[52:55], a[16:19], v[32:35], v[52:55]
ds_read_b128 v[28:31], v1 offset:23552
v_mul_f32 v88, s64, v48
v_mfma_f32_16x16x32_bf16 v[60:63], a[144:147], v[32:35], v[60:63]
v_mul_f32 v89, s64, v49
v_mul_f32 v90, s64, v50
v_mfma_f32_16x16x32_bf16 v[52:55], a[20:23], v[36:39], v[52:55]
ds_read_b128 v[32:35], v1 offset:25600
v_mul_f32 v91, s64, v51
v_mfma_f32_16x16x32_bf16 v[60:63], a[148:151], v[36:39], v[60:63]
s_waitcnt lgkmcnt(5)
v_exp_f32 v88, v88
v_mfma_f32_16x16x32_bf16 v[52:55], a[24:27], v[40:43], v[52:55]
s_add_u32 m0, s50, 16384
ds_read_b128 v[36:39], v1 offset:27648
s_add_u32 s39, s45, 16384
v_mfma_f32_16x16x32_bf16 v[60:63], a[152:155], v[40:43], v[60:63]
buffer_load_dwordx4 v0, s[4:7], s39 offen offset:0 sc1 lds
v_mfma_f32_16x16x32_bf16 v[52:55], a[28:31], v[44:47], v[52:55]
ds_read_b128 v[40:43], v1 offset:29696
v_mfma_f32_16x16x32_bf16 v[60:63], a[156:159], v[44:47], v[60:63]
s_waitcnt lgkmcnt(5)
v_exp_f32 v89, v89
v_mfma_f32_16x16x32_bf16 v[52:55], a[32:35], v[16:19], v[52:55]
ds_read_b128 v[44:47], v1 offset:31744
v_mfma_f32_16x16x32_bf16 v[60:63], a[160:163], v[16:19], v[60:63]
v_exp_f32 v90, v90
v_mfma_f32_16x16x32_bf16 v[52:55], a[36:39], v[20:23], v[52:55]
ds_read_b128 v[16:19], v1 offset:33792
buffer_load_dwordx4 v0, s[4:7], s39 offen offset:1024 sc1 lds
v_mfma_f32_16x16x32_bf16 v[60:63], a[164:167], v[20:23], v[60:63]
s_waitcnt lgkmcnt(5)
v_exp_f32 v91, v91
v_mfma_f32_16x16x32_bf16 v[52:55], a[40:43], v[24:27], v[52:55]
ds_read_b128 v[20:23], v1 offset:35840
v_mul_f32 v104, v48, v56
v_mfma_f32_16x16x32_bf16 v[60:63], a[168:171], v[24:27], v[60:63]
v_mul_f32 v105, v49, v57
v_mul_f32 v106, v50, v58
v_mfma_f32_16x16x32_bf16 v[52:55], a[44:47], v[28:31], v[52:55]
ds_read_b128 v[24:27], v1 offset:37888
v_mul_f32 v107, v51, v59
v_mfma_f32_16x16x32_bf16 v[60:63], a[172:175], v[28:31], v[60:63]
s_waitcnt lgkmcnt(5)
buffer_load_dwordx4 v0, s[4:7], s39 offen offset:2048 sc1 lds
v_add_f32 v88, 1.0, v88
v_mfma_f32_16x16x32_bf16 v[52:55], a[48:51], v[32:35], v[52:55]
ds_read_b128 v[28:31], v1 offset:39936
v_add_f32 v89, 1.0, v89
v_mfma_f32_16x16x32_bf16 v[60:63], a[176:179], v[32:35], v[60:63]
v_add_f32 v90, 1.0, v90
v_add_f32 v91, 1.0, v91
v_mfma_f32_16x16x32_bf16 v[52:55], a[52:55], v[36:39], v[52:55]
ds_read_b128 v[32:35], v1 offset:41984
v_mfma_f32_16x16x32_bf16 v[60:63], a[180:183], v[36:39], v[60:63]
s_waitcnt lgkmcnt(5)
v_rcp_f32 v88, v88
v_mfma_f32_16x16x32_bf16 v[52:55], a[56:59], v[40:43], v[52:55]
ds_read_b128 v[36:39], v1 offset:44032
buffer_load_dwordx4 v0, s[4:7], s39 offen offset:3072 sc1 lds
v_mfma_f32_16x16x32_bf16 v[60:63], a[184:187], v[40:43], v[60:63]
v_rcp_f32 v89, v89
v_mfma_f32_16x16x32_bf16 v[52:55], a[60:63], v[44:47], v[52:55]
ds_read_b128 v[40:43], v1 offset:46080
v_mfma_f32_16x16x32_bf16 v[60:63], a[188:191], v[44:47], v[60:63]
s_waitcnt lgkmcnt(5)
v_rcp_f32 v90, v90
v_mfma_f32_16x16x32_bf16 v[52:55], a[64:67], v[16:19], v[52:55]
ds_read_b128 v[44:47], v1 offset:48128
v_mfma_f32_16x16x32_bf16 v[60:63], a[192:195], v[16:19], v[60:63]
s_add_u32 m0, s50, 32768
s_add_u32 s39, s45, 32768
buffer_load_dwordx4 v0, s[4:7], s39 offen offset:0 sc1 lds
v_mfma_f32_16x16x32_bf16 v[52:55], a[68:71], v[20:23], v[52:55]
ds_read_b128 v[16:19], v1 offset:50176
v_mfma_f32_16x16x32_bf16 v[60:63], a[196:199], v[20:23], v[60:63]
s_waitcnt lgkmcnt(5)
v_rcp_f32 v91, v91
v_mfma_f32_16x16x32_bf16 v[52:55], a[72:75], v[24:27], v[52:55]
ds_read_b128 v[20:23], v1 offset:52224
v_mul_f32 v104, v104, v88
v_mfma_f32_16x16x32_bf16 v[60:63], a[200:203], v[24:27], v[60:63]
v_mul_f32 v105, v105, v89
v_mul_f32 v106, v106, v90
v_mfma_f32_16x16x32_bf16 v[52:55], a[76:79], v[28:31], v[52:55]
ds_read_b128 v[24:27], v1 offset:54272
buffer_load_dwordx4 v0, s[4:7], s39 offen offset:1024 sc1 lds
v_mfma_f32_16x16x32_bf16 v[60:63], a[204:207], v[28:31], v[60:63]
s_waitcnt lgkmcnt(5)
v_mul_f32 v107, v107, v91
v_mfma_f32_16x16x32_bf16 v[52:55], a[80:83], v[32:35], v[52:55]
ds_read_b128 v[28:31], v1 offset:56320
v_mfma_f32_16x16x32_bf16 v[60:63], a[208:211], v[32:35], v[60:63]
v_mfma_f32_16x16x32_bf16 v[52:55], a[84:87], v[36:39], v[52:55]
ds_read_b128 v[32:35], v1 offset:58368
v_mfma_f32_16x16x32_bf16 v[60:63], a[212:215], v[36:39], v[60:63]
s_waitcnt lgkmcnt(5)
buffer_load_dwordx4 v0, s[4:7], s39 offen offset:2048 sc1 lds
v_mfma_f32_16x16x32_bf16 v[52:55], a[88:91], v[40:43], v[52:55]
ds_read_b128 v[36:39], v1 offset:60416
v_mfma_f32_16x16x32_bf16 v[60:63], a[216:219], v[40:43], v[60:63]
v_mfma_f32_16x16x32_bf16 v[52:55], a[92:95], v[44:47], v[52:55]
ds_read_b128 v[40:43], v1 offset:62464
v_mfma_f32_16x16x32_bf16 v[60:63], a[220:223], v[44:47], v[60:63]
s_waitcnt lgkmcnt(5)
v_mfma_f32_16x16x32_bf16 v[52:55], a[96:99], v[16:19], v[52:55]
ds_read_b128 v[44:47], v1 offset:64512
buffer_load_dwordx4 v0, s[4:7], s39 offen offset:3072 sc1 lds
v_mfma_f32_16x16x32_bf16 v[60:63], a[224:227], v[16:19], v[60:63]
v_mfma_f32_16x16x32_bf16 v[52:55], a[100:103], v[20:23], v[52:55]
v_mfma_f32_16x16x32_bf16 v[60:63], a[228:231], v[20:23], v[60:63]
s_waitcnt lgkmcnt(4)
v_mfma_f32_16x16x32_bf16 v[52:55], a[104:107], v[24:27], v[52:55]
v_mfma_f32_16x16x32_bf16 v[60:63], a[232:235], v[24:27], v[60:63]
s_add_u32 m0, s50, 49152
s_add_u32 s39, s45, 49152
buffer_load_dwordx4 v0, s[4:7], s39 offen offset:0 sc1 lds
s_cmp_eq_u32 s56, 0
s_cbranch_scc1 Lfl_606
s_waitcnt vmcnt(14) lgkmcnt(0)
Lfg_607:
s_barrier
v_mfma_f32_16x16x32_bf16 v[52:55], a[108:111], v[28:31], v[52:55]
ds_read_b128 v[16:19], v11 offset:0
ds_read_b128 v[20:23], v11 offset:1024
v_mfma_f32_16x16x32_bf16 v[60:63], a[236:239], v[28:31], v[60:63]
s_add_u32 s48, s36, 2
ds_read_b128 v[24:27], v11 offset:2048
s_and_b32 s47, s48, 1
v_mfma_f32_16x16x32_bf16 v[52:55], a[112:115], v[32:35], v[52:55]
ds_read_b128 v[28:31], v11 offset:3072
buffer_load_dwordx4 v0, s[4:7], s39 offen offset:1024 sc1 lds
v_mfma_f32_16x16x32_bf16 v[60:63], a[240:243], v[32:35], v[60:63]
s_lshl_b32 s47, s47, 9
s_add_u32 s47, s47, 3423232
s_add_u32 s48, s48, 1
v_mfma_f32_16x16x32_bf16 v[52:55], a[116:119], v[36:39], v[52:55]
ds_read_b128 v[32:35], v11 offset:4096
v_xor_b32 v1, 0x10000, v1
v_mfma_f32_16x16x32_bf16 v[60:63], a[244:247], v[36:39], v[60:63]
v_mfma_f32_16x16x32_bf16 v[52:55], a[120:123], v[40:43], v[52:55]
ds_read_b128 v[36:39], v11 offset:5120
buffer_load_dwordx4 v0, s[4:7], s39 offen offset:2048 sc1 lds
v_mfma_f32_16x16x32_bf16 v[60:63], a[248:251], v[40:43], v[60:63]
v_mfma_f32_16x16x32_bf16 v[52:55], a[124:127], v[44:47], v[52:55]
ds_read_b128 v[40:43], v11 offset:6144
v_mfma_f32_16x16x32_bf16 v[60:63], a[252:255], v[44:47], v[60:63]
s_waitcnt lgkmcnt(5)
v_mfma_f32_16x16x32_bf16 v[64:67], v[128:131], v[16:19], 0
ds_read_b128 v[44:47], v11 offset:7168
buffer_load_dwordx4 v0, s[4:7], s39 offen offset:3072 sc1 lds
v_mfma_f32_16x16x32_bf16 v[68:71], v[192:195], v[16:19], 0
v_mfma_f32_16x16x32_bf16 v[72:75], v[128:131], v[20:23], 0
ds_read_b128 v[16:19], v11 offset:8192
v_mfma_f32_16x16x32_bf16 v[76:79], v[192:195], v[20:23], 0
s_waitcnt lgkmcnt(5)
v_mfma_f32_16x16x32_bf16 v[64:67], v[132:135], v[24:27], v[64:67]
ds_read_b128 v[20:23], v11 offset:9216
buffer_load_dword v3, v2, s[4:7], s47 offen sc1
v_mfma_f32_16x16x32_bf16 v[68:71], v[196:199], v[24:27], v[68:71]
v_mfma_f32_16x16x32_bf16 v[72:75], v[132:135], v[28:31], v[72:75]
ds_read_b128 v[24:27], v11 offset:10240
buffer_load_dword v13, v12, s[4:7], s61 offen sc1
v_mfma_f32_16x16x32_bf16 v[76:79], v[196:199], v[28:31], v[76:79]
s_waitcnt lgkmcnt(5)
v_mfma_f32_16x16x32_bf16 v[64:67], v[136:139], v[32:35], v[64:67]
ds_read_b128 v[28:31], v11 offset:11264
v_mul_f32 v88, s64, v52
v_mfma_f32_16x16x32_bf16 v[68:71], v[200:203], v[32:35], v[68:71]
buffer_store_dwordx4 v[80:83], v7, s[4:7], s58 offen offset:0 sc1
v_mfma_f32_16x16x32_bf16 v[72:75], v[136:139], v[36:39], v[72:75]
ds_read_b128 v[32:35], v11 offset:12288
v_mul_f32 v89, s64, v53
v_mfma_f32_16x16x32_bf16 v[76:79], v[200:203], v[36:39], v[76:79]
s_waitcnt lgkmcnt(5)
v_mul_f32 v90, s64, v54
v_mul_f32 v91, s64, v55
v_mfma_f32_16x16x32_bf16 v[64:67], v[140:143], v[40:43], v[64:67]
ds_read_b128 v[36:39], v11 offset:13312
v_mfma_f32_16x16x32_bf16 v[68:71], v[204:207], v[40:43], v[68:71]
buffer_store_dwordx4 v[84:87], v7, s[4:7], s58 offen offset:1024 sc1
v_mfma_f32_16x16x32_bf16 v[72:75], v[140:143], v[44:47], v[72:75]
ds_read_b128 v[40:43], v11 offset:14336
v_mfma_f32_16x16x32_bf16 v[76:79], v[204:207], v[44:47], v[76:79]
s_waitcnt lgkmcnt(5)
v_exp_f32 v88, v88
v_mfma_f32_16x16x32_bf16 v[64:67], v[144:147], v[16:19], v[64:67]
ds_read_b128 v[44:47], v11 offset:15360
v_mfma_f32_16x16x32_bf16 v[68:71], v[208:211], v[16:19], v[68:71]
v_exp_f32 v89, v89
v_mfma_f32_16x16x32_bf16 v[72:75], v[144:147], v[20:23], v[72:75]
ds_read_b128 v[16:19], v11 offset:16384
v_mfma_f32_16x16x32_bf16 v[76:79], v[208:211], v[20:23], v[76:79]
s_waitcnt lgkmcnt(5)
v_exp_f32 v90, v90
v_mfma_f32_16x16x32_bf16 v[64:67], v[148:151], v[24:27], v[64:67]
ds_read_b128 v[20:23], v11 offset:17408
v_mfma_f32_16x16x32_bf16 v[68:71], v[212:215], v[24:27], v[68:71]
v_exp_f32 v91, v91
v_mfma_f32_16x16x32_bf16 v[72:75], v[148:151], v[28:31], v[72:75]
ds_read_b128 v[24:27], v11 offset:18432
v_mul_f32 v108, v52, v60
v_mfma_f32_16x16x32_bf16 v[76:79], v[212:215], v[28:31], v[76:79]
s_waitcnt lgkmcnt(5)
v_mul_f32 v109, v53, v61
v_mul_f32 v110, v54, v62
v_mfma_f32_16x16x32_bf16 v[64:67], v[152:155], v[32:35], v[64:67]
ds_read_b128 v[28:31], v11 offset:19456
v_mul_f32 v111, v55, v63
v_mfma_f32_16x16x32_bf16 v[68:71], v[216:219], v[32:35], v[68:71]
v_add_f32 v88, 1.0, v88
v_add_f32 v89, 1.0, v89
v_mfma_f32_16x16x32_bf16 v[72:75], v[152:155], v[36:39], v[72:75]
ds_read_b128 v[32:35], v11 offset:20480
v_add_f32 v90, 1.0, v90
v_mfma_f32_16x16x32_bf16 v[76:79], v[216:219], v[36:39], v[76:79]
s_waitcnt lgkmcnt(5)
v_add_f32 v91, 1.0, v91
v_mfma_f32_16x16x32_bf16 v[64:67], v[156:159], v[40:43], v[64:67]
ds_read_b128 v[36:39], v11 offset:21504
v_mfma_f32_16x16x32_bf16 v[68:71], v[220:223], v[40:43], v[68:71]
v_rcp_f32 v88, v88
v_mfma_f32_16x16x32_bf16 v[72:75], v[156:159], v[44:47], v[72:75]
ds_read_b128 v[40:43], v11 offset:22528
v_mfma_f32_16x16x32_bf16 v[76:79], v[220:223], v[44:47], v[76:79]
s_waitcnt lgkmcnt(5)
v_rcp_f32 v89, v89
v_mfma_f32_16x16x32_bf16 v[64:67], v[160:163], v[16:19], v[64:67]
ds_read_b128 v[44:47], v11 offset:23552
v_mfma_f32_16x16x32_bf16 v[68:71], v[224:227], v[16:19], v[68:71]
v_rcp_f32 v90, v90
v_mfma_f32_16x16x32_bf16 v[72:75], v[160:163], v[20:23], v[72:75]
ds_read_b128 v[16:19], v11 offset:24576
v_mfma_f32_16x16x32_bf16 v[76:79], v[224:227], v[20:23], v[76:79]
s_waitcnt lgkmcnt(5)
v_rcp_f32 v91, v91
v_mfma_f32_16x16x32_bf16 v[64:67], v[164:167], v[24:27], v[64:67]
ds_read_b128 v[20:23], v11 offset:25600
v_mul_f32 v108, v108, v88
v_mfma_f32_16x16x32_bf16 v[68:71], v[228:231], v[24:27], v[68:71]
v_mul_f32 v109, v109, v89
v_mul_f32 v110, v110, v90
v_mfma_f32_16x16x32_bf16 v[72:75], v[164:167], v[28:31], v[72:75]
ds_read_b128 v[24:27], v11 offset:26624
v_mul_f32 v111, v111, v91
v_mfma_f32_16x16x32_bf16 v[76:79], v[228:231], v[28:31], v[76:79]
s_waitcnt lgkmcnt(5)
v_cvt_pk_bf16_f32 v96, v104, v105
v_cvt_pk_bf16_f32 v97, v106, v107
v_mfma_f32_16x16x32_bf16 v[64:67], v[168:171], v[32:35], v[64:67]
ds_read_b128 v[28:31], v11 offset:27648
v_cvt_pk_bf16_f32 v98, v108, v109
v_mfma_f32_16x16x32_bf16 v[68:71], v[232:235], v[32:35], v[68:71]
v_cvt_pk_bf16_f32 v99, v110, v111
v_mfma_f32_16x16x32_bf16 v[72:75], v[168:171], v[36:39], v[72:75]
ds_read_b128 v[32:35], v11 offset:28672
v_mfma_f32_16x16x32_bf16 v[76:79], v[232:235], v[36:39], v[76:79]
s_waitcnt lgkmcnt(5)
v_permlane16_swap_b32 v96, v98
v_permlane16_swap_b32 v97, v99
v_mfma_f32_16x16x32_bf16 v[64:67], v[172:175], v[40:43], v[64:67]
ds_read_b128 v[36:39], v11 offset:29696
v_mfma_f32_16x16x32_bf16 v[68:71], v[236:239], v[40:43], v[68:71]
buffer_store_dwordx4 v[96:99], v6, s[4:7], s49 offen sc1
v_mfma_f32_16x16x32_bf16 v[72:75], v[172:175], v[44:47], v[72:75]
s_cmp_ge_u32 s36, 3
ds_read_b128 v[40:43], v11 offset:30720
s_cselect_b32 s58, s62, 0x70000000
v_mfma_f32_16x16x32_bf16 v[76:79], v[236:239], v[44:47], v[76:79]
s_waitcnt lgkmcnt(5)
s_add_u32 s49, s49, 229376
s_add_u32 s62, s62, 65536
v_mfma_f32_16x16x32_bf16 v[64:67], v[176:179], v[16:19], v[64:67]
s_add_u32 s59, s59, 229376
ds_read_b128 v[44:47], v11 offset:31744
s_add_u32 s36, s36, 1
v_mfma_f32_16x16x32_bf16 v[68:71], v[240:243], v[16:19], v[68:71]
v_mfma_f32_16x16x32_bf16 v[72:75], v[176:179], v[20:23], v[72:75]
v_mfma_f32_16x16x32_bf16 v[76:79], v[240:243], v[20:23], v[76:79]
s_waitcnt lgkmcnt(4)
v_mfma_f32_16x16x32_bf16 v[64:67], v[180:183], v[24:27], v[64:67]
v_mfma_f32_16x16x32_bf16 v[68:71], v[244:247], v[24:27], v[68:71]
s_cmp_eq_u32 s46, 0
s_cbranch_scc1 Lfs_608
s_waitcnt vmcnt(3) lgkmcnt(0)
s_barrier
v_mfma_f32_16x16x32_bf16 v[72:75], v[180:183], v[28:31], v[72:75]
ds_read_b128 v[16:19], v1 offset:0
ds_read_b128 v[20:23], v1 offset:2048
v_mfma_f32_16x16x32_bf16 v[76:79], v[244:247], v[28:31], v[76:79]
ds_read_b128 v[24:27], v1 offset:4096
v_mfma_f32_16x16x32_bf16 v[64:67], v[184:187], v[32:35], v[64:67]
ds_read_b128 v[28:31], v1 offset:6144
v_mfma_f32_16x16x32_bf16 v[68:71], v[248:251], v[32:35], v[68:71]
v_mfma_f32_16x16x32_bf16 v[72:75], v[184:187], v[36:39], v[72:75]
ds_read_b128 v[32:35], v1 offset:8192
v_mfma_f32_16x16x32_bf16 v[76:79], v[248:251], v[36:39], v[76:79]
v_mfma_f32_16x16x32_bf16 v[64:67], v[188:191], v[40:43], v[64:67]
ds_read_b128 v[36:39], v1 offset:10240
v_mfma_f32_16x16x32_bf16 v[68:71], v[252:255], v[40:43], v[68:71]
v_mfma_f32_16x16x32_bf16 v[72:75], v[188:191], v[44:47], v[72:75]
ds_read_b128 v[40:43], v1 offset:12288
v_mfma_f32_16x16x32_bf16 v[76:79], v[252:255], v[44:47], v[76:79]
s_branch Lfb_604
Lfs_608:
s_waitcnt lgkmcnt(0)
v_mfma_f32_16x16x32_bf16 v[72:75], v[180:183], v[28:31], v[72:75]
v_mfma_f32_16x16x32_bf16 v[76:79], v[244:247], v[28:31], v[76:79]
s_waitcnt lgkmcnt(2)
v_mfma_f32_16x16x32_bf16 v[64:67], v[184:187], v[32:35], v[64:67]
v_mfma_f32_16x16x32_bf16 v[68:71], v[248:251], v[32:35], v[68:71]
v_mfma_f32_16x16x32_bf16 v[72:75], v[184:187], v[36:39], v[72:75]
v_mfma_f32_16x16x32_bf16 v[76:79], v[248:251], v[36:39], v[76:79]
s_waitcnt lgkmcnt(0)
v_mfma_f32_16x16x32_bf16 v[64:67], v[188:191], v[40:43], v[64:67]
v_mfma_f32_16x16x32_bf16 v[68:71], v[252:255], v[40:43], v[68:71]
v_mfma_f32_16x16x32_bf16 v[72:75], v[188:191], v[44:47], v[72:75]
v_mfma_f32_16x16x32_bf16 v[76:79], v[252:255], v[44:47], v[76:79]
s_nop 7
v_cvt_pk_bf16_f32 v80, v64, v65
v_cvt_pk_bf16_f32 v81, v66, v67
v_cvt_pk_bf16_f32 v82, v68, v69
v_cvt_pk_bf16_f32 v83, v70, v71
v_cvt_pk_bf16_f32 v84, v72, v73
v_cvt_pk_bf16_f32 v85, v74, v75
v_cvt_pk_bf16_f32 v86, v76, v77
v_cvt_pk_bf16_f32 v87, v78, v79
s_cmp_eq_u32 s36, 64
s_cbranch_scc1 Lfz_609
buffer_store_dwordx4 v[80:83], v7, s[4:7], s58 offen offset:0 sc1
buffer_store_dwordx4 v[84:87], v7, s[4:7], s58 offen offset:1024 sc1
s_branch Lfw_605
Lfl_606:
Lbw_612:
buffer_load_dword v13, v12, s[4:7], s61 offen sc1
s_waitcnt vmcnt(0)
v_cmp_gt_u32 vcc, s57, v13
s_cbranch_vccz Lbo_613
s_sub_u32 s37, s37, 1
s_cbranch_scc1 Lend_7
s_sleep 2
s_branch Lbw_612
Lbo_613:
s_add_u32 m0, s60, 131072
s_add_u32 s39, s59, 0
buffer_load_dwordx4 v0, s[4:7], s39 offen offset:0 sc1 lds
buffer_load_dwordx4 v0, s[4:7], s39 offen offset:1024 sc1 lds
buffer_load_dwordx4 v0, s[4:7], s39 offen offset:2048 sc1 lds
buffer_load_dwordx4 v0, s[4:7], s39 offen offset:3072 sc1 lds
s_add_u32 m0, s60, 147456
s_add_u32 s39, s59, 16384
buffer_load_dwordx4 v0, s[4:7], s39 offen offset:0 sc1 lds
buffer_load_dwordx4 v0, s[4:7], s39 offen offset:1024 sc1 lds
buffer_load_dwordx4 v0, s[4:7], s39 offen offset:2048 sc1 lds
buffer_load_dwordx4 v0, s[4:7], s39 offen offset:3072 sc1 lds
s_add_u32 m0, s50, 49152
s_add_u32 s39, s45, 49152
s_waitcnt vmcnt(0) lgkmcnt(0)
s_branch Lfg_607
Lfz_609:
s_mov_b32 s57, 63
s_waitcnt vmcnt(0)
v_cmp_gt_u32 vcc, s57, v13
s_barrier
v_min_u32 v100, s36, 64
s_sub_u32 s38, s36, 4
v_max_i32 v101, s38, 0
buffer_store_dwordx2 v[100:101], v4, s[4:7], 0 offen sc1
s_cbranch_vccz Lfh_614
Lbw_617:
buffer_load_dword v13, v12, s[4:7], s61 offen sc1
s_waitcnt vmcnt(0)
v_cmp_gt_u32 vcc, s57, v13
s_cbranch_vccz Lbo_618
s_sub_u32 s37, s37, 1
s_cbranch_scc1 Lend_7
s_sleep 1
s_branch Lbw_617
Lbo_618:
Lfh_614:
s_add_u32 s55, s59, 0
s_add_u32 m0, s60, 65536
s_add_u32 s39, s55, 0
buffer_load_dwordx4 v0, s[4:7], s39 offen offset:0 sc1 lds
buffer_load_dwordx4 v0, s[4:7], s39 offen offset:1024 sc1 lds
buffer_load_dwordx4 v0, s[4:7], s39 offen offset:2048 sc1 lds
buffer_load_dwordx4 v0, s[4:7], s39 offen offset:3072 sc1 lds
s_add_u32 m0, s60, 81920
s_add_u32 s39, s55, 16384
buffer_load_dwordx4 v0, s[4:7], s39 offen offset:0 sc1 lds
buffer_load_dwordx4 v0, s[4:7], s39 offen offset:1024 sc1 lds
buffer_load_dwordx4 v0, s[4:7], s39 offen offset:2048 sc1 lds
buffer_load_dwordx4 v0, s[4:7], s39 offen offset:3072 sc1 lds
s_add_u32 s55, s59, 229376
s_add_u32 m0, s60, 98304
s_add_u32 s39, s55, 0
buffer_load_dwordx4 v0, s[4:7], s39 offen offset:0 sc1 lds
buffer_load_dwordx4 v0, s[4:7], s39 offen offset:1024 sc1 lds
buffer_load_dwordx4 v0, s[4:7], s39 offen offset:2048 sc1 lds
buffer_load_dwordx4 v0, s[4:7], s39 offen offset:3072 sc1 lds
s_add_u32 m0, s60, 114688
s_add_u32 s39, s55, 16384
buffer_load_dwordx4 v0, s[4:7], s39 offen offset:0 sc1 lds
buffer_load_dwordx4 v0, s[4:7], s39 offen offset:1024 sc1 lds
buffer_load_dwordx4 v0, s[4:7], s39 offen offset:2048 sc1 lds
buffer_load_dwordx4 v0, s[4:7], s39 offen offset:3072 sc1 lds
buffer_store_dwordx4 v[80:83], v7, s[4:7], s58 offen offset:0 sc1
buffer_store_dwordx4 v[84:87], v7, s[4:7], s58 offen offset:1024 sc1
s_add_u32 s55, s59, 458752
s_mov_b32 s57, 64
v_add_u32 v11, -0x10000, v11
s_waitcnt vmcnt(10)
s_barrier
ds_read_b128 v[16:19], v11 offset:0
ds_read_b128 v[20:23], v11 offset:1024
ds_read_b128 v[24:27], v11 offset:2048
ds_read_b128 v[28:31], v11 offset:3072
ds_read_b128 v[32:35], v11 offset:4096
ds_read_b128 v[36:39], v11 offset:5120
ds_read_b128 v[40:43], v11 offset:6144
s_waitcnt lgkmcnt(5)
v_mfma_f32_16x16x32_bf16 v[64:67], v[128:131], v[16:19], 0
ds_read_b128 v[44:47], v11 offset:7168
v_mfma_f32_16x16x32_bf16 v[68:71], v[192:195], v[16:19], 0
v_mfma_f32_16x16x32_bf16 v[72:75], v[128:131], v[20:23], 0
ds_read_b128 v[16:19], v11 offset:8192
v_mfma_f32_16x16x32_bf16 v[76:79], v[192:195], v[20:23], 0
s_waitcnt lgkmcnt(5)
v_mfma_f32_16x16x32_bf16 v[64:67], v[132:135], v[24:27], v[64:67]
ds_read_b128 v[20:23], v11 offset:9216
v_mfma_f32_16x16x32_bf16 v[68:71], v[196:199], v[24:27], v[68:71]
v_mfma_f32_16x16x32_bf16 v[72:75], v[132:135], v[28:31], v[72:75]
ds_read_b128 v[24:27], v11 offset:10240
v_mfma_f32_16x16x32_bf16 v[76:79], v[196:199], v[28:31], v[76:79]
s_waitcnt lgkmcnt(5)
v_mfma_f32_16x16x32_bf16 v[64:67], v[136:139], v[32:35], v[64:67]
ds_read_b128 v[28:31], v11 offset:11264
v_mfma_f32_16x16x32_bf16 v[68:71], v[200:203], v[32:35], v[68:71]
v_mfma_f32_16x16x32_bf16 v[72:75], v[136:139], v[36:39], v[72:75]
ds_read_b128 v[32:35], v11 offset:12288
v_mfma_f32_16x16x32_bf16 v[76:79], v[200:203], v[36:39], v[76:79]
s_waitcnt lgkmcnt(5)
v_mfma_f32_16x16x32_bf16 v[64:67], v[140:143], v[40:43], v[64:67]
ds_read_b128 v[36:39], v11 offset:13312
v_mfma_f32_16x16x32_bf16 v[68:71], v[204:207], v[40:43], v[68:71]
v_mfma_f32_16x16x32_bf16 v[72:75], v[140:143], v[44:47], v[72:75]
ds_read_b128 v[40:43], v11 offset:14336
v_mfma_f32_16x16x32_bf16 v[76:79], v[204:207], v[44:47], v[76:79]
s_waitcnt lgkmcnt(5)
v_mfma_f32_16x16x32_bf16 v[64:67], v[144:147], v[16:19], v[64:67]
ds_read_b128 v[44:47], v11 offset:15360
v_mfma_f32_16x16x32_bf16 v[68:71], v[208:211], v[16:19], v[68:71]
v_mfma_f32_16x16x32_bf16 v[72:75], v[144:147], v[20:23], v[72:75]
ds_read_b128 v[16:19], v11 offset:16384
v_mfma_f32_16x16x32_bf16 v[76:79], v[208:211], v[20:23], v[76:79]
s_waitcnt lgkmcnt(5)
v_mfma_f32_16x16x32_bf16 v[64:67], v[148:151], v[24:27], v[64:67]
ds_read_b128 v[20:23], v11 offset:17408
v_mfma_f32_16x16x32_bf16 v[68:71], v[212:215], v[24:27], v[68:71]
v_mfma_f32_16x16x32_bf16 v[72:75], v[148:151], v[28:31], v[72:75]
ds_read_b128 v[24:27], v11 offset:18432
v_mfma_f32_16x16x32_bf16 v[76:79], v[212:215], v[28:31], v[76:79]
s_waitcnt lgkmcnt(5)
v_mfma_f32_16x16x32_bf16 v[64:67], v[152:155], v[32:35], v[64:67]
ds_read_b128 v[28:31], v11 offset:19456
buffer_load_dword v13, v12, s[4:7], s61 offen sc1
v_mfma_f32_16x16x32_bf16 v[68:71], v[216:219], v[32:35], v[68:71]
v_mfma_f32_16x16x32_bf16 v[72:75], v[152:155], v[36:39], v[72:75]
ds_read_b128 v[32:35], v11 offset:20480
v_mfma_f32_16x16x32_bf16 v[76:79], v[216:219], v[36:39], v[76:79]
s_waitcnt lgkmcnt(5)
v_mfma_f32_16x16x32_bf16 v[64:67], v[156:159], v[40:43], v[64:67]
ds_read_b128 v[36:39], v11 offset:21504
v_mfma_f32_16x16x32_bf16 v[68:71], v[220:223], v[40:43], v[68:71]
v_mfma_f32_16x16x32_bf16 v[72:75], v[156:159], v[44:47], v[72:75]
ds_read_b128 v[40:43], v11 offset:22528
v_mfma_f32_16x16x32_bf16 v[76:79], v[220:223], v[44:47], v[76:79]
s_waitcnt lgkmcnt(5)
v_mfma_f32_16x16x32_bf16 v[64:67], v[160:163], v[16:19], v[64:67]
ds_read_b128 v[44:47], v11 offset:23552
v_mfma_f32_16x16x32_bf16 v[68:71], v[224:227], v[16:19], v[68:71]
v_mfma_f32_16x16x32_bf16 v[72:75], v[160:163], v[20:23], v[72:75]
ds_read_b128 v[16:19], v11 offset:24576
v_mfma_f32_16x16x32_bf16 v[76:79], v[224:227], v[20:23], v[76:79]
s_waitcnt lgkmcnt(5)
v_mfma_f32_16x16x32_bf16 v[64:67], v[164:167], v[24:27], v[64:67]
ds_read_b128 v[20:23], v11 offset:25600
v_mfma_f32_16x16x32_bf16 v[68:71], v[228:231], v[24:27], v[68:71]
v_mfma_f32_16x16x32_bf16 v[72:75], v[164:167], v[28:31], v[72:75]
ds_read_b128 v[24:27], v11 offset:26624
v_mfma_f32_16x16x32_bf16 v[76:79], v[228:231], v[28:31], v[76:79]
s_waitcnt lgkmcnt(5)
v_mfma_f32_16x16x32_bf16 v[64:67], v[168:171], v[32:35], v[64:67]
ds_read_b128 v[28:31], v11 offset:27648
v_mfma_f32_16x16x32_bf16 v[68:71], v[232:235], v[32:35], v[68:71]
v_mfma_f32_16x16x32_bf16 v[72:75], v[168:171], v[36:39], v[72:75]
ds_read_b128 v[32:35], v11 offset:28672
v_mfma_f32_16x16x32_bf16 v[76:79], v[232:235], v[36:39], v[76:79]
s_waitcnt lgkmcnt(5)
v_mfma_f32_16x16x32_bf16 v[64:67], v[172:175], v[40:43], v[64:67]
ds_read_b128 v[36:39], v11 offset:29696
v_mfma_f32_16x16x32_bf16 v[68:71], v[236:239], v[40:43], v[68:71]
v_mfma_f32_16x16x32_bf16 v[72:75], v[172:175], v[44:47], v[72:75]
ds_read_b128 v[40:43], v11 offset:30720
v_mfma_f32_16x16x32_bf16 v[76:79], v[236:239], v[44:47], v[76:79]
s_waitcnt lgkmcnt(5)
v_mfma_f32_16x16x32_bf16 v[64:67], v[176:179], v[16:19], v[64:67]
ds_read_b128 v[44:47], v11 offset:31744
v_mfma_f32_16x16x32_bf16 v[68:71], v[240:243], v[16:19], v[68:71]
v_mfma_f32_16x16x32_bf16 v[72:75], v[176:179], v[20:23], v[72:75]
v_mfma_f32_16x16x32_bf16 v[76:79], v[240:243], v[20:23], v[76:79]
s_waitcnt lgkmcnt(4)
v_mfma_f32_16x16x32_bf16 v[64:67], v[180:183], v[24:27], v[64:67]
v_mfma_f32_16x16x32_bf16 v[68:71], v[244:247], v[24:27], v[68:71]
v_mfma_f32_16x16x32_bf16 v[72:75], v[180:183], v[28:31], v[72:75]
v_mfma_f32_16x16x32_bf16 v[76:79], v[244:247], v[28:31], v[76:79]
s_waitcnt lgkmcnt(2)
v_mfma_f32_16x16x32_bf16 v[64:67], v[184:187], v[32:35], v[64:67]
v_mfma_f32_16x16x32_bf16 v[68:71], v[248:251], v[32:35], v[68:71]
v_mfma_f32_16x16x32_bf16 v[72:75], v[184:187], v[36:39], v[72:75]
v_mfma_f32_16x16x32_bf16 v[76:79], v[248:251], v[36:39], v[76:79]
s_waitcnt lgkmcnt(0)
v_mfma_f32_16x16x32_bf16 v[64:67], v[188:191], v[40:43], v[64:67]
v_mfma_f32_16x16x32_bf16 v[68:71], v[252:255], v[40:43], v[68:71]
v_mfma_f32_16x16x32_bf16 v[72:75], v[188:191], v[44:47], v[72:75]
v_mfma_f32_16x16x32_bf16 v[76:79], v[252:255], v[44:47], v[76:79]
s_cmp_ge_u32 s36, 3
s_cselect_b32 s58, s62, 0x70000000
s_add_u32 s49, s49, 229376
s_add_u32 s62, s62, 65536
s_add_u32 s59, s59, 229376
s_add_u32 s36, s36, 1
v_add_u32 v11, 0x8000, v11
s_nop 0
v_cvt_pk_bf16_f32 v80, v64, v65
v_cvt_pk_bf16_f32 v81, v66, v67
v_cvt_pk_bf16_f32 v82, v68, v69
v_cvt_pk_bf16_f32 v83, v70, v71
v_cvt_pk_bf16_f32 v84, v72, v73
v_cvt_pk_bf16_f32 v85, v74, v75
v_cvt_pk_bf16_f32 v86, v76, v77
v_cvt_pk_bf16_f32 v87, v78, v79
s_waitcnt vmcnt(0)
v_cmp_gt_u32 vcc, s57, v13
s_mov_b32 s56, 0
s_cbranch_vccnz Lfn_615
s_mov_b32 s56, 1
s_add_u32 m0, s60, 131072
s_add_u32 s39, s55, 0
buffer_load_dwordx4 v0, s[4:7], s39 offen offset:0 sc1 lds
buffer_load_dwordx4 v0, s[4:7], s39 offen offset:1024 sc1 lds
buffer_load_dwordx4 v0, s[4:7], s39 offen offset:2048 sc1 lds
buffer_load_dwordx4 v0, s[4:7], s39 offen offset:3072 sc1 lds
s_add_u32 m0, s60, 147456
s_add_u32 s39, s55, 16384
buffer_load_dwordx4 v0, s[4:7], s39 offen offset:0 sc1 lds
buffer_load_dwordx4 v0, s[4:7], s39 offen offset:1024 sc1 lds
buffer_load_dwordx4 v0, s[4:7], s39 offen offset:2048 sc1 lds
buffer_load_dwordx4 v0, s[4:7], s39 offen offset:3072 sc1 lds
Lfn_615:
buffer_store_dwordx4 v[80:83], v7, s[4:7], s58 offen offset:0 sc1
buffer_store_dwordx4 v[84:87], v7, s[4:7], s58 offen offset:1024 sc1
s_barrier
ds_read_b128 v[16:19], v11 offset:0
ds_read_b128 v[20:23], v11 offset:1024
ds_read_b128 v[24:27], v11 offset:2048
ds_read_b128 v[28:31], v11 offset:3072
ds_read_b128 v[32:35], v11 offset:4096
ds_read_b128 v[36:39], v11 offset:5120
ds_read_b128 v[40:43], v11 offset:6144
s_waitcnt lgkmcnt(5)
v_mfma_f32_16x16x32_bf16 v[64:67], v[128:131], v[16:19], 0
ds_read_b128 v[44:47], v11 offset:7168
v_mfma_f32_16x16x32_bf16 v[68:71], v[192:195], v[16:19], 0
v_mfma_f32_16x16x32_bf16 v[72:75], v[128:131], v[20:23], 0
ds_read_b128 v[16:19], v11 offset:8192
v_mfma_f32_16x16x32_bf16 v[76:79], v[192:195], v[20:23], 0
s_waitcnt lgkmcnt(5)
v_mfma_f32_16x16x32_bf16 v[64:67], v[132:135], v[24:27], v[64:67]
ds_read_b128 v[20:23], v11 offset:9216
v_mfma_f32_16x16x32_bf16 v[68:71], v[196:199], v[24:27], v[68:71]
v_mfma_f32_16x16x32_bf16 v[72:75], v[132:135], v[28:31], v[72:75]
ds_read_b128 v[24:27], v11 offset:10240
v_mfma_f32_16x16x32_bf16 v[76:79], v[196:199], v[28:31], v[76:79]
s_waitcnt lgkmcnt(5)
v_mfma_f32_16x16x32_bf16 v[64:67], v[136:139], v[32:35], v[64:67]
ds_read_b128 v[28:31], v11 offset:11264
v_mfma_f32_16x16x32_bf16 v[68:71], v[200:203], v[32:35], v[68:71]
v_mfma_f32_16x16x32_bf16 v[72:75], v[136:139], v[36:39], v[72:75]
ds_read_b128 v[32:35], v11 offset:12288
v_mfma_f32_16x16x32_bf16 v[76:79], v[200:203], v[36:39], v[76:79]
s_waitcnt lgkmcnt(5)
v_mfma_f32_16x16x32_bf16 v[64:67], v[140:143], v[40:43], v[64:67]
ds_read_b128 v[36:39], v11 offset:13312
v_mfma_f32_16x16x32_bf16 v[68:71], v[204:207], v[40:43], v[68:71]
v_mfma_f32_16x16x32_bf16 v[72:75], v[140:143], v[44:47], v[72:75]
ds_read_b128 v[40:43], v11 offset:14336
v_mfma_f32_16x16x32_bf16 v[76:79], v[204:207], v[44:47], v[76:79]
s_waitcnt lgkmcnt(5)
v_mfma_f32_16x16x32_bf16 v[64:67], v[144:147], v[16:19], v[64:67]
ds_read_b128 v[44:47], v11 offset:15360
v_mfma_f32_16x16x32_bf16 v[68:71], v[208:211], v[16:19], v[68:71]
v_mfma_f32_16x16x32_bf16 v[72:75], v[144:147], v[20:23], v[72:75]
ds_read_b128 v[16:19], v11 offset:16384
v_mfma_f32_16x16x32_bf16 v[76:79], v[208:211], v[20:23], v[76:79]
s_waitcnt lgkmcnt(5)
v_mfma_f32_16x16x32_bf16 v[64:67], v[148:151], v[24:27], v[64:67]
ds_read_b128 v[20:23], v11 offset:17408
v_mfma_f32_16x16x32_bf16 v[68:71], v[212:215], v[24:27], v[68:71]
v_mfma_f32_16x16x32_bf16 v[72:75], v[148:151], v[28:31], v[72:75]
ds_read_b128 v[24:27], v11 offset:18432
v_mfma_f32_16x16x32_bf16 v[76:79], v[212:215], v[28:31], v[76:79]
s_waitcnt lgkmcnt(5)
v_mfma_f32_16x16x32_bf16 v[64:67], v[152:155], v[32:35], v[64:67]
ds_read_b128 v[28:31], v11 offset:19456
v_mfma_f32_16x16x32_bf16 v[68:71], v[216:219], v[32:35], v[68:71]
v_mfma_f32_16x16x32_bf16 v[72:75], v[152:155], v[36:39], v[72:75]
ds_read_b128 v[32:35], v11 offset:20480
v_mfma_f32_16x16x32_bf16 v[76:79], v[216:219], v[36:39], v[76:79]
s_waitcnt lgkmcnt(5)
v_mfma_f32_16x16x32_bf16 v[64:67], v[156:159], v[40:43], v[64:67]
ds_read_b128 v[36:39], v11 offset:21504
v_mfma_f32_16x16x32_bf16 v[68:71], v[220:223], v[40:43], v[68:71]
v_mfma_f32_16x16x32_bf16 v[72:75], v[156:159], v[44:47], v[72:75]
ds_read_b128 v[40:43], v11 offset:22528
v_mfma_f32_16x16x32_bf16 v[76:79], v[220:223], v[44:47], v[76:79]
s_waitcnt lgkmcnt(5)
v_mfma_f32_16x16x32_bf16 v[64:67], v[160:163], v[16:19], v[64:67]
ds_read_b128 v[44:47], v11 offset:23552
v_mfma_f32_16x16x32_bf16 v[68:71], v[224:227], v[16:19], v[68:71]
v_mfma_f32_16x16x32_bf16 v[72:75], v[160:163], v[20:23], v[72:75]
ds_read_b128 v[16:19], v11 offset:24576
v_mfma_f32_16x16x32_bf16 v[76:79], v[224:227], v[20:23], v[76:79]
s_waitcnt lgkmcnt(5)
v_mfma_f32_16x16x32_bf16 v[64:67], v[164:167], v[24:27], v[64:67]
ds_read_b128 v[20:23], v11 offset:25600
v_mfma_f32_16x16x32_bf16 v[68:71], v[228:231], v[24:27], v[68:71]
v_mfma_f32_16x16x32_bf16 v[72:75], v[164:167], v[28:31], v[72:75]
ds_read_b128 v[24:27], v11 offset:26624
v_mfma_f32_16x16x32_bf16 v[76:79], v[228:231], v[28:31], v[76:79]
s_waitcnt lgkmcnt(5)
v_mfma_f32_16x16x32_bf16 v[64:67], v[168:171], v[32:35], v[64:67]
ds_read_b128 v[28:31], v11 offset:27648
v_mfma_f32_16x16x32_bf16 v[68:71], v[232:235], v[32:35], v[68:71]
v_mfma_f32_16x16x32_bf16 v[72:75], v[168:171], v[36:39], v[72:75]
ds_read_b128 v[32:35], v11 offset:28672
v_mfma_f32_16x16x32_bf16 v[76:79], v[232:235], v[36:39], v[76:79]
s_waitcnt lgkmcnt(5)
v_mfma_f32_16x16x32_bf16 v[64:67], v[172:175], v[40:43], v[64:67]
ds_read_b128 v[36:39], v11 offset:29696
v_mfma_f32_16x16x32_bf16 v[68:71], v[236:239], v[40:43], v[68:71]
v_mfma_f32_16x16x32_bf16 v[72:75], v[172:175], v[44:47], v[72:75]
ds_read_b128 v[40:43], v11 offset:30720
v_mfma_f32_16x16x32_bf16 v[76:79], v[236:239], v[44:47], v[76:79]
s_waitcnt lgkmcnt(5)
v_mfma_f32_16x16x32_bf16 v[64:67], v[176:179], v[16:19], v[64:67]
ds_read_b128 v[44:47], v11 offset:31744
v_mfma_f32_16x16x32_bf16 v[68:71], v[240:243], v[16:19], v[68:71]
v_mfma_f32_16x16x32_bf16 v[72:75], v[176:179], v[20:23], v[72:75]
v_mfma_f32_16x16x32_bf16 v[76:79], v[240:243], v[20:23], v[76:79]
s_waitcnt lgkmcnt(4)
v_mfma_f32_16x16x32_bf16 v[64:67], v[180:183], v[24:27], v[64:67]
v_mfma_f32_16x16x32_bf16 v[68:71], v[244:247], v[24:27], v[68:71]
v_mfma_f32_16x16x32_bf16 v[72:75], v[180:183], v[28:31], v[72:75]
v_mfma_f32_16x16x32_bf16 v[76:79], v[244:247], v[28:31], v[76:79]
s_waitcnt lgkmcnt(2)
v_mfma_f32_16x16x32_bf16 v[64:67], v[184:187], v[32:35], v[64:67]
v_mfma_f32_16x16x32_bf16 v[68:71], v[248:251], v[32:35], v[68:71]
v_mfma_f32_16x16x32_bf16 v[72:75], v[184:187], v[36:39], v[72:75]
v_mfma_f32_16x16x32_bf16 v[76:79], v[248:251], v[36:39], v[76:79]
s_waitcnt lgkmcnt(0)
v_mfma_f32_16x16x32_bf16 v[64:67], v[188:191], v[40:43], v[64:67]
v_mfma_f32_16x16x32_bf16 v[68:71], v[252:255], v[40:43], v[68:71]
v_mfma_f32_16x16x32_bf16 v[72:75], v[188:191], v[44:47], v[72:75]
v_mfma_f32_16x16x32_bf16 v[76:79], v[252:255], v[44:47], v[76:79]
s_cmp_ge_u32 s36, 3
s_cselect_b32 s58, s62, 0x70000000
s_add_u32 s49, s49, 229376
s_add_u32 s62, s62, 65536
s_add_u32 s59, s59, 229376
s_add_u32 s36, s36, 1
v_add_u32 v11, 0x8000, v11
s_nop 0
v_cvt_pk_bf16_f32 v80, v64, v65
v_cvt_pk_bf16_f32 v81, v66, v67
v_cvt_pk_bf16_f32 v82, v68, v69
v_cvt_pk_bf16_f32 v83, v70, v71
v_cvt_pk_bf16_f32 v84, v72, v73
v_cvt_pk_bf16_f32 v85, v74, v75
v_cvt_pk_bf16_f32 v86, v76, v77
v_cvt_pk_bf16_f32 v87, v78, v79
s_cmp_lg_u32 s56, 0
s_cbranch_scc1 Lfy_616
Lbw_619:
buffer_load_dword v13, v12, s[4:7], s61 offen sc1
s_waitcnt vmcnt(0)
v_cmp_gt_u32 vcc, s57, v13
s_cbranch_vccz Lbo_620
s_sub_u32 s37, s37, 1
s_cbranch_scc1 Lend_7
s_sleep 1
s_branch Lbw_619
Lbo_620:
s_add_u32 m0, s60, 131072
s_add_u32 s39, s55, 0
buffer_load_dwordx4 v0, s[4:7], s39 offen offset:0 sc1 lds
buffer_load_dwordx4 v0, s[4:7], s39 offen offset:1024 sc1 lds
buffer_load_dwordx4 v0, s[4:7], s39 offen offset:2048 sc1 lds
buffer_load_dwordx4 v0, s[4:7], s39 offen offset:3072 sc1 lds
s_add_u32 m0, s60, 147456
s_add_u32 s39, s55, 16384
buffer_load_dwordx4 v0, s[4:7], s39 offen offset:0 sc1 lds
buffer_load_dwordx4 v0, s[4:7], s39 offen offset:1024 sc1 lds
buffer_load_dwordx4 v0, s[4:7], s39 offen offset:2048 sc1 lds
buffer_load_dwordx4 v0, s[4:7], s39 offen offset:3072 sc1 lds
Lfy_616:
buffer_store_dwordx4 v[80:83], v7, s[4:7], s58 offen offset:0 sc1
buffer_store_dwordx4 v[84:87], v7, s[4:7], s58 offen offset:1024 sc1
s_waitcnt vmcnt(2)
s_barrier
ds_read_b128 v[16:19], v11 offset:0
ds_read_b128 v[20:23], v11 offset:1024
ds_read_b128 v[24:27], v11 offset:2048
ds_read_b128 v[28:31], v11 offset:3072
ds_read_b128 v[32:35], v11 offset:4096
ds_read_b128 v[36:39], v11 offset:5120
ds_read_b128 v[40:43], v11 offset:6144
s_waitcnt lgkmcnt(5)
v_mfma_f32_16x16x32_bf16 v[64:67], v[128:131], v[16:19], 0
ds_read_b128 v[44:47], v11 offset:7168
v_mfma_f32_16x16x32_bf16 v[68:71], v[192:195], v[16:19], 0
v_mfma_f32_16x16x32_bf16 v[72:75], v[128:131], v[20:23], 0
ds_read_b128 v[16:19], v11 offset:8192
v_mfma_f32_16x16x32_bf16 v[76:79], v[192:195], v[20:23], 0
s_waitcnt lgkmcnt(5)
v_mfma_f32_16x16x32_bf16 v[64:67], v[132:135], v[24:27], v[64:67]
ds_read_b128 v[20:23], v11 offset:9216
v_mfma_f32_16x16x32_bf16 v[68:71], v[196:199], v[24:27], v[68:71]
v_mfma_f32_16x16x32_bf16 v[72:75], v[132:135], v[28:31], v[72:75]
ds_read_b128 v[24:27], v11 offset:10240
v_mfma_f32_16x16x32_bf16 v[76:79], v[196:199], v[28:31], v[76:79]
s_waitcnt lgkmcnt(5)
v_mfma_f32_16x16x32_bf16 v[64:67], v[136:139], v[32:35], v[64:67]
ds_read_b128 v[28:31], v11 offset:11264
v_mfma_f32_16x16x32_bf16 v[68:71], v[200:203], v[32:35], v[68:71]
v_mfma_f32_16x16x32_bf16 v[72:75], v[136:139], v[36:39], v[72:75]
ds_read_b128 v[32:35], v11 offset:12288
v_mfma_f32_16x16x32_bf16 v[76:79], v[200:203], v[36:39], v[76:79]
s_waitcnt lgkmcnt(5)
v_mfma_f32_16x16x32_bf16 v[64:67], v[140:143], v[40:43], v[64:67]
ds_read_b128 v[36:39], v11 offset:13312
v_mfma_f32_16x16x32_bf16 v[68:71], v[204:207], v[40:43], v[68:71]
v_mfma_f32_16x16x32_bf16 v[72:75], v[140:143], v[44:47], v[72:75]
ds_read_b128 v[40:43], v11 offset:14336
v_mfma_f32_16x16x32_bf16 v[76:79], v[204:207], v[44:47], v[76:79]
s_waitcnt lgkmcnt(5)
v_mfma_f32_16x16x32_bf16 v[64:67], v[144:147], v[16:19], v[64:67]
ds_read_b128 v[44:47], v11 offset:15360
v_mfma_f32_16x16x32_bf16 v[68:71], v[208:211], v[16:19], v[68:71]
v_mfma_f32_16x16x32_bf16 v[72:75], v[144:147], v[20:23], v[72:75]
ds_read_b128 v[16:19], v11 offset:16384
v_mfma_f32_16x16x32_bf16 v[76:79], v[208:211], v[20:23], v[76:79]
s_waitcnt lgkmcnt(5)
v_mfma_f32_16x16x32_bf16 v[64:67], v[148:151], v[24:27], v[64:67]
ds_read_b128 v[20:23], v11 offset:17408
v_mfma_f32_16x16x32_bf16 v[68:71], v[212:215], v[24:27], v[68:71]
v_mfma_f32_16x16x32_bf16 v[72:75], v[148:151], v[28:31], v[72:75]
ds_read_b128 v[24:27], v11 offset:18432
v_mfma_f32_16x16x32_bf16 v[76:79], v[212:215], v[28:31], v[76:79]
s_waitcnt lgkmcnt(5)
v_mfma_f32_16x16x32_bf16 v[64:67], v[152:155], v[32:35], v[64:67]
ds_read_b128 v[28:31], v11 offset:19456
v_mfma_f32_16x16x32_bf16 v[68:71], v[216:219], v[32:35], v[68:71]
v_mfma_f32_16x16x32_bf16 v[72:75], v[152:155], v[36:39], v[72:75]
ds_read_b128 v[32:35], v11 offset:20480
v_mfma_f32_16x16x32_bf16 v[76:79], v[216:219], v[36:39], v[76:79]
s_waitcnt lgkmcnt(5)
v_mfma_f32_16x16x32_bf16 v[64:67], v[156:159], v[40:43], v[64:67]
ds_read_b128 v[36:39], v11 offset:21504
v_mfma_f32_16x16x32_bf16 v[68:71], v[220:223], v[40:43], v[68:71]
v_mfma_f32_16x16x32_bf16 v[72:75], v[156:159], v[44:47], v[72:75]
ds_read_b128 v[40:43], v11 offset:22528
v_mfma_f32_16x16x32_bf16 v[76:79], v[220:223], v[44:47], v[76:79]
s_waitcnt lgkmcnt(5)
v_mfma_f32_16x16x32_bf16 v[64:67], v[160:163], v[16:19], v[64:67]
ds_read_b128 v[44:47], v11 offset:23552
v_mfma_f32_16x16x32_bf16 v[68:71], v[224:227], v[16:19], v[68:71]
v_mfma_f32_16x16x32_bf16 v[72:75], v[160:163], v[20:23], v[72:75]
ds_read_b128 v[16:19], v11 offset:24576
v_mfma_f32_16x16x32_bf16 v[76:79], v[224:227], v[20:23], v[76:79]
s_waitcnt lgkmcnt(5)
v_mfma_f32_16x16x32_bf16 v[64:67], v[164:167], v[24:27], v[64:67]
ds_read_b128 v[20:23], v11 offset:25600
v_mfma_f32_16x16x32_bf16 v[68:71], v[228:231], v[24:27], v[68:71]
v_mfma_f32_16x16x32_bf16 v[72:75], v[164:167], v[28:31], v[72:75]
ds_read_b128 v[24:27], v11 offset:26624
v_mfma_f32_16x16x32_bf16 v[76:79], v[228:231], v[28:31], v[76:79]
s_waitcnt lgkmcnt(5)
v_mfma_f32_16x16x32_bf16 v[64:67], v[168:171], v[32:35], v[64:67]
ds_read_b128 v[28:31], v11 offset:27648
v_mfma_f32_16x16x32_bf16 v[68:71], v[232:235], v[32:35], v[68:71]
v_mfma_f32_16x16x32_bf16 v[72:75], v[168:171], v[36:39], v[72:75]
ds_read_b128 v[32:35], v11 offset:28672
v_mfma_f32_16x16x32_bf16 v[76:79], v[232:235], v[36:39], v[76:79]
s_waitcnt lgkmcnt(5)
v_mfma_f32_16x16x32_bf16 v[64:67], v[172:175], v[40:43], v[64:67]
ds_read_b128 v[36:39], v11 offset:29696
v_mfma_f32_16x16x32_bf16 v[68:71], v[236:239], v[40:43], v[68:71]
v_mfma_f32_16x16x32_bf16 v[72:75], v[172:175], v[44:47], v[72:75]
ds_read_b128 v[40:43], v11 offset:30720
v_mfma_f32_16x16x32_bf16 v[76:79], v[236:239], v[44:47], v[76:79]
s_waitcnt lgkmcnt(5)
v_mfma_f32_16x16x32_bf16 v[64:67], v[176:179], v[16:19], v[64:67]
ds_read_b128 v[44:47], v11 offset:31744
v_mfma_f32_16x16x32_bf16 v[68:71], v[240:243], v[16:19], v[68:71]
v_mfma_f32_16x16x32_bf16 v[72:75], v[176:179], v[20:23], v[72:75]
v_mfma_f32_16x16x32_bf16 v[76:79], v[240:243], v[20:23], v[76:79]
s_waitcnt lgkmcnt(4)
v_mfma_f32_16x16x32_bf16 v[64:67], v[180:183], v[24:27], v[64:67]
v_mfma_f32_16x16x32_bf16 v[68:71], v[244:247], v[24:27], v[68:71]
v_mfma_f32_16x16x32_bf16 v[72:75], v[180:183], v[28:31], v[72:75]
v_mfma_f32_16x16x32_bf16 v[76:79], v[244:247], v[28:31], v[76:79]
s_waitcnt lgkmcnt(2)
v_mfma_f32_16x16x32_bf16 v[64:67], v[184:187], v[32:35], v[64:67]
v_mfma_f32_16x16x32_bf16 v[68:71], v[248:251], v[32:35], v[68:71]
v_mfma_f32_16x16x32_bf16 v[72:75], v[184:187], v[36:39], v[72:75]
v_mfma_f32_16x16x32_bf16 v[76:79], v[248:251], v[36:39], v[76:79]
s_waitcnt lgkmcnt(0)
v_mfma_f32_16x16x32_bf16 v[64:67], v[188:191], v[40:43], v[64:67]
v_mfma_f32_16x16x32_bf16 v[68:71], v[252:255], v[40:43], v[68:71]
v_mfma_f32_16x16x32_bf16 v[72:75], v[188:191], v[44:47], v[72:75]
v_mfma_f32_16x16x32_bf16 v[76:79], v[252:255], v[44:47], v[76:79]
s_cmp_ge_u32 s36, 3
s_cselect_b32 s58, s62, 0x70000000
s_add_u32 s49, s49, 229376
s_add_u32 s62, s62, 65536
s_add_u32 s59, s59, 229376
s_add_u32 s36, s36, 1
v_add_u32 v11, 0x8000, v11
s_nop 0
v_cvt_pk_bf16_f32 v80, v64, v65
v_cvt_pk_bf16_f32 v81, v66, v67
v_cvt_pk_bf16_f32 v82, v68, v69
v_cvt_pk_bf16_f32 v83, v70, v71
v_cvt_pk_bf16_f32 v84, v72, v73
v_cvt_pk_bf16_f32 v85, v74, v75
v_cvt_pk_bf16_f32 v86, v76, v77
v_cvt_pk_bf16_f32 v87, v78, v79
buffer_store_dwordx4 v[80:83], v7, s[4:7], s58 offen offset:0 sc1
buffer_store_dwordx4 v[84:87], v7, s[4:7], s58 offen offset:1024 sc1
s_waitcnt vmcnt(0)
s_barrier
v_min_u32 v100, s36, 64
s_sub_u32 s38, s36, 3
v_max_i32 v101, s38, 0
buffer_store_dwordx2 v[100:101], v4, s[4:7], 0 offen sc1
s_endpgm
Lln_6:
s_sub_u32 s26, s44, 56
s_and_b32 s52, s26, 3
s_lshl_b32 s53, s32, 2
v_lshrrev_b32 v80, 3, v9
v_and_b32 v81, 7, v9
s_lshr_b32 s38, s52, 1
s_lshl_b32 s38, s38, 10
s_and_b32 s39, s52, 1
s_lshl_b32 s39, s39, 7
s_add_u32 s38, s38, s39
s_lshl_b32 s39, s53, 12
s_add_u32 s38, s38, s39
v_lshl_add_u32 v6, v81, 4, s38
v_and_b32 v82, 3, v80
v_lshl_add_u32 v6, v82, 8, v6
v_lshrrev_b32 v82, 2, v80
v_lshl_add_u32 v6, v82, 11, v6
s_lshl_b32 s38, s52, 14
s_lshl_b32 s39, s53, 7
s_add_u32 s38, s38, s39
v_lshl_add_u32 v7, v81, 11, s38
v_lshl_add_u32 v7, v80, 4, v7
s_lshl_b32 s38, s53, 8
v_lshl_add_u32 v8, v80, 5, s38
v_and_b32 v12, 7, v9
v_lshlrev_b32 v12, 4, v12
s_lshl_b32 s38, s32, 2
v_add_u32 v11, s38, v12
s_mov_b32 s60, 0x00003f80
s_mov_b32 s61, 0x3f800000
v_min_u32 v2, 31, v9
v_lshlrev_b32 v2, 7, v2
s_lshr_b32 s47, s26, 2
s_xor_b32 s47, s47, 1
s_lshl_b32 s47, s47, 12
s_add_u32 s47, s47, 3440640
Lst_621:
buffer_load_dword v48, off, s[12:15], 0 offset:32 sc1
buffer_load_dword v49, off, s[12:15], 0 offset:160 sc1
s_waitcnt vmcnt(0)
v_add_u32 v48, v48, v49
s_nop 0
v_readfirstlane_b32 s38, v48
s_nop 3
s_and_b32 s39, s38, 0xffff
s_cmp_eq_u32 s39, 0x100
s_cbranch_scc1 Lso_622
s_sub_u32 s37, s37, 1
s_cbranch_scc1 Lend_7
s_sleep 8
s_branch Lst_621
Lso_622:
s_bfe_u32 s35, s38, 0x80010
s_bfe_u32 s46, s38, 0x10018
s_lshl_b32 s46, s46, 13
s_barrier
v_lshlrev_b32 v80, 7, v9
s_mov_b32 s38, 3424256
Lbw_623:
buffer_load_dword v81, v80, s[4:7], s38 offen sc1
s_waitcnt vmcnt(0)
v_cmp_gt_u32 vcc, 4, v81
s_cbranch_vccz Lbo_624
s_sub_u32 s37, s37, 1
s_cbranch_scc1 Lend_7
s_sleep 2
s_branch Lbw_623
Lbo_624:
s_mov_b32 s38, 3153920
buffer_load_dwordx4 v[128:131], v8, s[4:7], s38 offen offset:0 sc1
buffer_load_dwordx4 v[132:135], v8, s[4:7], s38 offen offset:16 sc1
buffer_load_dwordx4 v[136:139], v8, s[4:7], s38 offen offset:256 sc1
buffer_load_dwordx4 v[140:143], v8, s[4:7], s38 offen offset:272 sc1
buffer_load_dwordx4 v[144:147], v8, s[4:7], s38 offen offset:512 sc1
buffer_load_dwordx4 v[148:151], v8, s[4:7], s38 offen offset:528 sc1
buffer_load_dwordx4 v[152:155], v8, s[4:7], s38 offen offset:768 sc1
buffer_load_dwordx4 v[156:159], v8, s[4:7], s38 offen offset:784 sc1
s_mov_b32 s38, 3158016
buffer_load_dwordx4 v[192:195], v8, s[4:7], s38 offen offset:0 sc1
buffer_load_dwordx4 v[196:199], v8, s[4:7], s38 offen offset:16 sc1
buffer_load_dwordx4 v[200:203], v8, s[4:7], s38 offen offset:256 sc1
buffer_load_dwordx4 v[204:207], v8, s[4:7], s38 offen offset:272 sc1
buffer_load_dwordx4 v[208:211], v8, s[4:7], s38 offen offset:512 sc1
buffer_load_dwordx4 v[212:215], v8, s[4:7], s38 offen offset:528 sc1
buffer_load_dwordx4 v[216:219], v8, s[4:7], s38 offen offset:768 sc1
buffer_load_dwordx4 v[220:223], v8, s[4:7], s38 offen offset:784 sc1
s_mov_b32 s38, 3162112
buffer_load_dwordx4 v[160:163], v8, s[4:7], s38 offen offset:0 sc1
buffer_load_dwordx4 v[164:167], v8, s[4:7], s38 offen offset:16 sc1
buffer_load_dwordx4 v[168:171], v8, s[4:7], s38 offen offset:256 sc1
buffer_load_dwordx4 v[172:175], v8, s[4:7], s38 offen offset:272 sc1
buffer_load_dwordx4 v[176:179], v8, s[4:7], s38 offen offset:512 sc1
buffer_load_dwordx4 v[180:183], v8, s[4:7], s38 offen offset:528 sc1
buffer_load_dwordx4 v[184:187], v8, s[4:7], s38 offen offset:768 sc1
buffer_load_dwordx4 v[188:191], v8, s[4:7], s38 offen offset:784 sc1
s_waitcnt vmcnt(0)
v_pk_add_f32 v[160:161], v[160:161], 1.0 op_sel_hi:[1,0]
v_pk_add_f32 v[162:163], v[162:163], 1.0 op_sel_hi:[1,0]
v_pk_add_f32 v[164:165], v[164:165], 1.0 op_sel_hi:[1,0]
v_pk_add_f32 v[166:167], v[166:167], 1.0 op_sel_hi:[1,0]
v_pk_add_f32 v[168:169], v[168:169], 1.0 op_sel_hi:[1,0]
v_pk_add_f32 v[170:171], v[170:171], 1.0 op_sel_hi:[1,0]
v_pk_add_f32 v[172:173], v[172:173], 1.0 op_sel_hi:[1,0]
v_pk_add_f32 v[174:175], v[174:175], 1.0 op_sel_hi:[1,0]
v_pk_add_f32 v[176:177], v[176:177], 1.0 op_sel_hi:[1,0]
v_pk_add_f32 v[178:179], v[178:179], 1.0 op_sel_hi:[1,0]
v_pk_add_f32 v[180:181], v[180:181], 1.0 op_sel_hi:[1,0]
v_pk_add_f32 v[182:183], v[182:183], 1.0 op_sel_hi:[1,0]
v_pk_add_f32 v[184:185], v[184:185], 1.0 op_sel_hi:[1,0]
v_pk_add_f32 v[186:187], v[186:187], 1.0 op_sel_hi:[1,0]
v_pk_add_f32 v[188:189], v[188:189], 1.0 op_sel_hi:[1,0]
v_pk_add_f32 v[190:191], v[190:191], 1.0 op_sel_hi:[1,0]
s_lshr_b32 s36, s26, 2
Lln_625:
s_lshl_b32 s49, s36, 16
buffer_load_dwordx4 v[80:83], v7, s[88:91], s49 offen offset:0
buffer_load_dwordx4 v[84:87], v7, s[88:91], s49 offen offset:128
buffer_load_dwordx4 v[88:91], v7, s[88:91], s49 offen offset:256
buffer_load_dwordx4 v[92:95], v7, s[88:91], s49 offen offset:384
s_add_u32 s48, s36, 1
Lbw_626:
buffer_load_dword v3, v2, s[4:7], s47 offen sc1
s_waitcnt vmcnt(0)
v_cmp_gt_u32 vcc, s48, v3
s_cbranch_vccz Lbo_627
s_sub_u32 s37, s37, 1
s_cbranch_scc1 Lend_7
s_sleep 2
s_branch Lbw_626
Lbo_627:
s_add_u32 s39, s49, 117440512
buffer_load_dwordx4 v[16:19], v6, s[4:7], s39 offen sc1
s_add_u32 s39, s49, 121634816
buffer_load_dwordx4 v[20:23], v6, s[4:7], s39 offen sc1
s_add_u32 s39, s49, 125829120
buffer_load_dwordx4 v[24:27], v6, s[4:7], s39 offen sc1
s_add_u32 s39, s49, 130023424
buffer_load_dwordx4 v[28:31], v6, s[4:7], s39 offen sc1
s_add_u32 s39, s49, 117444608
buffer_load_dwordx4 v[32:35], v6, s[4:7], s39 offen sc1
s_add_u32 s39, s49, 121638912
buffer_load_dwordx4 v[36:39], v6, s[4:7], s39 offen sc1
s_add_u32 s39, s49, 125833216
buffer_load_dwordx4 v[40:43], v6, s[4:7], s39 offen sc1
s_add_u32 s39, s49, 130027520
buffer_load_dwordx4 v[44:47], v6, s[4:7], s39 offen sc1
s_add_u32 s39, s49, 117448704
buffer_load_dwordx4 v[48:51], v6, s[4:7], s39 offen sc1
s_add_u32 s39, s49, 121643008
buffer_load_dwordx4 v[52:55], v6, s[4:7], s39 offen sc1
s_add_u32 s39, s49, 125837312
buffer_load_dwordx4 v[56:59], v6, s[4:7], s39 offen sc1
s_add_u32 s39, s49, 130031616
buffer_load_dwordx4 v[60:63], v6, s[4:7], s39 offen sc1
s_add_u32 s39, s49, 117452800
buffer_load_dwordx4 v[64:67], v6, s[4:7], s39 offen sc1
s_add_u32 s39, s49, 121647104
buffer_load_dwordx4 v[68:71], v6, s[4:7], s39 offen sc1
s_add_u32 s39, s49, 125841408
buffer_load_dwordx4 v[72:75], v6, s[4:7], s39 offen sc1
s_add_u32 s39, s49, 130035712
buffer_load_dwordx4 v[76:79], v6, s[4:7], s39 offen sc1
v_lshlrev_b32 v96, 16, v80
v_and_b32 v97, 0xffff0000, v80
v_lshlrev_b32 v98, 16, v81
v_and_b32 v99, 0xffff0000, v81
v_lshlrev_b32 v100, 16, v82
v_and_b32 v101, 0xffff0000, v82
v_lshlrev_b32 v102, 16, v83
v_and_b32 v103, 0xffff0000, v83
v_lshlrev_b32 v104, 16, v84
v_and_b32 v105, 0xffff0000, v84
v_lshlrev_b32 v106, 16, v85
v_and_b32 v107, 0xffff0000, v85
v_lshlrev_b32 v108, 16, v86
v_and_b32 v109, 0xffff0000, v86
v_lshlrev_b32 v110, 16, v87
v_and_b32 v111, 0xffff0000, v87
v_lshlrev_b32 v112, 16, v88
v_and_b32 v113, 0xffff0000, v88
v_lshlrev_b32 v114, 16, v89
v_and_b32 v115, 0xffff0000, v89
v_lshlrev_b32 v116, 16, v90
v_and_b32 v117, 0xffff0000, v90
v_lshlrev_b32 v118, 16, v91
v_and_b32 v119, 0xffff0000, v91
v_lshlrev_b32 v120, 16, v92
v_and_b32 v121, 0xffff0000, v92
v_lshlrev_b32 v122, 16, v93
v_and_b32 v123, 0xffff0000, v93
v_lshlrev_b32 v124, 16, v94
v_and_b32 v125, 0xffff0000, v94
v_lshlrev_b32 v126, 16, v95
v_and_b32 v127, 0xffff0000, v95
s_waitcnt vmcnt(12)
v_dot2_f32_bf16 v224, v16, s60, 0
v_dot2_f32_bf16 v225, v16, s61, 0
v_dot2_f32_bf16 v226, v17, s60, 0
v_dot2_f32_bf16 v227, v17, s61, 0
v_dot2_f32_bf16 v228, v18, s60, 0
v_dot2_f32_bf16 v229, v18, s61, 0
v_dot2_f32_bf16 v230, v19, s60, 0
v_dot2_f32_bf16 v231, v19, s61, 0
v_dot2_f32_bf16 v224, v20, s60, v224
v_dot2_f32_bf16 v225, v20, s61, v225
v_dot2_f32_bf16 v226, v21, s60, v226
v_dot2_f32_bf16 v227, v21, s61, v227
v_dot2_f32_bf16 v228, v22, s60, v228
v_dot2_f32_bf16 v229, v22, s61, v229
v_dot2_f32_bf16 v230, v23, s60, v230
v_dot2_f32_bf16 v231, v23, s61, v231
v_dot2_f32_bf16 v224, v24, s60, v224
v_dot2_f32_bf16 v225, v24, s61, v225
v_dot2_f32_bf16 v226, v25, s60, v226
v_dot2_f32_bf16 v227, v25, s61, v227
v_dot2_f32_bf16 v228, v26, s60, v228
v_dot2_f32_bf16 v229, v26, s61, v229
v_dot2_f32_bf16 v230, v27, s60, v230
v_dot2_f32_bf16 v231, v27, s61, v231
v_dot2_f32_bf16 v224, v28, s60, v224
v_dot2_f32_bf16 v225, v28, s61, v225
v_dot2_f32_bf16 v226, v29, s60, v226
v_dot2_f32_bf16 v227, v29, s61, v227
v_dot2_f32_bf16 v228, v30, s60, v228
v_dot2_f32_bf16 v229, v30, s61, v229
v_dot2_f32_bf16 v230, v31, s60, v230
v_dot2_f32_bf16 v231, v31, s61, v231
s_nop 1
v_pk_fma_f32 v[96:97], v[224:225], v[128:129], v[96:97]
v_pk_fma_f32 v[98:99], v[226:227], v[130:131], v[98:99]
v_pk_fma_f32 v[100:101], v[228:229], v[132:133], v[100:101]
v_pk_fma_f32 v[102:103], v[230:231], v[134:135], v[102:103]
v_cvt_pk_bf16_f32 v80, v96, v97
v_cvt_pk_bf16_f32 v81, v98, v99
v_cvt_pk_bf16_f32 v82, v100, v101
v_cvt_pk_bf16_f32 v83, v102, v103
s_add_u32 s39, s49, 12582912
buffer_store_dwordx4 v[80:83], v6, s[4:7], s39 offen sc1
v_lshlrev_b32 v96, 16, v80
v_and_b32 v97, 0xffff0000, v80
v_lshlrev_b32 v98, 16, v81
v_and_b32 v99, 0xffff0000, v81
v_lshlrev_b32 v100, 16, v82
v_and_b32 v101, 0xffff0000, v82
v_lshlrev_b32 v102, 16, v83
v_and_b32 v103, 0xffff0000, v83
s_waitcnt vmcnt(9)
v_dot2_f32_bf16 v224, v32, s60, 0
v_dot2_f32_bf16 v225, v32, s61, 0
v_dot2_f32_bf16 v226, v33, s60, 0
v_dot2_f32_bf16 v227, v33, s61, 0
v_dot2_f32_bf16 v228, v34, s60, 0
v_dot2_f32_bf16 v229, v34, s61, 0
v_dot2_f32_bf16 v230, v35, s60, 0
v_dot2_f32_bf16 v231, v35, s61, 0
v_dot2_f32_bf16 v224, v36, s60, v224
v_dot2_f32_bf16 v225, v36, s61, v225
v_dot2_f32_bf16 v226, v37, s60, v226
v_dot2_f32_bf16 v227, v37, s61, v227
v_dot2_f32_bf16 v228, v38, s60, v228
v_dot2_f32_bf16 v229, v38, s61, v229
v_dot2_f32_bf16 v230, v39, s60, v230
v_dot2_f32_bf16 v231, v39, s61, v231
v_dot2_f32_bf16 v224, v40, s60, v224
v_dot2_f32_bf16 v225, v40, s61, v225
v_dot2_f32_bf16 v226, v41, s60, v226
v_dot2_f32_bf16 v227, v41, s61, v227
v_dot2_f32_bf16 v228, v42, s60, v228
v_dot2_f32_bf16 v229, v42, s61, v229
v_dot2_f32_bf16 v230, v43, s60, v230
v_dot2_f32_bf16 v231, v43, s61, v231
v_dot2_f32_bf16 v224, v44, s60, v224
v_dot2_f32_bf16 v225, v44, s61, v225
v_dot2_f32_bf16 v226, v45, s60, v226
v_dot2_f32_bf16 v227, v45, s61, v227
v_dot2_f32_bf16 v228, v46, s60, v228
v_dot2_f32_bf16 v229, v46, s61, v229
v_dot2_f32_bf16 v230, v47, s60, v230
v_dot2_f32_bf16 v231, v47, s61, v231
s_nop 1
v_pk_fma_f32 v[104:105], v[224:225], v[136:137], v[104:105]
v_pk_fma_f32 v[106:107], v[226:227], v[138:139], v[106:107]
v_pk_fma_f32 v[108:109], v[228:229], v[140:141], v[108:109]
v_pk_fma_f32 v[110:111], v[230:231], v[142:143], v[110:111]
v_cvt_pk_bf16_f32 v84, v104, v105
v_cvt_pk_bf16_f32 v85, v106, v107
v_cvt_pk_bf16_f32 v86, v108, v109
v_cvt_pk_bf16_f32 v87, v110, v111
s_add_u32 s39, s49, 12587008
buffer_store_dwordx4 v[84:87], v6, s[4:7], s39 offen sc1
v_lshlrev_b32 v104, 16, v84
v_and_b32 v105, 0xffff0000, v84
v_lshlrev_b32 v106, 16, v85
v_and_b32 v107, 0xffff0000, v85
v_lshlrev_b32 v108, 16, v86
v_and_b32 v109, 0xffff0000, v86
v_lshlrev_b32 v110, 16, v87
v_and_b32 v111, 0xffff0000, v87
s_waitcnt vmcnt(6)
v_dot2_f32_bf16 v224, v48, s60, 0
v_dot2_f32_bf16 v225, v48, s61, 0
v_dot2_f32_bf16 v226, v49, s60, 0
v_dot2_f32_bf16 v227, v49, s61, 0
v_dot2_f32_bf16 v228, v50, s60, 0
v_dot2_f32_bf16 v229, v50, s61, 0
v_dot2_f32_bf16 v230, v51, s60, 0
v_dot2_f32_bf16 v231, v51, s61, 0
v_dot2_f32_bf16 v224, v52, s60, v224
v_dot2_f32_bf16 v225, v52, s61, v225
v_dot2_f32_bf16 v226, v53, s60, v226
v_dot2_f32_bf16 v227, v53, s61, v227
v_dot2_f32_bf16 v228, v54, s60, v228
v_dot2_f32_bf16 v229, v54, s61, v229
v_dot2_f32_bf16 v230, v55, s60, v230
v_dot2_f32_bf16 v231, v55, s61, v231
v_dot2_f32_bf16 v224, v56, s60, v224
v_dot2_f32_bf16 v225, v56, s61, v225
v_dot2_f32_bf16 v226, v57, s60, v226
v_dot2_f32_bf16 v227, v57, s61, v227
v_dot2_f32_bf16 v228, v58, s60, v228
v_dot2_f32_bf16 v229, v58, s61, v229
v_dot2_f32_bf16 v230, v59, s60, v230
v_dot2_f32_bf16 v231, v59, s61, v231
v_dot2_f32_bf16 v224, v60, s60, v224
v_dot2_f32_bf16 v225, v60, s61, v225
v_dot2_f32_bf16 v226, v61, s60, v226
v_dot2_f32_bf16 v227, v61, s61, v227
v_dot2_f32_bf16 v228, v62, s60, v228
v_dot2_f32_bf16 v229, v62, s61, v229
v_dot2_f32_bf16 v230, v63, s60, v230
v_dot2_f32_bf16 v231, v63, s61, v231
s_nop 1
v_pk_fma_f32 v[112:113], v[224:225], v[144:145], v[112:113]
v_pk_fma_f32 v[114:115], v[226:227], v[146:147], v[114:115]
v_pk_fma_f32 v[116:117], v[228:229], v[148:149], v[116:117]
v_pk_fma_f32 v[118:119], v[230:231], v[150:151], v[118:119]
v_cvt_pk_bf16_f32 v88, v112, v113
v_cvt_pk_bf16_f32 v89, v114, v115
v_cvt_pk_bf16_f32 v90, v116, v117
v_cvt_pk_bf16_f32 v91, v118, v119
s_add_u32 s39, s49, 12591104
buffer_store_dwordx4 v[88:91], v6, s[4:7], s39 offen sc1
v_lshlrev_b32 v112, 16, v88
v_and_b32 v113, 0xffff0000, v88
v_lshlrev_b32 v114, 16, v89
v_and_b32 v115, 0xffff0000, v89
v_lshlrev_b32 v116, 16, v90
v_and_b32 v117, 0xffff0000, v90
v_lshlrev_b32 v118, 16, v91
v_and_b32 v119, 0xffff0000, v91
s_waitcnt vmcnt(3)
v_dot2_f32_bf16 v224, v64, s60, 0
v_dot2_f32_bf16 v225, v64, s61, 0
v_dot2_f32_bf16 v226, v65, s60, 0
v_dot2_f32_bf16 v227, v65, s61, 0
v_dot2_f32_bf16 v228, v66, s60, 0
v_dot2_f32_bf16 v229, v66, s61, 0
v_dot2_f32_bf16 v230, v67, s60, 0
v_dot2_f32_bf16 v231, v67, s61, 0
v_dot2_f32_bf16 v224, v68, s60, v224
v_dot2_f32_bf16 v225, v68, s61, v225
v_dot2_f32_bf16 v226, v69, s60, v226
v_dot2_f32_bf16 v227, v69, s61, v227
v_dot2_f32_bf16 v228, v70, s60, v228
v_dot2_f32_bf16 v229, v70, s61, v229
v_dot2_f32_bf16 v230, v71, s60, v230
v_dot2_f32_bf16 v231, v71, s61, v231
v_dot2_f32_bf16 v224, v72, s60, v224
v_dot2_f32_bf16 v225, v72, s61, v225
v_dot2_f32_bf16 v226, v73, s60, v226
v_dot2_f32_bf16 v227, v73, s61, v227
v_dot2_f32_bf16 v228, v74, s60, v228
v_dot2_f32_bf16 v229, v74, s61, v229
v_dot2_f32_bf16 v230, v75, s60, v230
v_dot2_f32_bf16 v231, v75, s61, v231
v_dot2_f32_bf16 v224, v76, s60, v224
v_dot2_f32_bf16 v225, v76, s61, v225
v_dot2_f32_bf16 v226, v77, s60, v226
v_dot2_f32_bf16 v227, v77, s61, v227
v_dot2_f32_bf16 v228, v78, s60, v228
v_dot2_f32_bf16 v229, v78, s61, v229
v_dot2_f32_bf16 v230, v79, s60, v230
v_dot2_f32_bf16 v231, v79, s61, v231
s_nop 1
v_pk_fma_f32 v[120:121], v[224:225], v[152:153], v[120:121]
v_pk_fma_f32 v[122:123], v[226:227], v[154:155], v[122:123]
v_pk_fma_f32 v[124:125], v[228:229], v[156:157], v[124:125]
v_pk_fma_f32 v[126:127], v[230:231], v[158:159], v[126:127]
v_cvt_pk_bf16_f32 v92, v120, v121
v_cvt_pk_bf16_f32 v93, v122, v123
v_cvt_pk_bf16_f32 v94, v124, v125
v_cvt_pk_bf16_f32 v95, v126, v127
s_add_u32 s39, s49, 12595200
buffer_store_dwordx4 v[92:95], v6, s[4:7], s39 offen sc1
v_lshlrev_b32 v120, 16, v92
v_and_b32 v121, 0xffff0000, v92
v_lshlrev_b32 v122, 16, v93
v_and_b32 v123, 0xffff0000, v93
v_lshlrev_b32 v124, 16, v94
v_and_b32 v125, 0xffff0000, v94
v_lshlrev_b32 v126, 16, v95
v_and_b32 v127, 0xffff0000, v95
v_pk_add_f32 v[224:225], v[96:97], v[98:99]
v_pk_add_f32 v[224:225], v[224:225], v[100:101]
v_pk_add_f32 v[224:225], v[224:225], v[102:103]
v_pk_add_f32 v[224:225], v[224:225], v[104:105]
v_pk_add_f32 v[224:225], v[224:225], v[106:107]
v_pk_add_f32 v[224:225], v[224:225], v[108:109]
v_pk_add_f32 v[224:225], v[224:225], v[110:111]
v_pk_add_f32 v[224:225], v[224:225], v[112:113]
v_pk_add_f32 v[224:225], v[224:225], v[114:115]
v_pk_add_f32 v[224:225], v[224:225], v[116:117]
v_pk_add_f32 v[224:225], v[224:225], v[118:119]
v_pk_add_f32 v[224:225], v[224:225], v[120:121]
v_pk_add_f32 v[224:225], v[224:225], v[122:123]
v_pk_add_f32 v[224:225], v[224:225], v[124:125]
v_pk_add_f32 v[224:225], v[224:225], v[126:127]
v_add_f32 v224, v224, v225
s_nop 1
v_add_f32_dpp v224, v224, v224 row_ror:8 row_mask:0xf bank_mask:0xf
v_mov_b32 v225, v224
s_nop 1
v_permlane16_swap_b32 v224, v225
s_nop 0
v_add_f32 v224, v224, v225
v_mov_b32 v225, v224
s_nop 1
v_permlane32_swap_b32 v224, v225
s_nop 0
v_add_f32 v224, v224, v225
ds_write_b32 v11, v224 offset:512
s_waitcnt lgkmcnt(0)
s_barrier
ds_read_b128 v[224:227], v12 offset:512
s_waitcnt lgkmcnt(0)
v_pk_add_f32 v[224:225], v[224:225], v[226:227]
v_add_f32 v224, v224, v225
v_mul_f32 v224, 0x3a800000, v224
v_pk_add_f32 v[96:97], v[96:97], v[224:225] op_sel_hi:[1,0] neg_lo:[0,1] neg_hi:[0,1]
v_pk_add_f32 v[98:99], v[98:99], v[224:225] op_sel_hi:[1,0] neg_lo:[0,1] neg_hi:[0,1]
v_pk_add_f32 v[100:101], v[100:101], v[224:225] op_sel_hi:[1,0] neg_lo:[0,1] neg_hi:[0,1]
v_pk_add_f32 v[102:103], v[102:103], v[224:225] op_sel_hi:[1,0] neg_lo:[0,1] neg_hi:[0,1]
v_pk_add_f32 v[104:105], v[104:105], v[224:225] op_sel_hi:[1,0] neg_lo:[0,1] neg_hi:[0,1]
v_pk_add_f32 v[106:107], v[106:107], v[224:225] op_sel_hi:[1,0] neg_lo:[0,1] neg_hi:[0,1]
v_pk_add_f32 v[108:109], v[108:109], v[224:225] op_sel_hi:[1,0] neg_lo:[0,1] neg_hi:[0,1]
v_pk_add_f32 v[110:111], v[110:111], v[224:225] op_sel_hi:[1,0] neg_lo:[0,1] neg_hi:[0,1]
v_pk_add_f32 v[112:113], v[112:113], v[224:225] op_sel_hi:[1,0] neg_lo:[0,1] neg_hi:[0,1]
v_pk_add_f32 v[114:115], v[114:115], v[224:225] op_sel_hi:[1,0] neg_lo:[0,1] neg_hi:[0,1]
v_pk_add_f32 v[116:117], v[116:117], v[224:225] op_sel_hi:[1,0] neg_lo:[0,1] neg_hi:[0,1]
v_pk_add_f32 v[118:119], v[118:119], v[224:225] op_sel_hi:[1,0] neg_lo:[0,1] neg_hi:[0,1]
v_pk_add_f32 v[120:121], v[120:121], v[224:225] op_sel_hi:[1,0] neg_lo:[0,1] neg_hi:[0,1]
v_pk_add_f32 v[122:123], v[122:123], v[224:225] op_sel_hi:[1,0] neg_lo:[0,1] neg_hi:[0,1]
v_pk_add_f32 v[124:125], v[124:125], v[224:225] op_sel_hi:[1,0] neg_lo:[0,1] neg_hi:[0,1]
v_pk_add_f32 v[126:127], v[126:127], v[224:225] op_sel_hi:[1,0] neg_lo:[0,1] neg_hi:[0,1]
v_pk_mul_f32 v[224:225], v[96:97], v[96:97]
v_pk_fma_f32 v[224:225], v[98:99], v[98:99], v[224:225]
v_pk_fma_f32 v[224:225], v[100:101], v[100:101], v[224:225]
v_pk_fma_f32 v[224:225], v[102:103], v[102:103], v[224:225]
v_pk_fma_f32 v[224:225], v[104:105], v[104:105], v[224:225]
v_pk_fma_f32 v[224:225], v[106:107], v[106:107], v[224:225]
v_pk_fma_f32 v[224:225], v[108:109], v[108:109], v[224:225]
v_pk_fma_f32 v[224:225], v[110:111], v[110:111], v[224:225]
v_pk_fma_f32 v[224:225], v[112:113], v[112:113], v[224:225]
v_pk_fma_f32 v[224:225], v[114:115], v[114:115], v[224:225]
v_pk_fma_f32 v[224:225], v[116:117], v[116:117], v[224:225]
v_pk_fma_f32 v[224:225], v[118:119], v[118:119], v[224:225]
v_pk_fma_f32 v[224:225], v[120:121], v[120:121], v[224:225]
v_pk_fma_f32 v[224:225], v[122:123], v[122:123], v[224:225]
v_pk_fma_f32 v[224:225], v[124:125], v[124:125], v[224:225]
v_pk_fma_f32 v[224:225], v[126:127], v[126:127], v[224:225]
v_add_f32 v224, v224, v225
s_nop 1
v_add_f32_dpp v224, v224, v224 row_ror:8 row_mask:0xf bank_mask:0xf
v_mov_b32 v225, v224
s_nop 1
v_permlane16_swap_b32 v224, v225
s_nop 0
v_add_f32 v224, v224, v225
v_mov_b32 v225, v224
s_nop 1
v_permlane32_swap_b32 v224, v225
s_nop 0
v_add_f32 v224, v224, v225
ds_write_b32 v11, v224 offset:768
s_waitcnt lgkmcnt(0)
s_barrier
ds_read_b128 v[224:227], v12 offset:768
s_waitcnt lgkmcnt(0)
v_pk_add_f32 v[224:225], v[224:225], v[226:227]
v_add_f32 v224, v224, v225
v_mul_f32 v224, 0x3a800000, v224
v_add_f32 v224, 0x3727c5ac, v224
v_rsq_f32 v224, v224
s_nop 0
v_pk_mul_f32 v[96:97], v[96:97], v[224:225] op_sel_hi:[1,0]
v_pk_mul_f32 v[98:99], v[98:99], v[224:225] op_sel_hi:[1,0]
v_pk_mul_f32 v[100:101], v[100:101], v[224:225] op_sel_hi:[1,0]
v_pk_mul_f32 v[102:103], v[102:103], v[224:225] op_sel_hi:[1,0]
v_pk_mul_f32 v[104:105], v[104:105], v[224:225] op_sel_hi:[1,0]
v_pk_mul_f32 v[106:107], v[106:107], v[224:225] op_sel_hi:[1,0]
v_pk_mul_f32 v[108:109], v[108:109], v[224:225] op_sel_hi:[1,0]
v_pk_mul_f32 v[110:111], v[110:111], v[224:225] op_sel_hi:[1,0]
v_pk_mul_f32 v[112:113], v[112:113], v[224:225] op_sel_hi:[1,0]
v_pk_mul_f32 v[114:115], v[114:115], v[224:225] op_sel_hi:[1,0]
v_pk_mul_f32 v[116:117], v[116:117], v[224:225] op_sel_hi:[1,0]
v_pk_mul_f32 v[118:119], v[118:119], v[224:225] op_sel_hi:[1,0]
v_pk_mul_f32 v[120:121], v[120:121], v[224:225] op_sel_hi:[1,0]
v_pk_mul_f32 v[122:123], v[122:123], v[224:225] op_sel_hi:[1,0]
v_pk_mul_f32 v[124:125], v[124:125], v[224:225] op_sel_hi:[1,0]
v_pk_mul_f32 v[126:127], v[126:127], v[224:225] op_sel_hi:[1,0]
v_pk_fma_f32 v[96:97], v[96:97], v[160:161], v[192:193]
v_pk_fma_f32 v[98:99], v[98:99], v[162:163], v[194:195]
v_pk_fma_f32 v[100:101], v[100:101], v[164:165], v[196:197]
v_pk_fma_f32 v[102:103], v[102:103], v[166:167], v[198:199]
v_cvt_pk_bf16_f32 v16, v96, v97
v_cvt_pk_bf16_f32 v17, v98, v99
v_cvt_pk_bf16_f32 v18, v100, v101
v_cvt_pk_bf16_f32 v19, v102, v103
s_add_u32 s39, s49, 16777216
buffer_store_dwordx4 v[16:19], v6, s[4:7], s39 offen sc1
v_pk_fma_f32 v[104:105], v[104:105], v[168:169], v[200:201]
v_pk_fma_f32 v[106:107], v[106:107], v[170:171], v[202:203]
v_pk_fma_f32 v[108:109], v[108:109], v[172:173], v[204:205]
v_pk_fma_f32 v[110:111], v[110:111], v[174:175], v[206:207]
v_cvt_pk_bf16_f32 v20, v104, v105
v_cvt_pk_bf16_f32 v21, v106, v107
v_cvt_pk_bf16_f32 v22, v108, v109
v_cvt_pk_bf16_f32 v23, v110, v111
s_add_u32 s39, s49, 16781312
buffer_store_dwordx4 v[20:23], v6, s[4:7], s39 offen sc1
v_pk_fma_f32 v[112:113], v[112:113], v[176:177], v[208:209]
v_pk_fma_f32 v[114:115], v[114:115], v[178:179], v[210:211]
v_pk_fma_f32 v[116:117], v[116:117], v[180:181], v[212:213]
v_pk_fma_f32 v[118:119], v[118:119], v[182:183], v[214:215]
v_cvt_pk_bf16_f32 v24, v112, v113
v_cvt_pk_bf16_f32 v25, v114, v115
v_cvt_pk_bf16_f32 v26, v116, v117
v_cvt_pk_bf16_f32 v27, v118, v119
s_add_u32 s39, s49, 16785408
buffer_store_dwordx4 v[24:27], v6, s[4:7], s39 offen sc1
v_pk_fma_f32 v[120:121], v[120:121], v[184:185], v[216:217]
v_pk_fma_f32 v[122:123], v[122:123], v[186:187], v[218:219]
v_pk_fma_f32 v[124:125], v[124:125], v[188:189], v[220:221]
v_pk_fma_f32 v[126:127], v[126:127], v[190:191], v[222:223]
v_cvt_pk_bf16_f32 v28, v120, v121
v_cvt_pk_bf16_f32 v29, v122, v123
v_cvt_pk_bf16_f32 v30, v124, v125
v_cvt_pk_bf16_f32 v31, v126, v127
s_add_u32 s39, s49, 16789504
buffer_store_dwordx4 v[28:31], v6, s[4:7], s39 offen sc1
v_mov_b32 v5, s48
s_waitcnt vmcnt(0)
s_barrier
buffer_store_dword v5, v4, s[4:7], 0 offen sc1
s_add_u32 s36, s36, 2
s_cmp_lt_u32 s36, 64
s_cbranch_scc1 Lln_625
s_endpgm
Lcode_end:

.section .rodata,"a"
.p2align 6
.amdhsa_kernel adaLN_cond__memory_aug_recurrent_mem_tr__glu_gated_swiglu__prompt_kernel
  .amdhsa_next_free_vgpr 512
  .amdhsa_next_free_sgpr 102
  .amdhsa_accum_offset 256
  .amdhsa_group_segment_fixed_size 0
  .amdhsa_kernarg_size 128
  .amdhsa_user_sgpr_count 2
  .amdhsa_user_sgpr_kernarg_segment_ptr 1
  .amdhsa_system_sgpr_workgroup_id_x 1
  .amdhsa_float_denorm_mode_32 3
.end_amdhsa_kernel
```

```asm
; @launch grid=(256,1,1) block=(256,1,1) lds=163840
.amdgcn_target "amdgcn-amd-amdhsa--gfx950"
.text
.globl adaLN_cond__memory_aug_recurrent_mem_tr__glu_gated_swiglu__prompt_kernel
.p2align 8
.type adaLN_cond__memory_aug_recurrent_mem_tr__glu_gated_swiglu__prompt_kernel,@function
adaLN_cond__memory_aug_recurrent_mem_tr__glu_gated_swiglu__prompt_kernel:
s_cmp_ge_u32 s2, 256
s_cbranch_scc1 Lend_1
s_load_dwordx8 s[16:23], s[0:1], 8
s_load_dwordx2 s[24:25], s[0:1], 40
s_load_dwordx4 s[28:31], s[0:1], 112
s_getreg_b32 s51, hwreg(HW_REG_XCC_ID, 0, 4)
s_and_b32 s51, s51, 7
v_lshrrev_b32 v1, 6, v0
s_nop 0
v_readfirstlane_b32 s32, v1
v_and_b32 v1, 63, v0
s_waitcnt lgkmcnt(0)
s_mov_b32 s4, s30
s_and_b32 s5, s31, 0xffff
s_mov_b32 s6, 0x10000000
s_mov_b32 s7, 0x20000
s_mov_b32 s12, s28
s_and_b32 s13, s29, 0xffff
s_mov_b32 s14, 0x100
s_mov_b32 s15, 0x20000
s_mov_b32 s37, 200000
s_mov_b32 s80, 0
s_mov_b32 s81, 0
s_mov_b32 s82, 0
s_mov_b32 s83, 0
s_cmp_lg_u32 s32, 0
s_cbranch_scc1 Lrs_10
s_mov_b32 s33, s51
s_mov_b32 s35, 0
s_mov_b64 exec, 1
Lrl_9:
s_and_b32 s38, s33, 4
s_mul_i32 s38, s38, 7
s_add_u32 s38, s38, s33
v_lshlrev_b32 v2, 2, s38
v_mov_b32 v3, 1
buffer_atomic_add v3, v2, s[12:15], 0 offen sc0 sc1
s_waitcnt vmcnt(0)
v_readfirstlane_b32 s34, v3
s_nop 3
s_cmp_lt_u32 s34, 32
s_cbranch_scc1 Lrg_8
s_add_u32 s33, s33, 1
s_and_b32 s33, s33, 7
s_add_u32 s35, s35, 1
s_cmp_lt_u32 s35, 8
s_cbranch_scc1 Lrl_9
Lrg_8:
s_lshl_b32 s38, s33, 8
s_min_u32 s34, s34, 255
s_or_b32 s38, s38, s34
s_lshl_b32 s39, s35, 16
s_or_b32 s38, s38, s39
v_mov_b32 v3, s38
v_mov_b32 v2, 0
ds_write_b32 v2, v3
s_mov_b64 exec, -1
Lrs_10:
s_waitcnt lgkmcnt(0)
s_barrier
v_mov_b32 v2, 0
ds_read_b32 v3, v2
s_waitcnt lgkmcnt(0)
v_readfirstlane_b32 s38, v3
s_barrier
s_and_b32 s34, s38, 255
s_bfe_u32 s33, s38, 0x80008
s_lshr_b32 s35, s38, 16
s_min_u32 s35, s35, 1
s_cmp_ge_u32 s34, 32
s_cbranch_scc1 Lend_1
s_cmp_ge_u32 s33, 4
s_cselect_b32 s38, 16, 24
s_add_u32 s34, s34, s38
s_and_b32 s34, s34, 31
s_getpc_b64 s[40:41]
Lcode_here:
s_lshl_b32 s42, s34, 12
v_lshl_add_u32 v2, v0, 4, s42
v_min_u32 v2, Lcode_end-Lcode_here-16, v2
v_mov_b32 v3, s41
v_add_co_u32 v2, vcc, s40, v2
s_nop 1
v_addc_co_u32 v3, vcc, 0, v3, vcc
global_load_dword v255, v[2:3], off
s_cmp_ge_u32 s33, 4
s_cbranch_scc1 Lhi_4
s_cmp_ge_u32 s34, 24
s_cbranch_scc1 Lg3_3
s_cmp_ge_u32 s34, 8
s_cbranch_scc1 Lkvo_2
v_mov_b32 v48, v0
v_mov_b32 v50, v1
s_lshl_b32 s54, s33, 3
s_add_u32 s54, s54, s34
s_and_b32 s55, s32, 1
s_lshr_b32 s56, s32, 1
s_lshl_b32 s45, s33, 18
s_add_u32 s45, s45, 2097152
s_lshl_b32 s38, s32, 12
v_lshl_add_u32 v10, v50, 4, s38
s_lshl_b32 s38, s34, 11
s_add_u32 s39, s38, 16384
v_lshl_add_u32 v11, v50, 4, s39
s_lshl_b32 s39, s56, 10
s_add_u32 s38, s38, s39
s_lshl_b32 s39, s55, 9
s_add_u32 s39, s39, s38
s_add_u32 s39, s39, 32768
v_lshl_add_u32 v12, v50, 3, s39
v_xor_b32 v13, 512, v12
s_add_u32 s39, s39, 16384
v_mov_b32 v14, s39
v_bfe_u32 v51, v50, 5, 1
v_lshl_add_u32 v14, v51, 8, v14
v_bfe_u32 v51, v50, 1, 2
v_lshl_add_u32 v14, v51, 6, v14
v_bfe_u32 v51, v50, 4, 1
v_lshl_add_u32 v14, v51, 5, v14
v_bfe_u32 v51, v50, 0, 1
v_lshl_add_u32 v14, v51, 4, v14
v_bfe_u32 v51, v50, 3, 1
v_lshl_add_u32 v14, v51, 30, v14
v_bfe_u32 v15, v50, 1, 1
v_mul_u32_u24 v15, 0xaaaa, v15
v_add_u32 v15, 0x4444, v15
v_mov_b32 v200, 0
v_mov_b32 v201, 0
v_mov_b32 v202, 0
v_mov_b32 v203, 0
v_mov_b32 v204, 0
v_mov_b32 v205, 0
v_mov_b32 v206, 0
v_mov_b32 v207, 0
s_xor_b32 s38, s32, 3
s_mul_i32 s38, s38, 3072
s_add_u32 s38, s38, 0
v_lshl_add_u32 v211, v50, 4, s38
s_xor_b32 s38, s32, 2
s_mul_i32 s38, s38, 3072
s_add_u32 s38, s38, 1024
v_lshl_add_u32 v212, v50, 4, s38
s_xor_b32 s38, s32, 1
s_mul_i32 s38, s38, 3072
s_add_u32 s38, s38, 2048
v_lshl_add_u32 v213, v50, 4, s38
s_mul_i32 s38, s32, 3072
v_lshl_add_u32 v18, v50, 4, s38
s_lshl_b32 s38, s32, 9
v_and_b32 v51, 15, v50
v_lshl_add_u32 v19, v51, 4, s38
v_lshrrev_b32 v51, 4, v50
v_lshl_add_u32 v19, v51, 2, v19
v_lshrrev_b32 v51, 2, v50
v_and_b32 v52, 1, v50
v_lshlrev_b32 v52, 3, v52
v_lshl_add_u32 v20, v51, 4, v52
v_lshlrev_b32 v51, 4, v50
s_mul_i32 s38, s32, 6144
v_add_u32 v21, s38, v51
s_add_u32 s57, s38, 32768
v_add_u32 v22, 40960, v51
s_lshl_b32 s38, s55, 12
s_add_u32 s38, s38, 32768
v_add_u32 v23, s38, v51
s_lshl_b32 s38, s32, 11
s_add_u32 s38, s38, 49152
v_add_u32 v24, s38, v51
v_xor_b32 v25, 2048, v24
s_lshl_b32 s59, s33, 12
s_add_u32 s59, s59, 3276800
s_lshl_b32 s38, s32, 8
v_lshl_add_u32 v192, v50, 2, s38
s_lshr_b32 s38, s34, 1
s_lshl_b32 s38, s38, 8
s_and_b32 s39, s34, 1
s_lshl_b32 s39, s39, 2
s_add_u32 s38, s38, s39
s_add_u32 s38, s38, 2048
v_min_u32 v52, 1, v48
v_lshl_add_u32 v193, v52, 30, s38
v_mov_b32 v197, 0
buffer_store_dword v197, v193, s[4:7], s59 offen sc1
s_lshr_b32 s38, s34, 2
s_lshl_b32 s38, s38, 14
s_and_b32 s39, s34, 3
s_lshl_b32 s39, s39, 11
s_add_u32 s38, s38, s39
s_lshl_b32 s39, s33, 16
s_add_u32 s38, s38, s39
v_lshl_add_u32 v198, v48, 3, s38
s_lshl_b32 s38, s54, 2
s_add_u32 s38, s38, s32
s_lshl_b32 s38, s38, 11
s_lshl_b32 s39, s55, 10
s_add_u32 s38, s38, s39
v_add_u32 v26, s38, v51
v_xor_b32 v27, 2048, v26
s_lshl_b32 s38, s54, 5
s_add_u32 s38, s38, s32
s_lshl_b32 s38, s38, 2
s_add_u32 s38, s38, 3432448
v_min_u32 v52, 1, v50
v_lshl_add_u32 v199, v52, 30, s38
buffer_store_dword v197, v199, s[4:7], 0 offen sc1
v_min_u32 v53, 15, v50
v_lshlrev_b32 v53, 7, v53
s_lshr_b32 s38, s54, 2
s_lshl_b32 s38, s38, 10
s_add_u32 s38, s38, 3407872
v_add_u32 v208, s38, v53
s_lshl_b32 s38, s33, 10
s_add_u32 s38, s38, 3435520
v_add_u32 v53, s38, v53
v_cmp_lt_u32 vcc, 7, v50
s_nop 1
v_cndmask_b32 v208, v208, v53, vcc
v_cndmask_b32 v210, 0, 8, vcc
v_mov_b32 v28, -1
v_mov_b32 v32, 0x3f803f80
v_mov_b32 v29, -1
v_mov_b32 v33, 0x3f803f80
v_mov_b32 v30, -1
v_mov_b32 v34, 0x3f803f80
v_mov_b32 v31, -1
v_mov_b32 v35, 0x3f803f80
v_and_b32 v51, 15, v50
s_lshl_b32 s38, s55, 4
v_add_u32 v51, s38, v51
v_lshrrev_b32 v52, 4, v50
v_lshlrev_b32 v52, 2, v52
v_mov_b32 v54, 0xf149f2ca
v_add_u32 v53, 0, v52
v_cmp_gt_u32 vcc, v53, v51
s_nop 1
v_cndmask_b32 v36, 0, v54, vcc
v_add_u32 v53, 1, v52
v_cmp_gt_u32 vcc, v53, v51
s_nop 1
v_cndmask_b32 v37, 0, v54, vcc
v_add_u32 v53, 2, v52
v_cmp_gt_u32 vcc, v53, v51
s_nop 1
v_cndmask_b32 v38, 0, v54, vcc
v_add_u32 v53, 3, v52
v_cmp_gt_u32 vcc, v53, v51
s_nop 1
v_cndmask_b32 v39, 0, v54, vcc
v_add_u32 v53, 16, v52
v_cmp_gt_u32 vcc, v53, v51
s_nop 1
v_cndmask_b32 v40, 0, v54, vcc
v_add_u32 v53, 17, v52
v_cmp_gt_u32 vcc, v53, v51
s_nop 1
v_cndmask_b32 v41, 0, v54, vcc
v_add_u32 v53, 18, v52
v_cmp_gt_u32 vcc, v53, v51
s_nop 1
v_cndmask_b32 v42, 0, v54, vcc
v_add_u32 v53, 19, v52
v_cmp_gt_u32 vcc, v53, v51
s_nop 1
v_cndmask_b32 v43, 0, v54, vcc
v_mov_b32 v0, 0
v_mov_b32 v1, 0
v_mov_b32 v2, 0
v_mov_b32 v3, 0
v_mov_b32 v4, 0
v_mov_b32 v5, 0
v_mov_b32 v6, 0
v_mov_b32 v7, 0
v_mov_b32 v8, 0
v_mov_b32 v9, 0
s_mov_b32 s48, 0x3e0293ee
s_mov_b32 s49, 0xbe0293ee
s_add_u32 s38, s45, 0
buffer_store_dwordx4 v[28:31], v14, s[4:7], s38 offen sc1
s_add_u32 s38, s45, 65536
buffer_store_dwordx4 v[28:31], v14, s[4:7], s38 offen sc1
s_add_u32 s38, s45, 131072
buffer_store_dwordx4 v[28:31], v14, s[4:7], s38 offen sc1
s_add_u32 s38, s45, 196608
buffer_store_dwordx4 v[28:31], v14, s[4:7], s38 offen sc1
s_lshl_b32 s52, s35, 16
s_or_b32 s52, s52, 1
s_waitcnt vmcnt(0)
s_barrier
s_cmp_lg_u32 s32, 0
s_cbranch_scc1 Lar_11
s_mov_b64 exec, 1
v_mov_b32 v48, 32
v_mov_b32 v49, s52
buffer_atomic_add v49, v48, s[12:15], 0 offen sc1
s_mov_b64 exec, -1
Lar_11:
s_xor_b32 s52, s32, 3
s_lshl_b32 s52, s52, 6
v_and_b32 v54, 7, v50
v_lshlrev_b32 v54, 4, v54
v_xor_b32 v54, s52, v54
v_lshrrev_b32 v51, 3, v50
v_lshl_add_u32 v51, v51, 13, v54
s_xor_b32 s52, s32, 1
s_lshl_b32 s52, s52, 6
v_and_b32 v54, 7, v50
v_lshlrev_b32 v54, 4, v54
v_xor_b32 v54, s52, v54
v_lshrrev_b32 v52, 3, v50
v_lshl_add_u32 v52, v52, 13, v54
v_bfe_u32 v53, v50, 2, 1
v_bfe_u32 v54, v50, 5, 1
v_lshl_add_u32 v53, v54, 4, v53
v_bfe_u32 v54, v50, 4, 1
v_lshl_add_u32 v53, v54, 2, v53
v_bfe_u32 v54, v50, 3, 1
v_lshl_add_u32 v53, v54, 3, v53
s_mul_i32 s38, s32, 40960
v_lshl_add_u32 v53, v53, 7, s38
v_bfe_u32 v54, v50, 0, 1
v_lshl_add_u32 v53, v54, 3, v53
v_bfe_u32 v54, v50, 1, 1
v_lshl_add_u32 v53, v54, 4, v53
s_mov_b32 s8, s18
s_and_b32 s9, s19, 0xffff
s_mov_b32 s10, 0x800000
s_mov_b32 s11, 0x20000
s_lshl_b32 s39, s32, 21
s_lshl_b32 s38, s54, 8
s_add_u32 s39, s39, s38
s_add_u32 s39, s39, 1572864
s_mul_i32 s38, s32, 40960
s_add_u32 m0, s38, 0
s_nop 0
buffer_load_dwordx4 v52, s[8:11], s39 offen lds
s_add_u32 m0, m0, 1024
s_add_u32 s39, s39, 65536
buffer_load_dwordx4 v52, s[8:11], s39 offen lds
s_add_u32 m0, m0, 1024
s_add_u32 s39, s39, 65536
buffer_load_dwordx4 v52, s[8:11], s39 offen lds
s_add_u32 m0, m0, 1024
s_add_u32 s39, s39, 65536
buffer_load_dwordx4 v52, s[8:11], s39 offen lds
s_add_u32 m0, m0, 1024
s_add_u32 s39, s39, 65536
buffer_load_dwordx4 v52, s[8:11], s39 offen lds
s_add_u32 m0, m0, 1024
s_add_u32 s39, s39, 65536
buffer_load_dwordx4 v52, s[8:11], s39 offen lds
s_add_u32 m0, m0, 1024
s_add_u32 s39, s39, 65536
buffer_load_dwordx4 v52, s[8:11], s39 offen lds
s_add_u32 m0, m0, 1024
s_add_u32 s39, s39, 65536
buffer_load_dwordx4 v52, s[8:11], s39 offen lds
s_lshl_b32 s39, s32, 21
s_lshl_b32 s38, s54, 8
s_add_u32 s39, s39, s38
s_add_u32 s39, s39, 1572864
s_mul_i32 s38, s32, 40960
s_add_u32 m0, s38, 8192
s_nop 0
buffer_load_dwordx4 v51, s[8:11], s39 offen lds
s_add_u32 m0, m0, 1024
s_add_u32 s39, s39, 65536
buffer_load_dwordx4 v51, s[8:11], s39 offen lds
s_add_u32 m0, m0, 1024
s_add_u32 s39, s39, 65536
buffer_load_dwordx4 v51, s[8:11], s39 offen lds
s_add_u32 m0, m0, 1024
s_add_u32 s39, s39, 65536
buffer_load_dwordx4 v51, s[8:11], s39 offen lds
s_add_u32 m0, m0, 1024
s_add_u32 s39, s39, 65536
buffer_load_dwordx4 v51, s[8:11], s39 offen lds
s_add_u32 m0, m0, 1024
s_add_u32 s39, s39, 65536
buffer_load_dwordx4 v51, s[8:11], s39 offen lds
s_add_u32 m0, m0, 1024
s_add_u32 s39, s39, 65536
buffer_load_dwordx4 v51, s[8:11], s39 offen lds
s_add_u32 m0, m0, 1024
s_add_u32 s39, s39, 65536
buffer_load_dwordx4 v51, s[8:11], s39 offen lds
s_lshl_b32 s39, s32, 21
s_lshl_b32 s38, s54, 8
s_add_u32 s39, s39, s38
s_add_u32 s39, s39, 1048576
s_mul_i32 s38, s32, 40960
s_add_u32 m0, s38, 16384
s_nop 0
buffer_load_dwordx4 v52, s[8:11], s39 offen lds
s_add_u32 m0, m0, 1024
s_add_u32 s39, s39, 65536
buffer_load_dwordx4 v52, s[8:11], s39 offen lds
s_add_u32 m0, m0, 1024
s_add_u32 s39, s39, 65536
buffer_load_dwordx4 v52, s[8:11], s39 offen lds
s_add_u32 m0, m0, 1024
s_add_u32 s39, s39, 65536
buffer_load_dwordx4 v52, s[8:11], s39 offen lds
s_add_u32 m0, m0, 1024
s_add_u32 s39, s39, 65536
buffer_load_dwordx4 v52, s[8:11], s39 offen lds
s_add_u32 m0, m0, 1024
s_add_u32 s39, s39, 65536
buffer_load_dwordx4 v52, s[8:11], s39 offen lds
s_add_u32 m0, m0, 1024
s_add_u32 s39, s39, 65536
buffer_load_dwordx4 v52, s[8:11], s39 offen lds
s_add_u32 m0, m0, 1024
s_add_u32 s39, s39, 65536
buffer_load_dwordx4 v52, s[8:11], s39 offen lds
s_lshl_b32 s39, s32, 21
s_lshl_b32 s38, s54, 8
s_add_u32 s39, s39, s38
s_add_u32 s39, s39, 1048576
s_mul_i32 s38, s32, 40960
s_add_u32 m0, s38, 24576
s_nop 0
buffer_load_dwordx4 v51, s[8:11], s39 offen lds
s_add_u32 m0, m0, 1024
s_add_u32 s39, s39, 65536
buffer_load_dwordx4 v51, s[8:11], s39 offen lds
s_add_u32 m0, m0, 1024
s_add_u32 s39, s39, 65536
buffer_load_dwordx4 v51, s[8:11], s39 offen lds
s_add_u32 m0, m0, 1024
s_add_u32 s39, s39, 65536
buffer_load_dwordx4 v51, s[8:11], s39 offen lds
s_add_u32 m0, m0, 1024
s_add_u32 s39, s39, 65536
buffer_load_dwordx4 v51, s[8:11], s39 offen lds
s_add_u32 m0, m0, 1024
s_add_u32 s39, s39, 65536
buffer_load_dwordx4 v51, s[8:11], s39 offen lds
s_add_u32 m0, m0, 1024
s_add_u32 s39, s39, 65536
buffer_load_dwordx4 v51, s[8:11], s39 offen lds
s_add_u32 m0, m0, 1024
s_add_u32 s39, s39, 65536
buffer_load_dwordx4 v51, s[8:11], s39 offen lds
s_lshl_b32 s39, s32, 21
s_lshl_b32 s38, s54, 8
s_add_u32 s39, s39, s38
s_add_u32 s39, s39, 524288
s_mul_i32 s38, s32, 40960
s_add_u32 m0, s38, 32768
s_nop 0
buffer_load_dwordx4 v52, s[8:11], s39 offen lds
s_add_u32 m0, m0, 1024
s_add_u32 s39, s39, 65536
buffer_load_dwordx4 v52, s[8:11], s39 offen lds
s_add_u32 m0, m0, 1024
s_add_u32 s39, s39, 65536
buffer_load_dwordx4 v52, s[8:11], s39 offen lds
s_add_u32 m0, m0, 1024
s_add_u32 s39, s39, 65536
buffer_load_dwordx4 v52, s[8:11], s39 offen lds
s_add_u32 m0, m0, 1024
s_add_u32 s39, s39, 65536
buffer_load_dwordx4 v52, s[8:11], s39 offen lds
s_add_u32 m0, m0, 1024
s_add_u32 s39, s39, 65536
buffer_load_dwordx4 v52, s[8:11], s39 offen lds
s_add_u32 m0, m0, 1024
s_add_u32 s39, s39, 65536
buffer_load_dwordx4 v52, s[8:11], s39 offen lds
s_add_u32 m0, m0, 1024
s_add_u32 s39, s39, 65536
buffer_load_dwordx4 v52, s[8:11], s39 offen lds
s_waitcnt vmcnt(32)
ds_read_b64_tr_b16 a[224:225], v53 offset:0
ds_read_b64_tr_b16 a[226:227], v53 offset:256
ds_read_b64_tr_b16 a[228:229], v53 offset:4096
ds_read_b64_tr_b16 a[230:231], v53 offset:4352
ds_read_b64_tr_b16 a[232:233], v53 offset:32
ds_read_b64_tr_b16 a[234:235], v53 offset:288
ds_read_b64_tr_b16 a[236:237], v53 offset:4128
ds_read_b64_tr_b16 a[238:239], v53 offset:4384
ds_read_b64_tr_b16 a[240:241], v53 offset:64
ds_read_b64_tr_b16 a[242:243], v53 offset:320
ds_read_b64_tr_b16 a[244:245], v53 offset:4160
ds_read_b64_tr_b16 a[246:247], v53 offset:4416
ds_read_b64_tr_b16 a[248:249], v53 offset:96
ds_read_b64_tr_b16 a[250:251], v53 offset:352
ds_read_b64_tr_b16 a[252:253], v53 offset:4192
ds_read_b64_tr_b16 a[254:255], v53 offset:4448
s_waitcnt lgkmcnt(0)
s_lshl_b32 s39, s32, 21
s_lshl_b32 s38, s54, 8
s_add_u32 s39, s39, s38
s_add_u32 s39, s39, 524288
s_mul_i32 s38, s32, 40960
s_add_u32 m0, s38, 0
s_nop 0
buffer_load_dwordx4 v51, s[8:11], s39 offen lds
s_add_u32 m0, m0, 1024
s_add_u32 s39, s39, 65536
buffer_load_dwordx4 v51, s[8:11], s39 offen lds
s_add_u32 m0, m0, 1024
s_add_u32 s39, s39, 65536
buffer_load_dwordx4 v51, s[8:11], s39 offen lds
s_add_u32 m0, m0, 1024
s_add_u32 s39, s39, 65536
buffer_load_dwordx4 v51, s[8:11], s39 offen lds
s_add_u32 m0, m0, 1024
s_add_u32 s39, s39, 65536
buffer_load_dwordx4 v51, s[8:11], s39 offen lds
s_add_u32 m0, m0, 1024
s_add_u32 s39, s39, 65536
buffer_load_dwordx4 v51, s[8:11], s39 offen lds
s_add_u32 m0, m0, 1024
s_add_u32 s39, s39, 65536
buffer_load_dwordx4 v51, s[8:11], s39 offen lds
s_add_u32 m0, m0, 1024
s_add_u32 s39, s39, 65536
buffer_load_dwordx4 v51, s[8:11], s39 offen lds
s_waitcnt vmcnt(32)
ds_read_b64_tr_b16 a[192:193], v53 offset:8192
ds_read_b64_tr_b16 a[194:195], v53 offset:8448
ds_read_b64_tr_b16 a[196:197], v53 offset:12288
ds_read_b64_tr_b16 a[198:199], v53 offset:12544
ds_read_b64_tr_b16 a[200:201], v53 offset:8224
ds_read_b64_tr_b16 a[202:203], v53 offset:8480
ds_read_b64_tr_b16 a[204:205], v53 offset:12320
ds_read_b64_tr_b16 a[206:207], v53 offset:12576
ds_read_b64_tr_b16 a[208:209], v53 offset:8256
ds_read_b64_tr_b16 a[210:211], v53 offset:8512
ds_read_b64_tr_b16 a[212:213], v53 offset:12352
ds_read_b64_tr_b16 a[214:215], v53 offset:12608
ds_read_b64_tr_b16 a[216:217], v53 offset:8288
ds_read_b64_tr_b16 a[218:219], v53 offset:8544
ds_read_b64_tr_b16 a[220:221], v53 offset:12384
ds_read_b64_tr_b16 a[222:223], v53 offset:12640
s_waitcnt lgkmcnt(0)
s_lshl_b32 s39, s32, 21
s_lshl_b32 s38, s54, 8
s_add_u32 s39, s39, s38
s_add_u32 s39, s39, 0
s_mul_i32 s38, s32, 40960
s_add_u32 m0, s38, 8192
s_nop 0
buffer_load_dwordx4 v52, s[8:11], s39 offen lds
s_add_u32 m0, m0, 1024
s_add_u32 s39, s39, 65536
buffer_load_dwordx4 v52, s[8:11], s39 offen lds
s_add_u32 m0, m0, 1024
s_add_u32 s39, s39, 65536
buffer_load_dwordx4 v52, s[8:11], s39 offen lds
s_add_u32 m0, m0, 1024
s_add_u32 s39, s39, 65536
buffer_load_dwordx4 v52, s[8:11], s39 offen lds
s_add_u32 m0, m0, 1024
s_add_u32 s39, s39, 65536
buffer_load_dwordx4 v52, s[8:11], s39 offen lds
s_add_u32 m0, m0, 1024
s_add_u32 s39, s39, 65536
buffer_load_dwordx4 v52, s[8:11], s39 offen lds
s_add_u32 m0, m0, 1024
s_add_u32 s39, s39, 65536
buffer_load_dwordx4 v52, s[8:11], s39 offen lds
s_add_u32 m0, m0, 1024
s_add_u32 s39, s39, 65536
buffer_load_dwordx4 v52, s[8:11], s39 offen lds
s_waitcnt vmcnt(32)
ds_read_b64_tr_b16 a[160:161], v53 offset:16384
ds_read_b64_tr_b16 a[162:163], v53 offset:16640
ds_read_b64_tr_b16 a[164:165], v53 offset:20480
ds_read_b64_tr_b16 a[166:167], v53 offset:20736
ds_read_b64_tr_b16 a[168:169], v53 offset:16416
ds_read_b64_tr_b16 a[170:171], v53 offset:16672
ds_read_b64_tr_b16 a[172:173], v53 offset:20512
ds_read_b64_tr_b16 a[174:175], v53 offset:20768
ds_read_b64_tr_b16 a[176:177], v53 offset:16448
ds_read_b64_tr_b16 a[178:179], v53 offset:16704
ds_read_b64_tr_b16 a[180:181], v53 offset:20544
ds_read_b64_tr_b16 a[182:183], v53 offset:20800
ds_read_b64_tr_b16 a[184:185], v53 offset:16480
ds_read_b64_tr_b16 a[186:187], v53 offset:16736
ds_read_b64_tr_b16 a[188:189], v53 offset:20576
ds_read_b64_tr_b16 a[190:191], v53 offset:20832
s_waitcnt lgkmcnt(0)
s_lshl_b32 s39, s32, 21
s_lshl_b32 s38, s54, 8
s_add_u32 s39, s39, s38
s_add_u32 s39, s39, 0
s_mul_i32 s38, s32, 40960
s_add_u32 m0, s38, 16384
s_nop 0
buffer_load_dwordx4 v51, s[8:11], s39 offen lds
s_add_u32 m0, m0, 1024
s_add_u32 s39, s39, 65536
buffer_load_dwordx4 v51, s[8:11], s39 offen lds
s_add_u32 m0, m0, 1024
s_add_u32 s39, s39, 65536
buffer_load_dwordx4 v51, s[8:11], s39 offen lds
s_add_u32 m0, m0, 1024
s_add_u32 s39, s39, 65536
buffer_load_dwordx4 v51, s[8:11], s39 offen lds
s_add_u32 m0, m0, 1024
s_add_u32 s39, s39, 65536
buffer_load_dwordx4 v51, s[8:11], s39 offen lds
s_add_u32 m0, m0, 1024
s_add_u32 s39, s39, 65536
buffer_load_dwordx4 v51, s[8:11], s39 offen lds
s_add_u32 m0, m0, 1024
s_add_u32 s39, s39, 65536
buffer_load_dwordx4 v51, s[8:11], s39 offen lds
s_add_u32 m0, m0, 1024
s_add_u32 s39, s39, 65536
buffer_load_dwordx4 v51, s[8:11], s39 offen lds
s_waitcnt vmcnt(32)
ds_read_b64_tr_b16 a[128:129], v53 offset:24576
ds_read_b64_tr_b16 a[130:131], v53 offset:24832
ds_read_b64_tr_b16 a[132:133], v53 offset:28672
ds_read_b64_tr_b16 a[134:135], v53 offset:28928
ds_read_b64_tr_b16 a[136:137], v53 offset:24608
ds_read_b64_tr_b16 a[138:139], v53 offset:24864
ds_read_b64_tr_b16 a[140:141], v53 offset:28704
ds_read_b64_tr_b16 a[142:143], v53 offset:28960
ds_read_b64_tr_b16 a[144:145], v53 offset:24640
ds_read_b64_tr_b16 a[146:147], v53 offset:24896
ds_read_b64_tr_b16 a[148:149], v53 offset:28736
ds_read_b64_tr_b16 a[150:151], v53 offset:28992
ds_read_b64_tr_b16 a[152:153], v53 offset:24672
ds_read_b64_tr_b16 a[154:155], v53 offset:24928
ds_read_b64_tr_b16 a[156:157], v53 offset:28768
ds_read_b64_tr_b16 a[158:159], v53 offset:29024
s_waitcnt lgkmcnt(0)
s_waitcnt vmcnt(24)
ds_read_b64_tr_b16 a[96:97], v53 offset:32768
ds_read_b64_tr_b16 a[98:99], v53 offset:33024
ds_read_b64_tr_b16 a[100:101], v53 offset:36864
ds_read_b64_tr_b16 a[102:103], v53 offset:37120
ds_read_b64_tr_b16 a[104:105], v53 offset:32800
ds_read_b64_tr_b16 a[106:107], v53 offset:33056
ds_read_b64_tr_b16 a[108:109], v53 offset:36896
ds_read_b64_tr_b16 a[110:111], v53 offset:37152
ds_read_b64_tr_b16 a[112:113], v53 offset:32832
ds_read_b64_tr_b16 a[114:115], v53 offset:33088
ds_read_b64_tr_b16 a[116:117], v53 offset:36928
ds_read_b64_tr_b16 a[118:119], v53 offset:37184
ds_read_b64_tr_b16 a[120:121], v53 offset:32864
ds_read_b64_tr_b16 a[122:123], v53 offset:33120
ds_read_b64_tr_b16 a[124:125], v53 offset:36960
ds_read_b64_tr_b16 a[126:127], v53 offset:37216
s_waitcnt lgkmcnt(0)
s_waitcnt vmcnt(16)
ds_read_b64_tr_b16 a[64:65], v53 offset:0
ds_read_b64_tr_b16 a[66:67], v53 offset:256
ds_read_b64_tr_b16 a[68:69], v53 offset:4096
ds_read_b64_tr_b16 a[70:71], v53 offset:4352
ds_read_b64_tr_b16 a[72:73], v53 offset:32
ds_read_b64_tr_b16 a[74:75], v53 offset:288
ds_read_b64_tr_b16 a[76:77], v53 offset:4128
ds_read_b64_tr_b16 a[78:79], v53 offset:4384
ds_read_b64_tr_b16 a[80:81], v53 offset:64
ds_read_b64_tr_b16 a[82:83], v53 offset:320
ds_read_b64_tr_b16 a[84:85], v53 offset:4160
ds_read_b64_tr_b16 a[86:87], v53 offset:4416
ds_read_b64_tr_b16 a[88:89], v53 offset:96
ds_read_b64_tr_b16 a[90:91], v53 offset:352
ds_read_b64_tr_b16 a[92:93], v53 offset:4192
ds_read_b64_tr_b16 a[94:95], v53 offset:4448
s_waitcnt lgkmcnt(0)
s_waitcnt vmcnt(8)
ds_read_b64_tr_b16 a[32:33], v53 offset:8192
ds_read_b64_tr_b16 a[34:35], v53 offset:8448
ds_read_b64_tr_b16 a[36:37], v53 offset:12288
ds_read_b64_tr_b16 a[38:39], v53 offset:12544
ds_read_b64_tr_b16 a[40:41], v53 offset:8224
ds_read_b64_tr_b16 a[42:43], v53 offset:8480
ds_read_b64_tr_b16 a[44:45], v53 offset:12320
ds_read_b64_tr_b16 a[46:47], v53 offset:12576
ds_read_b64_tr_b16 a[48:49], v53 offset:8256
ds_read_b64_tr_b16 a[50:51], v53 offset:8512
ds_read_b64_tr_b16 a[52:53], v53 offset:12352
ds_read_b64_tr_b16 a[54:55], v53 offset:12608
ds_read_b64_tr_b16 a[56:57], v53 offset:8288
ds_read_b64_tr_b16 a[58:59], v53 offset:8544
ds_read_b64_tr_b16 a[60:61], v53 offset:12384
ds_read_b64_tr_b16 a[62:63], v53 offset:12640
s_waitcnt lgkmcnt(0)
s_waitcnt vmcnt(0)
ds_read_b64_tr_b16 a[0:1], v53 offset:16384
ds_read_b64_tr_b16 a[2:3], v53 offset:16640
ds_read_b64_tr_b16 a[4:5], v53 offset:20480
ds_read_b64_tr_b16 a[6:7], v53 offset:20736
ds_read_b64_tr_b16 a[8:9], v53 offset:16416
ds_read_b64_tr_b16 a[10:11], v53 offset:16672
ds_read_b64_tr_b16 a[12:13], v53 offset:20512
ds_read_b64_tr_b16 a[14:15], v53 offset:20768
ds_read_b64_tr_b16 a[16:17], v53 offset:16448
ds_read_b64_tr_b16 a[18:19], v53 offset:16704
ds_read_b64_tr_b16 a[20:21], v53 offset:20544
ds_read_b64_tr_b16 a[22:23], v53 offset:20800
ds_read_b64_tr_b16 a[24:25], v53 offset:16480
ds_read_b64_tr_b16 a[26:27], v53 offset:16736
ds_read_b64_tr_b16 a[28:29], v53 offset:20576
ds_read_b64_tr_b16 a[30:31], v53 offset:20832
s_waitcnt lgkmcnt(0)
s_cmp_lg_u32 s54, 0
s_cbranch_scc1 Lnp_12
s_barrier
s_mov_b32 s52, 0x2000000
s_cmp_lg_u32 s32, 0
s_cbranch_scc1 Lpb_13
v_lshlrev_b32 v52, 8, v50
v_mov_b32 v53, -1
s_mov_b32 s53, 32768
buffer_store_dword v53, v52, s[4:7], s53 offen sc1
s_waitcnt vmcnt(0)
s_mov_b64 exec, 1
s_mov_b32 s60, -1
s_mov_b32 s61, -1
v_mov_b32 v52, 0
s_mov_b32 s66, 5
Lpl_14:
s_memtime s[62:63]
s_waitcnt lgkmcnt(0)
buffer_load_dword v53, v52, s[4:7], s53 offen sc1
s_waitcnt vmcnt(0)
s_memtime s[64:65]
s_waitcnt lgkmcnt(0)
s_sub_u32 s62, s64, s62
s_min_u32 s60, s60, s62
v_add_u32 v52, 8192, v52
s_memtime s[62:63]
s_waitcnt lgkmcnt(0)
buffer_load_dword v53, v52, s[4:7], s53 offen sc1
s_waitcnt vmcnt(0)
s_memtime s[64:65]
s_waitcnt lgkmcnt(0)
s_sub_u32 s62, s64, s62
s_min_u32 s61, s61, s62
v_add_u32 v52, -6912, v52
s_sub_u32 s66, s66, 1
s_cmp_lg_u32 s66, 0
s_cbranch_scc1 Lpl_14
s_mov_b64 exec, -1
s_cmp_lt_u32 s61, s60
s_cselect_b32 s62, 1, 0
s_lshr_b32 s63, s51, 2
s_xor_b32 s62, s62, s63
s_lshl_b32 s62, s62, 24
s_or_b32 s52, s52, s62
Lpb_13:
s_waitcnt vmcnt(0)
s_barrier
s_cmp_lg_u32 s32, 0
s_cbranch_scc1 Lar_15
s_mov_b64 exec, 1
v_mov_b32 v48, 32
v_mov_b32 v49, s52
buffer_atomic_add v49, v48, s[12:15], 0 offen sc1
s_mov_b64 exec, -1
Lar_15:
Lnp_12:
Lst_16:
buffer_load_dword v48, off, s[12:15], 0 offset:32 sc1
buffer_load_dword v49, off, s[12:15], 0 offset:160 sc1
s_waitcnt vmcnt(0)
v_add_u32 v48, v48, v49
s_nop 0
v_readfirstlane_b32 s38, v48
s_nop 3
s_and_b32 s39, s38, 0x200ffff
s_cmp_eq_u32 s39, 0x2000100
s_cbranch_scc1 Lso_17
s_sub_u32 s37, s37, 1
s_cbranch_scc1 Lend_1
s_sleep 8
s_branch Lst_16
Lso_17:
s_bfe_u32 s35, s38, 0x80010
s_bfe_u32 s46, s38, 0x10018
s_lshl_b32 s46, s46, 13
s_barrier
s_mul_i32 s47, s54, 24576
s_add_u32 s47, s47, 33554432
s_mov_b32 s36, 0
s_mov_b32 s27, 1
Lbw_18:
buffer_load_dword v209, v208, s[4:7], 0 offen sc1
s_waitcnt vmcnt(0)
v_add_u32 v44, v209, v210
v_cmp_gt_u32 vcc, s27, v44
s_cbranch_vccz Lbo_19
s_sub_u32 s37, s37, 1
s_cbranch_scc1 Lend_1
s_sleep 2
s_branch Lbw_18
Lbo_19:
s_mov_b32 m0, s57
s_add_u32 s52, s47, 3072
buffer_load_dwordx4 v21, s[4:7], s47 offen offset:0 sc1 lds
buffer_load_dwordx4 v21, s[4:7], s47 offen offset:1024 sc1 lds
buffer_load_dwordx4 v21, s[4:7], s47 offen offset:2048 sc1 lds
s_add_u32 m0, s57, 3072
s_xor_b32 s57, s57, 98304
buffer_load_dwordx4 v21, s[4:7], s52 offen offset:0 sc1 lds
buffer_load_dwordx4 v21, s[4:7], s52 offen offset:1024 sc1 lds
buffer_load_dwordx4 v21, s[4:7], s52 offen offset:2048 sc1 lds
s_add_u32 s47, s47, 786432
s_cmp_lg_u32 s35, 0
s_cbranch_scc1 Lq_sc1_20
Lq_21:
s_cmp_gt_u32 s36, 3
s_cbranch_scc1 Lqf_22
s_waitcnt vmcnt(0)
s_barrier
Lqf_22:
ds_read_b128 v[128:131], v22 offset:0
ds_read_b128 v[132:135], v22 offset:1024
ds_read_b128 v[136:139], v22 offset:2048
ds_read_b128 v[140:143], v22 offset:3072
ds_read_b128 v[144:147], v22 offset:4096
ds_read_b128 v[148:151], v22 offset:5120
ds_read_b128 v[152:155], v22 offset:6144
ds_read_b128 v[156:159], v22 offset:7168
ds_read_b128 v[160:163], v24 offset:0
ds_read_b128 v[164:167], v24 offset:1024
ds_read_b128 v[168:171], v25 offset:0
ds_read_b128 v[172:175], v25 offset:1024
ds_read_b128 v[176:179], v23 offset:0
ds_read_b128 v[180:183], v23 offset:1024
ds_read_b128 v[184:187], v23 offset:2048
ds_read_b128 v[188:191], v23 offset:3072
v_xor_b32 v22, 98304, v22
v_xor_b32 v24, 98304, v24
v_xor_b32 v25, 98304, v25
v_xor_b32 v23, 98304, v23
s_and_b32 s38, s36, 3
s_lshl_b32 s39, s38, 16
s_add_u32 s40, s39, s45
s_xor_b32 s42, s40, 0x20000
s_add_u32 s26, s36, 1
v_pk_mul_f32 v[64:65], 0, 0
v_pk_mul_f32 v[66:67], 0, 0
v_pk_mul_f32 v[68:69], 0, 0
v_pk_mul_f32 v[70:71], 0, 0
v_pk_mul_f32 v[72:73], 0, 0
v_pk_mul_f32 v[74:75], 0, 0
v_pk_mul_f32 v[76:77], 0, 0
v_pk_mul_f32 v[78:79], 0, 0
v_pk_mul_f32 v[80:81], 0, 0
v_pk_mul_f32 v[82:83], 0, 0
v_pk_mul_f32 v[84:85], 0, 0
v_pk_mul_f32 v[86:87], 0, 0
v_pk_mul_f32 v[88:89], 0, 0
v_pk_mul_f32 v[90:91], 0, 0
v_pk_mul_f32 v[92:93], 0, 0
v_pk_mul_f32 v[94:95], 0, 0
v_mov_b32 v214, v197
s_waitcnt vmcnt(0)
buffer_store_dword v214, v199, s[4:7], 0 offen
v_add_u32 v197, 1, v197
s_mov_b64 exec, 15
buffer_load_dword v216, v192, s[4:7], s59 offen sc1
s_nop 5
buffer_load_dword v217, v192, s[4:7], s59 offen sc1
s_nop 5
buffer_load_dword v218, v192, s[4:7], s59 offen sc1
Lft_24:
s_waitcnt vmcnt(2)
v_cmp_gt_u32 vcc, s26, v216
buffer_load_dword v216, v192, s[4:7], s59 offen sc1
s_cbranch_vccz Lfg_23
s_waitcnt vmcnt(2)
v_cmp_gt_u32 vcc, s26, v217
buffer_load_dword v217, v192, s[4:7], s59 offen sc1
s_cbranch_vccz Lfg_23
s_waitcnt vmcnt(2)
v_cmp_gt_u32 vcc, s26, v218
buffer_load_dword v218, v192, s[4:7], s59 offen sc1
s_cbranch_vccz Lfg_23
s_sub_u32 s37, s37, 1
s_cbranch_scc1 Lend_1
s_branch Lft_24
Lfg_23:
s_mov_b64 exec, -1
buffer_load_dwordx4 v[48:51], v10, s[4:7], s40 offen offset:0 sc1
v_mfma_f32_16x16x32_bf16 v[200:203], v[204:207], v[204:207], 0
v_mfma_f32_16x16x32_bf16 v[200:203], v[204:207], v[204:207], 0
v_mfma_f32_16x16x32_bf16 v[200:203], v[204:207], v[204:207], 0
buffer_load_dwordx4 v[52:55], v10, s[4:7], s40 offen offset:1024 sc1
v_mfma_f32_16x16x32_bf16 v[200:203], v[204:207], v[204:207], 0
v_mfma_f32_16x16x32_bf16 v[200:203], v[204:207], v[204:207], 0
v_mfma_f32_16x16x32_bf16 v[200:203], v[204:207], v[204:207], 0
buffer_load_dwordx4 v[56:59], v10, s[4:7], s40 offen offset:2048 sc1
v_mfma_f32_16x16x32_bf16 v[200:203], v[204:207], v[204:207], 0
v_mfma_f32_16x16x32_bf16 v[200:203], v[204:207], v[204:207], 0
v_mfma_f32_16x16x32_bf16 v[200:203], v[204:207], v[204:207], 0
buffer_load_dwordx4 v[60:63], v10, s[4:7], s40 offen offset:3072 sc1
v_mfma_f32_16x16x32_bf16 v[200:203], v[204:207], v[204:207], 0
v_mfma_f32_16x16x32_bf16 v[200:203], v[204:207], v[204:207], 0
v_mfma_f32_16x16x32_bf16 v[200:203], v[204:207], v[204:207], 0
s_waitcnt vmcnt(3)
v_max3_u32 v44, v48, v49, v50
v_max_u32 v44, v44, v51
v_cmp_eq_u32 vcc, -1, v44
s_cbranch_vccnz Lpf_26
v_smfmac_f32_16x16x64_bf16 v[64:67], v[48:51], a[0:7], v15
v_smfmac_f32_16x16x64_bf16 v[68:71], v[48:51], a[8:15], v15
v_smfmac_f32_16x16x64_bf16 v[72:75], v[48:51], a[16:23], v15
s_waitcnt vmcnt(2)
v_max3_u32 v44, v52, v53, v54
v_max_u32 v44, v44, v55
v_cmp_eq_u32 vcc, -1, v44
v_smfmac_f32_16x16x64_bf16 v[76:79], v[48:51], a[24:31], v15
v_smfmac_f32_16x16x64_bf16 v[80:83], v[48:51], a[32:39], v15
v_smfmac_f32_16x16x64_bf16 v[84:87], v[48:51], a[40:47], v15
s_cbranch_vccnz Lpf_27
v_smfmac_f32_16x16x64_bf16 v[64:67], v[52:55], a[64:71], v15
v_smfmac_f32_16x16x64_bf16 v[68:71], v[52:55], a[72:79], v15
v_smfmac_f32_16x16x64_bf16 v[72:75], v[52:55], a[80:87], v15
s_waitcnt vmcnt(0)
v_max3_u32 v44, v56, v57, v58
v_max3_u32 v44, v44, v59, v60
v_max3_u32 v44, v44, v61, v62
v_max_u32 v44, v44, v63
v_cmp_eq_u32 vcc, -1, v44
v_smfmac_f32_16x16x64_bf16 v[76:79], v[52:55], a[88:95], v15
v_smfmac_f32_16x16x64_bf16 v[80:83], v[52:55], a[96:103], v15
v_smfmac_f32_16x16x64_bf16 v[84:87], v[52:55], a[104:111], v15
s_cbranch_vccnz Lpj_28
v_smfmac_f32_16x16x64_bf16 v[64:67], v[56:59], a[128:135], v15
s_nop 1
v_smfmac_f32_16x16x64_bf16 v[64:67], v[60:63], a[192:199], v15
s_nop 1
v_smfmac_f32_16x16x64_bf16 v[68:71], v[56:59], a[136:143], v15
s_nop 1
v_smfmac_f32_16x16x64_bf16 v[68:71], v[60:63], a[200:207], v15
s_nop 1
v_smfmac_f32_16x16x64_bf16 v[72:75], v[56:59], a[144:151], v15
v_add_f32 v96, v64, v66
v_add_f32 v97, v65, v67
v_smfmac_f32_16x16x64_bf16 v[72:75], v[60:63], a[208:215], v15
s_nop 1
v_smfmac_f32_16x16x64_bf16 v[76:79], v[56:59], a[152:159], v15
v_add_f32 v98, v68, v70
v_add_f32 v99, v69, v71
v_smfmac_f32_16x16x64_bf16 v[76:79], v[60:63], a[216:223], v15
ds_write_b128 v211, v[96:99] offset:0
s_nop 0
v_smfmac_f32_16x16x64_bf16 v[80:83], v[56:59], a[160:167], v15
v_add_f32 v100, v72, v74
v_add_f32 v101, v73, v75
v_smfmac_f32_16x16x64_bf16 v[80:83], v[60:63], a[224:231], v15
s_nop 1
v_smfmac_f32_16x16x64_bf16 v[84:87], v[56:59], a[168:175], v15
v_add_f32 v102, v76, v78
v_add_f32 v103, v77, v79
v_smfmac_f32_16x16x64_bf16 v[84:87], v[60:63], a[232:239], v15
ds_write_b128 v212, v[100:103] offset:0
s_nop 0
v_smfmac_f32_16x16x64_bf16 v[88:91], v[48:51], a[48:55], v15
v_add_f32 v104, v80, v82
v_add_f32 v105, v81, v83
v_smfmac_f32_16x16x64_bf16 v[88:91], v[52:55], a[112:119], v15
s_nop 1
v_add_f32 v106, v84, v86
v_add_f32 v107, v85, v87
ds_write_b128 v213, v[104:107] offset:0
Lpd_25:
v_smfmac_f32_16x16x64_bf16 v[88:91], v[56:59], a[176:183], v15
v_smfmac_f32_16x16x64_bf16 v[88:91], v[60:63], a[240:247], v15
v_smfmac_f32_16x16x64_bf16 v[92:95], v[48:51], a[56:63], v15
v_smfmac_f32_16x16x64_bf16 v[92:95], v[52:55], a[120:127], v15
s_waitcnt lgkmcnt(0)
s_barrier
ds_read_b128 v[76:79], v18 offset:0
ds_read_b128 v[80:83], v18 offset:1024
ds_read_b128 v[84:87], v18 offset:2048
v_smfmac_f32_16x16x64_bf16 v[92:95], v[56:59], a[184:191], v15
v_smfmac_f32_16x16x64_bf16 v[92:95], v[60:63], a[248:255], v15
v_mov_b32 v72, 0
v_mov_b32 v73, 0
v_mov_b32 v74, 0
v_mov_b32 v75, 0
v_add_f32 v108, v88, v90
v_add_f32 v109, v89, v91
s_nop 1
v_add_f32 v110, v92, v94
v_add_f32 v111, v93, v95
s_waitcnt lgkmcnt(0)
v_pk_add_f32 v[76:77], v[76:77], v[108:109]
v_pk_add_f32 v[80:81], v[80:81], v[84:85]
v_pk_add_f32 v[78:79], v[78:79], v[110:111]
v_pk_add_f32 v[82:83], v[82:83], v[86:87]
v_pk_add_f32 v[76:77], v[76:77], v[80:81]
v_pk_add_f32 v[78:79], v[78:79], v[82:83]
v_cvt_pk_bf16_f32 v76, v76, v77
v_cvt_pk_bf16_f32 v77, v78, v79
ds_write2st64_b32 v19, v76, v77 offset0:48 offset1:49
buffer_load_dwordx4 v[112:115], v11, s[4:7], s40 offen offset:0 sc1
buffer_load_dwordx4 v[116:119], v11, s[4:7], s40 offen offset:1024 sc1
s_waitcnt lgkmcnt(0)
s_barrier
ds_read_b64_tr_b16 v[96:97], v20 offset:12288
ds_read_b64_tr_b16 v[98:99], v20 offset:12544
ds_read_b64_tr_b16 v[100:101], v20 offset:12800
ds_read_b64_tr_b16 v[102:103], v20 offset:13056
ds_read_b64_tr_b16 v[104:105], v20 offset:13312
ds_read_b64_tr_b16 v[106:107], v20 offset:13568
ds_read_b64_tr_b16 v[108:109], v20 offset:13824
ds_read_b64_tr_b16 v[110:111], v20 offset:14080
s_waitcnt lgkmcnt(6)
v_mfma_f32_16x16x32_bf16 v[64:67], v[128:131], v[96:99], 0
v_mfma_f32_16x16x32_bf16 v[68:71], v[144:147], v[96:99], 0
s_waitcnt lgkmcnt(4)
buffer_load_dwordx4 v[48:51], v11, s[4:7], s40 offen offset:0 sc1
v_mfma_f32_16x16x32_bf16 v[64:67], v[132:135], v[100:103], v[64:67]
v_mfma_f32_16x16x32_bf16 v[68:71], v[148:151], v[100:103], v[68:71]
s_waitcnt lgkmcnt(2)
buffer_load_dwordx4 v[52:55], v11, s[4:7], s40 offen offset:1024 sc1
v_mfma_f32_16x16x32_bf16 v[64:67], v[136:139], v[104:107], v[64:67]
v_mfma_f32_16x16x32_bf16 v[68:71], v[152:155], v[104:107], v[68:71]
s_waitcnt lgkmcnt(0)
s_waitcnt vmcnt(2)
v_max3_u32 v44, v112, v113, v114
v_max3_u32 v44, v44, v115, v116
v_max3_u32 v44, v44, v117, v118
v_max_u32 v44, v44, v119
v_cmp_eq_u32 vcc, -1, v44
v_mfma_f32_16x16x32_bf16 v[64:67], v[140:143], v[108:111], v[64:67]
v_mfma_f32_16x16x32_bf16 v[68:71], v[156:159], v[108:111], v[68:71]
s_cbranch_vccnz Lkr_29
v_smfmac_f32_16x16x64_bf16 v[72:75], v[112:115], v[96:103], v15
v_smfmac_f32_16x16x64_bf16 v[72:75], v[116:119], v[104:111], v15
Lko_30:
s_nop 3
v_max3_f32 v45, v64, v65, v66
v_max3_f32 v45, v45, v67, v68
v_max3_f32 v45, v45, v69, v70
v_max_f32 v45, v45, v71
v_pk_add_f32 v[72:73], v[72:73], v[74:75]
v_max3_f32 v46, v45, v72, v73
v_max3_f32 v47, v45, v72, v73
buffer_load_dwordx2 v[120:121], v12, s[4:7], s40 offen sc1
buffer_load_dwordx2 v[122:123], v13, s[4:7], s40 offen sc1
v_permlane32_swap_b32 v46, v47
v_max_f32 v45, v46, v47
v_max_f32 v46, v46, v47
s_nop 1
v_permlane16_swap_b32 v45, v46
v_max_f32 v45, v45, v46
v_mul_f32 v46, s49, v45
v_pk_fma_f32 v[64:65], v[64:65], s[48:49], v[46:47] op_sel_hi:[1,0,0]
v_pk_fma_f32 v[66:67], v[66:67], s[48:49], v[46:47] op_sel_hi:[1,0,0]
v_pk_fma_f32 v[68:69], v[68:69], s[48:49], v[46:47] op_sel_hi:[1,0,0]
v_pk_fma_f32 v[70:71], v[70:71], s[48:49], v[46:47] op_sel_hi:[1,0,0]
v_pk_fma_f32 v[72:73], v[72:73], s[48:49], v[46:47] op_sel_hi:[1,0,0]
v_exp_f32 v64, v64
v_exp_f32 v65, v65
v_exp_f32 v66, v66
v_exp_f32 v67, v67
v_exp_f32 v68, v68
v_exp_f32 v69, v69
v_exp_f32 v70, v70
v_exp_f32 v71, v71
v_exp_f32 v72, v72
v_exp_f32 v73, v73
buffer_store_dword v197, v193, s[4:7], s59 offen
v_cvt_pk_bf16_f32 v76, v64, v65
v_cvt_pk_bf16_f32 v77, v66, v67
v_cvt_pk_bf16_f32 v78, v68, v69
v_cvt_pk_bf16_f32 v79, v70, v71
v_cvt_pk_bf16_f32 v2, v72, v73
v_cvt_pk_bf16_f32 v7, v72, v73
v_mfma_f32_16x16x32_bf16 v[84:87], v[32:35], v[76:79], 0
v_mfma_f32_16x16x32_bf16 v[84:87], v[32:35], v[2:5], v[84:87]
v_mfma_f32_16x16x32_bf16 v[96:99], v[160:163], v[76:79], 0
s_waitcnt vmcnt(1)
v_max3_u32 v44, v120, v121, v122
v_max_u32 v44, v44, v123
v_cmp_eq_u32 vcc, -1, v44
v_mfma_f32_16x16x32_bf16 v[100:103], v[164:167], v[76:79], 0
s_cbranch_vccnz Lvr_31
Lvo_32:
v_mfma_f32_16x16x32_bf16 v[96:99], v[120:123], v[2:5], v[96:99]
v_mfma_f32_16x16x32_bf16 v[100:103], v[120:123], v[6:9], v[100:103]
v_rcp_f32 v46, v84
s_nop 5
v_pk_mul_f32 v[96:97], v[96:97], v[46:47] op_sel_hi:[1,0]
v_pk_mul_f32 v[98:99], v[98:99], v[46:47] op_sel_hi:[1,0]
v_pk_mul_f32 v[100:101], v[100:101], v[46:47] op_sel_hi:[1,0]
v_pk_mul_f32 v[102:103], v[102:103], v[46:47] op_sel_hi:[1,0]
v_cvt_pk_bf16_f32 v124, v96, v97
v_cvt_pk_bf16_f32 v125, v98, v99
v_cvt_pk_bf16_f32 v126, v100, v101
v_cvt_pk_bf16_f32 v127, v102, v103
buffer_store_dwordx4 v[124:127], v14, s[4:7], s40 offen
s_barrier
buffer_store_dwordx4 v[28:31], v14, s[4:7], s42 offen
s_cmp_eq_u32 s36, 2
s_cbranch_scc1 Lp2_35
Lp1_36:
s_add_u32 s27, s27, 1
s_min_u32 s27, s27, 64
v_add_u32 v44, v209, v210
v_cmp_gt_u32 vcc, s27, v44
v_mov_b32 v72, 0
v_mov_b32 v73, 0
v_mov_b32 v74, 0
v_mov_b32 v75, 0
s_add_u32 s38, s36, 2
s_and_b32 s38, s38, 3
s_lshl_b32 s88, s38, 18
s_add_u32 s88, s88, s46
s_add_u32 s89, s88, 0x100000
s_cmp_lt_u32 s36, 62
s_cselect_b32 s53, s47, 0x70000000
s_cbranch_vccnz Lpw_33
Lpk_34:
buffer_store_dwordx2 v[28:29], v198, s[4:7], s88 offen sc1
buffer_store_dwordx2 v[28:29], v198, s[4:7], s89 offen sc1
v_mfma_f32_16x16x32_bf16 v[64:67], v[128:131], v[176:179], v[36:39]
v_mfma_f32_16x16x32_bf16 v[68:71], v[144:147], v[176:179], v[40:43]
s_mov_b32 m0, s57
s_add_u32 s52, s53, 3072
buffer_load_dwordx4 v21, s[4:7], s53 offen offset:0 sc1 lds
v_mfma_f32_16x16x32_bf16 v[64:67], v[132:135], v[180:183], v[64:67]
v_mfma_f32_16x16x32_bf16 v[68:71], v[148:151], v[180:183], v[68:71]
v_mfma_f32_16x16x32_bf16 v[64:67], v[136:139], v[184:187], v[64:67]
v_mfma_f32_16x16x32_bf16 v[68:71], v[152:155], v[184:187], v[68:71]
buffer_load_dwordx4 v21, s[4:7], s53 offen offset:1024 sc1 lds
v_mfma_f32_16x16x32_bf16 v[64:67], v[140:143], v[188:191], v[64:67]
v_mfma_f32_16x16x32_bf16 v[68:71], v[156:159], v[188:191], v[68:71]
v_smfmac_f32_16x16x64_bf16 v[72:75], v[112:115], v[176:183], v15
v_smfmac_f32_16x16x64_bf16 v[72:75], v[116:119], v[184:191], v15
s_and_b32 s38, s36, 7
s_lshl_b32 s38, s38, 18
s_add_u32 s50, s38, 83886080
buffer_load_dwordx4 v21, s[4:7], s53 offen offset:2048 sc1 lds
s_nop 1
v_max3_f32 v45, v64, v65, v66
v_max3_f32 v45, v45, v67, v68
v_max3_f32 v45, v45, v69, v70
v_max_f32 v45, v45, v71
v_pk_add_f32 v[72:73], v[72:73], v[74:75]
v_max3_f32 v46, v45, v72, v73
v_max3_f32 v47, v45, v72, v73
s_nop 1
v_permlane32_swap_b32 v46, v47
v_max_f32 v45, v46, v47
v_max_f32 v46, v46, v47
s_nop 1
v_permlane16_swap_b32 v45, v46
v_max_f32 v45, v45, v46
v_mul_f32 v46, s49, v45
s_add_u32 m0, s57, 3072
s_xor_b32 s57, s57, 98304
buffer_load_dwordx4 v21, s[4:7], s52 offen offset:0 sc1 lds
v_pk_fma_f32 v[64:65], v[64:65], s[48:49], v[46:47] op_sel_hi:[1,0,0]
v_pk_fma_f32 v[66:67], v[66:67], s[48:49], v[46:47] op_sel_hi:[1,0,0]
v_pk_fma_f32 v[68:69], v[68:69], s[48:49], v[46:47] op_sel_hi:[1,0,0]
v_pk_fma_f32 v[70:71], v[70:71], s[48:49], v[46:47] op_sel_hi:[1,0,0]
v_pk_fma_f32 v[72:73], v[72:73], s[48:49], v[46:47] op_sel_hi:[1,0,0]
v_exp_f32 v64, v64
v_exp_f32 v65, v65
v_exp_f32 v66, v66
v_exp_f32 v67, v67
v_exp_f32 v68, v68
buffer_load_dwordx4 v21, s[4:7], s52 offen offset:1024 sc1 lds
v_exp_f32 v69, v69
v_exp_f32 v70, v70
v_exp_f32 v71, v71
v_exp_f32 v72, v72
v_exp_f32 v73, v73
buffer_load_dwordx4 v21, s[4:7], s52 offen offset:2048 sc1 lds
s_add_u32 s47, s47, 786432
buffer_load_dword v209, v208, s[4:7], 0 offen sc1
v_cvt_pk_bf16_f32 v76, v64, v65
v_cvt_pk_bf16_f32 v77, v66, v67
v_cvt_pk_bf16_f32 v78, v68, v69
v_cvt_pk_bf16_f32 v79, v70, v71
v_cvt_pk_bf16_f32 v2, v72, v73
v_cvt_pk_bf16_f32 v7, v72, v73
v_mfma_f32_16x16x32_bf16 v[84:87], v[32:35], v[76:79], 0
v_mfma_f32_16x16x32_bf16 v[84:87], v[32:35], v[2:5], v[84:87]
v_mfma_f32_16x16x32_bf16 v[96:99], v[160:163], v[76:79], 0
v_mfma_f32_16x16x32_bf16 v[100:103], v[164:167], v[76:79], 0
v_mfma_f32_16x16x32_bf16 v[104:107], v[168:171], v[76:79], 0
v_mfma_f32_16x16x32_bf16 v[108:111], v[172:175], v[76:79], 0
v_mfma_f32_16x16x32_bf16 v[96:99], v[120:123], v[2:5], v[96:99]
v_mfma_f32_16x16x32_bf16 v[100:103], v[120:123], v[6:9], v[100:103]
v_mfma_f32_16x16x32_bf16 v[104:107], v[120:123], v[0:3], v[104:107]
v_mfma_f32_16x16x32_bf16 v[108:111], v[120:123], v[4:7], v[108:111]
v_rcp_f32 v46, v84
s_nop 3
v_pk_mul_f32 v[96:97], v[96:97], v[46:47] op_sel_hi:[1,0]
v_pk_mul_f32 v[98:99], v[98:99], v[46:47] op_sel_hi:[1,0]
v_pk_mul_f32 v[100:101], v[100:101], v[46:47] op_sel_hi:[1,0]
v_pk_mul_f32 v[102:103], v[102:103], v[46:47] op_sel_hi:[1,0]
v_pk_mul_f32 v[104:105], v[104:105], v[46:47] op_sel_hi:[1,0]
v_pk_mul_f32 v[106:107], v[106:107], v[46:47] op_sel_hi:[1,0]
v_pk_mul_f32 v[108:109], v[108:109], v[46:47] op_sel_hi:[1,0]
v_pk_mul_f32 v[110:111], v[110:111], v[46:47] op_sel_hi:[1,0]
v_cvt_pk_bf16_f32 v96, v96, v97
v_cvt_pk_bf16_f32 v97, v98, v99
v_cvt_pk_bf16_f32 v98, v100, v101
v_cvt_pk_bf16_f32 v99, v102, v103
v_cvt_pk_bf16_f32 v100, v104, v105
v_cvt_pk_bf16_f32 v101, v106, v107
v_cvt_pk_bf16_f32 v102, v108, v109
v_cvt_pk_bf16_f32 v103, v110, v111
buffer_store_dwordx4 v[96:99], v26, s[4:7], s50 offen
buffer_store_dwordx4 v[100:103], v27, s[4:7], s50 offen
s_add_u32 s36, s36, 1
s_cmp_lt_u32 s36, 64
s_cbranch_scc1 Lq_21
s_waitcnt vmcnt(0)
buffer_store_dword v197, v199, s[4:7], 0 offen
s_branch Lend_1
Lp2_35:
s_add_u32 s27, s27, 1
Lbw_37:
buffer_load_dword v209, v208, s[4:7], 0 offen sc1
s_waitcnt vmcnt(0)
v_add_u32 v44, v209, v210
v_cmp_gt_u32 vcc, s27, v44
s_cbranch_vccz Lbo_38
s_sub_u32 s37, s37, 1
s_cbranch_scc1 Lend_1
s_sleep 2
s_branch Lbw_37
Lbo_38:
s_mov_b32 m0, s57
s_add_u32 s52, s47, 3072
buffer_load_dwordx4 v21, s[4:7], s47 offen offset:0 sc1 lds
buffer_load_dwordx4 v21, s[4:7], s47 offen offset:1024 sc1 lds
buffer_load_dwordx4 v21, s[4:7], s47 offen offset:2048 sc1 lds
s_add_u32 m0, s57, 3072
s_xor_b32 s57, s57, 98304
buffer_load_dwordx4 v21, s[4:7], s52 offen offset:0 sc1 lds
buffer_load_dwordx4 v21, s[4:7], s52 offen offset:1024 sc1 lds
buffer_load_dwordx4 v21, s[4:7], s52 offen offset:2048 sc1 lds
s_add_u32 s47, s47, 786432
s_branch Lp1_36
Lpw_33:
Lbw_39:
buffer_load_dword v209, v208, s[4:7], 0 offen sc1
s_waitcnt vmcnt(0)
v_add_u32 v44, v209, v210
v_cmp_gt_u32 vcc, s27, v44
s_cbranch_vccz Lbo_40
s_sub_u32 s37, s37, 1
s_cbranch_scc1 Lend_1
s_sleep 2
s_branch Lbw_39
Lbo_40:
s_branch Lpk_34
Lpj_28:
buffer_load_dwordx4 v[56:59], v10, s[4:7], s40 offen offset:2048 sc1
buffer_load_dwordx4 v[60:63], v10, s[4:7], s40 offen offset:3072 sc1
s_sub_u32 s37, s37, 1
s_cbranch_scc1 Lend_1
s_branch Lps_41
Lpf_26:
buffer_load_dwordx4 v[48:51], v10, s[4:7], s40 offen offset:0 sc1
s_sub_u32 s37, s37, 1
s_cbranch_scc1 Lend_1
Lps_42:
s_waitcnt vmcnt(3)
v_max3_u32 v44, v52, v53, v54
v_max_u32 v44, v44, v55
v_cmp_eq_u32 vcc, -1, v44
s_cbranch_vccnz Lpf_43
v_smfmac_f32_16x16x64_bf16 v[64:67], v[52:55], a[64:71], v15
v_smfmac_f32_16x16x64_bf16 v[68:71], v[52:55], a[72:79], v15
v_smfmac_f32_16x16x64_bf16 v[72:75], v[52:55], a[80:87], v15
v_smfmac_f32_16x16x64_bf16 v[76:79], v[52:55], a[88:95], v15
v_smfmac_f32_16x16x64_bf16 v[80:83], v[52:55], a[96:103], v15
v_smfmac_f32_16x16x64_bf16 v[84:87], v[52:55], a[104:111], v15
Lps_44:
s_waitcnt vmcnt(2)
v_max3_u32 v44, v56, v57, v58
v_max_u32 v44, v44, v59
v_cmp_eq_u32 vcc, -1, v44
s_cbranch_vccnz Lpf_45
v_smfmac_f32_16x16x64_bf16 v[64:67], v[56:59], a[128:135], v15
v_smfmac_f32_16x16x64_bf16 v[68:71], v[56:59], a[136:143], v15
v_smfmac_f32_16x16x64_bf16 v[72:75], v[56:59], a[144:151], v15
v_smfmac_f32_16x16x64_bf16 v[76:79], v[56:59], a[152:159], v15
v_smfmac_f32_16x16x64_bf16 v[80:83], v[56:59], a[160:167], v15
v_smfmac_f32_16x16x64_bf16 v[84:87], v[56:59], a[168:175], v15
Lps_46:
s_waitcnt vmcnt(1)
v_max3_u32 v44, v60, v61, v62
v_max_u32 v44, v44, v63
v_cmp_eq_u32 vcc, -1, v44
s_cbranch_vccnz Lpf_47
v_smfmac_f32_16x16x64_bf16 v[64:67], v[60:63], a[192:199], v15
v_smfmac_f32_16x16x64_bf16 v[68:71], v[60:63], a[200:207], v15
v_smfmac_f32_16x16x64_bf16 v[72:75], v[60:63], a[208:215], v15
v_smfmac_f32_16x16x64_bf16 v[76:79], v[60:63], a[216:223], v15
v_smfmac_f32_16x16x64_bf16 v[80:83], v[60:63], a[224:231], v15
v_smfmac_f32_16x16x64_bf16 v[84:87], v[60:63], a[232:239], v15
Lps_48:
s_waitcnt vmcnt(0)
v_max3_u32 v44, v48, v49, v50
v_max_u32 v44, v44, v51
v_cmp_eq_u32 vcc, -1, v44
s_cbranch_vccnz Lpf_49
v_smfmac_f32_16x16x64_bf16 v[64:67], v[48:51], a[0:7], v15
s_nop 1
v_smfmac_f32_16x16x64_bf16 v[68:71], v[48:51], a[8:15], v15
s_nop 1
v_smfmac_f32_16x16x64_bf16 v[72:75], v[48:51], a[16:23], v15
s_nop 1
v_smfmac_f32_16x16x64_bf16 v[76:79], v[48:51], a[24:31], v15
v_add_f32 v96, v64, v66
v_add_f32 v97, v65, v67
v_smfmac_f32_16x16x64_bf16 v[80:83], v[48:51], a[32:39], v15
v_add_f32 v98, v68, v70
v_add_f32 v99, v69, v71
v_smfmac_f32_16x16x64_bf16 v[84:87], v[48:51], a[40:47], v15
v_add_f32 v100, v72, v74
v_add_f32 v101, v73, v75
ds_write_b128 v211, v[96:99] offset:0
v_smfmac_f32_16x16x64_bf16 v[88:91], v[48:51], a[48:55], v15
v_add_f32 v102, v76, v78
v_add_f32 v103, v77, v79
v_add_f32 v104, v80, v82
v_add_f32 v105, v81, v83
ds_write_b128 v212, v[100:103] offset:0
v_smfmac_f32_16x16x64_bf16 v[88:91], v[52:55], a[112:119], v15
v_add_f32 v106, v84, v86
v_add_f32 v107, v85, v87
ds_write_b128 v213, v[104:107] offset:0
s_branch Lpd_25
Lpf_27:
buffer_load_dwordx4 v[52:55], v10, s[4:7], s40 offen offset:1024 sc1
s_sub_u32 s37, s37, 1
s_cbranch_scc1 Lend_1
Lps_50:
s_waitcnt vmcnt(2)
v_max3_u32 v44, v56, v57, v58
v_max_u32 v44, v44, v59
v_cmp_eq_u32 vcc, -1, v44
s_cbranch_vccnz Lpf_51
v_smfmac_f32_16x16x64_bf16 v[64:67], v[56:59], a[128:135], v15
v_smfmac_f32_16x16x64_bf16 v[68:71], v[56:59], a[136:143], v15
v_smfmac_f32_16x16x64_bf16 v[72:75], v[56:59], a[144:151], v15
v_smfmac_f32_16x16x64_bf16 v[76:79], v[56:59], a[152:159], v15
v_smfmac_f32_16x16x64_bf16 v[80:83], v[56:59], a[160:167], v15
v_smfmac_f32_16x16x64_bf16 v[84:87], v[56:59], a[168:175], v15
Lps_52:
s_waitcnt vmcnt(1)
v_max3_u32 v44, v60, v61, v62
v_max_u32 v44, v44, v63
v_cmp_eq_u32 vcc, -1, v44
s_cbranch_vccnz Lpf_53
v_smfmac_f32_16x16x64_bf16 v[64:67], v[60:63], a[192:199], v15
v_smfmac_f32_16x16x64_bf16 v[68:71], v[60:63], a[200:207], v15
v_smfmac_f32_16x16x64_bf16 v[72:75], v[60:63], a[208:215], v15
v_smfmac_f32_16x16x64_bf16 v[76:79], v[60:63], a[216:223], v15
v_smfmac_f32_16x16x64_bf16 v[80:83], v[60:63], a[224:231], v15
v_smfmac_f32_16x16x64_bf16 v[84:87], v[60:63], a[232:239], v15
Lps_54:
s_waitcnt vmcnt(0)
v_max3_u32 v44, v52, v53, v54
v_max_u32 v44, v44, v55
v_cmp_eq_u32 vcc, -1, v44
s_cbranch_vccnz Lpf_55
v_smfmac_f32_16x16x64_bf16 v[64:67], v[52:55], a[64:71], v15
s_nop 1
v_smfmac_f32_16x16x64_bf16 v[68:71], v[52:55], a[72:79], v15
s_nop 1
v_smfmac_f32_16x16x64_bf16 v[72:75], v[52:55], a[80:87], v15
s_nop 1
v_smfmac_f32_16x16x64_bf16 v[76:79], v[52:55], a[88:95], v15
v_add_f32 v96, v64, v66
v_add_f32 v97, v65, v67
v_smfmac_f32_16x16x64_bf16 v[80:83], v[52:55], a[96:103], v15
v_add_f32 v98, v68, v70
v_add_f32 v99, v69, v71
v_smfmac_f32_16x16x64_bf16 v[84:87], v[52:55], a[104:111], v15
v_add_f32 v100, v72, v74
v_add_f32 v101, v73, v75
ds_write_b128 v211, v[96:99] offset:0
v_smfmac_f32_16x16x64_bf16 v[88:91], v[48:51], a[48:55], v15
v_add_f32 v102, v76, v78
v_add_f32 v103, v77, v79
v_add_f32 v104, v80, v82
v_add_f32 v105, v81, v83
ds_write_b128 v212, v[100:103] offset:0
v_smfmac_f32_16x16x64_bf16 v[88:91], v[52:55], a[112:119], v15
v_add_f32 v106, v84, v86
v_add_f32 v107, v85, v87
ds_write_b128 v213, v[104:107] offset:0
s_branch Lpd_25
Lpf_43:
buffer_load_dwordx4 v[52:55], v10, s[4:7], s40 offen offset:1024 sc1
Lps_56:
s_waitcnt vmcnt(3)
v_max3_u32 v44, v56, v57, v58
v_max_u32 v44, v44, v59
v_cmp_eq_u32 vcc, -1, v44
s_cbranch_vccnz Lpf_57
v_smfmac_f32_16x16x64_bf16 v[64:67], v[56:59], a[128:135], v15
v_smfmac_f32_16x16x64_bf16 v[68:71], v[56:59], a[136:143], v15
v_smfmac_f32_16x16x64_bf16 v[72:75], v[56:59], a[144:151], v15
v_smfmac_f32_16x16x64_bf16 v[76:79], v[56:59], a[152:159], v15
v_smfmac_f32_16x16x64_bf16 v[80:83], v[56:59], a[160:167], v15
v_smfmac_f32_16x16x64_bf16 v[84:87], v[56:59], a[168:175], v15
Lps_58:
s_waitcnt vmcnt(2)
v_max3_u32 v44, v60, v61, v62
v_max_u32 v44, v44, v63
v_cmp_eq_u32 vcc, -1, v44
s_cbranch_vccnz Lpf_59
v_smfmac_f32_16x16x64_bf16 v[64:67], v[60:63], a[192:199], v15
v_smfmac_f32_16x16x64_bf16 v[68:71], v[60:63], a[200:207], v15
v_smfmac_f32_16x16x64_bf16 v[72:75], v[60:63], a[208:215], v15
v_smfmac_f32_16x16x64_bf16 v[76:79], v[60:63], a[216:223], v15
v_smfmac_f32_16x16x64_bf16 v[80:83], v[60:63], a[224:231], v15
v_smfmac_f32_16x16x64_bf16 v[84:87], v[60:63], a[232:239], v15
Lps_60:
s_waitcnt vmcnt(1)
v_max3_u32 v44, v48, v49, v50
v_max_u32 v44, v44, v51
v_cmp_eq_u32 vcc, -1, v44
s_cbranch_vccnz Lpf_61
v_smfmac_f32_16x16x64_bf16 v[64:67], v[48:51], a[0:7], v15
v_smfmac_f32_16x16x64_bf16 v[68:71], v[48:51], a[8:15], v15
v_smfmac_f32_16x16x64_bf16 v[72:75], v[48:51], a[16:23], v15
v_smfmac_f32_16x16x64_bf16 v[76:79], v[48:51], a[24:31], v15
v_smfmac_f32_16x16x64_bf16 v[80:83], v[48:51], a[32:39], v15
v_smfmac_f32_16x16x64_bf16 v[84:87], v[48:51], a[40:47], v15
s_branch Lps_54
Lpf_45:
buffer_load_dwordx4 v[56:59], v10, s[4:7], s40 offen offset:2048 sc1
Lps_62:
s_waitcnt vmcnt(2)
v_max3_u32 v44, v60, v61, v62
v_max_u32 v44, v44, v63
v_cmp_eq_u32 vcc, -1, v44
s_cbranch_vccnz Lpf_63
v_smfmac_f32_16x16x64_bf16 v[64:67], v[60:63], a[192:199], v15
v_smfmac_f32_16x16x64_bf16 v[68:71], v[60:63], a[200:207], v15
v_smfmac_f32_16x16x64_bf16 v[72:75], v[60:63], a[208:215], v15
v_smfmac_f32_16x16x64_bf16 v[76:79], v[60:63], a[216:223], v15
v_smfmac_f32_16x16x64_bf16 v[80:83], v[60:63], a[224:231], v15
v_smfmac_f32_16x16x64_bf16 v[84:87], v[60:63], a[232:239], v15
Lps_64:
s_waitcnt vmcnt(1)
v_max3_u32 v44, v48, v49, v50
v_max_u32 v44, v44, v51
v_cmp_eq_u32 vcc, -1, v44
s_cbranch_vccnz Lpf_65
v_smfmac_f32_16x16x64_bf16 v[64:67], v[48:51], a[0:7], v15
v_smfmac_f32_16x16x64_bf16 v[68:71], v[48:51], a[8:15], v15
v_smfmac_f32_16x16x64_bf16 v[72:75], v[48:51], a[16:23], v15
v_smfmac_f32_16x16x64_bf16 v[76:79], v[48:51], a[24:31], v15
v_smfmac_f32_16x16x64_bf16 v[80:83], v[48:51], a[32:39], v15
v_smfmac_f32_16x16x64_bf16 v[84:87], v[48:51], a[40:47], v15
Lps_66:
s_waitcnt vmcnt(0)
v_max3_u32 v44, v56, v57, v58
v_max_u32 v44, v44, v59
v_cmp_eq_u32 vcc, -1, v44
s_cbranch_vccnz Lpf_67
v_smfmac_f32_16x16x64_bf16 v[64:67], v[56:59], a[128:135], v15
s_nop 1
v_smfmac_f32_16x16x64_bf16 v[68:71], v[56:59], a[136:143], v15
s_nop 1
v_smfmac_f32_16x16x64_bf16 v[72:75], v[56:59], a[144:151], v15
s_nop 1
v_smfmac_f32_16x16x64_bf16 v[76:79], v[56:59], a[152:159], v15
v_add_f32 v96, v64, v66
v_add_f32 v97, v65, v67
v_smfmac_f32_16x16x64_bf16 v[80:83], v[56:59], a[160:167], v15
v_add_f32 v98, v68, v70
v_add_f32 v99, v69, v71
v_smfmac_f32_16x16x64_bf16 v[84:87], v[56:59], a[168:175], v15
v_add_f32 v100, v72, v74
v_add_f32 v101, v73, v75
ds_write_b128 v211, v[96:99] offset:0
v_smfmac_f32_16x16x64_bf16 v[88:91], v[48:51], a[48:55], v15
v_add_f32 v102, v76, v78
v_add_f32 v103, v77, v79
v_add_f32 v104, v80, v82
v_add_f32 v105, v81, v83
ds_write_b128 v212, v[100:103] offset:0
v_smfmac_f32_16x16x64_bf16 v[88:91], v[52:55], a[112:119], v15
v_add_f32 v106, v84, v86
v_add_f32 v107, v85, v87
ds_write_b128 v213, v[104:107] offset:0
s_branch Lpd_25
Lpf_47:
buffer_load_dwordx4 v[60:63], v10, s[4:7], s40 offen offset:3072 sc1
Lps_68:
s_waitcnt vmcnt(1)
v_max3_u32 v44, v48, v49, v50
v_max_u32 v44, v44, v51
v_cmp_eq_u32 vcc, -1, v44
s_cbranch_vccnz Lpf_69
v_smfmac_f32_16x16x64_bf16 v[64:67], v[48:51], a[0:7], v15
v_smfmac_f32_16x16x64_bf16 v[68:71], v[48:51], a[8:15], v15
v_smfmac_f32_16x16x64_bf16 v[72:75], v[48:51], a[16:23], v15
v_smfmac_f32_16x16x64_bf16 v[76:79], v[48:51], a[24:31], v15
v_smfmac_f32_16x16x64_bf16 v[80:83], v[48:51], a[32:39], v15
v_smfmac_f32_16x16x64_bf16 v[84:87], v[48:51], a[40:47], v15
Lps_70:
s_waitcnt vmcnt(0)
v_max3_u32 v44, v60, v61, v62
v_max_u32 v44, v44, v63
v_cmp_eq_u32 vcc, -1, v44
s_cbranch_vccnz Lpf_71
v_smfmac_f32_16x16x64_bf16 v[64:67], v[60:63], a[192:199], v15
s_nop 1
v_smfmac_f32_16x16x64_bf16 v[68:71], v[60:63], a[200:207], v15
s_nop 1
v_smfmac_f32_16x16x64_bf16 v[72:75], v[60:63], a[208:215], v15
s_nop 1
v_smfmac_f32_16x16x64_bf16 v[76:79], v[60:63], a[216:223], v15
v_add_f32 v96, v64, v66
v_add_f32 v97, v65, v67
v_smfmac_f32_16x16x64_bf16 v[80:83], v[60:63], a[224:231], v15
v_add_f32 v98, v68, v70
v_add_f32 v99, v69, v71
v_smfmac_f32_16x16x64_bf16 v[84:87], v[60:63], a[232:239], v15
v_add_f32 v100, v72, v74
v_add_f32 v101, v73, v75
ds_write_b128 v211, v[96:99] offset:0
v_smfmac_f32_16x16x64_bf16 v[88:91], v[48:51], a[48:55], v15
v_add_f32 v102, v76, v78
v_add_f32 v103, v77, v79
v_add_f32 v104, v80, v82
v_add_f32 v105, v81, v83
ds_write_b128 v212, v[100:103] offset:0
v_smfmac_f32_16x16x64_bf16 v[88:91], v[52:55], a[112:119], v15
v_add_f32 v106, v84, v86
v_add_f32 v107, v85, v87
ds_write_b128 v213, v[104:107] offset:0
s_branch Lpd_25
Lpf_49:
buffer_load_dwordx4 v[48:51], v10, s[4:7], s40 offen offset:0 sc1
s_sub_u32 s37, s37, 1
s_cbranch_scc1 Lend_1
s_branch Lps_48
Lpf_51:
buffer_load_dwordx4 v[56:59], v10, s[4:7], s40 offen offset:2048 sc1
Lps_72:
s_waitcnt vmcnt(2)
v_max3_u32 v44, v60, v61, v62
v_max_u32 v44, v44, v63
v_cmp_eq_u32 vcc, -1, v44
s_cbranch_vccnz Lpf_73
v_smfmac_f32_16x16x64_bf16 v[64:67], v[60:63], a[192:199], v15
v_smfmac_f32_16x16x64_bf16 v[68:71], v[60:63], a[200:207], v15
v_smfmac_f32_16x16x64_bf16 v[72:75], v[60:63], a[208:215], v15
v_smfmac_f32_16x16x64_bf16 v[76:79], v[60:63], a[216:223], v15
v_smfmac_f32_16x16x64_bf16 v[80:83], v[60:63], a[224:231], v15
v_smfmac_f32_16x16x64_bf16 v[84:87], v[60:63], a[232:239], v15
Lps_74:
s_waitcnt vmcnt(1)
v_max3_u32 v44, v52, v53, v54
v_max_u32 v44, v44, v55
v_cmp_eq_u32 vcc, -1, v44
s_cbranch_vccnz Lpf_75
v_smfmac_f32_16x16x64_bf16 v[64:67], v[52:55], a[64:71], v15
v_smfmac_f32_16x16x64_bf16 v[68:71], v[52:55], a[72:79], v15
v_smfmac_f32_16x16x64_bf16 v[72:75], v[52:55], a[80:87], v15
v_smfmac_f32_16x16x64_bf16 v[76:79], v[52:55], a[88:95], v15
v_smfmac_f32_16x16x64_bf16 v[80:83], v[52:55], a[96:103], v15
v_smfmac_f32_16x16x64_bf16 v[84:87], v[52:55], a[104:111], v15
s_branch Lps_66
Lpf_53:
buffer_load_dwordx4 v[60:63], v10, s[4:7], s40 offen offset:3072 sc1
Lps_76:
s_waitcnt vmcnt(1)
v_max3_u32 v44, v52, v53, v54
v_max_u32 v44, v44, v55
v_cmp_eq_u32 vcc, -1, v44
s_cbranch_vccnz Lpf_77
v_smfmac_f32_16x16x64_bf16 v[64:67], v[52:55], a[64:71], v15
v_smfmac_f32_16x16x64_bf16 v[68:71], v[52:55], a[72:79], v15
v_smfmac_f32_16x16x64_bf16 v[72:75], v[52:55], a[80:87], v15
v_smfmac_f32_16x16x64_bf16 v[76:79], v[52:55], a[88:95], v15
v_smfmac_f32_16x16x64_bf16 v[80:83], v[52:55], a[96:103], v15
v_smfmac_f32_16x16x64_bf16 v[84:87], v[52:55], a[104:111], v15
s_branch Lps_70
Lpf_55:
buffer_load_dwordx4 v[52:55], v10, s[4:7], s40 offen offset:1024 sc1
s_sub_u32 s37, s37, 1
s_cbranch_scc1 Lend_1
s_branch Lps_54
Lpf_57:
buffer_load_dwordx4 v[56:59], v10, s[4:7], s40 offen offset:2048 sc1
Lps_78:
s_waitcnt vmcnt(3)
v_max3_u32 v44, v60, v61, v62
v_max_u32 v44, v44, v63
v_cmp_eq_u32 vcc, -1, v44
s_cbranch_vccnz Lpf_79
v_smfmac_f32_16x16x64_bf16 v[64:67], v[60:63], a[192:199], v15
v_smfmac_f32_16x16x64_bf16 v[68:71], v[60:63], a[200:207], v15
v_smfmac_f32_16x16x64_bf16 v[72:75], v[60:63], a[208:215], v15
v_smfmac_f32_16x16x64_bf16 v[76:79], v[60:63], a[216:223], v15
v_smfmac_f32_16x16x64_bf16 v[80:83], v[60:63], a[224:231], v15
v_smfmac_f32_16x16x64_bf16 v[84:87], v[60:63], a[232:239], v15
Lps_80:
s_waitcnt vmcnt(2)
v_max3_u32 v44, v48, v49, v50
v_max_u32 v44, v44, v51
v_cmp_eq_u32 vcc, -1, v44
s_cbranch_vccnz Lpf_81
v_smfmac_f32_16x16x64_bf16 v[64:67], v[48:51], a[0:7], v15
v_smfmac_f32_16x16x64_bf16 v[68:71], v[48:51], a[8:15], v15
v_smfmac_f32_16x16x64_bf16 v[72:75], v[48:51], a[16:23], v15
v_smfmac_f32_16x16x64_bf16 v[76:79], v[48:51], a[24:31], v15
v_smfmac_f32_16x16x64_bf16 v[80:83], v[48:51], a[32:39], v15
v_smfmac_f32_16x16x64_bf16 v[84:87], v[48:51], a[40:47], v15
s_branch Lps_74
Lpf_59:
buffer_load_dwordx4 v[60:63], v10, s[4:7], s40 offen offset:3072 sc1
Lps_82:
s_waitcnt vmcnt(2)
v_max3_u32 v44, v48, v49, v50
v_max_u32 v44, v44, v51
v_cmp_eq_u32 vcc, -1, v44
s_cbranch_vccnz Lpf_83
v_smfmac_f32_16x16x64_bf16 v[64:67], v[48:51], a[0:7], v15
v_smfmac_f32_16x16x64_bf16 v[68:71], v[48:51], a[8:15], v15
v_smfmac_f32_16x16x64_bf16 v[72:75], v[48:51], a[16:23], v15
v_smfmac_f32_16x16x64_bf16 v[76:79], v[48:51], a[24:31], v15
v_smfmac_f32_16x16x64_bf16 v[80:83], v[48:51], a[32:39], v15
v_smfmac_f32_16x16x64_bf16 v[84:87], v[48:51], a[40:47], v15
s_branch Lps_76
Lpf_61:
buffer_load_dwordx4 v[48:51], v10, s[4:7], s40 offen offset:0 sc1
s_sub_u32 s37, s37, 1
s_cbranch_scc1 Lend_1
Lps_84:
s_waitcnt vmcnt(1)
v_max3_u32 v44, v52, v53, v54
v_max_u32 v44, v44, v55
v_cmp_eq_u32 vcc, -1, v44
s_cbranch_vccnz Lpf_85
v_smfmac_f32_16x16x64_bf16 v[64:67], v[52:55], a[64:71], v15
v_smfmac_f32_16x16x64_bf16 v[68:71], v[52:55], a[72:79], v15
v_smfmac_f32_16x16x64_bf16 v[72:75], v[52:55], a[80:87], v15
v_smfmac_f32_16x16x64_bf16 v[76:79], v[52:55], a[88:95], v15
v_smfmac_f32_16x16x64_bf16 v[80:83], v[52:55], a[96:103], v15
v_smfmac_f32_16x16x64_bf16 v[84:87], v[52:55], a[104:111], v15
s_branch Lps_48
Lpf_63:
buffer_load_dwordx4 v[60:63], v10, s[4:7], s40 offen offset:3072 sc1
Lps_86:
s_waitcnt vmcnt(2)
v_max3_u32 v44, v48, v49, v50
v_max_u32 v44, v44, v51
v_cmp_eq_u32 vcc, -1, v44
s_cbranch_vccnz Lpf_87
v_smfmac_f32_16x16x64_bf16 v[64:67], v[48:51], a[0:7], v15
v_smfmac_f32_16x16x64_bf16 v[68:71], v[48:51], a[8:15], v15
v_smfmac_f32_16x16x64_bf16 v[72:75], v[48:51], a[16:23], v15
v_smfmac_f32_16x16x64_bf16 v[76:79], v[48:51], a[24:31], v15
v_smfmac_f32_16x16x64_bf16 v[80:83], v[48:51], a[32:39], v15
v_smfmac_f32_16x16x64_bf16 v[84:87], v[48:51], a[40:47], v15
Lps_41:
s_waitcnt vmcnt(1)
v_max3_u32 v44, v56, v57, v58
v_max_u32 v44, v44, v59
v_cmp_eq_u32 vcc, -1, v44
s_cbranch_vccnz Lpf_88
v_smfmac_f32_16x16x64_bf16 v[64:67], v[56:59], a[128:135], v15
v_smfmac_f32_16x16x64_bf16 v[68:71], v[56:59], a[136:143], v15
v_smfmac_f32_16x16x64_bf16 v[72:75], v[56:59], a[144:151], v15
v_smfmac_f32_16x16x64_bf16 v[76:79], v[56:59], a[152:159], v15
v_smfmac_f32_16x16x64_bf16 v[80:83], v[56:59], a[160:167], v15
v_smfmac_f32_16x16x64_bf16 v[84:87], v[56:59], a[168:175], v15
s_branch Lps_70
Lpf_65:
buffer_load_dwordx4 v[48:51], v10, s[4:7], s40 offen offset:0 sc1
s_sub_u32 s37, s37, 1
s_cbranch_scc1 Lend_1
Lps_89:
s_waitcnt vmcnt(1)
v_max3_u32 v44, v56, v57, v58
v_max_u32 v44, v44, v59
v_cmp_eq_u32 vcc, -1, v44
s_cbranch_vccnz Lpf_90
v_smfmac_f32_16x16x64_bf16 v[64:67], v[56:59], a[128:135], v15
v_smfmac_f32_16x16x64_bf16 v[68:71], v[56:59], a[136:143], v15
v_smfmac_f32_16x16x64_bf16 v[72:75], v[56:59], a[144:151], v15
v_smfmac_f32_16x16x64_bf16 v[76:79], v[56:59], a[152:159], v15
v_smfmac_f32_16x16x64_bf16 v[80:83], v[56:59], a[160:167], v15
v_smfmac_f32_16x16x64_bf16 v[84:87], v[56:59], a[168:175], v15
s_branch Lps_48
Lpf_67:
buffer_load_dwordx4 v[56:59], v10, s[4:7], s40 offen offset:2048 sc1
s_sub_u32 s37, s37, 1
s_cbranch_scc1 Lend_1
s_branch Lps_66
Lpf_69:
buffer_load_dwordx4 v[48:51], v10, s[4:7], s40 offen offset:0 sc1
s_sub_u32 s37, s37, 1
s_cbranch_scc1 Lend_1
s_branch Lps_46
Lpf_71:
buffer_load_dwordx4 v[60:63], v10, s[4:7], s40 offen offset:3072 sc1
s_sub_u32 s37, s37, 1
s_cbranch_scc1 Lend_1
s_branch Lps_70
Lpf_73:
buffer_load_dwordx4 v[60:63], v10, s[4:7], s40 offen offset:3072 sc1
Lps_91:
s_waitcnt vmcnt(2)
v_max3_u32 v44, v52, v53, v54
v_max_u32 v44, v44, v55
v_cmp_eq_u32 vcc, -1, v44
s_cbranch_vccnz Lpf_92
v_smfmac_f32_16x16x64_bf16 v[64:67], v[52:55], a[64:71], v15
v_smfmac_f32_16x16x64_bf16 v[68:71], v[52:55], a[72:79], v15
v_smfmac_f32_16x16x64_bf16 v[72:75], v[52:55], a[80:87], v15
v_smfmac_f32_16x16x64_bf16 v[76:79], v[52:55], a[88:95], v15
v_smfmac_f32_16x16x64_bf16 v[80:83], v[52:55], a[96:103], v15
v_smfmac_f32_16x16x64_bf16 v[84:87], v[52:55], a[104:111], v15
s_branch Lps_41
Lpf_75:
buffer_load_dwordx4 v[52:55], v10, s[4:7], s40 offen offset:1024 sc1
s_sub_u32 s37, s37, 1
s_cbranch_scc1 Lend_1
Lps_93:
s_waitcnt vmcnt(1)
v_max3_u32 v44, v56, v57, v58
v_max_u32 v44, v44, v59
v_cmp_eq_u32 vcc, -1, v44
s_cbranch_vccnz Lpf_94
v_smfmac_f32_16x16x64_bf16 v[64:67], v[56:59], a[128:135], v15
v_smfmac_f32_16x16x64_bf16 v[68:71], v[56:59], a[136:143], v15
v_smfmac_f32_16x16x64_bf16 v[72:75], v[56:59], a[144:151], v15
v_smfmac_f32_16x16x64_bf16 v[76:79], v[56:59], a[152:159], v15
v_smfmac_f32_16x16x64_bf16 v[80:83], v[56:59], a[160:167], v15
v_smfmac_f32_16x16x64_bf16 v[84:87], v[56:59], a[168:175], v15
s_branch Lps_54
Lpf_77:
buffer_load_dwordx4 v[52:55], v10, s[4:7], s40 offen offset:1024 sc1
s_sub_u32 s37, s37, 1
s_cbranch_scc1 Lend_1
s_branch Lps_52
Lpf_79:
buffer_load_dwordx4 v[60:63], v10, s[4:7], s40 offen offset:3072 sc1
Lps_95:
s_waitcnt vmcnt(3)
v_max3_u32 v44, v48, v49, v50
v_max_u32 v44, v44, v51
v_cmp_eq_u32 vcc, -1, v44
s_cbranch_vccnz Lpf_96
v_smfmac_f32_16x16x64_bf16 v[64:67], v[48:51], a[0:7], v15
v_smfmac_f32_16x16x64_bf16 v[68:71], v[48:51], a[8:15], v15
v_smfmac_f32_16x16x64_bf16 v[72:75], v[48:51], a[16:23], v15
v_smfmac_f32_16x16x64_bf16 v[76:79], v[48:51], a[24:31], v15
v_smfmac_f32_16x16x64_bf16 v[80:83], v[48:51], a[32:39], v15
v_smfmac_f32_16x16x64_bf16 v[84:87], v[48:51], a[40:47], v15
s_branch Lps_91
Lpf_81:
buffer_load_dwordx4 v[48:51], v10, s[4:7], s40 offen offset:0 sc1
s_sub_u32 s37, s37, 1
s_cbranch_scc1 Lend_1
Lps_97:
s_waitcnt vmcnt(2)
v_max3_u32 v44, v52, v53, v54
v_max_u32 v44, v44, v55
v_cmp_eq_u32 vcc, -1, v44
s_cbranch_vccnz Lpf_98
v_smfmac_f32_16x16x64_bf16 v[64:67], v[52:55], a[64:71], v15
v_smfmac_f32_16x16x64_bf16 v[68:71], v[52:55], a[72:79], v15
v_smfmac_f32_16x16x64_bf16 v[72:75], v[52:55], a[80:87], v15
v_smfmac_f32_16x16x64_bf16 v[76:79], v[52:55], a[88:95], v15
v_smfmac_f32_16x16x64_bf16 v[80:83], v[52:55], a[96:103], v15
v_smfmac_f32_16x16x64_bf16 v[84:87], v[52:55], a[104:111], v15
s_branch Lps_89
Lpf_83:
buffer_load_dwordx4 v[48:51], v10, s[4:7], s40 offen offset:0 sc1
s_sub_u32 s37, s37, 1
s_cbranch_scc1 Lend_1
Lps_99:
s_waitcnt vmcnt(2)
v_max3_u32 v44, v52, v53, v54
v_max_u32 v44, v44, v55
v_cmp_eq_u32 vcc, -1, v44
s_cbranch_vccnz Lpf_100
v_smfmac_f32_16x16x64_bf16 v[64:67], v[52:55], a[64:71], v15
v_smfmac_f32_16x16x64_bf16 v[68:71], v[52:55], a[72:79], v15
v_smfmac_f32_16x16x64_bf16 v[72:75], v[52:55], a[80:87], v15
v_smfmac_f32_16x16x64_bf16 v[76:79], v[52:55], a[88:95], v15
v_smfmac_f32_16x16x64_bf16 v[80:83], v[52:55], a[96:103], v15
v_smfmac_f32_16x16x64_bf16 v[84:87], v[52:55], a[104:111], v15
s_branch Lps_46
Lpf_85:
buffer_load_dwordx4 v[52:55], v10, s[4:7], s40 offen offset:1024 sc1
s_branch Lps_60
Lpf_87:
buffer_load_dwordx4 v[48:51], v10, s[4:7], s40 offen offset:0 sc1
s_sub_u32 s37, s37, 1
s_cbranch_scc1 Lend_1
s_branch Lps_44
Lpf_88:
buffer_load_dwordx4 v[56:59], v10, s[4:7], s40 offen offset:2048 sc1
s_sub_u32 s37, s37, 1
s_cbranch_scc1 Lend_1
Lps_101:
s_waitcnt vmcnt(1)
v_max3_u32 v44, v60, v61, v62
v_max_u32 v44, v44, v63
v_cmp_eq_u32 vcc, -1, v44
s_cbranch_vccnz Lpf_102
v_smfmac_f32_16x16x64_bf16 v[64:67], v[60:63], a[192:199], v15
v_smfmac_f32_16x16x64_bf16 v[68:71], v[60:63], a[200:207], v15
v_smfmac_f32_16x16x64_bf16 v[72:75], v[60:63], a[208:215], v15
v_smfmac_f32_16x16x64_bf16 v[76:79], v[60:63], a[216:223], v15
v_smfmac_f32_16x16x64_bf16 v[80:83], v[60:63], a[224:231], v15
v_smfmac_f32_16x16x64_bf16 v[84:87], v[60:63], a[232:239], v15
s_branch Lps_66
Lpf_90:
buffer_load_dwordx4 v[56:59], v10, s[4:7], s40 offen offset:2048 sc1
s_branch Lps_64
Lpf_92:
buffer_load_dwordx4 v[52:55], v10, s[4:7], s40 offen offset:1024 sc1
s_sub_u32 s37, s37, 1
s_cbranch_scc1 Lend_1
s_branch Lps_50
Lpf_94:
buffer_load_dwordx4 v[56:59], v10, s[4:7], s40 offen offset:2048 sc1
s_branch Lps_74
Lpf_96:
buffer_load_dwordx4 v[48:51], v10, s[4:7], s40 offen offset:0 sc1
s_sub_u32 s37, s37, 1
s_cbranch_scc1 Lend_1
s_branch Lps_42
Lpf_98:
buffer_load_dwordx4 v[52:55], v10, s[4:7], s40 offen offset:1024 sc1
Lps_103:
s_waitcnt vmcnt(2)
v_max3_u32 v44, v56, v57, v58
v_max_u32 v44, v44, v59
v_cmp_eq_u32 vcc, -1, v44
s_cbranch_vccnz Lpf_104
v_smfmac_f32_16x16x64_bf16 v[64:67], v[56:59], a[128:135], v15
v_smfmac_f32_16x16x64_bf16 v[68:71], v[56:59], a[136:143], v15
v_smfmac_f32_16x16x64_bf16 v[72:75], v[56:59], a[144:151], v15
v_smfmac_f32_16x16x64_bf16 v[76:79], v[56:59], a[152:159], v15
v_smfmac_f32_16x16x64_bf16 v[80:83], v[56:59], a[160:167], v15
v_smfmac_f32_16x16x64_bf16 v[84:87], v[56:59], a[168:175], v15
s_branch Lps_60
Lpf_100:
buffer_load_dwordx4 v[52:55], v10, s[4:7], s40 offen offset:1024 sc1
s_branch Lps_58
Lpf_102:
buffer_load_dwordx4 v[60:63], v10, s[4:7], s40 offen offset:3072 sc1
s_branch Lps_41
Lpf_104:
buffer_load_dwordx4 v[56:59], v10, s[4:7], s40 offen offset:2048 sc1
s_branch Lps_80
Lkr_29:
buffer_load_dwordx4 v[56:59], v11, s[4:7], s40 offen offset:0 sc1
buffer_load_dwordx4 v[60:63], v11, s[4:7], s40 offen offset:1024 sc1
Lps_106:
s_waitcnt vmcnt(3)
v_max3_u32 v44, v48, v49, v50
v_max_u32 v44, v44, v51
v_cmp_eq_u32 vcc, -1, v44
s_cbranch_vccnz Lpf_107
v_smfmac_f32_16x16x64_bf16 v[72:75], v[48:51], v[96:103], v15
v_mov_b32 v112, v48
v_mov_b32 v113, v49
v_mov_b32 v114, v50
v_mov_b32 v115, v51
Lps_108:
s_waitcnt vmcnt(2)
v_max3_u32 v44, v52, v53, v54
v_max_u32 v44, v44, v55
v_cmp_eq_u32 vcc, -1, v44
s_cbranch_vccnz Lpf_109
v_smfmac_f32_16x16x64_bf16 v[72:75], v[52:55], v[104:111], v15
v_mov_b32 v116, v52
v_mov_b32 v117, v53
v_mov_b32 v118, v54
v_mov_b32 v119, v55
Lpd_105:
s_branch Lko_30
Lpf_107:
buffer_load_dwordx4 v[48:51], v11, s[4:7], s40 offen offset:0 sc1
s_sub_u32 s37, s37, 1
s_cbranch_scc1 Lend_1
Lps_110:
s_waitcnt vmcnt(3)
v_max3_u32 v44, v52, v53, v54
v_max_u32 v44, v44, v55
v_cmp_eq_u32 vcc, -1, v44
s_cbranch_vccnz Lpf_111
v_smfmac_f32_16x16x64_bf16 v[72:75], v[52:55], v[104:111], v15
v_mov_b32 v116, v52
v_mov_b32 v117, v53
v_mov_b32 v118, v54
v_mov_b32 v119, v55
Lps_112:
s_waitcnt vmcnt(2)
v_max3_u32 v44, v56, v57, v58
v_max_u32 v44, v44, v59
v_cmp_eq_u32 vcc, -1, v44
s_cbranch_vccnz Lpf_113
v_smfmac_f32_16x16x64_bf16 v[72:75], v[56:59], v[96:103], v15
v_mov_b32 v112, v56
v_mov_b32 v113, v57
v_mov_b32 v114, v58
v_mov_b32 v115, v59
s_branch Lpd_105
Lpf_109:
buffer_load_dwordx4 v[52:55], v11, s[4:7], s40 offen offset:1024 sc1
s_sub_u32 s37, s37, 1
s_cbranch_scc1 Lend_1
Lps_114:
s_waitcnt vmcnt(2)
v_max3_u32 v44, v56, v57, v58
v_max_u32 v44, v44, v59
v_cmp_eq_u32 vcc, -1, v44
s_cbranch_vccnz Lpf_115
Lps_116:
s_waitcnt vmcnt(1)
v_max3_u32 v44, v60, v61, v62
v_max_u32 v44, v44, v63
v_cmp_eq_u32 vcc, -1, v44
s_cbranch_vccnz Lpf_117
v_smfmac_f32_16x16x64_bf16 v[72:75], v[60:63], v[104:111], v15
v_mov_b32 v116, v60
v_mov_b32 v117, v61
v_mov_b32 v118, v62
v_mov_b32 v119, v63
s_branch Lpd_105
Lpf_111:
buffer_load_dwordx4 v[52:55], v11, s[4:7], s40 offen offset:1024 sc1
Lps_118:
s_waitcnt vmcnt(3)
v_max3_u32 v44, v56, v57, v58
v_max_u32 v44, v44, v59
v_cmp_eq_u32 vcc, -1, v44
s_cbranch_vccnz Lpf_119
v_smfmac_f32_16x16x64_bf16 v[72:75], v[56:59], v[96:103], v15
v_mov_b32 v112, v56
v_mov_b32 v113, v57
v_mov_b32 v114, v58
v_mov_b32 v115, v59
Lps_120:
s_waitcnt vmcnt(2)
v_max3_u32 v44, v60, v61, v62
v_max_u32 v44, v44, v63
v_cmp_eq_u32 vcc, -1, v44
s_cbranch_vccnz Lpf_121
v_smfmac_f32_16x16x64_bf16 v[72:75], v[60:63], v[104:111], v15
v_mov_b32 v116, v60
v_mov_b32 v117, v61
v_mov_b32 v118, v62
v_mov_b32 v119, v63
s_branch Lpd_105
Lpf_113:
buffer_load_dwordx4 v[56:59], v11, s[4:7], s40 offen offset:0 sc1
Lps_122:
s_waitcnt vmcnt(2)
v_max3_u32 v44, v60, v61, v62
v_max_u32 v44, v44, v63
v_cmp_eq_u32 vcc, -1, v44
s_cbranch_vccnz Lpf_123
Lps_124:
s_waitcnt vmcnt(1)
v_max3_u32 v44, v48, v49, v50
v_max_u32 v44, v44, v51
v_cmp_eq_u32 vcc, -1, v44
s_cbranch_vccnz Lpf_125
v_smfmac_f32_16x16x64_bf16 v[72:75], v[48:51], v[96:103], v15
v_mov_b32 v112, v48
v_mov_b32 v113, v49
v_mov_b32 v114, v50
v_mov_b32 v115, v51
s_branch Lpd_105
Lpf_115:
buffer_load_dwordx4 v[56:59], v11, s[4:7], s40 offen offset:0 sc1
Lps_126:
s_waitcnt vmcnt(2)
v_max3_u32 v44, v60, v61, v62
v_max_u32 v44, v44, v63
v_cmp_eq_u32 vcc, -1, v44
s_cbranch_vccnz Lpf_127
v_smfmac_f32_16x16x64_bf16 v[72:75], v[60:63], v[104:111], v15
v_mov_b32 v116, v60
v_mov_b32 v117, v61
v_mov_b32 v118, v62
v_mov_b32 v119, v63
s_branch Lpd_105
Lpf_117:
buffer_load_dwordx4 v[60:63], v11, s[4:7], s40 offen offset:1024 sc1
Lps_128:
s_waitcnt vmcnt(1)
v_max3_u32 v44, v52, v53, v54
v_max_u32 v44, v44, v55
v_cmp_eq_u32 vcc, -1, v44
s_cbranch_vccnz Lpf_129
v_smfmac_f32_16x16x64_bf16 v[72:75], v[52:55], v[104:111], v15
v_mov_b32 v116, v52
v_mov_b32 v117, v53
v_mov_b32 v118, v54
v_mov_b32 v119, v55
s_branch Lpd_105
Lpf_119:
buffer_load_dwordx4 v[56:59], v11, s[4:7], s40 offen offset:0 sc1
Lps_130:
s_waitcnt vmcnt(3)
v_max3_u32 v44, v60, v61, v62
v_max_u32 v44, v44, v63
v_cmp_eq_u32 vcc, -1, v44
s_cbranch_vccnz Lpf_131
v_smfmac_f32_16x16x64_bf16 v[72:75], v[60:63], v[104:111], v15
v_mov_b32 v116, v60
v_mov_b32 v117, v61
v_mov_b32 v118, v62
v_mov_b32 v119, v63
Lps_132:
s_waitcnt vmcnt(2)
v_max3_u32 v44, v48, v49, v50
v_max_u32 v44, v44, v51
v_cmp_eq_u32 vcc, -1, v44
s_cbranch_vccnz Lpf_133
v_smfmac_f32_16x16x64_bf16 v[72:75], v[48:51], v[96:103], v15
v_mov_b32 v112, v48
v_mov_b32 v113, v49
v_mov_b32 v114, v50
v_mov_b32 v115, v51
s_branch Lpd_105
Lpf_121:
buffer_load_dwordx4 v[60:63], v11, s[4:7], s40 offen offset:1024 sc1
Lps_134:
s_waitcnt vmcnt(2)
v_max3_u32 v44, v48, v49, v50
v_max_u32 v44, v44, v51
v_cmp_eq_u32 vcc, -1, v44
s_cbranch_vccnz Lpf_135
s_branch Lps_128
Lpf_123:
buffer_load_dwordx4 v[60:63], v11, s[4:7], s40 offen offset:1024 sc1
Lps_136:
s_waitcnt vmcnt(2)
v_max3_u32 v44, v48, v49, v50
v_max_u32 v44, v44, v51
v_cmp_eq_u32 vcc, -1, v44
s_cbranch_vccnz Lpf_137
v_smfmac_f32_16x16x64_bf16 v[72:75], v[48:51], v[96:103], v15
v_mov_b32 v112, v48
v_mov_b32 v113, v49
v_mov_b32 v114, v50
v_mov_b32 v115, v51
s_branch Lpd_105
Lpf_125:
buffer_load_dwordx4 v[48:51], v11, s[4:7], s40 offen offset:0 sc1
s_sub_u32 s37, s37, 1
s_cbranch_scc1 Lend_1
Lps_138:
s_waitcnt vmcnt(1)
v_max3_u32 v44, v56, v57, v58
v_max_u32 v44, v44, v59
v_cmp_eq_u32 vcc, -1, v44
s_cbranch_vccnz Lpf_139
v_smfmac_f32_16x16x64_bf16 v[72:75], v[56:59], v[96:103], v15
v_mov_b32 v112, v56
v_mov_b32 v113, v57
v_mov_b32 v114, v58
v_mov_b32 v115, v59
s_branch Lpd_105
Lpf_127:
buffer_load_dwordx4 v[60:63], v11, s[4:7], s40 offen offset:1024 sc1
s_branch Lps_108
Lpf_129:
buffer_load_dwordx4 v[52:55], v11, s[4:7], s40 offen offset:1024 sc1
s_sub_u32 s37, s37, 1
s_cbranch_scc1 Lend_1
s_branch Lps_116
Lpf_131:
buffer_load_dwordx4 v[60:63], v11, s[4:7], s40 offen offset:1024 sc1
s_branch Lps_106
Lpf_133:
buffer_load_dwordx4 v[48:51], v11, s[4:7], s40 offen offset:0 sc1
s_sub_u32 s37, s37, 1
s_cbranch_scc1 Lend_1
Lps_140:
s_waitcnt vmcnt(2)
v_max3_u32 v44, v52, v53, v54
v_max_u32 v44, v44, v55
v_cmp_eq_u32 vcc, -1, v44
s_cbranch_vccnz Lpf_141
s_branch Lps_138
Lpf_135:
buffer_load_dwordx4 v[48:51], v11, s[4:7], s40 offen offset:0 sc1
s_sub_u32 s37, s37, 1
s_cbranch_scc1 Lend_1
Lps_142:
s_waitcnt vmcnt(2)
v_max3_u32 v44, v52, v53, v54
v_max_u32 v44, v44, v55
v_cmp_eq_u32 vcc, -1, v44
s_cbranch_vccnz Lpf_143
v_smfmac_f32_16x16x64_bf16 v[72:75], v[52:55], v[104:111], v15
v_mov_b32 v116, v52
v_mov_b32 v117, v53
v_mov_b32 v118, v54
v_mov_b32 v119, v55
s_branch Lpd_105
Lpf_137:
buffer_load_dwordx4 v[48:51], v11, s[4:7], s40 offen offset:0 sc1
s_sub_u32 s37, s37, 1
s_cbranch_scc1 Lend_1
s_branch Lps_112
Lpf_139:
buffer_load_dwordx4 v[56:59], v11, s[4:7], s40 offen offset:0 sc1
s_branch Lps_124
Lpf_141:
buffer_load_dwordx4 v[52:55], v11, s[4:7], s40 offen offset:1024 sc1
Lps_144:
s_waitcnt vmcnt(2)
v_max3_u32 v44, v56, v57, v58
v_max_u32 v44, v44, v59
v_cmp_eq_u32 vcc, -1, v44
s_cbranch_vccnz Lpf_145
v_smfmac_f32_16x16x64_bf16 v[72:75], v[56:59], v[96:103], v15
v_mov_b32 v112, v56
v_mov_b32 v113, v57
v_mov_b32 v114, v58
v_mov_b32 v115, v59
s_branch Lpd_105
Lpf_143:
buffer_load_dwordx4 v[52:55], v11, s[4:7], s40 offen offset:1024 sc1
s_branch Lps_120
Lpf_145:
buffer_load_dwordx4 v[56:59], v11, s[4:7], s40 offen offset:0 sc1
s_branch Lps_132
Lvr_31:
buffer_load_dwordx2 v[120:121], v12, s[4:7], s40 offen sc1
buffer_load_dwordx2 v[122:123], v13, s[4:7], s40 offen sc1
s_sub_u32 s37, s37, 1
s_cbranch_scc1 Lend_1
s_waitcnt vmcnt(0)
v_max3_u32 v44, v120, v121, v122
v_max_u32 v44, v44, v123
v_cmp_eq_u32 vcc, -1, v44
s_cbranch_vccnz Lvr_31
s_branch Lvo_32
Lq_sc1_20:
Lq_146:
s_cmp_gt_u32 s36, 3
s_cbranch_scc1 Lqf_147
s_waitcnt vmcnt(0)
s_barrier
Lqf_147:
ds_read_b128 v[128:131], v22 offset:0
ds_read_b128 v[132:135], v22 offset:1024
ds_read_b128 v[136:139], v22 offset:2048
ds_read_b128 v[140:143], v22 offset:3072
ds_read_b128 v[144:147], v22 offset:4096
ds_read_b128 v[148:151], v22 offset:5120
ds_read_b128 v[152:155], v22 offset:6144
ds_read_b128 v[156:159], v22 offset:7168
ds_read_b128 v[160:163], v24 offset:0
ds_read_b128 v[164:167], v24 offset:1024
ds_read_b128 v[168:171], v25 offset:0
ds_read_b128 v[172:175], v25 offset:1024
ds_read_b128 v[176:179], v23 offset:0
ds_read_b128 v[180:183], v23 offset:1024
ds_read_b128 v[184:187], v23 offset:2048
ds_read_b128 v[188:191], v23 offset:3072
v_xor_b32 v22, 98304, v22
v_xor_b32 v24, 98304, v24
v_xor_b32 v25, 98304, v25
v_xor_b32 v23, 98304, v23
s_and_b32 s38, s36, 3
s_lshl_b32 s39, s38, 16
s_add_u32 s40, s39, s45
s_xor_b32 s42, s40, 0x20000
s_add_u32 s26, s36, 1
v_pk_mul_f32 v[64:65], 0, 0
v_pk_mul_f32 v[66:67], 0, 0
v_pk_mul_f32 v[68:69], 0, 0
v_pk_mul_f32 v[70:71], 0, 0
v_pk_mul_f32 v[72:73], 0, 0
v_pk_mul_f32 v[74:75], 0, 0
v_pk_mul_f32 v[76:77], 0, 0
v_pk_mul_f32 v[78:79], 0, 0
v_pk_mul_f32 v[80:81], 0, 0
v_pk_mul_f32 v[82:83], 0, 0
v_pk_mul_f32 v[84:85], 0, 0
v_pk_mul_f32 v[86:87], 0, 0
v_pk_mul_f32 v[88:89], 0, 0
v_pk_mul_f32 v[90:91], 0, 0
v_pk_mul_f32 v[92:93], 0, 0
v_pk_mul_f32 v[94:95], 0, 0
v_mov_b32 v214, v197
s_waitcnt vmcnt(0)
buffer_store_dword v214, v199, s[4:7], 0 offen sc1
v_add_u32 v197, 1, v197
s_mov_b64 exec, 15
buffer_load_dword v216, v192, s[4:7], s59 offen sc1
s_nop 5
buffer_load_dword v217, v192, s[4:7], s59 offen sc1
s_nop 5
buffer_load_dword v218, v192, s[4:7], s59 offen sc1
Lft_149:
s_waitcnt vmcnt(2)
v_cmp_gt_u32 vcc, s26, v216
buffer_load_dword v216, v192, s[4:7], s59 offen sc1
s_cbranch_vccz Lfg_148
s_waitcnt vmcnt(2)
v_cmp_gt_u32 vcc, s26, v217
buffer_load_dword v217, v192, s[4:7], s59 offen sc1
s_cbranch_vccz Lfg_148
s_waitcnt vmcnt(2)
v_cmp_gt_u32 vcc, s26, v218
buffer_load_dword v218, v192, s[4:7], s59 offen sc1
s_cbranch_vccz Lfg_148
s_sub_u32 s37, s37, 1
s_cbranch_scc1 Lend_1
s_branch Lft_149
Lfg_148:
s_mov_b64 exec, -1
buffer_load_dwordx4 v[48:51], v10, s[4:7], s40 offen offset:0 sc1
v_mfma_f32_16x16x32_bf16 v[200:203], v[204:207], v[204:207], 0
v_mfma_f32_16x16x32_bf16 v[200:203], v[204:207], v[204:207], 0
v_mfma_f32_16x16x32_bf16 v[200:203], v[204:207], v[204:207], 0
buffer_load_dwordx4 v[52:55], v10, s[4:7], s40 offen offset:1024 sc1
v_mfma_f32_16x16x32_bf16 v[200:203], v[204:207], v[204:207], 0
v_mfma_f32_16x16x32_bf16 v[200:203], v[204:207], v[204:207], 0
v_mfma_f32_16x16x32_bf16 v[200:203], v[204:207], v[204:207], 0
buffer_load_dwordx4 v[56:59], v10, s[4:7], s40 offen offset:2048 sc1
v_mfma_f32_16x16x32_bf16 v[200:203], v[204:207], v[204:207], 0
v_mfma_f32_16x16x32_bf16 v[200:203], v[204:207], v[204:207], 0
v_mfma_f32_16x16x32_bf16 v[200:203], v[204:207], v[204:207], 0
buffer_load_dwordx4 v[60:63], v10, s[4:7], s40 offen offset:3072 sc1
v_mfma_f32_16x16x32_bf16 v[200:203], v[204:207], v[204:207], 0
v_mfma_f32_16x16x32_bf16 v[200:203], v[204:207], v[204:207], 0
v_mfma_f32_16x16x32_bf16 v[200:203], v[204:207], v[204:207], 0
s_waitcnt vmcnt(3)
v_max3_u32 v44, v48, v49, v50
v_max_u32 v44, v44, v51
v_cmp_eq_u32 vcc, -1, v44
s_cbranch_vccnz Lpf_151
v_smfmac_f32_16x16x64_bf16 v[64:67], v[48:51], a[0:7], v15
v_smfmac_f32_16x16x64_bf16 v[68:71], v[48:51], a[8:15], v15
v_smfmac_f32_16x16x64_bf16 v[72:75], v[48:51], a[16:23], v15
s_waitcnt vmcnt(2)
v_max3_u32 v44, v52, v53, v54
v_max_u32 v44, v44, v55
v_cmp_eq_u32 vcc, -1, v44
v_smfmac_f32_16x16x64_bf16 v[76:79], v[48:51], a[24:31], v15
v_smfmac_f32_16x16x64_bf16 v[80:83], v[48:51], a[32:39], v15
v_smfmac_f32_16x16x64_bf16 v[84:87], v[48:51], a[40:47], v15
s_cbranch_vccnz Lpf_152
v_smfmac_f32_16x16x64_bf16 v[64:67], v[52:55], a[64:71], v15
v_smfmac_f32_16x16x64_bf16 v[68:71], v[52:55], a[72:79], v15
v_smfmac_f32_16x16x64_bf16 v[72:75], v[52:55], a[80:87], v15
s_waitcnt vmcnt(0)
v_max3_u32 v44, v56, v57, v58
v_max3_u32 v44, v44, v59, v60
v_max3_u32 v44, v44, v61, v62
v_max_u32 v44, v44, v63
v_cmp_eq_u32 vcc, -1, v44
v_smfmac_f32_16x16x64_bf16 v[76:79], v[52:55], a[88:95], v15
v_smfmac_f32_16x16x64_bf16 v[80:83], v[52:55], a[96:103], v15
v_smfmac_f32_16x16x64_bf16 v[84:87], v[52:55], a[104:111], v15
s_cbranch_vccnz Lpj_153
v_smfmac_f32_16x16x64_bf16 v[64:67], v[56:59], a[128:135], v15
s_nop 1
v_smfmac_f32_16x16x64_bf16 v[64:67], v[60:63], a[192:199], v15
s_nop 1
v_smfmac_f32_16x16x64_bf16 v[68:71], v[56:59], a[136:143], v15
s_nop 1
v_smfmac_f32_16x16x64_bf16 v[68:71], v[60:63], a[200:207], v15
s_nop 1
v_smfmac_f32_16x16x64_bf16 v[72:75], v[56:59], a[144:151], v15
v_add_f32 v96, v64, v66
v_add_f32 v97, v65, v67
v_smfmac_f32_16x16x64_bf16 v[72:75], v[60:63], a[208:215], v15
s_nop 1
v_smfmac_f32_16x16x64_bf16 v[76:79], v[56:59], a[152:159], v15
v_add_f32 v98, v68, v70
v_add_f32 v99, v69, v71
v_smfmac_f32_16x16x64_bf16 v[76:79], v[60:63], a[216:223], v15
ds_write_b128 v211, v[96:99] offset:0
s_nop 0
v_smfmac_f32_16x16x64_bf16 v[80:83], v[56:59], a[160:167], v15
v_add_f32 v100, v72, v74
v_add_f32 v101, v73, v75
v_smfmac_f32_16x16x64_bf16 v[80:83], v[60:63], a[224:231], v15
s_nop 1
v_smfmac_f32_16x16x64_bf16 v[84:87], v[56:59], a[168:175], v15
v_add_f32 v102, v76, v78
v_add_f32 v103, v77, v79
v_smfmac_f32_16x16x64_bf16 v[84:87], v[60:63], a[232:239], v15
ds_write_b128 v212, v[100:103] offset:0
s_nop 0
v_smfmac_f32_16x16x64_bf16 v[88:91], v[48:51], a[48:55], v15
v_add_f32 v104, v80, v82
v_add_f32 v105, v81, v83
v_smfmac_f32_16x16x64_bf16 v[88:91], v[52:55], a[112:119], v15
s_nop 1
v_add_f32 v106, v84, v86
v_add_f32 v107, v85, v87
ds_write_b128 v213, v[104:107] offset:0
Lpd_150:
v_smfmac_f32_16x16x64_bf16 v[88:91], v[56:59], a[176:183], v15
v_smfmac_f32_16x16x64_bf16 v[88:91], v[60:63], a[240:247], v15
v_smfmac_f32_16x16x64_bf16 v[92:95], v[48:51], a[56:63], v15
v_smfmac_f32_16x16x64_bf16 v[92:95], v[52:55], a[120:127], v15
s_waitcnt lgkmcnt(0)
s_barrier
ds_read_b128 v[76:79], v18 offset:0
ds_read_b128 v[80:83], v18 offset:1024
ds_read_b128 v[84:87], v18 offset:2048
v_smfmac_f32_16x16x64_bf16 v[92:95], v[56:59], a[184:191], v15
v_smfmac_f32_16x16x64_bf16 v[92:95], v[60:63], a[248:255], v15
v_mov_b32 v72, 0
v_mov_b32 v73, 0
v_mov_b32 v74, 0
v_mov_b32 v75, 0
v_add_f32 v108, v88, v90
v_add_f32 v109, v89, v91
s_nop 1
v_add_f32 v110, v92, v94
v_add_f32 v111, v93, v95
s_waitcnt lgkmcnt(0)
v_pk_add_f32 v[76:77], v[76:77], v[108:109]
v_pk_add_f32 v[80:81], v[80:81], v[84:85]
v_pk_add_f32 v[78:79], v[78:79], v[110:111]
v_pk_add_f32 v[82:83], v[82:83], v[86:87]
v_pk_add_f32 v[76:77], v[76:77], v[80:81]
v_pk_add_f32 v[78:79], v[78:79], v[82:83]
v_cvt_pk_bf16_f32 v76, v76, v77
v_cvt_pk_bf16_f32 v77, v78, v79
ds_write2st64_b32 v19, v76, v77 offset0:48 offset1:49
buffer_load_dwordx4 v[112:115], v11, s[4:7], s40 offen offset:0 sc1
buffer_load_dwordx4 v[116:119], v11, s[4:7], s40 offen offset:1024 sc1
s_waitcnt lgkmcnt(0)
s_barrier
ds_read_b64_tr_b16 v[96:97], v20 offset:12288
ds_read_b64_tr_b16 v[98:99], v20 offset:12544
ds_read_b64_tr_b16 v[100:101], v20 offset:12800
ds_read_b64_tr_b16 v[102:103], v20 offset:13056
ds_read_b64_tr_b16 v[104:105], v20 offset:13312
ds_read_b64_tr_b16 v[106:107], v20 offset:13568
ds_read_b64_tr_b16 v[108:109], v20 offset:13824
ds_read_b64_tr_b16 v[110:111], v20 offset:14080
s_waitcnt lgkmcnt(6)
v_mfma_f32_16x16x32_bf16 v[64:67], v[128:131], v[96:99], 0
v_mfma_f32_16x16x32_bf16 v[68:71], v[144:147], v[96:99], 0
s_waitcnt lgkmcnt(4)
buffer_load_dwordx4 v[48:51], v11, s[4:7], s40 offen offset:0 sc1
v_mfma_f32_16x16x32_bf16 v[64:67], v[132:135], v[100:103], v[64:67]
v_mfma_f32_16x16x32_bf16 v[68:71], v[148:151], v[100:103], v[68:71]
s_waitcnt lgkmcnt(2)
buffer_load_dwordx4 v[52:55], v11, s[4:7], s40 offen offset:1024 sc1
v_mfma_f32_16x16x32_bf16 v[64:67], v[136:139], v[104:107], v[64:67]
v_mfma_f32_16x16x32_bf16 v[68:71], v[152:155], v[104:107], v[68:71]
s_waitcnt lgkmcnt(0)
s_waitcnt vmcnt(2)
v_max3_u32 v44, v112, v113, v114
v_max3_u32 v44, v44, v115, v116
v_max3_u32 v44, v44, v117, v118
v_max_u32 v44, v44, v119
v_cmp_eq_u32 vcc, -1, v44
v_mfma_f32_16x16x32_bf16 v[64:67], v[140:143], v[108:111], v[64:67]
v_mfma_f32_16x16x32_bf16 v[68:71], v[156:159], v[108:111], v[68:71]
s_cbranch_vccnz Lkr_154
v_smfmac_f32_16x16x64_bf16 v[72:75], v[112:115], v[96:103], v15
v_smfmac_f32_16x16x64_bf16 v[72:75], v[116:119], v[104:111], v15
Lko_155:
s_nop 3
v_max3_f32 v45, v64, v65, v66
v_max3_f32 v45, v45, v67, v68
v_max3_f32 v45, v45, v69, v70
v_max_f32 v45, v45, v71
v_pk_add_f32 v[72:73], v[72:73], v[74:75]
v_max3_f32 v46, v45, v72, v73
v_max3_f32 v47, v45, v72, v73
buffer_load_dwordx2 v[120:121], v12, s[4:7], s40 offen sc1
buffer_load_dwordx2 v[122:123], v13, s[4:7], s40 offen sc1
v_permlane32_swap_b32 v46, v47
v_max_f32 v45, v46, v47
v_max_f32 v46, v46, v47
s_nop 1
v_permlane16_swap_b32 v45, v46
v_max_f32 v45, v45, v46
v_mul_f32 v46, s49, v45
v_pk_fma_f32 v[64:65], v[64:65], s[48:49], v[46:47] op_sel_hi:[1,0,0]
v_pk_fma_f32 v[66:67], v[66:67], s[48:49], v[46:47] op_sel_hi:[1,0,0]
v_pk_fma_f32 v[68:69], v[68:69], s[48:49], v[46:47] op_sel_hi:[1,0,0]
v_pk_fma_f32 v[70:71], v[70:71], s[48:49], v[46:47] op_sel_hi:[1,0,0]
v_pk_fma_f32 v[72:73], v[72:73], s[48:49], v[46:47] op_sel_hi:[1,0,0]
v_exp_f32 v64, v64
v_exp_f32 v65, v65
v_exp_f32 v66, v66
v_exp_f32 v67, v67
v_exp_f32 v68, v68
v_exp_f32 v69, v69
v_exp_f32 v70, v70
v_exp_f32 v71, v71
v_exp_f32 v72, v72
v_exp_f32 v73, v73
buffer_store_dword v197, v193, s[4:7], s59 offen sc1
v_cvt_pk_bf16_f32 v76, v64, v65
v_cvt_pk_bf16_f32 v77, v66, v67
v_cvt_pk_bf16_f32 v78, v68, v69
v_cvt_pk_bf16_f32 v79, v70, v71
v_cvt_pk_bf16_f32 v2, v72, v73
v_cvt_pk_bf16_f32 v7, v72, v73
v_mfma_f32_16x16x32_bf16 v[84:87], v[32:35], v[76:79], 0
v_mfma_f32_16x16x32_bf16 v[84:87], v[32:35], v[2:5], v[84:87]
v_mfma_f32_16x16x32_bf16 v[96:99], v[160:163], v[76:79], 0
s_waitcnt vmcnt(1)
v_max3_u32 v44, v120, v121, v122
v_max_u32 v44, v44, v123
v_cmp_eq_u32 vcc, -1, v44
v_mfma_f32_16x16x32_bf16 v[100:103], v[164:167], v[76:79], 0
s_cbranch_vccnz Lvr_156
Lvo_157:
v_mfma_f32_16x16x32_bf16 v[96:99], v[120:123], v[2:5], v[96:99]
v_mfma_f32_16x16x32_bf16 v[100:103], v[120:123], v[6:9], v[100:103]
v_rcp_f32 v46, v84
s_nop 5
v_pk_mul_f32 v[96:97], v[96:97], v[46:47] op_sel_hi:[1,0]
v_pk_mul_f32 v[98:99], v[98:99], v[46:47] op_sel_hi:[1,0]
v_pk_mul_f32 v[100:101], v[100:101], v[46:47] op_sel_hi:[1,0]
v_pk_mul_f32 v[102:103], v[102:103], v[46:47] op_sel_hi:[1,0]
v_cvt_pk_bf16_f32 v124, v96, v97
v_cvt_pk_bf16_f32 v125, v98, v99
v_cvt_pk_bf16_f32 v126, v100, v101
v_cvt_pk_bf16_f32 v127, v102, v103
buffer_store_dwordx4 v[124:127], v14, s[4:7], s40 offen sc1
s_barrier
buffer_store_dwordx4 v[28:31], v14, s[4:7], s42 offen sc1
s_cmp_eq_u32 s36, 2
s_cbranch_scc1 Lp2_160
Lp1_161:
s_add_u32 s27, s27, 1
s_min_u32 s27, s27, 64
v_add_u32 v44, v209, v210
v_cmp_gt_u32 vcc, s27, v44
v_mov_b32 v72, 0
v_mov_b32 v73, 0
v_mov_b32 v74, 0
v_mov_b32 v75, 0
s_add_u32 s38, s36, 2
s_and_b32 s38, s38, 3
s_lshl_b32 s88, s38, 18
s_add_u32 s88, s88, s46
s_add_u32 s89, s88, 0x100000
s_cmp_lt_u32 s36, 62
s_cselect_b32 s53, s47, 0x70000000
s_cbranch_vccnz Lpw_158
Lpk_159:
buffer_store_dwordx2 v[28:29], v198, s[4:7], s88 offen sc1
buffer_store_dwordx2 v[28:29], v198, s[4:7], s89 offen sc1
v_mfma_f32_16x16x32_bf16 v[64:67], v[128:131], v[176:179], v[36:39]
v_mfma_f32_16x16x32_bf16 v[68:71], v[144:147], v[176:179], v[40:43]
s_mov_b32 m0, s57
s_add_u32 s52, s53, 3072
buffer_load_dwordx4 v21, s[4:7], s53 offen offset:0 sc1 lds
v_mfma_f32_16x16x32_bf16 v[64:67], v[132:135], v[180:183], v[64:67]
v_mfma_f32_16x16x32_bf16 v[68:71], v[148:151], v[180:183], v[68:71]
v_mfma_f32_16x16x32_bf16 v[64:67], v[136:139], v[184:187], v[64:67]
v_mfma_f32_16x16x32_bf16 v[68:71], v[152:155], v[184:187], v[68:71]
buffer_load_dwordx4 v21, s[4:7], s53 offen offset:1024 sc1 lds
v_mfma_f32_16x16x32_bf16 v[64:67], v[140:143], v[188:191], v[64:67]
v_mfma_f32_16x16x32_bf16 v[68:71], v[156:159], v[188:191], v[68:71]
v_smfmac_f32_16x16x64_bf16 v[72:75], v[112:115], v[176:183], v15
v_smfmac_f32_16x16x64_bf16 v[72:75], v[116:119], v[184:191], v15
s_and_b32 s38, s36, 7
s_lshl_b32 s38, s38, 18
s_add_u32 s50, s38, 83886080
buffer_load_dwordx4 v21, s[4:7], s53 offen offset:2048 sc1 lds
s_nop 1
v_max3_f32 v45, v64, v65, v66
v_max3_f32 v45, v45, v67, v68
v_max3_f32 v45, v45, v69, v70
v_max_f32 v45, v45, v71
v_pk_add_f32 v[72:73], v[72:73], v[74:75]
v_max3_f32 v46, v45, v72, v73
v_max3_f32 v47, v45, v72, v73
s_nop 1
v_permlane32_swap_b32 v46, v47
v_max_f32 v45, v46, v47
v_max_f32 v46, v46, v47
s_nop 1
v_permlane16_swap_b32 v45, v46
v_max_f32 v45, v45, v46
v_mul_f32 v46, s49, v45
s_add_u32 m0, s57, 3072
s_xor_b32 s57, s57, 98304
buffer_load_dwordx4 v21, s[4:7], s52 offen offset:0 sc1 lds
v_pk_fma_f32 v[64:65], v[64:65], s[48:49], v[46:47] op_sel_hi:[1,0,0]
v_pk_fma_f32 v[66:67], v[66:67], s[48:49], v[46:47] op_sel_hi:[1,0,0]
v_pk_fma_f32 v[68:69], v[68:69], s[48:49], v[46:47] op_sel_hi:[1,0,0]
v_pk_fma_f32 v[70:71], v[70:71], s[48:49], v[46:47] op_sel_hi:[1,0,0]
v_pk_fma_f32 v[72:73], v[72:73], s[48:49], v[46:47] op_sel_hi:[1,0,0]
v_exp_f32 v64, v64
v_exp_f32 v65, v65
v_exp_f32 v66, v66
v_exp_f32 v67, v67
v_exp_f32 v68, v68
buffer_load_dwordx4 v21, s[4:7], s52 offen offset:1024 sc1 lds
v_exp_f32 v69, v69
v_exp_f32 v70, v70
v_exp_f32 v71, v71
v_exp_f32 v72, v72
v_exp_f32 v73, v73
buffer_load_dwordx4 v21, s[4:7], s52 offen offset:2048 sc1 lds
s_add_u32 s47, s47, 786432
buffer_load_dword v209, v208, s[4:7], 0 offen sc1
v_cvt_pk_bf16_f32 v76, v64, v65
v_cvt_pk_bf16_f32 v77, v66, v67
v_cvt_pk_bf16_f32 v78, v68, v69
v_cvt_pk_bf16_f32 v79, v70, v71
v_cvt_pk_bf16_f32 v2, v72, v73
v_cvt_pk_bf16_f32 v7, v72, v73
v_mfma_f32_16x16x32_bf16 v[84:87], v[32:35], v[76:79], 0
v_mfma_f32_16x16x32_bf16 v[84:87], v[32:35], v[2:5], v[84:87]
v_mfma_f32_16x16x32_bf16 v[96:99], v[160:163], v[76:79], 0
v_mfma_f32_16x16x32_bf16 v[100:103], v[164:167], v[76:79], 0
v_mfma_f32_16x16x32_bf16 v[104:107], v[168:171], v[76:79], 0
v_mfma_f32_16x16x32_bf16 v[108:111], v[172:175], v[76:79], 0
v_mfma_f32_16x16x32_bf16 v[96:99], v[120:123], v[2:5], v[96:99]
v_mfma_f32_16x16x32_bf16 v[100:103], v[120:123], v[6:9], v[100:103]
v_mfma_f32_16x16x32_bf16 v[104:107], v[120:123], v[0:3], v[104:107]
v_mfma_f32_16x16x32_bf16 v[108:111], v[120:123], v[4:7], v[108:111]
v_rcp_f32 v46, v84
s_nop 3
v_pk_mul_f32 v[96:97], v[96:97], v[46:47] op_sel_hi:[1,0]
v_pk_mul_f32 v[98:99], v[98:99], v[46:47] op_sel_hi:[1,0]
v_pk_mul_f32 v[100:101], v[100:101], v[46:47] op_sel_hi:[1,0]
v_pk_mul_f32 v[102:103], v[102:103], v[46:47] op_sel_hi:[1,0]
v_pk_mul_f32 v[104:105], v[104:105], v[46:47] op_sel_hi:[1,0]
v_pk_mul_f32 v[106:107], v[106:107], v[46:47] op_sel_hi:[1,0]
v_pk_mul_f32 v[108:109], v[108:109], v[46:47] op_sel_hi:[1,0]
v_pk_mul_f32 v[110:111], v[110:111], v[46:47] op_sel_hi:[1,0]
v_cvt_pk_bf16_f32 v96, v96, v97
v_cvt_pk_bf16_f32 v97, v98, v99
v_cvt_pk_bf16_f32 v98, v100, v101
v_cvt_pk_bf16_f32 v99, v102, v103
v_cvt_pk_bf16_f32 v100, v104, v105
v_cvt_pk_bf16_f32 v101, v106, v107
v_cvt_pk_bf16_f32 v102, v108, v109
v_cvt_pk_bf16_f32 v103, v110, v111
buffer_store_dwordx4 v[96:99], v26, s[4:7], s50 offen sc1
buffer_store_dwordx4 v[100:103], v27, s[4:7], s50 offen sc1
s_add_u32 s36, s36, 1
s_cmp_lt_u32 s36, 64
s_cbranch_scc1 Lq_146
s_waitcnt vmcnt(0)
buffer_store_dword v197, v199, s[4:7], 0 offen sc1
s_branch Lend_1
Lp2_160:
s_add_u32 s27, s27, 1
Lbw_162:
buffer_load_dword v209, v208, s[4:7], 0 offen sc1
s_waitcnt vmcnt(0)
v_add_u32 v44, v209, v210
v_cmp_gt_u32 vcc, s27, v44
s_cbranch_vccz Lbo_163
s_sub_u32 s37, s37, 1
s_cbranch_scc1 Lend_1
s_sleep 2
s_branch Lbw_162
Lbo_163:
s_mov_b32 m0, s57
s_add_u32 s52, s47, 3072
buffer_load_dwordx4 v21, s[4:7], s47 offen offset:0 sc1 lds
buffer_load_dwordx4 v21, s[4:7], s47 offen offset:1024 sc1 lds
buffer_load_dwordx4 v21, s[4:7], s47 offen offset:2048 sc1 lds
s_add_u32 m0, s57, 3072
s_xor_b32 s57, s57, 98304
buffer_load_dwordx4 v21, s[4:7], s52 offen offset:0 sc1 lds
buffer_load_dwordx4 v21, s[4:7], s52 offen offset:1024 sc1 lds
buffer_load_dwordx4 v21, s[4:7], s52 offen offset:2048 sc1 lds
s_add_u32 s47, s47, 786432
s_branch Lp1_161
Lpw_158:
Lbw_164:
buffer_load_dword v209, v208, s[4:7], 0 offen sc1
s_waitcnt vmcnt(0)
v_add_u32 v44, v209, v210
v_cmp_gt_u32 vcc, s27, v44
s_cbranch_vccz Lbo_165
s_sub_u32 s37, s37, 1
s_cbranch_scc1 Lend_1
s_sleep 2
s_branch Lbw_164
Lbo_165:
s_branch Lpk_159
Lpj_153:
buffer_load_dwordx4 v[56:59], v10, s[4:7], s40 offen offset:2048 sc1
buffer_load_dwordx4 v[60:63], v10, s[4:7], s40 offen offset:3072 sc1
s_sub_u32 s37, s37, 1
s_cbranch_scc1 Lend_1
s_branch Lps_166
Lpf_151:
buffer_load_dwordx4 v[48:51], v10, s[4:7], s40 offen offset:0 sc1
s_sub_u32 s37, s37, 1
s_cbranch_scc1 Lend_1
Lps_167:
s_waitcnt vmcnt(3)
v_max3_u32 v44, v52, v53, v54
v_max_u32 v44, v44, v55
v_cmp_eq_u32 vcc, -1, v44
s_cbranch_vccnz Lpf_168
v_smfmac_f32_16x16x64_bf16 v[64:67], v[52:55], a[64:71], v15
v_smfmac_f32_16x16x64_bf16 v[68:71], v[52:55], a[72:79], v15
v_smfmac_f32_16x16x64_bf16 v[72:75], v[52:55], a[80:87], v15
v_smfmac_f32_16x16x64_bf16 v[76:79], v[52:55], a[88:95], v15
v_smfmac_f32_16x16x64_bf16 v[80:83], v[52:55], a[96:103], v15
v_smfmac_f32_16x16x64_bf16 v[84:87], v[52:55], a[104:111], v15
Lps_169:
s_waitcnt vmcnt(2)
v_max3_u32 v44, v56, v57, v58
v_max_u32 v44, v44, v59
v_cmp_eq_u32 vcc, -1, v44
s_cbranch_vccnz Lpf_170
v_smfmac_f32_16x16x64_bf16 v[64:67], v[56:59], a[128:135], v15
v_smfmac_f32_16x16x64_bf16 v[68:71], v[56:59], a[136:143], v15
v_smfmac_f32_16x16x64_bf16 v[72:75], v[56:59], a[144:151], v15
v_smfmac_f32_16x16x64_bf16 v[76:79], v[56:59], a[152:159], v15
v_smfmac_f32_16x16x64_bf16 v[80:83], v[56:59], a[160:167], v15
v_smfmac_f32_16x16x64_bf16 v[84:87], v[56:59], a[168:175], v15
Lps_171:
s_waitcnt vmcnt(1)
v_max3_u32 v44, v60, v61, v62
v_max_u32 v44, v44, v63
v_cmp_eq_u32 vcc, -1, v44
s_cbranch_vccnz Lpf_172
v_smfmac_f32_16x16x64_bf16 v[64:67], v[60:63], a[192:199], v15
v_smfmac_f32_16x16x64_bf16 v[68:71], v[60:63], a[200:207], v15
v_smfmac_f32_16x16x64_bf16 v[72:75], v[60:63], a[208:215], v15
v_smfmac_f32_16x16x64_bf16 v[76:79], v[60:63], a[216:223], v15
v_smfmac_f32_16x16x64_bf16 v[80:83], v[60:63], a[224:231], v15
v_smfmac_f32_16x16x64_bf16 v[84:87], v[60:63], a[232:239], v15
Lps_173:
s_waitcnt vmcnt(0)
v_max3_u32 v44, v48, v49, v50
v_max_u32 v44, v44, v51
v_cmp_eq_u32 vcc, -1, v44
s_cbranch_vccnz Lpf_174
v_smfmac_f32_16x16x64_bf16 v[64:67], v[48:51], a[0:7], v15
s_nop 1
v_smfmac_f32_16x16x64_bf16 v[68:71], v[48:51], a[8:15], v15
s_nop 1
v_smfmac_f32_16x16x64_bf16 v[72:75], v[48:51], a[16:23], v15
s_nop 1
v_smfmac_f32_16x16x64_bf16 v[76:79], v[48:51], a[24:31], v15
v_add_f32 v96, v64, v66
v_add_f32 v97, v65, v67
v_smfmac_f32_16x16x64_bf16 v[80:83], v[48:51], a[32:39], v15
v_add_f32 v98, v68, v70
v_add_f32 v99, v69, v71
v_smfmac_f32_16x16x64_bf16 v[84:87], v[48:51], a[40:47], v15
v_add_f32 v100, v72, v74
v_add_f32 v101, v73, v75
ds_write_b128 v211, v[96:99] offset:0
v_smfmac_f32_16x16x64_bf16 v[88:91], v[48:51], a[48:55], v15
v_add_f32 v102, v76, v78
v_add_f32 v103, v77, v79
v_add_f32 v104, v80, v82
v_add_f32 v105, v81, v83
ds_write_b128 v212, v[100:103] offset:0
v_smfmac_f32_16x16x64_bf16 v[88:91], v[52:55], a[112:119], v15
v_add_f32 v106, v84, v86
v_add_f32 v107, v85, v87
ds_write_b128 v213, v[104:107] offset:0
s_branch Lpd_150
Lpf_152:
buffer_load_dwordx4 v[52:55], v10, s[4:7], s40 offen offset:1024 sc1
s_sub_u32 s37, s37, 1
s_cbranch_scc1 Lend_1
Lps_175:
s_waitcnt vmcnt(2)
v_max3_u32 v44, v56, v57, v58
v_max_u32 v44, v44, v59
v_cmp_eq_u32 vcc, -1, v44
s_cbranch_vccnz Lpf_176
v_smfmac_f32_16x16x64_bf16 v[64:67], v[56:59], a[128:135], v15
v_smfmac_f32_16x16x64_bf16 v[68:71], v[56:59], a[136:143], v15
v_smfmac_f32_16x16x64_bf16 v[72:75], v[56:59], a[144:151], v15
v_smfmac_f32_16x16x64_bf16 v[76:79], v[56:59], a[152:159], v15
v_smfmac_f32_16x16x64_bf16 v[80:83], v[56:59], a[160:167], v15
v_smfmac_f32_16x16x64_bf16 v[84:87], v[56:59], a[168:175], v15
Lps_177:
s_waitcnt vmcnt(1)
v_max3_u32 v44, v60, v61, v62
v_max_u32 v44, v44, v63
v_cmp_eq_u32 vcc, -1, v44
s_cbranch_vccnz Lpf_178
v_smfmac_f32_16x16x64_bf16 v[64:67], v[60:63], a[192:199], v15
v_smfmac_f32_16x16x64_bf16 v[68:71], v[60:63], a[200:207], v15
v_smfmac_f32_16x16x64_bf16 v[72:75], v[60:63], a[208:215], v15
v_smfmac_f32_16x16x64_bf16 v[76:79], v[60:63], a[216:223], v15
v_smfmac_f32_16x16x64_bf16 v[80:83], v[60:63], a[224:231], v15
v_smfmac_f32_16x16x64_bf16 v[84:87], v[60:63], a[232:239], v15
Lps_179:
s_waitcnt vmcnt(0)
v_max3_u32 v44, v52, v53, v54
v_max_u32 v44, v44, v55
v_cmp_eq_u32 vcc, -1, v44
s_cbranch_vccnz Lpf_180
v_smfmac_f32_16x16x64_bf16 v[64:67], v[52:55], a[64:71], v15
s_nop 1
v_smfmac_f32_16x16x64_bf16 v[68:71], v[52:55], a[72:79], v15
s_nop 1
v_smfmac_f32_16x16x64_bf16 v[72:75], v[52:55], a[80:87], v15
s_nop 1
v_smfmac_f32_16x16x64_bf16 v[76:79], v[52:55], a[88:95], v15
v_add_f32 v96, v64, v66
v_add_f32 v97, v65, v67
v_smfmac_f32_16x16x64_bf16 v[80:83], v[52:55], a[96:103], v15
v_add_f32 v98, v68, v70
v_add_f32 v99, v69, v71
v_smfmac_f32_16x16x64_bf16 v[84:87], v[52:55], a[104:111], v15
v_add_f32 v100, v72, v74
v_add_f32 v101, v73, v75
ds_write_b128 v211, v[96:99] offset:0
v_smfmac_f32_16x16x64_bf16 v[88:91], v[48:51], a[48:55], v15
v_add_f32 v102, v76, v78
v_add_f32 v103, v77, v79
v_add_f32 v104, v80, v82
v_add_f32 v105, v81, v83
ds_write_b128 v212, v[100:103] offset:0
v_smfmac_f32_16x16x64_bf16 v[88:91], v[52:55], a[112:119], v15
v_add_f32 v106, v84, v86
v_add_f32 v107, v85, v87
ds_write_b128 v213, v[104:107] offset:0
s_branch Lpd_150
Lpf_168:
buffer_load_dwordx4 v[52:55], v10, s[4:7], s40 offen offset:1024 sc1
Lps_181:
s_waitcnt vmcnt(3)
v_max3_u32 v44, v56, v57, v58
v_max_u32 v44, v44, v59
v_cmp_eq_u32 vcc, -1, v44
s_cbranch_vccnz Lpf_182
v_smfmac_f32_16x16x64_bf16 v[64:67], v[56:59], a[128:135], v15
v_smfmac_f32_16x16x64_bf16 v[68:71], v[56:59], a[136:143], v15
v_smfmac_f32_16x16x64_bf16 v[72:75], v[56:59], a[144:151], v15
v_smfmac_f32_16x16x64_bf16 v[76:79], v[56:59], a[152:159], v15
v_smfmac_f32_16x16x64_bf16 v[80:83], v[56:59], a[160:167], v15
v_smfmac_f32_16x16x64_bf16 v[84:87], v[56:59], a[168:175], v15
Lps_183:
s_waitcnt vmcnt(2)
v_max3_u32 v44, v60, v61, v62
v_max_u32 v44, v44, v63
v_cmp_eq_u32 vcc, -1, v44
s_cbranch_vccnz Lpf_184
v_smfmac_f32_16x16x64_bf16 v[64:67], v[60:63], a[192:199], v15
v_smfmac_f32_16x16x64_bf16 v[68:71], v[60:63], a[200:207], v15
v_smfmac_f32_16x16x64_bf16 v[72:75], v[60:63], a[208:215], v15
v_smfmac_f32_16x16x64_bf16 v[76:79], v[60:63], a[216:223], v15
v_smfmac_f32_16x16x64_bf16 v[80:83], v[60:63], a[224:231], v15
v_smfmac_f32_16x16x64_bf16 v[84:87], v[60:63], a[232:239], v15
Lps_185:
s_waitcnt vmcnt(1)
v_max3_u32 v44, v48, v49, v50
v_max_u32 v44, v44, v51
v_cmp_eq_u32 vcc, -1, v44
s_cbranch_vccnz Lpf_186
v_smfmac_f32_16x16x64_bf16 v[64:67], v[48:51], a[0:7], v15
v_smfmac_f32_16x16x64_bf16 v[68:71], v[48:51], a[8:15], v15
v_smfmac_f32_16x16x64_bf16 v[72:75], v[48:51], a[16:23], v15
v_smfmac_f32_16x16x64_bf16 v[76:79], v[48:51], a[24:31], v15
v_smfmac_f32_16x16x64_bf16 v[80:83], v[48:51], a[32:39], v15
v_smfmac_f32_16x16x64_bf16 v[84:87], v[48:51], a[40:47], v15
s_branch Lps_179
Lpf_170:
buffer_load_dwordx4 v[56:59], v10, s[4:7], s40 offen offset:2048 sc1
Lps_187:
s_waitcnt vmcnt(2)
v_max3_u32 v44, v60, v61, v62
v_max_u32 v44, v44, v63
v_cmp_eq_u32 vcc, -1, v44
s_cbranch_vccnz Lpf_188
v_smfmac_f32_16x16x64_bf16 v[64:67], v[60:63], a[192:199], v15
v_smfmac_f32_16x16x64_bf16 v[68:71], v[60:63], a[200:207], v15
v_smfmac_f32_16x16x64_bf16 v[72:75], v[60:63], a[208:215], v15
v_smfmac_f32_16x16x64_bf16 v[76:79], v[60:63], a[216:223], v15
v_smfmac_f32_16x16x64_bf16 v[80:83], v[60:63], a[224:231], v15
v_smfmac_f32_16x16x64_bf16 v[84:87], v[60:63], a[232:239], v15
Lps_189:
s_waitcnt vmcnt(1)
v_max3_u32 v44, v48, v49, v50
v_max_u32 v44, v44, v51
v_cmp_eq_u32 vcc, -1, v44
s_cbranch_vccnz Lpf_190
v_smfmac_f32_16x16x64_bf16 v[64:67], v[48:51], a[0:7], v15
v_smfmac_f32_16x16x64_bf16 v[68:71], v[48:51], a[8:15], v15
v_smfmac_f32_16x16x64_bf16 v[72:75], v[48:51], a[16:23], v15
v_smfmac_f32_16x16x64_bf16 v[76:79], v[48:51], a[24:31], v15
v_smfmac_f32_16x16x64_bf16 v[80:83], v[48:51], a[32:39], v15
v_smfmac_f32_16x16x64_bf16 v[84:87], v[48:51], a[40:47], v15
Lps_191:
s_waitcnt vmcnt(0)
v_max3_u32 v44, v56, v57, v58
v_max_u32 v44, v44, v59
v_cmp_eq_u32 vcc, -1, v44
s_cbranch_vccnz Lpf_192
v_smfmac_f32_16x16x64_bf16 v[64:67], v[56:59], a[128:135], v15
s_nop 1
v_smfmac_f32_16x16x64_bf16 v[68:71], v[56:59], a[136:143], v15
s_nop 1
v_smfmac_f32_16x16x64_bf16 v[72:75], v[56:59], a[144:151], v15
s_nop 1
v_smfmac_f32_16x16x64_bf16 v[76:79], v[56:59], a[152:159], v15
v_add_f32 v96, v64, v66
v_add_f32 v97, v65, v67
v_smfmac_f32_16x16x64_bf16 v[80:83], v[56:59], a[160:167], v15
v_add_f32 v98, v68, v70
v_add_f32 v99, v69, v71
v_smfmac_f32_16x16x64_bf16 v[84:87], v[56:59], a[168:175], v15
v_add_f32 v100, v72, v74
v_add_f32 v101, v73, v75
ds_write_b128 v211, v[96:99] offset:0
v_smfmac_f32_16x16x64_bf16 v[88:91], v[48:51], a[48:55], v15
v_add_f32 v102, v76, v78
v_add_f32 v103, v77, v79
v_add_f32 v104, v80, v82
v_add_f32 v105, v81, v83
ds_write_b128 v212, v[100:103] offset:0
v_smfmac_f32_16x16x64_bf16 v[88:91], v[52:55], a[112:119], v15
v_add_f32 v106, v84, v86
v_add_f32 v107, v85, v87
ds_write_b128 v213, v[104:107] offset:0
s_branch Lpd_150
Lpf_172:
buffer_load_dwordx4 v[60:63], v10, s[4:7], s40 offen offset:3072 sc1
Lps_193:
s_waitcnt vmcnt(1)
v_max3_u32 v44, v48, v49, v50
v_max_u32 v44, v44, v51
v_cmp_eq_u32 vcc, -1, v44
s_cbranch_vccnz Lpf_194
v_smfmac_f32_16x16x64_bf16 v[64:67], v[48:51], a[0:7], v15
v_smfmac_f32_16x16x64_bf16 v[68:71], v[48:51], a[8:15], v15
v_smfmac_f32_16x16x64_bf16 v[72:75], v[48:51], a[16:23], v15
v_smfmac_f32_16x16x64_bf16 v[76:79], v[48:51], a[24:31], v15
v_smfmac_f32_16x16x64_bf16 v[80:83], v[48:51], a[32:39], v15
v_smfmac_f32_16x16x64_bf16 v[84:87], v[48:51], a[40:47], v15
Lps_195:
s_waitcnt vmcnt(0)
v_max3_u32 v44, v60, v61, v62
v_max_u32 v44, v44, v63
v_cmp_eq_u32 vcc, -1, v44
s_cbranch_vccnz Lpf_196
v_smfmac_f32_16x16x64_bf16 v[64:67], v[60:63], a[192:199], v15
s_nop 1
v_smfmac_f32_16x16x64_bf16 v[68:71], v[60:63], a[200:207], v15
s_nop 1
v_smfmac_f32_16x16x64_bf16 v[72:75], v[60:63], a[208:215], v15
s_nop 1
v_smfmac_f32_16x16x64_bf16 v[76:79], v[60:63], a[216:223], v15
v_add_f32 v96, v64, v66
v_add_f32 v97, v65, v67
v_smfmac_f32_16x16x64_bf16 v[80:83], v[60:63], a[224:231], v15
v_add_f32 v98, v68, v70
v_add_f32 v99, v69, v71
v_smfmac_f32_16x16x64_bf16 v[84:87], v[60:63], a[232:239], v15
v_add_f32 v100, v72, v74
v_add_f32 v101, v73, v75
ds_write_b128 v211, v[96:99] offset:0
v_smfmac_f32_16x16x64_bf16 v[88:91], v[48:51], a[48:55], v15
v_add_f32 v102, v76, v78
v_add_f32 v103, v77, v79
v_add_f32 v104, v80, v82
v_add_f32 v105, v81, v83
ds_write_b128 v212, v[100:103] offset:0
v_smfmac_f32_16x16x64_bf16 v[88:91], v[52:55], a[112:119], v15
v_add_f32 v106, v84, v86
v_add_f32 v107, v85, v87
ds_write_b128 v213, v[104:107] offset:0
s_branch Lpd_150
Lpf_174:
buffer_load_dwordx4 v[48:51], v10, s[4:7], s40 offen offset:0 sc1
s_sub_u32 s37, s37, 1
s_cbranch_scc1 Lend_1
s_branch Lps_173
Lpf_176:
buffer_load_dwordx4 v[56:59], v10, s[4:7], s40 offen offset:2048 sc1
Lps_197:
s_waitcnt vmcnt(2)
v_max3_u32 v44, v60, v61, v62
v_max_u32 v44, v44, v63
v_cmp_eq_u32 vcc, -1, v44
s_cbranch_vccnz Lpf_198
v_smfmac_f32_16x16x64_bf16 v[64:67], v[60:63], a[192:199], v15
v_smfmac_f32_16x16x64_bf16 v[68:71], v[60:63], a[200:207], v15
v_smfmac_f32_16x16x64_bf16 v[72:75], v[60:63], a[208:215], v15
v_smfmac_f32_16x16x64_bf16 v[76:79], v[60:63], a[216:223], v15
v_smfmac_f32_16x16x64_bf16 v[80:83], v[60:63], a[224:231], v15
v_smfmac_f32_16x16x64_bf16 v[84:87], v[60:63], a[232:239], v15
Lps_199:
s_waitcnt vmcnt(1)
v_max3_u32 v44, v52, v53, v54
v_max_u32 v44, v44, v55
v_cmp_eq_u32 vcc, -1, v44
s_cbranch_vccnz Lpf_200
v_smfmac_f32_16x16x64_bf16 v[64:67], v[52:55], a[64:71], v15
v_smfmac_f32_16x16x64_bf16 v[68:71], v[52:55], a[72:79], v15
v_smfmac_f32_16x16x64_bf16 v[72:75], v[52:55], a[80:87], v15
v_smfmac_f32_16x16x64_bf16 v[76:79], v[52:55], a[88:95], v15
v_smfmac_f32_16x16x64_bf16 v[80:83], v[52:55], a[96:103], v15
v_smfmac_f32_16x16x64_bf16 v[84:87], v[52:55], a[104:111], v15
s_branch Lps_191
Lpf_178:
buffer_load_dwordx4 v[60:63], v10, s[4:7], s40 offen offset:3072 sc1
Lps_201:
s_waitcnt vmcnt(1)
v_max3_u32 v44, v52, v53, v54
v_max_u32 v44, v44, v55
v_cmp_eq_u32 vcc, -1, v44
s_cbranch_vccnz Lpf_202
v_smfmac_f32_16x16x64_bf16 v[64:67], v[52:55], a[64:71], v15
v_smfmac_f32_16x16x64_bf16 v[68:71], v[52:55], a[72:79], v15
v_smfmac_f32_16x16x64_bf16 v[72:75], v[52:55], a[80:87], v15
v_smfmac_f32_16x16x64_bf16 v[76:79], v[52:55], a[88:95], v15
v_smfmac_f32_16x16x64_bf16 v[80:83], v[52:55], a[96:103], v15
v_smfmac_f32_16x16x64_bf16 v[84:87], v[52:55], a[104:111], v15
s_branch Lps_195
Lpf_180:
buffer_load_dwordx4 v[52:55], v10, s[4:7], s40 offen offset:1024 sc1
s_sub_u32 s37, s37, 1
s_cbranch_scc1 Lend_1
s_branch Lps_179
Lpf_182:
buffer_load_dwordx4 v[56:59], v10, s[4:7], s40 offen offset:2048 sc1
Lps_203:
s_waitcnt vmcnt(3)
v_max3_u32 v44, v60, v61, v62
v_max_u32 v44, v44, v63
v_cmp_eq_u32 vcc, -1, v44
s_cbranch_vccnz Lpf_204
v_smfmac_f32_16x16x64_bf16 v[64:67], v[60:63], a[192:199], v15
v_smfmac_f32_16x16x64_bf16 v[68:71], v[60:63], a[200:207], v15
v_smfmac_f32_16x16x64_bf16 v[72:75], v[60:63], a[208:215], v15
v_smfmac_f32_16x16x64_bf16 v[76:79], v[60:63], a[216:223], v15
v_smfmac_f32_16x16x64_bf16 v[80:83], v[60:63], a[224:231], v15
v_smfmac_f32_16x16x64_bf16 v[84:87], v[60:63], a[232:239], v15
Lps_205:
s_waitcnt vmcnt(2)
v_max3_u32 v44, v48, v49, v50
v_max_u32 v44, v44, v51
v_cmp_eq_u32 vcc, -1, v44
s_cbranch_vccnz Lpf_206
v_smfmac_f32_16x16x64_bf16 v[64:67], v[48:51], a[0:7], v15
v_smfmac_f32_16x16x64_bf16 v[68:71], v[48:51], a[8:15], v15
v_smfmac_f32_16x16x64_bf16 v[72:75], v[48:51], a[16:23], v15
v_smfmac_f32_16x16x64_bf16 v[76:79], v[48:51], a[24:31], v15
v_smfmac_f32_16x16x64_bf16 v[80:83], v[48:51], a[32:39], v15
v_smfmac_f32_16x16x64_bf16 v[84:87], v[48:51], a[40:47], v15
s_branch Lps_199
Lpf_184:
buffer_load_dwordx4 v[60:63], v10, s[4:7], s40 offen offset:3072 sc1
Lps_207:
s_waitcnt vmcnt(2)
v_max3_u32 v44, v48, v49, v50
v_max_u32 v44, v44, v51
v_cmp_eq_u32 vcc, -1, v44
s_cbranch_vccnz Lpf_208
v_smfmac_f32_16x16x64_bf16 v[64:67], v[48:51], a[0:7], v15
v_smfmac_f32_16x16x64_bf16 v[68:71], v[48:51], a[8:15], v15
v_smfmac_f32_16x16x64_bf16 v[72:75], v[48:51], a[16:23], v15
v_smfmac_f32_16x16x64_bf16 v[76:79], v[48:51], a[24:31], v15
v_smfmac_f32_16x16x64_bf16 v[80:83], v[48:51], a[32:39], v15
v_smfmac_f32_16x16x64_bf16 v[84:87], v[48:51], a[40:47], v15
s_branch Lps_201
Lpf_186:
buffer_load_dwordx4 v[48:51], v10, s[4:7], s40 offen offset:0 sc1
s_sub_u32 s37, s37, 1
s_cbranch_scc1 Lend_1
Lps_209:
s_waitcnt vmcnt(1)
v_max3_u32 v44, v52, v53, v54
v_max_u32 v44, v44, v55
v_cmp_eq_u32 vcc, -1, v44
s_cbranch_vccnz Lpf_210
v_smfmac_f32_16x16x64_bf16 v[64:67], v[52:55], a[64:71], v15
v_smfmac_f32_16x16x64_bf16 v[68:71], v[52:55], a[72:79], v15
v_smfmac_f32_16x16x64_bf16 v[72:75], v[52:55], a[80:87], v15
v_smfmac_f32_16x16x64_bf16 v[76:79], v[52:55], a[88:95], v15
v_smfmac_f32_16x16x64_bf16 v[80:83], v[52:55], a[96:103], v15
v_smfmac_f32_16x16x64_bf16 v[84:87], v[52:55], a[104:111], v15
s_branch Lps_173
Lpf_188:
buffer_load_dwordx4 v[60:63], v10, s[4:7], s40 offen offset:3072 sc1
Lps_211:
s_waitcnt vmcnt(2)
v_max3_u32 v44, v48, v49, v50
v_max_u32 v44, v44, v51
v_cmp_eq_u32 vcc, -1, v44
s_cbranch_vccnz Lpf_212
v_smfmac_f32_16x16x64_bf16 v[64:67], v[48:51], a[0:7], v15
v_smfmac_f32_16x16x64_bf16 v[68:71], v[48:51], a[8:15], v15
v_smfmac_f32_16x16x64_bf16 v[72:75], v[48:51], a[16:23], v15
v_smfmac_f32_16x16x64_bf16 v[76:79], v[48:51], a[24:31], v15
v_smfmac_f32_16x16x64_bf16 v[80:83], v[48:51], a[32:39], v15
v_smfmac_f32_16x16x64_bf16 v[84:87], v[48:51], a[40:47], v15
Lps_166:
s_waitcnt vmcnt(1)
v_max3_u32 v44, v56, v57, v58
v_max_u32 v44, v44, v59
v_cmp_eq_u32 vcc, -1, v44
s_cbranch_vccnz Lpf_213
v_smfmac_f32_16x16x64_bf16 v[64:67], v[56:59], a[128:135], v15
v_smfmac_f32_16x16x64_bf16 v[68:71], v[56:59], a[136:143], v15
v_smfmac_f32_16x16x64_bf16 v[72:75], v[56:59], a[144:151], v15
v_smfmac_f32_16x16x64_bf16 v[76:79], v[56:59], a[152:159], v15
v_smfmac_f32_16x16x64_bf16 v[80:83], v[56:59], a[160:167], v15
v_smfmac_f32_16x16x64_bf16 v[84:87], v[56:59], a[168:175], v15
s_branch Lps_195
Lpf_190:
buffer_load_dwordx4 v[48:51], v10, s[4:7], s40 offen offset:0 sc1
s_sub_u32 s37, s37, 1
s_cbranch_scc1 Lend_1
Lps_214:
s_waitcnt vmcnt(1)
v_max3_u32 v44, v56, v57, v58
v_max_u32 v44, v44, v59
v_cmp_eq_u32 vcc, -1, v44
s_cbranch_vccnz Lpf_215
v_smfmac_f32_16x16x64_bf16 v[64:67], v[56:59], a[128:135], v15
v_smfmac_f32_16x16x64_bf16 v[68:71], v[56:59], a[136:143], v15
v_smfmac_f32_16x16x64_bf16 v[72:75], v[56:59], a[144:151], v15
v_smfmac_f32_16x16x64_bf16 v[76:79], v[56:59], a[152:159], v15
v_smfmac_f32_16x16x64_bf16 v[80:83], v[56:59], a[160:167], v15
v_smfmac_f32_16x16x64_bf16 v[84:87], v[56:59], a[168:175], v15
s_branch Lps_173
Lpf_192:
buffer_load_dwordx4 v[56:59], v10, s[4:7], s40 offen offset:2048 sc1
s_sub_u32 s37, s37, 1
s_cbranch_scc1 Lend_1
s_branch Lps_191
Lpf_194:
buffer_load_dwordx4 v[48:51], v10, s[4:7], s40 offen offset:0 sc1
s_sub_u32 s37, s37, 1
s_cbranch_scc1 Lend_1
s_branch Lps_171
Lpf_196:
buffer_load_dwordx4 v[60:63], v10, s[4:7], s40 offen offset:3072 sc1
s_sub_u32 s37, s37, 1
s_cbranch_scc1 Lend_1
s_branch Lps_195
Lpf_198:
buffer_load_dwordx4 v[60:63], v10, s[4:7], s40 offen offset:3072 sc1
Lps_216:
s_waitcnt vmcnt(2)
v_max3_u32 v44, v52, v53, v54
v_max_u32 v44, v44, v55
v_cmp_eq_u32 vcc, -1, v44
s_cbranch_vccnz Lpf_217
v_smfmac_f32_16x16x64_bf16 v[64:67], v[52:55], a[64:71], v15
v_smfmac_f32_16x16x64_bf16 v[68:71], v[52:55], a[72:79], v15
v_smfmac_f32_16x16x64_bf16 v[72:75], v[52:55], a[80:87], v15
v_smfmac_f32_16x16x64_bf16 v[76:79], v[52:55], a[88:95], v15
v_smfmac_f32_16x16x64_bf16 v[80:83], v[52:55], a[96:103], v15
v_smfmac_f32_16x16x64_bf16 v[84:87], v[52:55], a[104:111], v15
s_branch Lps_166
Lpf_200:
buffer_load_dwordx4 v[52:55], v10, s[4:7], s40 offen offset:1024 sc1
s_sub_u32 s37, s37, 1
s_cbranch_scc1 Lend_1
Lps_218:
s_waitcnt vmcnt(1)
v_max3_u32 v44, v56, v57, v58
v_max_u32 v44, v44, v59
v_cmp_eq_u32 vcc, -1, v44
s_cbranch_vccnz Lpf_219
v_smfmac_f32_16x16x64_bf16 v[64:67], v[56:59], a[128:135], v15
v_smfmac_f32_16x16x64_bf16 v[68:71], v[56:59], a[136:143], v15
v_smfmac_f32_16x16x64_bf16 v[72:75], v[56:59], a[144:151], v15
v_smfmac_f32_16x16x64_bf16 v[76:79], v[56:59], a[152:159], v15
v_smfmac_f32_16x16x64_bf16 v[80:83], v[56:59], a[160:167], v15
v_smfmac_f32_16x16x64_bf16 v[84:87], v[56:59], a[168:175], v15
s_branch Lps_179
Lpf_202:
buffer_load_dwordx4 v[52:55], v10, s[4:7], s40 offen offset:1024 sc1
s_sub_u32 s37, s37, 1
s_cbranch_scc1 Lend_1
s_branch Lps_177
Lpf_204:
buffer_load_dwordx4 v[60:63], v10, s[4:7], s40 offen offset:3072 sc1
Lps_220:
s_waitcnt vmcnt(3)
v_max3_u32 v44, v48, v49, v50
v_max_u32 v44, v44, v51
v_cmp_eq_u32 vcc, -1, v44
s_cbranch_vccnz Lpf_221
v_smfmac_f32_16x16x64_bf16 v[64:67], v[48:51], a[0:7], v15
v_smfmac_f32_16x16x64_bf16 v[68:71], v[48:51], a[8:15], v15
v_smfmac_f32_16x16x64_bf16 v[72:75], v[48:51], a[16:23], v15
v_smfmac_f32_16x16x64_bf16 v[76:79], v[48:51], a[24:31], v15
v_smfmac_f32_16x16x64_bf16 v[80:83], v[48:51], a[32:39], v15
v_smfmac_f32_16x16x64_bf16 v[84:87], v[48:51], a[40:47], v15
s_branch Lps_216
Lpf_206:
buffer_load_dwordx4 v[48:51], v10, s[4:7], s40 offen offset:0 sc1
s_sub_u32 s37, s37, 1
s_cbranch_scc1 Lend_1
Lps_222:
s_waitcnt vmcnt(2)
v_max3_u32 v44, v52, v53, v54
v_max_u32 v44, v44, v55
v_cmp_eq_u32 vcc, -1, v44
s_cbranch_vccnz Lpf_223
v_smfmac_f32_16x16x64_bf16 v[64:67], v[52:55], a[64:71], v15
v_smfmac_f32_16x16x64_bf16 v[68:71], v[52:55], a[72:79], v15
v_smfmac_f32_16x16x64_bf16 v[72:75], v[52:55], a[80:87], v15
v_smfmac_f32_16x16x64_bf16 v[76:79], v[52:55], a[88:95], v15
v_smfmac_f32_16x16x64_bf16 v[80:83], v[52:55], a[96:103], v15
v_smfmac_f32_16x16x64_bf16 v[84:87], v[52:55], a[104:111], v15
s_branch Lps_214
Lpf_208:
buffer_load_dwordx4 v[48:51], v10, s[4:7], s40 offen offset:0 sc1
s_sub_u32 s37, s37, 1
s_cbranch_scc1 Lend_1
Lps_224:
s_waitcnt vmcnt(2)
v_max3_u32 v44, v52, v53, v54
v_max_u32 v44, v44, v55
v_cmp_eq_u32 vcc, -1, v44
s_cbranch_vccnz Lpf_225
v_smfmac_f32_16x16x64_bf16 v[64:67], v[52:55], a[64:71], v15
v_smfmac_f32_16x16x64_bf16 v[68:71], v[52:55], a[72:79], v15
v_smfmac_f32_16x16x64_bf16 v[72:75], v[52:55], a[80:87], v15
v_smfmac_f32_16x16x64_bf16 v[76:79], v[52:55], a[88:95], v15
v_smfmac_f32_16x16x64_bf16 v[80:83], v[52:55], a[96:103], v15
v_smfmac_f32_16x16x64_bf16 v[84:87], v[52:55], a[104:111], v15
s_branch Lps_171
Lpf_210:
buffer_load_dwordx4 v[52:55], v10, s[4:7], s40 offen offset:1024 sc1
s_branch Lps_185
Lpf_212:
buffer_load_dwordx4 v[48:51], v10, s[4:7], s40 offen offset:0 sc1
s_sub_u32 s37, s37, 1
s_cbranch_scc1 Lend_1
s_branch Lps_169
Lpf_213:
buffer_load_dwordx4 v[56:59], v10, s[4:7], s40 offen offset:2048 sc1
s_sub_u32 s37, s37, 1
s_cbranch_scc1 Lend_1
Lps_226:
s_waitcnt vmcnt(1)
v_max3_u32 v44, v60, v61, v62
v_max_u32 v44, v44, v63
v_cmp_eq_u32 vcc, -1, v44
s_cbranch_vccnz Lpf_227
v_smfmac_f32_16x16x64_bf16 v[64:67], v[60:63], a[192:199], v15
v_smfmac_f32_16x16x64_bf16 v[68:71], v[60:63], a[200:207], v15
v_smfmac_f32_16x16x64_bf16 v[72:75], v[60:63], a[208:215], v15
v_smfmac_f32_16x16x64_bf16 v[76:79], v[60:63], a[216:223], v15
v_smfmac_f32_16x16x64_bf16 v[80:83], v[60:63], a[224:231], v15
v_smfmac_f32_16x16x64_bf16 v[84:87], v[60:63], a[232:239], v15
s_branch Lps_191
Lpf_215:
buffer_load_dwordx4 v[56:59], v10, s[4:7], s40 offen offset:2048 sc1
s_branch Lps_189
Lpf_217:
buffer_load_dwordx4 v[52:55], v10, s[4:7], s40 offen offset:1024 sc1
s_sub_u32 s37, s37, 1
s_cbranch_scc1 Lend_1
s_branch Lps_175
Lpf_219:
buffer_load_dwordx4 v[56:59], v10, s[4:7], s40 offen offset:2048 sc1
s_branch Lps_199
Lpf_221:
buffer_load_dwordx4 v[48:51], v10, s[4:7], s40 offen offset:0 sc1
s_sub_u32 s37, s37, 1
s_cbranch_scc1 Lend_1
s_branch Lps_167
Lpf_223:
buffer_load_dwordx4 v[52:55], v10, s[4:7], s40 offen offset:1024 sc1
Lps_228:
s_waitcnt vmcnt(2)
v_max3_u32 v44, v56, v57, v58
v_max_u32 v44, v44, v59
v_cmp_eq_u32 vcc, -1, v44
s_cbranch_vccnz Lpf_229
v_smfmac_f32_16x16x64_bf16 v[64:67], v[56:59], a[128:135], v15
v_smfmac_f32_16x16x64_bf16 v[68:71], v[56:59], a[136:143], v15
v_smfmac_f32_16x16x64_bf16 v[72:75], v[56:59], a[144:151], v15
v_smfmac_f32_16x16x64_bf16 v[76:79], v[56:59], a[152:159], v15
v_smfmac_f32_16x16x64_bf16 v[80:83], v[56:59], a[160:167], v15
v_smfmac_f32_16x16x64_bf16 v[84:87], v[56:59], a[168:175], v15
s_branch Lps_185
Lpf_225:
buffer_load_dwordx4 v[52:55], v10, s[4:7], s40 offen offset:1024 sc1
s_branch Lps_183
Lpf_227:
buffer_load_dwordx4 v[60:63], v10, s[4:7], s40 offen offset:3072 sc1
s_branch Lps_166
Lpf_229:
buffer_load_dwordx4 v[56:59], v10, s[4:7], s40 offen offset:2048 sc1
s_branch Lps_205
Lkr_154:
buffer_load_dwordx4 v[56:59], v11, s[4:7], s40 offen offset:0 sc1
buffer_load_dwordx4 v[60:63], v11, s[4:7], s40 offen offset:1024 sc1
Lps_231:
s_waitcnt vmcnt(3)
v_max3_u32 v44, v48, v49, v50
v_max_u32 v44, v44, v51
v_cmp_eq_u32 vcc, -1, v44
s_cbranch_vccnz Lpf_232
v_smfmac_f32_16x16x64_bf16 v[72:75], v[48:51], v[96:103], v15
v_mov_b32 v112, v48
v_mov_b32 v113, v49
v_mov_b32 v114, v50
v_mov_b32 v115, v51
Lps_233:
s_waitcnt vmcnt(2)
v_max3_u32 v44, v52, v53, v54
v_max_u32 v44, v44, v55
v_cmp_eq_u32 vcc, -1, v44
s_cbranch_vccnz Lpf_234
v_smfmac_f32_16x16x64_bf16 v[72:75], v[52:55], v[104:111], v15
v_mov_b32 v116, v52
v_mov_b32 v117, v53
v_mov_b32 v118, v54
v_mov_b32 v119, v55
Lpd_230:
s_branch Lko_155
Lpf_232:
buffer_load_dwordx4 v[48:51], v11, s[4:7], s40 offen offset:0 sc1
s_sub_u32 s37, s37, 1
s_cbranch_scc1 Lend_1
Lps_235:
s_waitcnt vmcnt(3)
v_max3_u32 v44, v52, v53, v54
v_max_u32 v44, v44, v55
v_cmp_eq_u32 vcc, -1, v44
s_cbranch_vccnz Lpf_236
v_smfmac_f32_16x16x64_bf16 v[72:75], v[52:55], v[104:111], v15
v_mov_b32 v116, v52
v_mov_b32 v117, v53
v_mov_b32 v118, v54
v_mov_b32 v119, v55
Lps_237:
s_waitcnt vmcnt(2)
v_max3_u32 v44, v56, v57, v58
v_max_u32 v44, v44, v59
v_cmp_eq_u32 vcc, -1, v44
s_cbranch_vccnz Lpf_238
v_smfmac_f32_16x16x64_bf16 v[72:75], v[56:59], v[96:103], v15
v_mov_b32 v112, v56
v_mov_b32 v113, v57
v_mov_b32 v114, v58
v_mov_b32 v115, v59
s_branch Lpd_230
Lpf_234:
buffer_load_dwordx4 v[52:55], v11, s[4:7], s40 offen offset:1024 sc1
s_sub_u32 s37, s37, 1
s_cbranch_scc1 Lend_1
Lps_239:
s_waitcnt vmcnt(2)
v_max3_u32 v44, v56, v57, v58
v_max_u32 v44, v44, v59
v_cmp_eq_u32 vcc, -1, v44
s_cbranch_vccnz Lpf_240
Lps_241:
s_waitcnt vmcnt(1)
v_max3_u32 v44, v60, v61, v62
v_max_u32 v44, v44, v63
v_cmp_eq_u32 vcc, -1, v44
s_cbranch_vccnz Lpf_242
v_smfmac_f32_16x16x64_bf16 v[72:75], v[60:63], v[104:111], v15
v_mov_b32 v116, v60
v_mov_b32 v117, v61
v_mov_b32 v118, v62
v_mov_b32 v119, v63
s_branch Lpd_230
Lpf_236:
buffer_load_dwordx4 v[52:55], v11, s[4:7], s40 offen offset:1024 sc1
Lps_243:
s_waitcnt vmcnt(3)
v_max3_u32 v44, v56, v57, v58
v_max_u32 v44, v44, v59
v_cmp_eq_u32 vcc, -1, v44
s_cbranch_vccnz Lpf_244
v_smfmac_f32_16x16x64_bf16 v[72:75], v[56:59], v[96:103], v15
v_mov_b32 v112, v56
v_mov_b32 v113, v57
v_mov_b32 v114, v58
v_mov_b32 v115, v59
Lps_245:
s_waitcnt vmcnt(2)
v_max3_u32 v44, v60, v61, v62
v_max_u32 v44, v44, v63
v_cmp_eq_u32 vcc, -1, v44
s_cbranch_vccnz Lpf_246
v_smfmac_f32_16x16x64_bf16 v[72:75], v[60:63], v[104:111], v15
v_mov_b32 v116, v60
v_mov_b32 v117, v61
v_mov_b32 v118, v62
v_mov_b32 v119, v63
s_branch Lpd_230
Lpf_238:
buffer_load_dwordx4 v[56:59], v11, s[4:7], s40 offen offset:0 sc1
Lps_247:
s_waitcnt vmcnt(2)
v_max3_u32 v44, v60, v61, v62
v_max_u32 v44, v44, v63
v_cmp_eq_u32 vcc, -1, v44
s_cbranch_vccnz Lpf_248
Lps_249:
s_waitcnt vmcnt(1)
v_max3_u32 v44, v48, v49, v50
v_max_u32 v44, v44, v51
v_cmp_eq_u32 vcc, -1, v44
s_cbranch_vccnz Lpf_250
v_smfmac_f32_16x16x64_bf16 v[72:75], v[48:51], v[96:103], v15
v_mov_b32 v112, v48
v_mov_b32 v113, v49
v_mov_b32 v114, v50
v_mov_b32 v115, v51
s_branch Lpd_230
Lpf_240:
buffer_load_dwordx4 v[56:59], v11, s[4:7], s40 offen offset:0 sc1
Lps_251:
s_waitcnt vmcnt(2)
v_max3_u32 v44, v60, v61, v62
v_max_u32 v44, v44, v63
v_cmp_eq_u32 vcc, -1, v44
s_cbranch_vccnz Lpf_252
v_smfmac_f32_16x16x64_bf16 v[72:75], v[60:63], v[104:111], v15
v_mov_b32 v116, v60
v_mov_b32 v117, v61
v_mov_b32 v118, v62
v_mov_b32 v119, v63
s_branch Lpd_230
Lpf_242:
buffer_load_dwordx4 v[60:63], v11, s[4:7], s40 offen offset:1024 sc1
Lps_253:
s_waitcnt vmcnt(1)
v_max3_u32 v44, v52, v53, v54
v_max_u32 v44, v44, v55
v_cmp_eq_u32 vcc, -1, v44
s_cbranch_vccnz Lpf_254
v_smfmac_f32_16x16x64_bf16 v[72:75], v[52:55], v[104:111], v15
v_mov_b32 v116, v52
v_mov_b32 v117, v53
v_mov_b32 v118, v54
v_mov_b32 v119, v55
s_branch Lpd_230
Lpf_244:
buffer_load_dwordx4 v[56:59], v11, s[4:7], s40 offen offset:0 sc1
Lps_255:
s_waitcnt vmcnt(3)
v_max3_u32 v44, v60, v61, v62
v_max_u32 v44, v44, v63
v_cmp_eq_u32 vcc, -1, v44
s_cbranch_vccnz Lpf_256
v_smfmac_f32_16x16x64_bf16 v[72:75], v[60:63], v[104:111], v15
v_mov_b32 v116, v60
v_mov_b32 v117, v61
v_mov_b32 v118, v62
v_mov_b32 v119, v63
Lps_257:
s_waitcnt vmcnt(2)
v_max3_u32 v44, v48, v49, v50
v_max_u32 v44, v44, v51
v_cmp_eq_u32 vcc, -1, v44
s_cbranch_vccnz Lpf_258
v_smfmac_f32_16x16x64_bf16 v[72:75], v[48:51], v[96:103], v15
v_mov_b32 v112, v48
v_mov_b32 v113, v49
v_mov_b32 v114, v50
v_mov_b32 v115, v51
s_branch Lpd_230
Lpf_246:
buffer_load_dwordx4 v[60:63], v11, s[4:7], s40 offen offset:1024 sc1
Lps_259:
s_waitcnt vmcnt(2)
v_max3_u32 v44, v48, v49, v50
v_max_u32 v44, v44, v51
v_cmp_eq_u32 vcc, -1, v44
s_cbranch_vccnz Lpf_260
s_branch Lps_253
Lpf_248:
buffer_load_dwordx4 v[60:63], v11, s[4:7], s40 offen offset:1024 sc1
Lps_261:
s_waitcnt vmcnt(2)
v_max3_u32 v44, v48, v49, v50
v_max_u32 v44, v44, v51
v_cmp_eq_u32 vcc, -1, v44
s_cbranch_vccnz Lpf_262
v_smfmac_f32_16x16x64_bf16 v[72:75], v[48:51], v[96:103], v15
v_mov_b32 v112, v48
v_mov_b32 v113, v49
v_mov_b32 v114, v50
v_mov_b32 v115, v51
s_branch Lpd_230
Lpf_250:
buffer_load_dwordx4 v[48:51], v11, s[4:7], s40 offen offset:0 sc1
s_sub_u32 s37, s37, 1
s_cbranch_scc1 Lend_1
Lps_263:
s_waitcnt vmcnt(1)
v_max3_u32 v44, v56, v57, v58
v_max_u32 v44, v44, v59
v_cmp_eq_u32 vcc, -1, v44
s_cbranch_vccnz Lpf_264
v_smfmac_f32_16x16x64_bf16 v[72:75], v[56:59], v[96:103], v15
v_mov_b32 v112, v56
v_mov_b32 v113, v57
v_mov_b32 v114, v58
v_mov_b32 v115, v59
s_branch Lpd_230
Lpf_252:
buffer_load_dwordx4 v[60:63], v11, s[4:7], s40 offen offset:1024 sc1
s_branch Lps_233
Lpf_254:
buffer_load_dwordx4 v[52:55], v11, s[4:7], s40 offen offset:1024 sc1
s_sub_u32 s37, s37, 1
s_cbranch_scc1 Lend_1
s_branch Lps_241
Lpf_256:
buffer_load_dwordx4 v[60:63], v11, s[4:7], s40 offen offset:1024 sc1
s_branch Lps_231
Lpf_258:
buffer_load_dwordx4 v[48:51], v11, s[4:7], s40 offen offset:0 sc1
s_sub_u32 s37, s37, 1
s_cbranch_scc1 Lend_1
Lps_265:
s_waitcnt vmcnt(2)
v_max3_u32 v44, v52, v53, v54
v_max_u32 v44, v44, v55
v_cmp_eq_u32 vcc, -1, v44
s_cbranch_vccnz Lpf_266
s_branch Lps_263
Lpf_260:
buffer_load_dwordx4 v[48:51], v11, s[4:7], s40 offen offset:0 sc1
s_sub_u32 s37, s37, 1
s_cbranch_scc1 Lend_1
Lps_267:
s_waitcnt vmcnt(2)
v_max3_u32 v44, v52, v53, v54
v_max_u32 v44, v44, v55
v_cmp_eq_u32 vcc, -1, v44
s_cbranch_vccnz Lpf_268
v_smfmac_f32_16x16x64_bf16 v[72:75], v[52:55], v[104:111], v15
v_mov_b32 v116, v52
v_mov_b32 v117, v53
v_mov_b32 v118, v54
v_mov_b32 v119, v55
s_branch Lpd_230
Lpf_262:
buffer_load_dwordx4 v[48:51], v11, s[4:7], s40 offen offset:0 sc1
s_sub_u32 s37, s37, 1
s_cbranch_scc1 Lend_1
s_branch Lps_237
Lpf_264:
buffer_load_dwordx4 v[56:59], v11, s[4:7], s40 offen offset:0 sc1
s_branch Lps_249
Lpf_266:
buffer_load_dwordx4 v[52:55], v11, s[4:7], s40 offen offset:1024 sc1
Lps_269:
s_waitcnt vmcnt(2)
v_max3_u32 v44, v56, v57, v58
v_max_u32 v44, v44, v59
v_cmp_eq_u32 vcc, -1, v44
s_cbranch_vccnz Lpf_270
v_smfmac_f32_16x16x64_bf16 v[72:75], v[56:59], v[96:103], v15
v_mov_b32 v112, v56
v_mov_b32 v113, v57
v_mov_b32 v114, v58
v_mov_b32 v115, v59
s_branch Lpd_230
Lpf_268:
buffer_load_dwordx4 v[52:55], v11, s[4:7], s40 offen offset:1024 sc1
s_branch Lps_245
Lpf_270:
buffer_load_dwordx4 v[56:59], v11, s[4:7], s40 offen offset:0 sc1
s_branch Lps_257
Lvr_156:
buffer_load_dwordx2 v[120:121], v12, s[4:7], s40 offen sc1
buffer_load_dwordx2 v[122:123], v13, s[4:7], s40 offen sc1
s_sub_u32 s37, s37, 1
s_cbranch_scc1 Lend_1
s_waitcnt vmcnt(0)
v_max3_u32 v44, v120, v121, v122
v_max_u32 v44, v44, v123
v_cmp_eq_u32 vcc, -1, v44
s_cbranch_vccnz Lvr_156
s_branch Lvo_157
Lend_1:
s_endpgm
Lkvo_2:
v_mov_b32 v44, v0
v_mov_b32 v45, v1
s_sub_u32 s54, s34, 8
s_xor_b32 s57, s32, 3
s_lshl_b32 s45, s33, 18
s_add_u32 s45, s45, 2097152
s_lshl_b32 s59, s33, 12
s_add_u32 s59, s59, 3276800
s_lshl_b32 s38, s32, 12
v_lshl_add_u32 v8, v45, 4, s38
v_add_u32 v9, 49152, v8
s_lshl_b32 s38, s54, 10
s_lshl_b32 s39, s32, 8
s_add_u32 s39, s39, s38
v_mov_b32 v10, s39
v_bfe_u32 v46, v45, 1, 2
v_lshl_add_u32 v10, v46, 6, v10
v_bfe_u32 v46, v45, 5, 1
v_lshl_add_u32 v10, v46, 5, v10
v_bfe_u32 v46, v45, 0, 1
v_lshl_add_u32 v10, v46, 4, v10
v_bfe_u32 v46, v45, 4, 1
v_lshl_add_u32 v10, v46, 3, v10
v_bfe_u32 v46, v45, 3, 1
v_lshl_add_u32 v10, v46, 30, v10
v_and_b32 v46, 0xf0, v44
v_lshl_add_u32 v11, v46, 2, s38
v_and_b32 v46, 3, v45
v_lshl_add_u32 v11, v46, 4, v11
v_and_b32 v46, 12, v45
v_add_u32 v11, v11, v46
v_xor_b32 v11, 20480, v11
s_lshr_b32 s39, s32, 1
s_lshl_b32 s39, s39, 9
s_add_u32 s38, s38, s39
s_and_b32 s39, s32, 1
s_lshl_b32 s39, s39, 2
s_add_u32 s38, s38, s39
s_xor_b32 s38, s38, 34816
v_lshl_add_u32 v27, v45, 3, s38
s_lshl_b32 s38, s32, 8
s_add_u32 s38, s38, 2048
v_lshl_add_u32 v1, v45, 2, s38
s_lshr_b32 s38, s54, 2
s_lshl_b32 s38, s38, 8
s_and_b32 s39, s54, 3
s_lshl_b32 s39, s39, 2
s_add_u32 s38, s38, s39
v_min_u32 v46, 1, v44
v_lshl_add_u32 v2, v46, 30, s38
s_lshr_b32 s38, s54, 3
s_lshl_b32 s38, s38, 14
s_and_b32 s39, s54, 7
s_lshl_b32 s39, s39, 10
s_add_u32 s38, s38, s39
s_lshl_b32 s39, s33, 16
s_add_u32 s38, s38, s39
v_lshl_add_u32 v12, v44, 2, s38
v_xor_b32 v13, 0x10000, v12
v_xor_b32 v14, 0x20000, v12
v_xor_b32 v15, 0x30000, v12
v_bfe_u32 v126, v45, 1, 1
v_mul_u32_u24 v126, 0xaaaa, v126
v_add_u32 v126, 0x4444, v126
s_xor_b32 s38, s57, 0
s_mul_i32 s38, s38, 1536
s_add_u32 s38, s38, 0
v_lshl_add_u32 v24, v45, 3, s38
s_xor_b32 s38, s57, 1
s_mul_i32 s38, s38, 1536
s_add_u32 s38, s38, 512
v_lshl_add_u32 v25, v45, 3, s38
s_xor_b32 s38, s57, 2
s_mul_i32 s38, s38, 1536
s_add_u32 s38, s38, 1024
v_lshl_add_u32 v26, v45, 3, s38
s_mul_i32 s38, s32, 1536
v_lshl_add_u32 v0, v45, 3, s38
v_and_b32 v46, 1, v45
v_mov_b32 v3, 0x05040100
v_mov_b32 v47, 0x03020706
v_cmp_eq_u32 vcc, 1, v46
s_nop 1
v_cndmask_b32 v3, v3, v47, vcc
v_and_b32 v46, 7, v45
v_lshrrev_b32 v47, 4, v45
v_lshlrev_b32 v50, 3, v47
v_lshl_add_u32 v57, v46, 11, v50
s_mov_b32 s8, s16
s_and_b32 s9, s17, 0xffff
s_mov_b32 s10, 0x4000
s_mov_b32 s11, 0x20000
v_bfe_u32 v46, v45, 1, 3
v_cmp_eq_u32 vcc, v46, v47
v_and_b32 v46, 1, v45
v_lshlrev_b32 v46, 4, v46
v_mov_b32 v47, 0x3f80
v_lshlrev_b32 v46, v46, v47
v_cndmask_b32 v20, 0, v46, vcc
v_cndmask_b32 v21, 0, v46, vcc
v_cndmask_b32 v22, 0, v46, vcc
v_cndmask_b32 v23, 0, v46, vcc
v_mov_b32 v4, -1
v_mov_b32 v5, -1
s_add_u32 s38, s45, 0
buffer_store_dwordx2 v[4:5], v10, s[4:7], s38 offen sc1
buffer_store_dword v4, v11, s[4:7], s38 offen sc1
buffer_store_dword v4, v27, s[4:7], s38 offen sc1
s_mov_b32 s39, 0
buffer_store_dword v4, v12, s[4:7], s39 offen sc1
s_mov_b32 s39, 8192
buffer_store_dword v4, v12, s[4:7], s39 offen sc1
s_mov_b32 s39, 1048576
buffer_store_dword v4, v12, s[4:7], s39 offen sc1
s_mov_b32 s39, 1056768
buffer_store_dword v4, v12, s[4:7], s39 offen sc1
s_add_u32 s38, s45, 65536
buffer_store_dwordx2 v[4:5], v10, s[4:7], s38 offen sc1
buffer_store_dword v4, v11, s[4:7], s38 offen sc1
buffer_store_dword v4, v27, s[4:7], s38 offen sc1
s_mov_b32 s39, 262144
buffer_store_dword v4, v12, s[4:7], s39 offen sc1
s_mov_b32 s39, 270336
buffer_store_dword v4, v12, s[4:7], s39 offen sc1
s_mov_b32 s39, 1310720
buffer_store_dword v4, v12, s[4:7], s39 offen sc1
s_mov_b32 s39, 1318912
buffer_store_dword v4, v12, s[4:7], s39 offen sc1
s_add_u32 s38, s45, 131072
buffer_store_dwordx2 v[4:5], v10, s[4:7], s38 offen sc1
buffer_store_dword v4, v11, s[4:7], s38 offen sc1
buffer_store_dword v4, v27, s[4:7], s38 offen sc1
s_mov_b32 s39, 524288
buffer_store_dword v4, v12, s[4:7], s39 offen sc1
s_mov_b32 s39, 532480
buffer_store_dword v4, v12, s[4:7], s39 offen sc1
s_mov_b32 s39, 1572864
buffer_store_dword v4, v12, s[4:7], s39 offen sc1
s_mov_b32 s39, 1581056
buffer_store_dword v4, v12, s[4:7], s39 offen sc1
s_add_u32 s38, s45, 196608
buffer_store_dwordx2 v[4:5], v10, s[4:7], s38 offen sc1
buffer_store_dword v4, v11, s[4:7], s38 offen sc1
buffer_store_dword v4, v27, s[4:7], s38 offen sc1
s_mov_b32 s39, 786432
buffer_store_dword v4, v12, s[4:7], s39 offen sc1
s_mov_b32 s39, 794624
buffer_store_dword v4, v12, s[4:7], s39 offen sc1
s_mov_b32 s39, 1835008
buffer_store_dword v4, v12, s[4:7], s39 offen sc1
s_mov_b32 s39, 1843200
buffer_store_dword v4, v12, s[4:7], s39 offen sc1
v_mov_b32 v7, 1
buffer_store_dword v7, v2, s[4:7], s59 offen sc1
s_lshl_b32 s52, s35, 16
s_or_b32 s52, s52, 1
s_waitcnt vmcnt(0)
s_barrier
s_cmp_lg_u32 s32, 0
s_cbranch_scc1 Lar_271
s_mov_b64 exec, 1
v_mov_b32 v48, 32
v_mov_b32 v49, s52
buffer_atomic_add v49, v48, s[12:15], 0 offen sc1
s_mov_b64 exec, -1
Lar_271:
s_lshl_b32 s38, s54, 2
s_add_u32 s38, s38, s32
s_lshl_b32 s38, s38, 5
buffer_load_dwordx2 v[58:59], v57, s[8:11], s38 offen
s_lshl_b32 s52, s57, 5
v_and_b32 v46, 7, v45
v_lshlrev_b32 v46, 4, v46
v_xor_b32 v46, s52, v46
v_lshrrev_b32 v52, 3, v45
v_lshl_add_u32 v52, v52, 13, v46
v_and_b32 v46, 7, v45
v_lshlrev_b32 v46, 4, v46
v_xor_b32 v46, s52, v46
v_lshrrev_b32 v53, 3, v45
v_lshl_add_u32 v53, v53, 11, v46
s_and_b32 s53, s52, 32
s_lshr_b32 s53, s53, 1
s_and_b32 s52, s52, 64
s_or_b32 s52, s52, s53
v_and_b32 v46, 7, v45
v_lshlrev_b32 v46, 4, v46
v_xor_b32 v46, s52, v46
v_lshrrev_b32 v51, 3, v45
v_lshl_add_u32 v51, v51, 13, v46
v_bfe_u32 v54, v45, 2, 1
v_bfe_u32 v46, v45, 5, 1
v_lshl_add_u32 v54, v46, 4, v54
v_bfe_u32 v46, v45, 4, 1
v_lshl_add_u32 v54, v46, 2, v54
v_bfe_u32 v46, v45, 3, 1
v_lshl_add_u32 v54, v46, 3, v54
s_mul_i32 s38, s32, 40960
v_lshl_add_u32 v54, v54, 7, s38
v_bfe_u32 v46, v45, 0, 1
v_lshl_add_u32 v54, v46, 5, v54
v_bfe_u32 v46, v45, 1, 1
v_lshl_add_u32 v54, v46, 3, v54
v_bfe_u32 v55, v45, 2, 1
v_bfe_u32 v46, v45, 5, 1
v_lshl_add_u32 v55, v46, 4, v55
v_bfe_u32 v46, v45, 4, 1
v_lshl_add_u32 v55, v46, 2, v55
v_bfe_u32 v46, v45, 3, 1
v_lshl_add_u32 v55, v46, 3, v55
s_mul_i32 s38, s32, 40960
v_lshl_add_u32 v55, v55, 7, s38
v_bfe_u32 v46, v45, 0, 1
v_lshl_add_u32 v55, v46, 3, v55
v_bfe_u32 v46, v45, 1, 1
v_lshl_add_u32 v55, v46, 4, v55
v_bfe_u32 v56, v45, 2, 1
v_bfe_u32 v46, v45, 4, 1
v_lshl_add_u32 v56, v46, 4, v56
v_bfe_u32 v46, v45, 5, 1
v_lshl_add_u32 v56, v46, 3, v56
v_bfe_u32 v46, v45, 3, 1
v_lshl_add_u32 v56, v46, 2, v56
s_mul_i32 s38, s32, 40960
v_lshl_add_u32 v56, v56, 7, s38
v_bfe_u32 v46, v45, 0, 1
v_lshl_add_u32 v56, v46, 3, v56
v_bfe_u32 v46, v45, 1, 1
v_lshl_add_u32 v56, v46, 4, v56
s_mov_b32 s8, s20
s_and_b32 s9, s21, 0xffff
s_mov_b32 s10, 0x800000
s_mov_b32 s11, 0x20000
s_lshl_b32 s39, s32, 21
s_lshl_b32 s38, s33, 4
s_add_u32 s38, s38, s54
s_xor_b32 s38, s38, 4
s_lshl_b32 s38, s38, 7
s_add_u32 s39, s39, s38
s_add_u32 s39, s39, 1572864
s_mul_i32 s38, s32, 40960
s_add_u32 m0, s38, 0
s_nop 0
buffer_load_dwordx4 v51, s[8:11], s39 offen lds
s_add_u32 m0, m0, 1024
s_add_u32 s39, s39, 65536
buffer_load_dwordx4 v51, s[8:11], s39 offen lds
s_add_u32 m0, m0, 1024
s_add_u32 s39, s39, 65536
buffer_load_dwordx4 v51, s[8:11], s39 offen lds
s_add_u32 m0, m0, 1024
s_add_u32 s39, s39, 65536
buffer_load_dwordx4 v51, s[8:11], s39 offen lds
s_add_u32 m0, m0, 1024
s_add_u32 s39, s39, 65536
buffer_load_dwordx4 v51, s[8:11], s39 offen lds
s_add_u32 m0, m0, 1024
s_add_u32 s39, s39, 65536
buffer_load_dwordx4 v51, s[8:11], s39 offen lds
s_add_u32 m0, m0, 1024
s_add_u32 s39, s39, 65536
buffer_load_dwordx4 v51, s[8:11], s39 offen lds
s_add_u32 m0, m0, 1024
s_add_u32 s39, s39, 65536
buffer_load_dwordx4 v51, s[8:11], s39 offen lds
s_mov_b32 s8, s22
s_and_b32 s9, s23, 0xffff
s_mov_b32 s10, 0x800000
s_mov_b32 s11, 0x20000
s_lshl_b32 s39, s32, 21
s_lshl_b32 s38, s33, 4
s_add_u32 s38, s38, s54
s_xor_b32 s38, s38, 2
s_lshl_b32 s38, s38, 7
s_add_u32 s39, s39, s38
s_add_u32 s39, s39, 1572864
s_mul_i32 s38, s32, 40960
s_add_u32 m0, s38, 8192
s_nop 0
buffer_load_dwordx4 v52, s[8:11], s39 offen lds
s_add_u32 m0, m0, 1024
s_add_u32 s39, s39, 65536
buffer_load_dwordx4 v52, s[8:11], s39 offen lds
s_add_u32 m0, m0, 1024
s_add_u32 s39, s39, 65536
buffer_load_dwordx4 v52, s[8:11], s39 offen lds
s_add_u32 m0, m0, 1024
s_add_u32 s39, s39, 65536
buffer_load_dwordx4 v52, s[8:11], s39 offen lds
s_add_u32 m0, m0, 1024
s_add_u32 s39, s39, 65536
buffer_load_dwordx4 v52, s[8:11], s39 offen lds
s_add_u32 m0, m0, 1024
s_add_u32 s39, s39, 65536
buffer_load_dwordx4 v52, s[8:11], s39 offen lds
s_add_u32 m0, m0, 1024
s_add_u32 s39, s39, 65536
buffer_load_dwordx4 v52, s[8:11], s39 offen lds
s_add_u32 m0, m0, 1024
s_add_u32 s39, s39, 65536
buffer_load_dwordx4 v52, s[8:11], s39 offen lds
s_mov_b32 s8, s20
s_and_b32 s9, s21, 0xffff
s_mov_b32 s10, 0x800000
s_mov_b32 s11, 0x20000
s_lshl_b32 s39, s32, 21
s_lshl_b32 s38, s33, 4
s_add_u32 s38, s38, s54
s_xor_b32 s38, s38, 4
s_lshl_b32 s38, s38, 7
s_add_u32 s39, s39, s38
s_add_u32 s39, s39, 1048576
s_mul_i32 s38, s32, 40960
s_add_u32 m0, s38, 16384
s_nop 0
buffer_load_dwordx4 v51, s[8:11], s39 offen lds
s_add_u32 m0, m0, 1024
s_add_u32 s39, s39, 65536
buffer_load_dwordx4 v51, s[8:11], s39 offen lds
s_add_u32 m0, m0, 1024
s_add_u32 s39, s39, 65536
buffer_load_dwordx4 v51, s[8:11], s39 offen lds
s_add_u32 m0, m0, 1024
s_add_u32 s39, s39, 65536
buffer_load_dwordx4 v51, s[8:11], s39 offen lds
s_add_u32 m0, m0, 1024
s_add_u32 s39, s39, 65536
buffer_load_dwordx4 v51, s[8:11], s39 offen lds
s_add_u32 m0, m0, 1024
s_add_u32 s39, s39, 65536
buffer_load_dwordx4 v51, s[8:11], s39 offen lds
s_add_u32 m0, m0, 1024
s_add_u32 s39, s39, 65536
buffer_load_dwordx4 v51, s[8:11], s39 offen lds
s_add_u32 m0, m0, 1024
s_add_u32 s39, s39, 65536
buffer_load_dwordx4 v51, s[8:11], s39 offen lds
s_mov_b32 s8, s22
s_and_b32 s9, s23, 0xffff
s_mov_b32 s10, 0x800000
s_mov_b32 s11, 0x20000
s_lshl_b32 s39, s32, 21
s_lshl_b32 s38, s33, 4
s_add_u32 s38, s38, s54
s_xor_b32 s38, s38, 2
s_lshl_b32 s38, s38, 7
s_add_u32 s39, s39, s38
s_add_u32 s39, s39, 1048576
s_mul_i32 s38, s32, 40960
s_add_u32 m0, s38, 24576
s_nop 0
buffer_load_dwordx4 v52, s[8:11], s39 offen lds
s_add_u32 m0, m0, 1024
s_add_u32 s39, s39, 65536
buffer_load_dwordx4 v52, s[8:11], s39 offen lds
s_add_u32 m0, m0, 1024
s_add_u32 s39, s39, 65536
buffer_load_dwordx4 v52, s[8:11], s39 offen lds
s_add_u32 m0, m0, 1024
s_add_u32 s39, s39, 65536
buffer_load_dwordx4 v52, s[8:11], s39 offen lds
s_add_u32 m0, m0, 1024
s_add_u32 s39, s39, 65536
buffer_load_dwordx4 v52, s[8:11], s39 offen lds
s_add_u32 m0, m0, 1024
s_add_u32 s39, s39, 65536
buffer_load_dwordx4 v52, s[8:11], s39 offen lds
s_add_u32 m0, m0, 1024
s_add_u32 s39, s39, 65536
buffer_load_dwordx4 v52, s[8:11], s39 offen lds
s_add_u32 m0, m0, 1024
s_add_u32 s39, s39, 65536
buffer_load_dwordx4 v52, s[8:11], s39 offen lds
s_mov_b32 s8, s20
s_and_b32 s9, s21, 0xffff
s_mov_b32 s10, 0x800000
s_mov_b32 s11, 0x20000
s_lshl_b32 s39, s32, 21
s_lshl_b32 s38, s33, 4
s_add_u32 s38, s38, s54
s_xor_b32 s38, s38, 4
s_lshl_b32 s38, s38, 7
s_add_u32 s39, s39, s38
s_add_u32 s39, s39, 524288
s_mul_i32 s38, s32, 40960
s_add_u32 m0, s38, 32768
s_nop 0
buffer_load_dwordx4 v51, s[8:11], s39 offen lds
s_add_u32 m0, m0, 1024
s_add_u32 s39, s39, 65536
buffer_load_dwordx4 v51, s[8:11], s39 offen lds
s_add_u32 m0, m0, 1024
s_add_u32 s39, s39, 65536
buffer_load_dwordx4 v51, s[8:11], s39 offen lds
s_add_u32 m0, m0, 1024
s_add_u32 s39, s39, 65536
buffer_load_dwordx4 v51, s[8:11], s39 offen lds
s_add_u32 m0, m0, 1024
s_add_u32 s39, s39, 65536
buffer_load_dwordx4 v51, s[8:11], s39 offen lds
s_add_u32 m0, m0, 1024
s_add_u32 s39, s39, 65536
buffer_load_dwordx4 v51, s[8:11], s39 offen lds
s_add_u32 m0, m0, 1024
s_add_u32 s39, s39, 65536
buffer_load_dwordx4 v51, s[8:11], s39 offen lds
s_add_u32 m0, m0, 1024
s_add_u32 s39, s39, 65536
buffer_load_dwordx4 v51, s[8:11], s39 offen lds
s_waitcnt vmcnt(32)
v_min_u32 v58, -2, v58
v_min_u32 v59, -2, v59
buffer_store_dwordx2 v[58:59], v10, s[4:7], s45 offen sc1
ds_read_b64_tr_b16 a[96:97], v54 offset:0
ds_read_b64_tr_b16 a[98:99], v54 offset:256
ds_read_b64_tr_b16 a[100:101], v54 offset:4096
ds_read_b64_tr_b16 a[102:103], v54 offset:4352
ds_read_b64_tr_b16 a[104:105], v54 offset:16
ds_read_b64_tr_b16 a[106:107], v54 offset:272
ds_read_b64_tr_b16 a[108:109], v54 offset:4112
ds_read_b64_tr_b16 a[110:111], v54 offset:4368
ds_read_b64_tr_b16 a[112:113], v54 offset:64
ds_read_b64_tr_b16 a[114:115], v54 offset:320
ds_read_b64_tr_b16 a[116:117], v54 offset:4160
ds_read_b64_tr_b16 a[118:119], v54 offset:4416
ds_read_b64_tr_b16 a[120:121], v54 offset:80
ds_read_b64_tr_b16 a[122:123], v54 offset:336
ds_read_b64_tr_b16 a[124:125], v54 offset:4176
ds_read_b64_tr_b16 a[126:127], v54 offset:4432
s_waitcnt lgkmcnt(0)
s_mov_b32 s8, s22
s_and_b32 s9, s23, 0xffff
s_mov_b32 s10, 0x800000
s_mov_b32 s11, 0x20000
s_lshl_b32 s39, s32, 21
s_lshl_b32 s38, s33, 4
s_add_u32 s38, s38, s54
s_xor_b32 s38, s38, 2
s_lshl_b32 s38, s38, 7
s_add_u32 s39, s39, s38
s_add_u32 s39, s39, 524288
s_mul_i32 s38, s32, 40960
s_add_u32 m0, s38, 0
s_nop 0
buffer_load_dwordx4 v52, s[8:11], s39 offen lds
s_add_u32 m0, m0, 1024
s_add_u32 s39, s39, 65536
buffer_load_dwordx4 v52, s[8:11], s39 offen lds
s_add_u32 m0, m0, 1024
s_add_u32 s39, s39, 65536
buffer_load_dwordx4 v52, s[8:11], s39 offen lds
s_add_u32 m0, m0, 1024
s_add_u32 s39, s39, 65536
buffer_load_dwordx4 v52, s[8:11], s39 offen lds
s_add_u32 m0, m0, 1024
s_add_u32 s39, s39, 65536
buffer_load_dwordx4 v52, s[8:11], s39 offen lds
s_add_u32 m0, m0, 1024
s_add_u32 s39, s39, 65536
buffer_load_dwordx4 v52, s[8:11], s39 offen lds
s_add_u32 m0, m0, 1024
s_add_u32 s39, s39, 65536
buffer_load_dwordx4 v52, s[8:11], s39 offen lds
s_add_u32 m0, m0, 1024
s_add_u32 s39, s39, 65536
buffer_load_dwordx4 v52, s[8:11], s39 offen lds
s_waitcnt vmcnt(32)
ds_read_b64_tr_b16 v[224:225], v55 offset:8192
ds_read_b64_tr_b16 v[226:227], v55 offset:8448
ds_read_b64_tr_b16 v[228:229], v55 offset:12288
ds_read_b64_tr_b16 v[230:231], v55 offset:12544
ds_read_b64_tr_b16 v[232:233], v55 offset:8224
ds_read_b64_tr_b16 v[234:235], v55 offset:8480
ds_read_b64_tr_b16 v[236:237], v55 offset:12320
ds_read_b64_tr_b16 v[238:239], v55 offset:12576
ds_read_b64_tr_b16 v[240:241], v55 offset:8256
ds_read_b64_tr_b16 v[242:243], v55 offset:8512
ds_read_b64_tr_b16 v[244:245], v55 offset:12352
ds_read_b64_tr_b16 v[246:247], v55 offset:12608
ds_read_b64_tr_b16 v[248:249], v55 offset:8288
ds_read_b64_tr_b16 v[250:251], v55 offset:8544
ds_read_b64_tr_b16 v[252:253], v55 offset:12384
ds_read_b64_tr_b16 v[254:255], v55 offset:12640
s_waitcnt lgkmcnt(0)
s_mov_b32 s8, s20
s_and_b32 s9, s21, 0xffff
s_mov_b32 s10, 0x800000
s_mov_b32 s11, 0x20000
s_lshl_b32 s39, s32, 21
s_lshl_b32 s38, s33, 4
s_add_u32 s38, s38, s54
s_xor_b32 s38, s38, 4
s_lshl_b32 s38, s38, 7
s_add_u32 s39, s39, s38
s_add_u32 s39, s39, 0
s_mul_i32 s38, s32, 40960
s_add_u32 m0, s38, 8192
s_nop 0
buffer_load_dwordx4 v51, s[8:11], s39 offen lds
s_add_u32 m0, m0, 1024
s_add_u32 s39, s39, 65536
buffer_load_dwordx4 v51, s[8:11], s39 offen lds
s_add_u32 m0, m0, 1024
s_add_u32 s39, s39, 65536
buffer_load_dwordx4 v51, s[8:11], s39 offen lds
s_add_u32 m0, m0, 1024
s_add_u32 s39, s39, 65536
buffer_load_dwordx4 v51, s[8:11], s39 offen lds
s_add_u32 m0, m0, 1024
s_add_u32 s39, s39, 65536
buffer_load_dwordx4 v51, s[8:11], s39 offen lds
s_add_u32 m0, m0, 1024
s_add_u32 s39, s39, 65536
buffer_load_dwordx4 v51, s[8:11], s39 offen lds
s_add_u32 m0, m0, 1024
s_add_u32 s39, s39, 65536
buffer_load_dwordx4 v51, s[8:11], s39 offen lds
s_add_u32 m0, m0, 1024
s_add_u32 s39, s39, 65536
buffer_load_dwordx4 v51, s[8:11], s39 offen lds
s_waitcnt vmcnt(32)
ds_read_b64_tr_b16 a[64:65], v54 offset:16384
ds_read_b64_tr_b16 a[66:67], v54 offset:16640
ds_read_b64_tr_b16 a[68:69], v54 offset:20480
ds_read_b64_tr_b16 a[70:71], v54 offset:20736
ds_read_b64_tr_b16 a[72:73], v54 offset:16400
ds_read_b64_tr_b16 a[74:75], v54 offset:16656
ds_read_b64_tr_b16 a[76:77], v54 offset:20496
ds_read_b64_tr_b16 a[78:79], v54 offset:20752
ds_read_b64_tr_b16 a[80:81], v54 offset:16448
ds_read_b64_tr_b16 a[82:83], v54 offset:16704
ds_read_b64_tr_b16 a[84:85], v54 offset:20544
ds_read_b64_tr_b16 a[86:87], v54 offset:20800
ds_read_b64_tr_b16 a[88:89], v54 offset:16464
ds_read_b64_tr_b16 a[90:91], v54 offset:16720
ds_read_b64_tr_b16 a[92:93], v54 offset:20560
ds_read_b64_tr_b16 a[94:95], v54 offset:20816
s_waitcnt lgkmcnt(0)
s_mov_b32 s8, s22
s_and_b32 s9, s23, 0xffff
s_mov_b32 s10, 0x800000
s_mov_b32 s11, 0x20000
s_lshl_b32 s39, s32, 21
s_lshl_b32 s38, s33, 4
s_add_u32 s38, s38, s54
s_xor_b32 s38, s38, 2
s_lshl_b32 s38, s38, 7
s_add_u32 s39, s39, s38
s_add_u32 s39, s39, 0
s_mul_i32 s38, s32, 40960
s_add_u32 m0, s38, 16384
s_nop 0
buffer_load_dwordx4 v52, s[8:11], s39 offen lds
s_add_u32 m0, m0, 1024
s_add_u32 s39, s39, 65536
buffer_load_dwordx4 v52, s[8:11], s39 offen lds
s_add_u32 m0, m0, 1024
s_add_u32 s39, s39, 65536
buffer_load_dwordx4 v52, s[8:11], s39 offen lds
s_add_u32 m0, m0, 1024
s_add_u32 s39, s39, 65536
buffer_load_dwordx4 v52, s[8:11], s39 offen lds
s_add_u32 m0, m0, 1024
s_add_u32 s39, s39, 65536
buffer_load_dwordx4 v52, s[8:11], s39 offen lds
s_add_u32 m0, m0, 1024
s_add_u32 s39, s39, 65536
buffer_load_dwordx4 v52, s[8:11], s39 offen lds
s_add_u32 m0, m0, 1024
s_add_u32 s39, s39, 65536
buffer_load_dwordx4 v52, s[8:11], s39 offen lds
s_add_u32 m0, m0, 1024
s_add_u32 s39, s39, 65536
buffer_load_dwordx4 v52, s[8:11], s39 offen lds
s_waitcnt vmcnt(32)
ds_read_b64_tr_b16 v[192:193], v55 offset:24576
ds_read_b64_tr_b16 v[194:195], v55 offset:24832
ds_read_b64_tr_b16 v[196:197], v55 offset:28672
ds_read_b64_tr_b16 v[198:199], v55 offset:28928
ds_read_b64_tr_b16 v[200:201], v55 offset:24608
ds_read_b64_tr_b16 v[202:203], v55 offset:24864
ds_read_b64_tr_b16 v[204:205], v55 offset:28704
ds_read_b64_tr_b16 v[206:207], v55 offset:28960
ds_read_b64_tr_b16 v[208:209], v55 offset:24640
ds_read_b64_tr_b16 v[210:211], v55 offset:24896
ds_read_b64_tr_b16 v[212:213], v55 offset:28736
ds_read_b64_tr_b16 v[214:215], v55 offset:28992
ds_read_b64_tr_b16 v[216:217], v55 offset:24672
ds_read_b64_tr_b16 v[218:219], v55 offset:24928
ds_read_b64_tr_b16 v[220:221], v55 offset:28768
ds_read_b64_tr_b16 v[222:223], v55 offset:29024
s_waitcnt lgkmcnt(0)
s_mov_b32 s8, s24
s_and_b32 s9, s25, 0xffff
s_mov_b32 s10, 0x800000
s_mov_b32 s11, 0x20000
s_lshl_b32 s39, s33, 2
s_add_u32 s39, s39, s32
s_lshl_b32 s39, s39, 19
s_lshl_b32 s38, s54, 7
s_add_u32 s39, s39, s38
s_add_u32 s39, s39, 0
s_mul_i32 s38, s32, 40960
s_add_u32 m0, s38, 24576
s_nop 0
buffer_load_dwordx4 v53, s[8:11], s39 offen lds
s_add_u32 m0, m0, 1024
s_add_u32 s39, s39, 16384
buffer_load_dwordx4 v53, s[8:11], s39 offen lds
s_add_u32 m0, m0, 1024
s_add_u32 s39, s39, 16384
buffer_load_dwordx4 v53, s[8:11], s39 offen lds
s_add_u32 m0, m0, 1024
s_add_u32 s39, s39, 16384
buffer_load_dwordx4 v53, s[8:11], s39 offen lds
s_add_u32 m0, m0, 1024
s_add_u32 s39, s39, 16384
buffer_load_dwordx4 v53, s[8:11], s39 offen lds
s_add_u32 m0, m0, 1024
s_add_u32 s39, s39, 16384
buffer_load_dwordx4 v53, s[8:11], s39 offen lds
s_add_u32 m0, m0, 1024
s_add_u32 s39, s39, 16384
buffer_load_dwordx4 v53, s[8:11], s39 offen lds
s_add_u32 m0, m0, 1024
s_add_u32 s39, s39, 16384
buffer_load_dwordx4 v53, s[8:11], s39 offen lds
s_waitcnt vmcnt(32)
ds_read_b64_tr_b16 a[32:33], v54 offset:32768
ds_read_b64_tr_b16 a[34:35], v54 offset:33024
ds_read_b64_tr_b16 a[36:37], v54 offset:36864
ds_read_b64_tr_b16 a[38:39], v54 offset:37120
ds_read_b64_tr_b16 a[40:41], v54 offset:32784
ds_read_b64_tr_b16 a[42:43], v54 offset:33040
ds_read_b64_tr_b16 a[44:45], v54 offset:36880
ds_read_b64_tr_b16 a[46:47], v54 offset:37136
ds_read_b64_tr_b16 a[48:49], v54 offset:32832
ds_read_b64_tr_b16 a[50:51], v54 offset:33088
ds_read_b64_tr_b16 a[52:53], v54 offset:36928
ds_read_b64_tr_b16 a[54:55], v54 offset:37184
ds_read_b64_tr_b16 a[56:57], v54 offset:32848
ds_read_b64_tr_b16 a[58:59], v54 offset:33104
ds_read_b64_tr_b16 a[60:61], v54 offset:36944
ds_read_b64_tr_b16 a[62:63], v54 offset:37200
s_waitcnt lgkmcnt(0)
s_mov_b32 s8, s24
s_and_b32 s9, s25, 0xffff
s_mov_b32 s10, 0x800000
s_mov_b32 s11, 0x20000
s_lshl_b32 s39, s33, 2
s_add_u32 s39, s39, s32
s_lshl_b32 s39, s39, 19
s_lshl_b32 s38, s54, 7
s_add_u32 s39, s39, s38
s_add_u32 s39, s39, 131072
s_mul_i32 s38, s32, 40960
s_add_u32 m0, s38, 32768
s_nop 0
buffer_load_dwordx4 v53, s[8:11], s39 offen lds
s_add_u32 m0, m0, 1024
s_add_u32 s39, s39, 16384
buffer_load_dwordx4 v53, s[8:11], s39 offen lds
s_add_u32 m0, m0, 1024
s_add_u32 s39, s39, 16384
buffer_load_dwordx4 v53, s[8:11], s39 offen lds
s_add_u32 m0, m0, 1024
s_add_u32 s39, s39, 16384
buffer_load_dwordx4 v53, s[8:11], s39 offen lds
s_add_u32 m0, m0, 1024
s_add_u32 s39, s39, 16384
buffer_load_dwordx4 v53, s[8:11], s39 offen lds
s_add_u32 m0, m0, 1024
s_add_u32 s39, s39, 16384
buffer_load_dwordx4 v53, s[8:11], s39 offen lds
s_add_u32 m0, m0, 1024
s_add_u32 s39, s39, 16384
buffer_load_dwordx4 v53, s[8:11], s39 offen lds
s_add_u32 m0, m0, 1024
s_add_u32 s39, s39, 16384
buffer_load_dwordx4 v53, s[8:11], s39 offen lds
s_waitcnt vmcnt(32)
ds_read_b64_tr_b16 v[160:161], v55 offset:0
ds_read_b64_tr_b16 v[162:163], v55 offset:256
ds_read_b64_tr_b16 v[164:165], v55 offset:4096
ds_read_b64_tr_b16 v[166:167], v55 offset:4352
ds_read_b64_tr_b16 v[168:169], v55 offset:32
ds_read_b64_tr_b16 v[170:171], v55 offset:288
ds_read_b64_tr_b16 v[172:173], v55 offset:4128
ds_read_b64_tr_b16 v[174:175], v55 offset:4384
ds_read_b64_tr_b16 v[176:177], v55 offset:64
ds_read_b64_tr_b16 v[178:179], v55 offset:320
ds_read_b64_tr_b16 v[180:181], v55 offset:4160
ds_read_b64_tr_b16 v[182:183], v55 offset:4416
ds_read_b64_tr_b16 v[184:185], v55 offset:96
ds_read_b64_tr_b16 v[186:187], v55 offset:352
ds_read_b64_tr_b16 v[188:189], v55 offset:4192
ds_read_b64_tr_b16 v[190:191], v55 offset:4448
s_waitcnt lgkmcnt(0)
s_mov_b32 s8, s24
s_and_b32 s9, s25, 0xffff
s_mov_b32 s10, 0x800000
s_mov_b32 s11, 0x20000
s_lshl_b32 s39, s33, 2
s_add_u32 s39, s39, s32
s_lshl_b32 s39, s39, 19
s_lshl_b32 s38, s54, 7
s_add_u32 s39, s39, s38
s_add_u32 s39, s39, 262144
s_mul_i32 s38, s32, 40960
s_add_u32 m0, s38, 0
s_nop 0
buffer_load_dwordx4 v53, s[8:11], s39 offen lds
s_add_u32 m0, m0, 1024
s_add_u32 s39, s39, 16384
buffer_load_dwordx4 v53, s[8:11], s39 offen lds
s_add_u32 m0, m0, 1024
s_add_u32 s39, s39, 16384
buffer_load_dwordx4 v53, s[8:11], s39 offen lds
s_add_u32 m0, m0, 1024
s_add_u32 s39, s39, 16384
buffer_load_dwordx4 v53, s[8:11], s39 offen lds
s_add_u32 m0, m0, 1024
s_add_u32 s39, s39, 16384
buffer_load_dwordx4 v53, s[8:11], s39 offen lds
s_add_u32 m0, m0, 1024
s_add_u32 s39, s39, 16384
buffer_load_dwordx4 v53, s[8:11], s39 offen lds
s_add_u32 m0, m0, 1024
s_add_u32 s39, s39, 16384
buffer_load_dwordx4 v53, s[8:11], s39 offen lds
s_add_u32 m0, m0, 1024
s_add_u32 s39, s39, 16384
buffer_load_dwordx4 v53, s[8:11], s39 offen lds
s_waitcnt vmcnt(32)
ds_read_b64_tr_b16 a[0:1], v54 offset:8192
ds_read_b64_tr_b16 a[2:3], v54 offset:8448
ds_read_b64_tr_b16 a[4:5], v54 offset:12288
ds_read_b64_tr_b16 a[6:7], v54 offset:12544
ds_read_b64_tr_b16 a[8:9], v54 offset:8208
ds_read_b64_tr_b16 a[10:11], v54 offset:8464
ds_read_b64_tr_b16 a[12:13], v54 offset:12304
ds_read_b64_tr_b16 a[14:15], v54 offset:12560
ds_read_b64_tr_b16 a[16:17], v54 offset:8256
ds_read_b64_tr_b16 a[18:19], v54 offset:8512
ds_read_b64_tr_b16 a[20:21], v54 offset:12352
ds_read_b64_tr_b16 a[22:23], v54 offset:12608
ds_read_b64_tr_b16 a[24:25], v54 offset:8272
ds_read_b64_tr_b16 a[26:27], v54 offset:8528
ds_read_b64_tr_b16 a[28:29], v54 offset:12368
ds_read_b64_tr_b16 a[30:31], v54 offset:12624
s_waitcnt lgkmcnt(0)
s_mov_b32 s8, s24
s_and_b32 s9, s25, 0xffff
s_mov_b32 s10, 0x800000
s_mov_b32 s11, 0x20000
s_lshl_b32 s39, s33, 2
s_add_u32 s39, s39, s32
s_lshl_b32 s39, s39, 19
s_lshl_b32 s38, s54, 7
s_add_u32 s39, s39, s38
s_add_u32 s39, s39, 393216
s_mul_i32 s38, s32, 40960
s_add_u32 m0, s38, 8192
s_nop 0
buffer_load_dwordx4 v53, s[8:11], s39 offen lds
s_add_u32 m0, m0, 1024
s_add_u32 s39, s39, 16384
buffer_load_dwordx4 v53, s[8:11], s39 offen lds
s_add_u32 m0, m0, 1024
s_add_u32 s39, s39, 16384
buffer_load_dwordx4 v53, s[8:11], s39 offen lds
s_add_u32 m0, m0, 1024
s_add_u32 s39, s39, 16384
buffer_load_dwordx4 v53, s[8:11], s39 offen lds
s_add_u32 m0, m0, 1024
s_add_u32 s39, s39, 16384
buffer_load_dwordx4 v53, s[8:11], s39 offen lds
s_add_u32 m0, m0, 1024
s_add_u32 s39, s39, 16384
buffer_load_dwordx4 v53, s[8:11], s39 offen lds
s_add_u32 m0, m0, 1024
s_add_u32 s39, s39, 16384
buffer_load_dwordx4 v53, s[8:11], s39 offen lds
s_add_u32 m0, m0, 1024
s_add_u32 s39, s39, 16384
buffer_load_dwordx4 v53, s[8:11], s39 offen lds
s_waitcnt vmcnt(32)
ds_read_b64_tr_b16 v[128:129], v55 offset:16384
ds_read_b64_tr_b16 v[130:131], v55 offset:16640
ds_read_b64_tr_b16 v[132:133], v55 offset:20480
ds_read_b64_tr_b16 v[134:135], v55 offset:20736
ds_read_b64_tr_b16 v[136:137], v55 offset:16416
ds_read_b64_tr_b16 v[138:139], v55 offset:16672
ds_read_b64_tr_b16 v[140:141], v55 offset:20512
ds_read_b64_tr_b16 v[142:143], v55 offset:20768
ds_read_b64_tr_b16 v[144:145], v55 offset:16448
ds_read_b64_tr_b16 v[146:147], v55 offset:16704
ds_read_b64_tr_b16 v[148:149], v55 offset:20544
ds_read_b64_tr_b16 v[150:151], v55 offset:20800
ds_read_b64_tr_b16 v[152:153], v55 offset:16480
ds_read_b64_tr_b16 v[154:155], v55 offset:16736
ds_read_b64_tr_b16 v[156:157], v55 offset:20576
ds_read_b64_tr_b16 v[158:159], v55 offset:20832
s_waitcnt lgkmcnt(0)
s_waitcnt vmcnt(24)
ds_read_b64_tr_b16 a[128:129], v56 offset:24576
ds_read_b64_tr_b16 a[130:131], v56 offset:24832
ds_read_b64_tr_b16 a[132:133], v56 offset:28672
ds_read_b64_tr_b16 a[134:135], v56 offset:28928
ds_read_b64_tr_b16 a[136:137], v56 offset:24608
ds_read_b64_tr_b16 a[138:139], v56 offset:24864
ds_read_b64_tr_b16 a[140:141], v56 offset:28704
ds_read_b64_tr_b16 a[142:143], v56 offset:28960
ds_read_b64_tr_b16 a[144:145], v56 offset:24640
ds_read_b64_tr_b16 a[146:147], v56 offset:24896
ds_read_b64_tr_b16 a[148:149], v56 offset:28736
ds_read_b64_tr_b16 a[150:151], v56 offset:28992
ds_read_b64_tr_b16 a[152:153], v56 offset:24672
ds_read_b64_tr_b16 a[154:155], v56 offset:24928
ds_read_b64_tr_b16 a[156:157], v56 offset:28768
ds_read_b64_tr_b16 a[158:159], v56 offset:29024
s_waitcnt lgkmcnt(0)
s_waitcnt vmcnt(16)
ds_read_b64_tr_b16 a[160:161], v56 offset:32768
ds_read_b64_tr_b16 a[162:163], v56 offset:33024
ds_read_b64_tr_b16 a[164:165], v56 offset:36864
ds_read_b64_tr_b16 a[166:167], v56 offset:37120
ds_read_b64_tr_b16 a[168:169], v56 offset:32800
ds_read_b64_tr_b16 a[170:171], v56 offset:33056
ds_read_b64_tr_b16 a[172:173], v56 offset:36896
ds_read_b64_tr_b16 a[174:175], v56 offset:37152
ds_read_b64_tr_b16 a[176:177], v56 offset:32832
ds_read_b64_tr_b16 a[178:179], v56 offset:33088
ds_read_b64_tr_b16 a[180:181], v56 offset:36928
ds_read_b64_tr_b16 a[182:183], v56 offset:37184
ds_read_b64_tr_b16 a[184:185], v56 offset:32864
ds_read_b64_tr_b16 a[186:187], v56 offset:33120
ds_read_b64_tr_b16 a[188:189], v56 offset:36960
ds_read_b64_tr_b16 a[190:191], v56 offset:37216
s_waitcnt lgkmcnt(0)
s_waitcnt vmcnt(8)
ds_read_b64_tr_b16 a[192:193], v56 offset:0
ds_read_b64_tr_b16 a[194:195], v56 offset:256
ds_read_b64_tr_b16 a[196:197], v56 offset:4096
ds_read_b64_tr_b16 a[198:199], v56 offset:4352
ds_read_b64_tr_b16 a[200:201], v56 offset:32
ds_read_b64_tr_b16 a[202:203], v56 offset:288
ds_read_b64_tr_b16 a[204:205], v56 offset:4128
ds_read_b64_tr_b16 a[206:207], v56 offset:4384
ds_read_b64_tr_b16 a[208:209], v56 offset:64
ds_read_b64_tr_b16 a[210:211], v56 offset:320
ds_read_b64_tr_b16 a[212:213], v56 offset:4160
ds_read_b64_tr_b16 a[214:215], v56 offset:4416
ds_read_b64_tr_b16 a[216:217], v56 offset:96
ds_read_b64_tr_b16 a[218:219], v56 offset:352
ds_read_b64_tr_b16 a[220:221], v56 offset:4192
ds_read_b64_tr_b16 a[222:223], v56 offset:4448
s_waitcnt lgkmcnt(0)
s_waitcnt vmcnt(0)
ds_read_b64_tr_b16 a[224:225], v56 offset:8192
ds_read_b64_tr_b16 a[226:227], v56 offset:8448
ds_read_b64_tr_b16 a[228:229], v56 offset:12288
ds_read_b64_tr_b16 a[230:231], v56 offset:12544
ds_read_b64_tr_b16 a[232:233], v56 offset:8224
ds_read_b64_tr_b16 a[234:235], v56 offset:8480
ds_read_b64_tr_b16 a[236:237], v56 offset:12320
ds_read_b64_tr_b16 a[238:239], v56 offset:12576
ds_read_b64_tr_b16 a[240:241], v56 offset:8256
ds_read_b64_tr_b16 a[242:243], v56 offset:8512
ds_read_b64_tr_b16 a[244:245], v56 offset:12352
ds_read_b64_tr_b16 a[246:247], v56 offset:12608
ds_read_b64_tr_b16 a[248:249], v56 offset:8288
ds_read_b64_tr_b16 a[250:251], v56 offset:8544
ds_read_b64_tr_b16 a[252:253], v56 offset:12384
ds_read_b64_tr_b16 a[254:255], v56 offset:12640
s_waitcnt lgkmcnt(0)
Lst_272:
buffer_load_dword v48, off, s[12:15], 0 offset:32 sc1
buffer_load_dword v49, off, s[12:15], 0 offset:160 sc1
s_waitcnt vmcnt(0)
v_add_u32 v48, v48, v49
s_nop 0
v_readfirstlane_b32 s38, v48
s_nop 3
s_and_b32 s39, s38, 0x200ffff
s_cmp_eq_u32 s39, 0x2000100
s_cbranch_scc1 Lso_273
s_sub_u32 s37, s37, 1
s_cbranch_scc1 Lend_1
s_sleep 8
s_branch Lst_272
Lso_273:
s_bfe_u32 s35, s38, 0x80010
s_bfe_u32 s46, s38, 0x10018
s_lshl_b32 s46, s46, 13
s_barrier
s_lshl_b32 s38, s54, 14
s_add_u32 s38, s38, s45
buffer_load_dwordx4 v[28:31], v8, s[4:7], s38 offen offset:0 sc1
buffer_load_dwordx4 v[32:35], v8, s[4:7], s38 offen offset:1024 sc1
buffer_load_dwordx4 v[36:39], v8, s[4:7], s38 offen offset:2048 sc1
buffer_load_dwordx4 v[40:43], v8, s[4:7], s38 offen offset:3072 sc1
v_mov_b32 v44, 0
v_mov_b32 v45, 0
v_mov_b32 v46, 0
v_mov_b32 v47, 0
v_mov_b32 v48, 0
v_mov_b32 v49, 0
v_mov_b32 v50, 0
v_mov_b32 v51, 0
v_mov_b32 v52, 0
v_mov_b32 v53, 0
v_mov_b32 v54, 0
v_mov_b32 v55, 0
v_mov_b32 v56, 0
v_mov_b32 v57, 0
v_mov_b32 v58, 0
v_mov_b32 v59, 0
v_mov_b32 v60, 0
v_mov_b32 v61, 0
v_mov_b32 v62, 0
v_mov_b32 v63, 0
v_mov_b32 v64, 0
v_mov_b32 v65, 0
v_mov_b32 v66, 0
v_mov_b32 v67, 0
v_mov_b32 v68, 0
v_mov_b32 v69, 0
v_mov_b32 v70, 0
v_mov_b32 v71, 0
v_mov_b32 v72, 0
v_mov_b32 v73, 0
v_mov_b32 v74, 0
v_mov_b32 v75, 0
v_mov_b32 v76, 0
v_mov_b32 v77, 0
v_mov_b32 v78, 0
v_mov_b32 v79, 0
v_mov_b32 v80, 0
v_mov_b32 v81, 0
v_mov_b32 v82, 0
v_mov_b32 v83, 0
v_mov_b32 v84, 0
v_mov_b32 v85, 0
v_mov_b32 v86, 0
v_mov_b32 v87, 0
v_mov_b32 v88, 0
v_mov_b32 v89, 0
v_mov_b32 v90, 0
v_mov_b32 v91, 0
s_mov_b32 s36, 0
s_and_b32 s38, s36, 3
s_lshl_b32 s39, s38, 16
s_add_u32 s40, s39, s45
s_xor_b32 s42, s40, 0x20000
s_add_u32 s26, s36, 1
s_cmp_lg_u32 s35, 0
s_cbranch_scc1 Lkvo_sc1_274
Lkvo_275:
buffer_load_dwordx4 v[28:31], v8, s[4:7], s40 offen offset:0 sc1
v_mfma_f32_16x16x32_bf16 v[16:19], v[20:23], v[20:23], 0
v_mfma_f32_16x16x32_bf16 v[16:19], v[20:23], v[20:23], 0
v_mfma_f32_16x16x32_bf16 v[16:19], v[20:23], v[20:23], 0
buffer_load_dwordx4 v[32:35], v8, s[4:7], s40 offen offset:1024 sc1
v_mfma_f32_16x16x32_bf16 v[16:19], v[20:23], v[20:23], 0
v_mfma_f32_16x16x32_bf16 v[16:19], v[20:23], v[20:23], 0
v_mfma_f32_16x16x32_bf16 v[16:19], v[20:23], v[20:23], 0
buffer_load_dwordx4 v[36:39], v8, s[4:7], s40 offen offset:2048 sc1
v_mfma_f32_16x16x32_bf16 v[16:19], v[20:23], v[20:23], 0
v_mfma_f32_16x16x32_bf16 v[16:19], v[20:23], v[20:23], 0
v_mfma_f32_16x16x32_bf16 v[16:19], v[20:23], v[20:23], 0
buffer_load_dwordx4 v[40:43], v8, s[4:7], s40 offen offset:3072 sc1
v_mfma_f32_16x16x32_bf16 v[16:19], v[20:23], v[20:23], 0
v_mfma_f32_16x16x32_bf16 v[16:19], v[20:23], v[20:23], 0
v_mfma_f32_16x16x32_bf16 v[16:19], v[20:23], v[20:23], 0
s_waitcnt vmcnt(3)
v_max3_u32 v110, v28, v29, v30
v_max_u32 v110, v110, v31
v_cmp_eq_u32 vcc, -1, v110
s_cbranch_vccnz Lpf_277
v_smfmac_f32_16x16x64_bf16 v[44:47], v[28:31], a[0:7], v126
v_smfmac_f32_16x16x64_bf16 v[48:51], v[28:31], a[8:15], v126
s_waitcnt vmcnt(2)
v_max3_u32 v110, v32, v33, v34
v_max_u32 v110, v110, v35
v_cmp_eq_u32 vcc, -1, v110
v_smfmac_f32_16x16x64_bf16 v[52:55], v[28:31], a[16:23], v126
v_smfmac_f32_16x16x64_bf16 v[60:63], v[28:31], v[128:135], v126
s_cbranch_vccnz Lpf_278
v_smfmac_f32_16x16x64_bf16 v[44:47], v[32:35], a[32:39], v126
v_smfmac_f32_16x16x64_bf16 v[48:51], v[32:35], a[40:47], v126
s_waitcnt vmcnt(1)
v_max3_u32 v110, v36, v37, v38
v_max_u32 v110, v110, v39
v_cmp_eq_u32 vcc, -1, v110
v_smfmac_f32_16x16x64_bf16 v[52:55], v[32:35], a[48:55], v126
v_smfmac_f32_16x16x64_bf16 v[60:63], v[32:35], v[160:167], v126
s_cbranch_vccnz Lpf_279
v_smfmac_f32_16x16x64_bf16 v[44:47], v[36:39], a[64:71], v126
v_smfmac_f32_16x16x64_bf16 v[48:51], v[36:39], a[72:79], v126
s_waitcnt vmcnt(0)
v_max3_u32 v110, v40, v41, v42
v_max_u32 v110, v110, v43
v_cmp_eq_u32 vcc, -1, v110
v_smfmac_f32_16x16x64_bf16 v[52:55], v[36:39], a[80:87], v126
v_smfmac_f32_16x16x64_bf16 v[60:63], v[36:39], v[192:199], v126
s_cbranch_vccnz Lpf_280
v_smfmac_f32_16x16x64_bf16 v[44:47], v[40:43], a[96:103], v126
s_nop 1
v_smfmac_f32_16x16x64_bf16 v[48:51], v[40:43], a[104:111], v126
s_nop 1
v_smfmac_f32_16x16x64_bf16 v[52:55], v[40:43], a[112:119], v126
s_nop 1
v_add_f32 v92, v44, v46
v_add_f32 v93, v45, v47
v_smfmac_f32_16x16x64_bf16 v[56:59], v[28:31], a[24:31], v126
v_add_f32 v94, v48, v50
v_add_f32 v95, v49, v51
ds_write_b64 v24, v[92:93] offset:0
v_add_f32 v96, v52, v54
v_add_f32 v97, v53, v55
ds_write_b64 v25, v[94:95] offset:0
v_smfmac_f32_16x16x64_bf16 v[56:59], v[32:35], a[56:63], v126
ds_write_b64 v26, v[96:97] offset:0
v_smfmac_f32_16x16x64_bf16 v[56:59], v[36:39], a[88:95], v126
v_smfmac_f32_16x16x64_bf16 v[56:59], v[40:43], a[120:127], v126
v_smfmac_f32_16x16x64_bf16 v[60:63], v[40:43], v[224:231], v126
Lpd_276:
v_smfmac_f32_16x16x64_bf16 v[64:67], v[28:31], v[136:143], v126
v_smfmac_f32_16x16x64_bf16 v[64:67], v[32:35], v[168:175], v126
s_waitcnt lgkmcnt(0)
s_barrier
ds_read_b64 v[100:101], v0 offset:0
ds_read_b64 v[102:103], v0 offset:512
ds_read_b64 v[104:105], v0 offset:1024
s_nop 2
v_add_f32 v98, v56, v58
v_add_f32 v99, v57, v59
v_smfmac_f32_16x16x64_bf16 v[64:67], v[36:39], v[200:207], v126
v_smfmac_f32_16x16x64_bf16 v[64:67], v[40:43], v[232:239], v126
v_smfmac_f32_16x16x64_bf16 v[68:71], v[28:31], v[144:151], v126
v_smfmac_f32_16x16x64_bf16 v[68:71], v[32:35], v[176:183], v126
s_waitcnt lgkmcnt(0)
v_add_f32 v100, v100, v98
v_add_f32 v102, v102, v104
v_add_f32 v101, v101, v99
v_add_f32 v103, v103, v105
v_add_f32 v100, v100, v102
v_add_f32 v101, v101, v103
v_cvt_pk_bf16_f32 v108, v100, v101
s_nop 1
v_mov_b32_dpp v109, v108 quad_perm:[1,0,3,2] row_mask:0xf bank_mask:0xf
v_perm_b32 v109, v109, v108, v3
buffer_store_dword v109, v11, s[4:7], s40 offen
v_smfmac_f32_16x16x64_bf16 v[68:71], v[36:39], v[208:215], v126
v_smfmac_f32_16x16x64_bf16 v[68:71], v[40:43], v[240:247], v126
s_nop 3
v_smfmac_f32_16x16x64_bf16 v[72:75], v[28:31], v[152:159], v126
v_add_f32 v92, v60, v62
v_add_f32 v93, v61, v63
v_smfmac_f32_16x16x64_bf16 v[72:75], v[32:35], v[184:191], v126
v_add_f32 v94, v64, v66
v_add_f32 v95, v65, v67
ds_write_b64 v24, v[92:93] offset:6144
v_smfmac_f32_16x16x64_bf16 v[72:75], v[36:39], v[216:223], v126
v_add_f32 v96, v68, v70
v_add_f32 v97, v69, v71
ds_write_b64 v25, v[94:95] offset:6144
ds_write_b64 v26, v[96:97] offset:6144
v_smfmac_f32_16x16x64_bf16 v[72:75], v[40:43], v[248:255], v126
s_waitcnt lgkmcnt(0)
s_barrier
ds_read_b64 v[100:101], v0 offset:6144
ds_read_b64 v[102:103], v0 offset:6656
ds_read_b64 v[104:105], v0 offset:7168
s_nop 2
v_add_f32 v98, v72, v74
v_add_f32 v99, v73, v75
s_waitcnt lgkmcnt(0)
v_pk_add_f32 v[100:101], v[100:101], v[98:99]
v_pk_add_f32 v[102:103], v[102:103], v[104:105]
v_pk_add_f32 v[100:101], v[100:101], v[102:103]
v_cvt_pk_bf16_f32 v108, v100, v101
buffer_store_dword v108, v27, s[4:7], s40 offen
s_cmp_eq_u32 s36, 63
s_cbranch_scc1 Lend_1
v_add_u32 v7, 1, v7
s_and_b32 s38, s36, 3
s_lshl_b32 s84, s38, 18
s_add_u32 s84, s84, s46
s_add_u32 s85, s84, 0x100000
s_mov_b64 exec, 3
buffer_load_dword v112, v1, s[4:7], s59 offen sc1
s_nop 5
buffer_load_dword v113, v1, s[4:7], s59 offen sc1
s_nop 5
buffer_load_dword v114, v1, s[4:7], s59 offen sc1
Lft_282:
s_waitcnt vmcnt(2)
v_cmp_gt_u32 vcc, s26, v112
buffer_load_dword v112, v1, s[4:7], s59 offen sc1
s_cbranch_vccz Lfg_281
s_waitcnt vmcnt(2)
v_cmp_gt_u32 vcc, s26, v113
buffer_load_dword v113, v1, s[4:7], s59 offen sc1
s_cbranch_vccz Lfg_281
s_waitcnt vmcnt(2)
v_cmp_gt_u32 vcc, s26, v114
buffer_load_dword v114, v1, s[4:7], s59 offen sc1
s_cbranch_vccz Lfg_281
s_sub_u32 s37, s37, 1
s_cbranch_scc1 Lend_1
s_branch Lft_282
Lfg_281:
s_mov_b64 exec, -1
buffer_load_dwordx4 v[28:31], v9, s[4:7], s40 offen offset:0 sc1
v_mfma_f32_16x16x32_bf16 v[16:19], v[20:23], v[20:23], 0
v_mfma_f32_16x16x32_bf16 v[16:19], v[20:23], v[20:23], 0
v_mfma_f32_16x16x32_bf16 v[16:19], v[20:23], v[20:23], 0
buffer_load_dwordx4 v[32:35], v9, s[4:7], s40 offen offset:1024 sc1
v_mfma_f32_16x16x32_bf16 v[16:19], v[20:23], v[20:23], 0
v_mfma_f32_16x16x32_bf16 v[16:19], v[20:23], v[20:23], 0
v_mfma_f32_16x16x32_bf16 v[16:19], v[20:23], v[20:23], 0
buffer_load_dwordx4 v[36:39], v9, s[4:7], s40 offen offset:2048 sc1
v_mfma_f32_16x16x32_bf16 v[16:19], v[20:23], v[20:23], 0
v_mfma_f32_16x16x32_bf16 v[16:19], v[20:23], v[20:23], 0
v_mfma_f32_16x16x32_bf16 v[16:19], v[20:23], v[20:23], 0
buffer_load_dwordx4 v[40:43], v9, s[4:7], s40 offen offset:3072 sc1
v_mfma_f32_16x16x32_bf16 v[16:19], v[20:23], v[20:23], 0
v_mfma_f32_16x16x32_bf16 v[16:19], v[20:23], v[20:23], 0
v_mfma_f32_16x16x32_bf16 v[16:19], v[20:23], v[20:23], 0
s_waitcnt vmcnt(3)
v_max3_u32 v110, v28, v29, v30
v_max_u32 v110, v110, v31
v_cmp_eq_u32 vcc, -1, v110
s_cbranch_vccnz Lpf_284
v_smfmac_f32_16x16x64_bf16 v[76:79], v[28:31], a[128:135], v126
s_waitcnt vmcnt(2)
v_max3_u32 v110, v32, v33, v34
v_max_u32 v110, v110, v35
v_cmp_eq_u32 vcc, -1, v110
v_smfmac_f32_16x16x64_bf16 v[80:83], v[28:31], a[136:143], v126
v_smfmac_f32_16x16x64_bf16 v[84:87], v[28:31], a[144:151], v126
s_cbranch_vccnz Lpf_285
v_smfmac_f32_16x16x64_bf16 v[76:79], v[32:35], a[160:167], v126
s_waitcnt vmcnt(1)
v_max3_u32 v110, v36, v37, v38
v_max_u32 v110, v110, v39
v_cmp_eq_u32 vcc, -1, v110
v_smfmac_f32_16x16x64_bf16 v[80:83], v[32:35], a[168:175], v126
v_smfmac_f32_16x16x64_bf16 v[84:87], v[32:35], a[176:183], v126
s_cbranch_vccnz Lpf_286
v_smfmac_f32_16x16x64_bf16 v[76:79], v[36:39], a[192:199], v126
s_waitcnt vmcnt(0)
v_max3_u32 v110, v40, v41, v42
v_max_u32 v110, v110, v43
v_cmp_eq_u32 vcc, -1, v110
v_smfmac_f32_16x16x64_bf16 v[80:83], v[36:39], a[200:207], v126
v_smfmac_f32_16x16x64_bf16 v[84:87], v[36:39], a[208:215], v126
s_cbranch_vccnz Lpf_287
v_smfmac_f32_16x16x64_bf16 v[76:79], v[40:43], a[224:231], v126
s_nop 1
v_smfmac_f32_16x16x64_bf16 v[80:83], v[40:43], a[232:239], v126
s_nop 1
v_smfmac_f32_16x16x64_bf16 v[84:87], v[40:43], a[240:247], v126
s_nop 1
v_add_f32 v92, v76, v78
v_add_f32 v93, v77, v79
v_smfmac_f32_16x16x64_bf16 v[88:91], v[28:31], a[152:159], v126
v_add_f32 v94, v80, v82
v_add_f32 v95, v81, v83
ds_write_b64 v24, v[92:93] offset:12288
v_add_f32 v96, v84, v86
v_add_f32 v97, v85, v87
ds_write_b64 v25, v[94:95] offset:12288
v_smfmac_f32_16x16x64_bf16 v[88:91], v[32:35], a[184:191], v126
ds_write_b64 v26, v[96:97] offset:12288
v_smfmac_f32_16x16x64_bf16 v[88:91], v[36:39], a[216:223], v126
v_smfmac_f32_16x16x64_bf16 v[88:91], v[40:43], a[248:255], v126
Lpd_283:
s_waitcnt lgkmcnt(0)
s_barrier
ds_read_b64 v[100:101], v0 offset:12288
ds_read_b64 v[102:103], v0 offset:12800
ds_read_b64 v[104:105], v0 offset:13312
s_nop 2
v_add_f32 v98, v88, v90
v_add_f32 v99, v89, v91
s_waitcnt lgkmcnt(0)
v_pk_add_f32 v[100:101], v[100:101], v[98:99]
v_pk_add_f32 v[102:103], v[102:103], v[104:105]
v_pk_add_f32 v[100:101], v[100:101], v[102:103]
v_cvt_pk_bf16_f32 v108, v100, v101
buffer_store_dword v108, v12, s[4:7], s84 offen sc1
buffer_store_dword v108, v12, s[4:7], s85 offen sc1
buffer_store_dwordx2 v[4:5], v10, s[4:7], s42 offen
buffer_store_dword v4, v11, s[4:7], s42 offen
buffer_store_dword v4, v27, s[4:7], s42 offen
v_mov_b32 v112, v108
v_mov_b32 v116, v108
v_mov_b32 v120, v108
s_add_u32 s36, s36, 1
s_and_b32 s38, s36, 3
s_lshl_b32 s39, s38, 16
s_add_u32 s40, s39, s45
s_xor_b32 s42, s40, 0x20000
s_add_u32 s26, s36, 1
s_nop 15
s_nop 15
s_nop 15
s_nop 15
s_nop 3
buffer_load_dword v113, v13, s[4:7], s84 offen sc1
buffer_load_dword v114, v14, s[4:7], s84 offen sc1
buffer_load_dword v115, v15, s[4:7], s84 offen sc1
v_pk_mul_f32 v[44:45], 0, 0
v_pk_mul_f32 v[46:47], 0, 0
v_pk_mul_f32 v[48:49], 0, 0
v_pk_mul_f32 v[50:51], 0, 0
v_pk_mul_f32 v[52:53], 0, 0
v_pk_mul_f32 v[54:55], 0, 0
v_pk_mul_f32 v[56:57], 0, 0
v_pk_mul_f32 v[58:59], 0, 0
v_pk_mul_f32 v[60:61], 0, 0
v_pk_mul_f32 v[62:63], 0, 0
v_pk_mul_f32 v[64:65], 0, 0
v_pk_mul_f32 v[66:67], 0, 0
v_pk_mul_f32 v[68:69], 0, 0
v_pk_mul_f32 v[70:71], 0, 0
v_pk_mul_f32 v[72:73], 0, 0
v_pk_mul_f32 v[74:75], 0, 0
v_pk_mul_f32 v[76:77], 0, 0
v_pk_mul_f32 v[78:79], 0, 0
v_pk_mul_f32 v[80:81], 0, 0
v_pk_mul_f32 v[82:83], 0, 0
v_pk_mul_f32 v[84:85], 0, 0
v_pk_mul_f32 v[86:87], 0, 0
v_pk_mul_f32 v[88:89], 0, 0
v_pk_mul_f32 v[90:91], 0, 0
buffer_store_dword v7, v2, s[4:7], s59 offen
buffer_load_dword v117, v13, s[4:7], s85 offen sc1
buffer_load_dword v118, v14, s[4:7], s85 offen sc1
buffer_load_dword v119, v15, s[4:7], s85 offen sc1
s_nop 15
s_nop 15
s_nop 15
buffer_load_dword v121, v13, s[4:7], s84 offen sc1
buffer_load_dword v122, v14, s[4:7], s84 offen sc1
buffer_load_dword v123, v15, s[4:7], s84 offen sc1
v_mfma_f32_16x16x32_bf16 v[16:19], v[20:23], v[20:23], 0
v_mfma_f32_16x16x32_bf16 v[16:19], v[20:23], v[20:23], 0
v_mfma_f32_16x16x32_bf16 v[16:19], v[20:23], v[20:23], 0
v_mfma_f32_16x16x32_bf16 v[16:19], v[20:23], v[20:23], 0
s_waitcnt vmcnt(7)
v_mfma_f32_16x16x32_bf16 v[100:103], v[112:115], v[20:23], 0
v_max3_u32 v110, v113, v114, v115
v_cmp_eq_u32 vcc, -1, v110
s_nop 5
v_cvt_pk_bf16_f32 v106, v100, v101
v_cvt_pk_bf16_f32 v107, v102, v103
s_cbranch_vccnz Lx2_288
Lxs_289:
buffer_store_dwordx2 v[106:107], v10, s[4:7], s40 offen
s_nop 15
s_nop 15
s_nop 11
s_branch Lkvo_275
Lx2_288:
buffer_load_dword v113, v13, s[4:7], s85 offen sc1
buffer_load_dword v114, v14, s[4:7], s85 offen sc1
buffer_load_dword v115, v15, s[4:7], s85 offen sc1
s_waitcnt vmcnt(6)
v_mfma_f32_16x16x32_bf16 v[100:103], v[116:119], v[20:23], 0
v_max3_u32 v110, v117, v118, v119
v_cmp_eq_u32 vcc, -1, v110
s_nop 5
v_cvt_pk_bf16_f32 v106, v100, v101
v_cvt_pk_bf16_f32 v107, v102, v103
s_cbranch_vccz Lxs_289
buffer_load_dword v117, v13, s[4:7], s84 offen sc1
buffer_load_dword v118, v14, s[4:7], s84 offen sc1
buffer_load_dword v119, v15, s[4:7], s84 offen sc1
s_waitcnt vmcnt(6)
v_mfma_f32_16x16x32_bf16 v[100:103], v[120:123], v[20:23], 0
v_max3_u32 v110, v121, v122, v123
v_cmp_eq_u32 vcc, -1, v110
s_nop 5
v_cvt_pk_bf16_f32 v106, v100, v101
v_cvt_pk_bf16_f32 v107, v102, v103
s_cbranch_vccz Lxs_289
buffer_load_dword v121, v13, s[4:7], s85 offen sc1
buffer_load_dword v122, v14, s[4:7], s85 offen sc1
buffer_load_dword v123, v15, s[4:7], s85 offen sc1
s_waitcnt vmcnt(6)
v_mfma_f32_16x16x32_bf16 v[100:103], v[112:115], v[20:23], 0
v_max3_u32 v110, v113, v114, v115
v_cmp_eq_u32 vcc, -1, v110
s_nop 5
v_cvt_pk_bf16_f32 v106, v100, v101
v_cvt_pk_bf16_f32 v107, v102, v103
s_cbranch_vccz Lxs_289
buffer_load_dword v113, v13, s[4:7], s84 offen sc1
buffer_load_dword v114, v14, s[4:7], s84 offen sc1
buffer_load_dword v115, v15, s[4:7], s84 offen sc1
s_waitcnt vmcnt(6)
v_mfma_f32_16x16x32_bf16 v[100:103], v[116:119], v[20:23], 0
v_max3_u32 v110, v117, v118, v119
v_cmp_eq_u32 vcc, -1, v110
s_nop 5
v_cvt_pk_bf16_f32 v106, v100, v101
v_cvt_pk_bf16_f32 v107, v102, v103
s_cbranch_vccz Lxs_289
buffer_load_dword v117, v13, s[4:7], s85 offen sc1
buffer_load_dword v118, v14, s[4:7], s85 offen sc1
buffer_load_dword v119, v15, s[4:7], s85 offen sc1
s_waitcnt vmcnt(6)
v_mfma_f32_16x16x32_bf16 v[100:103], v[120:123], v[20:23], 0
v_max3_u32 v110, v121, v122, v123
v_cmp_eq_u32 vcc, -1, v110
s_nop 5
v_cvt_pk_bf16_f32 v106, v100, v101
v_cvt_pk_bf16_f32 v107, v102, v103
s_cbranch_vccz Lxs_289
buffer_load_dword v121, v13, s[4:7], s84 offen sc1
buffer_load_dword v122, v14, s[4:7], s84 offen sc1
buffer_load_dword v123, v15, s[4:7], s84 offen sc1
s_waitcnt vmcnt(6)
v_mfma_f32_16x16x32_bf16 v[100:103], v[112:115], v[20:23], 0
v_max3_u32 v110, v113, v114, v115
v_cmp_eq_u32 vcc, -1, v110
s_nop 5
v_cvt_pk_bf16_f32 v106, v100, v101
v_cvt_pk_bf16_f32 v107, v102, v103
s_cbranch_vccz Lxs_289
s_sub_u32 s37, s37, 1
s_cbranch_scc1 Lend_1
s_branch Lx2_288
Lpf_277:
buffer_load_dwordx4 v[28:31], v8, s[4:7], s40 offen offset:0 sc1
s_sub_u32 s37, s37, 1
s_cbranch_scc1 Lend_1
Lps_290:
s_waitcnt vmcnt(3)
v_max3_u32 v110, v32, v33, v34
v_max_u32 v110, v110, v35
v_cmp_eq_u32 vcc, -1, v110
s_cbranch_vccnz Lpf_291
v_smfmac_f32_16x16x64_bf16 v[44:47], v[32:35], a[32:39], v126
v_smfmac_f32_16x16x64_bf16 v[48:51], v[32:35], a[40:47], v126
v_smfmac_f32_16x16x64_bf16 v[52:55], v[32:35], a[48:55], v126
v_smfmac_f32_16x16x64_bf16 v[60:63], v[32:35], v[160:167], v126
Lps_292:
s_waitcnt vmcnt(2)
v_max3_u32 v110, v36, v37, v38
v_max_u32 v110, v110, v39
v_cmp_eq_u32 vcc, -1, v110
s_cbranch_vccnz Lpf_293
v_smfmac_f32_16x16x64_bf16 v[44:47], v[36:39], a[64:71], v126
v_smfmac_f32_16x16x64_bf16 v[48:51], v[36:39], a[72:79], v126
v_smfmac_f32_16x16x64_bf16 v[52:55], v[36:39], a[80:87], v126
v_smfmac_f32_16x16x64_bf16 v[60:63], v[36:39], v[192:199], v126
Lps_294:
s_waitcnt vmcnt(1)
v_max3_u32 v110, v40, v41, v42
v_max_u32 v110, v110, v43
v_cmp_eq_u32 vcc, -1, v110
s_cbranch_vccnz Lpf_295
v_smfmac_f32_16x16x64_bf16 v[44:47], v[40:43], a[96:103], v126
v_smfmac_f32_16x16x64_bf16 v[48:51], v[40:43], a[104:111], v126
v_smfmac_f32_16x16x64_bf16 v[52:55], v[40:43], a[112:119], v126
v_smfmac_f32_16x16x64_bf16 v[60:63], v[40:43], v[224:231], v126
Lps_296:
s_waitcnt vmcnt(0)
v_max3_u32 v110, v28, v29, v30
v_max_u32 v110, v110, v31
v_cmp_eq_u32 vcc, -1, v110
s_cbranch_vccnz Lpf_297
v_smfmac_f32_16x16x64_bf16 v[44:47], v[28:31], a[0:7], v126
s_nop 1
v_smfmac_f32_16x16x64_bf16 v[48:51], v[28:31], a[8:15], v126
s_nop 1
v_smfmac_f32_16x16x64_bf16 v[52:55], v[28:31], a[16:23], v126
s_nop 1
v_add_f32 v92, v44, v46
v_add_f32 v93, v45, v47
v_smfmac_f32_16x16x64_bf16 v[56:59], v[28:31], a[24:31], v126
v_add_f32 v94, v48, v50
v_add_f32 v95, v49, v51
ds_write_b64 v24, v[92:93] offset:0
v_add_f32 v96, v52, v54
v_add_f32 v97, v53, v55
ds_write_b64 v25, v[94:95] offset:0
v_smfmac_f32_16x16x64_bf16 v[56:59], v[32:35], a[56:63], v126
ds_write_b64 v26, v[96:97] offset:0
v_smfmac_f32_16x16x64_bf16 v[56:59], v[36:39], a[88:95], v126
v_smfmac_f32_16x16x64_bf16 v[56:59], v[40:43], a[120:127], v126
v_smfmac_f32_16x16x64_bf16 v[60:63], v[28:31], v[128:135], v126
s_branch Lpd_276
Lpf_278:
buffer_load_dwordx4 v[32:35], v8, s[4:7], s40 offen offset:1024 sc1
s_sub_u32 s37, s37, 1
s_cbranch_scc1 Lend_1
Lps_298:
s_waitcnt vmcnt(2)
v_max3_u32 v110, v36, v37, v38
v_max_u32 v110, v110, v39
v_cmp_eq_u32 vcc, -1, v110
s_cbranch_vccnz Lpf_299
v_smfmac_f32_16x16x64_bf16 v[44:47], v[36:39], a[64:71], v126
v_smfmac_f32_16x16x64_bf16 v[48:51], v[36:39], a[72:79], v126
v_smfmac_f32_16x16x64_bf16 v[52:55], v[36:39], a[80:87], v126
v_smfmac_f32_16x16x64_bf16 v[60:63], v[36:39], v[192:199], v126
Lps_300:
s_waitcnt vmcnt(1)
v_max3_u32 v110, v40, v41, v42
v_max_u32 v110, v110, v43
v_cmp_eq_u32 vcc, -1, v110
s_cbranch_vccnz Lpf_301
v_smfmac_f32_16x16x64_bf16 v[44:47], v[40:43], a[96:103], v126
v_smfmac_f32_16x16x64_bf16 v[48:51], v[40:43], a[104:111], v126
v_smfmac_f32_16x16x64_bf16 v[52:55], v[40:43], a[112:119], v126
v_smfmac_f32_16x16x64_bf16 v[60:63], v[40:43], v[224:231], v126
Lps_302:
s_waitcnt vmcnt(0)
v_max3_u32 v110, v32, v33, v34
v_max_u32 v110, v110, v35
v_cmp_eq_u32 vcc, -1, v110
s_cbranch_vccnz Lpf_303
v_smfmac_f32_16x16x64_bf16 v[44:47], v[32:35], a[32:39], v126
s_nop 1
v_smfmac_f32_16x16x64_bf16 v[48:51], v[32:35], a[40:47], v126
s_nop 1
v_smfmac_f32_16x16x64_bf16 v[52:55], v[32:35], a[48:55], v126
s_nop 1
v_add_f32 v92, v44, v46
v_add_f32 v93, v45, v47
v_smfmac_f32_16x16x64_bf16 v[56:59], v[28:31], a[24:31], v126
v_add_f32 v94, v48, v50
v_add_f32 v95, v49, v51
ds_write_b64 v24, v[92:93] offset:0
v_add_f32 v96, v52, v54
v_add_f32 v97, v53, v55
ds_write_b64 v25, v[94:95] offset:0
v_smfmac_f32_16x16x64_bf16 v[56:59], v[32:35], a[56:63], v126
ds_write_b64 v26, v[96:97] offset:0
v_smfmac_f32_16x16x64_bf16 v[56:59], v[36:39], a[88:95], v126
v_smfmac_f32_16x16x64_bf16 v[56:59], v[40:43], a[120:127], v126
v_smfmac_f32_16x16x64_bf16 v[60:63], v[32:35], v[160:167], v126
s_branch Lpd_276
Lpf_279:
buffer_load_dwordx4 v[36:39], v8, s[4:7], s40 offen offset:2048 sc1
s_sub_u32 s37, s37, 1
s_cbranch_scc1 Lend_1
Lps_304:
s_waitcnt vmcnt(1)
v_max3_u32 v110, v40, v41, v42
v_max_u32 v110, v110, v43
v_cmp_eq_u32 vcc, -1, v110
s_cbranch_vccnz Lpf_305
v_smfmac_f32_16x16x64_bf16 v[44:47], v[40:43], a[96:103], v126
v_smfmac_f32_16x16x64_bf16 v[48:51], v[40:43], a[104:111], v126
v_smfmac_f32_16x16x64_bf16 v[52:55], v[40:43], a[112:119], v126
v_smfmac_f32_16x16x64_bf16 v[60:63], v[40:43], v[224:231], v126
Lps_306:
s_waitcnt vmcnt(0)
v_max3_u32 v110, v36, v37, v38
v_max_u32 v110, v110, v39
v_cmp_eq_u32 vcc, -1, v110
s_cbranch_vccnz Lpf_307
v_smfmac_f32_16x16x64_bf16 v[44:47], v[36:39], a[64:71], v126
s_nop 1
v_smfmac_f32_16x16x64_bf16 v[48:51], v[36:39], a[72:79], v126
s_nop 1
v_smfmac_f32_16x16x64_bf16 v[52:55], v[36:39], a[80:87], v126
s_nop 1
v_add_f32 v92, v44, v46
v_add_f32 v93, v45, v47
v_smfmac_f32_16x16x64_bf16 v[56:59], v[28:31], a[24:31], v126
v_add_f32 v94, v48, v50
v_add_f32 v95, v49, v51
ds_write_b64 v24, v[92:93] offset:0
v_add_f32 v96, v52, v54
v_add_f32 v97, v53, v55
ds_write_b64 v25, v[94:95] offset:0
v_smfmac_f32_16x16x64_bf16 v[56:59], v[32:35], a[56:63], v126
ds_write_b64 v26, v[96:97] offset:0
v_smfmac_f32_16x16x64_bf16 v[56:59], v[36:39], a[88:95], v126
v_smfmac_f32_16x16x64_bf16 v[56:59], v[40:43], a[120:127], v126
v_smfmac_f32_16x16x64_bf16 v[60:63], v[36:39], v[192:199], v126
s_branch Lpd_276
Lpf_280:
buffer_load_dwordx4 v[40:43], v8, s[4:7], s40 offen offset:3072 sc1
s_sub_u32 s37, s37, 1
s_cbranch_scc1 Lend_1
Lps_308:
s_waitcnt vmcnt(0)
v_max3_u32 v110, v40, v41, v42
v_max_u32 v110, v110, v43
v_cmp_eq_u32 vcc, -1, v110
s_cbranch_vccnz Lpf_309
v_smfmac_f32_16x16x64_bf16 v[44:47], v[40:43], a[96:103], v126
s_nop 1
v_smfmac_f32_16x16x64_bf16 v[48:51], v[40:43], a[104:111], v126
s_nop 1
v_smfmac_f32_16x16x64_bf16 v[52:55], v[40:43], a[112:119], v126
s_nop 1
v_add_f32 v92, v44, v46
v_add_f32 v93, v45, v47
v_smfmac_f32_16x16x64_bf16 v[56:59], v[28:31], a[24:31], v126
v_add_f32 v94, v48, v50
v_add_f32 v95, v49, v51
ds_write_b64 v24, v[92:93] offset:0
v_add_f32 v96, v52, v54
v_add_f32 v97, v53, v55
ds_write_b64 v25, v[94:95] offset:0
v_smfmac_f32_16x16x64_bf16 v[56:59], v[32:35], a[56:63], v126
ds_write_b64 v26, v[96:97] offset:0
v_smfmac_f32_16x16x64_bf16 v[56:59], v[36:39], a[88:95], v126
v_smfmac_f32_16x16x64_bf16 v[56:59], v[40:43], a[120:127], v126
v_smfmac_f32_16x16x64_bf16 v[60:63], v[40:43], v[224:231], v126
s_branch Lpd_276
Lpf_291:
buffer_load_dwordx4 v[32:35], v8, s[4:7], s40 offen offset:1024 sc1
Lps_310:
s_waitcnt vmcnt(3)
v_max3_u32 v110, v36, v37, v38
v_max_u32 v110, v110, v39
v_cmp_eq_u32 vcc, -1, v110
s_cbranch_vccnz Lpf_311
v_smfmac_f32_16x16x64_bf16 v[44:47], v[36:39], a[64:71], v126
v_smfmac_f32_16x16x64_bf16 v[48:51], v[36:39], a[72:79], v126
v_smfmac_f32_16x16x64_bf16 v[52:55], v[36:39], a[80:87], v126
v_smfmac_f32_16x16x64_bf16 v[60:63], v[36:39], v[192:199], v126
Lps_312:
s_waitcnt vmcnt(2)
v_max3_u32 v110, v40, v41, v42
v_max_u32 v110, v110, v43
v_cmp_eq_u32 vcc, -1, v110
s_cbranch_vccnz Lpf_313
v_smfmac_f32_16x16x64_bf16 v[44:47], v[40:43], a[96:103], v126
v_smfmac_f32_16x16x64_bf16 v[48:51], v[40:43], a[104:111], v126
v_smfmac_f32_16x16x64_bf16 v[52:55], v[40:43], a[112:119], v126
v_smfmac_f32_16x16x64_bf16 v[60:63], v[40:43], v[224:231], v126
Lps_314:
s_waitcnt vmcnt(1)
v_max3_u32 v110, v28, v29, v30
v_max_u32 v110, v110, v31
v_cmp_eq_u32 vcc, -1, v110
s_cbranch_vccnz Lpf_315
v_smfmac_f32_16x16x64_bf16 v[44:47], v[28:31], a[0:7], v126
v_smfmac_f32_16x16x64_bf16 v[48:51], v[28:31], a[8:15], v126
v_smfmac_f32_16x16x64_bf16 v[52:55], v[28:31], a[16:23], v126
v_smfmac_f32_16x16x64_bf16 v[60:63], v[28:31], v[128:135], v126
s_branch Lps_302
Lpf_293:
buffer_load_dwordx4 v[36:39], v8, s[4:7], s40 offen offset:2048 sc1
Lps_316:
s_waitcnt vmcnt(2)
v_max3_u32 v110, v40, v41, v42
v_max_u32 v110, v110, v43
v_cmp_eq_u32 vcc, -1, v110
s_cbranch_vccnz Lpf_317
v_smfmac_f32_16x16x64_bf16 v[44:47], v[40:43], a[96:103], v126
v_smfmac_f32_16x16x64_bf16 v[48:51], v[40:43], a[104:111], v126
v_smfmac_f32_16x16x64_bf16 v[52:55], v[40:43], a[112:119], v126
v_smfmac_f32_16x16x64_bf16 v[60:63], v[40:43], v[224:231], v126
Lps_318:
s_waitcnt vmcnt(1)
v_max3_u32 v110, v28, v29, v30
v_max_u32 v110, v110, v31
v_cmp_eq_u32 vcc, -1, v110
s_cbranch_vccnz Lpf_319
v_smfmac_f32_16x16x64_bf16 v[44:47], v[28:31], a[0:7], v126
v_smfmac_f32_16x16x64_bf16 v[48:51], v[28:31], a[8:15], v126
v_smfmac_f32_16x16x64_bf16 v[52:55], v[28:31], a[16:23], v126
v_smfmac_f32_16x16x64_bf16 v[60:63], v[28:31], v[128:135], v126
s_branch Lps_306
Lpf_295:
buffer_load_dwordx4 v[40:43], v8, s[4:7], s40 offen offset:3072 sc1
Lps_320:
s_waitcnt vmcnt(1)
v_max3_u32 v110, v28, v29, v30
v_max_u32 v110, v110, v31
v_cmp_eq_u32 vcc, -1, v110
s_cbranch_vccnz Lpf_321
v_smfmac_f32_16x16x64_bf16 v[44:47], v[28:31], a[0:7], v126
v_smfmac_f32_16x16x64_bf16 v[48:51], v[28:31], a[8:15], v126
v_smfmac_f32_16x16x64_bf16 v[52:55], v[28:31], a[16:23], v126
v_smfmac_f32_16x16x64_bf16 v[60:63], v[28:31], v[128:135], v126
s_branch Lps_308
Lpf_297:
buffer_load_dwordx4 v[28:31], v8, s[4:7], s40 offen offset:0 sc1
s_sub_u32 s37, s37, 1
s_cbranch_scc1 Lend_1
s_branch Lps_296
Lpf_299:
buffer_load_dwordx4 v[36:39], v8, s[4:7], s40 offen offset:2048 sc1
Lps_322:
s_waitcnt vmcnt(2)
v_max3_u32 v110, v40, v41, v42
v_max_u32 v110, v110, v43
v_cmp_eq_u32 vcc, -1, v110
s_cbranch_vccnz Lpf_323
v_smfmac_f32_16x16x64_bf16 v[44:47], v[40:43], a[96:103], v126
v_smfmac_f32_16x16x64_bf16 v[48:51], v[40:43], a[104:111], v126
v_smfmac_f32_16x16x64_bf16 v[52:55], v[40:43], a[112:119], v126
v_smfmac_f32_16x16x64_bf16 v[60:63], v[40:43], v[224:231], v126
Lps_324:
s_waitcnt vmcnt(1)
v_max3_u32 v110, v32, v33, v34
v_max_u32 v110, v110, v35
v_cmp_eq_u32 vcc, -1, v110
s_cbranch_vccnz Lpf_325
v_smfmac_f32_16x16x64_bf16 v[44:47], v[32:35], a[32:39], v126
v_smfmac_f32_16x16x64_bf16 v[48:51], v[32:35], a[40:47], v126
v_smfmac_f32_16x16x64_bf16 v[52:55], v[32:35], a[48:55], v126
v_smfmac_f32_16x16x64_bf16 v[60:63], v[32:35], v[160:167], v126
s_branch Lps_306
Lpf_301:
buffer_load_dwordx4 v[40:43], v8, s[4:7], s40 offen offset:3072 sc1
Lps_326:
s_waitcnt vmcnt(1)
v_max3_u32 v110, v32, v33, v34
v_max_u32 v110, v110, v35
v_cmp_eq_u32 vcc, -1, v110
s_cbranch_vccnz Lpf_327
v_smfmac_f32_16x16x64_bf16 v[44:47], v[32:35], a[32:39], v126
v_smfmac_f32_16x16x64_bf16 v[48:51], v[32:35], a[40:47], v126
v_smfmac_f32_16x16x64_bf16 v[52:55], v[32:35], a[48:55], v126
v_smfmac_f32_16x16x64_bf16 v[60:63], v[32:35], v[160:167], v126
s_branch Lps_308
Lpf_303:
buffer_load_dwordx4 v[32:35], v8, s[4:7], s40 offen offset:1024 sc1
s_sub_u32 s37, s37, 1
s_cbranch_scc1 Lend_1
s_branch Lps_302
Lpf_305:
buffer_load_dwordx4 v[40:43], v8, s[4:7], s40 offen offset:3072 sc1
Lps_328:
s_waitcnt vmcnt(1)
v_max3_u32 v110, v36, v37, v38
v_max_u32 v110, v110, v39
v_cmp_eq_u32 vcc, -1, v110
s_cbranch_vccnz Lpf_329
v_smfmac_f32_16x16x64_bf16 v[44:47], v[36:39], a[64:71], v126
v_smfmac_f32_16x16x64_bf16 v[48:51], v[36:39], a[72:79], v126
v_smfmac_f32_16x16x64_bf16 v[52:55], v[36:39], a[80:87], v126
v_smfmac_f32_16x16x64_bf16 v[60:63], v[36:39], v[192:199], v126
s_branch Lps_308
Lpf_307:
buffer_load_dwordx4 v[36:39], v8, s[4:7], s40 offen offset:2048 sc1
s_sub_u32 s37, s37, 1
s_cbranch_scc1 Lend_1
s_branch Lps_306
Lpf_309:
buffer_load_dwordx4 v[40:43], v8, s[4:7], s40 offen offset:3072 sc1
s_sub_u32 s37, s37, 1
s_cbranch_scc1 Lend_1
s_branch Lps_308
Lpf_311:
buffer_load_dwordx4 v[36:39], v8, s[4:7], s40 offen offset:2048 sc1
Lps_330:
s_waitcnt vmcnt(3)
v_max3_u32 v110, v40, v41, v42
v_max_u32 v110, v110, v43
v_cmp_eq_u32 vcc, -1, v110
s_cbranch_vccnz Lpf_331
v_smfmac_f32_16x16x64_bf16 v[44:47], v[40:43], a[96:103], v126
v_smfmac_f32_16x16x64_bf16 v[48:51], v[40:43], a[104:111], v126
v_smfmac_f32_16x16x64_bf16 v[52:55], v[40:43], a[112:119], v126
v_smfmac_f32_16x16x64_bf16 v[60:63], v[40:43], v[224:231], v126
Lps_332:
s_waitcnt vmcnt(2)
v_max3_u32 v110, v28, v29, v30
v_max_u32 v110, v110, v31
v_cmp_eq_u32 vcc, -1, v110
s_cbranch_vccnz Lpf_333
v_smfmac_f32_16x16x64_bf16 v[44:47], v[28:31], a[0:7], v126
v_smfmac_f32_16x16x64_bf16 v[48:51], v[28:31], a[8:15], v126
v_smfmac_f32_16x16x64_bf16 v[52:55], v[28:31], a[16:23], v126
v_smfmac_f32_16x16x64_bf16 v[60:63], v[28:31], v[128:135], v126
s_branch Lps_324
Lpf_313:
buffer_load_dwordx4 v[40:43], v8, s[4:7], s40 offen offset:3072 sc1
Lps_334:
s_waitcnt vmcnt(2)
v_max3_u32 v110, v28, v29, v30
v_max_u32 v110, v110, v31
v_cmp_eq_u32 vcc, -1, v110
s_cbranch_vccnz Lpf_335
v_smfmac_f32_16x16x64_bf16 v[44:47], v[28:31], a[0:7], v126
v_smfmac_f32_16x16x64_bf16 v[48:51], v[28:31], a[8:15], v126
v_smfmac_f32_16x16x64_bf16 v[52:55], v[28:31], a[16:23], v126
v_smfmac_f32_16x16x64_bf16 v[60:63], v[28:31], v[128:135], v126
s_branch Lps_326
Lpf_315:
buffer_load_dwordx4 v[28:31], v8, s[4:7], s40 offen offset:0 sc1
s_sub_u32 s37, s37, 1
s_cbranch_scc1 Lend_1
Lps_336:
s_waitcnt vmcnt(1)
v_max3_u32 v110, v32, v33, v34
v_max_u32 v110, v110, v35
v_cmp_eq_u32 vcc, -1, v110
s_cbranch_vccnz Lpf_337
v_smfmac_f32_16x16x64_bf16 v[44:47], v[32:35], a[32:39], v126
v_smfmac_f32_16x16x64_bf16 v[48:51], v[32:35], a[40:47], v126
v_smfmac_f32_16x16x64_bf16 v[52:55], v[32:35], a[48:55], v126
v_smfmac_f32_16x16x64_bf16 v[60:63], v[32:35], v[160:167], v126
s_branch Lps_296
Lpf_317:
buffer_load_dwordx4 v[40:43], v8, s[4:7], s40 offen offset:3072 sc1
Lps_338:
s_waitcnt vmcnt(2)
v_max3_u32 v110, v28, v29, v30
v_max_u32 v110, v110, v31
v_cmp_eq_u32 vcc, -1, v110
s_cbranch_vccnz Lpf_339
v_smfmac_f32_16x16x64_bf16 v[44:47], v[28:31], a[0:7], v126
v_smfmac_f32_16x16x64_bf16 v[48:51], v[28:31], a[8:15], v126
v_smfmac_f32_16x16x64_bf16 v[52:55], v[28:31], a[16:23], v126
v_smfmac_f32_16x16x64_bf16 v[60:63], v[28:31], v[128:135], v126
s_branch Lps_328
Lpf_319:
buffer_load_dwordx4 v[28:31], v8, s[4:7], s40 offen offset:0 sc1
s_sub_u32 s37, s37, 1
s_cbranch_scc1 Lend_1
Lps_340:
s_waitcnt vmcnt(1)
v_max3_u32 v110, v36, v37, v38
v_max_u32 v110, v110, v39
v_cmp_eq_u32 vcc, -1, v110
s_cbranch_vccnz Lpf_341
v_smfmac_f32_16x16x64_bf16 v[44:47], v[36:39], a[64:71], v126
v_smfmac_f32_16x16x64_bf16 v[48:51], v[36:39], a[72:79], v126
v_smfmac_f32_16x16x64_bf16 v[52:55], v[36:39], a[80:87], v126
v_smfmac_f32_16x16x64_bf16 v[60:63], v[36:39], v[192:199], v126
s_branch Lps_296
Lpf_321:
buffer_load_dwordx4 v[28:31], v8, s[4:7], s40 offen offset:0 sc1
s_sub_u32 s37, s37, 1
s_cbranch_scc1 Lend_1
s_branch Lps_294
Lpf_323:
buffer_load_dwordx4 v[40:43], v8, s[4:7], s40 offen offset:3072 sc1
Lps_342:
s_waitcnt vmcnt(2)
v_max3_u32 v110, v32, v33, v34
v_max_u32 v110, v110, v35
v_cmp_eq_u32 vcc, -1, v110
s_cbranch_vccnz Lpf_343
v_smfmac_f32_16x16x64_bf16 v[44:47], v[32:35], a[32:39], v126
v_smfmac_f32_16x16x64_bf16 v[48:51], v[32:35], a[40:47], v126
v_smfmac_f32_16x16x64_bf16 v[52:55], v[32:35], a[48:55], v126
v_smfmac_f32_16x16x64_bf16 v[60:63], v[32:35], v[160:167], v126
s_branch Lps_328
Lpf_325:
buffer_load_dwordx4 v[32:35], v8, s[4:7], s40 offen offset:1024 sc1
s_sub_u32 s37, s37, 1
s_cbranch_scc1 Lend_1
Lps_344:
s_waitcnt vmcnt(1)
v_max3_u32 v110, v36, v37, v38
v_max_u32 v110, v110, v39
v_cmp_eq_u32 vcc, -1, v110
s_cbranch_vccnz Lpf_345
v_smfmac_f32_16x16x64_bf16 v[44:47], v[36:39], a[64:71], v126
v_smfmac_f32_16x16x64_bf16 v[48:51], v[36:39], a[72:79], v126
v_smfmac_f32_16x16x64_bf16 v[52:55], v[36:39], a[80:87], v126
v_smfmac_f32_16x16x64_bf16 v[60:63], v[36:39], v[192:199], v126
s_branch Lps_302
Lpf_327:
buffer_load_dwordx4 v[32:35], v8, s[4:7], s40 offen offset:1024 sc1
s_sub_u32 s37, s37, 1
s_cbranch_scc1 Lend_1
s_branch Lps_300
Lpf_329:
buffer_load_dwordx4 v[36:39], v8, s[4:7], s40 offen offset:2048 sc1
s_sub_u32 s37, s37, 1
s_cbranch_scc1 Lend_1
s_branch Lps_304
Lpf_331:
buffer_load_dwordx4 v[40:43], v8, s[4:7], s40 offen offset:3072 sc1
Lps_346:
s_waitcnt vmcnt(3)
v_max3_u32 v110, v28, v29, v30
v_max_u32 v110, v110, v31
v_cmp_eq_u32 vcc, -1, v110
s_cbranch_vccnz Lpf_347
v_smfmac_f32_16x16x64_bf16 v[44:47], v[28:31], a[0:7], v126
v_smfmac_f32_16x16x64_bf16 v[48:51], v[28:31], a[8:15], v126
v_smfmac_f32_16x16x64_bf16 v[52:55], v[28:31], a[16:23], v126
v_smfmac_f32_16x16x64_bf16 v[60:63], v[28:31], v[128:135], v126
s_branch Lps_342
Lpf_333:
buffer_load_dwordx4 v[28:31], v8, s[4:7], s40 offen offset:0 sc1
s_sub_u32 s37, s37, 1
s_cbranch_scc1 Lend_1
Lps_348:
s_waitcnt vmcnt(2)
v_max3_u32 v110, v32, v33, v34
v_max_u32 v110, v110, v35
v_cmp_eq_u32 vcc, -1, v110
s_cbranch_vccnz Lpf_349
v_smfmac_f32_16x16x64_bf16 v[44:47], v[32:35], a[32:39], v126
v_smfmac_f32_16x16x64_bf16 v[48:51], v[32:35], a[40:47], v126
v_smfmac_f32_16x16x64_bf16 v[52:55], v[32:35], a[48:55], v126
v_smfmac_f32_16x16x64_bf16 v[60:63], v[32:35], v[160:167], v126
s_branch Lps_340
Lpf_335:
buffer_load_dwordx4 v[28:31], v8, s[4:7], s40 offen offset:0 sc1
s_sub_u32 s37, s37, 1
s_cbranch_scc1 Lend_1
Lps_350:
s_waitcnt vmcnt(2)
v_max3_u32 v110, v32, v33, v34
v_max_u32 v110, v110, v35
v_cmp_eq_u32 vcc, -1, v110
s_cbranch_vccnz Lpf_351
v_smfmac_f32_16x16x64_bf16 v[44:47], v[32:35], a[32:39], v126
v_smfmac_f32_16x16x64_bf16 v[48:51], v[32:35], a[40:47], v126
v_smfmac_f32_16x16x64_bf16 v[52:55], v[32:35], a[48:55], v126
v_smfmac_f32_16x16x64_bf16 v[60:63], v[32:35], v[160:167], v126
s_branch Lps_294
Lpf_337:
buffer_load_dwordx4 v[32:35], v8, s[4:7], s40 offen offset:1024 sc1
s_branch Lps_314
Lpf_339:
buffer_load_dwordx4 v[28:31], v8, s[4:7], s40 offen offset:0 sc1
s_sub_u32 s37, s37, 1
s_cbranch_scc1 Lend_1
s_branch Lps_292
Lpf_341:
buffer_load_dwordx4 v[36:39], v8, s[4:7], s40 offen offset:2048 sc1
s_branch Lps_318
Lpf_343:
buffer_load_dwordx4 v[32:35], v8, s[4:7], s40 offen offset:1024 sc1
s_sub_u32 s37, s37, 1
s_cbranch_scc1 Lend_1
s_branch Lps_298
Lpf_345:
buffer_load_dwordx4 v[36:39], v8, s[4:7], s40 offen offset:2048 sc1
s_branch Lps_324
Lpf_347:
buffer_load_dwordx4 v[28:31], v8, s[4:7], s40 offen offset:0 sc1
s_sub_u32 s37, s37, 1
s_cbranch_scc1 Lend_1
s_branch Lps_290
Lpf_349:
buffer_load_dwordx4 v[32:35], v8, s[4:7], s40 offen offset:1024 sc1
Lps_352:
s_waitcnt vmcnt(2)
v_max3_u32 v110, v36, v37, v38
v_max_u32 v110, v110, v39
v_cmp_eq_u32 vcc, -1, v110
s_cbranch_vccnz Lpf_353
v_smfmac_f32_16x16x64_bf16 v[44:47], v[36:39], a[64:71], v126
v_smfmac_f32_16x16x64_bf16 v[48:51], v[36:39], a[72:79], v126
v_smfmac_f32_16x16x64_bf16 v[52:55], v[36:39], a[80:87], v126
v_smfmac_f32_16x16x64_bf16 v[60:63], v[36:39], v[192:199], v126
s_branch Lps_314
Lpf_351:
buffer_load_dwordx4 v[32:35], v8, s[4:7], s40 offen offset:1024 sc1
s_branch Lps_312
Lpf_353:
buffer_load_dwordx4 v[36:39], v8, s[4:7], s40 offen offset:2048 sc1
s_branch Lps_332
Lpf_284:
buffer_load_dwordx4 v[28:31], v9, s[4:7], s40 offen offset:0 sc1
s_sub_u32 s37, s37, 1
s_cbranch_scc1 Lend_1
Lps_354:
s_waitcnt vmcnt(3)
v_max3_u32 v110, v32, v33, v34
v_max_u32 v110, v110, v35
v_cmp_eq_u32 vcc, -1, v110
s_cbranch_vccnz Lpf_355
v_smfmac_f32_16x16x64_bf16 v[76:79], v[32:35], a[160:167], v126
v_smfmac_f32_16x16x64_bf16 v[80:83], v[32:35], a[168:175], v126
v_smfmac_f32_16x16x64_bf16 v[84:87], v[32:35], a[176:183], v126
Lps_356:
s_waitcnt vmcnt(2)
v_max3_u32 v110, v36, v37, v38
v_max_u32 v110, v110, v39
v_cmp_eq_u32 vcc, -1, v110
s_cbranch_vccnz Lpf_357
v_smfmac_f32_16x16x64_bf16 v[76:79], v[36:39], a[192:199], v126
v_smfmac_f32_16x16x64_bf16 v[80:83], v[36:39], a[200:207], v126
v_smfmac_f32_16x16x64_bf16 v[84:87], v[36:39], a[208:215], v126
Lps_358:
s_waitcnt vmcnt(1)
v_max3_u32 v110, v40, v41, v42
v_max_u32 v110, v110, v43
v_cmp_eq_u32 vcc, -1, v110
s_cbranch_vccnz Lpf_359
v_smfmac_f32_16x16x64_bf16 v[76:79], v[40:43], a[224:231], v126
v_smfmac_f32_16x16x64_bf16 v[80:83], v[40:43], a[232:239], v126
v_smfmac_f32_16x16x64_bf16 v[84:87], v[40:43], a[240:247], v126
Lps_360:
s_waitcnt vmcnt(0)
v_max3_u32 v110, v28, v29, v30
v_max_u32 v110, v110, v31
v_cmp_eq_u32 vcc, -1, v110
s_cbranch_vccnz Lpf_361
v_smfmac_f32_16x16x64_bf16 v[76:79], v[28:31], a[128:135], v126
s_nop 1
v_smfmac_f32_16x16x64_bf16 v[80:83], v[28:31], a[136:143], v126
s_nop 1
v_smfmac_f32_16x16x64_bf16 v[84:87], v[28:31], a[144:151], v126
s_nop 1
v_add_f32 v92, v76, v78
v_add_f32 v93, v77, v79
v_smfmac_f32_16x16x64_bf16 v[88:91], v[28:31], a[152:159], v126
v_add_f32 v94, v80, v82
v_add_f32 v95, v81, v83
ds_write_b64 v24, v[92:93] offset:12288
v_add_f32 v96, v84, v86
v_add_f32 v97, v85, v87
ds_write_b64 v25, v[94:95] offset:12288
v_smfmac_f32_16x16x64_bf16 v[88:91], v[32:35], a[184:191], v126
ds_write_b64 v26, v[96:97] offset:12288
v_smfmac_f32_16x16x64_bf16 v[88:91], v[36:39], a[216:223], v126
v_smfmac_f32_16x16x64_bf16 v[88:91], v[40:43], a[248:255], v126
s_branch Lpd_283
Lpf_285:
buffer_load_dwordx4 v[32:35], v9, s[4:7], s40 offen offset:1024 sc1
s_sub_u32 s37, s37, 1
s_cbranch_scc1 Lend_1
Lps_362:
s_waitcnt vmcnt(2)
v_max3_u32 v110, v36, v37, v38
v_max_u32 v110, v110, v39
v_cmp_eq_u32 vcc, -1, v110
s_cbranch_vccnz Lpf_363
v_smfmac_f32_16x16x64_bf16 v[76:79], v[36:39], a[192:199], v126
v_smfmac_f32_16x16x64_bf16 v[80:83], v[36:39], a[200:207], v126
v_smfmac_f32_16x16x64_bf16 v[84:87], v[36:39], a[208:215], v126
Lps_364:
s_waitcnt vmcnt(1)
v_max3_u32 v110, v40, v41, v42
v_max_u32 v110, v110, v43
v_cmp_eq_u32 vcc, -1, v110
s_cbranch_vccnz Lpf_365
v_smfmac_f32_16x16x64_bf16 v[76:79], v[40:43], a[224:231], v126
v_smfmac_f32_16x16x64_bf16 v[80:83], v[40:43], a[232:239], v126
v_smfmac_f32_16x16x64_bf16 v[84:87], v[40:43], a[240:247], v126
Lps_366:
s_waitcnt vmcnt(0)
v_max3_u32 v110, v32, v33, v34
v_max_u32 v110, v110, v35
v_cmp_eq_u32 vcc, -1, v110
s_cbranch_vccnz Lpf_367
v_smfmac_f32_16x16x64_bf16 v[76:79], v[32:35], a[160:167], v126
s_nop 1
v_smfmac_f32_16x16x64_bf16 v[80:83], v[32:35], a[168:175], v126
s_nop 1
v_smfmac_f32_16x16x64_bf16 v[84:87], v[32:35], a[176:183], v126
s_nop 1
v_add_f32 v92, v76, v78
v_add_f32 v93, v77, v79
v_smfmac_f32_16x16x64_bf16 v[88:91], v[28:31], a[152:159], v126
v_add_f32 v94, v80, v82
v_add_f32 v95, v81, v83
ds_write_b64 v24, v[92:93] offset:12288
v_add_f32 v96, v84, v86
v_add_f32 v97, v85, v87
ds_write_b64 v25, v[94:95] offset:12288
v_smfmac_f32_16x16x64_bf16 v[88:91], v[32:35], a[184:191], v126
ds_write_b64 v26, v[96:97] offset:12288
v_smfmac_f32_16x16x64_bf16 v[88:91], v[36:39], a[216:223], v126
v_smfmac_f32_16x16x64_bf16 v[88:91], v[40:43], a[248:255], v126
s_branch Lpd_283
Lpf_286:
buffer_load_dwordx4 v[36:39], v9, s[4:7], s40 offen offset:2048 sc1
s_sub_u32 s37, s37, 1
s_cbranch_scc1 Lend_1
Lps_368:
s_waitcnt vmcnt(1)
v_max3_u32 v110, v40, v41, v42
v_max_u32 v110, v110, v43
v_cmp_eq_u32 vcc, -1, v110
s_cbranch_vccnz Lpf_369
v_smfmac_f32_16x16x64_bf16 v[76:79], v[40:43], a[224:231], v126
v_smfmac_f32_16x16x64_bf16 v[80:83], v[40:43], a[232:239], v126
v_smfmac_f32_16x16x64_bf16 v[84:87], v[40:43], a[240:247], v126
Lps_370:
s_waitcnt vmcnt(0)
v_max3_u32 v110, v36, v37, v38
v_max_u32 v110, v110, v39
v_cmp_eq_u32 vcc, -1, v110
s_cbranch_vccnz Lpf_371
v_smfmac_f32_16x16x64_bf16 v[76:79], v[36:39], a[192:199], v126
s_nop 1
v_smfmac_f32_16x16x64_bf16 v[80:83], v[36:39], a[200:207], v126
s_nop 1
v_smfmac_f32_16x16x64_bf16 v[84:87], v[36:39], a[208:215], v126
s_nop 1
v_add_f32 v92, v76, v78
v_add_f32 v93, v77, v79
v_smfmac_f32_16x16x64_bf16 v[88:91], v[28:31], a[152:159], v126
v_add_f32 v94, v80, v82
v_add_f32 v95, v81, v83
ds_write_b64 v24, v[92:93] offset:12288
v_add_f32 v96, v84, v86
v_add_f32 v97, v85, v87
ds_write_b64 v25, v[94:95] offset:12288
v_smfmac_f32_16x16x64_bf16 v[88:91], v[32:35], a[184:191], v126
ds_write_b64 v26, v[96:97] offset:12288
v_smfmac_f32_16x16x64_bf16 v[88:91], v[36:39], a[216:223], v126
v_smfmac_f32_16x16x64_bf16 v[88:91], v[40:43], a[248:255], v126
s_branch Lpd_283
Lpf_287:
buffer_load_dwordx4 v[40:43], v9, s[4:7], s40 offen offset:3072 sc1
s_sub_u32 s37, s37, 1
s_cbranch_scc1 Lend_1
Lps_372:
s_waitcnt vmcnt(0)
v_max3_u32 v110, v40, v41, v42
v_max_u32 v110, v110, v43
v_cmp_eq_u32 vcc, -1, v110
s_cbranch_vccnz Lpf_373
v_smfmac_f32_16x16x64_bf16 v[76:79], v[40:43], a[224:231], v126
s_nop 1
v_smfmac_f32_16x16x64_bf16 v[80:83], v[40:43], a[232:239], v126
s_nop 1
v_smfmac_f32_16x16x64_bf16 v[84:87], v[40:43], a[240:247], v126
s_nop 1
v_add_f32 v92, v76, v78
v_add_f32 v93, v77, v79
v_smfmac_f32_16x16x64_bf16 v[88:91], v[28:31], a[152:159], v126
v_add_f32 v94, v80, v82
v_add_f32 v95, v81, v83
ds_write_b64 v24, v[92:93] offset:12288
v_add_f32 v96, v84, v86
v_add_f32 v97, v85, v87
ds_write_b64 v25, v[94:95] offset:12288
v_smfmac_f32_16x16x64_bf16 v[88:91], v[32:35], a[184:191], v126
ds_write_b64 v26, v[96:97] offset:12288
v_smfmac_f32_16x16x64_bf16 v[88:91], v[36:39], a[216:223], v126
v_smfmac_f32_16x16x64_bf16 v[88:91], v[40:43], a[248:255], v126
s_branch Lpd_283
Lpf_355:
buffer_load_dwordx4 v[32:35], v9, s[4:7], s40 offen offset:1024 sc1
Lps_374:
s_waitcnt vmcnt(3)
v_max3_u32 v110, v36, v37, v38
v_max_u32 v110, v110, v39
v_cmp_eq_u32 vcc, -1, v110
s_cbranch_vccnz Lpf_375
v_smfmac_f32_16x16x64_bf16 v[76:79], v[36:39], a[192:199], v126
v_smfmac_f32_16x16x64_bf16 v[80:83], v[36:39], a[200:207], v126
v_smfmac_f32_16x16x64_bf16 v[84:87], v[36:39], a[208:215], v126
Lps_376:
s_waitcnt vmcnt(2)
v_max3_u32 v110, v40, v41, v42
v_max_u32 v110, v110, v43
v_cmp_eq_u32 vcc, -1, v110
s_cbranch_vccnz Lpf_377
v_smfmac_f32_16x16x64_bf16 v[76:79], v[40:43], a[224:231], v126
v_smfmac_f32_16x16x64_bf16 v[80:83], v[40:43], a[232:239], v126
v_smfmac_f32_16x16x64_bf16 v[84:87], v[40:43], a[240:247], v126
Lps_378:
s_waitcnt vmcnt(1)
v_max3_u32 v110, v28, v29, v30
v_max_u32 v110, v110, v31
v_cmp_eq_u32 vcc, -1, v110
s_cbranch_vccnz Lpf_379
v_smfmac_f32_16x16x64_bf16 v[76:79], v[28:31], a[128:135], v126
v_smfmac_f32_16x16x64_bf16 v[80:83], v[28:31], a[136:143], v126
v_smfmac_f32_16x16x64_bf16 v[84:87], v[28:31], a[144:151], v126
s_branch Lps_366
Lpf_357:
buffer_load_dwordx4 v[36:39], v9, s[4:7], s40 offen offset:2048 sc1
Lps_380:
s_waitcnt vmcnt(2)
v_max3_u32 v110, v40, v41, v42
v_max_u32 v110, v110, v43
v_cmp_eq_u32 vcc, -1, v110
s_cbranch_vccnz Lpf_381
v_smfmac_f32_16x16x64_bf16 v[76:79], v[40:43], a[224:231], v126
v_smfmac_f32_16x16x64_bf16 v[80:83], v[40:43], a[232:239], v126
v_smfmac_f32_16x16x64_bf16 v[84:87], v[40:43], a[240:247], v126
Lps_382:
s_waitcnt vmcnt(1)
v_max3_u32 v110, v28, v29, v30
v_max_u32 v110, v110, v31
v_cmp_eq_u32 vcc, -1, v110
s_cbranch_vccnz Lpf_383
v_smfmac_f32_16x16x64_bf16 v[76:79], v[28:31], a[128:135], v126
v_smfmac_f32_16x16x64_bf16 v[80:83], v[28:31], a[136:143], v126
v_smfmac_f32_16x16x64_bf16 v[84:87], v[28:31], a[144:151], v126
s_branch Lps_370
Lpf_359:
buffer_load_dwordx4 v[40:43], v9, s[4:7], s40 offen offset:3072 sc1
Lps_384:
s_waitcnt vmcnt(1)
v_max3_u32 v110, v28, v29, v30
v_max_u32 v110, v110, v31
v_cmp_eq_u32 vcc, -1, v110
s_cbranch_vccnz Lpf_385
v_smfmac_f32_16x16x64_bf16 v[76:79], v[28:31], a[128:135], v126
v_smfmac_f32_16x16x64_bf16 v[80:83], v[28:31], a[136:143], v126
v_smfmac_f32_16x16x64_bf16 v[84:87], v[28:31], a[144:151], v126
s_branch Lps_372
Lpf_361:
buffer_load_dwordx4 v[28:31], v9, s[4:7], s40 offen offset:0 sc1
s_sub_u32 s37, s37, 1
s_cbranch_scc1 Lend_1
s_branch Lps_360
Lpf_363:
buffer_load_dwordx4 v[36:39], v9, s[4:7], s40 offen offset:2048 sc1
Lps_386:
s_waitcnt vmcnt(2)
v_max3_u32 v110, v40, v41, v42
v_max_u32 v110, v110, v43
v_cmp_eq_u32 vcc, -1, v110
s_cbranch_vccnz Lpf_387
v_smfmac_f32_16x16x64_bf16 v[76:79], v[40:43], a[224:231], v126
v_smfmac_f32_16x16x64_bf16 v[80:83], v[40:43], a[232:239], v126
v_smfmac_f32_16x16x64_bf16 v[84:87], v[40:43], a[240:247], v126
Lps_388:
s_waitcnt vmcnt(1)
v_max3_u32 v110, v32, v33, v34
v_max_u32 v110, v110, v35
v_cmp_eq_u32 vcc, -1, v110
s_cbranch_vccnz Lpf_389
v_smfmac_f32_16x16x64_bf16 v[76:79], v[32:35], a[160:167], v126
v_smfmac_f32_16x16x64_bf16 v[80:83], v[32:35], a[168:175], v126
v_smfmac_f32_16x16x64_bf16 v[84:87], v[32:35], a[176:183], v126
s_branch Lps_370
Lpf_365:
buffer_load_dwordx4 v[40:43], v9, s[4:7], s40 offen offset:3072 sc1
Lps_390:
s_waitcnt vmcnt(1)
v_max3_u32 v110, v32, v33, v34
v_max_u32 v110, v110, v35
v_cmp_eq_u32 vcc, -1, v110
s_cbranch_vccnz Lpf_391
v_smfmac_f32_16x16x64_bf16 v[76:79], v[32:35], a[160:167], v126
v_smfmac_f32_16x16x64_bf16 v[80:83], v[32:35], a[168:175], v126
v_smfmac_f32_16x16x64_bf16 v[84:87], v[32:35], a[176:183], v126
s_branch Lps_372
Lpf_367:
buffer_load_dwordx4 v[32:35], v9, s[4:7], s40 offen offset:1024 sc1
s_sub_u32 s37, s37, 1
s_cbranch_scc1 Lend_1
s_branch Lps_366
Lpf_369:
buffer_load_dwordx4 v[40:43], v9, s[4:7], s40 offen offset:3072 sc1
Lps_392:
s_waitcnt vmcnt(1)
v_max3_u32 v110, v36, v37, v38
v_max_u32 v110, v110, v39
v_cmp_eq_u32 vcc, -1, v110
s_cbranch_vccnz Lpf_393
v_smfmac_f32_16x16x64_bf16 v[76:79], v[36:39], a[192:199], v126
v_smfmac_f32_16x16x64_bf16 v[80:83], v[36:39], a[200:207], v126
v_smfmac_f32_16x16x64_bf16 v[84:87], v[36:39], a[208:215], v126
s_branch Lps_372
Lpf_371:
buffer_load_dwordx4 v[36:39], v9, s[4:7], s40 offen offset:2048 sc1
s_sub_u32 s37, s37, 1
s_cbranch_scc1 Lend_1
s_branch Lps_370
Lpf_373:
buffer_load_dwordx4 v[40:43], v9, s[4:7], s40 offen offset:3072 sc1
s_sub_u32 s37, s37, 1
s_cbranch_scc1 Lend_1
s_branch Lps_372
Lpf_375:
buffer_load_dwordx4 v[36:39], v9, s[4:7], s40 offen offset:2048 sc1
Lps_394:
s_waitcnt vmcnt(3)
v_max3_u32 v110, v40, v41, v42
v_max_u32 v110, v110, v43
v_cmp_eq_u32 vcc, -1, v110
s_cbranch_vccnz Lpf_395
v_smfmac_f32_16x16x64_bf16 v[76:79], v[40:43], a[224:231], v126
v_smfmac_f32_16x16x64_bf16 v[80:83], v[40:43], a[232:239], v126
v_smfmac_f32_16x16x64_bf16 v[84:87], v[40:43], a[240:247], v126
Lps_396:
s_waitcnt vmcnt(2)
v_max3_u32 v110, v28, v29, v30
v_max_u32 v110, v110, v31
v_cmp_eq_u32 vcc, -1, v110
s_cbranch_vccnz Lpf_397
v_smfmac_f32_16x16x64_bf16 v[76:79], v[28:31], a[128:135], v126
v_smfmac_f32_16x16x64_bf16 v[80:83], v[28:31], a[136:143], v126
v_smfmac_f32_16x16x64_bf16 v[84:87], v[28:31], a[144:151], v126
s_branch Lps_388
Lpf_377:
buffer_load_dwordx4 v[40:43], v9, s[4:7], s40 offen offset:3072 sc1
Lps_398:
s_waitcnt vmcnt(2)
v_max3_u32 v110, v28, v29, v30
v_max_u32 v110, v110, v31
v_cmp_eq_u32 vcc, -1, v110
s_cbranch_vccnz Lpf_399
v_smfmac_f32_16x16x64_bf16 v[76:79], v[28:31], a[128:135], v126
v_smfmac_f32_16x16x64_bf16 v[80:83], v[28:31], a[136:143], v126
v_smfmac_f32_16x16x64_bf16 v[84:87], v[28:31], a[144:151], v126
s_branch Lps_390
Lpf_379:
buffer_load_dwordx4 v[28:31], v9, s[4:7], s40 offen offset:0 sc1
s_sub_u32 s37, s37, 1
s_cbranch_scc1 Lend_1
Lps_400:
s_waitcnt vmcnt(1)
v_max3_u32 v110, v32, v33, v34
v_max_u32 v110, v110, v35
v_cmp_eq_u32 vcc, -1, v110
s_cbranch_vccnz Lpf_401
v_smfmac_f32_16x16x64_bf16 v[76:79], v[32:35], a[160:167], v126
v_smfmac_f32_16x16x64_bf16 v[80:83], v[32:35], a[168:175], v126
v_smfmac_f32_16x16x64_bf16 v[84:87], v[32:35], a[176:183], v126
s_branch Lps_360
Lpf_381:
buffer_load_dwordx4 v[40:43], v9, s[4:7], s40 offen offset:3072 sc1
Lps_402:
s_waitcnt vmcnt(2)
v_max3_u32 v110, v28, v29, v30
v_max_u32 v110, v110, v31
v_cmp_eq_u32 vcc, -1, v110
s_cbranch_vccnz Lpf_403
v_smfmac_f32_16x16x64_bf16 v[76:79], v[28:31], a[128:135], v126
v_smfmac_f32_16x16x64_bf16 v[80:83], v[28:31], a[136:143], v126
v_smfmac_f32_16x16x64_bf16 v[84:87], v[28:31], a[144:151], v126
s_branch Lps_392
Lpf_383:
buffer_load_dwordx4 v[28:31], v9, s[4:7], s40 offen offset:0 sc1
s_sub_u32 s37, s37, 1
s_cbranch_scc1 Lend_1
Lps_404:
s_waitcnt vmcnt(1)
v_max3_u32 v110, v36, v37, v38
v_max_u32 v110, v110, v39
v_cmp_eq_u32 vcc, -1, v110
s_cbranch_vccnz Lpf_405
v_smfmac_f32_16x16x64_bf16 v[76:79], v[36:39], a[192:199], v126
v_smfmac_f32_16x16x64_bf16 v[80:83], v[36:39], a[200:207], v126
v_smfmac_f32_16x16x64_bf16 v[84:87], v[36:39], a[208:215], v126
s_branch Lps_360
Lpf_385:
buffer_load_dwordx4 v[28:31], v9, s[4:7], s40 offen offset:0 sc1
s_sub_u32 s37, s37, 1
s_cbranch_scc1 Lend_1
s_branch Lps_358
Lpf_387:
buffer_load_dwordx4 v[40:43], v9, s[4:7], s40 offen offset:3072 sc1
Lps_406:
s_waitcnt vmcnt(2)
v_max3_u32 v110, v32, v33, v34
v_max_u32 v110, v110, v35
v_cmp_eq_u32 vcc, -1, v110
s_cbranch_vccnz Lpf_407
v_smfmac_f32_16x16x64_bf16 v[76:79], v[32:35], a[160:167], v126
v_smfmac_f32_16x16x64_bf16 v[80:83], v[32:35], a[168:175], v126
v_smfmac_f32_16x16x64_bf16 v[84:87], v[32:35], a[176:183], v126
s_branch Lps_392
Lpf_389:
buffer_load_dwordx4 v[32:35], v9, s[4:7], s40 offen offset:1024 sc1
s_sub_u32 s37, s37, 1
s_cbranch_scc1 Lend_1
Lps_408:
s_waitcnt vmcnt(1)
v_max3_u32 v110, v36, v37, v38
v_max_u32 v110, v110, v39
v_cmp_eq_u32 vcc, -1, v110
s_cbranch_vccnz Lpf_409
v_smfmac_f32_16x16x64_bf16 v[76:79], v[36:39], a[192:199], v126
v_smfmac_f32_16x16x64_bf16 v[80:83], v[36:39], a[200:207], v126
v_smfmac_f32_16x16x64_bf16 v[84:87], v[36:39], a[208:215], v126
s_branch Lps_366
Lpf_391:
buffer_load_dwordx4 v[32:35], v9, s[4:7], s40 offen offset:1024 sc1
s_sub_u32 s37, s37, 1
s_cbranch_scc1 Lend_1
s_branch Lps_364
Lpf_393:
buffer_load_dwordx4 v[36:39], v9, s[4:7], s40 offen offset:2048 sc1
s_sub_u32 s37, s37, 1
s_cbranch_scc1 Lend_1
s_branch Lps_368
Lpf_395:
buffer_load_dwordx4 v[40:43], v9, s[4:7], s40 offen offset:3072 sc1
Lps_410:
s_waitcnt vmcnt(3)
v_max3_u32 v110, v28, v29, v30
v_max_u32 v110, v110, v31
v_cmp_eq_u32 vcc, -1, v110
s_cbranch_vccnz Lpf_411
v_smfmac_f32_16x16x64_bf16 v[76:79], v[28:31], a[128:135], v126
v_smfmac_f32_16x16x64_bf16 v[80:83], v[28:31], a[136:143], v126
v_smfmac_f32_16x16x64_bf16 v[84:87], v[28:31], a[144:151], v126
s_branch Lps_406
Lpf_397:
buffer_load_dwordx4 v[28:31], v9, s[4:7], s40 offen offset:0 sc1
s_sub_u32 s37, s37, 1
s_cbranch_scc1 Lend_1
Lps_412:
s_waitcnt vmcnt(2)
v_max3_u32 v110, v32, v33, v34
v_max_u32 v110, v110, v35
v_cmp_eq_u32 vcc, -1, v110
s_cbranch_vccnz Lpf_413
v_smfmac_f32_16x16x64_bf16 v[76:79], v[32:35], a[160:167], v126
v_smfmac_f32_16x16x64_bf16 v[80:83], v[32:35], a[168:175], v126
v_smfmac_f32_16x16x64_bf16 v[84:87], v[32:35], a[176:183], v126
s_branch Lps_404
Lpf_399:
buffer_load_dwordx4 v[28:31], v9, s[4:7], s40 offen offset:0 sc1
s_sub_u32 s37, s37, 1
s_cbranch_scc1 Lend_1
Lps_414:
s_waitcnt vmcnt(2)
v_max3_u32 v110, v32, v33, v34
v_max_u32 v110, v110, v35
v_cmp_eq_u32 vcc, -1, v110
s_cbranch_vccnz Lpf_415
v_smfmac_f32_16x16x64_bf16 v[76:79], v[32:35], a[160:167], v126
v_smfmac_f32_16x16x64_bf16 v[80:83], v[32:35], a[168:175], v126
v_smfmac_f32_16x16x64_bf16 v[84:87], v[32:35], a[176:183], v126
s_branch Lps_358
Lpf_401:
buffer_load_dwordx4 v[32:35], v9, s[4:7], s40 offen offset:1024 sc1
s_branch Lps_378
Lpf_403:
buffer_load_dwordx4 v[28:31], v9, s[4:7], s40 offen offset:0 sc1
s_sub_u32 s37, s37, 1
s_cbranch_scc1 Lend_1
s_branch Lps_356
Lpf_405:
buffer_load_dwordx4 v[36:39], v9, s[4:7], s40 offen offset:2048 sc1
s_branch Lps_382
Lpf_407:
buffer_load_dwordx4 v[32:35], v9, s[4:7], s40 offen offset:1024 sc1
s_sub_u32 s37, s37, 1
s_cbranch_scc1 Lend_1
s_branch Lps_362
Lpf_409:
buffer_load_dwordx4 v[36:39], v9, s[4:7], s40 offen offset:2048 sc1
s_branch Lps_388
Lpf_411:
buffer_load_dwordx4 v[28:31], v9, s[4:7], s40 offen offset:0 sc1
s_sub_u32 s37, s37, 1
s_cbranch_scc1 Lend_1
s_branch Lps_354
Lpf_413:
buffer_load_dwordx4 v[32:35], v9, s[4:7], s40 offen offset:1024 sc1
Lps_416:
s_waitcnt vmcnt(2)
v_max3_u32 v110, v36, v37, v38
v_max_u32 v110, v110, v39
v_cmp_eq_u32 vcc, -1, v110
s_cbranch_vccnz Lpf_417
v_smfmac_f32_16x16x64_bf16 v[76:79], v[36:39], a[192:199], v126
v_smfmac_f32_16x16x64_bf16 v[80:83], v[36:39], a[200:207], v126
v_smfmac_f32_16x16x64_bf16 v[84:87], v[36:39], a[208:215], v126
s_branch Lps_378
Lpf_415:
buffer_load_dwordx4 v[32:35], v9, s[4:7], s40 offen offset:1024 sc1
s_branch Lps_376
Lpf_417:
buffer_load_dwordx4 v[36:39], v9, s[4:7], s40 offen offset:2048 sc1
s_branch Lps_396
Lkvo_sc1_274:
Lkvo_418:
buffer_load_dwordx4 v[28:31], v8, s[4:7], s40 offen offset:0 sc1
v_mfma_f32_16x16x32_bf16 v[16:19], v[20:23], v[20:23], 0
v_mfma_f32_16x16x32_bf16 v[16:19], v[20:23], v[20:23], 0
v_mfma_f32_16x16x32_bf16 v[16:19], v[20:23], v[20:23], 0
buffer_load_dwordx4 v[32:35], v8, s[4:7], s40 offen offset:1024 sc1
v_mfma_f32_16x16x32_bf16 v[16:19], v[20:23], v[20:23], 0
v_mfma_f32_16x16x32_bf16 v[16:19], v[20:23], v[20:23], 0
v_mfma_f32_16x16x32_bf16 v[16:19], v[20:23], v[20:23], 0
buffer_load_dwordx4 v[36:39], v8, s[4:7], s40 offen offset:2048 sc1
v_mfma_f32_16x16x32_bf16 v[16:19], v[20:23], v[20:23], 0
v_mfma_f32_16x16x32_bf16 v[16:19], v[20:23], v[20:23], 0
v_mfma_f32_16x16x32_bf16 v[16:19], v[20:23], v[20:23], 0
buffer_load_dwordx4 v[40:43], v8, s[4:7], s40 offen offset:3072 sc1
v_mfma_f32_16x16x32_bf16 v[16:19], v[20:23], v[20:23], 0
v_mfma_f32_16x16x32_bf16 v[16:19], v[20:23], v[20:23], 0
v_mfma_f32_16x16x32_bf16 v[16:19], v[20:23], v[20:23], 0
s_waitcnt vmcnt(3)
v_max3_u32 v110, v28, v29, v30
v_max_u32 v110, v110, v31
v_cmp_eq_u32 vcc, -1, v110
s_cbranch_vccnz Lpf_420
v_smfmac_f32_16x16x64_bf16 v[44:47], v[28:31], a[0:7], v126
v_smfmac_f32_16x16x64_bf16 v[48:51], v[28:31], a[8:15], v126
s_waitcnt vmcnt(2)
v_max3_u32 v110, v32, v33, v34
v_max_u32 v110, v110, v35
v_cmp_eq_u32 vcc, -1, v110
v_smfmac_f32_16x16x64_bf16 v[52:55], v[28:31], a[16:23], v126
v_smfmac_f32_16x16x64_bf16 v[60:63], v[28:31], v[128:135], v126
s_cbranch_vccnz Lpf_421
v_smfmac_f32_16x16x64_bf16 v[44:47], v[32:35], a[32:39], v126
v_smfmac_f32_16x16x64_bf16 v[48:51], v[32:35], a[40:47], v126
s_waitcnt vmcnt(1)
v_max3_u32 v110, v36, v37, v38
v_max_u32 v110, v110, v39
v_cmp_eq_u32 vcc, -1, v110
v_smfmac_f32_16x16x64_bf16 v[52:55], v[32:35], a[48:55], v126
v_smfmac_f32_16x16x64_bf16 v[60:63], v[32:35], v[160:167], v126
s_cbranch_vccnz Lpf_422
v_smfmac_f32_16x16x64_bf16 v[44:47], v[36:39], a[64:71], v126
v_smfmac_f32_16x16x64_bf16 v[48:51], v[36:39], a[72:79], v126
s_waitcnt vmcnt(0)
v_max3_u32 v110, v40, v41, v42
v_max_u32 v110, v110, v43
v_cmp_eq_u32 vcc, -1, v110
v_smfmac_f32_16x16x64_bf16 v[52:55], v[36:39], a[80:87], v126
v_smfmac_f32_16x16x64_bf16 v[60:63], v[36:39], v[192:199], v126
s_cbranch_vccnz Lpf_423
v_smfmac_f32_16x16x64_bf16 v[44:47], v[40:43], a[96:103], v126
s_nop 1
v_smfmac_f32_16x16x64_bf16 v[48:51], v[40:43], a[104:111], v126
s_nop 1
v_smfmac_f32_16x16x64_bf16 v[52:55], v[40:43], a[112:119], v126
s_nop 1
v_add_f32 v92, v44, v46
v_add_f32 v93, v45, v47
v_smfmac_f32_16x16x64_bf16 v[56:59], v[28:31], a[24:31], v126
v_add_f32 v94, v48, v50
v_add_f32 v95, v49, v51
ds_write_b64 v24, v[92:93] offset:0
v_add_f32 v96, v52, v54
v_add_f32 v97, v53, v55
ds_write_b64 v25, v[94:95] offset:0
v_smfmac_f32_16x16x64_bf16 v[56:59], v[32:35], a[56:63], v126
ds_write_b64 v26, v[96:97] offset:0
v_smfmac_f32_16x16x64_bf16 v[56:59], v[36:39], a[88:95], v126
v_smfmac_f32_16x16x64_bf16 v[56:59], v[40:43], a[120:127], v126
v_smfmac_f32_16x16x64_bf16 v[60:63], v[40:43], v[224:231], v126
Lpd_419:
v_smfmac_f32_16x16x64_bf16 v[64:67], v[28:31], v[136:143], v126
v_smfmac_f32_16x16x64_bf16 v[64:67], v[32:35], v[168:175], v126
s_waitcnt lgkmcnt(0)
s_barrier
ds_read_b64 v[100:101], v0 offset:0
ds_read_b64 v[102:103], v0 offset:512
ds_read_b64 v[104:105], v0 offset:1024
s_nop 2
v_add_f32 v98, v56, v58
v_add_f32 v99, v57, v59
v_smfmac_f32_16x16x64_bf16 v[64:67], v[36:39], v[200:207], v126
v_smfmac_f32_16x16x64_bf16 v[64:67], v[40:43], v[232:239], v126
v_smfmac_f32_16x16x64_bf16 v[68:71], v[28:31], v[144:151], v126
v_smfmac_f32_16x16x64_bf16 v[68:71], v[32:35], v[176:183], v126
s_waitcnt lgkmcnt(0)
v_add_f32 v100, v100, v98
v_add_f32 v102, v102, v104
v_add_f32 v101, v101, v99
v_add_f32 v103, v103, v105
v_add_f32 v100, v100, v102
v_add_f32 v101, v101, v103
v_cvt_pk_bf16_f32 v108, v100, v101
s_nop 1
v_mov_b32_dpp v109, v108 quad_perm:[1,0,3,2] row_mask:0xf bank_mask:0xf
v_perm_b32 v109, v109, v108, v3
buffer_store_dword v109, v11, s[4:7], s40 offen sc1
v_smfmac_f32_16x16x64_bf16 v[68:71], v[36:39], v[208:215], v126
v_smfmac_f32_16x16x64_bf16 v[68:71], v[40:43], v[240:247], v126
s_nop 3
v_smfmac_f32_16x16x64_bf16 v[72:75], v[28:31], v[152:159], v126
v_add_f32 v92, v60, v62
v_add_f32 v93, v61, v63
v_smfmac_f32_16x16x64_bf16 v[72:75], v[32:35], v[184:191], v126
v_add_f32 v94, v64, v66
v_add_f32 v95, v65, v67
ds_write_b64 v24, v[92:93] offset:6144
v_smfmac_f32_16x16x64_bf16 v[72:75], v[36:39], v[216:223], v126
v_add_f32 v96, v68, v70
v_add_f32 v97, v69, v71
ds_write_b64 v25, v[94:95] offset:6144
ds_write_b64 v26, v[96:97] offset:6144
v_smfmac_f32_16x16x64_bf16 v[72:75], v[40:43], v[248:255], v126
s_waitcnt lgkmcnt(0)
s_barrier
ds_read_b64 v[100:101], v0 offset:6144
ds_read_b64 v[102:103], v0 offset:6656
ds_read_b64 v[104:105], v0 offset:7168
s_nop 2
v_add_f32 v98, v72, v74
v_add_f32 v99, v73, v75
s_waitcnt lgkmcnt(0)
v_pk_add_f32 v[100:101], v[100:101], v[98:99]
v_pk_add_f32 v[102:103], v[102:103], v[104:105]
v_pk_add_f32 v[100:101], v[100:101], v[102:103]
v_cvt_pk_bf16_f32 v108, v100, v101
buffer_store_dword v108, v27, s[4:7], s40 offen sc1
s_cmp_eq_u32 s36, 63
s_cbranch_scc1 Lend_1
v_add_u32 v7, 1, v7
s_and_b32 s38, s36, 3
s_lshl_b32 s84, s38, 18
s_add_u32 s84, s84, s46
s_add_u32 s85, s84, 0x100000
s_mov_b64 exec, 3
buffer_load_dword v112, v1, s[4:7], s59 offen sc1
s_nop 5
buffer_load_dword v113, v1, s[4:7], s59 offen sc1
s_nop 5
buffer_load_dword v114, v1, s[4:7], s59 offen sc1
Lft_425:
s_waitcnt vmcnt(2)
v_cmp_gt_u32 vcc, s26, v112
buffer_load_dword v112, v1, s[4:7], s59 offen sc1
s_cbranch_vccz Lfg_424
s_waitcnt vmcnt(2)
v_cmp_gt_u32 vcc, s26, v113
buffer_load_dword v113, v1, s[4:7], s59 offen sc1
s_cbranch_vccz Lfg_424
s_waitcnt vmcnt(2)
v_cmp_gt_u32 vcc, s26, v114
buffer_load_dword v114, v1, s[4:7], s59 offen sc1
s_cbranch_vccz Lfg_424
s_sub_u32 s37, s37, 1
s_cbranch_scc1 Lend_1
s_branch Lft_425
Lfg_424:
s_mov_b64 exec, -1
buffer_load_dwordx4 v[28:31], v9, s[4:7], s40 offen offset:0 sc1
v_mfma_f32_16x16x32_bf16 v[16:19], v[20:23], v[20:23], 0
v_mfma_f32_16x16x32_bf16 v[16:19], v[20:23], v[20:23], 0
v_mfma_f32_16x16x32_bf16 v[16:19], v[20:23], v[20:23], 0
buffer_load_dwordx4 v[32:35], v9, s[4:7], s40 offen offset:1024 sc1
v_mfma_f32_16x16x32_bf16 v[16:19], v[20:23], v[20:23], 0
v_mfma_f32_16x16x32_bf16 v[16:19], v[20:23], v[20:23], 0
v_mfma_f32_16x16x32_bf16 v[16:19], v[20:23], v[20:23], 0
buffer_load_dwordx4 v[36:39], v9, s[4:7], s40 offen offset:2048 sc1
v_mfma_f32_16x16x32_bf16 v[16:19], v[20:23], v[20:23], 0
v_mfma_f32_16x16x32_bf16 v[16:19], v[20:23], v[20:23], 0
v_mfma_f32_16x16x32_bf16 v[16:19], v[20:23], v[20:23], 0
buffer_load_dwordx4 v[40:43], v9, s[4:7], s40 offen offset:3072 sc1
v_mfma_f32_16x16x32_bf16 v[16:19], v[20:23], v[20:23], 0
v_mfma_f32_16x16x32_bf16 v[16:19], v[20:23], v[20:23], 0
v_mfma_f32_16x16x32_bf16 v[16:19], v[20:23], v[20:23], 0
s_waitcnt vmcnt(3)
v_max3_u32 v110, v28, v29, v30
v_max_u32 v110, v110, v31
v_cmp_eq_u32 vcc, -1, v110
s_cbranch_vccnz Lpf_427
v_smfmac_f32_16x16x64_bf16 v[76:79], v[28:31], a[128:135], v126
s_waitcnt vmcnt(2)
v_max3_u32 v110, v32, v33, v34
v_max_u32 v110, v110, v35
v_cmp_eq_u32 vcc, -1, v110
v_smfmac_f32_16x16x64_bf16 v[80:83], v[28:31], a[136:143], v126
v_smfmac_f32_16x16x64_bf16 v[84:87], v[28:31], a[144:151], v126
s_cbranch_vccnz Lpf_428
v_smfmac_f32_16x16x64_bf16 v[76:79], v[32:35], a[160:167], v126
s_waitcnt vmcnt(1)
v_max3_u32 v110, v36, v37, v38
v_max_u32 v110, v110, v39
v_cmp_eq_u32 vcc, -1, v110
v_smfmac_f32_16x16x64_bf16 v[80:83], v[32:35], a[168:175], v126
v_smfmac_f32_16x16x64_bf16 v[84:87], v[32:35], a[176:183], v126
s_cbranch_vccnz Lpf_429
v_smfmac_f32_16x16x64_bf16 v[76:79], v[36:39], a[192:199], v126
s_waitcnt vmcnt(0)
v_max3_u32 v110, v40, v41, v42
v_max_u32 v110, v110, v43
v_cmp_eq_u32 vcc, -1, v110
v_smfmac_f32_16x16x64_bf16 v[80:83], v[36:39], a[200:207], v126
v_smfmac_f32_16x16x64_bf16 v[84:87], v[36:39], a[208:215], v126
s_cbranch_vccnz Lpf_430
v_smfmac_f32_16x16x64_bf16 v[76:79], v[40:43], a[224:231], v126
s_nop 1
v_smfmac_f32_16x16x64_bf16 v[80:83], v[40:43], a[232:239], v126
s_nop 1
v_smfmac_f32_16x16x64_bf16 v[84:87], v[40:43], a[240:247], v126
s_nop 1
v_add_f32 v92, v76, v78
v_add_f32 v93, v77, v79
v_smfmac_f32_16x16x64_bf16 v[88:91], v[28:31], a[152:159], v126
v_add_f32 v94, v80, v82
v_add_f32 v95, v81, v83
ds_write_b64 v24, v[92:93] offset:12288
v_add_f32 v96, v84, v86
v_add_f32 v97, v85, v87
ds_write_b64 v25, v[94:95] offset:12288
v_smfmac_f32_16x16x64_bf16 v[88:91], v[32:35], a[184:191], v126
ds_write_b64 v26, v[96:97] offset:12288
v_smfmac_f32_16x16x64_bf16 v[88:91], v[36:39], a[216:223], v126
v_smfmac_f32_16x16x64_bf16 v[88:91], v[40:43], a[248:255], v126
Lpd_426:
s_waitcnt lgkmcnt(0)
s_barrier
ds_read_b64 v[100:101], v0 offset:12288
ds_read_b64 v[102:103], v0 offset:12800
ds_read_b64 v[104:105], v0 offset:13312
s_nop 2
v_add_f32 v98, v88, v90
v_add_f32 v99, v89, v91
s_waitcnt lgkmcnt(0)
v_pk_add_f32 v[100:101], v[100:101], v[98:99]
v_pk_add_f32 v[102:103], v[102:103], v[104:105]
v_pk_add_f32 v[100:101], v[100:101], v[102:103]
v_cvt_pk_bf16_f32 v108, v100, v101
buffer_store_dword v108, v12, s[4:7], s84 offen sc1
buffer_store_dword v108, v12, s[4:7], s85 offen sc1
buffer_store_dwordx2 v[4:5], v10, s[4:7], s42 offen sc1
buffer_store_dword v4, v11, s[4:7], s42 offen sc1
buffer_store_dword v4, v27, s[4:7], s42 offen sc1
v_mov_b32 v112, v108
v_mov_b32 v116, v108
v_mov_b32 v120, v108
s_add_u32 s36, s36, 1
s_and_b32 s38, s36, 3
s_lshl_b32 s39, s38, 16
s_add_u32 s40, s39, s45
s_xor_b32 s42, s40, 0x20000
s_add_u32 s26, s36, 1
s_nop 15
s_nop 15
s_nop 15
s_nop 15
s_nop 3
buffer_load_dword v113, v13, s[4:7], s84 offen sc1
buffer_load_dword v114, v14, s[4:7], s84 offen sc1
buffer_load_dword v115, v15, s[4:7], s84 offen sc1
v_pk_mul_f32 v[44:45], 0, 0
v_pk_mul_f32 v[46:47], 0, 0
v_pk_mul_f32 v[48:49], 0, 0
v_pk_mul_f32 v[50:51], 0, 0
v_pk_mul_f32 v[52:53], 0, 0
v_pk_mul_f32 v[54:55], 0, 0
v_pk_mul_f32 v[56:57], 0, 0
v_pk_mul_f32 v[58:59], 0, 0
v_pk_mul_f32 v[60:61], 0, 0
v_pk_mul_f32 v[62:63], 0, 0
v_pk_mul_f32 v[64:65], 0, 0
v_pk_mul_f32 v[66:67], 0, 0
v_pk_mul_f32 v[68:69], 0, 0
v_pk_mul_f32 v[70:71], 0, 0
v_pk_mul_f32 v[72:73], 0, 0
v_pk_mul_f32 v[74:75], 0, 0
v_pk_mul_f32 v[76:77], 0, 0
v_pk_mul_f32 v[78:79], 0, 0
v_pk_mul_f32 v[80:81], 0, 0
v_pk_mul_f32 v[82:83], 0, 0
v_pk_mul_f32 v[84:85], 0, 0
v_pk_mul_f32 v[86:87], 0, 0
v_pk_mul_f32 v[88:89], 0, 0
v_pk_mul_f32 v[90:91], 0, 0
buffer_store_dword v7, v2, s[4:7], s59 offen sc1
buffer_load_dword v117, v13, s[4:7], s85 offen sc1
buffer_load_dword v118, v14, s[4:7], s85 offen sc1
buffer_load_dword v119, v15, s[4:7], s85 offen sc1
s_nop 15
s_nop 15
s_nop 15
buffer_load_dword v121, v13, s[4:7], s84 offen sc1
buffer_load_dword v122, v14, s[4:7], s84 offen sc1
buffer_load_dword v123, v15, s[4:7], s84 offen sc1
v_mfma_f32_16x16x32_bf16 v[16:19], v[20:23], v[20:23], 0
v_mfma_f32_16x16x32_bf16 v[16:19], v[20:23], v[20:23], 0
v_mfma_f32_16x16x32_bf16 v[16:19], v[20:23], v[20:23], 0
v_mfma_f32_16x16x32_bf16 v[16:19], v[20:23], v[20:23], 0
s_waitcnt vmcnt(7)
v_mfma_f32_16x16x32_bf16 v[100:103], v[112:115], v[20:23], 0
v_max3_u32 v110, v113, v114, v115
v_cmp_eq_u32 vcc, -1, v110
s_nop 5
v_cvt_pk_bf16_f32 v106, v100, v101
v_cvt_pk_bf16_f32 v107, v102, v103
s_cbranch_vccnz Lx2_431
Lxs_432:
buffer_store_dwordx2 v[106:107], v10, s[4:7], s40 offen sc1
s_nop 15
s_nop 15
s_nop 11
s_branch Lkvo_418
Lx2_431:
buffer_load_dword v113, v13, s[4:7], s85 offen sc1
buffer_load_dword v114, v14, s[4:7], s85 offen sc1
buffer_load_dword v115, v15, s[4:7], s85 offen sc1
s_waitcnt vmcnt(6)
v_mfma_f32_16x16x32_bf16 v[100:103], v[116:119], v[20:23], 0
v_max3_u32 v110, v117, v118, v119
v_cmp_eq_u32 vcc, -1, v110
s_nop 5
v_cvt_pk_bf16_f32 v106, v100, v101
v_cvt_pk_bf16_f32 v107, v102, v103
s_cbranch_vccz Lxs_432
buffer_load_dword v117, v13, s[4:7], s84 offen sc1
buffer_load_dword v118, v14, s[4:7], s84 offen sc1
buffer_load_dword v119, v15, s[4:7], s84 offen sc1
s_waitcnt vmcnt(6)
v_mfma_f32_16x16x32_bf16 v[100:103], v[120:123], v[20:23], 0
v_max3_u32 v110, v121, v122, v123
v_cmp_eq_u32 vcc, -1, v110
s_nop 5
v_cvt_pk_bf16_f32 v106, v100, v101
v_cvt_pk_bf16_f32 v107, v102, v103
s_cbranch_vccz Lxs_432
buffer_load_dword v121, v13, s[4:7], s85 offen sc1
buffer_load_dword v122, v14, s[4:7], s85 offen sc1
buffer_load_dword v123, v15, s[4:7], s85 offen sc1
s_waitcnt vmcnt(6)
v_mfma_f32_16x16x32_bf16 v[100:103], v[112:115], v[20:23], 0
v_max3_u32 v110, v113, v114, v115
v_cmp_eq_u32 vcc, -1, v110
s_nop 5
v_cvt_pk_bf16_f32 v106, v100, v101
v_cvt_pk_bf16_f32 v107, v102, v103
s_cbranch_vccz Lxs_432
buffer_load_dword v113, v13, s[4:7], s84 offen sc1
buffer_load_dword v114, v14, s[4:7], s84 offen sc1
buffer_load_dword v115, v15, s[4:7], s84 offen sc1
s_waitcnt vmcnt(6)
v_mfma_f32_16x16x32_bf16 v[100:103], v[116:119], v[20:23], 0
v_max3_u32 v110, v117, v118, v119
v_cmp_eq_u32 vcc, -1, v110
s_nop 5
v_cvt_pk_bf16_f32 v106, v100, v101
v_cvt_pk_bf16_f32 v107, v102, v103
s_cbranch_vccz Lxs_432
buffer_load_dword v117, v13, s[4:7], s85 offen sc1
buffer_load_dword v118, v14, s[4:7], s85 offen sc1
buffer_load_dword v119, v15, s[4:7], s85 offen sc1
s_waitcnt vmcnt(6)
v_mfma_f32_16x16x32_bf16 v[100:103], v[120:123], v[20:23], 0
v_max3_u32 v110, v121, v122, v123
v_cmp_eq_u32 vcc, -1, v110
s_nop 5
v_cvt_pk_bf16_f32 v106, v100, v101
v_cvt_pk_bf16_f32 v107, v102, v103
s_cbranch_vccz Lxs_432
buffer_load_dword v121, v13, s[4:7], s84 offen sc1
buffer_load_dword v122, v14, s[4:7], s84 offen sc1
buffer_load_dword v123, v15, s[4:7], s84 offen sc1
s_waitcnt vmcnt(6)
v_mfma_f32_16x16x32_bf16 v[100:103], v[112:115], v[20:23], 0
v_max3_u32 v110, v113, v114, v115
v_cmp_eq_u32 vcc, -1, v110
s_nop 5
v_cvt_pk_bf16_f32 v106, v100, v101
v_cvt_pk_bf16_f32 v107, v102, v103
s_cbranch_vccz Lxs_432
s_sub_u32 s37, s37, 1
s_cbranch_scc1 Lend_1
s_branch Lx2_431
Lpf_420:
buffer_load_dwordx4 v[28:31], v8, s[4:7], s40 offen offset:0 sc1
s_sub_u32 s37, s37, 1
s_cbranch_scc1 Lend_1
Lps_433:
s_waitcnt vmcnt(3)
v_max3_u32 v110, v32, v33, v34
v_max_u32 v110, v110, v35
v_cmp_eq_u32 vcc, -1, v110
s_cbranch_vccnz Lpf_434
v_smfmac_f32_16x16x64_bf16 v[44:47], v[32:35], a[32:39], v126
v_smfmac_f32_16x16x64_bf16 v[48:51], v[32:35], a[40:47], v126
v_smfmac_f32_16x16x64_bf16 v[52:55], v[32:35], a[48:55], v126
v_smfmac_f32_16x16x64_bf16 v[60:63], v[32:35], v[160:167], v126
Lps_435:
s_waitcnt vmcnt(2)
v_max3_u32 v110, v36, v37, v38
v_max_u32 v110, v110, v39
v_cmp_eq_u32 vcc, -1, v110
s_cbranch_vccnz Lpf_436
v_smfmac_f32_16x16x64_bf16 v[44:47], v[36:39], a[64:71], v126
v_smfmac_f32_16x16x64_bf16 v[48:51], v[36:39], a[72:79], v126
v_smfmac_f32_16x16x64_bf16 v[52:55], v[36:39], a[80:87], v126
v_smfmac_f32_16x16x64_bf16 v[60:63], v[36:39], v[192:199], v126
Lps_437:
s_waitcnt vmcnt(1)
v_max3_u32 v110, v40, v41, v42
v_max_u32 v110, v110, v43
v_cmp_eq_u32 vcc, -1, v110
s_cbranch_vccnz Lpf_438
v_smfmac_f32_16x16x64_bf16 v[44:47], v[40:43], a[96:103], v126
v_smfmac_f32_16x16x64_bf16 v[48:51], v[40:43], a[104:111], v126
v_smfmac_f32_16x16x64_bf16 v[52:55], v[40:43], a[112:119], v126
v_smfmac_f32_16x16x64_bf16 v[60:63], v[40:43], v[224:231], v126
Lps_439:
s_waitcnt vmcnt(0)
v_max3_u32 v110, v28, v29, v30
v_max_u32 v110, v110, v31
v_cmp_eq_u32 vcc, -1, v110
s_cbranch_vccnz Lpf_440
v_smfmac_f32_16x16x64_bf16 v[44:47], v[28:31], a[0:7], v126
s_nop 1
v_smfmac_f32_16x16x64_bf16 v[48:51], v[28:31], a[8:15], v126
s_nop 1
v_smfmac_f32_16x16x64_bf16 v[52:55], v[28:31], a[16:23], v126
s_nop 1
v_add_f32 v92, v44, v46
v_add_f32 v93, v45, v47
v_smfmac_f32_16x16x64_bf16 v[56:59], v[28:31], a[24:31], v126
v_add_f32 v94, v48, v50
v_add_f32 v95, v49, v51
ds_write_b64 v24, v[92:93] offset:0
v_add_f32 v96, v52, v54
v_add_f32 v97, v53, v55
ds_write_b64 v25, v[94:95] offset:0
v_smfmac_f32_16x16x64_bf16 v[56:59], v[32:35], a[56:63], v126
ds_write_b64 v26, v[96:97] offset:0
v_smfmac_f32_16x16x64_bf16 v[56:59], v[36:39], a[88:95], v126
v_smfmac_f32_16x16x64_bf16 v[56:59], v[40:43], a[120:127], v126
v_smfmac_f32_16x16x64_bf16 v[60:63], v[28:31], v[128:135], v126
s_branch Lpd_419
Lpf_421:
buffer_load_dwordx4 v[32:35], v8, s[4:7], s40 offen offset:1024 sc1
s_sub_u32 s37, s37, 1
s_cbranch_scc1 Lend_1
Lps_441:
s_waitcnt vmcnt(2)
v_max3_u32 v110, v36, v37, v38
v_max_u32 v110, v110, v39
v_cmp_eq_u32 vcc, -1, v110
s_cbranch_vccnz Lpf_442
v_smfmac_f32_16x16x64_bf16 v[44:47], v[36:39], a[64:71], v126
v_smfmac_f32_16x16x64_bf16 v[48:51], v[36:39], a[72:79], v126
v_smfmac_f32_16x16x64_bf16 v[52:55], v[36:39], a[80:87], v126
v_smfmac_f32_16x16x64_bf16 v[60:63], v[36:39], v[192:199], v126
Lps_443:
s_waitcnt vmcnt(1)
v_max3_u32 v110, v40, v41, v42
v_max_u32 v110, v110, v43
v_cmp_eq_u32 vcc, -1, v110
s_cbranch_vccnz Lpf_444
v_smfmac_f32_16x16x64_bf16 v[44:47], v[40:43], a[96:103], v126
v_smfmac_f32_16x16x64_bf16 v[48:51], v[40:43], a[104:111], v126
v_smfmac_f32_16x16x64_bf16 v[52:55], v[40:43], a[112:119], v126
v_smfmac_f32_16x16x64_bf16 v[60:63], v[40:43], v[224:231], v126
Lps_445:
s_waitcnt vmcnt(0)
v_max3_u32 v110, v32, v33, v34
v_max_u32 v110, v110, v35
v_cmp_eq_u32 vcc, -1, v110
s_cbranch_vccnz Lpf_446
v_smfmac_f32_16x16x64_bf16 v[44:47], v[32:35], a[32:39], v126
s_nop 1
v_smfmac_f32_16x16x64_bf16 v[48:51], v[32:35], a[40:47], v126
s_nop 1
v_smfmac_f32_16x16x64_bf16 v[52:55], v[32:35], a[48:55], v126
s_nop 1
v_add_f32 v92, v44, v46
v_add_f32 v93, v45, v47
v_smfmac_f32_16x16x64_bf16 v[56:59], v[28:31], a[24:31], v126
v_add_f32 v94, v48, v50
v_add_f32 v95, v49, v51
ds_write_b64 v24, v[92:93] offset:0
v_add_f32 v96, v52, v54
v_add_f32 v97, v53, v55
ds_write_b64 v25, v[94:95] offset:0
v_smfmac_f32_16x16x64_bf16 v[56:59], v[32:35], a[56:63], v126
ds_write_b64 v26, v[96:97] offset:0
v_smfmac_f32_16x16x64_bf16 v[56:59], v[36:39], a[88:95], v126
v_smfmac_f32_16x16x64_bf16 v[56:59], v[40:43], a[120:127], v126
v_smfmac_f32_16x16x64_bf16 v[60:63], v[32:35], v[160:167], v126
s_branch Lpd_419
Lpf_422:
buffer_load_dwordx4 v[36:39], v8, s[4:7], s40 offen offset:2048 sc1
s_sub_u32 s37, s37, 1
s_cbranch_scc1 Lend_1
Lps_447:
s_waitcnt vmcnt(1)
v_max3_u32 v110, v40, v41, v42
v_max_u32 v110, v110, v43
v_cmp_eq_u32 vcc, -1, v110
s_cbranch_vccnz Lpf_448
v_smfmac_f32_16x16x64_bf16 v[44:47], v[40:43], a[96:103], v126
v_smfmac_f32_16x16x64_bf16 v[48:51], v[40:43], a[104:111], v126
v_smfmac_f32_16x16x64_bf16 v[52:55], v[40:43], a[112:119], v126
v_smfmac_f32_16x16x64_bf16 v[60:63], v[40:43], v[224:231], v126
Lps_449:
s_waitcnt vmcnt(0)
v_max3_u32 v110, v36, v37, v38
v_max_u32 v110, v110, v39
v_cmp_eq_u32 vcc, -1, v110
s_cbranch_vccnz Lpf_450
v_smfmac_f32_16x16x64_bf16 v[44:47], v[36:39], a[64:71], v126
s_nop 1
v_smfmac_f32_16x16x64_bf16 v[48:51], v[36:39], a[72:79], v126
s_nop 1
v_smfmac_f32_16x16x64_bf16 v[52:55], v[36:39], a[80:87], v126
s_nop 1
v_add_f32 v92, v44, v46
v_add_f32 v93, v45, v47
v_smfmac_f32_16x16x64_bf16 v[56:59], v[28:31], a[24:31], v126
v_add_f32 v94, v48, v50
v_add_f32 v95, v49, v51
ds_write_b64 v24, v[92:93] offset:0
v_add_f32 v96, v52, v54
v_add_f32 v97, v53, v55
ds_write_b64 v25, v[94:95] offset:0
v_smfmac_f32_16x16x64_bf16 v[56:59], v[32:35], a[56:63], v126
ds_write_b64 v26, v[96:97] offset:0
v_smfmac_f32_16x16x64_bf16 v[56:59], v[36:39], a[88:95], v126
v_smfmac_f32_16x16x64_bf16 v[56:59], v[40:43], a[120:127], v126
v_smfmac_f32_16x16x64_bf16 v[60:63], v[36:39], v[192:199], v126
s_branch Lpd_419
Lpf_423:
buffer_load_dwordx4 v[40:43], v8, s[4:7], s40 offen offset:3072 sc1
s_sub_u32 s37, s37, 1
s_cbranch_scc1 Lend_1
Lps_451:
s_waitcnt vmcnt(0)
v_max3_u32 v110, v40, v41, v42
v_max_u32 v110, v110, v43
v_cmp_eq_u32 vcc, -1, v110
s_cbranch_vccnz Lpf_452
v_smfmac_f32_16x16x64_bf16 v[44:47], v[40:43], a[96:103], v126
s_nop 1
v_smfmac_f32_16x16x64_bf16 v[48:51], v[40:43], a[104:111], v126
s_nop 1
v_smfmac_f32_16x16x64_bf16 v[52:55], v[40:43], a[112:119], v126
s_nop 1
v_add_f32 v92, v44, v46
v_add_f32 v93, v45, v47
v_smfmac_f32_16x16x64_bf16 v[56:59], v[28:31], a[24:31], v126
v_add_f32 v94, v48, v50
v_add_f32 v95, v49, v51
ds_write_b64 v24, v[92:93] offset:0
v_add_f32 v96, v52, v54
v_add_f32 v97, v53, v55
ds_write_b64 v25, v[94:95] offset:0
v_smfmac_f32_16x16x64_bf16 v[56:59], v[32:35], a[56:63], v126
ds_write_b64 v26, v[96:97] offset:0
v_smfmac_f32_16x16x64_bf16 v[56:59], v[36:39], a[88:95], v126
v_smfmac_f32_16x16x64_bf16 v[56:59], v[40:43], a[120:127], v126
v_smfmac_f32_16x16x64_bf16 v[60:63], v[40:43], v[224:231], v126
s_branch Lpd_419
Lpf_434:
buffer_load_dwordx4 v[32:35], v8, s[4:7], s40 offen offset:1024 sc1
Lps_453:
s_waitcnt vmcnt(3)
v_max3_u32 v110, v36, v37, v38
v_max_u32 v110, v110, v39
v_cmp_eq_u32 vcc, -1, v110
s_cbranch_vccnz Lpf_454
v_smfmac_f32_16x16x64_bf16 v[44:47], v[36:39], a[64:71], v126
v_smfmac_f32_16x16x64_bf16 v[48:51], v[36:39], a[72:79], v126
v_smfmac_f32_16x16x64_bf16 v[52:55], v[36:39], a[80:87], v126
v_smfmac_f32_16x16x64_bf16 v[60:63], v[36:39], v[192:199], v126
Lps_455:
s_waitcnt vmcnt(2)
v_max3_u32 v110, v40, v41, v42
v_max_u32 v110, v110, v43
v_cmp_eq_u32 vcc, -1, v110
s_cbranch_vccnz Lpf_456
v_smfmac_f32_16x16x64_bf16 v[44:47], v[40:43], a[96:103], v126
v_smfmac_f32_16x16x64_bf16 v[48:51], v[40:43], a[104:111], v126
v_smfmac_f32_16x16x64_bf16 v[52:55], v[40:43], a[112:119], v126
v_smfmac_f32_16x16x64_bf16 v[60:63], v[40:43], v[224:231], v126
Lps_457:
s_waitcnt vmcnt(1)
v_max3_u32 v110, v28, v29, v30
v_max_u32 v110, v110, v31
v_cmp_eq_u32 vcc, -1, v110
s_cbranch_vccnz Lpf_458
v_smfmac_f32_16x16x64_bf16 v[44:47], v[28:31], a[0:7], v126
v_smfmac_f32_16x16x64_bf16 v[48:51], v[28:31], a[8:15], v126
v_smfmac_f32_16x16x64_bf16 v[52:55], v[28:31], a[16:23], v126
v_smfmac_f32_16x16x64_bf16 v[60:63], v[28:31], v[128:135], v126
s_branch Lps_445
Lpf_436:
buffer_load_dwordx4 v[36:39], v8, s[4:7], s40 offen offset:2048 sc1
Lps_459:
s_waitcnt vmcnt(2)
v_max3_u32 v110, v40, v41, v42
v_max_u32 v110, v110, v43
v_cmp_eq_u32 vcc, -1, v110
s_cbranch_vccnz Lpf_460
v_smfmac_f32_16x16x64_bf16 v[44:47], v[40:43], a[96:103], v126
v_smfmac_f32_16x16x64_bf16 v[48:51], v[40:43], a[104:111], v126
v_smfmac_f32_16x16x64_bf16 v[52:55], v[40:43], a[112:119], v126
v_smfmac_f32_16x16x64_bf16 v[60:63], v[40:43], v[224:231], v126
Lps_461:
s_waitcnt vmcnt(1)
v_max3_u32 v110, v28, v29, v30
v_max_u32 v110, v110, v31
v_cmp_eq_u32 vcc, -1, v110
s_cbranch_vccnz Lpf_462
v_smfmac_f32_16x16x64_bf16 v[44:47], v[28:31], a[0:7], v126
v_smfmac_f32_16x16x64_bf16 v[48:51], v[28:31], a[8:15], v126
v_smfmac_f32_16x16x64_bf16 v[52:55], v[28:31], a[16:23], v126
v_smfmac_f32_16x16x64_bf16 v[60:63], v[28:31], v[128:135], v126
s_branch Lps_449
Lpf_438:
buffer_load_dwordx4 v[40:43], v8, s[4:7], s40 offen offset:3072 sc1
Lps_463:
s_waitcnt vmcnt(1)
v_max3_u32 v110, v28, v29, v30
v_max_u32 v110, v110, v31
v_cmp_eq_u32 vcc, -1, v110
s_cbranch_vccnz Lpf_464
v_smfmac_f32_16x16x64_bf16 v[44:47], v[28:31], a[0:7], v126
v_smfmac_f32_16x16x64_bf16 v[48:51], v[28:31], a[8:15], v126
v_smfmac_f32_16x16x64_bf16 v[52:55], v[28:31], a[16:23], v126
v_smfmac_f32_16x16x64_bf16 v[60:63], v[28:31], v[128:135], v126
s_branch Lps_451
Lpf_440:
buffer_load_dwordx4 v[28:31], v8, s[4:7], s40 offen offset:0 sc1
s_sub_u32 s37, s37, 1
s_cbranch_scc1 Lend_1
s_branch Lps_439
Lpf_442:
buffer_load_dwordx4 v[36:39], v8, s[4:7], s40 offen offset:2048 sc1
Lps_465:
s_waitcnt vmcnt(2)
v_max3_u32 v110, v40, v41, v42
v_max_u32 v110, v110, v43
v_cmp_eq_u32 vcc, -1, v110
s_cbranch_vccnz Lpf_466
v_smfmac_f32_16x16x64_bf16 v[44:47], v[40:43], a[96:103], v126
v_smfmac_f32_16x16x64_bf16 v[48:51], v[40:43], a[104:111], v126
v_smfmac_f32_16x16x64_bf16 v[52:55], v[40:43], a[112:119], v126
v_smfmac_f32_16x16x64_bf16 v[60:63], v[40:43], v[224:231], v126
Lps_467:
s_waitcnt vmcnt(1)
v_max3_u32 v110, v32, v33, v34
v_max_u32 v110, v110, v35
v_cmp_eq_u32 vcc, -1, v110
s_cbranch_vccnz Lpf_468
v_smfmac_f32_16x16x64_bf16 v[44:47], v[32:35], a[32:39], v126
v_smfmac_f32_16x16x64_bf16 v[48:51], v[32:35], a[40:47], v126
v_smfmac_f32_16x16x64_bf16 v[52:55], v[32:35], a[48:55], v126
v_smfmac_f32_16x16x64_bf16 v[60:63], v[32:35], v[160:167], v126
s_branch Lps_449
Lpf_444:
buffer_load_dwordx4 v[40:43], v8, s[4:7], s40 offen offset:3072 sc1
Lps_469:
s_waitcnt vmcnt(1)
v_max3_u32 v110, v32, v33, v34
v_max_u32 v110, v110, v35
v_cmp_eq_u32 vcc, -1, v110
s_cbranch_vccnz Lpf_470
v_smfmac_f32_16x16x64_bf16 v[44:47], v[32:35], a[32:39], v126
v_smfmac_f32_16x16x64_bf16 v[48:51], v[32:35], a[40:47], v126
v_smfmac_f32_16x16x64_bf16 v[52:55], v[32:35], a[48:55], v126
v_smfmac_f32_16x16x64_bf16 v[60:63], v[32:35], v[160:167], v126
s_branch Lps_451
Lpf_446:
buffer_load_dwordx4 v[32:35], v8, s[4:7], s40 offen offset:1024 sc1
s_sub_u32 s37, s37, 1
s_cbranch_scc1 Lend_1
s_branch Lps_445
Lpf_448:
buffer_load_dwordx4 v[40:43], v8, s[4:7], s40 offen offset:3072 sc1
Lps_471:
s_waitcnt vmcnt(1)
v_max3_u32 v110, v36, v37, v38
v_max_u32 v110, v110, v39
v_cmp_eq_u32 vcc, -1, v110
s_cbranch_vccnz Lpf_472
v_smfmac_f32_16x16x64_bf16 v[44:47], v[36:39], a[64:71], v126
v_smfmac_f32_16x16x64_bf16 v[48:51], v[36:39], a[72:79], v126
v_smfmac_f32_16x16x64_bf16 v[52:55], v[36:39], a[80:87], v126
v_smfmac_f32_16x16x64_bf16 v[60:63], v[36:39], v[192:199], v126
s_branch Lps_451
Lpf_450:
buffer_load_dwordx4 v[36:39], v8, s[4:7], s40 offen offset:2048 sc1
s_sub_u32 s37, s37, 1
s_cbranch_scc1 Lend_1
s_branch Lps_449
Lpf_452:
buffer_load_dwordx4 v[40:43], v8, s[4:7], s40 offen offset:3072 sc1
s_sub_u32 s37, s37, 1
s_cbranch_scc1 Lend_1
s_branch Lps_451
Lpf_454:
buffer_load_dwordx4 v[36:39], v8, s[4:7], s40 offen offset:2048 sc1
Lps_473:
s_waitcnt vmcnt(3)
v_max3_u32 v110, v40, v41, v42
v_max_u32 v110, v110, v43
v_cmp_eq_u32 vcc, -1, v110
s_cbranch_vccnz Lpf_474
v_smfmac_f32_16x16x64_bf16 v[44:47], v[40:43], a[96:103], v126
v_smfmac_f32_16x16x64_bf16 v[48:51], v[40:43], a[104:111], v126
v_smfmac_f32_16x16x64_bf16 v[52:55], v[40:43], a[112:119], v126
v_smfmac_f32_16x16x64_bf16 v[60:63], v[40:43], v[224:231], v126
Lps_475:
s_waitcnt vmcnt(2)
v_max3_u32 v110, v28, v29, v30
v_max_u32 v110, v110, v31
v_cmp_eq_u32 vcc, -1, v110
s_cbranch_vccnz Lpf_476
v_smfmac_f32_16x16x64_bf16 v[44:47], v[28:31], a[0:7], v126
v_smfmac_f32_16x16x64_bf16 v[48:51], v[28:31], a[8:15], v126
v_smfmac_f32_16x16x64_bf16 v[52:55], v[28:31], a[16:23], v126
v_smfmac_f32_16x16x64_bf16 v[60:63], v[28:31], v[128:135], v126
s_branch Lps_467
Lpf_456:
buffer_load_dwordx4 v[40:43], v8, s[4:7], s40 offen offset:3072 sc1
Lps_477:
s_waitcnt vmcnt(2)
v_max3_u32 v110, v28, v29, v30
v_max_u32 v110, v110, v31
v_cmp_eq_u32 vcc, -1, v110
s_cbranch_vccnz Lpf_478
v_smfmac_f32_16x16x64_bf16 v[44:47], v[28:31], a[0:7], v126
v_smfmac_f32_16x16x64_bf16 v[48:51], v[28:31], a[8:15], v126
v_smfmac_f32_16x16x64_bf16 v[52:55], v[28:31], a[16:23], v126
v_smfmac_f32_16x16x64_bf16 v[60:63], v[28:31], v[128:135], v126
s_branch Lps_469
Lpf_458:
buffer_load_dwordx4 v[28:31], v8, s[4:7], s40 offen offset:0 sc1
s_sub_u32 s37, s37, 1
s_cbranch_scc1 Lend_1
Lps_479:
s_waitcnt vmcnt(1)
v_max3_u32 v110, v32, v33, v34
v_max_u32 v110, v110, v35
v_cmp_eq_u32 vcc, -1, v110
s_cbranch_vccnz Lpf_480
v_smfmac_f32_16x16x64_bf16 v[44:47], v[32:35], a[32:39], v126
v_smfmac_f32_16x16x64_bf16 v[48:51], v[32:35], a[40:47], v126
v_smfmac_f32_16x16x64_bf16 v[52:55], v[32:35], a[48:55], v126
v_smfmac_f32_16x16x64_bf16 v[60:63], v[32:35], v[160:167], v126
s_branch Lps_439
Lpf_460:
buffer_load_dwordx4 v[40:43], v8, s[4:7], s40 offen offset:3072 sc1
Lps_481:
s_waitcnt vmcnt(2)
v_max3_u32 v110, v28, v29, v30
v_max_u32 v110, v110, v31
v_cmp_eq_u32 vcc, -1, v110
s_cbranch_vccnz Lpf_482
v_smfmac_f32_16x16x64_bf16 v[44:47], v[28:31], a[0:7], v126
v_smfmac_f32_16x16x64_bf16 v[48:51], v[28:31], a[8:15], v126
v_smfmac_f32_16x16x64_bf16 v[52:55], v[28:31], a[16:23], v126
v_smfmac_f32_16x16x64_bf16 v[60:63], v[28:31], v[128:135], v126
s_branch Lps_471
Lpf_462:
buffer_load_dwordx4 v[28:31], v8, s[4:7], s40 offen offset:0 sc1
s_sub_u32 s37, s37, 1
s_cbranch_scc1 Lend_1
Lps_483:
s_waitcnt vmcnt(1)
v_max3_u32 v110, v36, v37, v38
v_max_u32 v110, v110, v39
v_cmp_eq_u32 vcc, -1, v110
s_cbranch_vccnz Lpf_484
v_smfmac_f32_16x16x64_bf16 v[44:47], v[36:39], a[64:71], v126
v_smfmac_f32_16x16x64_bf16 v[48:51], v[36:39], a[72:79], v126
v_smfmac_f32_16x16x64_bf16 v[52:55], v[36:39], a[80:87], v126
v_smfmac_f32_16x16x64_bf16 v[60:63], v[36:39], v[192:199], v126
s_branch Lps_439
Lpf_464:
buffer_load_dwordx4 v[28:31], v8, s[4:7], s40 offen offset:0 sc1
s_sub_u32 s37, s37, 1
s_cbranch_scc1 Lend_1
s_branch Lps_437
Lpf_466:
buffer_load_dwordx4 v[40:43], v8, s[4:7], s40 offen offset:3072 sc1
Lps_485:
s_waitcnt vmcnt(2)
v_max3_u32 v110, v32, v33, v34
v_max_u32 v110, v110, v35
v_cmp_eq_u32 vcc, -1, v110
s_cbranch_vccnz Lpf_486
v_smfmac_f32_16x16x64_bf16 v[44:47], v[32:35], a[32:39], v126
v_smfmac_f32_16x16x64_bf16 v[48:51], v[32:35], a[40:47], v126
v_smfmac_f32_16x16x64_bf16 v[52:55], v[32:35], a[48:55], v126
v_smfmac_f32_16x16x64_bf16 v[60:63], v[32:35], v[160:167], v126
s_branch Lps_471
Lpf_468:
buffer_load_dwordx4 v[32:35], v8, s[4:7], s40 offen offset:1024 sc1
s_sub_u32 s37, s37, 1
s_cbranch_scc1 Lend_1
Lps_487:
s_waitcnt vmcnt(1)
v_max3_u32 v110, v36, v37, v38
v_max_u32 v110, v110, v39
v_cmp_eq_u32 vcc, -1, v110
s_cbranch_vccnz Lpf_488
v_smfmac_f32_16x16x64_bf16 v[44:47], v[36:39], a[64:71], v126
v_smfmac_f32_16x16x64_bf16 v[48:51], v[36:39], a[72:79], v126
v_smfmac_f32_16x16x64_bf16 v[52:55], v[36:39], a[80:87], v126
v_smfmac_f32_16x16x64_bf16 v[60:63], v[36:39], v[192:199], v126
s_branch Lps_445
Lpf_470:
buffer_load_dwordx4 v[32:35], v8, s[4:7], s40 offen offset:1024 sc1
s_sub_u32 s37, s37, 1
s_cbranch_scc1 Lend_1
s_branch Lps_443
Lpf_472:
buffer_load_dwordx4 v[36:39], v8, s[4:7], s40 offen offset:2048 sc1
s_sub_u32 s37, s37, 1
s_cbranch_scc1 Lend_1
s_branch Lps_447
Lpf_474:
buffer_load_dwordx4 v[40:43], v8, s[4:7], s40 offen offset:3072 sc1
Lps_489:
s_waitcnt vmcnt(3)
v_max3_u32 v110, v28, v29, v30
v_max_u32 v110, v110, v31
v_cmp_eq_u32 vcc, -1, v110
s_cbranch_vccnz Lpf_490
v_smfmac_f32_16x16x64_bf16 v[44:47], v[28:31], a[0:7], v126
v_smfmac_f32_16x16x64_bf16 v[48:51], v[28:31], a[8:15], v126
v_smfmac_f32_16x16x64_bf16 v[52:55], v[28:31], a[16:23], v126
v_smfmac_f32_16x16x64_bf16 v[60:63], v[28:31], v[128:135], v126
s_branch Lps_485
Lpf_476:
buffer_load_dwordx4 v[28:31], v8, s[4:7], s40 offen offset:0 sc1
s_sub_u32 s37, s37, 1
s_cbranch_scc1 Lend_1
Lps_491:
s_waitcnt vmcnt(2)
v_max3_u32 v110, v32, v33, v34
v_max_u32 v110, v110, v35
v_cmp_eq_u32 vcc, -1, v110
s_cbranch_vccnz Lpf_492
v_smfmac_f32_16x16x64_bf16 v[44:47], v[32:35], a[32:39], v126
v_smfmac_f32_16x16x64_bf16 v[48:51], v[32:35], a[40:47], v126
v_smfmac_f32_16x16x64_bf16 v[52:55], v[32:35], a[48:55], v126
v_smfmac_f32_16x16x64_bf16 v[60:63], v[32:35], v[160:167], v126
s_branch Lps_483
Lpf_478:
buffer_load_dwordx4 v[28:31], v8, s[4:7], s40 offen offset:0 sc1
s_sub_u32 s37, s37, 1
s_cbranch_scc1 Lend_1
Lps_493:
s_waitcnt vmcnt(2)
v_max3_u32 v110, v32, v33, v34
v_max_u32 v110, v110, v35
v_cmp_eq_u32 vcc, -1, v110
s_cbranch_vccnz Lpf_494
v_smfmac_f32_16x16x64_bf16 v[44:47], v[32:35], a[32:39], v126
v_smfmac_f32_16x16x64_bf16 v[48:51], v[32:35], a[40:47], v126
v_smfmac_f32_16x16x64_bf16 v[52:55], v[32:35], a[48:55], v126
v_smfmac_f32_16x16x64_bf16 v[60:63], v[32:35], v[160:167], v126
s_branch Lps_437
Lpf_480:
buffer_load_dwordx4 v[32:35], v8, s[4:7], s40 offen offset:1024 sc1
s_branch Lps_457
Lpf_482:
buffer_load_dwordx4 v[28:31], v8, s[4:7], s40 offen offset:0 sc1
s_sub_u32 s37, s37, 1
s_cbranch_scc1 Lend_1
s_branch Lps_435
Lpf_484:
buffer_load_dwordx4 v[36:39], v8, s[4:7], s40 offen offset:2048 sc1
s_branch Lps_461
Lpf_486:
buffer_load_dwordx4 v[32:35], v8, s[4:7], s40 offen offset:1024 sc1
s_sub_u32 s37, s37, 1
s_cbranch_scc1 Lend_1
s_branch Lps_441
Lpf_488:
buffer_load_dwordx4 v[36:39], v8, s[4:7], s40 offen offset:2048 sc1
s_branch Lps_467
Lpf_490:
buffer_load_dwordx4 v[28:31], v8, s[4:7], s40 offen offset:0 sc1
s_sub_u32 s37, s37, 1
s_cbranch_scc1 Lend_1
s_branch Lps_433
Lpf_492:
buffer_load_dwordx4 v[32:35], v8, s[4:7], s40 offen offset:1024 sc1
Lps_495:
s_waitcnt vmcnt(2)
v_max3_u32 v110, v36, v37, v38
v_max_u32 v110, v110, v39
v_cmp_eq_u32 vcc, -1, v110
s_cbranch_vccnz Lpf_496
v_smfmac_f32_16x16x64_bf16 v[44:47], v[36:39], a[64:71], v126
v_smfmac_f32_16x16x64_bf16 v[48:51], v[36:39], a[72:79], v126
v_smfmac_f32_16x16x64_bf16 v[52:55], v[36:39], a[80:87], v126
v_smfmac_f32_16x16x64_bf16 v[60:63], v[36:39], v[192:199], v126
s_branch Lps_457
Lpf_494:
buffer_load_dwordx4 v[32:35], v8, s[4:7], s40 offen offset:1024 sc1
s_branch Lps_455
Lpf_496:
buffer_load_dwordx4 v[36:39], v8, s[4:7], s40 offen offset:2048 sc1
s_branch Lps_475
Lpf_427:
buffer_load_dwordx4 v[28:31], v9, s[4:7], s40 offen offset:0 sc1
s_sub_u32 s37, s37, 1
s_cbranch_scc1 Lend_1
Lps_497:
s_waitcnt vmcnt(3)
v_max3_u32 v110, v32, v33, v34
v_max_u32 v110, v110, v35
v_cmp_eq_u32 vcc, -1, v110
s_cbranch_vccnz Lpf_498
v_smfmac_f32_16x16x64_bf16 v[76:79], v[32:35], a[160:167], v126
v_smfmac_f32_16x16x64_bf16 v[80:83], v[32:35], a[168:175], v126
v_smfmac_f32_16x16x64_bf16 v[84:87], v[32:35], a[176:183], v126
Lps_499:
s_waitcnt vmcnt(2)
v_max3_u32 v110, v36, v37, v38
v_max_u32 v110, v110, v39
v_cmp_eq_u32 vcc, -1, v110
s_cbranch_vccnz Lpf_500
v_smfmac_f32_16x16x64_bf16 v[76:79], v[36:39], a[192:199], v126
v_smfmac_f32_16x16x64_bf16 v[80:83], v[36:39], a[200:207], v126
v_smfmac_f32_16x16x64_bf16 v[84:87], v[36:39], a[208:215], v126
Lps_501:
s_waitcnt vmcnt(1)
v_max3_u32 v110, v40, v41, v42
v_max_u32 v110, v110, v43
v_cmp_eq_u32 vcc, -1, v110
s_cbranch_vccnz Lpf_502
v_smfmac_f32_16x16x64_bf16 v[76:79], v[40:43], a[224:231], v126
v_smfmac_f32_16x16x64_bf16 v[80:83], v[40:43], a[232:239], v126
v_smfmac_f32_16x16x64_bf16 v[84:87], v[40:43], a[240:247], v126
Lps_503:
s_waitcnt vmcnt(0)
v_max3_u32 v110, v28, v29, v30
v_max_u32 v110, v110, v31
v_cmp_eq_u32 vcc, -1, v110
s_cbranch_vccnz Lpf_504
v_smfmac_f32_16x16x64_bf16 v[76:79], v[28:31], a[128:135], v126
s_nop 1
v_smfmac_f32_16x16x64_bf16 v[80:83], v[28:31], a[136:143], v126
s_nop 1
v_smfmac_f32_16x16x64_bf16 v[84:87], v[28:31], a[144:151], v126
s_nop 1
v_add_f32 v92, v76, v78
v_add_f32 v93, v77, v79
v_smfmac_f32_16x16x64_bf16 v[88:91], v[28:31], a[152:159], v126
v_add_f32 v94, v80, v82
v_add_f32 v95, v81, v83
ds_write_b64 v24, v[92:93] offset:12288
v_add_f32 v96, v84, v86
v_add_f32 v97, v85, v87
ds_write_b64 v25, v[94:95] offset:12288
v_smfmac_f32_16x16x64_bf16 v[88:91], v[32:35], a[184:191], v126
ds_write_b64 v26, v[96:97] offset:12288
v_smfmac_f32_16x16x64_bf16 v[88:91], v[36:39], a[216:223], v126
v_smfmac_f32_16x16x64_bf16 v[88:91], v[40:43], a[248:255], v126
s_branch Lpd_426
Lpf_428:
buffer_load_dwordx4 v[32:35], v9, s[4:7], s40 offen offset:1024 sc1
s_sub_u32 s37, s37, 1
s_cbranch_scc1 Lend_1
Lps_505:
s_waitcnt vmcnt(2)
v_max3_u32 v110, v36, v37, v38
v_max_u32 v110, v110, v39
v_cmp_eq_u32 vcc, -1, v110
s_cbranch_vccnz Lpf_506
v_smfmac_f32_16x16x64_bf16 v[76:79], v[36:39], a[192:199], v126
v_smfmac_f32_16x16x64_bf16 v[80:83], v[36:39], a[200:207], v126
v_smfmac_f32_16x16x64_bf16 v[84:87], v[36:39], a[208:215], v126
Lps_507:
s_waitcnt vmcnt(1)
v_max3_u32 v110, v40, v41, v42
v_max_u32 v110, v110, v43
v_cmp_eq_u32 vcc, -1, v110
s_cbranch_vccnz Lpf_508
v_smfmac_f32_16x16x64_bf16 v[76:79], v[40:43], a[224:231], v126
v_smfmac_f32_16x16x64_bf16 v[80:83], v[40:43], a[232:239], v126
v_smfmac_f32_16x16x64_bf16 v[84:87], v[40:43], a[240:247], v126
Lps_509:
s_waitcnt vmcnt(0)
v_max3_u32 v110, v32, v33, v34
v_max_u32 v110, v110, v35
v_cmp_eq_u32 vcc, -1, v110
s_cbranch_vccnz Lpf_510
v_smfmac_f32_16x16x64_bf16 v[76:79], v[32:35], a[160:167], v126
s_nop 1
v_smfmac_f32_16x16x64_bf16 v[80:83], v[32:35], a[168:175], v126
s_nop 1
v_smfmac_f32_16x16x64_bf16 v[84:87], v[32:35], a[176:183], v126
s_nop 1
v_add_f32 v92, v76, v78
v_add_f32 v93, v77, v79
v_smfmac_f32_16x16x64_bf16 v[88:91], v[28:31], a[152:159], v126
v_add_f32 v94, v80, v82
v_add_f32 v95, v81, v83
ds_write_b64 v24, v[92:93] offset:12288
v_add_f32 v96, v84, v86
v_add_f32 v97, v85, v87
ds_write_b64 v25, v[94:95] offset:12288
v_smfmac_f32_16x16x64_bf16 v[88:91], v[32:35], a[184:191], v126
ds_write_b64 v26, v[96:97] offset:12288
v_smfmac_f32_16x16x64_bf16 v[88:91], v[36:39], a[216:223], v126
v_smfmac_f32_16x16x64_bf16 v[88:91], v[40:43], a[248:255], v126
s_branch Lpd_426
Lpf_429:
buffer_load_dwordx4 v[36:39], v9, s[4:7], s40 offen offset:2048 sc1
s_sub_u32 s37, s37, 1
s_cbranch_scc1 Lend_1
Lps_511:
s_waitcnt vmcnt(1)
v_max3_u32 v110, v40, v41, v42
v_max_u32 v110, v110, v43
v_cmp_eq_u32 vcc, -1, v110
s_cbranch_vccnz Lpf_512
v_smfmac_f32_16x16x64_bf16 v[76:79], v[40:43], a[224:231], v126
v_smfmac_f32_16x16x64_bf16 v[80:83], v[40:43], a[232:239], v126
v_smfmac_f32_16x16x64_bf16 v[84:87], v[40:43], a[240:247], v126
Lps_513:
s_waitcnt vmcnt(0)
v_max3_u32 v110, v36, v37, v38
v_max_u32 v110, v110, v39
v_cmp_eq_u32 vcc, -1, v110
s_cbranch_vccnz Lpf_514
v_smfmac_f32_16x16x64_bf16 v[76:79], v[36:39], a[192:199], v126
s_nop 1
v_smfmac_f32_16x16x64_bf16 v[80:83], v[36:39], a[200:207], v126
s_nop 1
v_smfmac_f32_16x16x64_bf16 v[84:87], v[36:39], a[208:215], v126
s_nop 1
v_add_f32 v92, v76, v78
v_add_f32 v93, v77, v79
v_smfmac_f32_16x16x64_bf16 v[88:91], v[28:31], a[152:159], v126
v_add_f32 v94, v80, v82
v_add_f32 v95, v81, v83
ds_write_b64 v24, v[92:93] offset:12288
v_add_f32 v96, v84, v86
v_add_f32 v97, v85, v87
ds_write_b64 v25, v[94:95] offset:12288
v_smfmac_f32_16x16x64_bf16 v[88:91], v[32:35], a[184:191], v126
ds_write_b64 v26, v[96:97] offset:12288
v_smfmac_f32_16x16x64_bf16 v[88:91], v[36:39], a[216:223], v126
v_smfmac_f32_16x16x64_bf16 v[88:91], v[40:43], a[248:255], v126
s_branch Lpd_426
Lpf_430:
buffer_load_dwordx4 v[40:43], v9, s[4:7], s40 offen offset:3072 sc1
s_sub_u32 s37, s37, 1
s_cbranch_scc1 Lend_1
Lps_515:
s_waitcnt vmcnt(0)
v_max3_u32 v110, v40, v41, v42
v_max_u32 v110, v110, v43
v_cmp_eq_u32 vcc, -1, v110
s_cbranch_vccnz Lpf_516
v_smfmac_f32_16x16x64_bf16 v[76:79], v[40:43], a[224:231], v126
s_nop 1
v_smfmac_f32_16x16x64_bf16 v[80:83], v[40:43], a[232:239], v126
s_nop 1
v_smfmac_f32_16x16x64_bf16 v[84:87], v[40:43], a[240:247], v126
s_nop 1
v_add_f32 v92, v76, v78
v_add_f32 v93, v77, v79
v_smfmac_f32_16x16x64_bf16 v[88:91], v[28:31], a[152:159], v126
v_add_f32 v94, v80, v82
v_add_f32 v95, v81, v83
ds_write_b64 v24, v[92:93] offset:12288
v_add_f32 v96, v84, v86
v_add_f32 v97, v85, v87
ds_write_b64 v25, v[94:95] offset:12288
v_smfmac_f32_16x16x64_bf16 v[88:91], v[32:35], a[184:191], v126
ds_write_b64 v26, v[96:97] offset:12288
v_smfmac_f32_16x16x64_bf16 v[88:91], v[36:39], a[216:223], v126
v_smfmac_f32_16x16x64_bf16 v[88:91], v[40:43], a[248:255], v126
s_branch Lpd_426
Lpf_498:
buffer_load_dwordx4 v[32:35], v9, s[4:7], s40 offen offset:1024 sc1
Lps_517:
s_waitcnt vmcnt(3)
v_max3_u32 v110, v36, v37, v38
v_max_u32 v110, v110, v39
v_cmp_eq_u32 vcc, -1, v110
s_cbranch_vccnz Lpf_518
v_smfmac_f32_16x16x64_bf16 v[76:79], v[36:39], a[192:199], v126
v_smfmac_f32_16x16x64_bf16 v[80:83], v[36:39], a[200:207], v126
v_smfmac_f32_16x16x64_bf16 v[84:87], v[36:39], a[208:215], v126
Lps_519:
s_waitcnt vmcnt(2)
v_max3_u32 v110, v40, v41, v42
v_max_u32 v110, v110, v43
v_cmp_eq_u32 vcc, -1, v110
s_cbranch_vccnz Lpf_520
v_smfmac_f32_16x16x64_bf16 v[76:79], v[40:43], a[224:231], v126
v_smfmac_f32_16x16x64_bf16 v[80:83], v[40:43], a[232:239], v126
v_smfmac_f32_16x16x64_bf16 v[84:87], v[40:43], a[240:247], v126
Lps_521:
s_waitcnt vmcnt(1)
v_max3_u32 v110, v28, v29, v30
v_max_u32 v110, v110, v31
v_cmp_eq_u32 vcc, -1, v110
s_cbranch_vccnz Lpf_522
v_smfmac_f32_16x16x64_bf16 v[76:79], v[28:31], a[128:135], v126
v_smfmac_f32_16x16x64_bf16 v[80:83], v[28:31], a[136:143], v126
v_smfmac_f32_16x16x64_bf16 v[84:87], v[28:31], a[144:151], v126
s_branch Lps_509
Lpf_500:
buffer_load_dwordx4 v[36:39], v9, s[4:7], s40 offen offset:2048 sc1
Lps_523:
s_waitcnt vmcnt(2)
v_max3_u32 v110, v40, v41, v42
v_max_u32 v110, v110, v43
v_cmp_eq_u32 vcc, -1, v110
s_cbranch_vccnz Lpf_524
v_smfmac_f32_16x16x64_bf16 v[76:79], v[40:43], a[224:231], v126
v_smfmac_f32_16x16x64_bf16 v[80:83], v[40:43], a[232:239], v126
v_smfmac_f32_16x16x64_bf16 v[84:87], v[40:43], a[240:247], v126
Lps_525:
s_waitcnt vmcnt(1)
v_max3_u32 v110, v28, v29, v30
v_max_u32 v110, v110, v31
v_cmp_eq_u32 vcc, -1, v110
s_cbranch_vccnz Lpf_526
v_smfmac_f32_16x16x64_bf16 v[76:79], v[28:31], a[128:135], v126
v_smfmac_f32_16x16x64_bf16 v[80:83], v[28:31], a[136:143], v126
v_smfmac_f32_16x16x64_bf16 v[84:87], v[28:31], a[144:151], v126
s_branch Lps_513
Lpf_502:
buffer_load_dwordx4 v[40:43], v9, s[4:7], s40 offen offset:3072 sc1
Lps_527:
s_waitcnt vmcnt(1)
v_max3_u32 v110, v28, v29, v30
v_max_u32 v110, v110, v31
v_cmp_eq_u32 vcc, -1, v110
s_cbranch_vccnz Lpf_528
v_smfmac_f32_16x16x64_bf16 v[76:79], v[28:31], a[128:135], v126
v_smfmac_f32_16x16x64_bf16 v[80:83], v[28:31], a[136:143], v126
v_smfmac_f32_16x16x64_bf16 v[84:87], v[28:31], a[144:151], v126
s_branch Lps_515
Lpf_504:
buffer_load_dwordx4 v[28:31], v9, s[4:7], s40 offen offset:0 sc1
s_sub_u32 s37, s37, 1
s_cbranch_scc1 Lend_1
s_branch Lps_503
Lpf_506:
buffer_load_dwordx4 v[36:39], v9, s[4:7], s40 offen offset:2048 sc1
Lps_529:
s_waitcnt vmcnt(2)
v_max3_u32 v110, v40, v41, v42
v_max_u32 v110, v110, v43
v_cmp_eq_u32 vcc, -1, v110
s_cbranch_vccnz Lpf_530
v_smfmac_f32_16x16x64_bf16 v[76:79], v[40:43], a[224:231], v126
v_smfmac_f32_16x16x64_bf16 v[80:83], v[40:43], a[232:239], v126
v_smfmac_f32_16x16x64_bf16 v[84:87], v[40:43], a[240:247], v126
Lps_531:
s_waitcnt vmcnt(1)
v_max3_u32 v110, v32, v33, v34
v_max_u32 v110, v110, v35
v_cmp_eq_u32 vcc, -1, v110
s_cbranch_vccnz Lpf_532
v_smfmac_f32_16x16x64_bf16 v[76:79], v[32:35], a[160:167], v126
v_smfmac_f32_16x16x64_bf16 v[80:83], v[32:35], a[168:175], v126
v_smfmac_f32_16x16x64_bf16 v[84:87], v[32:35], a[176:183], v126
s_branch Lps_513
Lpf_508:
buffer_load_dwordx4 v[40:43], v9, s[4:7], s40 offen offset:3072 sc1
Lps_533:
s_waitcnt vmcnt(1)
v_max3_u32 v110, v32, v33, v34
v_max_u32 v110, v110, v35
v_cmp_eq_u32 vcc, -1, v110
s_cbranch_vccnz Lpf_534
v_smfmac_f32_16x16x64_bf16 v[76:79], v[32:35], a[160:167], v126
v_smfmac_f32_16x16x64_bf16 v[80:83], v[32:35], a[168:175], v126
v_smfmac_f32_16x16x64_bf16 v[84:87], v[32:35], a[176:183], v126
s_branch Lps_515
Lpf_510:
buffer_load_dwordx4 v[32:35], v9, s[4:7], s40 offen offset:1024 sc1
s_sub_u32 s37, s37, 1
s_cbranch_scc1 Lend_1
s_branch Lps_509
Lpf_512:
buffer_load_dwordx4 v[40:43], v9, s[4:7], s40 offen offset:3072 sc1
Lps_535:
s_waitcnt vmcnt(1)
v_max3_u32 v110, v36, v37, v38
v_max_u32 v110, v110, v39
v_cmp_eq_u32 vcc, -1, v110
s_cbranch_vccnz Lpf_536
v_smfmac_f32_16x16x64_bf16 v[76:79], v[36:39], a[192:199], v126
v_smfmac_f32_16x16x64_bf16 v[80:83], v[36:39], a[200:207], v126
v_smfmac_f32_16x16x64_bf16 v[84:87], v[36:39], a[208:215], v126
s_branch Lps_515
Lpf_514:
buffer_load_dwordx4 v[36:39], v9, s[4:7], s40 offen offset:2048 sc1
s_sub_u32 s37, s37, 1
s_cbranch_scc1 Lend_1
s_branch Lps_513
Lpf_516:
buffer_load_dwordx4 v[40:43], v9, s[4:7], s40 offen offset:3072 sc1
s_sub_u32 s37, s37, 1
s_cbranch_scc1 Lend_1
s_branch Lps_515
Lpf_518:
buffer_load_dwordx4 v[36:39], v9, s[4:7], s40 offen offset:2048 sc1
Lps_537:
s_waitcnt vmcnt(3)
v_max3_u32 v110, v40, v41, v42
v_max_u32 v110, v110, v43
v_cmp_eq_u32 vcc, -1, v110
s_cbranch_vccnz Lpf_538
v_smfmac_f32_16x16x64_bf16 v[76:79], v[40:43], a[224:231], v126
v_smfmac_f32_16x16x64_bf16 v[80:83], v[40:43], a[232:239], v126
v_smfmac_f32_16x16x64_bf16 v[84:87], v[40:43], a[240:247], v126
Lps_539:
s_waitcnt vmcnt(2)
v_max3_u32 v110, v28, v29, v30
v_max_u32 v110, v110, v31
v_cmp_eq_u32 vcc, -1, v110
s_cbranch_vccnz Lpf_540
v_smfmac_f32_16x16x64_bf16 v[76:79], v[28:31], a[128:135], v126
v_smfmac_f32_16x16x64_bf16 v[80:83], v[28:31], a[136:143], v126
v_smfmac_f32_16x16x64_bf16 v[84:87], v[28:31], a[144:151], v126
s_branch Lps_531
Lpf_520:
buffer_load_dwordx4 v[40:43], v9, s[4:7], s40 offen offset:3072 sc1
Lps_541:
s_waitcnt vmcnt(2)
v_max3_u32 v110, v28, v29, v30
v_max_u32 v110, v110, v31
v_cmp_eq_u32 vcc, -1, v110
s_cbranch_vccnz Lpf_542
v_smfmac_f32_16x16x64_bf16 v[76:79], v[28:31], a[128:135], v126
v_smfmac_f32_16x16x64_bf16 v[80:83], v[28:31], a[136:143], v126
v_smfmac_f32_16x16x64_bf16 v[84:87], v[28:31], a[144:151], v126
s_branch Lps_533
Lpf_522:
buffer_load_dwordx4 v[28:31], v9, s[4:7], s40 offen offset:0 sc1
s_sub_u32 s37, s37, 1
s_cbranch_scc1 Lend_1
Lps_543:
s_waitcnt vmcnt(1)
v_max3_u32 v110, v32, v33, v34
v_max_u32 v110, v110, v35
v_cmp_eq_u32 vcc, -1, v110
s_cbranch_vccnz Lpf_544
v_smfmac_f32_16x16x64_bf16 v[76:79], v[32:35], a[160:167], v126
v_smfmac_f32_16x16x64_bf16 v[80:83], v[32:35], a[168:175], v126
v_smfmac_f32_16x16x64_bf16 v[84:87], v[32:35], a[176:183], v126
s_branch Lps_503
Lpf_524:
buffer_load_dwordx4 v[40:43], v9, s[4:7], s40 offen offset:3072 sc1
Lps_545:
s_waitcnt vmcnt(2)
v_max3_u32 v110, v28, v29, v30
v_max_u32 v110, v110, v31
v_cmp_eq_u32 vcc, -1, v110
s_cbranch_vccnz Lpf_546
v_smfmac_f32_16x16x64_bf16 v[76:79], v[28:31], a[128:135], v126
v_smfmac_f32_16x16x64_bf16 v[80:83], v[28:31], a[136:143], v126
v_smfmac_f32_16x16x64_bf16 v[84:87], v[28:31], a[144:151], v126
s_branch Lps_535
Lpf_526:
buffer_load_dwordx4 v[28:31], v9, s[4:7], s40 offen offset:0 sc1
s_sub_u32 s37, s37, 1
s_cbranch_scc1 Lend_1
Lps_547:
s_waitcnt vmcnt(1)
v_max3_u32 v110, v36, v37, v38
v_max_u32 v110, v110, v39
v_cmp_eq_u32 vcc, -1, v110
s_cbranch_vccnz Lpf_548
v_smfmac_f32_16x16x64_bf16 v[76:79], v[36:39], a[192:199], v126
v_smfmac_f32_16x16x64_bf16 v[80:83], v[36:39], a[200:207], v126
v_smfmac_f32_16x16x64_bf16 v[84:87], v[36:39], a[208:215], v126
s_branch Lps_503
Lpf_528:
buffer_load_dwordx4 v[28:31], v9, s[4:7], s40 offen offset:0 sc1
s_sub_u32 s37, s37, 1
s_cbranch_scc1 Lend_1
s_branch Lps_501
Lpf_530:
buffer_load_dwordx4 v[40:43], v9, s[4:7], s40 offen offset:3072 sc1
Lps_549:
s_waitcnt vmcnt(2)
v_max3_u32 v110, v32, v33, v34
v_max_u32 v110, v110, v35
v_cmp_eq_u32 vcc, -1, v110
s_cbranch_vccnz Lpf_550
v_smfmac_f32_16x16x64_bf16 v[76:79], v[32:35], a[160:167], v126
v_smfmac_f32_16x16x64_bf16 v[80:83], v[32:35], a[168:175], v126
v_smfmac_f32_16x16x64_bf16 v[84:87], v[32:35], a[176:183], v126
s_branch Lps_535
Lpf_532:
buffer_load_dwordx4 v[32:35], v9, s[4:7], s40 offen offset:1024 sc1
s_sub_u32 s37, s37, 1
s_cbranch_scc1 Lend_1
Lps_551:
s_waitcnt vmcnt(1)
v_max3_u32 v110, v36, v37, v38
v_max_u32 v110, v110, v39
v_cmp_eq_u32 vcc, -1, v110
s_cbranch_vccnz Lpf_552
v_smfmac_f32_16x16x64_bf16 v[76:79], v[36:39], a[192:199], v126
v_smfmac_f32_16x16x64_bf16 v[80:83], v[36:39], a[200:207], v126
v_smfmac_f32_16x16x64_bf16 v[84:87], v[36:39], a[208:215], v126
s_branch Lps_509
Lpf_534:
buffer_load_dwordx4 v[32:35], v9, s[4:7], s40 offen offset:1024 sc1
s_sub_u32 s37, s37, 1
s_cbranch_scc1 Lend_1
s_branch Lps_507
Lpf_536:
buffer_load_dwordx4 v[36:39], v9, s[4:7], s40 offen offset:2048 sc1
s_sub_u32 s37, s37, 1
s_cbranch_scc1 Lend_1
s_branch Lps_511
Lpf_538:
buffer_load_dwordx4 v[40:43], v9, s[4:7], s40 offen offset:3072 sc1
Lps_553:
s_waitcnt vmcnt(3)
v_max3_u32 v110, v28, v29, v30
v_max_u32 v110, v110, v31
v_cmp_eq_u32 vcc, -1, v110
s_cbranch_vccnz Lpf_554
v_smfmac_f32_16x16x64_bf16 v[76:79], v[28:31], a[128:135], v126
v_smfmac_f32_16x16x64_bf16 v[80:83], v[28:31], a[136:143], v126
v_smfmac_f32_16x16x64_bf16 v[84:87], v[28:31], a[144:151], v126
s_branch Lps_549
Lpf_540:
buffer_load_dwordx4 v[28:31], v9, s[4:7], s40 offen offset:0 sc1
s_sub_u32 s37, s37, 1
s_cbranch_scc1 Lend_1
Lps_555:
s_waitcnt vmcnt(2)
v_max3_u32 v110, v32, v33, v34
v_max_u32 v110, v110, v35
v_cmp_eq_u32 vcc, -1, v110
s_cbranch_vccnz Lpf_556
v_smfmac_f32_16x16x64_bf16 v[76:79], v[32:35], a[160:167], v126
v_smfmac_f32_16x16x64_bf16 v[80:83], v[32:35], a[168:175], v126
v_smfmac_f32_16x16x64_bf16 v[84:87], v[32:35], a[176:183], v126
s_branch Lps_547
Lpf_542:
buffer_load_dwordx4 v[28:31], v9, s[4:7], s40 offen offset:0 sc1
s_sub_u32 s37, s37, 1
s_cbranch_scc1 Lend_1
Lps_557:
s_waitcnt vmcnt(2)
v_max3_u32 v110, v32, v33, v34
v_max_u32 v110, v110, v35
v_cmp_eq_u32 vcc, -1, v110
s_cbranch_vccnz Lpf_558
v_smfmac_f32_16x16x64_bf16 v[76:79], v[32:35], a[160:167], v126
v_smfmac_f32_16x16x64_bf16 v[80:83], v[32:35], a[168:175], v126
v_smfmac_f32_16x16x64_bf16 v[84:87], v[32:35], a[176:183], v126
s_branch Lps_501
Lpf_544:
buffer_load_dwordx4 v[32:35], v9, s[4:7], s40 offen offset:1024 sc1
s_branch Lps_521
Lpf_546:
buffer_load_dwordx4 v[28:31], v9, s[4:7], s40 offen offset:0 sc1
s_sub_u32 s37, s37, 1
s_cbranch_scc1 Lend_1
s_branch Lps_499
Lpf_548:
buffer_load_dwordx4 v[36:39], v9, s[4:7], s40 offen offset:2048 sc1
s_branch Lps_525
Lpf_550:
buffer_load_dwordx4 v[32:35], v9, s[4:7], s40 offen offset:1024 sc1
s_sub_u32 s37, s37, 1
s_cbranch_scc1 Lend_1
s_branch Lps_505
Lpf_552:
buffer_load_dwordx4 v[36:39], v9, s[4:7], s40 offen offset:2048 sc1
s_branch Lps_531
Lpf_554:
buffer_load_dwordx4 v[28:31], v9, s[4:7], s40 offen offset:0 sc1
s_sub_u32 s37, s37, 1
s_cbranch_scc1 Lend_1
s_branch Lps_497
Lpf_556:
buffer_load_dwordx4 v[32:35], v9, s[4:7], s40 offen offset:1024 sc1
Lps_559:
s_waitcnt vmcnt(2)
v_max3_u32 v110, v36, v37, v38
v_max_u32 v110, v110, v39
v_cmp_eq_u32 vcc, -1, v110
s_cbranch_vccnz Lpf_560
v_smfmac_f32_16x16x64_bf16 v[76:79], v[36:39], a[192:199], v126
v_smfmac_f32_16x16x64_bf16 v[80:83], v[36:39], a[200:207], v126
v_smfmac_f32_16x16x64_bf16 v[84:87], v[36:39], a[208:215], v126
s_branch Lps_521
Lpf_558:
buffer_load_dwordx4 v[32:35], v9, s[4:7], s40 offen offset:1024 sc1
s_branch Lps_519
Lpf_560:
buffer_load_dwordx4 v[36:39], v9, s[4:7], s40 offen offset:2048 sc1
s_branch Lps_539
Lg3_3:
v_mov_b32 v9, v1
s_sub_u32 s26, s34, 24
s_lshl_b32 s44, s33, 3
s_add_u32 s44, s44, s26
s_lshl_b32 s38, s44, 7
s_add_u32 s38, s38, 3440640
v_min_u32 v80, 1, v0
v_lshl_add_u32 v4, v80, 30, s38
v_mov_b32 v5, 0
buffer_store_dword v5, v4, s[4:7], 0 offen sc1
s_mov_b32 s52, 1
s_mov_b32 s38, 4096
buffer_store_dword v5, v4, s[4:7], s38 offen sc1
s_lshl_b32 s38, s44, 7
s_add_u32 s38, s38, 3436544
v_min_u32 v80, 1, v0
v_lshl_add_u32 v7, v80, 30, s38
buffer_store_dword v5, v7, s[4:7], 0 offen sc1
s_lshl_b32 s38, s35, 16
s_or_b32 s52, s52, s38
s_waitcnt vmcnt(0)
s_cmp_lg_u32 s32, 0
s_cbranch_scc1 Lar_562
s_mov_b64 exec, 1
v_mov_b32 v48, 32
v_mov_b32 v49, s52
buffer_atomic_add v49, v48, s[12:15], 0 offen sc1
s_mov_b64 exec, -1
Lar_562:
s_mov_b32 s8, s24
s_and_b32 s9, s25, 0xffff
s_mov_b32 s10, 0x800000
s_mov_b32 s11, 0x20000
s_lshl_b32 s60, s33, 21
s_lshl_b32 s38, s26, 8
s_add_u32 s60, s60, s38
s_add_u32 s61, s60, 128
s_lshr_b32 s52, s32, 1
s_lshl_b32 s52, s52, 14
s_and_b32 s53, s32, 1
s_lshl_b32 s53, s53, 6
s_add_u32 s52, s52, s53
v_bfe_u32 v84, v9, 2, 2
v_lshrrev_b32 v85, 4, v9
v_lshl_add_u32 v84, v85, 2, v84
v_lshl_add_u32 v84, v84, 7, s52
v_and_b32 v85, 3, v9
v_lshl_add_u32 v84, v85, 4, v84
v_add_u32 v80, 0, v84
v_bfe_u32 v84, v9, 2, 2
v_lshrrev_b32 v85, 4, v9
v_lshl_add_u32 v84, v85, 2, v84
v_lshl_add_u32 v84, v84, 7, s52
v_and_b32 v85, 3, v9
v_lshl_add_u32 v84, v85, 4, v84
v_add_u32 v81, 8, v84
v_lshrrev_b32 v84, 3, v9
s_mul_i32 s38, s32, 256
v_add_u32 v84, s38, v84
v_mul_u32_u24 v84, 2048, v84
v_and_b32 v85, 7, v9
v_lshl_add_u32 v84, v85, 4, v84
s_lshl_b32 s38, s32, 12
s_barrier
s_add_u32 m0, s38, 0
s_add_u32 s39, s60, 0
buffer_load_dwordx4 v84, s[8:11], s39 offen lds
s_add_u32 m0, s38, 1024
s_add_u32 s39, s60, 16384
buffer_load_dwordx4 v84, s[8:11], s39 offen lds
s_add_u32 m0, s38, 2048
s_add_u32 s39, s60, 32768
buffer_load_dwordx4 v84, s[8:11], s39 offen lds
s_add_u32 m0, s38, 3072
s_add_u32 s39, s60, 49152
buffer_load_dwordx4 v84, s[8:11], s39 offen lds
s_add_u32 m0, s38, 16384
s_add_u32 s39, s61, 0
buffer_load_dwordx4 v84, s[8:11], s39 offen lds
s_add_u32 m0, s38, 17408
s_add_u32 s39, s61, 16384
buffer_load_dwordx4 v84, s[8:11], s39 offen lds
s_add_u32 m0, s38, 18432
s_add_u32 s39, s61, 32768
buffer_load_dwordx4 v84, s[8:11], s39 offen lds
s_add_u32 m0, s38, 19456
s_add_u32 s39, s61, 49152
buffer_load_dwordx4 v84, s[8:11], s39 offen lds
s_add_u32 m0, s38, 32768
s_add_u32 s39, s60, 65536
buffer_load_dwordx4 v84, s[8:11], s39 offen lds
s_add_u32 m0, s38, 33792
s_add_u32 s39, s60, 81920
buffer_load_dwordx4 v84, s[8:11], s39 offen lds
s_add_u32 m0, s38, 34816
s_add_u32 s39, s60, 98304
buffer_load_dwordx4 v84, s[8:11], s39 offen lds
s_add_u32 m0, s38, 35840
s_add_u32 s39, s60, 114688
buffer_load_dwordx4 v84, s[8:11], s39 offen lds
s_add_u32 m0, s38, 49152
s_add_u32 s39, s61, 65536
buffer_load_dwordx4 v84, s[8:11], s39 offen lds
s_add_u32 m0, s38, 50176
s_add_u32 s39, s61, 81920
buffer_load_dwordx4 v84, s[8:11], s39 offen lds
s_add_u32 m0, s38, 51200
s_add_u32 s39, s61, 98304
buffer_load_dwordx4 v84, s[8:11], s39 offen lds
s_add_u32 m0, s38, 52224
s_add_u32 s39, s61, 114688
buffer_load_dwordx4 v84, s[8:11], s39 offen lds
s_add_u32 m0, s38, 65536
s_add_u32 s39, s60, 131072
buffer_load_dwordx4 v84, s[8:11], s39 offen lds
s_add_u32 m0, s38, 66560
s_add_u32 s39, s60, 147456
buffer_load_dwordx4 v84, s[8:11], s39 offen lds
s_add_u32 m0, s38, 67584
s_add_u32 s39, s60, 163840
buffer_load_dwordx4 v84, s[8:11], s39 offen lds
s_add_u32 m0, s38, 68608
s_add_u32 s39, s60, 180224
buffer_load_dwordx4 v84, s[8:11], s39 offen lds
s_add_u32 m0, s38, 81920
s_add_u32 s39, s61, 131072
buffer_load_dwordx4 v84, s[8:11], s39 offen lds
s_add_u32 m0, s38, 82944
s_add_u32 s39, s61, 147456
buffer_load_dwordx4 v84, s[8:11], s39 offen lds
s_add_u32 m0, s38, 83968
s_add_u32 s39, s61, 163840
buffer_load_dwordx4 v84, s[8:11], s39 offen lds
s_add_u32 m0, s38, 84992
s_add_u32 s39, s61, 180224
buffer_load_dwordx4 v84, s[8:11], s39 offen lds
s_add_u32 m0, s38, 98304
s_add_u32 s39, s60, 196608
buffer_load_dwordx4 v84, s[8:11], s39 offen lds
s_add_u32 m0, s38, 99328
s_add_u32 s39, s60, 212992
buffer_load_dwordx4 v84, s[8:11], s39 offen lds
s_add_u32 m0, s38, 100352
s_add_u32 s39, s60, 229376
buffer_load_dwordx4 v84, s[8:11], s39 offen lds
s_add_u32 m0, s38, 101376
s_add_u32 s39, s60, 245760
buffer_load_dwordx4 v84, s[8:11], s39 offen lds
s_add_u32 m0, s38, 114688
s_add_u32 s39, s61, 196608
buffer_load_dwordx4 v84, s[8:11], s39 offen lds
s_add_u32 m0, s38, 115712
s_add_u32 s39, s61, 212992
buffer_load_dwordx4 v84, s[8:11], s39 offen lds
s_add_u32 m0, s38, 116736
s_add_u32 s39, s61, 229376
buffer_load_dwordx4 v84, s[8:11], s39 offen lds
s_add_u32 m0, s38, 117760
s_add_u32 s39, s61, 245760
buffer_load_dwordx4 v84, s[8:11], s39 offen lds
s_add_u32 m0, s38, 131072
s_add_u32 s39, s60, 262144
buffer_load_dwordx4 v84, s[8:11], s39 offen lds
s_add_u32 m0, s38, 132096
s_add_u32 s39, s60, 278528
buffer_load_dwordx4 v84, s[8:11], s39 offen lds
s_add_u32 m0, s38, 133120
s_add_u32 s39, s60, 294912
buffer_load_dwordx4 v84, s[8:11], s39 offen lds
s_add_u32 m0, s38, 134144
s_add_u32 s39, s60, 311296
buffer_load_dwordx4 v84, s[8:11], s39 offen lds
s_add_u32 m0, s38, 147456
s_add_u32 s39, s61, 262144
buffer_load_dwordx4 v84, s[8:11], s39 offen lds
s_add_u32 m0, s38, 148480
s_add_u32 s39, s61, 278528
buffer_load_dwordx4 v84, s[8:11], s39 offen lds
s_add_u32 m0, s38, 149504
s_add_u32 s39, s61, 294912
buffer_load_dwordx4 v84, s[8:11], s39 offen lds
s_add_u32 m0, s38, 150528
s_add_u32 s39, s61, 311296
buffer_load_dwordx4 v84, s[8:11], s39 offen lds
s_waitcnt vmcnt(32)
s_barrier
ds_read_b64_tr_b16 a[0:1], v80 offset:0
ds_read_b64_tr_b16 a[2:3], v80 offset:2048
ds_read_b64_tr_b16 a[32:33], v80 offset:4096
ds_read_b64_tr_b16 a[34:35], v80 offset:6144
ds_read_b64_tr_b16 a[64:65], v80 offset:8192
ds_read_b64_tr_b16 a[66:67], v80 offset:10240
ds_read_b64_tr_b16 a[96:97], v80 offset:12288
ds_read_b64_tr_b16 a[98:99], v80 offset:14336
ds_read_b64_tr_b16 a[128:129], v81 offset:0
ds_read_b64_tr_b16 a[130:131], v81 offset:2048
ds_read_b64_tr_b16 a[160:161], v81 offset:4096
ds_read_b64_tr_b16 a[162:163], v81 offset:6144
ds_read_b64_tr_b16 a[192:193], v81 offset:8192
ds_read_b64_tr_b16 a[194:195], v81 offset:10240
ds_read_b64_tr_b16 a[224:225], v81 offset:12288
ds_read_b64_tr_b16 a[226:227], v81 offset:14336
v_add_u32 v80, 32768, v80
v_add_u32 v81, 32768, v81
s_waitcnt lgkmcnt(0)
s_barrier
s_add_u32 m0, s38, 0
s_add_u32 s39, s60, 327680
buffer_load_dwordx4 v84, s[8:11], s39 offen lds
s_add_u32 m0, s38, 1024
s_add_u32 s39, s60, 344064
buffer_load_dwordx4 v84, s[8:11], s39 offen lds
s_add_u32 m0, s38, 2048
s_add_u32 s39, s60, 360448
buffer_load_dwordx4 v84, s[8:11], s39 offen lds
s_add_u32 m0, s38, 3072
s_add_u32 s39, s60, 376832
buffer_load_dwordx4 v84, s[8:11], s39 offen lds
s_add_u32 m0, s38, 16384
s_add_u32 s39, s61, 327680
buffer_load_dwordx4 v84, s[8:11], s39 offen lds
s_add_u32 m0, s38, 17408
s_add_u32 s39, s61, 344064
buffer_load_dwordx4 v84, s[8:11], s39 offen lds
s_add_u32 m0, s38, 18432
s_add_u32 s39, s61, 360448
buffer_load_dwordx4 v84, s[8:11], s39 offen lds
s_add_u32 m0, s38, 19456
s_add_u32 s39, s61, 376832
buffer_load_dwordx4 v84, s[8:11], s39 offen lds
s_waitcnt vmcnt(32)
s_barrier
ds_read_b64_tr_b16 a[4:5], v80 offset:0
ds_read_b64_tr_b16 a[6:7], v80 offset:2048
ds_read_b64_tr_b16 a[36:37], v80 offset:4096
ds_read_b64_tr_b16 a[38:39], v80 offset:6144
ds_read_b64_tr_b16 a[68:69], v80 offset:8192
ds_read_b64_tr_b16 a[70:71], v80 offset:10240
ds_read_b64_tr_b16 a[100:101], v80 offset:12288
ds_read_b64_tr_b16 a[102:103], v80 offset:14336
ds_read_b64_tr_b16 a[132:133], v81 offset:0
ds_read_b64_tr_b16 a[134:135], v81 offset:2048
ds_read_b64_tr_b16 a[164:165], v81 offset:4096
ds_read_b64_tr_b16 a[166:167], v81 offset:6144
ds_read_b64_tr_b16 a[196:197], v81 offset:8192
ds_read_b64_tr_b16 a[198:199], v81 offset:10240
ds_read_b64_tr_b16 a[228:229], v81 offset:12288
ds_read_b64_tr_b16 a[230:231], v81 offset:14336
v_add_u32 v80, 32768, v80
v_add_u32 v81, 32768, v81
s_waitcnt lgkmcnt(0)
s_barrier
s_add_u32 m0, s38, 32768
s_add_u32 s39, s60, 393216
buffer_load_dwordx4 v84, s[8:11], s39 offen lds
s_add_u32 m0, s38, 33792
s_add_u32 s39, s60, 409600
buffer_load_dwordx4 v84, s[8:11], s39 offen lds
s_add_u32 m0, s38, 34816
s_add_u32 s39, s60, 425984
buffer_load_dwordx4 v84, s[8:11], s39 offen lds
s_add_u32 m0, s38, 35840
s_add_u32 s39, s60, 442368
buffer_load_dwordx4 v84, s[8:11], s39 offen lds
s_add_u32 m0, s38, 49152
s_add_u32 s39, s61, 393216
buffer_load_dwordx4 v84, s[8:11], s39 offen lds
s_add_u32 m0, s38, 50176
s_add_u32 s39, s61, 409600
buffer_load_dwordx4 v84, s[8:11], s39 offen lds
s_add_u32 m0, s38, 51200
s_add_u32 s39, s61, 425984
buffer_load_dwordx4 v84, s[8:11], s39 offen lds
s_add_u32 m0, s38, 52224
s_add_u32 s39, s61, 442368
buffer_load_dwordx4 v84, s[8:11], s39 offen lds
s_waitcnt vmcnt(32)
s_barrier
ds_read_b64_tr_b16 a[8:9], v80 offset:0
ds_read_b64_tr_b16 a[10:11], v80 offset:2048
ds_read_b64_tr_b16 a[40:41], v80 offset:4096
ds_read_b64_tr_b16 a[42:43], v80 offset:6144
ds_read_b64_tr_b16 a[72:73], v80 offset:8192
ds_read_b64_tr_b16 a[74:75], v80 offset:10240
ds_read_b64_tr_b16 a[104:105], v80 offset:12288
ds_read_b64_tr_b16 a[106:107], v80 offset:14336
ds_read_b64_tr_b16 a[136:137], v81 offset:0
ds_read_b64_tr_b16 a[138:139], v81 offset:2048
ds_read_b64_tr_b16 a[168:169], v81 offset:4096
ds_read_b64_tr_b16 a[170:171], v81 offset:6144
ds_read_b64_tr_b16 a[200:201], v81 offset:8192
ds_read_b64_tr_b16 a[202:203], v81 offset:10240
ds_read_b64_tr_b16 a[232:233], v81 offset:12288
ds_read_b64_tr_b16 a[234:235], v81 offset:14336
v_add_u32 v80, 32768, v80
v_add_u32 v81, 32768, v81
s_waitcnt lgkmcnt(0)
s_barrier
s_add_u32 m0, s38, 65536
s_add_u32 s39, s60, 458752
buffer_load_dwordx4 v84, s[8:11], s39 offen lds
s_add_u32 m0, s38, 66560
s_add_u32 s39, s60, 475136
buffer_load_dwordx4 v84, s[8:11], s39 offen lds
s_add_u32 m0, s38, 67584
s_add_u32 s39, s60, 491520
buffer_load_dwordx4 v84, s[8:11], s39 offen lds
s_add_u32 m0, s38, 68608
s_add_u32 s39, s60, 507904
buffer_load_dwordx4 v84, s[8:11], s39 offen lds
s_add_u32 m0, s38, 81920
s_add_u32 s39, s61, 458752
buffer_load_dwordx4 v84, s[8:11], s39 offen lds
s_add_u32 m0, s38, 82944
s_add_u32 s39, s61, 475136
buffer_load_dwordx4 v84, s[8:11], s39 offen lds
s_add_u32 m0, s38, 83968
s_add_u32 s39, s61, 491520
buffer_load_dwordx4 v84, s[8:11], s39 offen lds
s_add_u32 m0, s38, 84992
s_add_u32 s39, s61, 507904
buffer_load_dwordx4 v84, s[8:11], s39 offen lds
s_waitcnt vmcnt(32)
s_barrier
ds_read_b64_tr_b16 a[12:13], v80 offset:0
ds_read_b64_tr_b16 a[14:15], v80 offset:2048
ds_read_b64_tr_b16 a[44:45], v80 offset:4096
ds_read_b64_tr_b16 a[46:47], v80 offset:6144
ds_read_b64_tr_b16 a[76:77], v80 offset:8192
ds_read_b64_tr_b16 a[78:79], v80 offset:10240
ds_read_b64_tr_b16 a[108:109], v80 offset:12288
ds_read_b64_tr_b16 a[110:111], v80 offset:14336
ds_read_b64_tr_b16 a[140:141], v81 offset:0
ds_read_b64_tr_b16 a[142:143], v81 offset:2048
ds_read_b64_tr_b16 a[172:173], v81 offset:4096
ds_read_b64_tr_b16 a[174:175], v81 offset:6144
ds_read_b64_tr_b16 a[204:205], v81 offset:8192
ds_read_b64_tr_b16 a[206:207], v81 offset:10240
ds_read_b64_tr_b16 a[236:237], v81 offset:12288
ds_read_b64_tr_b16 a[238:239], v81 offset:14336
v_add_u32 v80, 32768, v80
v_add_u32 v81, 32768, v81
s_waitcnt lgkmcnt(0)
s_barrier
s_waitcnt vmcnt(24)
s_barrier
ds_read_b64_tr_b16 a[16:17], v80 offset:0
ds_read_b64_tr_b16 a[18:19], v80 offset:2048
ds_read_b64_tr_b16 a[48:49], v80 offset:4096
ds_read_b64_tr_b16 a[50:51], v80 offset:6144
ds_read_b64_tr_b16 a[80:81], v80 offset:8192
ds_read_b64_tr_b16 a[82:83], v80 offset:10240
ds_read_b64_tr_b16 a[112:113], v80 offset:12288
ds_read_b64_tr_b16 a[114:115], v80 offset:14336
ds_read_b64_tr_b16 a[144:145], v81 offset:0
ds_read_b64_tr_b16 a[146:147], v81 offset:2048
ds_read_b64_tr_b16 a[176:177], v81 offset:4096
ds_read_b64_tr_b16 a[178:179], v81 offset:6144
ds_read_b64_tr_b16 a[208:209], v81 offset:8192
ds_read_b64_tr_b16 a[210:211], v81 offset:10240
ds_read_b64_tr_b16 a[240:241], v81 offset:12288
ds_read_b64_tr_b16 a[242:243], v81 offset:14336
v_add_u32 v80, -131072, v80
v_add_u32 v81, -131072, v81
s_waitcnt lgkmcnt(0)
s_barrier
s_waitcnt vmcnt(16)
s_barrier
ds_read_b64_tr_b16 a[20:21], v80 offset:0
ds_read_b64_tr_b16 a[22:23], v80 offset:2048
ds_read_b64_tr_b16 a[52:53], v80 offset:4096
ds_read_b64_tr_b16 a[54:55], v80 offset:6144
ds_read_b64_tr_b16 a[84:85], v80 offset:8192
ds_read_b64_tr_b16 a[86:87], v80 offset:10240
ds_read_b64_tr_b16 a[116:117], v80 offset:12288
ds_read_b64_tr_b16 a[118:119], v80 offset:14336
ds_read_b64_tr_b16 a[148:149], v81 offset:0
ds_read_b64_tr_b16 a[150:151], v81 offset:2048
ds_read_b64_tr_b16 a[180:181], v81 offset:4096
ds_read_b64_tr_b16 a[182:183], v81 offset:6144
ds_read_b64_tr_b16 a[212:213], v81 offset:8192
ds_read_b64_tr_b16 a[214:215], v81 offset:10240
ds_read_b64_tr_b16 a[244:245], v81 offset:12288
ds_read_b64_tr_b16 a[246:247], v81 offset:14336
v_add_u32 v80, 32768, v80
v_add_u32 v81, 32768, v81
s_waitcnt lgkmcnt(0)
s_barrier
s_waitcnt vmcnt(8)
s_barrier
ds_read_b64_tr_b16 a[24:25], v80 offset:0
ds_read_b64_tr_b16 a[26:27], v80 offset:2048
ds_read_b64_tr_b16 a[56:57], v80 offset:4096
ds_read_b64_tr_b16 a[58:59], v80 offset:6144
ds_read_b64_tr_b16 a[88:89], v80 offset:8192
ds_read_b64_tr_b16 a[90:91], v80 offset:10240
ds_read_b64_tr_b16 a[120:121], v80 offset:12288
ds_read_b64_tr_b16 a[122:123], v80 offset:14336
ds_read_b64_tr_b16 a[152:153], v81 offset:0
ds_read_b64_tr_b16 a[154:155], v81 offset:2048
ds_read_b64_tr_b16 a[184:185], v81 offset:4096
ds_read_b64_tr_b16 a[186:187], v81 offset:6144
ds_read_b64_tr_b16 a[216:217], v81 offset:8192
ds_read_b64_tr_b16 a[218:219], v81 offset:10240
ds_read_b64_tr_b16 a[248:249], v81 offset:12288
ds_read_b64_tr_b16 a[250:251], v81 offset:14336
v_add_u32 v80, 32768, v80
v_add_u32 v81, 32768, v81
s_waitcnt lgkmcnt(0)
s_barrier
s_waitcnt vmcnt(0)
s_barrier
ds_read_b64_tr_b16 a[28:29], v80 offset:0
ds_read_b64_tr_b16 a[30:31], v80 offset:2048
ds_read_b64_tr_b16 a[60:61], v80 offset:4096
ds_read_b64_tr_b16 a[62:63], v80 offset:6144
ds_read_b64_tr_b16 a[92:93], v80 offset:8192
ds_read_b64_tr_b16 a[94:95], v80 offset:10240
ds_read_b64_tr_b16 a[124:125], v80 offset:12288
ds_read_b64_tr_b16 a[126:127], v80 offset:14336
ds_read_b64_tr_b16 a[156:157], v81 offset:0
ds_read_b64_tr_b16 a[158:159], v81 offset:2048
ds_read_b64_tr_b16 a[188:189], v81 offset:4096
ds_read_b64_tr_b16 a[190:191], v81 offset:6144
ds_read_b64_tr_b16 a[220:221], v81 offset:8192
ds_read_b64_tr_b16 a[222:223], v81 offset:10240
ds_read_b64_tr_b16 a[252:253], v81 offset:12288
ds_read_b64_tr_b16 a[254:255], v81 offset:14336
v_add_u32 v80, 32768, v80
v_add_u32 v81, 32768, v81
s_waitcnt lgkmcnt(0)
s_barrier
Lst_563:
buffer_load_dword v48, off, s[12:15], 0 offset:32 sc1
buffer_load_dword v49, off, s[12:15], 0 offset:160 sc1
s_waitcnt vmcnt(0)
v_add_u32 v48, v48, v49
s_nop 0
v_readfirstlane_b32 s38, v48
s_nop 3
s_and_b32 s39, s38, 0x200ffff
s_cmp_eq_u32 s39, 0x2000100
s_cbranch_scc1 Lso_564
s_sub_u32 s37, s37, 1
s_cbranch_scc1 Lend_7
s_sleep 8
s_branch Lst_563
Lso_564:
s_bfe_u32 s35, s38, 0x80010
s_bfe_u32 s46, s38, 0x10018
s_lshl_b32 s46, s46, 13
s_barrier
s_mul_i32 s50, s32, 4096
v_lshlrev_b32 v1, 4, v9
v_add_u32 v0, s50, v1
v_lshrrev_b32 v80, 2, v9
v_min_u32 v80, 7, v80
v_lshlrev_b32 v80, 7, v80
v_and_b32 v2, 3, v9
v_lshl_add_u32 v2, v2, 2, v80
s_lshl_b32 s47, s33, 10
s_add_u32 s47, s47, 3432448
v_mov_b32 v6, v1
s_lshl_b32 s38, s26, 2
s_add_u32 s38, s38, s32
s_lshl_b32 s38, s38, 11
s_lshl_b32 s49, s33, 22
s_add_u32 s49, s49, s38
s_add_u32 s49, s49, 117374976
s_lshl_b32 s54, s33, 16
s_add_u32 s54, s54, 83886080
s_lshl_b32 s45, s26, 18
s_add_u32 s45, s45, s54
s_add_u32 m0, s50, 0
s_add_u32 s39, s45, 0
buffer_load_dwordx4 v0, s[4:7], s39 offen offset:0 sc1 lds
buffer_load_dwordx4 v0, s[4:7], s39 offen offset:1024 sc1 lds
buffer_load_dwordx4 v0, s[4:7], s39 offen offset:2048 sc1 lds
buffer_load_dwordx4 v0, s[4:7], s39 offen offset:3072 sc1 lds
s_add_u32 m0, s50, 16384
s_add_u32 s39, s45, 16384
buffer_load_dwordx4 v0, s[4:7], s39 offen offset:0 sc1 lds
buffer_load_dwordx4 v0, s[4:7], s39 offen offset:1024 sc1 lds
buffer_load_dwordx4 v0, s[4:7], s39 offen offset:2048 sc1 lds
buffer_load_dwordx4 v0, s[4:7], s39 offen offset:3072 sc1 lds
s_add_u32 m0, s50, 32768
s_add_u32 s39, s45, 32768
buffer_load_dwordx4 v0, s[4:7], s39 offen offset:0 sc1 lds
buffer_load_dwordx4 v0, s[4:7], s39 offen offset:1024 sc1 lds
buffer_load_dwordx4 v0, s[4:7], s39 offen offset:2048 sc1 lds
buffer_load_dwordx4 v0, s[4:7], s39 offen offset:3072 sc1 lds
s_add_u32 m0, s50, 49152
s_add_u32 s39, s45, 49152
buffer_load_dwordx4 v0, s[4:7], s39 offen offset:0 sc1 lds
buffer_load_dwordx4 v0, s[4:7], s39 offen offset:1024 sc1 lds
buffer_load_dwordx4 v0, s[4:7], s39 offen offset:2048 sc1 lds
buffer_load_dwordx4 v0, s[4:7], s39 offen offset:3072 sc1 lds
v_mov_b32 v8, 0
s_mov_b32 s36, 0
s_add_u32 s48, s36, 1
Lsw_565:
Lbw_570:
buffer_load_dword v3, v2, s[4:7], s47 offen sc1
s_waitcnt vmcnt(0)
v_cmp_gt_u32 vcc, s48, v3
s_cbranch_vccz Lbo_571
s_sub_u32 s37, s37, 1
s_cbranch_scc1 Lend_7
s_sleep 1
s_branch Lbw_570
Lbo_571:
s_add_u32 m0, s50, 0
s_add_u32 s39, s54, 0
buffer_load_dwordx4 v0, s[4:7], s39 offen offset:0 sc1 lds
buffer_load_dwordx4 v0, s[4:7], s39 offen offset:1024 sc1 lds
buffer_load_dwordx4 v0, s[4:7], s39 offen offset:2048 sc1 lds
buffer_load_dwordx4 v0, s[4:7], s39 offen offset:3072 sc1 lds
s_add_u32 m0, s50, 16384
s_add_u32 s39, s54, 16384
buffer_load_dwordx4 v0, s[4:7], s39 offen offset:0 sc1 lds
buffer_load_dwordx4 v0, s[4:7], s39 offen offset:1024 sc1 lds
buffer_load_dwordx4 v0, s[4:7], s39 offen offset:2048 sc1 lds
buffer_load_dwordx4 v0, s[4:7], s39 offen offset:3072 sc1 lds
s_add_u32 m0, s50, 32768
s_add_u32 s39, s54, 32768
buffer_load_dwordx4 v0, s[4:7], s39 offen offset:0 sc1 lds
buffer_load_dwordx4 v0, s[4:7], s39 offen offset:1024 sc1 lds
buffer_load_dwordx4 v0, s[4:7], s39 offen offset:2048 sc1 lds
buffer_load_dwordx4 v0, s[4:7], s39 offen offset:3072 sc1 lds
s_add_u32 m0, s50, 49152
s_add_u32 s39, s54, 49152
buffer_load_dwordx4 v0, s[4:7], s39 offen offset:0 sc1 lds
buffer_load_dwordx4 v0, s[4:7], s39 offen offset:1024 sc1 lds
buffer_load_dwordx4 v0, s[4:7], s39 offen offset:2048 sc1 lds
buffer_load_dwordx4 v0, s[4:7], s39 offen offset:3072 sc1 lds
buffer_load_dword v3, v2, s[4:7], s47 offen sc1
Lse_566:
s_waitcnt vmcnt(13)
s_barrier
ds_read_b128 v[16:19], v1 offset:0
ds_read_b128 v[20:23], v1 offset:1024
ds_read_b128 v[24:27], v1 offset:2048
ds_read_b128 v[28:31], v1 offset:3072
ds_read_b128 v[32:35], v1 offset:4096
ds_read_b128 v[36:39], v1 offset:5120
ds_read_b128 v[40:43], v1 offset:6144
s_add_u32 s54, s54, 262144
s_bitset0_b32 s54, 21
s_xor_b32 s50, s50, 0x10000
s_add_u32 s49, s49, 65536
s_add_u32 s36, s36, 1
s_add_u32 s48, s36, 1
s_waitcnt lgkmcnt(5)
v_mfma_f32_16x16x32_bf16 v[48:51], a[0:3], v[16:19], 0
ds_read_b128 v[44:47], v1 offset:7168
v_mfma_f32_16x16x32_bf16 v[52:55], a[128:131], v[16:19], 0
v_mfma_f32_16x16x32_bf16 v[56:59], a[0:3], v[20:23], 0
ds_read_b128 v[16:19], v1 offset:8192
v_mfma_f32_16x16x32_bf16 v[60:63], a[128:131], v[20:23], 0
s_waitcnt lgkmcnt(5)
v_mfma_f32_16x16x32_bf16 v[48:51], a[4:7], v[24:27], v[48:51]
ds_read_b128 v[20:23], v1 offset:9216
v_mfma_f32_16x16x32_bf16 v[52:55], a[132:135], v[24:27], v[52:55]
v_mfma_f32_16x16x32_bf16 v[56:59], a[4:7], v[28:31], v[56:59]
ds_read_b128 v[24:27], v1 offset:10240
v_mfma_f32_16x16x32_bf16 v[60:63], a[132:135], v[28:31], v[60:63]
s_waitcnt lgkmcnt(5)
v_mfma_f32_16x16x32_bf16 v[48:51], a[8:11], v[32:35], v[48:51]
ds_read_b128 v[28:31], v1 offset:11264
v_mfma_f32_16x16x32_bf16 v[52:55], a[136:139], v[32:35], v[52:55]
v_mfma_f32_16x16x32_bf16 v[56:59], a[8:11], v[36:39], v[56:59]
ds_read_b128 v[32:35], v1 offset:12288
v_mfma_f32_16x16x32_bf16 v[60:63], a[136:139], v[36:39], v[60:63]
s_waitcnt lgkmcnt(5)
v_mfma_f32_16x16x32_bf16 v[48:51], a[12:15], v[40:43], v[48:51]
ds_read_b128 v[36:39], v1 offset:13312
v_mfma_f32_16x16x32_bf16 v[52:55], a[140:143], v[40:43], v[52:55]
v_mfma_f32_16x16x32_bf16 v[56:59], a[12:15], v[44:47], v[56:59]
ds_read_b128 v[40:43], v1 offset:14336
v_mfma_f32_16x16x32_bf16 v[60:63], a[140:143], v[44:47], v[60:63]
s_waitcnt lgkmcnt(5)
v_mfma_f32_16x16x32_bf16 v[48:51], a[16:19], v[16:19], v[48:51]
ds_read_b128 v[44:47], v1 offset:15360
v_mfma_f32_16x16x32_bf16 v[52:55], a[144:147], v[16:19], v[52:55]
v_mfma_f32_16x16x32_bf16 v[56:59], a[16:19], v[20:23], v[56:59]
s_waitcnt vmcnt(9)
s_barrier
ds_read_b128 v[16:19], v1 offset:16384
v_mfma_f32_16x16x32_bf16 v[60:63], a[144:147], v[20:23], v[60:63]
s_waitcnt lgkmcnt(5)
v_mfma_f32_16x16x32_bf16 v[48:51], a[20:23], v[24:27], v[48:51]
ds_read_b128 v[20:23], v1 offset:17408
v_mfma_f32_16x16x32_bf16 v[52:55], a[148:151], v[24:27], v[52:55]
v_mfma_f32_16x16x32_bf16 v[56:59], a[20:23], v[28:31], v[56:59]
ds_read_b128 v[24:27], v1 offset:18432
v_mfma_f32_16x16x32_bf16 v[60:63], a[148:151], v[28:31], v[60:63]
s_waitcnt lgkmcnt(5)
v_mfma_f32_16x16x32_bf16 v[48:51], a[24:27], v[32:35], v[48:51]
ds_read_b128 v[28:31], v1 offset:19456
v_mfma_f32_16x16x32_bf16 v[52:55], a[152:155], v[32:35], v[52:55]
v_mfma_f32_16x16x32_bf16 v[56:59], a[24:27], v[36:39], v[56:59]
ds_read_b128 v[32:35], v1 offset:20480
v_mfma_f32_16x16x32_bf16 v[60:63], a[152:155], v[36:39], v[60:63]
s_waitcnt lgkmcnt(5)
v_mfma_f32_16x16x32_bf16 v[48:51], a[28:31], v[40:43], v[48:51]
ds_read_b128 v[36:39], v1 offset:21504
v_mfma_f32_16x16x32_bf16 v[52:55], a[156:159], v[40:43], v[52:55]
v_mfma_f32_16x16x32_bf16 v[56:59], a[28:31], v[44:47], v[56:59]
ds_read_b128 v[40:43], v1 offset:22528
v_mfma_f32_16x16x32_bf16 v[60:63], a[156:159], v[44:47], v[60:63]
s_waitcnt lgkmcnt(5)
v_mfma_f32_16x16x32_bf16 v[48:51], a[32:35], v[16:19], v[48:51]
ds_read_b128 v[44:47], v1 offset:23552
v_mfma_f32_16x16x32_bf16 v[52:55], a[160:163], v[16:19], v[52:55]
v_mfma_f32_16x16x32_bf16 v[56:59], a[32:35], v[20:23], v[56:59]
ds_read_b128 v[16:19], v1 offset:24576
v_mfma_f32_16x16x32_bf16 v[60:63], a[160:163], v[20:23], v[60:63]
s_waitcnt lgkmcnt(5)
v_mfma_f32_16x16x32_bf16 v[48:51], a[36:39], v[24:27], v[48:51]
ds_read_b128 v[20:23], v1 offset:25600
v_mfma_f32_16x16x32_bf16 v[52:55], a[164:167], v[24:27], v[52:55]
v_mfma_f32_16x16x32_bf16 v[56:59], a[36:39], v[28:31], v[56:59]
ds_read_b128 v[24:27], v1 offset:26624
v_mfma_f32_16x16x32_bf16 v[60:63], a[164:167], v[28:31], v[60:63]
s_waitcnt lgkmcnt(5)
v_mfma_f32_16x16x32_bf16 v[48:51], a[40:43], v[32:35], v[48:51]
ds_read_b128 v[28:31], v1 offset:27648
v_mfma_f32_16x16x32_bf16 v[52:55], a[168:171], v[32:35], v[52:55]
v_mfma_f32_16x16x32_bf16 v[56:59], a[40:43], v[36:39], v[56:59]
ds_read_b128 v[32:35], v1 offset:28672
v_mfma_f32_16x16x32_bf16 v[60:63], a[168:171], v[36:39], v[60:63]
s_waitcnt lgkmcnt(5)
v_mfma_f32_16x16x32_bf16 v[48:51], a[44:47], v[40:43], v[48:51]
ds_read_b128 v[36:39], v1 offset:29696
v_mfma_f32_16x16x32_bf16 v[52:55], a[172:175], v[40:43], v[52:55]
v_mfma_f32_16x16x32_bf16 v[56:59], a[44:47], v[44:47], v[56:59]
ds_read_b128 v[40:43], v1 offset:30720
v_mfma_f32_16x16x32_bf16 v[60:63], a[172:175], v[44:47], v[60:63]
s_waitcnt lgkmcnt(5)
v_mfma_f32_16x16x32_bf16 v[48:51], a[48:51], v[16:19], v[48:51]
ds_read_b128 v[44:47], v1 offset:31744
v_mfma_f32_16x16x32_bf16 v[52:55], a[176:179], v[16:19], v[52:55]
v_mfma_f32_16x16x32_bf16 v[56:59], a[48:51], v[20:23], v[56:59]
s_waitcnt vmcnt(5)
s_barrier
ds_read_b128 v[16:19], v1 offset:32768
v_mfma_f32_16x16x32_bf16 v[60:63], a[176:179], v[20:23], v[60:63]
s_waitcnt lgkmcnt(5)
v_mfma_f32_16x16x32_bf16 v[48:51], a[52:55], v[24:27], v[48:51]
ds_read_b128 v[20:23], v1 offset:33792
v_mfma_f32_16x16x32_bf16 v[52:55], a[180:183], v[24:27], v[52:55]
v_mfma_f32_16x16x32_bf16 v[56:59], a[52:55], v[28:31], v[56:59]
ds_read_b128 v[24:27], v1 offset:34816
v_mfma_f32_16x16x32_bf16 v[60:63], a[180:183], v[28:31], v[60:63]
s_waitcnt lgkmcnt(5)
v_mfma_f32_16x16x32_bf16 v[48:51], a[56:59], v[32:35], v[48:51]
ds_read_b128 v[28:31], v1 offset:35840
v_mfma_f32_16x16x32_bf16 v[52:55], a[184:187], v[32:35], v[52:55]
v_mfma_f32_16x16x32_bf16 v[56:59], a[56:59], v[36:39], v[56:59]
ds_read_b128 v[32:35], v1 offset:36864
v_mfma_f32_16x16x32_bf16 v[60:63], a[184:187], v[36:39], v[60:63]
s_waitcnt lgkmcnt(5)
v_mfma_f32_16x16x32_bf16 v[48:51], a[60:63], v[40:43], v[48:51]
ds_read_b128 v[36:39], v1 offset:37888
v_mfma_f32_16x16x32_bf16 v[52:55], a[188:191], v[40:43], v[52:55]
v_mfma_f32_16x16x32_bf16 v[56:59], a[60:63], v[44:47], v[56:59]
ds_read_b128 v[40:43], v1 offset:38912
v_mfma_f32_16x16x32_bf16 v[60:63], a[188:191], v[44:47], v[60:63]
s_waitcnt lgkmcnt(5)
v_mfma_f32_16x16x32_bf16 v[48:51], a[64:67], v[16:19], v[48:51]
ds_read_b128 v[44:47], v1 offset:39936
v_mfma_f32_16x16x32_bf16 v[52:55], a[192:195], v[16:19], v[52:55]
v_mfma_f32_16x16x32_bf16 v[56:59], a[64:67], v[20:23], v[56:59]
ds_read_b128 v[16:19], v1 offset:40960
v_mfma_f32_16x16x32_bf16 v[60:63], a[192:195], v[20:23], v[60:63]
s_waitcnt lgkmcnt(5)
v_mfma_f32_16x16x32_bf16 v[48:51], a[68:71], v[24:27], v[48:51]
ds_read_b128 v[20:23], v1 offset:41984
v_mfma_f32_16x16x32_bf16 v[52:55], a[196:199], v[24:27], v[52:55]
v_mfma_f32_16x16x32_bf16 v[56:59], a[68:71], v[28:31], v[56:59]
ds_read_b128 v[24:27], v1 offset:43008
v_mfma_f32_16x16x32_bf16 v[60:63], a[196:199], v[28:31], v[60:63]
s_waitcnt lgkmcnt(5)
v_mfma_f32_16x16x32_bf16 v[48:51], a[72:75], v[32:35], v[48:51]
ds_read_b128 v[28:31], v1 offset:44032
v_mfma_f32_16x16x32_bf16 v[52:55], a[200:203], v[32:35], v[52:55]
v_mfma_f32_16x16x32_bf16 v[56:59], a[72:75], v[36:39], v[56:59]
ds_read_b128 v[32:35], v1 offset:45056
v_mfma_f32_16x16x32_bf16 v[60:63], a[200:203], v[36:39], v[60:63]
s_waitcnt lgkmcnt(5)
v_mfma_f32_16x16x32_bf16 v[48:51], a[76:79], v[40:43], v[48:51]
ds_read_b128 v[36:39], v1 offset:46080
v_mfma_f32_16x16x32_bf16 v[52:55], a[204:207], v[40:43], v[52:55]
v_mfma_f32_16x16x32_bf16 v[56:59], a[76:79], v[44:47], v[56:59]
ds_read_b128 v[40:43], v1 offset:47104
v_mfma_f32_16x16x32_bf16 v[60:63], a[204:207], v[44:47], v[60:63]
s_waitcnt lgkmcnt(5)
v_mfma_f32_16x16x32_bf16 v[48:51], a[80:83], v[16:19], v[48:51]
ds_read_b128 v[44:47], v1 offset:48128
v_mfma_f32_16x16x32_bf16 v[52:55], a[208:211], v[16:19], v[52:55]
v_mfma_f32_16x16x32_bf16 v[56:59], a[80:83], v[20:23], v[56:59]
s_waitcnt vmcnt(1)
s_barrier
ds_read_b128 v[16:19], v1 offset:49152
v_mfma_f32_16x16x32_bf16 v[60:63], a[208:211], v[20:23], v[60:63]
s_waitcnt lgkmcnt(5)
v_mfma_f32_16x16x32_bf16 v[48:51], a[84:87], v[24:27], v[48:51]
ds_read_b128 v[20:23], v1 offset:50176
v_mfma_f32_16x16x32_bf16 v[52:55], a[212:215], v[24:27], v[52:55]
v_mfma_f32_16x16x32_bf16 v[56:59], a[84:87], v[28:31], v[56:59]
ds_read_b128 v[24:27], v1 offset:51200
v_mfma_f32_16x16x32_bf16 v[60:63], a[212:215], v[28:31], v[60:63]
s_waitcnt lgkmcnt(5)
v_mfma_f32_16x16x32_bf16 v[48:51], a[88:91], v[32:35], v[48:51]
ds_read_b128 v[28:31], v1 offset:52224
v_mfma_f32_16x16x32_bf16 v[52:55], a[216:219], v[32:35], v[52:55]
v_mfma_f32_16x16x32_bf16 v[56:59], a[88:91], v[36:39], v[56:59]
ds_read_b128 v[32:35], v1 offset:53248
v_mfma_f32_16x16x32_bf16 v[60:63], a[216:219], v[36:39], v[60:63]
s_waitcnt lgkmcnt(5)
v_mfma_f32_16x16x32_bf16 v[48:51], a[92:95], v[40:43], v[48:51]
ds_read_b128 v[36:39], v1 offset:54272
buffer_load_dword v3, v2, s[4:7], s47 offen sc1
v_mfma_f32_16x16x32_bf16 v[52:55], a[220:223], v[40:43], v[52:55]
v_mfma_f32_16x16x32_bf16 v[56:59], a[92:95], v[44:47], v[56:59]
ds_read_b128 v[40:43], v1 offset:55296
v_mfma_f32_16x16x32_bf16 v[60:63], a[220:223], v[44:47], v[60:63]
s_waitcnt lgkmcnt(5)
v_mfma_f32_16x16x32_bf16 v[48:51], a[96:99], v[16:19], v[48:51]
ds_read_b128 v[44:47], v1 offset:56320
v_mfma_f32_16x16x32_bf16 v[52:55], a[224:227], v[16:19], v[52:55]
v_mfma_f32_16x16x32_bf16 v[56:59], a[96:99], v[20:23], v[56:59]
ds_read_b128 v[16:19], v1 offset:57344
v_mfma_f32_16x16x32_bf16 v[60:63], a[224:227], v[20:23], v[60:63]
s_waitcnt lgkmcnt(5)
v_mfma_f32_16x16x32_bf16 v[48:51], a[100:103], v[24:27], v[48:51]
ds_read_b128 v[20:23], v1 offset:58368
v_mfma_f32_16x16x32_bf16 v[52:55], a[228:231], v[24:27], v[52:55]
v_mfma_f32_16x16x32_bf16 v[56:59], a[100:103], v[28:31], v[56:59]
ds_read_b128 v[24:27], v1 offset:59392
v_mfma_f32_16x16x32_bf16 v[60:63], a[228:231], v[28:31], v[60:63]
s_waitcnt lgkmcnt(5)
v_mfma_f32_16x16x32_bf16 v[48:51], a[104:107], v[32:35], v[48:51]
ds_read_b128 v[28:31], v1 offset:60416
v_mfma_f32_16x16x32_bf16 v[52:55], a[232:235], v[32:35], v[52:55]
v_mfma_f32_16x16x32_bf16 v[56:59], a[104:107], v[36:39], v[56:59]
ds_read_b128 v[32:35], v1 offset:61440
v_mfma_f32_16x16x32_bf16 v[60:63], a[232:235], v[36:39], v[60:63]
s_waitcnt lgkmcnt(5)
v_mfma_f32_16x16x32_bf16 v[48:51], a[108:111], v[40:43], v[48:51]
ds_read_b128 v[36:39], v1 offset:62464
v_mfma_f32_16x16x32_bf16 v[52:55], a[236:239], v[40:43], v[52:55]
v_mfma_f32_16x16x32_bf16 v[56:59], a[108:111], v[44:47], v[56:59]
ds_read_b128 v[40:43], v1 offset:63488
v_mfma_f32_16x16x32_bf16 v[60:63], a[236:239], v[44:47], v[60:63]
s_waitcnt lgkmcnt(5)
v_mfma_f32_16x16x32_bf16 v[48:51], a[112:115], v[16:19], v[48:51]
ds_read_b128 v[44:47], v1 offset:64512
v_mfma_f32_16x16x32_bf16 v[52:55], a[240:243], v[16:19], v[52:55]
v_mfma_f32_16x16x32_bf16 v[56:59], a[112:115], v[20:23], v[56:59]
v_mfma_f32_16x16x32_bf16 v[60:63], a[240:243], v[20:23], v[60:63]
s_waitcnt lgkmcnt(4)
v_mfma_f32_16x16x32_bf16 v[48:51], a[116:119], v[24:27], v[48:51]
v_mfma_f32_16x16x32_bf16 v[52:55], a[244:247], v[24:27], v[52:55]
v_mfma_f32_16x16x32_bf16 v[56:59], a[116:119], v[28:31], v[56:59]
v_mfma_f32_16x16x32_bf16 v[60:63], a[244:247], v[28:31], v[60:63]
s_waitcnt lgkmcnt(2)
v_mfma_f32_16x16x32_bf16 v[48:51], a[120:123], v[32:35], v[48:51]
v_mfma_f32_16x16x32_bf16 v[52:55], a[248:251], v[32:35], v[52:55]
v_mfma_f32_16x16x32_bf16 v[56:59], a[120:123], v[36:39], v[56:59]
v_mfma_f32_16x16x32_bf16 v[60:63], a[248:251], v[36:39], v[60:63]
s_waitcnt lgkmcnt(0)
v_mfma_f32_16x16x32_bf16 v[48:51], a[124:127], v[40:43], v[48:51]
v_mfma_f32_16x16x32_bf16 v[52:55], a[252:255], v[40:43], v[52:55]
v_mfma_f32_16x16x32_bf16 v[56:59], a[124:127], v[44:47], v[56:59]
v_mfma_f32_16x16x32_bf16 v[60:63], a[252:255], v[44:47], v[60:63]
v_xor_b32 v1, 0x10000, v1
v_mov_b32 v5, s36
s_waitcnt vmcnt(0)
v_cmp_gt_u32 vcc, s48, v3
v_add_u32 v8, 1, v8
s_cmp_lg_u32 s35, 0
s_cbranch_scc1 Llf_572
buffer_store_dword v8, v7, s[4:7], 0 offen
s_branch Llo_573
Llf_572:
buffer_store_dword v8, v7, s[4:7], 0 offen sc1
Llo_573:
s_nop 3
v_cvt_pk_bf16_f32 v80, v48, v49
v_cvt_pk_bf16_f32 v81, v50, v51
v_cvt_pk_bf16_f32 v82, v52, v53
v_cvt_pk_bf16_f32 v83, v54, v55
buffer_store_dwordx4 v[80:83], v6, s[4:7], s49 offen offset:0 sc1
v_cvt_pk_bf16_f32 v84, v56, v57
v_cvt_pk_bf16_f32 v85, v58, v59
v_cvt_pk_bf16_f32 v86, v60, v61
v_cvt_pk_bf16_f32 v87, v62, v63
buffer_store_dwordx4 v[84:87], v6, s[4:7], s49 offen offset:1024 sc1
s_mov_b32 s46, 0
s_cbranch_vccnz Lsk_568
s_mov_b32 s46, 1
s_add_u32 m0, s50, 0
s_add_u32 s39, s54, 0
buffer_load_dwordx4 v0, s[4:7], s39 offen offset:0 sc1 lds
buffer_load_dwordx4 v0, s[4:7], s39 offen offset:1024 sc1 lds
buffer_load_dwordx4 v0, s[4:7], s39 offen offset:2048 sc1 lds
buffer_load_dwordx4 v0, s[4:7], s39 offen offset:3072 sc1 lds
s_add_u32 m0, s50, 16384
s_add_u32 s39, s54, 16384
buffer_load_dwordx4 v0, s[4:7], s39 offen offset:0 sc1 lds
buffer_load_dwordx4 v0, s[4:7], s39 offen offset:1024 sc1 lds
buffer_load_dwordx4 v0, s[4:7], s39 offen offset:2048 sc1 lds
buffer_load_dwordx4 v0, s[4:7], s39 offen offset:3072 sc1 lds
s_add_u32 m0, s50, 32768
s_add_u32 s39, s54, 32768
buffer_load_dwordx4 v0, s[4:7], s39 offen offset:0 sc1 lds
buffer_load_dwordx4 v0, s[4:7], s39 offen offset:1024 sc1 lds
buffer_load_dwordx4 v0, s[4:7], s39 offen offset:2048 sc1 lds
buffer_load_dwordx4 v0, s[4:7], s39 offen offset:3072 sc1 lds
s_add_u32 m0, s50, 49152
s_add_u32 s39, s54, 49152
buffer_load_dwordx4 v0, s[4:7], s39 offen offset:0 sc1 lds
buffer_load_dwordx4 v0, s[4:7], s39 offen offset:1024 sc1 lds
buffer_load_dwordx4 v0, s[4:7], s39 offen offset:2048 sc1 lds
buffer_load_dwordx4 v0, s[4:7], s39 offen offset:3072 sc1 lds
s_waitcnt vmcnt(16)
s_branch Lsj_569
Lsk_568:
s_waitcnt vmcnt(0)
Lsj_569:
s_barrier
s_and_b32 s38, s36, 1
s_lshl_b32 s38, s38, 12
buffer_store_dword v5, v4, s[4:7], s38 offen sc1
s_cmp_eq_u32 s36, 64
s_cbranch_scc1 Lso_567
s_cmp_lg_u32 s46, 0
s_cbranch_scc1 Lse_566
s_branch Lsw_565
Lso_567:
s_endpgm
Lhi_4:
s_cmp_ge_u32 s34, 16
s_cbranch_scc1 Lhelper_5
v_mov_b32 v9, v1
s_sub_u32 s44, s33, 4
s_lshl_b32 s44, s44, 4
s_add_u32 s44, s44, s34
s_lshl_b32 s38, s44, 7
s_add_u32 s38, s38, 3407872
v_min_u32 v80, 1, v0
v_lshl_add_u32 v4, v80, 30, s38
v_mov_b32 v5, 0
buffer_store_dword v5, v4, s[4:7], 0 offen sc1
s_mov_b32 s52, 1
s_waitcnt vmcnt(0)
s_cmp_lg_u32 s32, 0
s_cbranch_scc1 Lar_574
s_mov_b64 exec, 1
v_mov_b32 v48, 160
v_mov_b32 v49, s52
buffer_atomic_add v49, v48, s[12:15], 0 offen sc1
s_mov_b64 exec, -1
Lar_574:
s_mov_b32 s8, s18
s_and_b32 s9, s19, 0xffff
s_mov_b32 s10, 0x800000
s_mov_b32 s11, 0x20000
s_mov_b32 s84, s20
s_and_b32 s85, s21, 0xffff
s_mov_b32 s86, 0x800000
s_mov_b32 s87, 0x20000
s_mov_b32 s88, s22
s_and_b32 s89, s23, 0xffff
s_mov_b32 s90, 0x800000
s_mov_b32 s91, 0x20000
s_lshl_b32 s60, s44, 7
s_xor_b32 s61, s60, 512
s_xor_b32 s62, s60, 256
s_and_b32 s52, s32, 1
s_lshl_b32 s52, s52, 6
v_bfe_u32 v84, v9, 2, 2
v_lshrrev_b32 v85, 4, v9
v_lshl_add_u32 v84, v85, 3, v84
v_lshl_add_u32 v84, v84, 7, s52
v_and_b32 v85, 3, v9
v_lshl_add_u32 v84, v85, 3, v84
v_add_u32 v80, 0, v84
v_bfe_u32 v84, v9, 2, 2
v_lshrrev_b32 v85, 4, v9
v_lshl_add_u32 v84, v85, 3, v84
v_lshl_add_u32 v84, v84, 7, s52
v_and_b32 v85, 3, v9
v_lshl_add_u32 v84, v85, 3, v84
v_add_u32 v81, 32, v84
s_lshl_b32 s52, s32, 5
v_bfe_u32 v84, v9, 2, 2
v_lshrrev_b32 v85, 4, v9
v_lshl_add_u32 v84, v85, 3, v84
v_lshl_add_u32 v84, v84, 7, s52
v_and_b32 v85, 3, v9
v_lshl_add_u32 v84, v85, 3, v84
v_add_u32 v82, 0, v84
v_lshrrev_b32 v84, 3, v9
s_lshl_b32 s38, s32, 8
v_add_u32 v84, s38, v84
v_mul_u32_u24 v84, 8192, v84
v_and_b32 v85, 7, v9
v_lshl_add_u32 v84, v85, 4, v84
s_lshl_b32 s38, s32, 13
s_barrier
s_add_u32 m0, s38, 0
s_add_u32 s39, s62, 0
buffer_load_dwordx4 v84, s[88:91], s39 offen lds
s_add_u32 m0, s38, 1024
s_add_u32 s39, s62, 65536
buffer_load_dwordx4 v84, s[88:91], s39 offen lds
s_add_u32 m0, s38, 2048
s_add_u32 s39, s62, 131072
buffer_load_dwordx4 v84, s[88:91], s39 offen lds
s_add_u32 m0, s38, 3072
s_add_u32 s39, s62, 196608
buffer_load_dwordx4 v84, s[88:91], s39 offen lds
s_add_u32 m0, s38, 4096
s_add_u32 s39, s62, 262144
buffer_load_dwordx4 v84, s[88:91], s39 offen lds
s_add_u32 m0, s38, 5120
s_add_u32 s39, s62, 327680
buffer_load_dwordx4 v84, s[88:91], s39 offen lds
s_add_u32 m0, s38, 6144
s_add_u32 s39, s62, 393216
buffer_load_dwordx4 v84, s[88:91], s39 offen lds
s_add_u32 m0, s38, 7168
s_add_u32 s39, s62, 458752
buffer_load_dwordx4 v84, s[88:91], s39 offen lds
s_add_u32 m0, s38, 32768
s_add_u32 s39, s62, 524288
buffer_load_dwordx4 v84, s[88:91], s39 offen lds
s_add_u32 m0, s38, 33792
s_add_u32 s39, s62, 589824
buffer_load_dwordx4 v84, s[88:91], s39 offen lds
s_add_u32 m0, s38, 34816
s_add_u32 s39, s62, 655360
buffer_load_dwordx4 v84, s[88:91], s39 offen lds
s_add_u32 m0, s38, 35840
s_add_u32 s39, s62, 720896
buffer_load_dwordx4 v84, s[88:91], s39 offen lds
s_add_u32 m0, s38, 36864
s_add_u32 s39, s62, 786432
buffer_load_dwordx4 v84, s[88:91], s39 offen lds
s_add_u32 m0, s38, 37888
s_add_u32 s39, s62, 851968
buffer_load_dwordx4 v84, s[88:91], s39 offen lds
s_add_u32 m0, s38, 38912
s_add_u32 s39, s62, 917504
buffer_load_dwordx4 v84, s[88:91], s39 offen lds
s_add_u32 m0, s38, 39936
s_add_u32 s39, s62, 983040
buffer_load_dwordx4 v84, s[88:91], s39 offen lds
s_add_u32 m0, s38, 65536
s_add_u32 s39, s62, 1048576
buffer_load_dwordx4 v84, s[88:91], s39 offen lds
s_add_u32 m0, s38, 66560
s_add_u32 s39, s62, 1114112
buffer_load_dwordx4 v84, s[88:91], s39 offen lds
s_add_u32 m0, s38, 67584
s_add_u32 s39, s62, 1179648
buffer_load_dwordx4 v84, s[88:91], s39 offen lds
s_add_u32 m0, s38, 68608
s_add_u32 s39, s62, 1245184
buffer_load_dwordx4 v84, s[88:91], s39 offen lds
s_add_u32 m0, s38, 69632
s_add_u32 s39, s62, 1310720
buffer_load_dwordx4 v84, s[88:91], s39 offen lds
s_add_u32 m0, s38, 70656
s_add_u32 s39, s62, 1376256
buffer_load_dwordx4 v84, s[88:91], s39 offen lds
s_add_u32 m0, s38, 71680
s_add_u32 s39, s62, 1441792
buffer_load_dwordx4 v84, s[88:91], s39 offen lds
s_add_u32 m0, s38, 72704
s_add_u32 s39, s62, 1507328
buffer_load_dwordx4 v84, s[88:91], s39 offen lds
s_add_u32 m0, s38, 98304
s_add_u32 s39, s62, 1572864
buffer_load_dwordx4 v84, s[88:91], s39 offen lds
s_add_u32 m0, s38, 99328
s_add_u32 s39, s62, 1638400
buffer_load_dwordx4 v84, s[88:91], s39 offen lds
s_add_u32 m0, s38, 100352
s_add_u32 s39, s62, 1703936
buffer_load_dwordx4 v84, s[88:91], s39 offen lds
s_add_u32 m0, s38, 101376
s_add_u32 s39, s62, 1769472
buffer_load_dwordx4 v84, s[88:91], s39 offen lds
s_add_u32 m0, s38, 102400
s_add_u32 s39, s62, 1835008
buffer_load_dwordx4 v84, s[88:91], s39 offen lds
s_add_u32 m0, s38, 103424
s_add_u32 s39, s62, 1900544
buffer_load_dwordx4 v84, s[88:91], s39 offen lds
s_add_u32 m0, s38, 104448
s_add_u32 s39, s62, 1966080
buffer_load_dwordx4 v84, s[88:91], s39 offen lds
s_add_u32 m0, s38, 105472
s_add_u32 s39, s62, 2031616
buffer_load_dwordx4 v84, s[88:91], s39 offen lds
s_add_u32 m0, s38, 131072
s_add_u32 s39, s61, 0
buffer_load_dwordx4 v84, s[84:87], s39 offen lds
s_add_u32 m0, s38, 132096
s_add_u32 s39, s61, 65536
buffer_load_dwordx4 v84, s[84:87], s39 offen lds
s_add_u32 m0, s38, 133120
s_add_u32 s39, s61, 131072
buffer_load_dwordx4 v84, s[84:87], s39 offen lds
s_add_u32 m0, s38, 134144
s_add_u32 s39, s61, 196608
buffer_load_dwordx4 v84, s[84:87], s39 offen lds
s_add_u32 m0, s38, 135168
s_add_u32 s39, s61, 262144
buffer_load_dwordx4 v84, s[84:87], s39 offen lds
s_add_u32 m0, s38, 136192
s_add_u32 s39, s61, 327680
buffer_load_dwordx4 v84, s[84:87], s39 offen lds
s_add_u32 m0, s38, 137216
s_add_u32 s39, s61, 393216
buffer_load_dwordx4 v84, s[84:87], s39 offen lds
s_add_u32 m0, s38, 138240
s_add_u32 s39, s61, 458752
buffer_load_dwordx4 v84, s[84:87], s39 offen lds
s_waitcnt vmcnt(32)
s_barrier
ds_read_b64_tr_b16 v[128:129], v82 offset:0
ds_read_b64_tr_b16 v[130:131], v82 offset:512
ds_read_b64_tr_b16 v[132:133], v82 offset:4096
ds_read_b64_tr_b16 v[134:135], v82 offset:4608
ds_read_b64_tr_b16 v[160:161], v82 offset:8192
ds_read_b64_tr_b16 v[162:163], v82 offset:8704
ds_read_b64_tr_b16 v[164:165], v82 offset:12288
ds_read_b64_tr_b16 v[166:167], v82 offset:12800
ds_read_b64_tr_b16 v[192:193], v82 offset:16384
ds_read_b64_tr_b16 v[194:195], v82 offset:16896
ds_read_b64_tr_b16 v[196:197], v82 offset:20480
ds_read_b64_tr_b16 v[198:199], v82 offset:20992
ds_read_b64_tr_b16 v[224:225], v82 offset:24576
ds_read_b64_tr_b16 v[226:227], v82 offset:25088
ds_read_b64_tr_b16 v[228:229], v82 offset:28672
ds_read_b64_tr_b16 v[230:231], v82 offset:29184
Llw_575:
v_add_u32 v80, 32768, v80
v_add_u32 v81, 32768, v81
v_add_u32 v82, 32768, v82
s_waitcnt lgkmcnt(0)
s_barrier
s_add_u32 m0, s38, 0
s_add_u32 s39, s61, 524288
buffer_load_dwordx4 v84, s[84:87], s39 offen lds
s_add_u32 m0, s38, 1024
s_add_u32 s39, s61, 589824
buffer_load_dwordx4 v84, s[84:87], s39 offen lds
s_add_u32 m0, s38, 2048
s_add_u32 s39, s61, 655360
buffer_load_dwordx4 v84, s[84:87], s39 offen lds
s_add_u32 m0, s38, 3072
s_add_u32 s39, s61, 720896
buffer_load_dwordx4 v84, s[84:87], s39 offen lds
s_add_u32 m0, s38, 4096
s_add_u32 s39, s61, 786432
buffer_load_dwordx4 v84, s[84:87], s39 offen lds
s_add_u32 m0, s38, 5120
s_add_u32 s39, s61, 851968
buffer_load_dwordx4 v84, s[84:87], s39 offen lds
s_add_u32 m0, s38, 6144
s_add_u32 s39, s61, 917504
buffer_load_dwordx4 v84, s[84:87], s39 offen lds
s_add_u32 m0, s38, 7168
s_add_u32 s39, s61, 983040
buffer_load_dwordx4 v84, s[84:87], s39 offen lds
s_waitcnt vmcnt(32)
s_barrier
ds_read_b64_tr_b16 v[136:137], v82 offset:0
ds_read_b64_tr_b16 v[138:139], v82 offset:512
ds_read_b64_tr_b16 v[140:141], v82 offset:4096
ds_read_b64_tr_b16 v[142:143], v82 offset:4608
ds_read_b64_tr_b16 v[168:169], v82 offset:8192
ds_read_b64_tr_b16 v[170:171], v82 offset:8704
ds_read_b64_tr_b16 v[172:173], v82 offset:12288
ds_read_b64_tr_b16 v[174:175], v82 offset:12800
ds_read_b64_tr_b16 v[200:201], v82 offset:16384
ds_read_b64_tr_b16 v[202:203], v82 offset:16896
ds_read_b64_tr_b16 v[204:205], v82 offset:20480
ds_read_b64_tr_b16 v[206:207], v82 offset:20992
ds_read_b64_tr_b16 v[232:233], v82 offset:24576
ds_read_b64_tr_b16 v[234:235], v82 offset:25088
ds_read_b64_tr_b16 v[236:237], v82 offset:28672
ds_read_b64_tr_b16 v[238:239], v82 offset:29184
Llw_576:
v_add_u32 v80, 32768, v80
v_add_u32 v81, 32768, v81
v_add_u32 v82, 32768, v82
s_waitcnt lgkmcnt(0)
s_barrier
s_add_u32 m0, s38, 32768
s_add_u32 s39, s61, 1048576
buffer_load_dwordx4 v84, s[84:87], s39 offen lds
s_add_u32 m0, s38, 33792
s_add_u32 s39, s61, 1114112
buffer_load_dwordx4 v84, s[84:87], s39 offen lds
s_add_u32 m0, s38, 34816
s_add_u32 s39, s61, 1179648
buffer_load_dwordx4 v84, s[84:87], s39 offen lds
s_add_u32 m0, s38, 35840
s_add_u32 s39, s61, 1245184
buffer_load_dwordx4 v84, s[84:87], s39 offen lds
s_add_u32 m0, s38, 36864
s_add_u32 s39, s61, 1310720
buffer_load_dwordx4 v84, s[84:87], s39 offen lds
s_add_u32 m0, s38, 37888
s_add_u32 s39, s61, 1376256
buffer_load_dwordx4 v84, s[84:87], s39 offen lds
s_add_u32 m0, s38, 38912
s_add_u32 s39, s61, 1441792
buffer_load_dwordx4 v84, s[84:87], s39 offen lds
s_add_u32 m0, s38, 39936
s_add_u32 s39, s61, 1507328
buffer_load_dwordx4 v84, s[84:87], s39 offen lds
s_waitcnt vmcnt(32)
s_barrier
ds_read_b64_tr_b16 v[144:145], v82 offset:0
ds_read_b64_tr_b16 v[146:147], v82 offset:512
ds_read_b64_tr_b16 v[148:149], v82 offset:4096
ds_read_b64_tr_b16 v[150:151], v82 offset:4608
ds_read_b64_tr_b16 v[176:177], v82 offset:8192
ds_read_b64_tr_b16 v[178:179], v82 offset:8704
ds_read_b64_tr_b16 v[180:181], v82 offset:12288
ds_read_b64_tr_b16 v[182:183], v82 offset:12800
ds_read_b64_tr_b16 v[208:209], v82 offset:16384
ds_read_b64_tr_b16 v[210:211], v82 offset:16896
ds_read_b64_tr_b16 v[212:213], v82 offset:20480
ds_read_b64_tr_b16 v[214:215], v82 offset:20992
ds_read_b64_tr_b16 v[240:241], v82 offset:24576
ds_read_b64_tr_b16 v[242:243], v82 offset:25088
ds_read_b64_tr_b16 v[244:245], v82 offset:28672
ds_read_b64_tr_b16 v[246:247], v82 offset:29184
Llw_577:
v_add_u32 v80, 32768, v80
v_add_u32 v81, 32768, v81
v_add_u32 v82, 32768, v82
s_waitcnt lgkmcnt(0)
s_barrier
s_add_u32 m0, s38, 65536
s_add_u32 s39, s61, 1572864
buffer_load_dwordx4 v84, s[84:87], s39 offen lds
s_add_u32 m0, s38, 66560
s_add_u32 s39, s61, 1638400
buffer_load_dwordx4 v84, s[84:87], s39 offen lds
s_add_u32 m0, s38, 67584
s_add_u32 s39, s61, 1703936
buffer_load_dwordx4 v84, s[84:87], s39 offen lds
s_add_u32 m0, s38, 68608
s_add_u32 s39, s61, 1769472
buffer_load_dwordx4 v84, s[84:87], s39 offen lds
s_add_u32 m0, s38, 69632
s_add_u32 s39, s61, 1835008
buffer_load_dwordx4 v84, s[84:87], s39 offen lds
s_add_u32 m0, s38, 70656
s_add_u32 s39, s61, 1900544
buffer_load_dwordx4 v84, s[84:87], s39 offen lds
s_add_u32 m0, s38, 71680
s_add_u32 s39, s61, 1966080
buffer_load_dwordx4 v84, s[84:87], s39 offen lds
s_add_u32 m0, s38, 72704
s_add_u32 s39, s61, 2031616
buffer_load_dwordx4 v84, s[84:87], s39 offen lds
s_waitcnt vmcnt(32)
s_barrier
ds_read_b64_tr_b16 v[152:153], v82 offset:0
ds_read_b64_tr_b16 v[154:155], v82 offset:512
ds_read_b64_tr_b16 v[156:157], v82 offset:4096
ds_read_b64_tr_b16 v[158:159], v82 offset:4608
ds_read_b64_tr_b16 v[184:185], v82 offset:8192
ds_read_b64_tr_b16 v[186:187], v82 offset:8704
ds_read_b64_tr_b16 v[188:189], v82 offset:12288
ds_read_b64_tr_b16 v[190:191], v82 offset:12800
ds_read_b64_tr_b16 v[216:217], v82 offset:16384
ds_read_b64_tr_b16 v[218:219], v82 offset:16896
ds_read_b64_tr_b16 v[220:221], v82 offset:20480
ds_read_b64_tr_b16 v[222:223], v82 offset:20992
ds_read_b64_tr_b16 v[248:249], v82 offset:24576
ds_read_b64_tr_b16 v[250:251], v82 offset:25088
ds_read_b64_tr_b16 v[252:253], v82 offset:28672
ds_read_b64_tr_b16 v[254:255], v82 offset:29184
Llw_578:
v_add_u32 v80, 32768, v80
v_add_u32 v81, 32768, v81
v_add_u32 v82, 32768, v82
s_waitcnt lgkmcnt(0)
s_barrier
s_add_u32 m0, s38, 98304
s_add_u32 s39, s60, 0
buffer_load_dwordx4 v84, s[8:11], s39 offen lds
s_add_u32 m0, s38, 99328
s_add_u32 s39, s60, 65536
buffer_load_dwordx4 v84, s[8:11], s39 offen lds
s_add_u32 m0, s38, 100352
s_add_u32 s39, s60, 131072
buffer_load_dwordx4 v84, s[8:11], s39 offen lds
s_add_u32 m0, s38, 101376
s_add_u32 s39, s60, 196608
buffer_load_dwordx4 v84, s[8:11], s39 offen lds
s_add_u32 m0, s38, 102400
s_add_u32 s39, s60, 262144
buffer_load_dwordx4 v84, s[8:11], s39 offen lds
s_add_u32 m0, s38, 103424
s_add_u32 s39, s60, 327680
buffer_load_dwordx4 v84, s[8:11], s39 offen lds
s_add_u32 m0, s38, 104448
s_add_u32 s39, s60, 393216
buffer_load_dwordx4 v84, s[8:11], s39 offen lds
s_add_u32 m0, s38, 105472
s_add_u32 s39, s60, 458752
buffer_load_dwordx4 v84, s[8:11], s39 offen lds
s_waitcnt vmcnt(32)
s_barrier
s_bitcmp0_b32 s32, 1
s_cbranch_scc1 Llw_579
ds_read_b64_tr_b16 a[0:1], v80 offset:0
ds_read_b64_tr_b16 a[2:3], v80 offset:512
ds_read_b64_tr_b16 a[4:5], v80 offset:4096
ds_read_b64_tr_b16 a[6:7], v80 offset:4608
ds_read_b64_tr_b16 a[32:33], v80 offset:8192
ds_read_b64_tr_b16 a[34:35], v80 offset:8704
ds_read_b64_tr_b16 a[36:37], v80 offset:12288
ds_read_b64_tr_b16 a[38:39], v80 offset:12800
ds_read_b64_tr_b16 a[64:65], v80 offset:16384
ds_read_b64_tr_b16 a[66:67], v80 offset:16896
ds_read_b64_tr_b16 a[68:69], v80 offset:20480
ds_read_b64_tr_b16 a[70:71], v80 offset:20992
ds_read_b64_tr_b16 a[96:97], v80 offset:24576
ds_read_b64_tr_b16 a[98:99], v80 offset:25088
ds_read_b64_tr_b16 a[100:101], v80 offset:28672
ds_read_b64_tr_b16 a[102:103], v80 offset:29184
ds_read_b64_tr_b16 a[128:129], v81 offset:0
ds_read_b64_tr_b16 a[130:131], v81 offset:512
ds_read_b64_tr_b16 a[132:133], v81 offset:4096
ds_read_b64_tr_b16 a[134:135], v81 offset:4608
ds_read_b64_tr_b16 a[160:161], v81 offset:8192
ds_read_b64_tr_b16 a[162:163], v81 offset:8704
ds_read_b64_tr_b16 a[164:165], v81 offset:12288
ds_read_b64_tr_b16 a[166:167], v81 offset:12800
ds_read_b64_tr_b16 a[192:193], v81 offset:16384
ds_read_b64_tr_b16 a[194:195], v81 offset:16896
ds_read_b64_tr_b16 a[196:197], v81 offset:20480
ds_read_b64_tr_b16 a[198:199], v81 offset:20992
ds_read_b64_tr_b16 a[224:225], v81 offset:24576
ds_read_b64_tr_b16 a[226:227], v81 offset:25088
ds_read_b64_tr_b16 a[228:229], v81 offset:28672
ds_read_b64_tr_b16 a[230:231], v81 offset:29184
Llw_579:
v_add_u32 v80, -131072, v80
v_add_u32 v81, -131072, v81
v_add_u32 v82, -131072, v82
s_waitcnt lgkmcnt(0)
s_barrier
s_add_u32 m0, s38, 131072
s_add_u32 s39, s60, 524288
buffer_load_dwordx4 v84, s[8:11], s39 offen lds
s_add_u32 m0, s38, 132096
s_add_u32 s39, s60, 589824
buffer_load_dwordx4 v84, s[8:11], s39 offen lds
s_add_u32 m0, s38, 133120
s_add_u32 s39, s60, 655360
buffer_load_dwordx4 v84, s[8:11], s39 offen lds
s_add_u32 m0, s38, 134144
s_add_u32 s39, s60, 720896
buffer_load_dwordx4 v84, s[8:11], s39 offen lds
s_add_u32 m0, s38, 135168
s_add_u32 s39, s60, 786432
buffer_load_dwordx4 v84, s[8:11], s39 offen lds
s_add_u32 m0, s38, 136192
s_add_u32 s39, s60, 851968
buffer_load_dwordx4 v84, s[8:11], s39 offen lds
s_add_u32 m0, s38, 137216
s_add_u32 s39, s60, 917504
buffer_load_dwordx4 v84, s[8:11], s39 offen lds
s_add_u32 m0, s38, 138240
s_add_u32 s39, s60, 983040
buffer_load_dwordx4 v84, s[8:11], s39 offen lds
s_waitcnt vmcnt(32)
s_barrier
s_bitcmp0_b32 s32, 1
s_cbranch_scc1 Llw_580
ds_read_b64_tr_b16 a[8:9], v80 offset:0
ds_read_b64_tr_b16 a[10:11], v80 offset:512
ds_read_b64_tr_b16 a[12:13], v80 offset:4096
ds_read_b64_tr_b16 a[14:15], v80 offset:4608
ds_read_b64_tr_b16 a[40:41], v80 offset:8192
ds_read_b64_tr_b16 a[42:43], v80 offset:8704
ds_read_b64_tr_b16 a[44:45], v80 offset:12288
ds_read_b64_tr_b16 a[46:47], v80 offset:12800
ds_read_b64_tr_b16 a[72:73], v80 offset:16384
ds_read_b64_tr_b16 a[74:75], v80 offset:16896
ds_read_b64_tr_b16 a[76:77], v80 offset:20480
ds_read_b64_tr_b16 a[78:79], v80 offset:20992
ds_read_b64_tr_b16 a[104:105], v80 offset:24576
ds_read_b64_tr_b16 a[106:107], v80 offset:25088
ds_read_b64_tr_b16 a[108:109], v80 offset:28672
ds_read_b64_tr_b16 a[110:111], v80 offset:29184
ds_read_b64_tr_b16 a[136:137], v81 offset:0
ds_read_b64_tr_b16 a[138:139], v81 offset:512
ds_read_b64_tr_b16 a[140:141], v81 offset:4096
ds_read_b64_tr_b16 a[142:143], v81 offset:4608
ds_read_b64_tr_b16 a[168:169], v81 offset:8192
ds_read_b64_tr_b16 a[170:171], v81 offset:8704
ds_read_b64_tr_b16 a[172:173], v81 offset:12288
ds_read_b64_tr_b16 a[174:175], v81 offset:12800
ds_read_b64_tr_b16 a[200:201], v81 offset:16384
ds_read_b64_tr_b16 a[202:203], v81 offset:16896
ds_read_b64_tr_b16 a[204:205], v81 offset:20480
ds_read_b64_tr_b16 a[206:207], v81 offset:20992
ds_read_b64_tr_b16 a[232:233], v81 offset:24576
ds_read_b64_tr_b16 a[234:235], v81 offset:25088
ds_read_b64_tr_b16 a[236:237], v81 offset:28672
ds_read_b64_tr_b16 a[238:239], v81 offset:29184
Llw_580:
v_add_u32 v80, 32768, v80
v_add_u32 v81, 32768, v81
v_add_u32 v82, 32768, v82
s_waitcnt lgkmcnt(0)
s_barrier
s_add_u32 m0, s38, 0
s_add_u32 s39, s60, 1048576
buffer_load_dwordx4 v84, s[8:11], s39 offen lds
s_add_u32 m0, s38, 1024
s_add_u32 s39, s60, 1114112
buffer_load_dwordx4 v84, s[8:11], s39 offen lds
s_add_u32 m0, s38, 2048
s_add_u32 s39, s60, 1179648
buffer_load_dwordx4 v84, s[8:11], s39 offen lds
s_add_u32 m0, s38, 3072
s_add_u32 s39, s60, 1245184
buffer_load_dwordx4 v84, s[8:11], s39 offen lds
s_add_u32 m0, s38, 4096
s_add_u32 s39, s60, 1310720
buffer_load_dwordx4 v84, s[8:11], s39 offen lds
s_add_u32 m0, s38, 5120
s_add_u32 s39, s60, 1376256
buffer_load_dwordx4 v84, s[8:11], s39 offen lds
s_add_u32 m0, s38, 6144
s_add_u32 s39, s60, 1441792
buffer_load_dwordx4 v84, s[8:11], s39 offen lds
s_add_u32 m0, s38, 7168
s_add_u32 s39, s60, 1507328
buffer_load_dwordx4 v84, s[8:11], s39 offen lds
s_waitcnt vmcnt(32)
s_barrier
s_bitcmp0_b32 s32, 1
s_cbranch_scc1 Llw_581
ds_read_b64_tr_b16 a[16:17], v80 offset:0
ds_read_b64_tr_b16 a[18:19], v80 offset:512
ds_read_b64_tr_b16 a[20:21], v80 offset:4096
ds_read_b64_tr_b16 a[22:23], v80 offset:4608
ds_read_b64_tr_b16 a[48:49], v80 offset:8192
ds_read_b64_tr_b16 a[50:51], v80 offset:8704
ds_read_b64_tr_b16 a[52:53], v80 offset:12288
ds_read_b64_tr_b16 a[54:55], v80 offset:12800
ds_read_b64_tr_b16 a[80:81], v80 offset:16384
ds_read_b64_tr_b16 a[82:83], v80 offset:16896
ds_read_b64_tr_b16 a[84:85], v80 offset:20480
ds_read_b64_tr_b16 a[86:87], v80 offset:20992
ds_read_b64_tr_b16 a[112:113], v80 offset:24576
ds_read_b64_tr_b16 a[114:115], v80 offset:25088
ds_read_b64_tr_b16 a[116:117], v80 offset:28672
ds_read_b64_tr_b16 a[118:119], v80 offset:29184
ds_read_b64_tr_b16 a[144:145], v81 offset:0
ds_read_b64_tr_b16 a[146:147], v81 offset:512
ds_read_b64_tr_b16 a[148:149], v81 offset:4096
ds_read_b64_tr_b16 a[150:151], v81 offset:4608
ds_read_b64_tr_b16 a[176:177], v81 offset:8192
ds_read_b64_tr_b16 a[178:179], v81 offset:8704
ds_read_b64_tr_b16 a[180:181], v81 offset:12288
ds_read_b64_tr_b16 a[182:183], v81 offset:12800
ds_read_b64_tr_b16 a[208:209], v81 offset:16384
ds_read_b64_tr_b16 a[210:211], v81 offset:16896
ds_read_b64_tr_b16 a[212:213], v81 offset:20480
ds_read_b64_tr_b16 a[214:215], v81 offset:20992
ds_read_b64_tr_b16 a[240:241], v81 offset:24576
ds_read_b64_tr_b16 a[242:243], v81 offset:25088
ds_read_b64_tr_b16 a[244:245], v81 offset:28672
ds_read_b64_tr_b16 a[246:247], v81 offset:29184
Llw_581:
v_add_u32 v80, 32768, v80
v_add_u32 v81, 32768, v81
v_add_u32 v82, 32768, v82
s_waitcnt lgkmcnt(0)
s_barrier
s_add_u32 m0, s38, 32768
s_add_u32 s39, s60, 1572864
buffer_load_dwordx4 v84, s[8:11], s39 offen lds
s_add_u32 m0, s38, 33792
s_add_u32 s39, s60, 1638400
buffer_load_dwordx4 v84, s[8:11], s39 offen lds
s_add_u32 m0, s38, 34816
s_add_u32 s39, s60, 1703936
buffer_load_dwordx4 v84, s[8:11], s39 offen lds
s_add_u32 m0, s38, 35840
s_add_u32 s39, s60, 1769472
buffer_load_dwordx4 v84, s[8:11], s39 offen lds
s_add_u32 m0, s38, 36864
s_add_u32 s39, s60, 1835008
buffer_load_dwordx4 v84, s[8:11], s39 offen lds
s_add_u32 m0, s38, 37888
s_add_u32 s39, s60, 1900544
buffer_load_dwordx4 v84, s[8:11], s39 offen lds
s_add_u32 m0, s38, 38912
s_add_u32 s39, s60, 1966080
buffer_load_dwordx4 v84, s[8:11], s39 offen lds
s_add_u32 m0, s38, 39936
s_add_u32 s39, s60, 2031616
buffer_load_dwordx4 v84, s[8:11], s39 offen lds
s_waitcnt vmcnt(32)
s_barrier
s_bitcmp0_b32 s32, 1
s_cbranch_scc1 Llw_582
ds_read_b64_tr_b16 a[24:25], v80 offset:0
ds_read_b64_tr_b16 a[26:27], v80 offset:512
ds_read_b64_tr_b16 a[28:29], v80 offset:4096
ds_read_b64_tr_b16 a[30:31], v80 offset:4608
ds_read_b64_tr_b16 a[56:57], v80 offset:8192
ds_read_b64_tr_b16 a[58:59], v80 offset:8704
ds_read_b64_tr_b16 a[60:61], v80 offset:12288
ds_read_b64_tr_b16 a[62:63], v80 offset:12800
ds_read_b64_tr_b16 a[88:89], v80 offset:16384
ds_read_b64_tr_b16 a[90:91], v80 offset:16896
ds_read_b64_tr_b16 a[92:93], v80 offset:20480
ds_read_b64_tr_b16 a[94:95], v80 offset:20992
ds_read_b64_tr_b16 a[120:121], v80 offset:24576
ds_read_b64_tr_b16 a[122:123], v80 offset:25088
ds_read_b64_tr_b16 a[124:125], v80 offset:28672
ds_read_b64_tr_b16 a[126:127], v80 offset:29184
ds_read_b64_tr_b16 a[152:153], v81 offset:0
ds_read_b64_tr_b16 a[154:155], v81 offset:512
ds_read_b64_tr_b16 a[156:157], v81 offset:4096
ds_read_b64_tr_b16 a[158:159], v81 offset:4608
ds_read_b64_tr_b16 a[184:185], v81 offset:8192
ds_read_b64_tr_b16 a[186:187], v81 offset:8704
ds_read_b64_tr_b16 a[188:189], v81 offset:12288
ds_read_b64_tr_b16 a[190:191], v81 offset:12800
ds_read_b64_tr_b16 a[216:217], v81 offset:16384
ds_read_b64_tr_b16 a[218:219], v81 offset:16896
ds_read_b64_tr_b16 a[220:221], v81 offset:20480
ds_read_b64_tr_b16 a[222:223], v81 offset:20992
ds_read_b64_tr_b16 a[248:249], v81 offset:24576
ds_read_b64_tr_b16 a[250:251], v81 offset:25088
ds_read_b64_tr_b16 a[252:253], v81 offset:28672
ds_read_b64_tr_b16 a[254:255], v81 offset:29184
Llw_582:
v_add_u32 v80, 32768, v80
v_add_u32 v81, 32768, v81
v_add_u32 v82, 32768, v82
s_waitcnt lgkmcnt(0)
s_barrier
s_waitcnt vmcnt(24)
s_barrier
s_bitcmp1_b32 s32, 1
s_cbranch_scc1 Llw_583
ds_read_b64_tr_b16 a[0:1], v80 offset:0
ds_read_b64_tr_b16 a[2:3], v80 offset:512
ds_read_b64_tr_b16 a[4:5], v80 offset:4096
ds_read_b64_tr_b16 a[6:7], v80 offset:4608
ds_read_b64_tr_b16 a[32:33], v80 offset:8192
ds_read_b64_tr_b16 a[34:35], v80 offset:8704
ds_read_b64_tr_b16 a[36:37], v80 offset:12288
ds_read_b64_tr_b16 a[38:39], v80 offset:12800
ds_read_b64_tr_b16 a[64:65], v80 offset:16384
ds_read_b64_tr_b16 a[66:67], v80 offset:16896
ds_read_b64_tr_b16 a[68:69], v80 offset:20480
ds_read_b64_tr_b16 a[70:71], v80 offset:20992
ds_read_b64_tr_b16 a[96:97], v80 offset:24576
ds_read_b64_tr_b16 a[98:99], v80 offset:25088
ds_read_b64_tr_b16 a[100:101], v80 offset:28672
ds_read_b64_tr_b16 a[102:103], v80 offset:29184
ds_read_b64_tr_b16 a[128:129], v81 offset:0
ds_read_b64_tr_b16 a[130:131], v81 offset:512
ds_read_b64_tr_b16 a[132:133], v81 offset:4096
ds_read_b64_tr_b16 a[134:135], v81 offset:4608
ds_read_b64_tr_b16 a[160:161], v81 offset:8192
ds_read_b64_tr_b16 a[162:163], v81 offset:8704
ds_read_b64_tr_b16 a[164:165], v81 offset:12288
ds_read_b64_tr_b16 a[166:167], v81 offset:12800
ds_read_b64_tr_b16 a[192:193], v81 offset:16384
ds_read_b64_tr_b16 a[194:195], v81 offset:16896
ds_read_b64_tr_b16 a[196:197], v81 offset:20480
ds_read_b64_tr_b16 a[198:199], v81 offset:20992
ds_read_b64_tr_b16 a[224:225], v81 offset:24576
ds_read_b64_tr_b16 a[226:227], v81 offset:25088
ds_read_b64_tr_b16 a[228:229], v81 offset:28672
ds_read_b64_tr_b16 a[230:231], v81 offset:29184
Llw_583:
v_add_u32 v80, 32768, v80
v_add_u32 v81, 32768, v81
v_add_u32 v82, 32768, v82
s_waitcnt lgkmcnt(0)
s_barrier
s_waitcnt vmcnt(16)
s_barrier
s_bitcmp1_b32 s32, 1
s_cbranch_scc1 Llw_584
ds_read_b64_tr_b16 a[8:9], v80 offset:0
ds_read_b64_tr_b16 a[10:11], v80 offset:512
ds_read_b64_tr_b16 a[12:13], v80 offset:4096
ds_read_b64_tr_b16 a[14:15], v80 offset:4608
ds_read_b64_tr_b16 a[40:41], v80 offset:8192
ds_read_b64_tr_b16 a[42:43], v80 offset:8704
ds_read_b64_tr_b16 a[44:45], v80 offset:12288
ds_read_b64_tr_b16 a[46:47], v80 offset:12800
ds_read_b64_tr_b16 a[72:73], v80 offset:16384
ds_read_b64_tr_b16 a[74:75], v80 offset:16896
ds_read_b64_tr_b16 a[76:77], v80 offset:20480
ds_read_b64_tr_b16 a[78:79], v80 offset:20992
ds_read_b64_tr_b16 a[104:105], v80 offset:24576
ds_read_b64_tr_b16 a[106:107], v80 offset:25088
ds_read_b64_tr_b16 a[108:109], v80 offset:28672
ds_read_b64_tr_b16 a[110:111], v80 offset:29184
ds_read_b64_tr_b16 a[136:137], v81 offset:0
ds_read_b64_tr_b16 a[138:139], v81 offset:512
ds_read_b64_tr_b16 a[140:141], v81 offset:4096
ds_read_b64_tr_b16 a[142:143], v81 offset:4608
ds_read_b64_tr_b16 a[168:169], v81 offset:8192
ds_read_b64_tr_b16 a[170:171], v81 offset:8704
ds_read_b64_tr_b16 a[172:173], v81 offset:12288
ds_read_b64_tr_b16 a[174:175], v81 offset:12800
ds_read_b64_tr_b16 a[200:201], v81 offset:16384
ds_read_b64_tr_b16 a[202:203], v81 offset:16896
ds_read_b64_tr_b16 a[204:205], v81 offset:20480
ds_read_b64_tr_b16 a[206:207], v81 offset:20992
ds_read_b64_tr_b16 a[232:233], v81 offset:24576
ds_read_b64_tr_b16 a[234:235], v81 offset:25088
ds_read_b64_tr_b16 a[236:237], v81 offset:28672
ds_read_b64_tr_b16 a[238:239], v81 offset:29184
Llw_584:
v_add_u32 v80, -131072, v80
v_add_u32 v81, -131072, v81
v_add_u32 v82, -131072, v82
s_waitcnt lgkmcnt(0)
s_barrier
s_waitcnt vmcnt(8)
s_barrier
s_bitcmp1_b32 s32, 1
s_cbranch_scc1 Llw_585
ds_read_b64_tr_b16 a[16:17], v80 offset:0
ds_read_b64_tr_b16 a[18:19], v80 offset:512
ds_read_b64_tr_b16 a[20:21], v80 offset:4096
ds_read_b64_tr_b16 a[22:23], v80 offset:4608
ds_read_b64_tr_b16 a[48:49], v80 offset:8192
ds_read_b64_tr_b16 a[50:51], v80 offset:8704
ds_read_b64_tr_b16 a[52:53], v80 offset:12288
ds_read_b64_tr_b16 a[54:55], v80 offset:12800
ds_read_b64_tr_b16 a[80:81], v80 offset:16384
ds_read_b64_tr_b16 a[82:83], v80 offset:16896
ds_read_b64_tr_b16 a[84:85], v80 offset:20480
ds_read_b64_tr_b16 a[86:87], v80 offset:20992
ds_read_b64_tr_b16 a[112:113], v80 offset:24576
ds_read_b64_tr_b16 a[114:115], v80 offset:25088
ds_read_b64_tr_b16 a[116:117], v80 offset:28672
ds_read_b64_tr_b16 a[118:119], v80 offset:29184
ds_read_b64_tr_b16 a[144:145], v81 offset:0
ds_read_b64_tr_b16 a[146:147], v81 offset:512
ds_read_b64_tr_b16 a[148:149], v81 offset:4096
ds_read_b64_tr_b16 a[150:151], v81 offset:4608
ds_read_b64_tr_b16 a[176:177], v81 offset:8192
ds_read_b64_tr_b16 a[178:179], v81 offset:8704
ds_read_b64_tr_b16 a[180:181], v81 offset:12288
ds_read_b64_tr_b16 a[182:183], v81 offset:12800
ds_read_b64_tr_b16 a[208:209], v81 offset:16384
ds_read_b64_tr_b16 a[210:211], v81 offset:16896
ds_read_b64_tr_b16 a[212:213], v81 offset:20480
ds_read_b64_tr_b16 a[214:215], v81 offset:20992
ds_read_b64_tr_b16 a[240:241], v81 offset:24576
ds_read_b64_tr_b16 a[242:243], v81 offset:25088
ds_read_b64_tr_b16 a[244:245], v81 offset:28672
ds_read_b64_tr_b16 a[246:247], v81 offset:29184
Llw_585:
v_add_u32 v80, 32768, v80
v_add_u32 v81, 32768, v81
v_add_u32 v82, 32768, v82
s_waitcnt lgkmcnt(0)
s_barrier
s_waitcnt vmcnt(0)
s_barrier
s_bitcmp1_b32 s32, 1
s_cbranch_scc1 Llw_586
ds_read_b64_tr_b16 a[24:25], v80 offset:0
ds_read_b64_tr_b16 a[26:27], v80 offset:512
ds_read_b64_tr_b16 a[28:29], v80 offset:4096
ds_read_b64_tr_b16 a[30:31], v80 offset:4608
ds_read_b64_tr_b16 a[56:57], v80 offset:8192
ds_read_b64_tr_b16 a[58:59], v80 offset:8704
ds_read_b64_tr_b16 a[60:61], v80 offset:12288
ds_read_b64_tr_b16 a[62:63], v80 offset:12800
ds_read_b64_tr_b16 a[88:89], v80 offset:16384
ds_read_b64_tr_b16 a[90:91], v80 offset:16896
ds_read_b64_tr_b16 a[92:93], v80 offset:20480
ds_read_b64_tr_b16 a[94:95], v80 offset:20992
ds_read_b64_tr_b16 a[120:121], v80 offset:24576
ds_read_b64_tr_b16 a[122:123], v80 offset:25088
ds_read_b64_tr_b16 a[124:125], v80 offset:28672
ds_read_b64_tr_b16 a[126:127], v80 offset:29184
ds_read_b64_tr_b16 a[152:153], v81 offset:0
ds_read_b64_tr_b16 a[154:155], v81 offset:512
ds_read_b64_tr_b16 a[156:157], v81 offset:4096
ds_read_b64_tr_b16 a[158:159], v81 offset:4608
ds_read_b64_tr_b16 a[184:185], v81 offset:8192
ds_read_b64_tr_b16 a[186:187], v81 offset:8704
ds_read_b64_tr_b16 a[188:189], v81 offset:12288
ds_read_b64_tr_b16 a[190:191], v81 offset:12800
ds_read_b64_tr_b16 a[216:217], v81 offset:16384
ds_read_b64_tr_b16 a[218:219], v81 offset:16896
ds_read_b64_tr_b16 a[220:221], v81 offset:20480
ds_read_b64_tr_b16 a[222:223], v81 offset:20992
ds_read_b64_tr_b16 a[248:249], v81 offset:24576
ds_read_b64_tr_b16 a[250:251], v81 offset:25088
ds_read_b64_tr_b16 a[252:253], v81 offset:28672
ds_read_b64_tr_b16 a[254:255], v81 offset:29184
Llw_586:
v_add_u32 v80, 32768, v80
v_add_u32 v81, 32768, v81
v_add_u32 v82, 32768, v82
s_waitcnt lgkmcnt(0)
s_barrier
Lst_587:
buffer_load_dword v48, off, s[12:15], 0 offset:160 sc1
buffer_load_dword v49, off, s[12:15], 0 offset:160 sc1
s_waitcnt vmcnt(0)
v_add_u32 v48, v48, v49
s_nop 0
v_readfirstlane_b32 s38, v48
s_nop 3
s_and_b32 s39, s38, 0xffff
s_cmp_eq_u32 s39, 0x100
s_cbranch_scc1 Lso_588
s_sub_u32 s37, s37, 1
s_cbranch_scc1 Lend_7
s_sleep 8
s_branch Lst_587
Lso_588:
s_bfe_u32 s35, s38, 0x80010
s_bfe_u32 s46, s38, 0x10018
s_lshl_b32 s46, s46, 13
s_barrier
s_mul_i32 s50, s32, 4096
v_lshlrev_b32 v1, 4, v9
v_add_u32 v0, s50, v1
v_min_u32 v2, 1, v9
v_lshlrev_b32 v2, 7, v2
s_and_b32 s52, s44, 1
s_lshr_b32 s38, s32, 1
s_lshl_b32 s38, s38, 3
s_and_b32 s39, s32, 1
s_add_u32 s38, s38, s39
s_lshl_b32 s39, s52, 1
s_add_u32 s38, s38, s39
s_lshl_b32 s38, s38, 10
s_lshr_b32 s53, s44, 1
s_and_b32 s39, s32, 2
s_xor_b32 s39, s39, s53
s_mul_i32 s39, s39, 24576
s_add_u32 s38, s38, s39
v_add_u32 v6, s38, v1
v_add_u32 v7, 4096, v6
s_lshl_b32 s38, s52, 2
s_add_u32 s38, s38, s32
s_add_u32 s38, s38, 16
s_lshl_b32 s38, s38, 10
s_xor_b32 s39, s53, 1
s_mul_i32 s39, s39, 24576
s_add_u32 s38, s38, s39
v_add_u32 v8, s38, v1
s_mov_b32 s49, 32768000
s_mov_b32 s54, 8388608
s_mov_b32 s36, 0
v_lshlrev_b32 v80, 7, v9
s_mov_b32 s38, 3424256
Lbw_592:
buffer_load_dword v81, v80, s[4:7], s38 offen sc1
s_waitcnt vmcnt(0)
v_cmp_gt_u32 vcc, 2, v81
s_cbranch_vccz Lbo_593
s_sub_u32 s37, s37, 1
s_cbranch_scc1 Lend_7
s_sleep 2
s_branch Lbw_592
Lbo_593:
s_add_u32 m0, s50, 0
s_add_u32 s39, s54, 0
buffer_load_dwordx4 v0, s[4:7], s39 offen offset:0 sc1 lds
buffer_load_dwordx4 v0, s[4:7], s39 offen offset:2048 sc1 lds
s_add_u32 m0, s50, 16384
s_add_u32 s39, s54, 16384
buffer_load_dwordx4 v0, s[4:7], s39 offen offset:0 sc1 lds
buffer_load_dwordx4 v0, s[4:7], s39 offen offset:2048 sc1 lds
s_add_u32 m0, s50, 32768
s_add_u32 s39, s54, 32768
buffer_load_dwordx4 v0, s[4:7], s39 offen offset:0 sc1 lds
buffer_load_dwordx4 v0, s[4:7], s39 offen offset:2048 sc1 lds
s_add_u32 m0, s50, 49152
s_add_u32 s39, s54, 49152
buffer_load_dwordx4 v0, s[4:7], s39 offen offset:0 sc1 lds
buffer_load_dwordx4 v0, s[4:7], s39 offen offset:2048 sc1 lds
s_add_u32 m0, s50, 0
s_add_u32 s39, s54, 0
buffer_load_dwordx4 v0, s[4:7], s39 offen offset:1024 sc1 lds
buffer_load_dwordx4 v0, s[4:7], s39 offen offset:3072 sc1 lds
s_add_u32 m0, s50, 16384
s_add_u32 s39, s54, 16384
buffer_load_dwordx4 v0, s[4:7], s39 offen offset:1024 sc1 lds
buffer_load_dwordx4 v0, s[4:7], s39 offen offset:3072 sc1 lds
s_add_u32 m0, s50, 32768
s_add_u32 s39, s54, 32768
buffer_load_dwordx4 v0, s[4:7], s39 offen offset:1024 sc1 lds
buffer_load_dwordx4 v0, s[4:7], s39 offen offset:3072 sc1 lds
s_add_u32 m0, s50, 49152
s_add_u32 s39, s54, 49152
buffer_load_dwordx4 v0, s[4:7], s39 offen offset:1024 sc1 lds
buffer_load_dwordx4 v0, s[4:7], s39 offen offset:3072 sc1 lds
s_waitcnt vmcnt(8)
s_barrier
ds_read_b128 v[16:19], v1 offset:0
ds_read_b128 v[20:23], v1 offset:2048
ds_read_b128 v[24:27], v1 offset:4096
ds_read_b128 v[28:31], v1 offset:6144
ds_read_b128 v[32:35], v1 offset:8192
ds_read_b128 v[36:39], v1 offset:10240
ds_read_b128 v[40:43], v1 offset:12288
s_mov_b32 s55, 0x70000000
s_mov_b32 s48, 28
Lql_589:
s_waitcnt lgkmcnt(5)
v_mfma_f32_16x16x32_bf16 v[48:51], a[0:3], v[16:19], 0
s_add_u32 s54, s54, 65536
ds_read_b128 v[44:47], v1 offset:14336
s_xor_b32 s50, s50, 0x10000
v_mfma_f32_16x16x32_bf16 v[52:55], a[128:131], v[16:19], 0
s_cmp_lt_u32 s36, 63
s_cselect_b32 s45, s54, 0x70000000
v_mfma_f32_16x16x32_bf16 v[64:67], v[16:19], v[128:131], 0
v_mfma_f32_16x16x32_bf16 v[48:51], a[4:7], v[20:23], v[48:51]
ds_read_b128 v[16:19], v1 offset:16384
v_mfma_f32_16x16x32_bf16 v[52:55], a[132:135], v[20:23], v[52:55]
v_mfma_f32_16x16x32_bf16 v[64:67], v[20:23], v[132:135], v[64:67]
s_waitcnt lgkmcnt(5)
v_mfma_f32_16x16x32_bf16 v[48:51], a[8:11], v[24:27], v[48:51]
ds_read_b128 v[20:23], v1 offset:18432
v_mfma_f32_16x16x32_bf16 v[52:55], a[136:139], v[24:27], v[52:55]
v_mfma_f32_16x16x32_bf16 v[64:67], v[24:27], v[136:139], v[64:67]
v_cvt_pk_bf16_f32 v84, v56, v57
v_cvt_pk_bf16_f32 v85, v58, v59
v_mfma_f32_16x16x32_bf16 v[48:51], a[12:15], v[28:31], v[48:51]
ds_read_b128 v[24:27], v1 offset:20480
v_cvt_pk_bf16_f32 v86, v60, v61
v_mfma_f32_16x16x32_bf16 v[52:55], a[140:143], v[28:31], v[52:55]
v_cvt_pk_bf16_f32 v87, v62, v63
v_cvt_pk_bf16_f32 v90, v68, v69
v_mfma_f32_16x16x32_bf16 v[64:67], v[28:31], v[140:143], v[64:67]
s_waitcnt lgkmcnt(5)
v_cvt_pk_bf16_f32 v91, v70, v71
v_mfma_f32_16x16x32_bf16 v[48:51], a[16:19], v[32:35], v[48:51]
ds_read_b128 v[28:31], v1 offset:22528
v_mfma_f32_16x16x32_bf16 v[52:55], a[144:147], v[32:35], v[52:55]
buffer_store_dwordx4 v[80:83], v6, s[4:7], s55 offen sc1
v_mfma_f32_16x16x32_bf16 v[64:67], v[32:35], v[144:147], v[64:67]
v_mfma_f32_16x16x32_bf16 v[48:51], a[20:23], v[36:39], v[48:51]
ds_read_b128 v[32:35], v1 offset:24576
v_mfma_f32_16x16x32_bf16 v[52:55], a[148:151], v[36:39], v[52:55]
v_mfma_f32_16x16x32_bf16 v[64:67], v[36:39], v[148:151], v[64:67]
s_waitcnt lgkmcnt(5)
buffer_store_dwordx4 v[84:87], v7, s[4:7], s55 offen sc1
v_mfma_f32_16x16x32_bf16 v[48:51], a[24:27], v[40:43], v[48:51]
ds_read_b128 v[36:39], v1 offset:26624
v_mfma_f32_16x16x32_bf16 v[52:55], a[152:155], v[40:43], v[52:55]
v_mfma_f32_16x16x32_bf16 v[64:67], v[40:43], v[152:155], v[64:67]
v_mfma_f32_16x16x32_bf16 v[48:51], a[28:31], v[44:47], v[48:51]
ds_read_b128 v[40:43], v1 offset:28672
v_mfma_f32_16x16x32_bf16 v[52:55], a[156:159], v[44:47], v[52:55]
buffer_store_dwordx4 v[88:91], v8, s[4:7], s55 offen sc1
v_mfma_f32_16x16x32_bf16 v[64:67], v[44:47], v[156:159], v[64:67]
s_waitcnt lgkmcnt(5)
v_mfma_f32_16x16x32_bf16 v[48:51], a[32:35], v[16:19], v[48:51]
ds_read_b128 v[44:47], v1 offset:30720
v_mfma_f32_16x16x32_bf16 v[52:55], a[160:163], v[16:19], v[52:55]
v_mfma_f32_16x16x32_bf16 v[64:67], v[16:19], v[160:163], v[64:67]
v_mov_b32 v5, s36
s_add_u32 m0, s50, 0
v_mfma_f32_16x16x32_bf16 v[48:51], a[36:39], v[20:23], v[48:51]
s_add_u32 s39, s45, 0
ds_read_b128 v[16:19], v1 offset:32768
buffer_load_dwordx4 v0, s[4:7], s39 offen offset:0 sc1 lds
v_mfma_f32_16x16x32_bf16 v[52:55], a[164:167], v[20:23], v[52:55]
v_mfma_f32_16x16x32_bf16 v[64:67], v[20:23], v[164:167], v[64:67]
s_waitcnt lgkmcnt(5)
v_mfma_f32_16x16x32_bf16 v[48:51], a[40:43], v[24:27], v[48:51]
ds_read_b128 v[20:23], v1 offset:34816
v_mfma_f32_16x16x32_bf16 v[52:55], a[168:171], v[24:27], v[52:55]
v_mfma_f32_16x16x32_bf16 v[64:67], v[24:27], v[168:171], v[64:67]
v_mfma_f32_16x16x32_bf16 v[48:51], a[44:47], v[28:31], v[48:51]
ds_read_b128 v[24:27], v1 offset:36864
v_mfma_f32_16x16x32_bf16 v[52:55], a[172:175], v[28:31], v[52:55]
v_mfma_f32_16x16x32_bf16 v[64:67], v[28:31], v[172:175], v[64:67]
s_waitcnt lgkmcnt(5)
v_mfma_f32_16x16x32_bf16 v[48:51], a[48:51], v[32:35], v[48:51]
ds_read_b128 v[28:31], v1 offset:38912
v_mfma_f32_16x16x32_bf16 v[52:55], a[176:179], v[32:35], v[52:55]
buffer_load_dwordx4 v0, s[4:7], s39 offen offset:2048 sc1 lds
v_mfma_f32_16x16x32_bf16 v[64:67], v[32:35], v[176:179], v[64:67]
v_mfma_f32_16x16x32_bf16 v[48:51], a[52:55], v[36:39], v[48:51]
ds_read_b128 v[32:35], v1 offset:40960
v_mfma_f32_16x16x32_bf16 v[52:55], a[180:183], v[36:39], v[52:55]
v_mfma_f32_16x16x32_bf16 v[64:67], v[36:39], v[180:183], v[64:67]
s_waitcnt lgkmcnt(5)
v_mfma_f32_16x16x32_bf16 v[48:51], a[56:59], v[40:43], v[48:51]
ds_read_b128 v[36:39], v1 offset:43008
v_mfma_f32_16x16x32_bf16 v[52:55], a[184:187], v[40:43], v[52:55]
v_mfma_f32_16x16x32_bf16 v[64:67], v[40:43], v[184:187], v[64:67]
v_mfma_f32_16x16x32_bf16 v[48:51], a[60:63], v[44:47], v[48:51]
ds_read_b128 v[40:43], v1 offset:45056
v_mfma_f32_16x16x32_bf16 v[52:55], a[188:191], v[44:47], v[52:55]
v_mfma_f32_16x16x32_bf16 v[64:67], v[44:47], v[188:191], v[64:67]
s_waitcnt lgkmcnt(5)
s_add_u32 m0, s50, 16384
s_add_u32 s39, s45, 16384
v_mfma_f32_16x16x32_bf16 v[48:51], a[64:67], v[16:19], v[48:51]
ds_read_b128 v[44:47], v1 offset:47104
buffer_load_dwordx4 v0, s[4:7], s39 offen offset:0 sc1 lds
v_mfma_f32_16x16x32_bf16 v[52:55], a[192:195], v[16:19], v[52:55]
v_mfma_f32_16x16x32_bf16 v[64:67], v[16:19], v[192:195], v[64:67]
v_mfma_f32_16x16x32_bf16 v[48:51], a[68:71], v[20:23], v[48:51]
ds_read_b128 v[16:19], v1 offset:49152
v_mfma_f32_16x16x32_bf16 v[52:55], a[196:199], v[20:23], v[52:55]
v_mfma_f32_16x16x32_bf16 v[64:67], v[20:23], v[196:199], v[64:67]
s_waitcnt lgkmcnt(5)
v_mfma_f32_16x16x32_bf16 v[48:51], a[72:75], v[24:27], v[48:51]
ds_read_b128 v[20:23], v1 offset:51200
v_mfma_f32_16x16x32_bf16 v[52:55], a[200:203], v[24:27], v[52:55]
v_mfma_f32_16x16x32_bf16 v[64:67], v[24:27], v[200:203], v[64:67]
v_mfma_f32_16x16x32_bf16 v[48:51], a[76:79], v[28:31], v[48:51]
ds_read_b128 v[24:27], v1 offset:53248
v_mfma_f32_16x16x32_bf16 v[52:55], a[204:207], v[28:31], v[52:55]
buffer_load_dwordx4 v0, s[4:7], s39 offen offset:2048 sc1 lds
v_mfma_f32_16x16x32_bf16 v[64:67], v[28:31], v[204:207], v[64:67]
s_waitcnt lgkmcnt(5)
v_mfma_f32_16x16x32_bf16 v[48:51], a[80:83], v[32:35], v[48:51]
ds_read_b128 v[28:31], v1 offset:55296
v_mfma_f32_16x16x32_bf16 v[52:55], a[208:211], v[32:35], v[52:55]
v_mfma_f32_16x16x32_bf16 v[64:67], v[32:35], v[208:211], v[64:67]
v_mfma_f32_16x16x32_bf16 v[48:51], a[84:87], v[36:39], v[48:51]
ds_read_b128 v[32:35], v1 offset:57344
v_mfma_f32_16x16x32_bf16 v[52:55], a[212:215], v[36:39], v[52:55]
v_mfma_f32_16x16x32_bf16 v[64:67], v[36:39], v[212:215], v[64:67]
s_waitcnt lgkmcnt(5)
v_mfma_f32_16x16x32_bf16 v[48:51], a[88:91], v[40:43], v[48:51]
ds_read_b128 v[36:39], v1 offset:59392
v_mfma_f32_16x16x32_bf16 v[52:55], a[216:219], v[40:43], v[52:55]
v_mfma_f32_16x16x32_bf16 v[64:67], v[40:43], v[216:219], v[64:67]
s_add_u32 m0, s50, 32768
s_add_u32 s39, s45, 32768
buffer_load_dwordx4 v0, s[4:7], s39 offen offset:0 sc1 lds
v_mfma_f32_16x16x32_bf16 v[48:51], a[92:95], v[44:47], v[48:51]
ds_read_b128 v[40:43], v1 offset:61440
v_mfma_f32_16x16x32_bf16 v[52:55], a[220:223], v[44:47], v[52:55]
v_mfma_f32_16x16x32_bf16 v[64:67], v[44:47], v[220:223], v[64:67]
s_waitcnt lgkmcnt(5)
v_mfma_f32_16x16x32_bf16 v[48:51], a[96:99], v[16:19], v[48:51]
ds_read_b128 v[44:47], v1 offset:63488
v_mfma_f32_16x16x32_bf16 v[52:55], a[224:227], v[16:19], v[52:55]
v_mfma_f32_16x16x32_bf16 v[64:67], v[16:19], v[224:227], v[64:67]
v_mfma_f32_16x16x32_bf16 v[48:51], a[100:103], v[20:23], v[48:51]
s_waitcnt vmcnt(5)
s_barrier
ds_read_b128 v[16:19], v1 offset:1024
v_mfma_f32_16x16x32_bf16 v[52:55], a[228:231], v[20:23], v[52:55]
buffer_store_dword v5, v4, s[4:7], 0 offen sc1
v_mfma_f32_16x16x32_bf16 v[64:67], v[20:23], v[228:231], v[64:67]
s_waitcnt lgkmcnt(5)
v_mfma_f32_16x16x32_bf16 v[48:51], a[104:107], v[24:27], v[48:51]
ds_read_b128 v[20:23], v1 offset:3072
v_mfma_f32_16x16x32_bf16 v[52:55], a[232:235], v[24:27], v[52:55]
v_mfma_f32_16x16x32_bf16 v[64:67], v[24:27], v[232:235], v[64:67]
v_mfma_f32_16x16x32_bf16 v[48:51], a[108:111], v[28:31], v[48:51]
ds_read_b128 v[24:27], v1 offset:5120
buffer_load_dwordx4 v0, s[4:7], s39 offen offset:2048 sc1 lds
v_mfma_f32_16x16x32_bf16 v[52:55], a[236:239], v[28:31], v[52:55]
v_mfma_f32_16x16x32_bf16 v[64:67], v[28:31], v[236:239], v[64:67]
s_waitcnt lgkmcnt(5)
v_mfma_f32_16x16x32_bf16 v[48:51], a[112:115], v[32:35], v[48:51]
ds_read_b128 v[28:31], v1 offset:7168
v_mfma_f32_16x16x32_bf16 v[52:55], a[240:243], v[32:35], v[52:55]
v_mfma_f32_16x16x32_bf16 v[64:67], v[32:35], v[240:243], v[64:67]
v_mfma_f32_16x16x32_bf16 v[48:51], a[116:119], v[36:39], v[48:51]
ds_read_b128 v[32:35], v1 offset:9216
v_mfma_f32_16x16x32_bf16 v[52:55], a[244:247], v[36:39], v[52:55]
v_mfma_f32_16x16x32_bf16 v[64:67], v[36:39], v[244:247], v[64:67]
s_waitcnt lgkmcnt(5)
v_mfma_f32_16x16x32_bf16 v[48:51], a[120:123], v[40:43], v[48:51]
ds_read_b128 v[36:39], v1 offset:11264
v_mfma_f32_16x16x32_bf16 v[52:55], a[248:251], v[40:43], v[52:55]
s_add_u32 m0, s50, 49152
s_add_u32 s39, s45, 49152
buffer_load_dwordx4 v0, s[4:7], s39 offen offset:0 sc1 lds
v_mfma_f32_16x16x32_bf16 v[64:67], v[40:43], v[248:251], v[64:67]
v_mfma_f32_16x16x32_bf16 v[48:51], a[124:127], v[44:47], v[48:51]
ds_read_b128 v[40:43], v1 offset:13312
v_mfma_f32_16x16x32_bf16 v[52:55], a[252:255], v[44:47], v[52:55]
v_mfma_f32_16x16x32_bf16 v[64:67], v[44:47], v[252:255], v[64:67]
s_waitcnt lgkmcnt(5)
v_mfma_f32_16x16x32_bf16 v[56:59], a[0:3], v[16:19], 0
ds_read_b128 v[44:47], v1 offset:15360
v_mfma_f32_16x16x32_bf16 v[60:63], a[128:131], v[16:19], 0
v_mfma_f32_16x16x32_bf16 v[68:71], v[16:19], v[128:131], 0
v_mfma_f32_16x16x32_bf16 v[56:59], a[4:7], v[20:23], v[56:59]
ds_read_b128 v[16:19], v1 offset:17408
v_mfma_f32_16x16x32_bf16 v[60:63], a[132:135], v[20:23], v[60:63]
v_mfma_f32_16x16x32_bf16 v[68:71], v[20:23], v[132:135], v[68:71]
s_waitcnt lgkmcnt(5)
buffer_load_dwordx4 v0, s[4:7], s39 offen offset:2048 sc1 lds
v_mfma_f32_16x16x32_bf16 v[56:59], a[8:11], v[24:27], v[56:59]
ds_read_b128 v[20:23], v1 offset:19456
v_mfma_f32_16x16x32_bf16 v[60:63], a[136:139], v[24:27], v[60:63]
v_mfma_f32_16x16x32_bf16 v[68:71], v[24:27], v[136:139], v[68:71]
v_mfma_f32_16x16x32_bf16 v[56:59], a[12:15], v[28:31], v[56:59]
ds_read_b128 v[24:27], v1 offset:21504
v_cvt_pk_bf16_f32 v80, v48, v49
v_mfma_f32_16x16x32_bf16 v[60:63], a[140:143], v[28:31], v[60:63]
v_cvt_pk_bf16_f32 v81, v50, v51
v_cvt_pk_bf16_f32 v82, v52, v53
v_mfma_f32_16x16x32_bf16 v[68:71], v[28:31], v[140:143], v[68:71]
s_waitcnt lgkmcnt(5)
v_cvt_pk_bf16_f32 v83, v54, v55
v_cvt_pk_bf16_f32 v88, v64, v65
v_mfma_f32_16x16x32_bf16 v[56:59], a[16:19], v[32:35], v[56:59]
ds_read_b128 v[28:31], v1 offset:23552
v_cvt_pk_bf16_f32 v89, v66, v67
v_mfma_f32_16x16x32_bf16 v[60:63], a[144:147], v[32:35], v[60:63]
s_add_u32 s49, s49, 786432
s_mov_b32 s55, s49
s_add_u32 s36, s36, 1
v_mfma_f32_16x16x32_bf16 v[68:71], v[32:35], v[144:147], v[68:71]
v_mfma_f32_16x16x32_bf16 v[56:59], a[20:23], v[36:39], v[56:59]
s_add_u32 m0, s50, 0
ds_read_b128 v[32:35], v1 offset:25600
s_add_u32 s39, s45, 0
v_mfma_f32_16x16x32_bf16 v[60:63], a[148:151], v[36:39], v[60:63]
buffer_load_dwordx4 v0, s[4:7], s39 offen offset:1024 sc1 lds
v_mfma_f32_16x16x32_bf16 v[68:71], v[36:39], v[148:151], v[68:71]
s_waitcnt lgkmcnt(5)
v_mfma_f32_16x16x32_bf16 v[56:59], a[24:27], v[40:43], v[56:59]
ds_read_b128 v[36:39], v1 offset:27648
v_mfma_f32_16x16x32_bf16 v[60:63], a[152:155], v[40:43], v[60:63]
v_mfma_f32_16x16x32_bf16 v[68:71], v[40:43], v[152:155], v[68:71]
v_mfma_f32_16x16x32_bf16 v[56:59], a[28:31], v[44:47], v[56:59]
ds_read_b128 v[40:43], v1 offset:29696
v_mfma_f32_16x16x32_bf16 v[60:63], a[156:159], v[44:47], v[60:63]
v_mfma_f32_16x16x32_bf16 v[68:71], v[44:47], v[156:159], v[68:71]
s_waitcnt lgkmcnt(5)
v_mfma_f32_16x16x32_bf16 v[56:59], a[32:35], v[16:19], v[56:59]
ds_read_b128 v[44:47], v1 offset:31744
v_mfma_f32_16x16x32_bf16 v[60:63], a[160:163], v[16:19], v[60:63]
v_mfma_f32_16x16x32_bf16 v[68:71], v[16:19], v[160:163], v[68:71]
buffer_load_dwordx4 v0, s[4:7], s39 offen offset:3072 sc1 lds
v_mfma_f32_16x16x32_bf16 v[56:59], a[36:39], v[20:23], v[56:59]
ds_read_b128 v[16:19], v1 offset:33792
v_mfma_f32_16x16x32_bf16 v[60:63], a[164:167], v[20:23], v[60:63]
v_mfma_f32_16x16x32_bf16 v[68:71], v[20:23], v[164:167], v[68:71]
s_waitcnt lgkmcnt(5)
v_mfma_f32_16x16x32_bf16 v[56:59], a[40:43], v[24:27], v[56:59]
ds_read_b128 v[20:23], v1 offset:35840
v_mfma_f32_16x16x32_bf16 v[60:63], a[168:171], v[24:27], v[60:63]
v_mfma_f32_16x16x32_bf16 v[68:71], v[24:27], v[168:171], v[68:71]
v_mfma_f32_16x16x32_bf16 v[56:59], a[44:47], v[28:31], v[56:59]
ds_read_b128 v[24:27], v1 offset:37888
v_mfma_f32_16x16x32_bf16 v[60:63], a[172:175], v[28:31], v[60:63]
v_mfma_f32_16x16x32_bf16 v[68:71], v[28:31], v[172:175], v[68:71]
s_waitcnt lgkmcnt(5)
v_mfma_f32_16x16x32_bf16 v[56:59], a[48:51], v[32:35], v[56:59]
s_add_u32 m0, s50, 16384
ds_read_b128 v[28:31], v1 offset:39936
s_add_u32 s39, s45, 16384
v_mfma_f32_16x16x32_bf16 v[60:63], a[176:179], v[32:35], v[60:63]
buffer_load_dwordx4 v0, s[4:7], s39 offen offset:1024 sc1 lds
v_mfma_f32_16x16x32_bf16 v[68:71], v[32:35], v[176:179], v[68:71]
v_mfma_f32_16x16x32_bf16 v[56:59], a[52:55], v[36:39], v[56:59]
ds_read_b128 v[32:35], v1 offset:41984
v_mfma_f32_16x16x32_bf16 v[60:63], a[180:183], v[36:39], v[60:63]
v_mfma_f32_16x16x32_bf16 v[68:71], v[36:39], v[180:183], v[68:71]
s_waitcnt lgkmcnt(5)
v_mfma_f32_16x16x32_bf16 v[56:59], a[56:59], v[40:43], v[56:59]
ds_read_b128 v[36:39], v1 offset:44032
v_mfma_f32_16x16x32_bf16 v[60:63], a[184:187], v[40:43], v[60:63]
v_mfma_f32_16x16x32_bf16 v[68:71], v[40:43], v[184:187], v[68:71]
v_mfma_f32_16x16x32_bf16 v[56:59], a[60:63], v[44:47], v[56:59]
ds_read_b128 v[40:43], v1 offset:46080
v_mfma_f32_16x16x32_bf16 v[60:63], a[188:191], v[44:47], v[60:63]
v_mfma_f32_16x16x32_bf16 v[68:71], v[44:47], v[188:191], v[68:71]
s_waitcnt lgkmcnt(5)
buffer_load_dwordx4 v0, s[4:7], s39 offen offset:3072 sc1 lds
v_mfma_f32_16x16x32_bf16 v[56:59], a[64:67], v[16:19], v[56:59]
ds_read_b128 v[44:47], v1 offset:48128
v_mfma_f32_16x16x32_bf16 v[60:63], a[192:195], v[16:19], v[60:63]
v_mfma_f32_16x16x32_bf16 v[68:71], v[16:19], v[192:195], v[68:71]
v_mfma_f32_16x16x32_bf16 v[56:59], a[68:71], v[20:23], v[56:59]
ds_read_b128 v[16:19], v1 offset:50176
v_mfma_f32_16x16x32_bf16 v[60:63], a[196:199], v[20:23], v[60:63]
v_mfma_f32_16x16x32_bf16 v[68:71], v[20:23], v[196:199], v[68:71]
s_waitcnt lgkmcnt(5)
v_mfma_f32_16x16x32_bf16 v[56:59], a[72:75], v[24:27], v[56:59]
ds_read_b128 v[20:23], v1 offset:52224
v_mfma_f32_16x16x32_bf16 v[60:63], a[200:203], v[24:27], v[60:63]
v_mfma_f32_16x16x32_bf16 v[68:71], v[24:27], v[200:203], v[68:71]
v_mfma_f32_16x16x32_bf16 v[56:59], a[76:79], v[28:31], v[56:59]
s_add_u32 m0, s50, 32768
ds_read_b128 v[24:27], v1 offset:54272
s_add_u32 s39, s45, 32768
v_mfma_f32_16x16x32_bf16 v[60:63], a[204:207], v[28:31], v[60:63]
buffer_load_dwordx4 v0, s[4:7], s39 offen offset:1024 sc1 lds
v_mfma_f32_16x16x32_bf16 v[68:71], v[28:31], v[204:207], v[68:71]
s_waitcnt lgkmcnt(5)
v_mfma_f32_16x16x32_bf16 v[56:59], a[80:83], v[32:35], v[56:59]
ds_read_b128 v[28:31], v1 offset:56320
v_mfma_f32_16x16x32_bf16 v[60:63], a[208:211], v[32:35], v[60:63]
v_mfma_f32_16x16x32_bf16 v[68:71], v[32:35], v[208:211], v[68:71]
v_mfma_f32_16x16x32_bf16 v[56:59], a[84:87], v[36:39], v[56:59]
ds_read_b128 v[32:35], v1 offset:58368
v_mfma_f32_16x16x32_bf16 v[60:63], a[212:215], v[36:39], v[60:63]
v_mfma_f32_16x16x32_bf16 v[68:71], v[36:39], v[212:215], v[68:71]
s_waitcnt lgkmcnt(5)
v_mfma_f32_16x16x32_bf16 v[56:59], a[88:91], v[40:43], v[56:59]
ds_read_b128 v[36:39], v1 offset:60416
v_mfma_f32_16x16x32_bf16 v[60:63], a[216:219], v[40:43], v[60:63]
v_mfma_f32_16x16x32_bf16 v[68:71], v[40:43], v[216:219], v[68:71]
buffer_load_dwordx4 v0, s[4:7], s39 offen offset:3072 sc1 lds
v_mfma_f32_16x16x32_bf16 v[56:59], a[92:95], v[44:47], v[56:59]
ds_read_b128 v[40:43], v1 offset:62464
v_mfma_f32_16x16x32_bf16 v[60:63], a[220:223], v[44:47], v[60:63]
v_mfma_f32_16x16x32_bf16 v[68:71], v[44:47], v[220:223], v[68:71]
s_waitcnt lgkmcnt(5)
v_mfma_f32_16x16x32_bf16 v[56:59], a[96:99], v[16:19], v[56:59]
ds_read_b128 v[44:47], v1 offset:64512
v_mfma_f32_16x16x32_bf16 v[60:63], a[224:227], v[16:19], v[60:63]
v_mfma_f32_16x16x32_bf16 v[68:71], v[16:19], v[224:227], v[68:71]
v_mfma_f32_16x16x32_bf16 v[56:59], a[100:103], v[20:23], v[56:59]
v_mfma_f32_16x16x32_bf16 v[60:63], a[228:231], v[20:23], v[60:63]
v_mfma_f32_16x16x32_bf16 v[68:71], v[20:23], v[228:231], v[68:71]
s_waitcnt lgkmcnt(4)
v_mfma_f32_16x16x32_bf16 v[56:59], a[104:107], v[24:27], v[56:59]
s_add_u32 m0, s50, 49152
s_add_u32 s39, s45, 49152
buffer_load_dwordx4 v0, s[4:7], s39 offen offset:1024 sc1 lds
v_mfma_f32_16x16x32_bf16 v[60:63], a[232:235], v[24:27], v[60:63]
v_mfma_f32_16x16x32_bf16 v[68:71], v[24:27], v[232:235], v[68:71]
v_xor_b32 v1, 0x10000, v1
s_waitcnt vmcnt(7) lgkmcnt(0)
s_barrier
v_mfma_f32_16x16x32_bf16 v[56:59], a[108:111], v[28:31], v[56:59]
ds_read_b128 v[16:19], v1 offset:0
ds_read_b128 v[20:23], v1 offset:2048
v_mfma_f32_16x16x32_bf16 v[60:63], a[236:239], v[28:31], v[60:63]
ds_read_b128 v[24:27], v1 offset:4096
v_mfma_f32_16x16x32_bf16 v[68:71], v[28:31], v[236:239], v[68:71]
v_mfma_f32_16x16x32_bf16 v[56:59], a[112:115], v[32:35], v[56:59]
ds_read_b128 v[28:31], v1 offset:6144
v_mfma_f32_16x16x32_bf16 v[60:63], a[240:243], v[32:35], v[60:63]
v_mfma_f32_16x16x32_bf16 v[68:71], v[32:35], v[240:243], v[68:71]
v_mfma_f32_16x16x32_bf16 v[56:59], a[116:119], v[36:39], v[56:59]
ds_read_b128 v[32:35], v1 offset:8192
v_mfma_f32_16x16x32_bf16 v[60:63], a[244:247], v[36:39], v[60:63]
buffer_load_dwordx4 v0, s[4:7], s39 offen offset:3072 sc1 lds
v_mfma_f32_16x16x32_bf16 v[68:71], v[36:39], v[244:247], v[68:71]
v_mfma_f32_16x16x32_bf16 v[56:59], a[120:123], v[40:43], v[56:59]
ds_read_b128 v[36:39], v1 offset:10240
v_mfma_f32_16x16x32_bf16 v[60:63], a[248:251], v[40:43], v[60:63]
v_mfma_f32_16x16x32_bf16 v[68:71], v[40:43], v[248:251], v[68:71]
s_cmp_lt_u32 s36, s48
v_mfma_f32_16x16x32_bf16 v[56:59], a[124:127], v[44:47], v[56:59]
ds_read_b128 v[40:43], v1 offset:12288
v_mfma_f32_16x16x32_bf16 v[60:63], a[252:255], v[44:47], v[60:63]
v_mfma_f32_16x16x32_bf16 v[68:71], v[44:47], v[252:255], v[68:71]
s_cbranch_scc1 Lql_589
s_cmp_eq_u32 s36, 64
s_cbranch_scc1 Lqe_591
v_lshlrev_b32 v14, 7, v9
s_mov_b32 s38, 3424256
Lbw_594:
buffer_load_dword v15, v14, s[4:7], s38 offen sc1
s_waitcnt vmcnt(0)
v_cmp_gt_u32 vcc, 3, v15
s_cbranch_vccz Lbo_595
s_sub_u32 s37, s37, 1
s_cbranch_scc1 Lend_7
s_sleep 2
s_branch Lbw_594
Lbo_595:
s_mov_b32 s48, 64
s_branch Lql_589
Lqe_591:
s_nop 7
v_cvt_pk_bf16_f32 v84, v56, v57
v_cvt_pk_bf16_f32 v85, v58, v59
v_cvt_pk_bf16_f32 v86, v60, v61
v_cvt_pk_bf16_f32 v87, v62, v63
v_cvt_pk_bf16_f32 v90, v68, v69
v_cvt_pk_bf16_f32 v91, v70, v71
buffer_store_dwordx4 v[80:83], v6, s[4:7], s55 offen sc1
buffer_store_dwordx4 v[84:87], v7, s[4:7], s55 offen sc1
buffer_store_dwordx4 v[88:91], v8, s[4:7], s55 offen sc1
v_mov_b32 v5, 64
s_waitcnt vmcnt(0) lgkmcnt(0)
s_barrier
buffer_store_dword v5, v4, s[4:7], 0 offen sc1
s_load_dwordx2 s[16:17], s[0:1], 104
s_and_b32 s52, s44, 3
s_lshr_b32 s53, s44, 2
v_lshrrev_b32 v80, 3, v9
v_and_b32 v81, 7, v9
s_lshr_b32 s38, s52, 1
s_lshl_b32 s38, s38, 10
s_and_b32 s39, s52, 1
s_lshl_b32 s39, s39, 7
s_add_u32 s38, s38, s39
s_lshl_b32 s39, s53, 12
s_add_u32 s38, s38, s39
v_lshl_add_u32 v6, v81, 4, s38
v_and_b32 v82, 3, v80
v_lshl_add_u32 v6, v82, 8, v6
v_lshrrev_b32 v82, 2, v80
v_lshl_add_u32 v6, v82, 11, v6
s_lshl_b32 s38, s52, 14
s_lshl_b32 s39, s53, 7
s_add_u32 s38, s38, s39
v_lshl_add_u32 v7, v81, 11, s38
v_lshl_add_u32 v7, v80, 4, v7
s_lshl_b32 s38, s53, 8
v_lshl_add_u32 v8, v80, 5, s38
v_min_u32 v2, 6, v9
v_lshlrev_b32 v2, 10, v2
s_lshr_b32 s47, s44, 3
s_lshl_b32 s47, s47, 7
s_add_u32 s47, s47, 3416068
s_mov_b32 s60, 0x00003f80
s_mov_b32 s61, 0x3f800000
s_waitcnt lgkmcnt(0)
s_mov_b32 s8, s16
s_and_b32 s9, s17, 0xffff
s_mov_b32 s10, 0x400000
s_mov_b32 s11, 0x20000
v_lshlrev_b32 v80, 7, v9
s_mov_b32 s38, 3424256
Lbw_596:
buffer_load_dword v81, v80, s[4:7], s38 offen sc1
s_waitcnt vmcnt(0)
v_cmp_gt_u32 vcc, 4, v81
s_cbranch_vccz Lbo_597
s_sub_u32 s37, s37, 1
s_cbranch_scc1 Lend_7
s_sleep 2
s_branch Lbw_596
Lbo_597:
s_mov_b32 s38, 3166208
buffer_load_dwordx4 v[16:19], v8, s[4:7], s38 offen offset:0 sc1
buffer_load_dwordx4 v[20:23], v8, s[4:7], s38 offen offset:16 sc1
s_mov_b32 s36, s32
Lfin_598:
s_add_u32 s48, s36, 13
Lbw_599:
buffer_load_dword v3, v2, s[4:7], s47 offen sc1
s_waitcnt vmcnt(0)
v_cmp_gt_u32 vcc, s48, v3
s_cbranch_vccz Lbo_600
s_sub_u32 s37, s37, 1
s_cbranch_scc1 Lend_7
s_sleep 32
s_branch Lbw_599
Lbo_600:
s_lshl_b32 s49, s36, 16
s_add_u32 s39, s49, 134217728
buffer_load_dwordx4 v[64:67], v6, s[4:7], s39 offen sc1
s_add_u32 s39, s49, 138412032
buffer_load_dwordx4 v[68:71], v6, s[4:7], s39 offen sc1
s_add_u32 s39, s49, 142606336
buffer_load_dwordx4 v[72:75], v6, s[4:7], s39 offen sc1
s_add_u32 s39, s49, 146800640
buffer_load_dwordx4 v[76:79], v6, s[4:7], s39 offen sc1
s_add_u32 s39, s49, 150994944
buffer_load_dwordx4 v[80:83], v6, s[4:7], s39 offen sc1
s_add_u32 s39, s49, 155189248
buffer_load_dwordx4 v[84:87], v6, s[4:7], s39 offen sc1
s_add_u32 s39, s49, 159383552
buffer_load_dwordx4 v[88:91], v6, s[4:7], s39 offen sc1
s_add_u32 s39, s49, 12582912
buffer_load_dwordx4 v[92:95], v6, s[4:7], s39 offen sc1
s_add_u32 s39, s49, 134479872
buffer_load_dwordx4 v[96:99], v6, s[4:7], s39 offen sc1
s_add_u32 s39, s49, 138674176
buffer_load_dwordx4 v[100:103], v6, s[4:7], s39 offen sc1
s_add_u32 s39, s49, 142868480
buffer_load_dwordx4 v[104:107], v6, s[4:7], s39 offen sc1
s_add_u32 s39, s49, 147062784
buffer_load_dwordx4 v[108:111], v6, s[4:7], s39 offen sc1
s_add_u32 s39, s49, 151257088
buffer_load_dwordx4 v[112:115], v6, s[4:7], s39 offen sc1
s_add_u32 s39, s49, 155451392
buffer_load_dwordx4 v[116:119], v6, s[4:7], s39 offen sc1
s_add_u32 s39, s49, 159645696
buffer_load_dwordx4 v[120:123], v6, s[4:7], s39 offen sc1
s_add_u32 s39, s49, 12845056
buffer_load_dwordx4 v[124:127], v6, s[4:7], s39 offen sc1
s_add_u32 s39, s49, 134742016
buffer_load_dwordx4 v[128:131], v6, s[4:7], s39 offen sc1
s_add_u32 s39, s49, 138936320
buffer_load_dwordx4 v[132:135], v6, s[4:7], s39 offen sc1
s_add_u32 s39, s49, 143130624
buffer_load_dwordx4 v[136:139], v6, s[4:7], s39 offen sc1
s_add_u32 s39, s49, 147324928
buffer_load_dwordx4 v[140:143], v6, s[4:7], s39 offen sc1
s_add_u32 s39, s49, 151519232
buffer_load_dwordx4 v[144:147], v6, s[4:7], s39 offen sc1
s_add_u32 s39, s49, 155713536
buffer_load_dwordx4 v[148:151], v6, s[4:7], s39 offen sc1
s_add_u32 s39, s49, 159907840
buffer_load_dwordx4 v[152:155], v6, s[4:7], s39 offen sc1
s_add_u32 s39, s49, 13107200
buffer_load_dwordx4 v[156:159], v6, s[4:7], s39 offen sc1
s_add_u32 s39, s49, 135004160
buffer_load_dwordx4 v[160:163], v6, s[4:7], s39 offen sc1
s_add_u32 s39, s49, 139198464
buffer_load_dwordx4 v[164:167], v6, s[4:7], s39 offen sc1
s_add_u32 s39, s49, 143392768
buffer_load_dwordx4 v[168:171], v6, s[4:7], s39 offen sc1
s_add_u32 s39, s49, 147587072
buffer_load_dwordx4 v[172:175], v6, s[4:7], s39 offen sc1
s_add_u32 s39, s49, 151781376
buffer_load_dwordx4 v[176:179], v6, s[4:7], s39 offen sc1
s_add_u32 s39, s49, 155975680
buffer_load_dwordx4 v[180:183], v6, s[4:7], s39 offen sc1
s_add_u32 s39, s49, 160169984
buffer_load_dwordx4 v[184:187], v6, s[4:7], s39 offen sc1
s_add_u32 s39, s49, 13369344
buffer_load_dwordx4 v[188:191], v6, s[4:7], s39 offen sc1
s_waitcnt vmcnt(24)
v_dot2_f32_bf16 v24, v64, s60, 0
v_dot2_f32_bf16 v25, v64, s61, 0
v_dot2_f32_bf16 v26, v65, s60, 0
v_dot2_f32_bf16 v27, v65, s61, 0
v_dot2_f32_bf16 v28, v66, s60, 0
v_dot2_f32_bf16 v29, v66, s61, 0
v_dot2_f32_bf16 v30, v67, s60, 0
v_dot2_f32_bf16 v31, v67, s61, 0
v_dot2_f32_bf16 v24, v68, s60, v24
v_dot2_f32_bf16 v25, v68, s61, v25
v_dot2_f32_bf16 v26, v69, s60, v26
v_dot2_f32_bf16 v27, v69, s61, v27
v_dot2_f32_bf16 v28, v70, s60, v28
v_dot2_f32_bf16 v29, v70, s61, v29
v_dot2_f32_bf16 v30, v71, s60, v30
v_dot2_f32_bf16 v31, v71, s61, v31
v_dot2_f32_bf16 v24, v72, s60, v24
v_dot2_f32_bf16 v25, v72, s61, v25
v_dot2_f32_bf16 v26, v73, s60, v26
v_dot2_f32_bf16 v27, v73, s61, v27
v_dot2_f32_bf16 v28, v74, s60, v28
v_dot2_f32_bf16 v29, v74, s61, v29
v_dot2_f32_bf16 v30, v75, s60, v30
v_dot2_f32_bf16 v31, v75, s61, v31
v_dot2_f32_bf16 v24, v76, s60, v24
v_dot2_f32_bf16 v25, v76, s61, v25
v_dot2_f32_bf16 v26, v77, s60, v26
v_dot2_f32_bf16 v27, v77, s61, v27
v_dot2_f32_bf16 v28, v78, s60, v28
v_dot2_f32_bf16 v29, v78, s61, v29
v_dot2_f32_bf16 v30, v79, s60, v30
v_dot2_f32_bf16 v31, v79, s61, v31
v_dot2_f32_bf16 v24, v80, s60, v24
v_dot2_f32_bf16 v25, v80, s61, v25
v_dot2_f32_bf16 v26, v81, s60, v26
v_dot2_f32_bf16 v27, v81, s61, v27
v_dot2_f32_bf16 v28, v82, s60, v28
v_dot2_f32_bf16 v29, v82, s61, v29
v_dot2_f32_bf16 v30, v83, s60, v30
v_dot2_f32_bf16 v31, v83, s61, v31
v_dot2_f32_bf16 v24, v84, s60, v24
v_dot2_f32_bf16 v25, v84, s61, v25
v_dot2_f32_bf16 v26, v85, s60, v26
v_dot2_f32_bf16 v27, v85, s61, v27
v_dot2_f32_bf16 v28, v86, s60, v28
v_dot2_f32_bf16 v29, v86, s61, v29
v_dot2_f32_bf16 v30, v87, s60, v30
v_dot2_f32_bf16 v31, v87, s61, v31
v_dot2_f32_bf16 v24, v88, s60, v24
v_dot2_f32_bf16 v25, v88, s61, v25
v_dot2_f32_bf16 v26, v89, s60, v26
v_dot2_f32_bf16 v27, v89, s61, v27
v_dot2_f32_bf16 v28, v90, s60, v28
v_dot2_f32_bf16 v29, v90, s61, v29
v_dot2_f32_bf16 v30, v91, s60, v30
v_dot2_f32_bf16 v31, v91, s61, v31
v_lshlrev_b32 v32, 16, v92
v_and_b32 v33, 0xffff0000, v92
v_lshlrev_b32 v34, 16, v93
v_and_b32 v35, 0xffff0000, v93
v_lshlrev_b32 v36, 16, v94
v_and_b32 v37, 0xffff0000, v94
v_lshlrev_b32 v38, 16, v95
v_and_b32 v39, 0xffff0000, v95
v_pk_fma_f32 v[32:33], v[24:25], v[16:17], v[32:33]
v_pk_fma_f32 v[34:35], v[26:27], v[18:19], v[34:35]
v_pk_fma_f32 v[36:37], v[28:29], v[20:21], v[36:37]
v_pk_fma_f32 v[38:39], v[30:31], v[22:23], v[38:39]
v_cvt_pk_bf16_f32 v40, v32, v33
v_cvt_pk_bf16_f32 v41, v34, v35
v_cvt_pk_bf16_f32 v42, v36, v37
v_cvt_pk_bf16_f32 v43, v38, v39
s_add_u32 s39, s49, 0
buffer_store_dwordx4 v[40:43], v7, s[8:11], s39 offen sc1
s_waitcnt vmcnt(17)
v_dot2_f32_bf16 v24, v96, s60, 0
v_dot2_f32_bf16 v25, v96, s61, 0
v_dot2_f32_bf16 v26, v97, s60, 0
v_dot2_f32_bf16 v27, v97, s61, 0
v_dot2_f32_bf16 v28, v98, s60, 0
v_dot2_f32_bf16 v29, v98, s61, 0
v_dot2_f32_bf16 v30, v99, s60, 0
v_dot2_f32_bf16 v31, v99, s61, 0
v_dot2_f32_bf16 v24, v100, s60, v24
v_dot2_f32_bf16 v25, v100, s61, v25
v_dot2_f32_bf16 v26, v101, s60, v26
v_dot2_f32_bf16 v27, v101, s61, v27
v_dot2_f32_bf16 v28, v102, s60, v28
v_dot2_f32_bf16 v29, v102, s61, v29
v_dot2_f32_bf16 v30, v103, s60, v30
v_dot2_f32_bf16 v31, v103, s61, v31
v_dot2_f32_bf16 v24, v104, s60, v24
v_dot2_f32_bf16 v25, v104, s61, v25
v_dot2_f32_bf16 v26, v105, s60, v26
v_dot2_f32_bf16 v27, v105, s61, v27
v_dot2_f32_bf16 v28, v106, s60, v28
v_dot2_f32_bf16 v29, v106, s61, v29
v_dot2_f32_bf16 v30, v107, s60, v30
v_dot2_f32_bf16 v31, v107, s61, v31
v_dot2_f32_bf16 v24, v108, s60, v24
v_dot2_f32_bf16 v25, v108, s61, v25
v_dot2_f32_bf16 v26, v109, s60, v26
v_dot2_f32_bf16 v27, v109, s61, v27
v_dot2_f32_bf16 v28, v110, s60, v28
v_dot2_f32_bf16 v29, v110, s61, v29
v_dot2_f32_bf16 v30, v111, s60, v30
v_dot2_f32_bf16 v31, v111, s61, v31
v_dot2_f32_bf16 v24, v112, s60, v24
v_dot2_f32_bf16 v25, v112, s61, v25
v_dot2_f32_bf16 v26, v113, s60, v26
v_dot2_f32_bf16 v27, v113, s61, v27
v_dot2_f32_bf16 v28, v114, s60, v28
v_dot2_f32_bf16 v29, v114, s61, v29
v_dot2_f32_bf16 v30, v115, s60, v30
v_dot2_f32_bf16 v31, v115, s61, v31
v_dot2_f32_bf16 v24, v116, s60, v24
v_dot2_f32_bf16 v25, v116, s61, v25
v_dot2_f32_bf16 v26, v117, s60, v26
v_dot2_f32_bf16 v27, v117, s61, v27
v_dot2_f32_bf16 v28, v118, s60, v28
v_dot2_f32_bf16 v29, v118, s61, v29
v_dot2_f32_bf16 v30, v119, s60, v30
v_dot2_f32_bf16 v31, v119, s61, v31
v_dot2_f32_bf16 v24, v120, s60, v24
v_dot2_f32_bf16 v25, v120, s61, v25
v_dot2_f32_bf16 v26, v121, s60, v26
v_dot2_f32_bf16 v27, v121, s61, v27
v_dot2_f32_bf16 v28, v122, s60, v28
v_dot2_f32_bf16 v29, v122, s61, v29
v_dot2_f32_bf16 v30, v123, s60, v30
v_dot2_f32_bf16 v31, v123, s61, v31
v_lshlrev_b32 v32, 16, v124
v_and_b32 v33, 0xffff0000, v124
v_lshlrev_b32 v34, 16, v125
v_and_b32 v35, 0xffff0000, v125
v_lshlrev_b32 v36, 16, v126
v_and_b32 v37, 0xffff0000, v126
v_lshlrev_b32 v38, 16, v127
v_and_b32 v39, 0xffff0000, v127
v_pk_fma_f32 v[32:33], v[24:25], v[16:17], v[32:33]
v_pk_fma_f32 v[34:35], v[26:27], v[18:19], v[34:35]
v_pk_fma_f32 v[36:37], v[28:29], v[20:21], v[36:37]
v_pk_fma_f32 v[38:39], v[30:31], v[22:23], v[38:39]
v_cvt_pk_bf16_f32 v44, v32, v33
v_cvt_pk_bf16_f32 v45, v34, v35
v_cvt_pk_bf16_f32 v46, v36, v37
v_cvt_pk_bf16_f32 v47, v38, v39
s_add_u32 s39, s49, 262144
buffer_store_dwordx4 v[44:47], v7, s[8:11], s39 offen sc1
s_waitcnt vmcnt(10)
v_dot2_f32_bf16 v24, v128, s60, 0
v_dot2_f32_bf16 v25, v128, s61, 0
v_dot2_f32_bf16 v26, v129, s60, 0
v_dot2_f32_bf16 v27, v129, s61, 0
v_dot2_f32_bf16 v28, v130, s60, 0
v_dot2_f32_bf16 v29, v130, s61, 0
v_dot2_f32_bf16 v30, v131, s60, 0
v_dot2_f32_bf16 v31, v131, s61, 0
v_dot2_f32_bf16 v24, v132, s60, v24
v_dot2_f32_bf16 v25, v132, s61, v25
v_dot2_f32_bf16 v26, v133, s60, v26
v_dot2_f32_bf16 v27, v133, s61, v27
v_dot2_f32_bf16 v28, v134, s60, v28
v_dot2_f32_bf16 v29, v134, s61, v29
v_dot2_f32_bf16 v30, v135, s60, v30
v_dot2_f32_bf16 v31, v135, s61, v31
v_dot2_f32_bf16 v24, v136, s60, v24
v_dot2_f32_bf16 v25, v136, s61, v25
v_dot2_f32_bf16 v26, v137, s60, v26
v_dot2_f32_bf16 v27, v137, s61, v27
v_dot2_f32_bf16 v28, v138, s60, v28
v_dot2_f32_bf16 v29, v138, s61, v29
v_dot2_f32_bf16 v30, v139, s60, v30
v_dot2_f32_bf16 v31, v139, s61, v31
v_dot2_f32_bf16 v24, v140, s60, v24
v_dot2_f32_bf16 v25, v140, s61, v25
v_dot2_f32_bf16 v26, v141, s60, v26
v_dot2_f32_bf16 v27, v141, s61, v27
v_dot2_f32_bf16 v28, v142, s60, v28
v_dot2_f32_bf16 v29, v142, s61, v29
v_dot2_f32_bf16 v30, v143, s60, v30
v_dot2_f32_bf16 v31, v143, s61, v31
v_dot2_f32_bf16 v24, v144, s60, v24
v_dot2_f32_bf16 v25, v144, s61, v25
v_dot2_f32_bf16 v26, v145, s60, v26
v_dot2_f32_bf16 v27, v145, s61, v27
v_dot2_f32_bf16 v28, v146, s60, v28
v_dot2_f32_bf16 v29, v146, s61, v29
v_dot2_f32_bf16 v30, v147, s60, v30
v_dot2_f32_bf16 v31, v147, s61, v31
v_dot2_f32_bf16 v24, v148, s60, v24
v_dot2_f32_bf16 v25, v148, s61, v25
v_dot2_f32_bf16 v26, v149, s60, v26
v_dot2_f32_bf16 v27, v149, s61, v27
v_dot2_f32_bf16 v28, v150, s60, v28
v_dot2_f32_bf16 v29, v150, s61, v29
v_dot2_f32_bf16 v30, v151, s60, v30
v_dot2_f32_bf16 v31, v151, s61, v31
v_dot2_f32_bf16 v24, v152, s60, v24
v_dot2_f32_bf16 v25, v152, s61, v25
v_dot2_f32_bf16 v26, v153, s60, v26
v_dot2_f32_bf16 v27, v153, s61, v27
v_dot2_f32_bf16 v28, v154, s60, v28
v_dot2_f32_bf16 v29, v154, s61, v29
v_dot2_f32_bf16 v30, v155, s60, v30
v_dot2_f32_bf16 v31, v155, s61, v31
v_lshlrev_b32 v32, 16, v156
v_and_b32 v33, 0xffff0000, v156
v_lshlrev_b32 v34, 16, v157
v_and_b32 v35, 0xffff0000, v157
v_lshlrev_b32 v36, 16, v158
v_and_b32 v37, 0xffff0000, v158
v_lshlrev_b32 v38, 16, v159
v_and_b32 v39, 0xffff0000, v159
v_pk_fma_f32 v[32:33], v[24:25], v[16:17], v[32:33]
v_pk_fma_f32 v[34:35], v[26:27], v[18:19], v[34:35]
v_pk_fma_f32 v[36:37], v[28:29], v[20:21], v[36:37]
v_pk_fma_f32 v[38:39], v[30:31], v[22:23], v[38:39]
v_cvt_pk_bf16_f32 v48, v32, v33
v_cvt_pk_bf16_f32 v49, v34, v35
v_cvt_pk_bf16_f32 v50, v36, v37
v_cvt_pk_bf16_f32 v51, v38, v39
s_add_u32 s39, s49, 524288
buffer_store_dwordx4 v[48:51], v7, s[8:11], s39 offen sc1
s_waitcnt vmcnt(3)
v_dot2_f32_bf16 v24, v160, s60, 0
v_dot2_f32_bf16 v25, v160, s61, 0
v_dot2_f32_bf16 v26, v161, s60, 0
v_dot2_f32_bf16 v27, v161, s61, 0
v_dot2_f32_bf16 v28, v162, s60, 0
v_dot2_f32_bf16 v29, v162, s61, 0
v_dot2_f32_bf16 v30, v163, s60, 0
v_dot2_f32_bf16 v31, v163, s61, 0
v_dot2_f32_bf16 v24, v164, s60, v24
v_dot2_f32_bf16 v25, v164, s61, v25
v_dot2_f32_bf16 v26, v165, s60, v26
v_dot2_f32_bf16 v27, v165, s61, v27
v_dot2_f32_bf16 v28, v166, s60, v28
v_dot2_f32_bf16 v29, v166, s61, v29
v_dot2_f32_bf16 v30, v167, s60, v30
v_dot2_f32_bf16 v31, v167, s61, v31
v_dot2_f32_bf16 v24, v168, s60, v24
v_dot2_f32_bf16 v25, v168, s61, v25
v_dot2_f32_bf16 v26, v169, s60, v26
v_dot2_f32_bf16 v27, v169, s61, v27
v_dot2_f32_bf16 v28, v170, s60, v28
v_dot2_f32_bf16 v29, v170, s61, v29
v_dot2_f32_bf16 v30, v171, s60, v30
v_dot2_f32_bf16 v31, v171, s61, v31
v_dot2_f32_bf16 v24, v172, s60, v24
v_dot2_f32_bf16 v25, v172, s61, v25
v_dot2_f32_bf16 v26, v173, s60, v26
v_dot2_f32_bf16 v27, v173, s61, v27
v_dot2_f32_bf16 v28, v174, s60, v28
v_dot2_f32_bf16 v29, v174, s61, v29
v_dot2_f32_bf16 v30, v175, s60, v30
v_dot2_f32_bf16 v31, v175, s61, v31
v_dot2_f32_bf16 v24, v176, s60, v24
v_dot2_f32_bf16 v25, v176, s61, v25
v_dot2_f32_bf16 v26, v177, s60, v26
v_dot2_f32_bf16 v27, v177, s61, v27
v_dot2_f32_bf16 v28, v178, s60, v28
v_dot2_f32_bf16 v29, v178, s61, v29
v_dot2_f32_bf16 v30, v179, s60, v30
v_dot2_f32_bf16 v31, v179, s61, v31
v_dot2_f32_bf16 v24, v180, s60, v24
v_dot2_f32_bf16 v25, v180, s61, v25
v_dot2_f32_bf16 v26, v181, s60, v26
v_dot2_f32_bf16 v27, v181, s61, v27
v_dot2_f32_bf16 v28, v182, s60, v28
v_dot2_f32_bf16 v29, v182, s61, v29
v_dot2_f32_bf16 v30, v183, s60, v30
v_dot2_f32_bf16 v31, v183, s61, v31
v_dot2_f32_bf16 v24, v184, s60, v24
v_dot2_f32_bf16 v25, v184, s61, v25
v_dot2_f32_bf16 v26, v185, s60, v26
v_dot2_f32_bf16 v27, v185, s61, v27
v_dot2_f32_bf16 v28, v186, s60, v28
v_dot2_f32_bf16 v29, v186, s61, v29
v_dot2_f32_bf16 v30, v187, s60, v30
v_dot2_f32_bf16 v31, v187, s61, v31
v_lshlrev_b32 v32, 16, v188
v_and_b32 v33, 0xffff0000, v188
v_lshlrev_b32 v34, 16, v189
v_and_b32 v35, 0xffff0000, v189
v_lshlrev_b32 v36, 16, v190
v_and_b32 v37, 0xffff0000, v190
v_lshlrev_b32 v38, 16, v191
v_and_b32 v39, 0xffff0000, v191
v_pk_fma_f32 v[32:33], v[24:25], v[16:17], v[32:33]
v_pk_fma_f32 v[34:35], v[26:27], v[18:19], v[34:35]
v_pk_fma_f32 v[36:37], v[28:29], v[20:21], v[36:37]
v_pk_fma_f32 v[38:39], v[30:31], v[22:23], v[38:39]
v_cvt_pk_bf16_f32 v52, v32, v33
v_cvt_pk_bf16_f32 v53, v34, v35
v_cvt_pk_bf16_f32 v54, v36, v37
v_cvt_pk_bf16_f32 v55, v38, v39
s_add_u32 s39, s49, 786432
buffer_store_dwordx4 v[52:55], v7, s[8:11], s39 offen sc1
s_add_u32 s36, s36, 16
s_cmp_lt_u32 s36, 48
s_cbranch_scc1 Lfin_598
Lfin_601:
s_add_u32 s48, s36, 1
Lbw_602:
buffer_load_dword v3, v2, s[4:7], s47 offen sc1
s_waitcnt vmcnt(0)
v_cmp_gt_u32 vcc, s48, v3
s_cbranch_vccz Lbo_603
s_sub_u32 s37, s37, 1
s_cbranch_scc1 Lend_7
s_sleep 4
s_branch Lbw_602
Lbo_603:
s_lshl_b32 s49, s36, 16
s_add_u32 s39, s49, 134217728
buffer_load_dwordx4 v[64:67], v6, s[4:7], s39 offen sc1
s_add_u32 s39, s49, 138412032
buffer_load_dwordx4 v[68:71], v6, s[4:7], s39 offen sc1
s_add_u32 s39, s49, 142606336
buffer_load_dwordx4 v[72:75], v6, s[4:7], s39 offen sc1
s_add_u32 s39, s49, 146800640
buffer_load_dwordx4 v[76:79], v6, s[4:7], s39 offen sc1
s_add_u32 s39, s49, 150994944
buffer_load_dwordx4 v[80:83], v6, s[4:7], s39 offen sc1
s_add_u32 s39, s49, 155189248
buffer_load_dwordx4 v[84:87], v6, s[4:7], s39 offen sc1
s_add_u32 s39, s49, 159383552
buffer_load_dwordx4 v[88:91], v6, s[4:7], s39 offen sc1
s_add_u32 s39, s49, 12582912
buffer_load_dwordx4 v[92:95], v6, s[4:7], s39 offen sc1
s_waitcnt vmcnt(0)
v_dot2_f32_bf16 v24, v64, s60, 0
v_dot2_f32_bf16 v25, v64, s61, 0
v_dot2_f32_bf16 v26, v65, s60, 0
v_dot2_f32_bf16 v27, v65, s61, 0
v_dot2_f32_bf16 v28, v66, s60, 0
v_dot2_f32_bf16 v29, v66, s61, 0
v_dot2_f32_bf16 v30, v67, s60, 0
v_dot2_f32_bf16 v31, v67, s61, 0
v_dot2_f32_bf16 v24, v68, s60, v24
v_dot2_f32_bf16 v25, v68, s61, v25
v_dot2_f32_bf16 v26, v69, s60, v26
v_dot2_f32_bf16 v27, v69, s61, v27
v_dot2_f32_bf16 v28, v70, s60, v28
v_dot2_f32_bf16 v29, v70, s61, v29
v_dot2_f32_bf16 v30, v71, s60, v30
v_dot2_f32_bf16 v31, v71, s61, v31
v_dot2_f32_bf16 v24, v72, s60, v24
v_dot2_f32_bf16 v25, v72, s61, v25
v_dot2_f32_bf16 v26, v73, s60, v26
v_dot2_f32_bf16 v27, v73, s61, v27
v_dot2_f32_bf16 v28, v74, s60, v28
v_dot2_f32_bf16 v29, v74, s61, v29
v_dot2_f32_bf16 v30, v75, s60, v30
v_dot2_f32_bf16 v31, v75, s61, v31
v_dot2_f32_bf16 v24, v76, s60, v24
v_dot2_f32_bf16 v25, v76, s61, v25
v_dot2_f32_bf16 v26, v77, s60, v26
v_dot2_f32_bf16 v27, v77, s61, v27
v_dot2_f32_bf16 v28, v78, s60, v28
v_dot2_f32_bf16 v29, v78, s61, v29
v_dot2_f32_bf16 v30, v79, s60, v30
v_dot2_f32_bf16 v31, v79, s61, v31
v_dot2_f32_bf16 v24, v80, s60, v24
v_dot2_f32_bf16 v25, v80, s61, v25
v_dot2_f32_bf16 v26, v81, s60, v26
v_dot2_f32_bf16 v27, v81, s61, v27
v_dot2_f32_bf16 v28, v82, s60, v28
v_dot2_f32_bf16 v29, v82, s61, v29
v_dot2_f32_bf16 v30, v83, s60, v30
v_dot2_f32_bf16 v31, v83, s61, v31
v_dot2_f32_bf16 v24, v84, s60, v24
v_dot2_f32_bf16 v25, v84, s61, v25
v_dot2_f32_bf16 v26, v85, s60, v26
v_dot2_f32_bf16 v27, v85, s61, v27
v_dot2_f32_bf16 v28, v86, s60, v28
v_dot2_f32_bf16 v29, v86, s61, v29
v_dot2_f32_bf16 v30, v87, s60, v30
v_dot2_f32_bf16 v31, v87, s61, v31
v_dot2_f32_bf16 v24, v88, s60, v24
v_dot2_f32_bf16 v25, v88, s61, v25
v_dot2_f32_bf16 v26, v89, s60, v26
v_dot2_f32_bf16 v27, v89, s61, v27
v_dot2_f32_bf16 v28, v90, s60, v28
v_dot2_f32_bf16 v29, v90, s61, v29
v_dot2_f32_bf16 v30, v91, s60, v30
v_dot2_f32_bf16 v31, v91, s61, v31
v_lshlrev_b32 v32, 16, v92
v_and_b32 v33, 0xffff0000, v92
v_lshlrev_b32 v34, 16, v93
v_and_b32 v35, 0xffff0000, v93
v_lshlrev_b32 v36, 16, v94
v_and_b32 v37, 0xffff0000, v94
v_lshlrev_b32 v38, 16, v95
v_and_b32 v39, 0xffff0000, v95
v_pk_fma_f32 v[32:33], v[24:25], v[16:17], v[32:33]
v_pk_fma_f32 v[34:35], v[26:27], v[18:19], v[34:35]
v_pk_fma_f32 v[36:37], v[28:29], v[20:21], v[36:37]
v_pk_fma_f32 v[38:39], v[30:31], v[22:23], v[38:39]
v_cvt_pk_bf16_f32 v40, v32, v33
v_cvt_pk_bf16_f32 v41, v34, v35
v_cvt_pk_bf16_f32 v42, v36, v37
v_cvt_pk_bf16_f32 v43, v38, v39
s_add_u32 s39, s49, 0
buffer_store_dwordx4 v[40:43], v7, s[8:11], s39 offen sc1
s_add_u32 s36, s36, 4
s_cmp_lt_u32 s36, 64
s_cbranch_scc1 Lfin_601
s_endpgm
Lend_7:
s_endpgm
Lhelper_5:
v_mov_b32 v9, v1
s_sub_u32 s52, s33, 4
s_lshl_b32 s26, s34, 2
s_add_u32 s26, s26, s52
s_sub_u32 s26, s26, 64
s_lshr_b32 s38, s52, 1
s_lshl_b32 s39, s38, 3
s_add_u32 s39, s39, 16
s_lshl_b32 s38, s38, 2
s_cmp_ge_u32 s34, 28
s_cselect_b32 s53, 28, 24
s_add_u32 s38, s38, s53
s_cmp_ge_u32 s34, 24
s_cselect_b32 s38, s38, s39
s_lshl_b32 s39, s52, 3
s_sub_u32 s39, s39, 16
s_bitcmp1_b32 s52, 0
s_cselect_b32 s38, s38, s39
s_add_u32 s44, s38, s34
s_load_dwordx2 s[16:17], s[0:1], 96
s_load_dwordx2 s[18:19], s[0:1], 88
s_load_dwordx2 s[20:21], s[0:1], 0
s_lshl_b32 s38, s26, 7
s_add_u32 s38, s38, 3424256
v_min_u32 v80, 1, v0
v_lshl_add_u32 v10, v80, 30, s38
s_lshl_b32 s38, s44, 7
s_add_u32 s38, s38, 3416064
v_min_u32 v80, 1, v0
v_lshl_add_u32 v8, v80, 30, s38
v_mov_b32 v14, 0
v_mov_b32 v15, 0
buffer_store_dword v14, v10, s[4:7], 0 offen sc1
buffer_store_dwordx2 v[14:15], v8, s[4:7], 0 offen sc1
s_waitcnt lgkmcnt(0)
s_mov_b32 s8, s16
s_and_b32 s9, s17, 0xffff
s_mov_b32 s10, 0xc00000
s_mov_b32 s11, 0x20000
s_mov_b32 s84, s18
s_and_b32 s85, s19, 0xffff
s_mov_b32 s86, 0x800
s_mov_b32 s87, 0x20000
s_mov_b32 s88, s20
s_and_b32 s89, s21, 0xffff
s_mov_b32 s90, 0x400000
s_mov_b32 s91, 0x20000
v_and_b32 v12, 15, v9
v_lshlrev_b32 v12, 4, v12
s_lshl_b32 s38, s32, 2
v_add_u32 v11, s38, v12
v_lshlrev_b32 v13, 4, v9
v_lshrrev_b32 v7, 4, v9
v_lshlrev_b32 v6, 7, v12
v_lshl_add_u32 v6, v7, 4, v6
v_lshlrev_b32 v7, 5, v7
s_lshr_b32 s60, s26, 1
s_and_b32 s61, s26, 1
s_lshl_b32 s62, s60, 8
s_lshl_b32 s38, s61, 13
s_add_u32 s62, s62, s38
s_add_u32 s62, s62, 3178496
s_min_u32 s38, s32, 1
s_lshl_b32 s38, s38, 30
s_add_u32 s38, s38, s62
v_lshlrev_b32 v2, 2, v9
v_mov_b32 v3, -1
buffer_store_dword v3, v2, s[4:7], s38 offen sc1
s_mov_b32 s52, 1
s_waitcnt vmcnt(0)
s_cmp_lg_u32 s32, 0
s_cbranch_scc1 Lar_604
s_mov_b64 exec, 1
v_mov_b32 v14, 160
v_mov_b32 v15, s52
buffer_atomic_add v15, v14, s[12:15], 0 offen sc1
s_mov_b64 exec, -1
Lar_604:
v_lshrrev_b32 v2, 3, v0
v_and_b32 v3, 7, v0
v_mul_u32_u24 v4, 12288, v2
v_lshl_add_u32 v4, v3, 4, v4
v_lshlrev_b32 v5, 1, v2
v_mov_b32 v96, 0
v_mov_b32 v97, 0
v_mov_b32 v98, 0
v_mov_b32 v99, 0
v_mov_b32 v100, 0
v_mov_b32 v101, 0
v_mov_b32 v102, 0
v_mov_b32 v103, 0
s_lshl_b32 s41, s61, 10
s_mul_i32 s40, s61, 6291456
s_lshl_b32 s42, s60, 7
s_add_u32 s40, s40, s42
buffer_load_ushort v80, v5, s[84:87], s41 offen offset:0
buffer_load_ushort v81, v5, s[84:87], s41 offen offset:64
buffer_load_ushort v82, v5, s[84:87], s41 offen offset:128
buffer_load_ushort v83, v5, s[84:87], s41 offen offset:192
buffer_load_ushort v84, v5, s[84:87], s41 offen offset:256
buffer_load_ushort v85, v5, s[84:87], s41 offen offset:320
buffer_load_ushort v86, v5, s[84:87], s41 offen offset:384
buffer_load_ushort v87, v5, s[84:87], s41 offen offset:448
buffer_load_ushort v88, v5, s[84:87], s41 offen offset:512
buffer_load_ushort v89, v5, s[84:87], s41 offen offset:576
buffer_load_ushort v90, v5, s[84:87], s41 offen offset:640
buffer_load_ushort v91, v5, s[84:87], s41 offen offset:704
buffer_load_ushort v92, v5, s[84:87], s41 offen offset:768
buffer_load_ushort v93, v5, s[84:87], s41 offen offset:832
buffer_load_ushort v94, v5, s[84:87], s41 offen offset:896
buffer_load_ushort v95, v5, s[84:87], s41 offen offset:960
buffer_load_dwordx4 v[16:19], v4, s[8:11], s40 offen
s_add_u32 s40, s40, 393216
buffer_load_dwordx4 v[20:23], v4, s[8:11], s40 offen
s_add_u32 s40, s40, 393216
buffer_load_dwordx4 v[24:27], v4, s[8:11], s40 offen
s_add_u32 s40, s40, 393216
buffer_load_dwordx4 v[28:31], v4, s[8:11], s40 offen
s_add_u32 s40, s40, 393216
buffer_load_dwordx4 v[32:35], v4, s[8:11], s40 offen
s_add_u32 s40, s40, 393216
buffer_load_dwordx4 v[36:39], v4, s[8:11], s40 offen
s_add_u32 s40, s40, 393216
buffer_load_dwordx4 v[40:43], v4, s[8:11], s40 offen
s_add_u32 s40, s40, 393216
buffer_load_dwordx4 v[44:47], v4, s[8:11], s40 offen
s_add_u32 s40, s40, 393216
buffer_load_dwordx4 v[48:51], v4, s[8:11], s40 offen
s_add_u32 s40, s40, 393216
buffer_load_dwordx4 v[52:55], v4, s[8:11], s40 offen
s_add_u32 s40, s40, 393216
buffer_load_dwordx4 v[56:59], v4, s[8:11], s40 offen
s_add_u32 s40, s40, 393216
buffer_load_dwordx4 v[60:63], v4, s[8:11], s40 offen
s_add_u32 s40, s40, 393216
buffer_load_dwordx4 v[64:67], v4, s[8:11], s40 offen
s_add_u32 s40, s40, 393216
buffer_load_dwordx4 v[68:71], v4, s[8:11], s40 offen
s_add_u32 s40, s40, 393216
buffer_load_dwordx4 v[72:75], v4, s[8:11], s40 offen
s_add_u32 s40, s40, 393216
buffer_load_dwordx4 v[76:79], v4, s[8:11], s40 offen
s_add_u32 s40, s40, 393216
s_add_u32 s52, s26, 0
s_lshl_b32 s41, s52, 15
s_lshl_b32 s42, s32, 9
s_add_u32 s41, s41, s42
buffer_load_dwordx4 a[0:3], v6, s[88:91], s41 offen offset:0
buffer_load_dwordx4 a[4:7], v6, s[88:91], s41 offen offset:64
buffer_load_dwordx4 a[8:11], v6, s[88:91], s41 offen offset:128
buffer_load_dwordx4 a[12:15], v6, s[88:91], s41 offen offset:192
buffer_load_dwordx4 a[16:19], v6, s[88:91], s41 offen offset:256
buffer_load_dwordx4 a[20:23], v6, s[88:91], s41 offen offset:320
buffer_load_dwordx4 a[24:27], v6, s[88:91], s41 offen offset:384
buffer_load_dwordx4 a[28:31], v6, s[88:91], s41 offen offset:448
s_add_u32 s52, s26, 64
s_lshl_b32 s41, s52, 15
s_lshl_b32 s42, s32, 9
s_add_u32 s41, s41, s42
buffer_load_dwordx4 a[32:35], v6, s[88:91], s41 offen offset:0
buffer_load_dwordx4 a[36:39], v6, s[88:91], s41 offen offset:64
buffer_load_dwordx4 a[40:43], v6, s[88:91], s41 offen offset:128
buffer_load_dwordx4 a[44:47], v6, s[88:91], s41 offen offset:192
buffer_load_dwordx4 a[48:51], v6, s[88:91], s41 offen offset:256
buffer_load_dwordx4 a[52:55], v6, s[88:91], s41 offen offset:320
buffer_load_dwordx4 a[56:59], v6, s[88:91], s41 offen offset:384
buffer_load_dwordx4 a[60:63], v6, s[88:91], s41 offen offset:448
s_waitcnt vmcnt(32)
v_lshlrev_b32 v80, 16, v80
v_mul_f32 v104, 0xbfb8aa3b, v80
v_exp_f32 v104, v104
s_nop 0
v_add_f32 v104, 1.0, v104
v_rcp_f32 v104, v104
s_nop 0
v_mul_f32 v104, v104, v80
v_cvt_pk_bf16_f32 v80, 0, v104
v_lshlrev_b32 v81, 16, v81
v_mul_f32 v104, 0xbfb8aa3b, v81
v_exp_f32 v104, v104
s_nop 0
v_add_f32 v104, 1.0, v104
v_rcp_f32 v104, v104
s_nop 0
v_mul_f32 v104, v104, v81
v_cvt_pk_bf16_f32 v81, 0, v104
v_lshlrev_b32 v82, 16, v82
v_mul_f32 v104, 0xbfb8aa3b, v82
v_exp_f32 v104, v104
s_nop 0
v_add_f32 v104, 1.0, v104
v_rcp_f32 v104, v104
s_nop 0
v_mul_f32 v104, v104, v82
v_cvt_pk_bf16_f32 v82, 0, v104
v_lshlrev_b32 v83, 16, v83
v_mul_f32 v104, 0xbfb8aa3b, v83
v_exp_f32 v104, v104
s_nop 0
v_add_f32 v104, 1.0, v104
v_rcp_f32 v104, v104
s_nop 0
v_mul_f32 v104, v104, v83
v_cvt_pk_bf16_f32 v83, 0, v104
v_lshlrev_b32 v84, 16, v84
v_mul_f32 v104, 0xbfb8aa3b, v84
v_exp_f32 v104, v104
s_nop 0
v_add_f32 v104, 1.0, v104
v_rcp_f32 v104, v104
s_nop 0
v_mul_f32 v104, v104, v84
v_cvt_pk_bf16_f32 v84, 0, v104
v_lshlrev_b32 v85, 16, v85
v_mul_f32 v104, 0xbfb8aa3b, v85
v_exp_f32 v104, v104
s_nop 0
v_add_f32 v104, 1.0, v104
v_rcp_f32 v104, v104
s_nop 0
v_mul_f32 v104, v104, v85
v_cvt_pk_bf16_f32 v85, 0, v104
v_lshlrev_b32 v86, 16, v86
v_mul_f32 v104, 0xbfb8aa3b, v86
v_exp_f32 v104, v104
s_nop 0
v_add_f32 v104, 1.0, v104
v_rcp_f32 v104, v104
s_nop 0
v_mul_f32 v104, v104, v86
v_cvt_pk_bf16_f32 v86, 0, v104
v_lshlrev_b32 v87, 16, v87
v_mul_f32 v104, 0xbfb8aa3b, v87
v_exp_f32 v104, v104
s_nop 0
v_add_f32 v104, 1.0, v104
v_rcp_f32 v104, v104
s_nop 0
v_mul_f32 v104, v104, v87
v_cvt_pk_bf16_f32 v87, 0, v104
v_lshlrev_b32 v88, 16, v88
v_mul_f32 v104, 0xbfb8aa3b, v88
v_exp_f32 v104, v104
s_nop 0
v_add_f32 v104, 1.0, v104
v_rcp_f32 v104, v104
s_nop 0
v_mul_f32 v104, v104, v88
v_cvt_pk_bf16_f32 v88, 0, v104
v_lshlrev_b32 v89, 16, v89
v_mul_f32 v104, 0xbfb8aa3b, v89
v_exp_f32 v104, v104
s_nop 0
v_add_f32 v104, 1.0, v104
v_rcp_f32 v104, v104
s_nop 0
v_mul_f32 v104, v104, v89
v_cvt_pk_bf16_f32 v89, 0, v104
v_lshlrev_b32 v90, 16, v90
v_mul_f32 v104, 0xbfb8aa3b, v90
v_exp_f32 v104, v104
s_nop 0
v_add_f32 v104, 1.0, v104
v_rcp_f32 v104, v104
s_nop 0
v_mul_f32 v104, v104, v90
v_cvt_pk_bf16_f32 v90, 0, v104
v_lshlrev_b32 v91, 16, v91
v_mul_f32 v104, 0xbfb8aa3b, v91
v_exp_f32 v104, v104
s_nop 0
v_add_f32 v104, 1.0, v104
v_rcp_f32 v104, v104
s_nop 0
v_mul_f32 v104, v104, v91
v_cvt_pk_bf16_f32 v91, 0, v104
v_lshlrev_b32 v92, 16, v92
v_mul_f32 v104, 0xbfb8aa3b, v92
v_exp_f32 v104, v104
s_nop 0
v_add_f32 v104, 1.0, v104
v_rcp_f32 v104, v104
s_nop 0
v_mul_f32 v104, v104, v92
v_cvt_pk_bf16_f32 v92, 0, v104
v_lshlrev_b32 v93, 16, v93
v_mul_f32 v104, 0xbfb8aa3b, v93
v_exp_f32 v104, v104
s_nop 0
v_add_f32 v104, 1.0, v104
v_rcp_f32 v104, v104
s_nop 0
v_mul_f32 v104, v104, v93
v_cvt_pk_bf16_f32 v93, 0, v104
v_lshlrev_b32 v94, 16, v94
v_mul_f32 v104, 0xbfb8aa3b, v94
v_exp_f32 v104, v104
s_nop 0
v_add_f32 v104, 1.0, v104
v_rcp_f32 v104, v104
s_nop 0
v_mul_f32 v104, v104, v94
v_cvt_pk_bf16_f32 v94, 0, v104
v_lshlrev_b32 v95, 16, v95
v_mul_f32 v104, 0xbfb8aa3b, v95
v_exp_f32 v104, v104
s_nop 0
v_add_f32 v104, 1.0, v104
v_rcp_f32 v104, v104
s_nop 0
v_mul_f32 v104, v104, v95
v_cvt_pk_bf16_f32 v95, 0, v104
s_waitcnt vmcnt(31)
v_lshlrev_b32 v104, 16, v16
v_and_b32 v105, 0xffff0000, v16
v_fmac_f32 v96, v104, v80
v_fmac_f32 v97, v105, v80
v_lshlrev_b32 v104, 16, v17
v_and_b32 v105, 0xffff0000, v17
v_fmac_f32 v98, v104, v80
v_fmac_f32 v99, v105, v80
v_lshlrev_b32 v104, 16, v18
v_and_b32 v105, 0xffff0000, v18
v_fmac_f32 v100, v104, v80
v_fmac_f32 v101, v105, v80
v_lshlrev_b32 v104, 16, v19
v_and_b32 v105, 0xffff0000, v19
v_fmac_f32 v102, v104, v80
v_fmac_f32 v103, v105, v80
s_waitcnt vmcnt(30)
v_lshlrev_b32 v104, 16, v20
v_and_b32 v105, 0xffff0000, v20
v_fmac_f32 v96, v104, v81
v_fmac_f32 v97, v105, v81
v_lshlrev_b32 v104, 16, v21
v_and_b32 v105, 0xffff0000, v21
v_fmac_f32 v98, v104, v81
v_fmac_f32 v99, v105, v81
v_lshlrev_b32 v104, 16, v22
v_and_b32 v105, 0xffff0000, v22
v_fmac_f32 v100, v104, v81
v_fmac_f32 v101, v105, v81
v_lshlrev_b32 v104, 16, v23
v_and_b32 v105, 0xffff0000, v23
v_fmac_f32 v102, v104, v81
v_fmac_f32 v103, v105, v81
s_waitcnt vmcnt(29)
v_lshlrev_b32 v104, 16, v24
v_and_b32 v105, 0xffff0000, v24
v_fmac_f32 v96, v104, v82
v_fmac_f32 v97, v105, v82
v_lshlrev_b32 v104, 16, v25
v_and_b32 v105, 0xffff0000, v25
v_fmac_f32 v98, v104, v82
v_fmac_f32 v99, v105, v82
v_lshlrev_b32 v104, 16, v26
v_and_b32 v105, 0xffff0000, v26
v_fmac_f32 v100, v104, v82
v_fmac_f32 v101, v105, v82
v_lshlrev_b32 v104, 16, v27
v_and_b32 v105, 0xffff0000, v27
v_fmac_f32 v102, v104, v82
v_fmac_f32 v103, v105, v82
s_waitcnt vmcnt(28)
v_lshlrev_b32 v104, 16, v28
v_and_b32 v105, 0xffff0000, v28
v_fmac_f32 v96, v104, v83
v_fmac_f32 v97, v105, v83
v_lshlrev_b32 v104, 16, v29
v_and_b32 v105, 0xffff0000, v29
v_fmac_f32 v98, v104, v83
v_fmac_f32 v99, v105, v83
v_lshlrev_b32 v104, 16, v30
v_and_b32 v105, 0xffff0000, v30
v_fmac_f32 v100, v104, v83
v_fmac_f32 v101, v105, v83
v_lshlrev_b32 v104, 16, v31
v_and_b32 v105, 0xffff0000, v31
v_fmac_f32 v102, v104, v83
v_fmac_f32 v103, v105, v83
s_waitcnt vmcnt(27)
v_lshlrev_b32 v104, 16, v32
v_and_b32 v105, 0xffff0000, v32
v_fmac_f32 v96, v104, v84
v_fmac_f32 v97, v105, v84
v_lshlrev_b32 v104, 16, v33
v_and_b32 v105, 0xffff0000, v33
v_fmac_f32 v98, v104, v84
v_fmac_f32 v99, v105, v84
v_lshlrev_b32 v104, 16, v34
v_and_b32 v105, 0xffff0000, v34
v_fmac_f32 v100, v104, v84
v_fmac_f32 v101, v105, v84
v_lshlrev_b32 v104, 16, v35
v_and_b32 v105, 0xffff0000, v35
v_fmac_f32 v102, v104, v84
v_fmac_f32 v103, v105, v84
s_waitcnt vmcnt(26)
v_lshlrev_b32 v104, 16, v36
v_and_b32 v105, 0xffff0000, v36
v_fmac_f32 v96, v104, v85
v_fmac_f32 v97, v105, v85
v_lshlrev_b32 v104, 16, v37
v_and_b32 v105, 0xffff0000, v37
v_fmac_f32 v98, v104, v85
v_fmac_f32 v99, v105, v85
v_lshlrev_b32 v104, 16, v38
v_and_b32 v105, 0xffff0000, v38
v_fmac_f32 v100, v104, v85
v_fmac_f32 v101, v105, v85
v_lshlrev_b32 v104, 16, v39
v_and_b32 v105, 0xffff0000, v39
v_fmac_f32 v102, v104, v85
v_fmac_f32 v103, v105, v85
s_waitcnt vmcnt(25)
v_lshlrev_b32 v104, 16, v40
v_and_b32 v105, 0xffff0000, v40
v_fmac_f32 v96, v104, v86
v_fmac_f32 v97, v105, v86
v_lshlrev_b32 v104, 16, v41
v_and_b32 v105, 0xffff0000, v41
v_fmac_f32 v98, v104, v86
v_fmac_f32 v99, v105, v86
v_lshlrev_b32 v104, 16, v42
v_and_b32 v105, 0xffff0000, v42
v_fmac_f32 v100, v104, v86
v_fmac_f32 v101, v105, v86
v_lshlrev_b32 v104, 16, v43
v_and_b32 v105, 0xffff0000, v43
v_fmac_f32 v102, v104, v86
v_fmac_f32 v103, v105, v86
s_waitcnt vmcnt(24)
v_lshlrev_b32 v104, 16, v44
v_and_b32 v105, 0xffff0000, v44
v_fmac_f32 v96, v104, v87
v_fmac_f32 v97, v105, v87
v_lshlrev_b32 v104, 16, v45
v_and_b32 v105, 0xffff0000, v45
v_fmac_f32 v98, v104, v87
v_fmac_f32 v99, v105, v87
v_lshlrev_b32 v104, 16, v46
v_and_b32 v105, 0xffff0000, v46
v_fmac_f32 v100, v104, v87
v_fmac_f32 v101, v105, v87
v_lshlrev_b32 v104, 16, v47
v_and_b32 v105, 0xffff0000, v47
v_fmac_f32 v102, v104, v87
v_fmac_f32 v103, v105, v87
s_waitcnt vmcnt(23)
v_lshlrev_b32 v104, 16, v48
v_and_b32 v105, 0xffff0000, v48
v_fmac_f32 v96, v104, v88
v_fmac_f32 v97, v105, v88
v_lshlrev_b32 v104, 16, v49
v_and_b32 v105, 0xffff0000, v49
v_fmac_f32 v98, v104, v88
v_fmac_f32 v99, v105, v88
v_lshlrev_b32 v104, 16, v50
v_and_b32 v105, 0xffff0000, v50
v_fmac_f32 v100, v104, v88
v_fmac_f32 v101, v105, v88
v_lshlrev_b32 v104, 16, v51
v_and_b32 v105, 0xffff0000, v51
v_fmac_f32 v102, v104, v88
v_fmac_f32 v103, v105, v88
s_waitcnt vmcnt(22)
v_lshlrev_b32 v104, 16, v52
v_and_b32 v105, 0xffff0000, v52
v_fmac_f32 v96, v104, v89
v_fmac_f32 v97, v105, v89
v_lshlrev_b32 v104, 16, v53
v_and_b32 v105, 0xffff0000, v53
v_fmac_f32 v98, v104, v89
v_fmac_f32 v99, v105, v89
v_lshlrev_b32 v104, 16, v54
v_and_b32 v105, 0xffff0000, v54
v_fmac_f32 v100, v104, v89
v_fmac_f32 v101, v105, v89
v_lshlrev_b32 v104, 16, v55
v_and_b32 v105, 0xffff0000, v55
v_fmac_f32 v102, v104, v89
v_fmac_f32 v103, v105, v89
s_waitcnt vmcnt(21)
v_lshlrev_b32 v104, 16, v56
v_and_b32 v105, 0xffff0000, v56
v_fmac_f32 v96, v104, v90
v_fmac_f32 v97, v105, v90
v_lshlrev_b32 v104, 16, v57
v_and_b32 v105, 0xffff0000, v57
v_fmac_f32 v98, v104, v90
v_fmac_f32 v99, v105, v90
v_lshlrev_b32 v104, 16, v58
v_and_b32 v105, 0xffff0000, v58
v_fmac_f32 v100, v104, v90
v_fmac_f32 v101, v105, v90
v_lshlrev_b32 v104, 16, v59
v_and_b32 v105, 0xffff0000, v59
v_fmac_f32 v102, v104, v90
v_fmac_f32 v103, v105, v90
s_waitcnt vmcnt(20)
v_lshlrev_b32 v104, 16, v60
v_and_b32 v105, 0xffff0000, v60
v_fmac_f32 v96, v104, v91
v_fmac_f32 v97, v105, v91
v_lshlrev_b32 v104, 16, v61
v_and_b32 v105, 0xffff0000, v61
v_fmac_f32 v98, v104, v91
v_fmac_f32 v99, v105, v91
v_lshlrev_b32 v104, 16, v62
v_and_b32 v105, 0xffff0000, v62
v_fmac_f32 v100, v104, v91
v_fmac_f32 v101, v105, v91
v_lshlrev_b32 v104, 16, v63
v_and_b32 v105, 0xffff0000, v63
v_fmac_f32 v102, v104, v91
v_fmac_f32 v103, v105, v91
s_waitcnt vmcnt(19)
v_lshlrev_b32 v104, 16, v64
v_and_b32 v105, 0xffff0000, v64
v_fmac_f32 v96, v104, v92
v_fmac_f32 v97, v105, v92
v_lshlrev_b32 v104, 16, v65
v_and_b32 v105, 0xffff0000, v65
v_fmac_f32 v98, v104, v92
v_fmac_f32 v99, v105, v92
v_lshlrev_b32 v104, 16, v66
v_and_b32 v105, 0xffff0000, v66
v_fmac_f32 v100, v104, v92
v_fmac_f32 v101, v105, v92
v_lshlrev_b32 v104, 16, v67
v_and_b32 v105, 0xffff0000, v67
v_fmac_f32 v102, v104, v92
v_fmac_f32 v103, v105, v92
s_waitcnt vmcnt(18)
v_lshlrev_b32 v104, 16, v68
v_and_b32 v105, 0xffff0000, v68
v_fmac_f32 v96, v104, v93
v_fmac_f32 v97, v105, v93
v_lshlrev_b32 v104, 16, v69
v_and_b32 v105, 0xffff0000, v69
v_fmac_f32 v98, v104, v93
v_fmac_f32 v99, v105, v93
v_lshlrev_b32 v104, 16, v70
v_and_b32 v105, 0xffff0000, v70
v_fmac_f32 v100, v104, v93
v_fmac_f32 v101, v105, v93
v_lshlrev_b32 v104, 16, v71
v_and_b32 v105, 0xffff0000, v71
v_fmac_f32 v102, v104, v93
v_fmac_f32 v103, v105, v93
s_waitcnt vmcnt(17)
v_lshlrev_b32 v104, 16, v72
v_and_b32 v105, 0xffff0000, v72
v_fmac_f32 v96, v104, v94
v_fmac_f32 v97, v105, v94
v_lshlrev_b32 v104, 16, v73
v_and_b32 v105, 0xffff0000, v73
v_fmac_f32 v98, v104, v94
v_fmac_f32 v99, v105, v94
v_lshlrev_b32 v104, 16, v74
v_and_b32 v105, 0xffff0000, v74
v_fmac_f32 v100, v104, v94
v_fmac_f32 v101, v105, v94
v_lshlrev_b32 v104, 16, v75
v_and_b32 v105, 0xffff0000, v75
v_fmac_f32 v102, v104, v94
v_fmac_f32 v103, v105, v94
s_waitcnt vmcnt(16)
v_lshlrev_b32 v104, 16, v76
v_and_b32 v105, 0xffff0000, v76
v_fmac_f32 v96, v104, v95
v_fmac_f32 v97, v105, v95
v_lshlrev_b32 v104, 16, v77
v_and_b32 v105, 0xffff0000, v77
v_fmac_f32 v98, v104, v95
v_fmac_f32 v99, v105, v95
v_lshlrev_b32 v104, 16, v78
v_and_b32 v105, 0xffff0000, v78
v_fmac_f32 v100, v104, v95
v_fmac_f32 v101, v105, v95
v_lshlrev_b32 v104, 16, v79
v_and_b32 v105, 0xffff0000, v79
v_fmac_f32 v102, v104, v95
v_fmac_f32 v103, v105, v95
s_nop 1
v_add_f32_dpp v96, v96, v96 row_ror:8 row_mask:0xf bank_mask:0xf
v_add_f32_dpp v97, v97, v97 row_ror:8 row_mask:0xf bank_mask:0xf
v_add_f32_dpp v98, v98, v98 row_ror:8 row_mask:0xf bank_mask:0xf
v_add_f32_dpp v99, v99, v99 row_ror:8 row_mask:0xf bank_mask:0xf
v_add_f32_dpp v100, v100, v100 row_ror:8 row_mask:0xf bank_mask:0xf
v_add_f32_dpp v101, v101, v101 row_ror:8 row_mask:0xf bank_mask:0xf
v_add_f32_dpp v102, v102, v102 row_ror:8 row_mask:0xf bank_mask:0xf
v_add_f32_dpp v103, v103, v103 row_ror:8 row_mask:0xf bank_mask:0xf
v_mov_b32 v16, v96
v_mov_b32 v17, v97
v_mov_b32 v18, v98
v_mov_b32 v19, v99
v_mov_b32 v20, v100
v_mov_b32 v21, v101
v_mov_b32 v22, v102
v_mov_b32 v23, v103
v_permlane16_swap_b32 v96, v16
v_permlane16_swap_b32 v97, v17
v_permlane16_swap_b32 v98, v18
v_permlane16_swap_b32 v99, v19
v_permlane16_swap_b32 v100, v20
v_permlane16_swap_b32 v101, v21
v_permlane16_swap_b32 v102, v22
v_permlane16_swap_b32 v103, v23
v_add_f32 v96, v96, v16
v_add_f32 v97, v97, v17
v_add_f32 v98, v98, v18
v_add_f32 v99, v99, v19
v_add_f32 v100, v100, v20
v_add_f32 v101, v101, v21
v_add_f32 v102, v102, v22
v_add_f32 v103, v103, v23
v_mov_b32 v16, v96
v_mov_b32 v17, v97
v_mov_b32 v18, v98
v_mov_b32 v19, v99
v_mov_b32 v20, v100
v_mov_b32 v21, v101
v_mov_b32 v22, v102
v_mov_b32 v23, v103
v_permlane32_swap_b32 v96, v16
v_permlane32_swap_b32 v97, v17
v_permlane32_swap_b32 v98, v18
v_permlane32_swap_b32 v99, v19
v_permlane32_swap_b32 v100, v20
v_permlane32_swap_b32 v101, v21
v_permlane32_swap_b32 v102, v22
v_permlane32_swap_b32 v103, v23
v_add_f32 v96, v96, v16
v_add_f32 v97, v97, v17
v_add_f32 v98, v98, v18
v_add_f32 v99, v99, v19
v_add_f32 v100, v100, v20
v_add_f32 v101, v101, v21
v_add_f32 v102, v102, v22
v_add_f32 v103, v103, v23
s_lshl_b32 s40, s32, 8
v_lshl_add_u32 v2, v3, 5, s40
ds_write_b128 v2, v[96:99] offset:1024
ds_write_b128 v2, v[100:103] offset:1040
s_waitcnt lgkmcnt(0)
s_barrier
v_and_b32 v2, 63, v0
v_lshlrev_b32 v2, 2, v2
ds_read_b32 v96, v2 offset:1024
ds_read_b32 v97, v2 offset:1280
ds_read_b32 v98, v2 offset:1536
ds_read_b32 v99, v2 offset:1792
s_min_u32 s40, s32, 1
s_lshl_b32 s40, s40, 30
s_add_u32 s40, s40, s62
s_waitcnt lgkmcnt(0)
v_add_f32 v96, v96, v97
v_add_f32 v98, v98, v99
v_add_f32 v96, v96, v98
v_min_u32 v96, -2, v96
buffer_store_dword v96, v2, s[4:7], s40 offen sc1
Lst_605:
buffer_load_dword v14, off, s[12:15], 0 offset:160 sc1
buffer_load_dword v15, off, s[12:15], 0 offset:160 sc1
s_waitcnt vmcnt(0)
v_add_u32 v14, v14, v15
s_nop 0
v_readfirstlane_b32 s38, v14
s_nop 3
s_and_b32 s39, s38, 0xffff
s_cmp_eq_u32 s39, 0x100
s_cbranch_scc1 Lso_606
s_sub_u32 s37, s37, 1
s_cbranch_scc1 Lend_7
s_sleep 8
s_branch Lst_605
Lso_606:
s_bfe_u32 s35, s38, 0x80010
s_bfe_u32 s46, s38, 0x10018
s_lshl_b32 s46, s46, 13
s_barrier
s_add_u32 s52, s26, 0
v_accvgpr_read_b32 v16, a0
v_accvgpr_read_b32 v17, a1
v_accvgpr_read_b32 v18, a2
v_accvgpr_read_b32 v19, a3
v_accvgpr_read_b32 v20, a4
v_accvgpr_read_b32 v21, a5
v_accvgpr_read_b32 v22, a6
v_accvgpr_read_b32 v23, a7
v_accvgpr_read_b32 v24, a8
v_accvgpr_read_b32 v25, a9
v_accvgpr_read_b32 v26, a10
v_accvgpr_read_b32 v27, a11
v_accvgpr_read_b32 v28, a12
v_accvgpr_read_b32 v29, a13
v_accvgpr_read_b32 v30, a14
v_accvgpr_read_b32 v31, a15
v_accvgpr_read_b32 v32, a16
v_accvgpr_read_b32 v33, a17
v_accvgpr_read_b32 v34, a18
v_accvgpr_read_b32 v35, a19
v_accvgpr_read_b32 v36, a20
v_accvgpr_read_b32 v37, a21
v_accvgpr_read_b32 v38, a22
v_accvgpr_read_b32 v39, a23
v_accvgpr_read_b32 v40, a24
v_accvgpr_read_b32 v41, a25
v_accvgpr_read_b32 v42, a26
v_accvgpr_read_b32 v43, a27
v_accvgpr_read_b32 v44, a28
v_accvgpr_read_b32 v45, a29
v_accvgpr_read_b32 v46, a30
v_accvgpr_read_b32 v47, a31
s_lshr_b32 s40, s52, 1
s_lshl_b32 s40, s40, 2
s_add_u32 s40, s40, s32
s_lshl_b32 s40, s40, 14
s_and_b32 s41, s52, 1
s_lshl_b32 s41, s41, 10
s_add_u32 s40, s40, s41
v_lshlrev_b32 v48, 16, v16
v_and_b32 v49, 0xffff0000, v16
v_lshlrev_b32 v50, 16, v17
v_and_b32 v51, 0xffff0000, v17
v_lshlrev_b32 v52, 16, v18
v_and_b32 v53, 0xffff0000, v18
v_lshlrev_b32 v54, 16, v19
v_and_b32 v55, 0xffff0000, v19
v_lshlrev_b32 v56, 16, v20
v_and_b32 v57, 0xffff0000, v20
v_lshlrev_b32 v58, 16, v21
v_and_b32 v59, 0xffff0000, v21
v_lshlrev_b32 v60, 16, v22
v_and_b32 v61, 0xffff0000, v22
v_lshlrev_b32 v62, 16, v23
v_and_b32 v63, 0xffff0000, v23
v_lshlrev_b32 v64, 16, v24
v_and_b32 v65, 0xffff0000, v24
v_lshlrev_b32 v66, 16, v25
v_and_b32 v67, 0xffff0000, v25
v_lshlrev_b32 v68, 16, v26
v_and_b32 v69, 0xffff0000, v26
v_lshlrev_b32 v70, 16, v27
v_and_b32 v71, 0xffff0000, v27
v_lshlrev_b32 v72, 16, v28
v_and_b32 v73, 0xffff0000, v28
v_lshlrev_b32 v74, 16, v29
v_and_b32 v75, 0xffff0000, v29
v_lshlrev_b32 v76, 16, v30
v_and_b32 v77, 0xffff0000, v30
v_lshlrev_b32 v78, 16, v31
v_and_b32 v79, 0xffff0000, v31
v_lshlrev_b32 v80, 16, v32
v_and_b32 v81, 0xffff0000, v32
v_lshlrev_b32 v82, 16, v33
v_and_b32 v83, 0xffff0000, v33
v_lshlrev_b32 v84, 16, v34
v_and_b32 v85, 0xffff0000, v34
v_lshlrev_b32 v86, 16, v35
v_and_b32 v87, 0xffff0000, v35
v_lshlrev_b32 v88, 16, v36
v_and_b32 v89, 0xffff0000, v36
v_lshlrev_b32 v90, 16, v37
v_and_b32 v91, 0xffff0000, v37
v_lshlrev_b32 v92, 16, v38
v_and_b32 v93, 0xffff0000, v38
v_lshlrev_b32 v94, 16, v39
v_and_b32 v95, 0xffff0000, v39
v_lshlrev_b32 v96, 16, v40
v_and_b32 v97, 0xffff0000, v40
v_lshlrev_b32 v98, 16, v41
v_and_b32 v99, 0xffff0000, v41
v_lshlrev_b32 v100, 16, v42
v_and_b32 v101, 0xffff0000, v42
v_lshlrev_b32 v102, 16, v43
v_and_b32 v103, 0xffff0000, v43
v_lshlrev_b32 v104, 16, v44
v_and_b32 v105, 0xffff0000, v44
v_lshlrev_b32 v106, 16, v45
v_and_b32 v107, 0xffff0000, v45
v_lshlrev_b32 v108, 16, v46
v_and_b32 v109, 0xffff0000, v46
v_lshlrev_b32 v110, 16, v47
v_and_b32 v111, 0xffff0000, v47
v_pk_add_f32 v[240:241], v[48:49], v[50:51]
v_pk_add_f32 v[240:241], v[240:241], v[52:53]
v_pk_add_f32 v[240:241], v[240:241], v[54:55]
v_pk_add_f32 v[240:241], v[240:241], v[56:57]
v_pk_add_f32 v[240:241], v[240:241], v[58:59]
v_pk_add_f32 v[240:241], v[240:241], v[60:61]
v_pk_add_f32 v[240:241], v[240:241], v[62:63]
v_pk_add_f32 v[240:241], v[240:241], v[64:65]
v_pk_add_f32 v[240:241], v[240:241], v[66:67]
v_pk_add_f32 v[240:241], v[240:241], v[68:69]
v_pk_add_f32 v[240:241], v[240:241], v[70:71]
v_pk_add_f32 v[240:241], v[240:241], v[72:73]
v_pk_add_f32 v[240:241], v[240:241], v[74:75]
v_pk_add_f32 v[240:241], v[240:241], v[76:77]
v_pk_add_f32 v[240:241], v[240:241], v[78:79]
v_pk_add_f32 v[240:241], v[240:241], v[80:81]
v_pk_add_f32 v[240:241], v[240:241], v[82:83]
v_pk_add_f32 v[240:241], v[240:241], v[84:85]
v_pk_add_f32 v[240:241], v[240:241], v[86:87]
v_pk_add_f32 v[240:241], v[240:241], v[88:89]
v_pk_add_f32 v[240:241], v[240:241], v[90:91]
v_pk_add_f32 v[240:241], v[240:241], v[92:93]
v_pk_add_f32 v[240:241], v[240:241], v[94:95]
v_pk_add_f32 v[240:241], v[240:241], v[96:97]
v_pk_add_f32 v[240:241], v[240:241], v[98:99]
v_pk_add_f32 v[240:241], v[240:241], v[100:101]
v_pk_add_f32 v[240:241], v[240:241], v[102:103]
v_pk_add_f32 v[240:241], v[240:241], v[104:105]
v_pk_add_f32 v[240:241], v[240:241], v[106:107]
v_pk_add_f32 v[240:241], v[240:241], v[108:109]
v_pk_add_f32 v[240:241], v[240:241], v[110:111]
v_add_f32 v240, v240, v241
v_mov_b32 v241, v240
s_nop 1
v_permlane16_swap_b32 v240, v241
s_nop 0
v_add_f32 v240, v240, v241
v_mov_b32 v241, v240
s_nop 1
v_permlane32_swap_b32 v240, v241
s_nop 0
v_add_f32 v240, v240, v241
ds_write_b32 v11, v240 offset:512
s_waitcnt lgkmcnt(0)
s_barrier
ds_read_b128 v[240:243], v12 offset:512
s_waitcnt lgkmcnt(0)
v_pk_add_f32 v[240:241], v[240:241], v[242:243]
v_add_f32 v240, v240, v241
v_mul_f32 v240, 0x3a800000, v240
v_pk_add_f32 v[48:49], v[48:49], v[240:241] op_sel_hi:[1,0] neg_lo:[0,1] neg_hi:[0,1]
v_pk_add_f32 v[50:51], v[50:51], v[240:241] op_sel_hi:[1,0] neg_lo:[0,1] neg_hi:[0,1]
v_pk_add_f32 v[52:53], v[52:53], v[240:241] op_sel_hi:[1,0] neg_lo:[0,1] neg_hi:[0,1]
v_pk_add_f32 v[54:55], v[54:55], v[240:241] op_sel_hi:[1,0] neg_lo:[0,1] neg_hi:[0,1]
v_pk_add_f32 v[56:57], v[56:57], v[240:241] op_sel_hi:[1,0] neg_lo:[0,1] neg_hi:[0,1]
v_pk_add_f32 v[58:59], v[58:59], v[240:241] op_sel_hi:[1,0] neg_lo:[0,1] neg_hi:[0,1]
v_pk_add_f32 v[60:61], v[60:61], v[240:241] op_sel_hi:[1,0] neg_lo:[0,1] neg_hi:[0,1]
v_pk_add_f32 v[62:63], v[62:63], v[240:241] op_sel_hi:[1,0] neg_lo:[0,1] neg_hi:[0,1]
v_pk_add_f32 v[64:65], v[64:65], v[240:241] op_sel_hi:[1,0] neg_lo:[0,1] neg_hi:[0,1]
v_pk_add_f32 v[66:67], v[66:67], v[240:241] op_sel_hi:[1,0] neg_lo:[0,1] neg_hi:[0,1]
v_pk_add_f32 v[68:69], v[68:69], v[240:241] op_sel_hi:[1,0] neg_lo:[0,1] neg_hi:[0,1]
v_pk_add_f32 v[70:71], v[70:71], v[240:241] op_sel_hi:[1,0] neg_lo:[0,1] neg_hi:[0,1]
v_pk_add_f32 v[72:73], v[72:73], v[240:241] op_sel_hi:[1,0] neg_lo:[0,1] neg_hi:[0,1]
v_pk_add_f32 v[74:75], v[74:75], v[240:241] op_sel_hi:[1,0] neg_lo:[0,1] neg_hi:[0,1]
v_pk_add_f32 v[76:77], v[76:77], v[240:241] op_sel_hi:[1,0] neg_lo:[0,1] neg_hi:[0,1]
v_pk_add_f32 v[78:79], v[78:79], v[240:241] op_sel_hi:[1,0] neg_lo:[0,1] neg_hi:[0,1]
v_pk_add_f32 v[80:81], v[80:81], v[240:241] op_sel_hi:[1,0] neg_lo:[0,1] neg_hi:[0,1]
v_pk_add_f32 v[82:83], v[82:83], v[240:241] op_sel_hi:[1,0] neg_lo:[0,1] neg_hi:[0,1]
v_pk_add_f32 v[84:85], v[84:85], v[240:241] op_sel_hi:[1,0] neg_lo:[0,1] neg_hi:[0,1]
v_pk_add_f32 v[86:87], v[86:87], v[240:241] op_sel_hi:[1,0] neg_lo:[0,1] neg_hi:[0,1]
v_pk_add_f32 v[88:89], v[88:89], v[240:241] op_sel_hi:[1,0] neg_lo:[0,1] neg_hi:[0,1]
v_pk_add_f32 v[90:91], v[90:91], v[240:241] op_sel_hi:[1,0] neg_lo:[0,1] neg_hi:[0,1]
v_pk_add_f32 v[92:93], v[92:93], v[240:241] op_sel_hi:[1,0] neg_lo:[0,1] neg_hi:[0,1]
v_pk_add_f32 v[94:95], v[94:95], v[240:241] op_sel_hi:[1,0] neg_lo:[0,1] neg_hi:[0,1]
v_pk_add_f32 v[96:97], v[96:97], v[240:241] op_sel_hi:[1,0] neg_lo:[0,1] neg_hi:[0,1]
v_pk_add_f32 v[98:99], v[98:99], v[240:241] op_sel_hi:[1,0] neg_lo:[0,1] neg_hi:[0,1]
v_pk_add_f32 v[100:101], v[100:101], v[240:241] op_sel_hi:[1,0] neg_lo:[0,1] neg_hi:[0,1]
v_pk_add_f32 v[102:103], v[102:103], v[240:241] op_sel_hi:[1,0] neg_lo:[0,1] neg_hi:[0,1]
v_pk_add_f32 v[104:105], v[104:105], v[240:241] op_sel_hi:[1,0] neg_lo:[0,1] neg_hi:[0,1]
v_pk_add_f32 v[106:107], v[106:107], v[240:241] op_sel_hi:[1,0] neg_lo:[0,1] neg_hi:[0,1]
v_pk_add_f32 v[108:109], v[108:109], v[240:241] op_sel_hi:[1,0] neg_lo:[0,1] neg_hi:[0,1]
v_pk_add_f32 v[110:111], v[110:111], v[240:241] op_sel_hi:[1,0] neg_lo:[0,1] neg_hi:[0,1]
v_pk_mul_f32 v[240:241], v[48:49], v[48:49]
v_pk_fma_f32 v[240:241], v[50:51], v[50:51], v[240:241]
v_pk_fma_f32 v[240:241], v[52:53], v[52:53], v[240:241]
v_pk_fma_f32 v[240:241], v[54:55], v[54:55], v[240:241]
v_pk_fma_f32 v[240:241], v[56:57], v[56:57], v[240:241]
v_pk_fma_f32 v[240:241], v[58:59], v[58:59], v[240:241]
v_pk_fma_f32 v[240:241], v[60:61], v[60:61], v[240:241]
v_pk_fma_f32 v[240:241], v[62:63], v[62:63], v[240:241]
v_pk_fma_f32 v[240:241], v[64:65], v[64:65], v[240:241]
v_pk_fma_f32 v[240:241], v[66:67], v[66:67], v[240:241]
v_pk_fma_f32 v[240:241], v[68:69], v[68:69], v[240:241]
v_pk_fma_f32 v[240:241], v[70:71], v[70:71], v[240:241]
v_pk_fma_f32 v[240:241], v[72:73], v[72:73], v[240:241]
v_pk_fma_f32 v[240:241], v[74:75], v[74:75], v[240:241]
v_pk_fma_f32 v[240:241], v[76:77], v[76:77], v[240:241]
v_pk_fma_f32 v[240:241], v[78:79], v[78:79], v[240:241]
v_pk_fma_f32 v[240:241], v[80:81], v[80:81], v[240:241]
v_pk_fma_f32 v[240:241], v[82:83], v[82:83], v[240:241]
v_pk_fma_f32 v[240:241], v[84:85], v[84:85], v[240:241]
v_pk_fma_f32 v[240:241], v[86:87], v[86:87], v[240:241]
v_pk_fma_f32 v[240:241], v[88:89], v[88:89], v[240:241]
v_pk_fma_f32 v[240:241], v[90:91], v[90:91], v[240:241]
v_pk_fma_f32 v[240:241], v[92:93], v[92:93], v[240:241]
v_pk_fma_f32 v[240:241], v[94:95], v[94:95], v[240:241]
v_pk_fma_f32 v[240:241], v[96:97], v[96:97], v[240:241]
v_pk_fma_f32 v[240:241], v[98:99], v[98:99], v[240:241]
v_pk_fma_f32 v[240:241], v[100:101], v[100:101], v[240:241]
v_pk_fma_f32 v[240:241], v[102:103], v[102:103], v[240:241]
v_pk_fma_f32 v[240:241], v[104:105], v[104:105], v[240:241]
v_pk_fma_f32 v[240:241], v[106:107], v[106:107], v[240:241]
v_pk_fma_f32 v[240:241], v[108:109], v[108:109], v[240:241]
v_pk_fma_f32 v[240:241], v[110:111], v[110:111], v[240:241]
v_add_f32 v240, v240, v241
v_mov_b32 v241, v240
s_nop 1
v_permlane16_swap_b32 v240, v241
s_nop 0
v_add_f32 v240, v240, v241
v_mov_b32 v241, v240
s_nop 1
v_permlane32_swap_b32 v240, v241
s_nop 0
v_add_f32 v240, v240, v241
ds_write_b32 v11, v240 offset:768
s_waitcnt lgkmcnt(0)
s_barrier
ds_read_b128 v[240:243], v12 offset:768
s_waitcnt lgkmcnt(0)
v_pk_add_f32 v[240:241], v[240:241], v[242:243]
v_add_f32 v240, v240, v241
v_mul_f32 v240, 0x3a800000, v240
v_add_f32 v240, 0x3727c5ac, v240
v_rsq_f32 v240, v240
s_nop 0
v_pk_mul_f32 v[48:49], v[48:49], v[240:241] op_sel_hi:[1,0]
v_pk_mul_f32 v[50:51], v[50:51], v[240:241] op_sel_hi:[1,0]
v_pk_mul_f32 v[52:53], v[52:53], v[240:241] op_sel_hi:[1,0]
v_pk_mul_f32 v[54:55], v[54:55], v[240:241] op_sel_hi:[1,0]
v_pk_mul_f32 v[56:57], v[56:57], v[240:241] op_sel_hi:[1,0]
v_pk_mul_f32 v[58:59], v[58:59], v[240:241] op_sel_hi:[1,0]
v_pk_mul_f32 v[60:61], v[60:61], v[240:241] op_sel_hi:[1,0]
v_pk_mul_f32 v[62:63], v[62:63], v[240:241] op_sel_hi:[1,0]
v_pk_mul_f32 v[64:65], v[64:65], v[240:241] op_sel_hi:[1,0]
v_pk_mul_f32 v[66:67], v[66:67], v[240:241] op_sel_hi:[1,0]
v_pk_mul_f32 v[68:69], v[68:69], v[240:241] op_sel_hi:[1,0]
v_pk_mul_f32 v[70:71], v[70:71], v[240:241] op_sel_hi:[1,0]
v_pk_mul_f32 v[72:73], v[72:73], v[240:241] op_sel_hi:[1,0]
v_pk_mul_f32 v[74:75], v[74:75], v[240:241] op_sel_hi:[1,0]
v_pk_mul_f32 v[76:77], v[76:77], v[240:241] op_sel_hi:[1,0]
v_pk_mul_f32 v[78:79], v[78:79], v[240:241] op_sel_hi:[1,0]
v_pk_mul_f32 v[80:81], v[80:81], v[240:241] op_sel_hi:[1,0]
v_pk_mul_f32 v[82:83], v[82:83], v[240:241] op_sel_hi:[1,0]
v_pk_mul_f32 v[84:85], v[84:85], v[240:241] op_sel_hi:[1,0]
v_pk_mul_f32 v[86:87], v[86:87], v[240:241] op_sel_hi:[1,0]
v_pk_mul_f32 v[88:89], v[88:89], v[240:241] op_sel_hi:[1,0]
v_pk_mul_f32 v[90:91], v[90:91], v[240:241] op_sel_hi:[1,0]
v_pk_mul_f32 v[92:93], v[92:93], v[240:241] op_sel_hi:[1,0]
v_pk_mul_f32 v[94:95], v[94:95], v[240:241] op_sel_hi:[1,0]
v_pk_mul_f32 v[96:97], v[96:97], v[240:241] op_sel_hi:[1,0]
v_pk_mul_f32 v[98:99], v[98:99], v[240:241] op_sel_hi:[1,0]
v_pk_mul_f32 v[100:101], v[100:101], v[240:241] op_sel_hi:[1,0]
v_pk_mul_f32 v[102:103], v[102:103], v[240:241] op_sel_hi:[1,0]
v_pk_mul_f32 v[104:105], v[104:105], v[240:241] op_sel_hi:[1,0]
v_pk_mul_f32 v[106:107], v[106:107], v[240:241] op_sel_hi:[1,0]
v_pk_mul_f32 v[108:109], v[108:109], v[240:241] op_sel_hi:[1,0]
v_pk_mul_f32 v[110:111], v[110:111], v[240:241] op_sel_hi:[1,0]
v_lshlrev_b32 v14, 5, v0
Lbw_607:
s_mov_b32 s42, 3178496
buffer_load_dwordx4 v[16:19], v14, s[4:7], s42 offen offset:0 sc1
buffer_load_dwordx4 v[20:23], v14, s[4:7], s42 offen offset:16 sc1
s_mov_b32 s42, 3186688
buffer_load_dwordx4 v[24:27], v14, s[4:7], s42 offen offset:0 sc1
buffer_load_dwordx4 v[28:31], v14, s[4:7], s42 offen offset:16 sc1
s_waitcnt vmcnt(0)
v_max3_u32 v15, v16, v17, v18
v_max3_u32 v15, v15, v19, v20
v_max3_u32 v15, v15, v21, v22
v_max3_u32 v15, v15, v23, v24
v_max3_u32 v15, v15, v25, v26
v_max3_u32 v15, v15, v27, v28
v_max3_u32 v15, v15, v29, v30
v_max_u32 v15, v15, v31
v_cmp_eq_u32 vcc, -1, v15
s_cbranch_vccz Lbo_608
s_sub_u32 s37, s37, 1
s_cbranch_scc1 Lend_7
s_sleep 4
s_branch Lbw_607
Lbo_608:
s_cmp_ge_u32 s32, 2
s_cselect_b32 s42, 1.0, 0
s_lshl_b32 s43, s32, 10
v_add_u32 v7, s43, v7
s_waitcnt vmcnt(0)
v_add_f32 v16, v16, v24
v_add_f32 v17, v17, v25
v_add_f32 v18, v18, v26
v_add_f32 v19, v19, v27
v_add_f32 v20, v20, v28
v_add_f32 v21, v21, v29
v_add_f32 v22, v22, v30
v_add_f32 v23, v23, v31
v_cvt_pk_bf16_f32 v16, 0, v16
v_cvt_pk_bf16_f32 v17, 0, v17
v_cvt_pk_bf16_f32 v18, 0, v18
v_cvt_pk_bf16_f32 v19, 0, v19
v_cvt_pk_bf16_f32 v20, 0, v20
v_cvt_pk_bf16_f32 v21, 0, v21
v_cvt_pk_bf16_f32 v22, 0, v22
v_cvt_pk_bf16_f32 v23, 0, v23
v_add_f32 v16, s42, v16
v_add_f32 v17, s42, v17
v_add_f32 v18, s42, v18
v_add_f32 v19, s42, v19
v_add_f32 v20, s42, v20
v_add_f32 v21, s42, v21
v_add_f32 v22, s42, v22
v_add_f32 v23, s42, v23
ds_write_b128 v14, v[16:19] offset:4096
ds_write_b128 v14, v[20:23] offset:4112
s_waitcnt lgkmcnt(0)
s_barrier
ds_read_b128 v[112:115], v7 offset:4096
ds_read_b128 v[176:179], v7 offset:8192
ds_read_b128 v[116:119], v7 offset:4112
ds_read_b128 v[180:183], v7 offset:8208
ds_read_b128 v[120:123], v7 offset:4224
ds_read_b128 v[184:187], v7 offset:8320
ds_read_b128 v[124:127], v7 offset:4240
ds_read_b128 v[188:191], v7 offset:8336
ds_read_b128 v[128:131], v7 offset:4352
ds_read_b128 v[192:195], v7 offset:8448
ds_read_b128 v[132:135], v7 offset:4368
ds_read_b128 v[196:199], v7 offset:8464
ds_read_b128 v[136:139], v7 offset:4480
ds_read_b128 v[200:203], v7 offset:8576
ds_read_b128 v[140:143], v7 offset:4496
ds_read_b128 v[204:207], v7 offset:8592
ds_read_b128 v[144:147], v7 offset:4608
ds_read_b128 v[208:211], v7 offset:8704
ds_read_b128 v[148:151], v7 offset:4624
ds_read_b128 v[212:215], v7 offset:8720
ds_read_b128 v[152:155], v7 offset:4736
ds_read_b128 v[216:219], v7 offset:8832
ds_read_b128 v[156:159], v7 offset:4752
ds_read_b128 v[220:223], v7 offset:8848
ds_read_b128 v[160:163], v7 offset:4864
ds_read_b128 v[224:227], v7 offset:8960
ds_read_b128 v[164:167], v7 offset:4880
ds_read_b128 v[228:231], v7 offset:8976
ds_read_b128 v[168:171], v7 offset:4992
ds_read_b128 v[232:235], v7 offset:9088
ds_read_b128 v[172:175], v7 offset:5008
ds_read_b128 v[236:239], v7 offset:9104
s_waitcnt lgkmcnt(0)
v_pk_fma_f32 v[48:49], v[48:49], v[176:177], v[112:113]
v_pk_fma_f32 v[50:51], v[50:51], v[178:179], v[114:115]
v_pk_fma_f32 v[52:53], v[52:53], v[180:181], v[116:117]
v_pk_fma_f32 v[54:55], v[54:55], v[182:183], v[118:119]
v_cvt_pk_bf16_f32 v16, v48, v49
v_cvt_pk_bf16_f32 v17, v50, v51
v_cvt_pk_bf16_f32 v18, v52, v53
v_cvt_pk_bf16_f32 v19, v54, v55
s_add_u32 s41, s40, 8388608
buffer_store_dwordx4 v[16:19], v13, s[4:7], s41 offen sc1
v_pk_fma_f32 v[56:57], v[56:57], v[184:185], v[120:121]
v_pk_fma_f32 v[58:59], v[58:59], v[186:187], v[122:123]
v_pk_fma_f32 v[60:61], v[60:61], v[188:189], v[124:125]
v_pk_fma_f32 v[62:63], v[62:63], v[190:191], v[126:127]
v_cvt_pk_bf16_f32 v20, v56, v57
v_cvt_pk_bf16_f32 v21, v58, v59
v_cvt_pk_bf16_f32 v22, v60, v61
v_cvt_pk_bf16_f32 v23, v62, v63
s_add_u32 s41, s40, 8390656
buffer_store_dwordx4 v[20:23], v13, s[4:7], s41 offen sc1
v_pk_fma_f32 v[64:65], v[64:65], v[192:193], v[128:129]
v_pk_fma_f32 v[66:67], v[66:67], v[194:195], v[130:131]
v_pk_fma_f32 v[68:69], v[68:69], v[196:197], v[132:133]
v_pk_fma_f32 v[70:71], v[70:71], v[198:199], v[134:135]
v_cvt_pk_bf16_f32 v24, v64, v65
v_cvt_pk_bf16_f32 v25, v66, v67
v_cvt_pk_bf16_f32 v26, v68, v69
v_cvt_pk_bf16_f32 v27, v70, v71
s_add_u32 s41, s40, 8392704
buffer_store_dwordx4 v[24:27], v13, s[4:7], s41 offen sc1
v_pk_fma_f32 v[72:73], v[72:73], v[200:201], v[136:137]
v_pk_fma_f32 v[74:75], v[74:75], v[202:203], v[138:139]
v_pk_fma_f32 v[76:77], v[76:77], v[204:205], v[140:141]
v_pk_fma_f32 v[78:79], v[78:79], v[206:207], v[142:143]
v_cvt_pk_bf16_f32 v28, v72, v73
v_cvt_pk_bf16_f32 v29, v74, v75
v_cvt_pk_bf16_f32 v30, v76, v77
v_cvt_pk_bf16_f32 v31, v78, v79
s_add_u32 s41, s40, 8394752
buffer_store_dwordx4 v[28:31], v13, s[4:7], s41 offen sc1
v_pk_fma_f32 v[80:81], v[80:81], v[208:209], v[144:145]
v_pk_fma_f32 v[82:83], v[82:83], v[210:211], v[146:147]
v_pk_fma_f32 v[84:85], v[84:85], v[212:213], v[148:149]
v_pk_fma_f32 v[86:87], v[86:87], v[214:215], v[150:151]
v_cvt_pk_bf16_f32 v32, v80, v81
v_cvt_pk_bf16_f32 v33, v82, v83
v_cvt_pk_bf16_f32 v34, v84, v85
v_cvt_pk_bf16_f32 v35, v86, v87
s_add_u32 s41, s40, 8396800
buffer_store_dwordx4 v[32:35], v13, s[4:7], s41 offen sc1
v_pk_fma_f32 v[88:89], v[88:89], v[216:217], v[152:153]
v_pk_fma_f32 v[90:91], v[90:91], v[218:219], v[154:155]
v_pk_fma_f32 v[92:93], v[92:93], v[220:221], v[156:157]
v_pk_fma_f32 v[94:95], v[94:95], v[222:223], v[158:159]
v_cvt_pk_bf16_f32 v36, v88, v89
v_cvt_pk_bf16_f32 v37, v90, v91
v_cvt_pk_bf16_f32 v38, v92, v93
v_cvt_pk_bf16_f32 v39, v94, v95
s_add_u32 s41, s40, 8398848
buffer_store_dwordx4 v[36:39], v13, s[4:7], s41 offen sc1
v_pk_fma_f32 v[96:97], v[96:97], v[224:225], v[160:161]
v_pk_fma_f32 v[98:99], v[98:99], v[226:227], v[162:163]
v_pk_fma_f32 v[100:101], v[100:101], v[228:229], v[164:165]
v_pk_fma_f32 v[102:103], v[102:103], v[230:231], v[166:167]
v_cvt_pk_bf16_f32 v40, v96, v97
v_cvt_pk_bf16_f32 v41, v98, v99
v_cvt_pk_bf16_f32 v42, v100, v101
v_cvt_pk_bf16_f32 v43, v102, v103
s_add_u32 s41, s40, 8400896
buffer_store_dwordx4 v[40:43], v13, s[4:7], s41 offen sc1
v_pk_fma_f32 v[104:105], v[104:105], v[232:233], v[168:169]
v_pk_fma_f32 v[106:107], v[106:107], v[234:235], v[170:171]
v_pk_fma_f32 v[108:109], v[108:109], v[236:237], v[172:173]
v_pk_fma_f32 v[110:111], v[110:111], v[238:239], v[174:175]
v_cvt_pk_bf16_f32 v44, v104, v105
v_cvt_pk_bf16_f32 v45, v106, v107
v_cvt_pk_bf16_f32 v46, v108, v109
v_cvt_pk_bf16_f32 v47, v110, v111
s_add_u32 s41, s40, 8402944
buffer_store_dwordx4 v[44:47], v13, s[4:7], s41 offen sc1
v_mov_b32 v14, 2
s_waitcnt vmcnt(0)
s_barrier
buffer_store_dword v14, v10, s[4:7], 0 offen sc1
s_add_u32 s52, s26, 64
v_accvgpr_read_b32 v16, a32
v_accvgpr_read_b32 v17, a33
v_accvgpr_read_b32 v18, a34
v_accvgpr_read_b32 v19, a35
v_accvgpr_read_b32 v20, a36
v_accvgpr_read_b32 v21, a37
v_accvgpr_read_b32 v22, a38
v_accvgpr_read_b32 v23, a39
v_accvgpr_read_b32 v24, a40
v_accvgpr_read_b32 v25, a41
v_accvgpr_read_b32 v26, a42
v_accvgpr_read_b32 v27, a43
v_accvgpr_read_b32 v28, a44
v_accvgpr_read_b32 v29, a45
v_accvgpr_read_b32 v30, a46
v_accvgpr_read_b32 v31, a47
v_accvgpr_read_b32 v32, a48
v_accvgpr_read_b32 v33, a49
v_accvgpr_read_b32 v34, a50
v_accvgpr_read_b32 v35, a51
v_accvgpr_read_b32 v36, a52
v_accvgpr_read_b32 v37, a53
v_accvgpr_read_b32 v38, a54
v_accvgpr_read_b32 v39, a55
v_accvgpr_read_b32 v40, a56
v_accvgpr_read_b32 v41, a57
v_accvgpr_read_b32 v42, a58
v_accvgpr_read_b32 v43, a59
v_accvgpr_read_b32 v44, a60
v_accvgpr_read_b32 v45, a61
v_accvgpr_read_b32 v46, a62
v_accvgpr_read_b32 v47, a63
s_lshr_b32 s40, s52, 1
s_lshl_b32 s40, s40, 2
s_add_u32 s40, s40, s32
s_lshl_b32 s40, s40, 14
s_and_b32 s41, s52, 1
s_lshl_b32 s41, s41, 10
s_add_u32 s40, s40, s41
v_lshlrev_b32 v48, 16, v16
v_and_b32 v49, 0xffff0000, v16
v_lshlrev_b32 v50, 16, v17
v_and_b32 v51, 0xffff0000, v17
v_lshlrev_b32 v52, 16, v18
v_and_b32 v53, 0xffff0000, v18
v_lshlrev_b32 v54, 16, v19
v_and_b32 v55, 0xffff0000, v19
v_lshlrev_b32 v56, 16, v20
v_and_b32 v57, 0xffff0000, v20
v_lshlrev_b32 v58, 16, v21
v_and_b32 v59, 0xffff0000, v21
v_lshlrev_b32 v60, 16, v22
v_and_b32 v61, 0xffff0000, v22
v_lshlrev_b32 v62, 16, v23
v_and_b32 v63, 0xffff0000, v23
v_lshlrev_b32 v64, 16, v24
v_and_b32 v65, 0xffff0000, v24
v_lshlrev_b32 v66, 16, v25
v_and_b32 v67, 0xffff0000, v25
v_lshlrev_b32 v68, 16, v26
v_and_b32 v69, 0xffff0000, v26
v_lshlrev_b32 v70, 16, v27
v_and_b32 v71, 0xffff0000, v27
v_lshlrev_b32 v72, 16, v28
v_and_b32 v73, 0xffff0000, v28
v_lshlrev_b32 v74, 16, v29
v_and_b32 v75, 0xffff0000, v29
v_lshlrev_b32 v76, 16, v30
v_and_b32 v77, 0xffff0000, v30
v_lshlrev_b32 v78, 16, v31
v_and_b32 v79, 0xffff0000, v31
v_lshlrev_b32 v80, 16, v32
v_and_b32 v81, 0xffff0000, v32
v_lshlrev_b32 v82, 16, v33
v_and_b32 v83, 0xffff0000, v33
v_lshlrev_b32 v84, 16, v34
v_and_b32 v85, 0xffff0000, v34
v_lshlrev_b32 v86, 16, v35
v_and_b32 v87, 0xffff0000, v35
v_lshlrev_b32 v88, 16, v36
v_and_b32 v89, 0xffff0000, v36
v_lshlrev_b32 v90, 16, v37
v_and_b32 v91, 0xffff0000, v37
v_lshlrev_b32 v92, 16, v38
v_and_b32 v93, 0xffff0000, v38
v_lshlrev_b32 v94, 16, v39
v_and_b32 v95, 0xffff0000, v39
v_lshlrev_b32 v96, 16, v40
v_and_b32 v97, 0xffff0000, v40
v_lshlrev_b32 v98, 16, v41
v_and_b32 v99, 0xffff0000, v41
v_lshlrev_b32 v100, 16, v42
v_and_b32 v101, 0xffff0000, v42
v_lshlrev_b32 v102, 16, v43
v_and_b32 v103, 0xffff0000, v43
v_lshlrev_b32 v104, 16, v44
v_and_b32 v105, 0xffff0000, v44
v_lshlrev_b32 v106, 16, v45
v_and_b32 v107, 0xffff0000, v45
v_lshlrev_b32 v108, 16, v46
v_and_b32 v109, 0xffff0000, v46
v_lshlrev_b32 v110, 16, v47
v_and_b32 v111, 0xffff0000, v47
v_pk_add_f32 v[240:241], v[48:49], v[50:51]
v_pk_add_f32 v[240:241], v[240:241], v[52:53]
v_pk_add_f32 v[240:241], v[240:241], v[54:55]
v_pk_add_f32 v[240:241], v[240:241], v[56:57]
v_pk_add_f32 v[240:241], v[240:241], v[58:59]
v_pk_add_f32 v[240:241], v[240:241], v[60:61]
v_pk_add_f32 v[240:241], v[240:241], v[62:63]
v_pk_add_f32 v[240:241], v[240:241], v[64:65]
v_pk_add_f32 v[240:241], v[240:241], v[66:67]
v_pk_add_f32 v[240:241], v[240:241], v[68:69]
v_pk_add_f32 v[240:241], v[240:241], v[70:71]
v_pk_add_f32 v[240:241], v[240:241], v[72:73]
v_pk_add_f32 v[240:241], v[240:241], v[74:75]
v_pk_add_f32 v[240:241], v[240:241], v[76:77]
v_pk_add_f32 v[240:241], v[240:241], v[78:79]
v_pk_add_f32 v[240:241], v[240:241], v[80:81]
v_pk_add_f32 v[240:241], v[240:241], v[82:83]
v_pk_add_f32 v[240:241], v[240:241], v[84:85]
v_pk_add_f32 v[240:241], v[240:241], v[86:87]
v_pk_add_f32 v[240:241], v[240:241], v[88:89]
v_pk_add_f32 v[240:241], v[240:241], v[90:91]
v_pk_add_f32 v[240:241], v[240:241], v[92:93]
v_pk_add_f32 v[240:241], v[240:241], v[94:95]
v_pk_add_f32 v[240:241], v[240:241], v[96:97]
v_pk_add_f32 v[240:241], v[240:241], v[98:99]
v_pk_add_f32 v[240:241], v[240:241], v[100:101]
v_pk_add_f32 v[240:241], v[240:241], v[102:103]
v_pk_add_f32 v[240:241], v[240:241], v[104:105]
v_pk_add_f32 v[240:241], v[240:241], v[106:107]
v_pk_add_f32 v[240:241], v[240:241], v[108:109]
v_pk_add_f32 v[240:241], v[240:241], v[110:111]
v_add_f32 v240, v240, v241
v_mov_b32 v241, v240
s_nop 1
v_permlane16_swap_b32 v240, v241
s_nop 0
v_add_f32 v240, v240, v241
v_mov_b32 v241, v240
s_nop 1
v_permlane32_swap_b32 v240, v241
s_nop 0
v_add_f32 v240, v240, v241
ds_write_b32 v11, v240 offset:512
s_waitcnt lgkmcnt(0)
s_barrier
ds_read_b128 v[240:243], v12 offset:512
s_waitcnt lgkmcnt(0)
v_pk_add_f32 v[240:241], v[240:241], v[242:243]
v_add_f32 v240, v240, v241
v_mul_f32 v240, 0x3a800000, v240
v_pk_add_f32 v[48:49], v[48:49], v[240:241] op_sel_hi:[1,0] neg_lo:[0,1] neg_hi:[0,1]
v_pk_add_f32 v[50:51], v[50:51], v[240:241] op_sel_hi:[1,0] neg_lo:[0,1] neg_hi:[0,1]
v_pk_add_f32 v[52:53], v[52:53], v[240:241] op_sel_hi:[1,0] neg_lo:[0,1] neg_hi:[0,1]
v_pk_add_f32 v[54:55], v[54:55], v[240:241] op_sel_hi:[1,0] neg_lo:[0,1] neg_hi:[0,1]
v_pk_add_f32 v[56:57], v[56:57], v[240:241] op_sel_hi:[1,0] neg_lo:[0,1] neg_hi:[0,1]
v_pk_add_f32 v[58:59], v[58:59], v[240:241] op_sel_hi:[1,0] neg_lo:[0,1] neg_hi:[0,1]
v_pk_add_f32 v[60:61], v[60:61], v[240:241] op_sel_hi:[1,0] neg_lo:[0,1] neg_hi:[0,1]
v_pk_add_f32 v[62:63], v[62:63], v[240:241] op_sel_hi:[1,0] neg_lo:[0,1] neg_hi:[0,1]
v_pk_add_f32 v[64:65], v[64:65], v[240:241] op_sel_hi:[1,0] neg_lo:[0,1] neg_hi:[0,1]
v_pk_add_f32 v[66:67], v[66:67], v[240:241] op_sel_hi:[1,0] neg_lo:[0,1] neg_hi:[0,1]
v_pk_add_f32 v[68:69], v[68:69], v[240:241] op_sel_hi:[1,0] neg_lo:[0,1] neg_hi:[0,1]
v_pk_add_f32 v[70:71], v[70:71], v[240:241] op_sel_hi:[1,0] neg_lo:[0,1] neg_hi:[0,1]
v_pk_add_f32 v[72:73], v[72:73], v[240:241] op_sel_hi:[1,0] neg_lo:[0,1] neg_hi:[0,1]
v_pk_add_f32 v[74:75], v[74:75], v[240:241] op_sel_hi:[1,0] neg_lo:[0,1] neg_hi:[0,1]
v_pk_add_f32 v[76:77], v[76:77], v[240:241] op_sel_hi:[1,0] neg_lo:[0,1] neg_hi:[0,1]
v_pk_add_f32 v[78:79], v[78:79], v[240:241] op_sel_hi:[1,0] neg_lo:[0,1] neg_hi:[0,1]
v_pk_add_f32 v[80:81], v[80:81], v[240:241] op_sel_hi:[1,0] neg_lo:[0,1] neg_hi:[0,1]
v_pk_add_f32 v[82:83], v[82:83], v[240:241] op_sel_hi:[1,0] neg_lo:[0,1] neg_hi:[0,1]
v_pk_add_f32 v[84:85], v[84:85], v[240:241] op_sel_hi:[1,0] neg_lo:[0,1] neg_hi:[0,1]
v_pk_add_f32 v[86:87], v[86:87], v[240:241] op_sel_hi:[1,0] neg_lo:[0,1] neg_hi:[0,1]
v_pk_add_f32 v[88:89], v[88:89], v[240:241] op_sel_hi:[1,0] neg_lo:[0,1] neg_hi:[0,1]
v_pk_add_f32 v[90:91], v[90:91], v[240:241] op_sel_hi:[1,0] neg_lo:[0,1] neg_hi:[0,1]
v_pk_add_f32 v[92:93], v[92:93], v[240:241] op_sel_hi:[1,0] neg_lo:[0,1] neg_hi:[0,1]
v_pk_add_f32 v[94:95], v[94:95], v[240:241] op_sel_hi:[1,0] neg_lo:[0,1] neg_hi:[0,1]
v_pk_add_f32 v[96:97], v[96:97], v[240:241] op_sel_hi:[1,0] neg_lo:[0,1] neg_hi:[0,1]
v_pk_add_f32 v[98:99], v[98:99], v[240:241] op_sel_hi:[1,0] neg_lo:[0,1] neg_hi:[0,1]
v_pk_add_f32 v[100:101], v[100:101], v[240:241] op_sel_hi:[1,0] neg_lo:[0,1] neg_hi:[0,1]
v_pk_add_f32 v[102:103], v[102:103], v[240:241] op_sel_hi:[1,0] neg_lo:[0,1] neg_hi:[0,1]
v_pk_add_f32 v[104:105], v[104:105], v[240:241] op_sel_hi:[1,0] neg_lo:[0,1] neg_hi:[0,1]
v_pk_add_f32 v[106:107], v[106:107], v[240:241] op_sel_hi:[1,0] neg_lo:[0,1] neg_hi:[0,1]
v_pk_add_f32 v[108:109], v[108:109], v[240:241] op_sel_hi:[1,0] neg_lo:[0,1] neg_hi:[0,1]
v_pk_add_f32 v[110:111], v[110:111], v[240:241] op_sel_hi:[1,0] neg_lo:[0,1] neg_hi:[0,1]
v_pk_mul_f32 v[240:241], v[48:49], v[48:49]
v_pk_fma_f32 v[240:241], v[50:51], v[50:51], v[240:241]
v_pk_fma_f32 v[240:241], v[52:53], v[52:53], v[240:241]
v_pk_fma_f32 v[240:241], v[54:55], v[54:55], v[240:241]
v_pk_fma_f32 v[240:241], v[56:57], v[56:57], v[240:241]
v_pk_fma_f32 v[240:241], v[58:59], v[58:59], v[240:241]
v_pk_fma_f32 v[240:241], v[60:61], v[60:61], v[240:241]
v_pk_fma_f32 v[240:241], v[62:63], v[62:63], v[240:241]
v_pk_fma_f32 v[240:241], v[64:65], v[64:65], v[240:241]
v_pk_fma_f32 v[240:241], v[66:67], v[66:67], v[240:241]
v_pk_fma_f32 v[240:241], v[68:69], v[68:69], v[240:241]
v_pk_fma_f32 v[240:241], v[70:71], v[70:71], v[240:241]
v_pk_fma_f32 v[240:241], v[72:73], v[72:73], v[240:241]
v_pk_fma_f32 v[240:241], v[74:75], v[74:75], v[240:241]
v_pk_fma_f32 v[240:241], v[76:77], v[76:77], v[240:241]
v_pk_fma_f32 v[240:241], v[78:79], v[78:79], v[240:241]
v_pk_fma_f32 v[240:241], v[80:81], v[80:81], v[240:241]
v_pk_fma_f32 v[240:241], v[82:83], v[82:83], v[240:241]
v_pk_fma_f32 v[240:241], v[84:85], v[84:85], v[240:241]
v_pk_fma_f32 v[240:241], v[86:87], v[86:87], v[240:241]
v_pk_fma_f32 v[240:241], v[88:89], v[88:89], v[240:241]
v_pk_fma_f32 v[240:241], v[90:91], v[90:91], v[240:241]
v_pk_fma_f32 v[240:241], v[92:93], v[92:93], v[240:241]
v_pk_fma_f32 v[240:241], v[94:95], v[94:95], v[240:241]
v_pk_fma_f32 v[240:241], v[96:97], v[96:97], v[240:241]
v_pk_fma_f32 v[240:241], v[98:99], v[98:99], v[240:241]
v_pk_fma_f32 v[240:241], v[100:101], v[100:101], v[240:241]
v_pk_fma_f32 v[240:241], v[102:103], v[102:103], v[240:241]
v_pk_fma_f32 v[240:241], v[104:105], v[104:105], v[240:241]
v_pk_fma_f32 v[240:241], v[106:107], v[106:107], v[240:241]
v_pk_fma_f32 v[240:241], v[108:109], v[108:109], v[240:241]
v_pk_fma_f32 v[240:241], v[110:111], v[110:111], v[240:241]
v_add_f32 v240, v240, v241
v_mov_b32 v241, v240
s_nop 1
v_permlane16_swap_b32 v240, v241
s_nop 0
v_add_f32 v240, v240, v241
v_mov_b32 v241, v240
s_nop 1
v_permlane32_swap_b32 v240, v241
s_nop 0
v_add_f32 v240, v240, v241
ds_write_b32 v11, v240 offset:768
s_waitcnt lgkmcnt(0)
s_barrier
ds_read_b128 v[240:243], v12 offset:768
s_waitcnt lgkmcnt(0)
v_pk_add_f32 v[240:241], v[240:241], v[242:243]
v_add_f32 v240, v240, v241
v_mul_f32 v240, 0x3a800000, v240
v_add_f32 v240, 0x3727c5ac, v240
v_rsq_f32 v240, v240
s_nop 0
v_pk_mul_f32 v[48:49], v[48:49], v[240:241] op_sel_hi:[1,0]
v_pk_mul_f32 v[50:51], v[50:51], v[240:241] op_sel_hi:[1,0]
v_pk_mul_f32 v[52:53], v[52:53], v[240:241] op_sel_hi:[1,0]
v_pk_mul_f32 v[54:55], v[54:55], v[240:241] op_sel_hi:[1,0]
v_pk_mul_f32 v[56:57], v[56:57], v[240:241] op_sel_hi:[1,0]
v_pk_mul_f32 v[58:59], v[58:59], v[240:241] op_sel_hi:[1,0]
v_pk_mul_f32 v[60:61], v[60:61], v[240:241] op_sel_hi:[1,0]
v_pk_mul_f32 v[62:63], v[62:63], v[240:241] op_sel_hi:[1,0]
v_pk_mul_f32 v[64:65], v[64:65], v[240:241] op_sel_hi:[1,0]
v_pk_mul_f32 v[66:67], v[66:67], v[240:241] op_sel_hi:[1,0]
v_pk_mul_f32 v[68:69], v[68:69], v[240:241] op_sel_hi:[1,0]
v_pk_mul_f32 v[70:71], v[70:71], v[240:241] op_sel_hi:[1,0]
v_pk_mul_f32 v[72:73], v[72:73], v[240:241] op_sel_hi:[1,0]
v_pk_mul_f32 v[74:75], v[74:75], v[240:241] op_sel_hi:[1,0]
v_pk_mul_f32 v[76:77], v[76:77], v[240:241] op_sel_hi:[1,0]
v_pk_mul_f32 v[78:79], v[78:79], v[240:241] op_sel_hi:[1,0]
v_pk_mul_f32 v[80:81], v[80:81], v[240:241] op_sel_hi:[1,0]
v_pk_mul_f32 v[82:83], v[82:83], v[240:241] op_sel_hi:[1,0]
v_pk_mul_f32 v[84:85], v[84:85], v[240:241] op_sel_hi:[1,0]
v_pk_mul_f32 v[86:87], v[86:87], v[240:241] op_sel_hi:[1,0]
v_pk_mul_f32 v[88:89], v[88:89], v[240:241] op_sel_hi:[1,0]
v_pk_mul_f32 v[90:91], v[90:91], v[240:241] op_sel_hi:[1,0]
v_pk_mul_f32 v[92:93], v[92:93], v[240:241] op_sel_hi:[1,0]
v_pk_mul_f32 v[94:95], v[94:95], v[240:241] op_sel_hi:[1,0]
v_pk_mul_f32 v[96:97], v[96:97], v[240:241] op_sel_hi:[1,0]
v_pk_mul_f32 v[98:99], v[98:99], v[240:241] op_sel_hi:[1,0]
v_pk_mul_f32 v[100:101], v[100:101], v[240:241] op_sel_hi:[1,0]
v_pk_mul_f32 v[102:103], v[102:103], v[240:241] op_sel_hi:[1,0]
v_pk_mul_f32 v[104:105], v[104:105], v[240:241] op_sel_hi:[1,0]
v_pk_mul_f32 v[106:107], v[106:107], v[240:241] op_sel_hi:[1,0]
v_pk_mul_f32 v[108:109], v[108:109], v[240:241] op_sel_hi:[1,0]
v_pk_mul_f32 v[110:111], v[110:111], v[240:241] op_sel_hi:[1,0]
v_pk_fma_f32 v[48:49], v[48:49], v[176:177], v[112:113]
v_pk_fma_f32 v[50:51], v[50:51], v[178:179], v[114:115]
v_pk_fma_f32 v[52:53], v[52:53], v[180:181], v[116:117]
v_pk_fma_f32 v[54:55], v[54:55], v[182:183], v[118:119]
v_cvt_pk_bf16_f32 v16, v48, v49
v_cvt_pk_bf16_f32 v17, v50, v51
v_cvt_pk_bf16_f32 v18, v52, v53
v_cvt_pk_bf16_f32 v19, v54, v55
s_add_u32 s41, s40, 8388608
buffer_store_dwordx4 v[16:19], v13, s[4:7], s41 offen sc1
v_pk_fma_f32 v[56:57], v[56:57], v[184:185], v[120:121]
v_pk_fma_f32 v[58:59], v[58:59], v[186:187], v[122:123]
v_pk_fma_f32 v[60:61], v[60:61], v[188:189], v[124:125]
v_pk_fma_f32 v[62:63], v[62:63], v[190:191], v[126:127]
v_cvt_pk_bf16_f32 v20, v56, v57
v_cvt_pk_bf16_f32 v21, v58, v59
v_cvt_pk_bf16_f32 v22, v60, v61
v_cvt_pk_bf16_f32 v23, v62, v63
s_add_u32 s41, s40, 8390656
buffer_store_dwordx4 v[20:23], v13, s[4:7], s41 offen sc1
v_pk_fma_f32 v[64:65], v[64:65], v[192:193], v[128:129]
v_pk_fma_f32 v[66:67], v[66:67], v[194:195], v[130:131]
v_pk_fma_f32 v[68:69], v[68:69], v[196:197], v[132:133]
v_pk_fma_f32 v[70:71], v[70:71], v[198:199], v[134:135]
v_cvt_pk_bf16_f32 v24, v64, v65
v_cvt_pk_bf16_f32 v25, v66, v67
v_cvt_pk_bf16_f32 v26, v68, v69
v_cvt_pk_bf16_f32 v27, v70, v71
s_add_u32 s41, s40, 8392704
buffer_store_dwordx4 v[24:27], v13, s[4:7], s41 offen sc1
v_pk_fma_f32 v[72:73], v[72:73], v[200:201], v[136:137]
v_pk_fma_f32 v[74:75], v[74:75], v[202:203], v[138:139]
v_pk_fma_f32 v[76:77], v[76:77], v[204:205], v[140:141]
v_pk_fma_f32 v[78:79], v[78:79], v[206:207], v[142:143]
v_cvt_pk_bf16_f32 v28, v72, v73
v_cvt_pk_bf16_f32 v29, v74, v75
v_cvt_pk_bf16_f32 v30, v76, v77
v_cvt_pk_bf16_f32 v31, v78, v79
s_add_u32 s41, s40, 8394752
buffer_store_dwordx4 v[28:31], v13, s[4:7], s41 offen sc1
v_pk_fma_f32 v[80:81], v[80:81], v[208:209], v[144:145]
v_pk_fma_f32 v[82:83], v[82:83], v[210:211], v[146:147]
v_pk_fma_f32 v[84:85], v[84:85], v[212:213], v[148:149]
v_pk_fma_f32 v[86:87], v[86:87], v[214:215], v[150:151]
v_cvt_pk_bf16_f32 v32, v80, v81
v_cvt_pk_bf16_f32 v33, v82, v83
v_cvt_pk_bf16_f32 v34, v84, v85
v_cvt_pk_bf16_f32 v35, v86, v87
s_add_u32 s41, s40, 8396800
buffer_store_dwordx4 v[32:35], v13, s[4:7], s41 offen sc1
v_pk_fma_f32 v[88:89], v[88:89], v[216:217], v[152:153]
v_pk_fma_f32 v[90:91], v[90:91], v[218:219], v[154:155]
v_pk_fma_f32 v[92:93], v[92:93], v[220:221], v[156:157]
v_pk_fma_f32 v[94:95], v[94:95], v[222:223], v[158:159]
v_cvt_pk_bf16_f32 v36, v88, v89
v_cvt_pk_bf16_f32 v37, v90, v91
v_cvt_pk_bf16_f32 v38, v92, v93
v_cvt_pk_bf16_f32 v39, v94, v95
s_add_u32 s41, s40, 8398848
buffer_store_dwordx4 v[36:39], v13, s[4:7], s41 offen sc1
v_pk_fma_f32 v[96:97], v[96:97], v[224:225], v[160:161]
v_pk_fma_f32 v[98:99], v[98:99], v[226:227], v[162:163]
v_pk_fma_f32 v[100:101], v[100:101], v[228:229], v[164:165]
v_pk_fma_f32 v[102:103], v[102:103], v[230:231], v[166:167]
v_cvt_pk_bf16_f32 v40, v96, v97
v_cvt_pk_bf16_f32 v41, v98, v99
v_cvt_pk_bf16_f32 v42, v100, v101
v_cvt_pk_bf16_f32 v43, v102, v103
s_add_u32 s41, s40, 8400896
buffer_store_dwordx4 v[40:43], v13, s[4:7], s41 offen sc1
v_pk_fma_f32 v[104:105], v[104:105], v[232:233], v[168:169]
v_pk_fma_f32 v[106:107], v[106:107], v[234:235], v[170:171]
v_pk_fma_f32 v[108:109], v[108:109], v[236:237], v[172:173]
v_pk_fma_f32 v[110:111], v[110:111], v[238:239], v[174:175]
v_cvt_pk_bf16_f32 v44, v104, v105
v_cvt_pk_bf16_f32 v45, v106, v107
v_cvt_pk_bf16_f32 v46, v108, v109
v_cvt_pk_bf16_f32 v47, v110, v111
s_add_u32 s41, s40, 8402944
buffer_store_dwordx4 v[44:47], v13, s[4:7], s41 offen sc1
v_mov_b32 v14, 3
s_waitcnt vmcnt(0)
s_barrier
buffer_store_dword v14, v10, s[4:7], 0 offen sc1
s_add_u32 s60, s26, 32
s_mov_b32 s61, 0
v_lshrrev_b32 v2, 3, v0
v_and_b32 v3, 7, v0
v_mul_u32_u24 v4, 12288, v2
v_lshl_add_u32 v4, v3, 4, v4
v_lshlrev_b32 v5, 1, v2
v_mov_b32 v96, 0
v_mov_b32 v97, 0
v_mov_b32 v98, 0
v_mov_b32 v99, 0
v_mov_b32 v100, 0
v_mov_b32 v101, 0
v_mov_b32 v102, 0
v_mov_b32 v103, 0
Lmd_609:
s_lshl_b32 s41, s61, 10
s_mul_i32 s40, s61, 6291456
s_lshl_b32 s42, s60, 7
s_add_u32 s40, s40, s42
buffer_load_ushort v80, v5, s[84:87], s41 offen offset:0
buffer_load_ushort v81, v5, s[84:87], s41 offen offset:64
buffer_load_ushort v82, v5, s[84:87], s41 offen offset:128
buffer_load_ushort v83, v5, s[84:87], s41 offen offset:192
buffer_load_ushort v84, v5, s[84:87], s41 offen offset:256
buffer_load_ushort v85, v5, s[84:87], s41 offen offset:320
buffer_load_ushort v86, v5, s[84:87], s41 offen offset:384
buffer_load_ushort v87, v5, s[84:87], s41 offen offset:448
buffer_load_ushort v88, v5, s[84:87], s41 offen offset:512
buffer_load_ushort v89, v5, s[84:87], s41 offen offset:576
buffer_load_ushort v90, v5, s[84:87], s41 offen offset:640
buffer_load_ushort v91, v5, s[84:87], s41 offen offset:704
buffer_load_ushort v92, v5, s[84:87], s41 offen offset:768
buffer_load_ushort v93, v5, s[84:87], s41 offen offset:832
buffer_load_ushort v94, v5, s[84:87], s41 offen offset:896
buffer_load_ushort v95, v5, s[84:87], s41 offen offset:960
buffer_load_dwordx4 v[16:19], v4, s[8:11], s40 offen
s_add_u32 s40, s40, 393216
buffer_load_dwordx4 v[20:23], v4, s[8:11], s40 offen
s_add_u32 s40, s40, 393216
buffer_load_dwordx4 v[24:27], v4, s[8:11], s40 offen
s_add_u32 s40, s40, 393216
buffer_load_dwordx4 v[28:31], v4, s[8:11], s40 offen
s_add_u32 s40, s40, 393216
buffer_load_dwordx4 v[32:35], v4, s[8:11], s40 offen
s_add_u32 s40, s40, 393216
buffer_load_dwordx4 v[36:39], v4, s[8:11], s40 offen
s_add_u32 s40, s40, 393216
buffer_load_dwordx4 v[40:43], v4, s[8:11], s40 offen
s_add_u32 s40, s40, 393216
buffer_load_dwordx4 v[44:47], v4, s[8:11], s40 offen
s_add_u32 s40, s40, 393216
buffer_load_dwordx4 v[48:51], v4, s[8:11], s40 offen
s_add_u32 s40, s40, 393216
buffer_load_dwordx4 v[52:55], v4, s[8:11], s40 offen
s_add_u32 s40, s40, 393216
buffer_load_dwordx4 v[56:59], v4, s[8:11], s40 offen
s_add_u32 s40, s40, 393216
buffer_load_dwordx4 v[60:63], v4, s[8:11], s40 offen
s_add_u32 s40, s40, 393216
buffer_load_dwordx4 v[64:67], v4, s[8:11], s40 offen
s_add_u32 s40, s40, 393216
buffer_load_dwordx4 v[68:71], v4, s[8:11], s40 offen
s_add_u32 s40, s40, 393216
buffer_load_dwordx4 v[72:75], v4, s[8:11], s40 offen
s_add_u32 s40, s40, 393216
buffer_load_dwordx4 v[76:79], v4, s[8:11], s40 offen
s_add_u32 s40, s40, 393216
s_waitcnt vmcnt(16)
v_lshlrev_b32 v80, 16, v80
v_mul_f32 v104, 0xbfb8aa3b, v80
v_exp_f32 v104, v104
s_nop 0
v_add_f32 v104, 1.0, v104
v_rcp_f32 v104, v104
s_nop 0
v_mul_f32 v104, v104, v80
v_cvt_pk_bf16_f32 v80, 0, v104
v_lshlrev_b32 v81, 16, v81
v_mul_f32 v104, 0xbfb8aa3b, v81
v_exp_f32 v104, v104
s_nop 0
v_add_f32 v104, 1.0, v104
v_rcp_f32 v104, v104
s_nop 0
v_mul_f32 v104, v104, v81
v_cvt_pk_bf16_f32 v81, 0, v104
v_lshlrev_b32 v82, 16, v82
v_mul_f32 v104, 0xbfb8aa3b, v82
v_exp_f32 v104, v104
s_nop 0
v_add_f32 v104, 1.0, v104
v_rcp_f32 v104, v104
s_nop 0
v_mul_f32 v104, v104, v82
v_cvt_pk_bf16_f32 v82, 0, v104
v_lshlrev_b32 v83, 16, v83
v_mul_f32 v104, 0xbfb8aa3b, v83
v_exp_f32 v104, v104
s_nop 0
v_add_f32 v104, 1.0, v104
v_rcp_f32 v104, v104
s_nop 0
v_mul_f32 v104, v104, v83
v_cvt_pk_bf16_f32 v83, 0, v104
v_lshlrev_b32 v84, 16, v84
v_mul_f32 v104, 0xbfb8aa3b, v84
v_exp_f32 v104, v104
s_nop 0
v_add_f32 v104, 1.0, v104
v_rcp_f32 v104, v104
s_nop 0
v_mul_f32 v104, v104, v84
v_cvt_pk_bf16_f32 v84, 0, v104
v_lshlrev_b32 v85, 16, v85
v_mul_f32 v104, 0xbfb8aa3b, v85
v_exp_f32 v104, v104
s_nop 0
v_add_f32 v104, 1.0, v104
v_rcp_f32 v104, v104
s_nop 0
v_mul_f32 v104, v104, v85
v_cvt_pk_bf16_f32 v85, 0, v104
v_lshlrev_b32 v86, 16, v86
v_mul_f32 v104, 0xbfb8aa3b, v86
v_exp_f32 v104, v104
s_nop 0
v_add_f32 v104, 1.0, v104
v_rcp_f32 v104, v104
s_nop 0
v_mul_f32 v104, v104, v86
v_cvt_pk_bf16_f32 v86, 0, v104
v_lshlrev_b32 v87, 16, v87
v_mul_f32 v104, 0xbfb8aa3b, v87
v_exp_f32 v104, v104
s_nop 0
v_add_f32 v104, 1.0, v104
v_rcp_f32 v104, v104
s_nop 0
v_mul_f32 v104, v104, v87
v_cvt_pk_bf16_f32 v87, 0, v104
v_lshlrev_b32 v88, 16, v88
v_mul_f32 v104, 0xbfb8aa3b, v88
v_exp_f32 v104, v104
s_nop 0
v_add_f32 v104, 1.0, v104
v_rcp_f32 v104, v104
s_nop 0
v_mul_f32 v104, v104, v88
v_cvt_pk_bf16_f32 v88, 0, v104
v_lshlrev_b32 v89, 16, v89
v_mul_f32 v104, 0xbfb8aa3b, v89
v_exp_f32 v104, v104
s_nop 0
v_add_f32 v104, 1.0, v104
v_rcp_f32 v104, v104
s_nop 0
v_mul_f32 v104, v104, v89
v_cvt_pk_bf16_f32 v89, 0, v104
v_lshlrev_b32 v90, 16, v90
v_mul_f32 v104, 0xbfb8aa3b, v90
v_exp_f32 v104, v104
s_nop 0
v_add_f32 v104, 1.0, v104
v_rcp_f32 v104, v104
s_nop 0
v_mul_f32 v104, v104, v90
v_cvt_pk_bf16_f32 v90, 0, v104
v_lshlrev_b32 v91, 16, v91
v_mul_f32 v104, 0xbfb8aa3b, v91
v_exp_f32 v104, v104
s_nop 0
v_add_f32 v104, 1.0, v104
v_rcp_f32 v104, v104
s_nop 0
v_mul_f32 v104, v104, v91
v_cvt_pk_bf16_f32 v91, 0, v104
v_lshlrev_b32 v92, 16, v92
v_mul_f32 v104, 0xbfb8aa3b, v92
v_exp_f32 v104, v104
s_nop 0
v_add_f32 v104, 1.0, v104
v_rcp_f32 v104, v104
s_nop 0
v_mul_f32 v104, v104, v92
v_cvt_pk_bf16_f32 v92, 0, v104
v_lshlrev_b32 v93, 16, v93
v_mul_f32 v104, 0xbfb8aa3b, v93
v_exp_f32 v104, v104
s_nop 0
v_add_f32 v104, 1.0, v104
v_rcp_f32 v104, v104
s_nop 0
v_mul_f32 v104, v104, v93
v_cvt_pk_bf16_f32 v93, 0, v104
v_lshlrev_b32 v94, 16, v94
v_mul_f32 v104, 0xbfb8aa3b, v94
v_exp_f32 v104, v104
s_nop 0
v_add_f32 v104, 1.0, v104
v_rcp_f32 v104, v104
s_nop 0
v_mul_f32 v104, v104, v94
v_cvt_pk_bf16_f32 v94, 0, v104
v_lshlrev_b32 v95, 16, v95
v_mul_f32 v104, 0xbfb8aa3b, v95
v_exp_f32 v104, v104
s_nop 0
v_add_f32 v104, 1.0, v104
v_rcp_f32 v104, v104
s_nop 0
v_mul_f32 v104, v104, v95
v_cvt_pk_bf16_f32 v95, 0, v104
s_waitcnt vmcnt(15)
v_lshlrev_b32 v104, 16, v16
v_and_b32 v105, 0xffff0000, v16
v_fmac_f32 v96, v104, v80
v_fmac_f32 v97, v105, v80
v_lshlrev_b32 v104, 16, v17
v_and_b32 v105, 0xffff0000, v17
v_fmac_f32 v98, v104, v80
v_fmac_f32 v99, v105, v80
v_lshlrev_b32 v104, 16, v18
v_and_b32 v105, 0xffff0000, v18
v_fmac_f32 v100, v104, v80
v_fmac_f32 v101, v105, v80
v_lshlrev_b32 v104, 16, v19
v_and_b32 v105, 0xffff0000, v19
v_fmac_f32 v102, v104, v80
v_fmac_f32 v103, v105, v80
s_waitcnt vmcnt(14)
v_lshlrev_b32 v104, 16, v20
v_and_b32 v105, 0xffff0000, v20
v_fmac_f32 v96, v104, v81
v_fmac_f32 v97, v105, v81
v_lshlrev_b32 v104, 16, v21
v_and_b32 v105, 0xffff0000, v21
v_fmac_f32 v98, v104, v81
v_fmac_f32 v99, v105, v81
v_lshlrev_b32 v104, 16, v22
v_and_b32 v105, 0xffff0000, v22
v_fmac_f32 v100, v104, v81
v_fmac_f32 v101, v105, v81
v_lshlrev_b32 v104, 16, v23
v_and_b32 v105, 0xffff0000, v23
v_fmac_f32 v102, v104, v81
v_fmac_f32 v103, v105, v81
s_waitcnt vmcnt(13)
v_lshlrev_b32 v104, 16, v24
v_and_b32 v105, 0xffff0000, v24
v_fmac_f32 v96, v104, v82
v_fmac_f32 v97, v105, v82
v_lshlrev_b32 v104, 16, v25
v_and_b32 v105, 0xffff0000, v25
v_fmac_f32 v98, v104, v82
v_fmac_f32 v99, v105, v82
v_lshlrev_b32 v104, 16, v26
v_and_b32 v105, 0xffff0000, v26
v_fmac_f32 v100, v104, v82
v_fmac_f32 v101, v105, v82
v_lshlrev_b32 v104, 16, v27
v_and_b32 v105, 0xffff0000, v27
v_fmac_f32 v102, v104, v82
v_fmac_f32 v103, v105, v82
s_waitcnt vmcnt(12)
v_lshlrev_b32 v104, 16, v28
v_and_b32 v105, 0xffff0000, v28
v_fmac_f32 v96, v104, v83
v_fmac_f32 v97, v105, v83
v_lshlrev_b32 v104, 16, v29
v_and_b32 v105, 0xffff0000, v29
v_fmac_f32 v98, v104, v83
v_fmac_f32 v99, v105, v83
v_lshlrev_b32 v104, 16, v30
v_and_b32 v105, 0xffff0000, v30
v_fmac_f32 v100, v104, v83
v_fmac_f32 v101, v105, v83
v_lshlrev_b32 v104, 16, v31
v_and_b32 v105, 0xffff0000, v31
v_fmac_f32 v102, v104, v83
v_fmac_f32 v103, v105, v83
s_waitcnt vmcnt(11)
v_lshlrev_b32 v104, 16, v32
v_and_b32 v105, 0xffff0000, v32
v_fmac_f32 v96, v104, v84
v_fmac_f32 v97, v105, v84
v_lshlrev_b32 v104, 16, v33
v_and_b32 v105, 0xffff0000, v33
v_fmac_f32 v98, v104, v84
v_fmac_f32 v99, v105, v84
v_lshlrev_b32 v104, 16, v34
v_and_b32 v105, 0xffff0000, v34
v_fmac_f32 v100, v104, v84
v_fmac_f32 v101, v105, v84
v_lshlrev_b32 v104, 16, v35
v_and_b32 v105, 0xffff0000, v35
v_fmac_f32 v102, v104, v84
v_fmac_f32 v103, v105, v84
s_waitcnt vmcnt(10)
v_lshlrev_b32 v104, 16, v36
v_and_b32 v105, 0xffff0000, v36
v_fmac_f32 v96, v104, v85
v_fmac_f32 v97, v105, v85
v_lshlrev_b32 v104, 16, v37
v_and_b32 v105, 0xffff0000, v37
v_fmac_f32 v98, v104, v85
v_fmac_f32 v99, v105, v85
v_lshlrev_b32 v104, 16, v38
v_and_b32 v105, 0xffff0000, v38
v_fmac_f32 v100, v104, v85
v_fmac_f32 v101, v105, v85
v_lshlrev_b32 v104, 16, v39
v_and_b32 v105, 0xffff0000, v39
v_fmac_f32 v102, v104, v85
v_fmac_f32 v103, v105, v85
s_waitcnt vmcnt(9)
v_lshlrev_b32 v104, 16, v40
v_and_b32 v105, 0xffff0000, v40
v_fmac_f32 v96, v104, v86
v_fmac_f32 v97, v105, v86
v_lshlrev_b32 v104, 16, v41
v_and_b32 v105, 0xffff0000, v41
v_fmac_f32 v98, v104, v86
v_fmac_f32 v99, v105, v86
v_lshlrev_b32 v104, 16, v42
v_and_b32 v105, 0xffff0000, v42
v_fmac_f32 v100, v104, v86
v_fmac_f32 v101, v105, v86
v_lshlrev_b32 v104, 16, v43
v_and_b32 v105, 0xffff0000, v43
v_fmac_f32 v102, v104, v86
v_fmac_f32 v103, v105, v86
s_waitcnt vmcnt(8)
v_lshlrev_b32 v104, 16, v44
v_and_b32 v105, 0xffff0000, v44
v_fmac_f32 v96, v104, v87
v_fmac_f32 v97, v105, v87
v_lshlrev_b32 v104, 16, v45
v_and_b32 v105, 0xffff0000, v45
v_fmac_f32 v98, v104, v87
v_fmac_f32 v99, v105, v87
v_lshlrev_b32 v104, 16, v46
v_and_b32 v105, 0xffff0000, v46
v_fmac_f32 v100, v104, v87
v_fmac_f32 v101, v105, v87
v_lshlrev_b32 v104, 16, v47
v_and_b32 v105, 0xffff0000, v47
v_fmac_f32 v102, v104, v87
v_fmac_f32 v103, v105, v87
s_waitcnt vmcnt(7)
v_lshlrev_b32 v104, 16, v48
v_and_b32 v105, 0xffff0000, v48
v_fmac_f32 v96, v104, v88
v_fmac_f32 v97, v105, v88
v_lshlrev_b32 v104, 16, v49
v_and_b32 v105, 0xffff0000, v49
v_fmac_f32 v98, v104, v88
v_fmac_f32 v99, v105, v88
v_lshlrev_b32 v104, 16, v50
v_and_b32 v105, 0xffff0000, v50
v_fmac_f32 v100, v104, v88
v_fmac_f32 v101, v105, v88
v_lshlrev_b32 v104, 16, v51
v_and_b32 v105, 0xffff0000, v51
v_fmac_f32 v102, v104, v88
v_fmac_f32 v103, v105, v88
s_waitcnt vmcnt(6)
v_lshlrev_b32 v104, 16, v52
v_and_b32 v105, 0xffff0000, v52
v_fmac_f32 v96, v104, v89
v_fmac_f32 v97, v105, v89
v_lshlrev_b32 v104, 16, v53
v_and_b32 v105, 0xffff0000, v53
v_fmac_f32 v98, v104, v89
v_fmac_f32 v99, v105, v89
v_lshlrev_b32 v104, 16, v54
v_and_b32 v105, 0xffff0000, v54
v_fmac_f32 v100, v104, v89
v_fmac_f32 v101, v105, v89
v_lshlrev_b32 v104, 16, v55
v_and_b32 v105, 0xffff0000, v55
v_fmac_f32 v102, v104, v89
v_fmac_f32 v103, v105, v89
s_waitcnt vmcnt(5)
v_lshlrev_b32 v104, 16, v56
v_and_b32 v105, 0xffff0000, v56
v_fmac_f32 v96, v104, v90
v_fmac_f32 v97, v105, v90
v_lshlrev_b32 v104, 16, v57
v_and_b32 v105, 0xffff0000, v57
v_fmac_f32 v98, v104, v90
v_fmac_f32 v99, v105, v90
v_lshlrev_b32 v104, 16, v58
v_and_b32 v105, 0xffff0000, v58
v_fmac_f32 v100, v104, v90
v_fmac_f32 v101, v105, v90
v_lshlrev_b32 v104, 16, v59
v_and_b32 v105, 0xffff0000, v59
v_fmac_f32 v102, v104, v90
v_fmac_f32 v103, v105, v90
s_waitcnt vmcnt(4)
v_lshlrev_b32 v104, 16, v60
v_and_b32 v105, 0xffff0000, v60
v_fmac_f32 v96, v104, v91
v_fmac_f32 v97, v105, v91
v_lshlrev_b32 v104, 16, v61
v_and_b32 v105, 0xffff0000, v61
v_fmac_f32 v98, v104, v91
v_fmac_f32 v99, v105, v91
v_lshlrev_b32 v104, 16, v62
v_and_b32 v105, 0xffff0000, v62
v_fmac_f32 v100, v104, v91
v_fmac_f32 v101, v105, v91
v_lshlrev_b32 v104, 16, v63
v_and_b32 v105, 0xffff0000, v63
v_fmac_f32 v102, v104, v91
v_fmac_f32 v103, v105, v91
s_waitcnt vmcnt(3)
v_lshlrev_b32 v104, 16, v64
v_and_b32 v105, 0xffff0000, v64
v_fmac_f32 v96, v104, v92
v_fmac_f32 v97, v105, v92
v_lshlrev_b32 v104, 16, v65
v_and_b32 v105, 0xffff0000, v65
v_fmac_f32 v98, v104, v92
v_fmac_f32 v99, v105, v92
v_lshlrev_b32 v104, 16, v66
v_and_b32 v105, 0xffff0000, v66
v_fmac_f32 v100, v104, v92
v_fmac_f32 v101, v105, v92
v_lshlrev_b32 v104, 16, v67
v_and_b32 v105, 0xffff0000, v67
v_fmac_f32 v102, v104, v92
v_fmac_f32 v103, v105, v92
s_waitcnt vmcnt(2)
v_lshlrev_b32 v104, 16, v68
v_and_b32 v105, 0xffff0000, v68
v_fmac_f32 v96, v104, v93
v_fmac_f32 v97, v105, v93
v_lshlrev_b32 v104, 16, v69
v_and_b32 v105, 0xffff0000, v69
v_fmac_f32 v98, v104, v93
v_fmac_f32 v99, v105, v93
v_lshlrev_b32 v104, 16, v70
v_and_b32 v105, 0xffff0000, v70
v_fmac_f32 v100, v104, v93
v_fmac_f32 v101, v105, v93
v_lshlrev_b32 v104, 16, v71
v_and_b32 v105, 0xffff0000, v71
v_fmac_f32 v102, v104, v93
v_fmac_f32 v103, v105, v93
s_waitcnt vmcnt(1)
v_lshlrev_b32 v104, 16, v72
v_and_b32 v105, 0xffff0000, v72
v_fmac_f32 v96, v104, v94
v_fmac_f32 v97, v105, v94
v_lshlrev_b32 v104, 16, v73
v_and_b32 v105, 0xffff0000, v73
v_fmac_f32 v98, v104, v94
v_fmac_f32 v99, v105, v94
v_lshlrev_b32 v104, 16, v74
v_and_b32 v105, 0xffff0000, v74
v_fmac_f32 v100, v104, v94
v_fmac_f32 v101, v105, v94
v_lshlrev_b32 v104, 16, v75
v_and_b32 v105, 0xffff0000, v75
v_fmac_f32 v102, v104, v94
v_fmac_f32 v103, v105, v94
s_waitcnt vmcnt(0)
v_lshlrev_b32 v104, 16, v76
v_and_b32 v105, 0xffff0000, v76
v_fmac_f32 v96, v104, v95
v_fmac_f32 v97, v105, v95
v_lshlrev_b32 v104, 16, v77
v_and_b32 v105, 0xffff0000, v77
v_fmac_f32 v98, v104, v95
v_fmac_f32 v99, v105, v95
v_lshlrev_b32 v104, 16, v78
v_and_b32 v105, 0xffff0000, v78
v_fmac_f32 v100, v104, v95
v_fmac_f32 v101, v105, v95
v_lshlrev_b32 v104, 16, v79
v_and_b32 v105, 0xffff0000, v79
v_fmac_f32 v102, v104, v95
v_fmac_f32 v103, v105, v95
s_add_u32 s61, s61, 1
s_cmp_lt_u32 s61, 2
s_cbranch_scc1 Lmd_609
s_lshl_b32 s60, s60, 8
s_add_u32 s60, s60, 3145728
s_nop 1
v_add_f32_dpp v96, v96, v96 row_ror:8 row_mask:0xf bank_mask:0xf
v_add_f32_dpp v97, v97, v97 row_ror:8 row_mask:0xf bank_mask:0xf
v_add_f32_dpp v98, v98, v98 row_ror:8 row_mask:0xf bank_mask:0xf
v_add_f32_dpp v99, v99, v99 row_ror:8 row_mask:0xf bank_mask:0xf
v_add_f32_dpp v100, v100, v100 row_ror:8 row_mask:0xf bank_mask:0xf
v_add_f32_dpp v101, v101, v101 row_ror:8 row_mask:0xf bank_mask:0xf
v_add_f32_dpp v102, v102, v102 row_ror:8 row_mask:0xf bank_mask:0xf
v_add_f32_dpp v103, v103, v103 row_ror:8 row_mask:0xf bank_mask:0xf
v_mov_b32 v16, v96
v_mov_b32 v17, v97
v_mov_b32 v18, v98
v_mov_b32 v19, v99
v_mov_b32 v20, v100
v_mov_b32 v21, v101
v_mov_b32 v22, v102
v_mov_b32 v23, v103
v_permlane16_swap_b32 v96, v16
v_permlane16_swap_b32 v97, v17
v_permlane16_swap_b32 v98, v18
v_permlane16_swap_b32 v99, v19
v_permlane16_swap_b32 v100, v20
v_permlane16_swap_b32 v101, v21
v_permlane16_swap_b32 v102, v22
v_permlane16_swap_b32 v103, v23
v_add_f32 v96, v96, v16
v_add_f32 v97, v97, v17
v_add_f32 v98, v98, v18
v_add_f32 v99, v99, v19
v_add_f32 v100, v100, v20
v_add_f32 v101, v101, v21
v_add_f32 v102, v102, v22
v_add_f32 v103, v103, v23
v_mov_b32 v16, v96
v_mov_b32 v17, v97
v_mov_b32 v18, v98
v_mov_b32 v19, v99
v_mov_b32 v20, v100
v_mov_b32 v21, v101
v_mov_b32 v22, v102
v_mov_b32 v23, v103
v_permlane32_swap_b32 v96, v16
v_permlane32_swap_b32 v97, v17
v_permlane32_swap_b32 v98, v18
v_permlane32_swap_b32 v99, v19
v_permlane32_swap_b32 v100, v20
v_permlane32_swap_b32 v101, v21
v_permlane32_swap_b32 v102, v22
v_permlane32_swap_b32 v103, v23
v_add_f32 v96, v96, v16
v_add_f32 v97, v97, v17
v_add_f32 v98, v98, v18
v_add_f32 v99, v99, v19
v_add_f32 v100, v100, v20
v_add_f32 v101, v101, v21
v_add_f32 v102, v102, v22
v_add_f32 v103, v103, v23
s_lshl_b32 s40, s32, 8
v_lshl_add_u32 v2, v3, 5, s40
ds_write_b128 v2, v[96:99] offset:1024
ds_write_b128 v2, v[100:103] offset:1040
s_waitcnt lgkmcnt(0)
s_barrier
v_and_b32 v2, 63, v0
v_lshlrev_b32 v2, 2, v2
ds_read_b32 v96, v2 offset:1024
ds_read_b32 v97, v2 offset:1280
ds_read_b32 v98, v2 offset:1536
ds_read_b32 v99, v2 offset:1792
s_min_u32 s40, s32, 1
s_lshl_b32 s40, s40, 30
s_add_u32 s40, s40, s60
s_waitcnt lgkmcnt(0)
v_add_f32 v96, v96, v97
v_add_f32 v98, v98, v99
v_add_f32 v96, v96, v98
v_cvt_pk_bf16_f32 v96, 0, v96
buffer_store_dword v96, v2, s[4:7], s40 offen sc1
v_mov_b32 v14, 4
s_waitcnt vmcnt(0)
buffer_store_dword v14, v10, s[4:7], 0 offen sc1
v_mov_b32 v4, v8
v_mov_b32 v5, 0
s_cmp_ge_u32 s44, 56
s_cbranch_scc1 Lln_6
s_load_dwordx2 s[16:17], s[0:1], 64
s_load_dwordx2 s[18:19], s[0:1], 72
s_load_dwordx2 s[20:21], s[0:1], 80
s_waitcnt lgkmcnt(0)
s_mov_b32 s8, s16
s_and_b32 s9, s17, 0xffff
s_mov_b32 s10, 0x700000
s_mov_b32 s11, 0x20000
s_mov_b32 s84, s18
s_and_b32 s85, s19, 0xffff
s_mov_b32 s86, 0x700000
s_mov_b32 s87, 0x20000
s_mov_b32 s88, s20
s_and_b32 s89, s21, 0xffff
s_mov_b32 s90, 0x700000
s_mov_b32 s91, 0x20000
s_lshl_b32 s60, s44, 7
s_lshl_b32 s52, s32, 5
v_bfe_u32 v84, v9, 2, 2
v_lshrrev_b32 v85, 4, v9
v_lshl_add_u32 v84, v85, 3, v84
v_lshl_add_u32 v84, v84, 7, s52
v_and_b32 v85, 3, v9
v_lshl_add_u32 v84, v85, 3, v84
v_add_u32 v80, 0, v84
v_bfe_u32 v84, v9, 2, 2
v_lshrrev_b32 v85, 4, v9
v_lshl_add_u32 v84, v85, 3, v84
v_lshl_add_u32 v84, v84, 7, s52
v_and_b32 v85, 3, v9
v_lshl_add_u32 v84, v85, 3, v84
v_add_u32 v81, 16384, v84
v_lshrrev_b32 v84, 3, v9
s_mul_i32 s38, s32, 256
v_add_u32 v84, s38, v84
v_mul_u32_u24 v84, 7168, v84
v_and_b32 v85, 7, v9
v_lshl_add_u32 v84, v85, 4, v84
s_lshl_b32 s38, s32, 12
s_barrier
s_add_u32 m0, s38, 0
s_add_u32 s39, s60, 0
buffer_load_dwordx4 v84, s[8:11], s39 offen lds
s_add_u32 m0, s38, 1024
s_add_u32 s39, s60, 57344
buffer_load_dwordx4 v84, s[8:11], s39 offen lds
s_add_u32 m0, s38, 2048
s_add_u32 s39, s60, 114688
buffer_load_dwordx4 v84, s[8:11], s39 offen lds
s_add_u32 m0, s38, 3072
s_add_u32 s39, s60, 172032
buffer_load_dwordx4 v84, s[8:11], s39 offen lds
s_add_u32 m0, s38, 16384
s_add_u32 s39, s60, 0
buffer_load_dwordx4 v84, s[84:87], s39 offen lds
s_add_u32 m0, s38, 17408
s_add_u32 s39, s60, 57344
buffer_load_dwordx4 v84, s[84:87], s39 offen lds
s_add_u32 m0, s38, 18432
s_add_u32 s39, s60, 114688
buffer_load_dwordx4 v84, s[84:87], s39 offen lds
s_add_u32 m0, s38, 19456
s_add_u32 s39, s60, 172032
buffer_load_dwordx4 v84, s[84:87], s39 offen lds
s_add_u32 m0, s38, 32768
s_add_u32 s39, s60, 229376
buffer_load_dwordx4 v84, s[8:11], s39 offen lds
s_add_u32 m0, s38, 33792
s_add_u32 s39, s60, 286720
buffer_load_dwordx4 v84, s[8:11], s39 offen lds
s_add_u32 m0, s38, 34816
s_add_u32 s39, s60, 344064
buffer_load_dwordx4 v84, s[8:11], s39 offen lds
s_add_u32 m0, s38, 35840
s_add_u32 s39, s60, 401408
buffer_load_dwordx4 v84, s[8:11], s39 offen lds
s_add_u32 m0, s38, 49152
s_add_u32 s39, s60, 229376
buffer_load_dwordx4 v84, s[84:87], s39 offen lds
s_add_u32 m0, s38, 50176
s_add_u32 s39, s60, 286720
buffer_load_dwordx4 v84, s[84:87], s39 offen lds
s_add_u32 m0, s38, 51200
s_add_u32 s39, s60, 344064
buffer_load_dwordx4 v84, s[84:87], s39 offen lds
s_add_u32 m0, s38, 52224
s_add_u32 s39, s60, 401408
buffer_load_dwordx4 v84, s[84:87], s39 offen lds
s_add_u32 m0, s38, 65536
s_add_u32 s39, s60, 458752
buffer_load_dwordx4 v84, s[8:11], s39 offen lds
s_add_u32 m0, s38, 66560
s_add_u32 s39, s60, 516096
buffer_load_dwordx4 v84, s[8:11], s39 offen lds
s_add_u32 m0, s38, 67584
s_add_u32 s39, s60, 573440
buffer_load_dwordx4 v84, s[8:11], s39 offen lds
s_add_u32 m0, s38, 68608
s_add_u32 s39, s60, 630784
buffer_load_dwordx4 v84, s[8:11], s39 offen lds
s_add_u32 m0, s38, 81920
s_add_u32 s39, s60, 458752
buffer_load_dwordx4 v84, s[84:87], s39 offen lds
s_add_u32 m0, s38, 82944
s_add_u32 s39, s60, 516096
buffer_load_dwordx4 v84, s[84:87], s39 offen lds
s_add_u32 m0, s38, 83968
s_add_u32 s39, s60, 573440
buffer_load_dwordx4 v84, s[84:87], s39 offen lds
s_add_u32 m0, s38, 84992
s_add_u32 s39, s60, 630784
buffer_load_dwordx4 v84, s[84:87], s39 offen lds
s_add_u32 m0, s38, 98304
s_add_u32 s39, s60, 688128
buffer_load_dwordx4 v84, s[8:11], s39 offen lds
s_add_u32 m0, s38, 99328
s_add_u32 s39, s60, 745472
buffer_load_dwordx4 v84, s[8:11], s39 offen lds
s_add_u32 m0, s38, 100352
s_add_u32 s39, s60, 802816
buffer_load_dwordx4 v84, s[8:11], s39 offen lds
s_add_u32 m0, s38, 101376
s_add_u32 s39, s60, 860160
buffer_load_dwordx4 v84, s[8:11], s39 offen lds
s_add_u32 m0, s38, 114688
s_add_u32 s39, s60, 688128
buffer_load_dwordx4 v84, s[84:87], s39 offen lds
s_add_u32 m0, s38, 115712
s_add_u32 s39, s60, 745472
buffer_load_dwordx4 v84, s[84:87], s39 offen lds
s_add_u32 m0, s38, 116736
s_add_u32 s39, s60, 802816
buffer_load_dwordx4 v84, s[84:87], s39 offen lds
s_add_u32 m0, s38, 117760
s_add_u32 s39, s60, 860160
buffer_load_dwordx4 v84, s[84:87], s39 offen lds
s_add_u32 m0, s38, 131072
s_add_u32 s39, s60, 917504
buffer_load_dwordx4 v84, s[8:11], s39 offen lds
s_add_u32 m0, s38, 132096
s_add_u32 s39, s60, 974848
buffer_load_dwordx4 v84, s[8:11], s39 offen lds
s_add_u32 m0, s38, 133120
s_add_u32 s39, s60, 1032192
buffer_load_dwordx4 v84, s[8:11], s39 offen lds
s_add_u32 m0, s38, 134144
s_add_u32 s39, s60, 1089536
buffer_load_dwordx4 v84, s[8:11], s39 offen lds
s_add_u32 m0, s38, 147456
s_add_u32 s39, s60, 917504
buffer_load_dwordx4 v84, s[84:87], s39 offen lds
s_add_u32 m0, s38, 148480
s_add_u32 s39, s60, 974848
buffer_load_dwordx4 v84, s[84:87], s39 offen lds
s_add_u32 m0, s38, 149504
s_add_u32 s39, s60, 1032192
buffer_load_dwordx4 v84, s[84:87], s39 offen lds
s_add_u32 m0, s38, 150528
s_add_u32 s39, s60, 1089536
buffer_load_dwordx4 v84, s[84:87], s39 offen lds
s_waitcnt vmcnt(32)
s_barrier
ds_read_b64_tr_b16 a[0:1], v80 offset:0
ds_read_b64_tr_b16 a[2:3], v80 offset:512
ds_read_b64_tr_b16 a[32:33], v80 offset:4096
ds_read_b64_tr_b16 a[34:35], v80 offset:4608
ds_read_b64_tr_b16 a[64:65], v80 offset:8192
ds_read_b64_tr_b16 a[66:67], v80 offset:8704
ds_read_b64_tr_b16 a[96:97], v80 offset:12288
ds_read_b64_tr_b16 a[98:99], v80 offset:12800
ds_read_b64_tr_b16 a[128:129], v81 offset:0
ds_read_b64_tr_b16 a[130:131], v81 offset:512
ds_read_b64_tr_b16 a[160:161], v81 offset:4096
ds_read_b64_tr_b16 a[162:163], v81 offset:4608
ds_read_b64_tr_b16 a[192:193], v81 offset:8192
ds_read_b64_tr_b16 a[194:195], v81 offset:8704
ds_read_b64_tr_b16 a[224:225], v81 offset:12288
ds_read_b64_tr_b16 a[226:227], v81 offset:12800
v_add_u32 v80, 32768, v80
v_add_u32 v81, 32768, v81
s_waitcnt lgkmcnt(0)
s_barrier
s_add_u32 m0, s38, 0
s_add_u32 s39, s60, 1146880
buffer_load_dwordx4 v84, s[8:11], s39 offen lds
s_add_u32 m0, s38, 1024
s_add_u32 s39, s60, 1204224
buffer_load_dwordx4 v84, s[8:11], s39 offen lds
s_add_u32 m0, s38, 2048
s_add_u32 s39, s60, 1261568
buffer_load_dwordx4 v84, s[8:11], s39 offen lds
s_add_u32 m0, s38, 3072
s_add_u32 s39, s60, 1318912
buffer_load_dwordx4 v84, s[8:11], s39 offen lds
s_add_u32 m0, s38, 16384
s_add_u32 s39, s60, 1146880
buffer_load_dwordx4 v84, s[84:87], s39 offen lds
s_add_u32 m0, s38, 17408
s_add_u32 s39, s60, 1204224
buffer_load_dwordx4 v84, s[84:87], s39 offen lds
s_add_u32 m0, s38, 18432
s_add_u32 s39, s60, 1261568
buffer_load_dwordx4 v84, s[84:87], s39 offen lds
s_add_u32 m0, s38, 19456
s_add_u32 s39, s60, 1318912
buffer_load_dwordx4 v84, s[84:87], s39 offen lds
s_waitcnt vmcnt(32)
s_barrier
ds_read_b64_tr_b16 a[4:5], v80 offset:0
ds_read_b64_tr_b16 a[6:7], v80 offset:512
ds_read_b64_tr_b16 a[36:37], v80 offset:4096
ds_read_b64_tr_b16 a[38:39], v80 offset:4608
ds_read_b64_tr_b16 a[68:69], v80 offset:8192
ds_read_b64_tr_b16 a[70:71], v80 offset:8704
ds_read_b64_tr_b16 a[100:101], v80 offset:12288
ds_read_b64_tr_b16 a[102:103], v80 offset:12800
ds_read_b64_tr_b16 a[132:133], v81 offset:0
ds_read_b64_tr_b16 a[134:135], v81 offset:512
ds_read_b64_tr_b16 a[164:165], v81 offset:4096
ds_read_b64_tr_b16 a[166:167], v81 offset:4608
ds_read_b64_tr_b16 a[196:197], v81 offset:8192
ds_read_b64_tr_b16 a[198:199], v81 offset:8704
ds_read_b64_tr_b16 a[228:229], v81 offset:12288
ds_read_b64_tr_b16 a[230:231], v81 offset:12800
v_add_u32 v80, 32768, v80
v_add_u32 v81, 32768, v81
s_waitcnt lgkmcnt(0)
s_barrier
s_add_u32 m0, s38, 32768
s_add_u32 s39, s60, 1376256
buffer_load_dwordx4 v84, s[8:11], s39 offen lds
s_add_u32 m0, s38, 33792
s_add_u32 s39, s60, 1433600
buffer_load_dwordx4 v84, s[8:11], s39 offen lds
s_add_u32 m0, s38, 34816
s_add_u32 s39, s60, 1490944
buffer_load_dwordx4 v84, s[8:11], s39 offen lds
s_add_u32 m0, s38, 35840
s_add_u32 s39, s60, 1548288
buffer_load_dwordx4 v84, s[8:11], s39 offen lds
s_add_u32 m0, s38, 49152
s_add_u32 s39, s60, 1376256
buffer_load_dwordx4 v84, s[84:87], s39 offen lds
s_add_u32 m0, s38, 50176
s_add_u32 s39, s60, 1433600
buffer_load_dwordx4 v84, s[84:87], s39 offen lds
s_add_u32 m0, s38, 51200
s_add_u32 s39, s60, 1490944
buffer_load_dwordx4 v84, s[84:87], s39 offen lds
s_add_u32 m0, s38, 52224
s_add_u32 s39, s60, 1548288
buffer_load_dwordx4 v84, s[84:87], s39 offen lds
s_waitcnt vmcnt(32)
s_barrier
ds_read_b64_tr_b16 a[8:9], v80 offset:0
ds_read_b64_tr_b16 a[10:11], v80 offset:512
ds_read_b64_tr_b16 a[40:41], v80 offset:4096
ds_read_b64_tr_b16 a[42:43], v80 offset:4608
ds_read_b64_tr_b16 a[72:73], v80 offset:8192
ds_read_b64_tr_b16 a[74:75], v80 offset:8704
ds_read_b64_tr_b16 a[104:105], v80 offset:12288
ds_read_b64_tr_b16 a[106:107], v80 offset:12800
ds_read_b64_tr_b16 a[136:137], v81 offset:0
ds_read_b64_tr_b16 a[138:139], v81 offset:512
ds_read_b64_tr_b16 a[168:169], v81 offset:4096
ds_read_b64_tr_b16 a[170:171], v81 offset:4608
ds_read_b64_tr_b16 a[200:201], v81 offset:8192
ds_read_b64_tr_b16 a[202:203], v81 offset:8704
ds_read_b64_tr_b16 a[232:233], v81 offset:12288
ds_read_b64_tr_b16 a[234:235], v81 offset:12800
v_add_u32 v80, 32768, v80
v_add_u32 v81, 32768, v81
s_waitcnt lgkmcnt(0)
s_barrier
s_add_u32 m0, s38, 65536
s_add_u32 s39, s60, 1605632
buffer_load_dwordx4 v84, s[8:11], s39 offen lds
s_add_u32 m0, s38, 66560
s_add_u32 s39, s60, 1662976
buffer_load_dwordx4 v84, s[8:11], s39 offen lds
s_add_u32 m0, s38, 67584
s_add_u32 s39, s60, 1720320
buffer_load_dwordx4 v84, s[8:11], s39 offen lds
s_add_u32 m0, s38, 68608
s_add_u32 s39, s60, 1777664
buffer_load_dwordx4 v84, s[8:11], s39 offen lds
s_add_u32 m0, s38, 81920
s_add_u32 s39, s60, 1605632
buffer_load_dwordx4 v84, s[84:87], s39 offen lds
s_add_u32 m0, s38, 82944
s_add_u32 s39, s60, 1662976
buffer_load_dwordx4 v84, s[84:87], s39 offen lds
s_add_u32 m0, s38, 83968
s_add_u32 s39, s60, 1720320
buffer_load_dwordx4 v84, s[84:87], s39 offen lds
s_add_u32 m0, s38, 84992
s_add_u32 s39, s60, 1777664
buffer_load_dwordx4 v84, s[84:87], s39 offen lds
s_waitcnt vmcnt(32)
s_barrier
ds_read_b64_tr_b16 a[12:13], v80 offset:0
ds_read_b64_tr_b16 a[14:15], v80 offset:512
ds_read_b64_tr_b16 a[44:45], v80 offset:4096
ds_read_b64_tr_b16 a[46:47], v80 offset:4608
ds_read_b64_tr_b16 a[76:77], v80 offset:8192
ds_read_b64_tr_b16 a[78:79], v80 offset:8704
ds_read_b64_tr_b16 a[108:109], v80 offset:12288
ds_read_b64_tr_b16 a[110:111], v80 offset:12800
ds_read_b64_tr_b16 a[140:141], v81 offset:0
ds_read_b64_tr_b16 a[142:143], v81 offset:512
ds_read_b64_tr_b16 a[172:173], v81 offset:4096
ds_read_b64_tr_b16 a[174:175], v81 offset:4608
ds_read_b64_tr_b16 a[204:205], v81 offset:8192
ds_read_b64_tr_b16 a[206:207], v81 offset:8704
ds_read_b64_tr_b16 a[236:237], v81 offset:12288
ds_read_b64_tr_b16 a[238:239], v81 offset:12800
v_add_u32 v80, 32768, v80
v_add_u32 v81, 32768, v81
s_waitcnt lgkmcnt(0)
s_barrier
s_waitcnt vmcnt(24)
s_barrier
ds_read_b64_tr_b16 a[16:17], v80 offset:0
ds_read_b64_tr_b16 a[18:19], v80 offset:512
ds_read_b64_tr_b16 a[48:49], v80 offset:4096
ds_read_b64_tr_b16 a[50:51], v80 offset:4608
ds_read_b64_tr_b16 a[80:81], v80 offset:8192
ds_read_b64_tr_b16 a[82:83], v80 offset:8704
ds_read_b64_tr_b16 a[112:113], v80 offset:12288
ds_read_b64_tr_b16 a[114:115], v80 offset:12800
ds_read_b64_tr_b16 a[144:145], v81 offset:0
ds_read_b64_tr_b16 a[146:147], v81 offset:512
ds_read_b64_tr_b16 a[176:177], v81 offset:4096
ds_read_b64_tr_b16 a[178:179], v81 offset:4608
ds_read_b64_tr_b16 a[208:209], v81 offset:8192
ds_read_b64_tr_b16 a[210:211], v81 offset:8704
ds_read_b64_tr_b16 a[240:241], v81 offset:12288
ds_read_b64_tr_b16 a[242:243], v81 offset:12800
v_add_u32 v80, -131072, v80
v_add_u32 v81, -131072, v81
s_waitcnt lgkmcnt(0)
s_barrier
s_waitcnt vmcnt(16)
s_barrier
ds_read_b64_tr_b16 a[20:21], v80 offset:0
ds_read_b64_tr_b16 a[22:23], v80 offset:512
ds_read_b64_tr_b16 a[52:53], v80 offset:4096
ds_read_b64_tr_b16 a[54:55], v80 offset:4608
ds_read_b64_tr_b16 a[84:85], v80 offset:8192
ds_read_b64_tr_b16 a[86:87], v80 offset:8704
ds_read_b64_tr_b16 a[116:117], v80 offset:12288
ds_read_b64_tr_b16 a[118:119], v80 offset:12800
ds_read_b64_tr_b16 a[148:149], v81 offset:0
ds_read_b64_tr_b16 a[150:151], v81 offset:512
ds_read_b64_tr_b16 a[180:181], v81 offset:4096
ds_read_b64_tr_b16 a[182:183], v81 offset:4608
ds_read_b64_tr_b16 a[212:213], v81 offset:8192
ds_read_b64_tr_b16 a[214:215], v81 offset:8704
ds_read_b64_tr_b16 a[244:245], v81 offset:12288
ds_read_b64_tr_b16 a[246:247], v81 offset:12800
v_add_u32 v80, 32768, v80
v_add_u32 v81, 32768, v81
s_waitcnt lgkmcnt(0)
s_barrier
s_waitcnt vmcnt(8)
s_barrier
ds_read_b64_tr_b16 a[24:25], v80 offset:0
ds_read_b64_tr_b16 a[26:27], v80 offset:512
ds_read_b64_tr_b16 a[56:57], v80 offset:4096
ds_read_b64_tr_b16 a[58:59], v80 offset:4608
ds_read_b64_tr_b16 a[88:89], v80 offset:8192
ds_read_b64_tr_b16 a[90:91], v80 offset:8704
ds_read_b64_tr_b16 a[120:121], v80 offset:12288
ds_read_b64_tr_b16 a[122:123], v80 offset:12800
ds_read_b64_tr_b16 a[152:153], v81 offset:0
ds_read_b64_tr_b16 a[154:155], v81 offset:512
ds_read_b64_tr_b16 a[184:185], v81 offset:4096
ds_read_b64_tr_b16 a[186:187], v81 offset:4608
ds_read_b64_tr_b16 a[216:217], v81 offset:8192
ds_read_b64_tr_b16 a[218:219], v81 offset:8704
ds_read_b64_tr_b16 a[248:249], v81 offset:12288
ds_read_b64_tr_b16 a[250:251], v81 offset:12800
v_add_u32 v80, 32768, v80
v_add_u32 v81, 32768, v81
s_waitcnt lgkmcnt(0)
s_barrier
s_waitcnt vmcnt(0)
s_barrier
ds_read_b64_tr_b16 a[28:29], v80 offset:0
ds_read_b64_tr_b16 a[30:31], v80 offset:512
ds_read_b64_tr_b16 a[60:61], v80 offset:4096
ds_read_b64_tr_b16 a[62:63], v80 offset:4608
ds_read_b64_tr_b16 a[92:93], v80 offset:8192
ds_read_b64_tr_b16 a[94:95], v80 offset:8704
ds_read_b64_tr_b16 a[124:125], v80 offset:12288
ds_read_b64_tr_b16 a[126:127], v80 offset:12800
ds_read_b64_tr_b16 a[156:157], v81 offset:0
ds_read_b64_tr_b16 a[158:159], v81 offset:512
ds_read_b64_tr_b16 a[188:189], v81 offset:4096
ds_read_b64_tr_b16 a[190:191], v81 offset:4608
ds_read_b64_tr_b16 a[220:221], v81 offset:8192
ds_read_b64_tr_b16 a[222:223], v81 offset:8704
ds_read_b64_tr_b16 a[252:253], v81 offset:12288
ds_read_b64_tr_b16 a[254:255], v81 offset:12800
v_add_u32 v80, 32768, v80
v_add_u32 v81, 32768, v81
s_waitcnt lgkmcnt(0)
s_barrier
s_lshr_b32 s26, s44, 3
s_and_b32 s62, s44, 7
s_lshl_b32 s60, s26, 20
s_lshl_b32 s38, s62, 8
s_add_u32 s60, s60, s38
s_add_u32 s61, s60, 128
s_lshr_b32 s52, s32, 1
s_lshl_b32 s52, s52, 14
s_and_b32 s53, s32, 1
s_lshl_b32 s53, s53, 6
s_add_u32 s52, s52, s53
v_bfe_u32 v84, v9, 2, 2
v_lshrrev_b32 v85, 4, v9
v_lshl_add_u32 v84, v85, 3, v84
v_lshl_add_u32 v84, v84, 7, s52
v_and_b32 v85, 3, v9
v_lshl_add_u32 v84, v85, 4, v84
v_add_u32 v80, 0, v84
v_bfe_u32 v84, v9, 2, 2
v_lshrrev_b32 v85, 4, v9
v_lshl_add_u32 v84, v85, 3, v84
v_lshl_add_u32 v84, v84, 7, s52
v_and_b32 v85, 3, v9
v_lshl_add_u32 v84, v85, 4, v84
v_add_u32 v81, 8, v84
v_lshrrev_b32 v84, 3, v9
s_mul_i32 s38, s32, 128
v_add_u32 v84, s38, v84
v_mul_u32_u24 v84, 2048, v84
v_and_b32 v85, 7, v9
v_lshl_add_u32 v84, v85, 4, v84
s_lshl_b32 s38, s32, 12
s_barrier
s_add_u32 m0, s38, 0
s_add_u32 s39, s60, 0
buffer_load_dwordx4 v84, s[88:91], s39 offen lds
s_add_u32 m0, s38, 1024
s_add_u32 s39, s60, 16384
buffer_load_dwordx4 v84, s[88:91], s39 offen lds
s_add_u32 m0, s38, 2048
s_add_u32 s39, s60, 32768
buffer_load_dwordx4 v84, s[88:91], s39 offen lds
s_add_u32 m0, s38, 3072
s_add_u32 s39, s60, 49152
buffer_load_dwordx4 v84, s[88:91], s39 offen lds
s_add_u32 m0, s38, 16384
s_add_u32 s39, s61, 0
buffer_load_dwordx4 v84, s[88:91], s39 offen lds
s_add_u32 m0, s38, 17408
s_add_u32 s39, s61, 16384
buffer_load_dwordx4 v84, s[88:91], s39 offen lds
s_add_u32 m0, s38, 18432
s_add_u32 s39, s61, 32768
buffer_load_dwordx4 v84, s[88:91], s39 offen lds
s_add_u32 m0, s38, 19456
s_add_u32 s39, s61, 49152
buffer_load_dwordx4 v84, s[88:91], s39 offen lds
s_add_u32 m0, s38, 32768
s_add_u32 s39, s60, 65536
buffer_load_dwordx4 v84, s[88:91], s39 offen lds
s_add_u32 m0, s38, 33792
s_add_u32 s39, s60, 81920
buffer_load_dwordx4 v84, s[88:91], s39 offen lds
s_add_u32 m0, s38, 34816
s_add_u32 s39, s60, 98304
buffer_load_dwordx4 v84, s[88:91], s39 offen lds
s_add_u32 m0, s38, 35840
s_add_u32 s39, s60, 114688
buffer_load_dwordx4 v84, s[88:91], s39 offen lds
s_add_u32 m0, s38, 49152
s_add_u32 s39, s61, 65536
buffer_load_dwordx4 v84, s[88:91], s39 offen lds
s_add_u32 m0, s38, 50176
s_add_u32 s39, s61, 81920
buffer_load_dwordx4 v84, s[88:91], s39 offen lds
s_add_u32 m0, s38, 51200
s_add_u32 s39, s61, 98304
buffer_load_dwordx4 v84, s[88:91], s39 offen lds
s_add_u32 m0, s38, 52224
s_add_u32 s39, s61, 114688
buffer_load_dwordx4 v84, s[88:91], s39 offen lds
s_add_u32 m0, s38, 65536
s_add_u32 s39, s60, 131072
buffer_load_dwordx4 v84, s[88:91], s39 offen lds
s_add_u32 m0, s38, 66560
s_add_u32 s39, s60, 147456
buffer_load_dwordx4 v84, s[88:91], s39 offen lds
s_add_u32 m0, s38, 67584
s_add_u32 s39, s60, 163840
buffer_load_dwordx4 v84, s[88:91], s39 offen lds
s_add_u32 m0, s38, 68608
s_add_u32 s39, s60, 180224
buffer_load_dwordx4 v84, s[88:91], s39 offen lds
s_add_u32 m0, s38, 81920
s_add_u32 s39, s61, 131072
buffer_load_dwordx4 v84, s[88:91], s39 offen lds
s_add_u32 m0, s38, 82944
s_add_u32 s39, s61, 147456
buffer_load_dwordx4 v84, s[88:91], s39 offen lds
s_add_u32 m0, s38, 83968
s_add_u32 s39, s61, 163840
buffer_load_dwordx4 v84, s[88:91], s39 offen lds
s_add_u32 m0, s38, 84992
s_add_u32 s39, s61, 180224
buffer_load_dwordx4 v84, s[88:91], s39 offen lds
s_add_u32 m0, s38, 98304
s_add_u32 s39, s60, 196608
buffer_load_dwordx4 v84, s[88:91], s39 offen lds
s_add_u32 m0, s38, 99328
s_add_u32 s39, s60, 212992
buffer_load_dwordx4 v84, s[88:91], s39 offen lds
s_add_u32 m0, s38, 100352
s_add_u32 s39, s60, 229376
buffer_load_dwordx4 v84, s[88:91], s39 offen lds
s_add_u32 m0, s38, 101376
s_add_u32 s39, s60, 245760
buffer_load_dwordx4 v84, s[88:91], s39 offen lds
s_add_u32 m0, s38, 114688
s_add_u32 s39, s61, 196608
buffer_load_dwordx4 v84, s[88:91], s39 offen lds
s_add_u32 m0, s38, 115712
s_add_u32 s39, s61, 212992
buffer_load_dwordx4 v84, s[88:91], s39 offen lds
s_add_u32 m0, s38, 116736
s_add_u32 s39, s61, 229376
buffer_load_dwordx4 v84, s[88:91], s39 offen lds
s_add_u32 m0, s38, 117760
s_add_u32 s39, s61, 245760
buffer_load_dwordx4 v84, s[88:91], s39 offen lds
s_waitcnt vmcnt(24)
s_barrier
ds_read_b64_tr_b16 v[128:129], v80 offset:0
ds_read_b64_tr_b16 v[130:131], v80 offset:512
ds_read_b64_tr_b16 v[144:145], v80 offset:4096
ds_read_b64_tr_b16 v[146:147], v80 offset:4608
ds_read_b64_tr_b16 v[160:161], v80 offset:8192
ds_read_b64_tr_b16 v[162:163], v80 offset:8704
ds_read_b64_tr_b16 v[176:177], v80 offset:12288
ds_read_b64_tr_b16 v[178:179], v80 offset:12800
ds_read_b64_tr_b16 v[192:193], v81 offset:0
ds_read_b64_tr_b16 v[194:195], v81 offset:512
ds_read_b64_tr_b16 v[208:209], v81 offset:4096
ds_read_b64_tr_b16 v[210:211], v81 offset:4608
ds_read_b64_tr_b16 v[224:225], v81 offset:8192
ds_read_b64_tr_b16 v[226:227], v81 offset:8704
ds_read_b64_tr_b16 v[240:241], v81 offset:12288
ds_read_b64_tr_b16 v[242:243], v81 offset:12800
v_add_u32 v80, 32768, v80
v_add_u32 v81, 32768, v81
s_waitcnt lgkmcnt(0)
s_barrier
s_waitcnt vmcnt(16)
s_barrier
ds_read_b64_tr_b16 v[132:133], v80 offset:0
ds_read_b64_tr_b16 v[134:135], v80 offset:512
ds_read_b64_tr_b16 v[148:149], v80 offset:4096
ds_read_b64_tr_b16 v[150:151], v80 offset:4608
ds_read_b64_tr_b16 v[164:165], v80 offset:8192
ds_read_b64_tr_b16 v[166:167], v80 offset:8704
ds_read_b64_tr_b16 v[180:181], v80 offset:12288
ds_read_b64_tr_b16 v[182:183], v80 offset:12800
ds_read_b64_tr_b16 v[196:197], v81 offset:0
ds_read_b64_tr_b16 v[198:199], v81 offset:512
ds_read_b64_tr_b16 v[212:213], v81 offset:4096
ds_read_b64_tr_b16 v[214:215], v81 offset:4608
ds_read_b64_tr_b16 v[228:229], v81 offset:8192
ds_read_b64_tr_b16 v[230:231], v81 offset:8704
ds_read_b64_tr_b16 v[244:245], v81 offset:12288
ds_read_b64_tr_b16 v[246:247], v81 offset:12800
v_add_u32 v80, 32768, v80
v_add_u32 v81, 32768, v81
s_waitcnt lgkmcnt(0)
s_barrier
s_waitcnt vmcnt(8)
s_barrier
ds_read_b64_tr_b16 v[136:137], v80 offset:0
ds_read_b64_tr_b16 v[138:139], v80 offset:512
ds_read_b64_tr_b16 v[152:153], v80 offset:4096
ds_read_b64_tr_b16 v[154:155], v80 offset:4608
ds_read_b64_tr_b16 v[168:169], v80 offset:8192
ds_read_b64_tr_b16 v[170:171], v80 offset:8704
ds_read_b64_tr_b16 v[184:185], v80 offset:12288
ds_read_b64_tr_b16 v[186:187], v80 offset:12800
ds_read_b64_tr_b16 v[200:201], v81 offset:0
ds_read_b64_tr_b16 v[202:203], v81 offset:512
ds_read_b64_tr_b16 v[216:217], v81 offset:4096
ds_read_b64_tr_b16 v[218:219], v81 offset:4608
ds_read_b64_tr_b16 v[232:233], v81 offset:8192
ds_read_b64_tr_b16 v[234:235], v81 offset:8704
ds_read_b64_tr_b16 v[248:249], v81 offset:12288
ds_read_b64_tr_b16 v[250:251], v81 offset:12800
v_add_u32 v80, 32768, v80
v_add_u32 v81, 32768, v81
s_waitcnt lgkmcnt(0)
s_barrier
s_waitcnt vmcnt(0)
s_barrier
ds_read_b64_tr_b16 v[140:141], v80 offset:0
ds_read_b64_tr_b16 v[142:143], v80 offset:512
ds_read_b64_tr_b16 v[156:157], v80 offset:4096
ds_read_b64_tr_b16 v[158:159], v80 offset:4608
ds_read_b64_tr_b16 v[172:173], v80 offset:8192
ds_read_b64_tr_b16 v[174:175], v80 offset:8704
ds_read_b64_tr_b16 v[188:189], v80 offset:12288
ds_read_b64_tr_b16 v[190:191], v80 offset:12800
ds_read_b64_tr_b16 v[204:205], v81 offset:0
ds_read_b64_tr_b16 v[206:207], v81 offset:512
ds_read_b64_tr_b16 v[220:221], v81 offset:4096
ds_read_b64_tr_b16 v[222:223], v81 offset:4608
ds_read_b64_tr_b16 v[236:237], v81 offset:8192
ds_read_b64_tr_b16 v[238:239], v81 offset:8704
ds_read_b64_tr_b16 v[252:253], v81 offset:12288
ds_read_b64_tr_b16 v[254:255], v81 offset:12800
v_add_u32 v80, -98304, v80
v_add_u32 v81, -98304, v81
s_waitcnt lgkmcnt(0)
s_barrier
s_mul_i32 s50, s32, 4096
v_lshlrev_b32 v1, 4, v9
v_add_u32 v0, s50, v1
s_mov_b32 s60, s50
v_add_u32 v11, 0x20000, v1
v_mov_b32 v7, v1
v_min_u32 v2, 3, v9
v_lshlrev_b32 v2, 7, v2
v_min_u32 v12, 7, v9
v_lshlrev_b32 v12, 7, v12
s_lshl_b32 s61, s26, 10
s_add_u32 s61, s61, 3416064
s_lshl_b32 s38, s44, 1
s_lshr_b32 s39, s32, 1
s_add_u32 s38, s38, s39
s_lshl_b32 s38, s38, 11
s_and_b32 s39, s32, 1
s_lshl_b32 s39, s39, 9
s_add_u32 s38, s38, s39
v_and_b32 v80, 15, v9
v_lshl_add_u32 v6, v80, 4, s38
v_bfe_u32 v80, v9, 4, 1
v_lshl_add_u32 v6, v80, 10, v6
v_lshrrev_b32 v80, 5, v9
v_lshl_add_u32 v6, v80, 8, v6
s_mov_b32 s49, 100663296
s_mov_b32 s54, 16777216
s_lshl_b32 s59, s26, 15
s_add_u32 s59, s59, 99975168
s_lshl_b32 s38, s62, 2
s_add_u32 s38, s38, s32
s_lshl_b32 s38, s38, 11
s_lshl_b32 s62, s26, 22
s_add_u32 s62, s62, s38
s_add_u32 s62, s62, 134021120
s_mov_b32 s64, 0xbfb8aa3b
v_mov_b32 v100, 0
v_mov_b32 v101, 0
s_mov_b32 s36, 0
Lfw_611:
s_add_u32 s48, s36, 0
s_and_b32 s47, s48, 1
s_lshl_b32 s47, s47, 9
s_add_u32 s47, s47, 3423232
s_add_u32 s48, s48, 1
Lbw_616:
buffer_load_dword v3, v2, s[4:7], s47 offen sc1
s_waitcnt vmcnt(0)
v_cmp_gt_u32 vcc, s48, v3
s_cbranch_vccz Lbo_617
s_sub_u32 s37, s37, 1
s_cbranch_scc1 Lend_7
s_sleep 4
s_branch Lbw_616
Lbo_617:
s_add_u32 m0, s50, 0
s_add_u32 s39, s54, 0
buffer_load_dwordx4 v0, s[4:7], s39 offen offset:0 sc1 lds
buffer_load_dwordx4 v0, s[4:7], s39 offen offset:2048 sc1 lds
s_add_u32 m0, s50, 16384
s_add_u32 s39, s54, 16384
buffer_load_dwordx4 v0, s[4:7], s39 offen offset:0 sc1 lds
buffer_load_dwordx4 v0, s[4:7], s39 offen offset:2048 sc1 lds
s_add_u32 m0, s50, 32768
s_add_u32 s39, s54, 32768
buffer_load_dwordx4 v0, s[4:7], s39 offen offset:0 sc1 lds
buffer_load_dwordx4 v0, s[4:7], s39 offen offset:2048 sc1 lds
s_add_u32 m0, s50, 49152
s_add_u32 s39, s54, 49152
buffer_load_dwordx4 v0, s[4:7], s39 offen offset:0 sc1 lds
buffer_load_dwordx4 v0, s[4:7], s39 offen offset:2048 sc1 lds
s_add_u32 s48, s36, 1
s_and_b32 s47, s48, 1
s_lshl_b32 s47, s47, 9
s_add_u32 s47, s47, 3423232
s_add_u32 s48, s48, 1
buffer_load_dword v3, v2, s[4:7], s47 offen sc1
buffer_load_dword v13, v12, s[4:7], s61 offen sc1
s_add_u32 m0, s50, 0
s_add_u32 s39, s54, 0
buffer_load_dwordx4 v0, s[4:7], s39 offen offset:1024 sc1 lds
buffer_load_dwordx4 v0, s[4:7], s39 offen offset:3072 sc1 lds
s_add_u32 m0, s50, 16384
s_add_u32 s39, s54, 16384
buffer_load_dwordx4 v0, s[4:7], s39 offen offset:1024 sc1 lds
buffer_load_dwordx4 v0, s[4:7], s39 offen offset:3072 sc1 lds
s_add_u32 m0, s50, 32768
s_add_u32 s39, s54, 32768
buffer_load_dwordx4 v0, s[4:7], s39 offen offset:1024 sc1 lds
buffer_load_dwordx4 v0, s[4:7], s39 offen offset:3072 sc1 lds
s_add_u32 m0, s50, 49152
s_add_u32 s39, s54, 49152
buffer_load_dwordx4 v0, s[4:7], s39 offen offset:1024 sc1 lds
buffer_load_dwordx4 v0, s[4:7], s39 offen offset:3072 sc1 lds
s_mov_b32 s58, 0x70000000
s_waitcnt vmcnt(8)
s_barrier
ds_read_b128 v[16:19], v1 offset:0
ds_read_b128 v[20:23], v1 offset:2048
ds_read_b128 v[24:27], v1 offset:4096
ds_read_b128 v[28:31], v1 offset:6144
ds_read_b128 v[32:35], v1 offset:8192
ds_read_b128 v[36:39], v1 offset:10240
ds_read_b128 v[40:43], v1 offset:12288
Lfb_610:
s_waitcnt lgkmcnt(5)
v_mfma_f32_16x16x32_bf16 v[48:51], a[0:3], v[16:19], 0
s_add_u32 s54, s54, 65536
ds_read_b128 v[44:47], v1 offset:14336
s_xor_b32 s50, s50, 0x10000
v_mfma_f32_16x16x32_bf16 v[56:59], a[128:131], v[16:19], 0
s_sub_u32 s57, s36, 2
s_max_i32 s57, s57, 0
v_cmp_gt_u32 vcc, s48, v3
v_mfma_f32_16x16x32_bf16 v[48:51], a[4:7], v[20:23], v[48:51]
ds_read_b128 v[16:19], v1 offset:16384
v_mfma_f32_16x16x32_bf16 v[56:59], a[132:135], v[20:23], v[56:59]
s_waitcnt lgkmcnt(5)
s_cmp_eq_u64 vcc, 0
s_cselect_b32 s46, 1, 0
v_mfma_f32_16x16x32_bf16 v[48:51], a[8:11], v[24:27], v[48:51]
s_cselect_b32 s45, s54, 0x70000000
ds_read_b128 v[20:23], v1 offset:18432
v_cmp_gt_u32 vcc, s57, v13
v_mfma_f32_16x16x32_bf16 v[56:59], a[136:139], v[24:27], v[56:59]
v_mfma_f32_16x16x32_bf16 v[48:51], a[12:15], v[28:31], v[48:51]
s_cmp_eq_u64 vcc, 0
ds_read_b128 v[24:27], v1 offset:20480
s_cselect_b32 s56, 1, 0
v_mfma_f32_16x16x32_bf16 v[56:59], a[140:143], v[28:31], v[56:59]
s_waitcnt lgkmcnt(5)
s_cselect_b32 s55, s59, 0x70000000
s_add_u32 m0, s60, 131072
v_mfma_f32_16x16x32_bf16 v[48:51], a[16:19], v[32:35], v[48:51]
s_add_u32 s39, s55, 0
ds_read_b128 v[28:31], v1 offset:22528
buffer_load_dwordx4 v0, s[4:7], s39 offen offset:0 sc1 lds
v_mfma_f32_16x16x32_bf16 v[56:59], a[144:147], v[32:35], v[56:59]
v_mfma_f32_16x16x32_bf16 v[48:51], a[20:23], v[36:39], v[48:51]
ds_read_b128 v[32:35], v1 offset:24576
v_cvt_pk_bf16_f32 v80, v64, v65
v_mfma_f32_16x16x32_bf16 v[56:59], a[148:151], v[36:39], v[56:59]
s_waitcnt lgkmcnt(5)
v_cvt_pk_bf16_f32 v81, v66, v67
v_cvt_pk_bf16_f32 v82, v68, v69
v_mfma_f32_16x16x32_bf16 v[48:51], a[24:27], v[40:43], v[48:51]
ds_read_b128 v[36:39], v1 offset:26624
v_cvt_pk_bf16_f32 v83, v70, v71
v_mfma_f32_16x16x32_bf16 v[56:59], a[152:155], v[40:43], v[56:59]
v_cvt_pk_bf16_f32 v84, v72, v73
v_cvt_pk_bf16_f32 v85, v74, v75
v_mfma_f32_16x16x32_bf16 v[48:51], a[28:31], v[44:47], v[48:51]
ds_read_b128 v[40:43], v1 offset:28672
v_cvt_pk_bf16_f32 v86, v76, v77
v_mfma_f32_16x16x32_bf16 v[56:59], a[156:159], v[44:47], v[56:59]
s_waitcnt lgkmcnt(5)
v_cvt_pk_bf16_f32 v87, v78, v79
v_mfma_f32_16x16x32_bf16 v[48:51], a[32:35], v[16:19], v[48:51]
ds_read_b128 v[44:47], v1 offset:30720
buffer_load_dwordx4 v0, s[4:7], s39 offen offset:1024 sc1 lds
v_mfma_f32_16x16x32_bf16 v[56:59], a[160:163], v[16:19], v[56:59]
v_mfma_f32_16x16x32_bf16 v[48:51], a[36:39], v[20:23], v[48:51]
ds_read_b128 v[16:19], v1 offset:32768
v_mfma_f32_16x16x32_bf16 v[56:59], a[164:167], v[20:23], v[56:59]
s_waitcnt lgkmcnt(5)
v_mfma_f32_16x16x32_bf16 v[48:51], a[40:43], v[24:27], v[48:51]
ds_read_b128 v[20:23], v1 offset:34816
v_mfma_f32_16x16x32_bf16 v[56:59], a[168:171], v[24:27], v[56:59]
v_mfma_f32_16x16x32_bf16 v[48:51], a[44:47], v[28:31], v[48:51]
ds_read_b128 v[24:27], v1 offset:36864
v_mfma_f32_16x16x32_bf16 v[56:59], a[172:175], v[28:31], v[56:59]
s_waitcnt lgkmcnt(5)
v_mfma_f32_16x16x32_bf16 v[48:51], a[48:51], v[32:35], v[48:51]
ds_read_b128 v[28:31], v1 offset:38912
buffer_load_dwordx4 v0, s[4:7], s39 offen offset:2048 sc1 lds
v_mfma_f32_16x16x32_bf16 v[56:59], a[176:179], v[32:35], v[56:59]
v_mfma_f32_16x16x32_bf16 v[48:51], a[52:55], v[36:39], v[48:51]
ds_read_b128 v[32:35], v1 offset:40960
v_mfma_f32_16x16x32_bf16 v[56:59], a[180:183], v[36:39], v[56:59]
s_waitcnt lgkmcnt(5)
v_mfma_f32_16x16x32_bf16 v[48:51], a[56:59], v[40:43], v[48:51]
ds_read_b128 v[36:39], v1 offset:43008
v_mfma_f32_16x16x32_bf16 v[56:59], a[184:187], v[40:43], v[56:59]
v_mfma_f32_16x16x32_bf16 v[48:51], a[60:63], v[44:47], v[48:51]
ds_read_b128 v[40:43], v1 offset:45056
v_mfma_f32_16x16x32_bf16 v[56:59], a[188:191], v[44:47], v[56:59]
s_waitcnt lgkmcnt(5)
v_mfma_f32_16x16x32_bf16 v[48:51], a[64:67], v[16:19], v[48:51]
ds_read_b128 v[44:47], v1 offset:47104
buffer_load_dwordx4 v0, s[4:7], s39 offen offset:3072 sc1 lds
v_mfma_f32_16x16x32_bf16 v[56:59], a[192:195], v[16:19], v[56:59]
v_mfma_f32_16x16x32_bf16 v[48:51], a[68:71], v[20:23], v[48:51]
ds_read_b128 v[16:19], v1 offset:49152
v_mfma_f32_16x16x32_bf16 v[56:59], a[196:199], v[20:23], v[56:59]
s_waitcnt lgkmcnt(5)
v_mfma_f32_16x16x32_bf16 v[48:51], a[72:75], v[24:27], v[48:51]
ds_read_b128 v[20:23], v1 offset:51200
v_mfma_f32_16x16x32_bf16 v[56:59], a[200:203], v[24:27], v[56:59]
v_mfma_f32_16x16x32_bf16 v[48:51], a[76:79], v[28:31], v[48:51]
ds_read_b128 v[24:27], v1 offset:53248
v_mfma_f32_16x16x32_bf16 v[56:59], a[204:207], v[28:31], v[56:59]
s_waitcnt lgkmcnt(5)
v_mfma_f32_16x16x32_bf16 v[48:51], a[80:83], v[32:35], v[48:51]
s_add_u32 m0, s60, 147456
ds_read_b128 v[28:31], v1 offset:55296
s_add_u32 s39, s55, 16384
v_mfma_f32_16x16x32_bf16 v[56:59], a[208:211], v[32:35], v[56:59]
buffer_load_dwordx4 v0, s[4:7], s39 offen offset:0 sc1 lds
v_mfma_f32_16x16x32_bf16 v[48:51], a[84:87], v[36:39], v[48:51]
ds_read_b128 v[32:35], v1 offset:57344
v_mfma_f32_16x16x32_bf16 v[56:59], a[212:215], v[36:39], v[56:59]
s_waitcnt lgkmcnt(5)
v_mfma_f32_16x16x32_bf16 v[48:51], a[88:91], v[40:43], v[48:51]
ds_read_b128 v[36:39], v1 offset:59392
v_mfma_f32_16x16x32_bf16 v[56:59], a[216:219], v[40:43], v[56:59]
v_mfma_f32_16x16x32_bf16 v[48:51], a[92:95], v[44:47], v[48:51]
ds_read_b128 v[40:43], v1 offset:61440
v_mfma_f32_16x16x32_bf16 v[56:59], a[220:223], v[44:47], v[56:59]
s_waitcnt lgkmcnt(5)
v_mfma_f32_16x16x32_bf16 v[48:51], a[96:99], v[16:19], v[48:51]
ds_read_b128 v[44:47], v1 offset:63488
v_mfma_f32_16x16x32_bf16 v[56:59], a[224:227], v[16:19], v[56:59]
buffer_load_dwordx4 v0, s[4:7], s39 offen offset:1024 sc1 lds
v_mfma_f32_16x16x32_bf16 v[48:51], a[100:103], v[20:23], v[48:51]
s_waitcnt vmcnt(6)
s_barrier
ds_read_b128 v[16:19], v1 offset:1024
v_mfma_f32_16x16x32_bf16 v[56:59], a[228:231], v[20:23], v[56:59]
s_waitcnt lgkmcnt(5)
v_min_u32 v100, s36, 64
s_sub_u32 s38, s36, 4
v_mfma_f32_16x16x32_bf16 v[48:51], a[104:107], v[24:27], v[48:51]
ds_read_b128 v[20:23], v1 offset:3072
v_max_i32 v101, s38, 0
v_mfma_f32_16x16x32_bf16 v[56:59], a[232:235], v[24:27], v[56:59]
buffer_store_dwordx2 v[100:101], v4, s[4:7], 0 offen sc1
v_mfma_f32_16x16x32_bf16 v[48:51], a[108:111], v[28:31], v[48:51]
ds_read_b128 v[24:27], v1 offset:5120
v_mfma_f32_16x16x32_bf16 v[56:59], a[236:239], v[28:31], v[56:59]
s_waitcnt lgkmcnt(5)
v_mfma_f32_16x16x32_bf16 v[48:51], a[112:115], v[32:35], v[48:51]
ds_read_b128 v[28:31], v1 offset:7168
buffer_load_dwordx4 v0, s[4:7], s39 offen offset:2048 sc1 lds
v_mfma_f32_16x16x32_bf16 v[56:59], a[240:243], v[32:35], v[56:59]
v_mfma_f32_16x16x32_bf16 v[48:51], a[116:119], v[36:39], v[48:51]
ds_read_b128 v[32:35], v1 offset:9216
v_mfma_f32_16x16x32_bf16 v[56:59], a[244:247], v[36:39], v[56:59]
s_waitcnt lgkmcnt(5)
v_mfma_f32_16x16x32_bf16 v[48:51], a[120:123], v[40:43], v[48:51]
ds_read_b128 v[36:39], v1 offset:11264
v_mfma_f32_16x16x32_bf16 v[56:59], a[248:251], v[40:43], v[56:59]
v_mfma_f32_16x16x32_bf16 v[48:51], a[124:127], v[44:47], v[48:51]
ds_read_b128 v[40:43], v1 offset:13312
v_mfma_f32_16x16x32_bf16 v[56:59], a[252:255], v[44:47], v[56:59]
s_waitcnt lgkmcnt(5)
v_mfma_f32_16x16x32_bf16 v[52:55], a[0:3], v[16:19], 0
ds_read_b128 v[44:47], v1 offset:15360
buffer_load_dwordx4 v0, s[4:7], s39 offen offset:3072 sc1 lds
v_mfma_f32_16x16x32_bf16 v[60:63], a[128:131], v[16:19], 0
v_mfma_f32_16x16x32_bf16 v[52:55], a[4:7], v[20:23], v[52:55]
ds_read_b128 v[16:19], v1 offset:17408
v_mfma_f32_16x16x32_bf16 v[60:63], a[132:135], v[20:23], v[60:63]
s_waitcnt lgkmcnt(5)
v_mfma_f32_16x16x32_bf16 v[52:55], a[8:11], v[24:27], v[52:55]
ds_read_b128 v[20:23], v1 offset:19456
v_mfma_f32_16x16x32_bf16 v[60:63], a[136:139], v[24:27], v[60:63]
v_mfma_f32_16x16x32_bf16 v[52:55], a[12:15], v[28:31], v[52:55]
ds_read_b128 v[24:27], v1 offset:21504
v_mfma_f32_16x16x32_bf16 v[60:63], a[140:143], v[28:31], v[60:63]
s_waitcnt lgkmcnt(5)
v_mfma_f32_16x16x32_bf16 v[52:55], a[16:19], v[32:35], v[52:55]
s_add_u32 m0, s50, 0
ds_read_b128 v[28:31], v1 offset:23552
s_add_u32 s39, s45, 0
v_mfma_f32_16x16x32_bf16 v[60:63], a[144:147], v[32:35], v[60:63]
buffer_load_dwordx4 v0, s[4:7], s39 offen offset:0 sc1 lds
v_mul_f32 v88, s64, v48
v_mfma_f32_16x16x32_bf16 v[52:55], a[20:23], v[36:39], v[52:55]
ds_read_b128 v[32:35], v1 offset:25600
v_mul_f32 v89, s64, v49
v_mfma_f32_16x16x32_bf16 v[60:63], a[148:151], v[36:39], v[60:63]
s_waitcnt lgkmcnt(5)
v_mul_f32 v90, s64, v50
v_mul_f32 v91, s64, v51
v_mfma_f32_16x16x32_bf16 v[52:55], a[24:27], v[40:43], v[52:55]
ds_read_b128 v[36:39], v1 offset:27648
v_mfma_f32_16x16x32_bf16 v[60:63], a[152:155], v[40:43], v[60:63]
v_exp_f32 v88, v88
v_mfma_f32_16x16x32_bf16 v[52:55], a[28:31], v[44:47], v[52:55]
ds_read_b128 v[40:43], v1 offset:29696
v_mfma_f32_16x16x32_bf16 v[60:63], a[156:159], v[44:47], v[60:63]
s_waitcnt lgkmcnt(5)
v_exp_f32 v89, v89
v_mfma_f32_16x16x32_bf16 v[52:55], a[32:35], v[16:19], v[52:55]
ds_read_b128 v[44:47], v1 offset:31744
v_mfma_f32_16x16x32_bf16 v[60:63], a[160:163], v[16:19], v[60:63]
buffer_load_dwordx4 v0, s[4:7], s39 offen offset:2048 sc1 lds
v_mfma_f32_16x16x32_bf16 v[52:55], a[36:39], v[20:23], v[52:55]
ds_read_b128 v[16:19], v1 offset:33792
v_mfma_f32_16x16x32_bf16 v[60:63], a[164:167], v[20:23], v[60:63]
s_waitcnt lgkmcnt(5)
v_exp_f32 v90, v90
v_mfma_f32_16x16x32_bf16 v[52:55], a[40:43], v[24:27], v[52:55]
ds_read_b128 v[20:23], v1 offset:35840
v_mfma_f32_16x16x32_bf16 v[60:63], a[168:171], v[24:27], v[60:63]
v_exp_f32 v91, v91
v_mfma_f32_16x16x32_bf16 v[52:55], a[44:47], v[28:31], v[52:55]
ds_read_b128 v[24:27], v1 offset:37888
v_mul_f32 v104, v48, v56
v_mfma_f32_16x16x32_bf16 v[60:63], a[172:175], v[28:31], v[60:63]
s_waitcnt lgkmcnt(5)
v_mul_f32 v105, v49, v57
v_mul_f32 v106, v50, v58
v_mfma_f32_16x16x32_bf16 v[52:55], a[48:51], v[32:35], v[52:55]
ds_read_b128 v[28:31], v1 offset:39936
v_mul_f32 v107, v51, v59
v_mfma_f32_16x16x32_bf16 v[60:63], a[176:179], v[32:35], v[60:63]
s_add_u32 m0, s50, 16384
s_add_u32 s39, s45, 16384
buffer_load_dwordx4 v0, s[4:7], s39 offen offset:0 sc1 lds
v_mfma_f32_16x16x32_bf16 v[52:55], a[52:55], v[36:39], v[52:55]
ds_read_b128 v[32:35], v1 offset:41984
v_add_f32 v88, 1.0, v88
v_mfma_f32_16x16x32_bf16 v[60:63], a[180:183], v[36:39], v[60:63]
s_waitcnt lgkmcnt(5)
v_add_f32 v89, 1.0, v89
v_add_f32 v90, 1.0, v90
v_mfma_f32_16x16x32_bf16 v[52:55], a[56:59], v[40:43], v[52:55]
ds_read_b128 v[36:39], v1 offset:44032
v_add_f32 v91, 1.0, v91
v_mfma_f32_16x16x32_bf16 v[60:63], a[184:187], v[40:43], v[60:63]
v_rcp_f32 v88, v88
v_mfma_f32_16x16x32_bf16 v[52:55], a[60:63], v[44:47], v[52:55]
ds_read_b128 v[40:43], v1 offset:46080
v_mfma_f32_16x16x32_bf16 v[60:63], a[188:191], v[44:47], v[60:63]
s_waitcnt lgkmcnt(5)
v_rcp_f32 v89, v89
v_mfma_f32_16x16x32_bf16 v[52:55], a[64:67], v[16:19], v[52:55]
ds_read_b128 v[44:47], v1 offset:48128
v_mfma_f32_16x16x32_bf16 v[60:63], a[192:195], v[16:19], v[60:63]
buffer_load_dwordx4 v0, s[4:7], s39 offen offset:2048 sc1 lds
v_mfma_f32_16x16x32_bf16 v[52:55], a[68:71], v[20:23], v[52:55]
ds_read_b128 v[16:19], v1 offset:50176
v_mfma_f32_16x16x32_bf16 v[60:63], a[196:199], v[20:23], v[60:63]
s_waitcnt lgkmcnt(5)
v_rcp_f32 v90, v90
v_mfma_f32_16x16x32_bf16 v[52:55], a[72:75], v[24:27], v[52:55]
ds_read_b128 v[20:23], v1 offset:52224
v_mfma_f32_16x16x32_bf16 v[60:63], a[200:203], v[24:27], v[60:63]
v_rcp_f32 v91, v91
v_mfma_f32_16x16x32_bf16 v[52:55], a[76:79], v[28:31], v[52:55]
ds_read_b128 v[24:27], v1 offset:54272
v_mul_f32 v104, v104, v88
v_mfma_f32_16x16x32_bf16 v[60:63], a[204:207], v[28:31], v[60:63]
s_waitcnt lgkmcnt(5)
v_mul_f32 v105, v105, v89
v_mul_f32 v106, v106, v90
v_mfma_f32_16x16x32_bf16 v[52:55], a[80:83], v[32:35], v[52:55]
ds_read_b128 v[28:31], v1 offset:56320
v_mul_f32 v107, v107, v91
v_mfma_f32_16x16x32_bf16 v[60:63], a[208:211], v[32:35], v[60:63]
s_add_u32 m0, s50, 32768
s_add_u32 s39, s45, 32768
buffer_load_dwordx4 v0, s[4:7], s39 offen offset:0 sc1 lds
v_mfma_f32_16x16x32_bf16 v[52:55], a[84:87], v[36:39], v[52:55]
ds_read_b128 v[32:35], v1 offset:58368
v_mfma_f32_16x16x32_bf16 v[60:63], a[212:215], v[36:39], v[60:63]
s_waitcnt lgkmcnt(5)
v_mfma_f32_16x16x32_bf16 v[52:55], a[88:91], v[40:43], v[52:55]
ds_read_b128 v[36:39], v1 offset:60416
v_mfma_f32_16x16x32_bf16 v[60:63], a[216:219], v[40:43], v[60:63]
v_mfma_f32_16x16x32_bf16 v[52:55], a[92:95], v[44:47], v[52:55]
ds_read_b128 v[40:43], v1 offset:62464
v_mfma_f32_16x16x32_bf16 v[60:63], a[220:223], v[44:47], v[60:63]
s_waitcnt lgkmcnt(5)
v_mfma_f32_16x16x32_bf16 v[52:55], a[96:99], v[16:19], v[52:55]
ds_read_b128 v[44:47], v1 offset:64512
v_mfma_f32_16x16x32_bf16 v[60:63], a[224:227], v[16:19], v[60:63]
buffer_load_dwordx4 v0, s[4:7], s39 offen offset:2048 sc1 lds
v_mfma_f32_16x16x32_bf16 v[52:55], a[100:103], v[20:23], v[52:55]
v_mfma_f32_16x16x32_bf16 v[60:63], a[228:231], v[20:23], v[60:63]
s_waitcnt lgkmcnt(4)
v_mfma_f32_16x16x32_bf16 v[52:55], a[104:107], v[24:27], v[52:55]
v_mfma_f32_16x16x32_bf16 v[60:63], a[232:235], v[24:27], v[60:63]
s_cmp_eq_u32 s56, 0
s_cbranch_scc1 Lfl_612
s_waitcnt vmcnt(6) lgkmcnt(0)
Lfg_613:
s_barrier
v_mfma_f32_16x16x32_bf16 v[52:55], a[108:111], v[28:31], v[52:55]
ds_read_b128 v[16:19], v11 offset:0
ds_read_b128 v[20:23], v11 offset:1024
v_mfma_f32_16x16x32_bf16 v[60:63], a[236:239], v[28:31], v[60:63]
s_add_u32 m0, s50, 49152
ds_read_b128 v[24:27], v11 offset:2048
s_add_u32 s39, s45, 49152
v_mfma_f32_16x16x32_bf16 v[52:55], a[112:115], v[32:35], v[52:55]
ds_read_b128 v[28:31], v11 offset:3072
buffer_load_dwordx4 v0, s[4:7], s39 offen offset:0 sc1 lds
v_mfma_f32_16x16x32_bf16 v[60:63], a[240:243], v[32:35], v[60:63]
s_add_u32 s48, s36, 2
s_and_b32 s47, s48, 1
s_lshl_b32 s47, s47, 9
v_mfma_f32_16x16x32_bf16 v[52:55], a[116:119], v[36:39], v[52:55]
s_add_u32 s47, s47, 3423232
ds_read_b128 v[32:35], v11 offset:4096
s_add_u32 s48, s48, 1
v_mfma_f32_16x16x32_bf16 v[60:63], a[244:247], v[36:39], v[60:63]
buffer_load_dword v3, v2, s[4:7], s47 offen sc1
v_mfma_f32_16x16x32_bf16 v[52:55], a[120:123], v[40:43], v[52:55]
ds_read_b128 v[36:39], v11 offset:5120
buffer_load_dword v13, v12, s[4:7], s61 offen sc1
v_mfma_f32_16x16x32_bf16 v[60:63], a[248:251], v[40:43], v[60:63]
v_xor_b32 v1, 0x10000, v1
v_mfma_f32_16x16x32_bf16 v[52:55], a[124:127], v[44:47], v[52:55]
ds_read_b128 v[40:43], v11 offset:6144
buffer_load_dwordx4 v0, s[4:7], s39 offen offset:2048 sc1 lds
v_mfma_f32_16x16x32_bf16 v[60:63], a[252:255], v[44:47], v[60:63]
s_waitcnt lgkmcnt(5)
v_mfma_f32_16x16x32_bf16 v[64:67], v[128:131], v[16:19], 0
ds_read_b128 v[44:47], v11 offset:7168
v_mfma_f32_16x16x32_bf16 v[68:71], v[192:195], v[16:19], 0
v_mfma_f32_16x16x32_bf16 v[72:75], v[128:131], v[20:23], 0
ds_read_b128 v[16:19], v11 offset:8192
v_mfma_f32_16x16x32_bf16 v[76:79], v[192:195], v[20:23], 0
s_waitcnt lgkmcnt(5)
s_add_u32 m0, s50, 0
s_add_u32 s39, s45, 0
v_mfma_f32_16x16x32_bf16 v[64:67], v[132:135], v[24:27], v[64:67]
ds_read_b128 v[20:23], v11 offset:9216
buffer_load_dwordx4 v0, s[4:7], s39 offen offset:1024 sc1 lds
v_mfma_f32_16x16x32_bf16 v[68:71], v[196:199], v[24:27], v[68:71]
v_mfma_f32_16x16x32_bf16 v[72:75], v[132:135], v[28:31], v[72:75]
ds_read_b128 v[24:27], v11 offset:10240
v_mfma_f32_16x16x32_bf16 v[76:79], v[196:199], v[28:31], v[76:79]
s_waitcnt lgkmcnt(5)
buffer_store_dwordx4 v[80:83], v7, s[4:7], s58 offen offset:0 sc1
v_mfma_f32_16x16x32_bf16 v[64:67], v[136:139], v[32:35], v[64:67]
ds_read_b128 v[28:31], v11 offset:11264
v_mul_f32 v88, s64, v52
v_mfma_f32_16x16x32_bf16 v[68:71], v[200:203], v[32:35], v[68:71]
v_mul_f32 v89, s64, v53
v_mul_f32 v90, s64, v54
v_mfma_f32_16x16x32_bf16 v[72:75], v[136:139], v[36:39], v[72:75]
ds_read_b128 v[32:35], v11 offset:12288
v_mul_f32 v91, s64, v55
v_mfma_f32_16x16x32_bf16 v[76:79], v[200:203], v[36:39], v[76:79]
s_waitcnt lgkmcnt(5)
v_exp_f32 v88, v88
v_mfma_f32_16x16x32_bf16 v[64:67], v[140:143], v[40:43], v[64:67]
ds_read_b128 v[36:39], v11 offset:13312
buffer_load_dwordx4 v0, s[4:7], s39 offen offset:3072 sc1 lds
v_mfma_f32_16x16x32_bf16 v[68:71], v[204:207], v[40:43], v[68:71]
v_exp_f32 v89, v89
v_mfma_f32_16x16x32_bf16 v[72:75], v[140:143], v[44:47], v[72:75]
ds_read_b128 v[40:43], v11 offset:14336
v_mfma_f32_16x16x32_bf16 v[76:79], v[204:207], v[44:47], v[76:79]
s_waitcnt lgkmcnt(5)
buffer_store_dwordx4 v[84:87], v7, s[4:7], s58 offen offset:1024 sc1
v_mfma_f32_16x16x32_bf16 v[64:67], v[144:147], v[16:19], v[64:67]
ds_read_b128 v[44:47], v11 offset:15360
v_mfma_f32_16x16x32_bf16 v[68:71], v[208:211], v[16:19], v[68:71]
v_exp_f32 v90, v90
v_mfma_f32_16x16x32_bf16 v[72:75], v[144:147], v[20:23], v[72:75]
ds_read_b128 v[16:19], v11 offset:16384
v_mfma_f32_16x16x32_bf16 v[76:79], v[208:211], v[20:23], v[76:79]
s_waitcnt lgkmcnt(5)
v_exp_f32 v91, v91
v_mfma_f32_16x16x32_bf16 v[64:67], v[148:151], v[24:27], v[64:67]
s_add_u32 m0, s50, 16384
ds_read_b128 v[20:23], v11 offset:17408
s_add_u32 s39, s45, 16384
v_mfma_f32_16x16x32_bf16 v[68:71], v[212:215], v[24:27], v[68:71]
buffer_load_dwordx4 v0, s[4:7], s39 offen offset:1024 sc1 lds
v_mul_f32 v108, v52, v60
v_mfma_f32_16x16x32_bf16 v[72:75], v[148:151], v[28:31], v[72:75]
ds_read_b128 v[24:27], v11 offset:18432
v_mul_f32 v109, v53, v61
v_mfma_f32_16x16x32_bf16 v[76:79], v[212:215], v[28:31], v[76:79]
s_waitcnt lgkmcnt(5)
v_mul_f32 v110, v54, v62
v_mul_f32 v111, v55, v63
v_mfma_f32_16x16x32_bf16 v[64:67], v[152:155], v[32:35], v[64:67]
ds_read_b128 v[28:31], v11 offset:19456
v_add_f32 v88, 1.0, v88
v_mfma_f32_16x16x32_bf16 v[68:71], v[216:219], v[32:35], v[68:71]
v_add_f32 v89, 1.0, v89
v_add_f32 v90, 1.0, v90
v_mfma_f32_16x16x32_bf16 v[72:75], v[152:155], v[36:39], v[72:75]
ds_read_b128 v[32:35], v11 offset:20480
v_add_f32 v91, 1.0, v91
v_mfma_f32_16x16x32_bf16 v[76:79], v[216:219], v[36:39], v[76:79]
s_waitcnt lgkmcnt(5)
v_rcp_f32 v88, v88
v_mfma_f32_16x16x32_bf16 v[64:67], v[156:159], v[40:43], v[64:67]
ds_read_b128 v[36:39], v11 offset:21504
v_mfma_f32_16x16x32_bf16 v[68:71], v[220:223], v[40:43], v[68:71]
buffer_load_dwordx4 v0, s[4:7], s39 offen offset:3072 sc1 lds
v_mfma_f32_16x16x32_bf16 v[72:75], v[156:159], v[44:47], v[72:75]
ds_read_b128 v[40:43], v11 offset:22528
v_mfma_f32_16x16x32_bf16 v[76:79], v[220:223], v[44:47], v[76:79]
s_waitcnt lgkmcnt(5)
v_rcp_f32 v89, v89
v_mfma_f32_16x16x32_bf16 v[64:67], v[160:163], v[16:19], v[64:67]
ds_read_b128 v[44:47], v11 offset:23552
v_mfma_f32_16x16x32_bf16 v[68:71], v[224:227], v[16:19], v[68:71]
v_rcp_f32 v90, v90
v_mfma_f32_16x16x32_bf16 v[72:75], v[160:163], v[20:23], v[72:75]
ds_read_b128 v[16:19], v11 offset:24576
v_mfma_f32_16x16x32_bf16 v[76:79], v[224:227], v[20:23], v[76:79]
s_waitcnt lgkmcnt(5)
v_rcp_f32 v91, v91
v_mfma_f32_16x16x32_bf16 v[64:67], v[164:167], v[24:27], v[64:67]
ds_read_b128 v[20:23], v11 offset:25600
v_mul_f32 v108, v108, v88
v_mfma_f32_16x16x32_bf16 v[68:71], v[228:231], v[24:27], v[68:71]
s_add_u32 m0, s50, 32768
s_add_u32 s39, s45, 32768
buffer_load_dwordx4 v0, s[4:7], s39 offen offset:1024 sc1 lds
v_mfma_f32_16x16x32_bf16 v[72:75], v[164:167], v[28:31], v[72:75]
ds_read_b128 v[24:27], v11 offset:26624
v_mul_f32 v109, v109, v89
v_mfma_f32_16x16x32_bf16 v[76:79], v[228:231], v[28:31], v[76:79]
s_waitcnt lgkmcnt(5)
v_mul_f32 v110, v110, v90
v_mul_f32 v111, v111, v91
v_mfma_f32_16x16x32_bf16 v[64:67], v[168:171], v[32:35], v[64:67]
ds_read_b128 v[28:31], v11 offset:27648
v_cvt_pk_bf16_f32 v96, v104, v105
v_mfma_f32_16x16x32_bf16 v[68:71], v[232:235], v[32:35], v[68:71]
v_cvt_pk_bf16_f32 v97, v106, v107
v_cvt_pk_bf16_f32 v98, v108, v109
v_mfma_f32_16x16x32_bf16 v[72:75], v[168:171], v[36:39], v[72:75]
ds_read_b128 v[32:35], v11 offset:28672
v_cvt_pk_bf16_f32 v99, v110, v111
v_mfma_f32_16x16x32_bf16 v[76:79], v[232:235], v[36:39], v[76:79]
s_waitcnt lgkmcnt(5)
v_mfma_f32_16x16x32_bf16 v[64:67], v[172:175], v[40:43], v[64:67]
ds_read_b128 v[36:39], v11 offset:29696
v_permlane16_swap_b32 v96, v98
v_mfma_f32_16x16x32_bf16 v[68:71], v[236:239], v[40:43], v[68:71]
buffer_load_dwordx4 v0, s[4:7], s39 offen offset:3072 sc1 lds
v_permlane16_swap_b32 v97, v99
v_mfma_f32_16x16x32_bf16 v[72:75], v[172:175], v[44:47], v[72:75]
ds_read_b128 v[40:43], v11 offset:30720
v_mfma_f32_16x16x32_bf16 v[76:79], v[236:239], v[44:47], v[76:79]
s_waitcnt lgkmcnt(5)
buffer_store_dwordx4 v[96:99], v6, s[4:7], s49 offen sc1
v_mfma_f32_16x16x32_bf16 v[64:67], v[176:179], v[16:19], v[64:67]
s_cmp_ge_u32 s36, 3
ds_read_b128 v[44:47], v11 offset:31744
s_cselect_b32 s58, s62, 0x70000000
v_mfma_f32_16x16x32_bf16 v[68:71], v[240:243], v[16:19], v[68:71]
s_add_u32 s49, s49, 229376
s_add_u32 s62, s62, 65536
s_add_u32 s59, s59, 229376
v_mfma_f32_16x16x32_bf16 v[72:75], v[176:179], v[20:23], v[72:75]
s_add_u32 s36, s36, 1
v_mfma_f32_16x16x32_bf16 v[76:79], v[240:243], v[20:23], v[76:79]
s_waitcnt lgkmcnt(4)
v_mfma_f32_16x16x32_bf16 v[64:67], v[180:183], v[24:27], v[64:67]
v_mfma_f32_16x16x32_bf16 v[68:71], v[244:247], v[24:27], v[68:71]
s_add_u32 m0, s50, 49152
s_add_u32 s39, s45, 49152
buffer_load_dwordx4 v0, s[4:7], s39 offen offset:1024 sc1 lds
s_cmp_eq_u32 s46, 0
s_cbranch_scc1 Lfs_614
s_waitcnt vmcnt(10) lgkmcnt(0)
s_barrier
v_mfma_f32_16x16x32_bf16 v[72:75], v[180:183], v[28:31], v[72:75]
ds_read_b128 v[16:19], v1 offset:0
ds_read_b128 v[20:23], v1 offset:2048
v_mfma_f32_16x16x32_bf16 v[76:79], v[244:247], v[28:31], v[76:79]
ds_read_b128 v[24:27], v1 offset:4096
v_mfma_f32_16x16x32_bf16 v[64:67], v[184:187], v[32:35], v[64:67]
ds_read_b128 v[28:31], v1 offset:6144
v_mfma_f32_16x16x32_bf16 v[68:71], v[248:251], v[32:35], v[68:71]
v_mfma_f32_16x16x32_bf16 v[72:75], v[184:187], v[36:39], v[72:75]
ds_read_b128 v[32:35], v1 offset:8192
v_mfma_f32_16x16x32_bf16 v[76:79], v[248:251], v[36:39], v[76:79]
buffer_load_dwordx4 v0, s[4:7], s39 offen offset:3072 sc1 lds
v_mfma_f32_16x16x32_bf16 v[64:67], v[188:191], v[40:43], v[64:67]
ds_read_b128 v[36:39], v1 offset:10240
v_mfma_f32_16x16x32_bf16 v[68:71], v[252:255], v[40:43], v[68:71]
v_mfma_f32_16x16x32_bf16 v[72:75], v[188:191], v[44:47], v[72:75]
ds_read_b128 v[40:43], v1 offset:12288
v_mfma_f32_16x16x32_bf16 v[76:79], v[252:255], v[44:47], v[76:79]
s_branch Lfb_610
Lfs_614:
s_waitcnt lgkmcnt(0)
v_mfma_f32_16x16x32_bf16 v[72:75], v[180:183], v[28:31], v[72:75]
v_mfma_f32_16x16x32_bf16 v[76:79], v[244:247], v[28:31], v[76:79]
s_waitcnt lgkmcnt(2)
v_mfma_f32_16x16x32_bf16 v[64:67], v[184:187], v[32:35], v[64:67]
v_mfma_f32_16x16x32_bf16 v[68:71], v[248:251], v[32:35], v[68:71]
v_mfma_f32_16x16x32_bf16 v[72:75], v[184:187], v[36:39], v[72:75]
v_mfma_f32_16x16x32_bf16 v[76:79], v[248:251], v[36:39], v[76:79]
s_waitcnt lgkmcnt(0)
v_mfma_f32_16x16x32_bf16 v[64:67], v[188:191], v[40:43], v[64:67]
v_mfma_f32_16x16x32_bf16 v[68:71], v[252:255], v[40:43], v[68:71]
v_mfma_f32_16x16x32_bf16 v[72:75], v[188:191], v[44:47], v[72:75]
v_mfma_f32_16x16x32_bf16 v[76:79], v[252:255], v[44:47], v[76:79]
s_nop 7
v_cvt_pk_bf16_f32 v80, v64, v65
v_cvt_pk_bf16_f32 v81, v66, v67
v_cvt_pk_bf16_f32 v82, v68, v69
v_cvt_pk_bf16_f32 v83, v70, v71
v_cvt_pk_bf16_f32 v84, v72, v73
v_cvt_pk_bf16_f32 v85, v74, v75
v_cvt_pk_bf16_f32 v86, v76, v77
v_cvt_pk_bf16_f32 v87, v78, v79
s_cmp_eq_u32 s36, 64
s_cbranch_scc1 Lfz_615
buffer_store_dwordx4 v[80:83], v7, s[4:7], s58 offen offset:0 sc1
buffer_store_dwordx4 v[84:87], v7, s[4:7], s58 offen offset:1024 sc1
s_branch Lfw_611
Lfl_612:
Lbw_618:
buffer_load_dword v13, v12, s[4:7], s61 offen sc1
s_waitcnt vmcnt(0)
v_cmp_gt_u32 vcc, s57, v13
s_cbranch_vccz Lbo_619
s_sub_u32 s37, s37, 1
s_cbranch_scc1 Lend_7
s_sleep 2
s_branch Lbw_618
Lbo_619:
s_add_u32 m0, s60, 131072
s_add_u32 s39, s59, 0
buffer_load_dwordx4 v0, s[4:7], s39 offen offset:0 sc1 lds
buffer_load_dwordx4 v0, s[4:7], s39 offen offset:1024 sc1 lds
buffer_load_dwordx4 v0, s[4:7], s39 offen offset:2048 sc1 lds
buffer_load_dwordx4 v0, s[4:7], s39 offen offset:3072 sc1 lds
s_add_u32 m0, s60, 147456
s_add_u32 s39, s59, 16384
buffer_load_dwordx4 v0, s[4:7], s39 offen offset:0 sc1 lds
buffer_load_dwordx4 v0, s[4:7], s39 offen offset:1024 sc1 lds
buffer_load_dwordx4 v0, s[4:7], s39 offen offset:2048 sc1 lds
buffer_load_dwordx4 v0, s[4:7], s39 offen offset:3072 sc1 lds
s_waitcnt vmcnt(0) lgkmcnt(0)
s_branch Lfg_613
Lfz_615:
s_mov_b32 s57, 63
s_waitcnt vmcnt(0)
v_cmp_gt_u32 vcc, s57, v13
s_barrier
v_min_u32 v100, s36, 64
s_sub_u32 s38, s36, 4
v_max_i32 v101, s38, 0
buffer_store_dwordx2 v[100:101], v4, s[4:7], 0 offen sc1
s_cbranch_vccz Lfh_620
Lbw_623:
buffer_load_dword v13, v12, s[4:7], s61 offen sc1
s_waitcnt vmcnt(0)
v_cmp_gt_u32 vcc, s57, v13
s_cbranch_vccz Lbo_624
s_sub_u32 s37, s37, 1
s_cbranch_scc1 Lend_7
s_sleep 1
s_branch Lbw_623
Lbo_624:
Lfh_620:
s_add_u32 s55, s59, 0
s_add_u32 m0, s60, 65536
s_add_u32 s39, s55, 0
buffer_load_dwordx4 v0, s[4:7], s39 offen offset:0 sc1 lds
buffer_load_dwordx4 v0, s[4:7], s39 offen offset:1024 sc1 lds
buffer_load_dwordx4 v0, s[4:7], s39 offen offset:2048 sc1 lds
buffer_load_dwordx4 v0, s[4:7], s39 offen offset:3072 sc1 lds
s_add_u32 m0, s60, 81920
s_add_u32 s39, s55, 16384
buffer_load_dwordx4 v0, s[4:7], s39 offen offset:0 sc1 lds
buffer_load_dwordx4 v0, s[4:7], s39 offen offset:1024 sc1 lds
buffer_load_dwordx4 v0, s[4:7], s39 offen offset:2048 sc1 lds
buffer_load_dwordx4 v0, s[4:7], s39 offen offset:3072 sc1 lds
s_add_u32 s55, s59, 229376
s_add_u32 m0, s60, 98304
s_add_u32 s39, s55, 0
buffer_load_dwordx4 v0, s[4:7], s39 offen offset:0 sc1 lds
buffer_load_dwordx4 v0, s[4:7], s39 offen offset:1024 sc1 lds
buffer_load_dwordx4 v0, s[4:7], s39 offen offset:2048 sc1 lds
buffer_load_dwordx4 v0, s[4:7], s39 offen offset:3072 sc1 lds
s_add_u32 m0, s60, 114688
s_add_u32 s39, s55, 16384
buffer_load_dwordx4 v0, s[4:7], s39 offen offset:0 sc1 lds
buffer_load_dwordx4 v0, s[4:7], s39 offen offset:1024 sc1 lds
buffer_load_dwordx4 v0, s[4:7], s39 offen offset:2048 sc1 lds
buffer_load_dwordx4 v0, s[4:7], s39 offen offset:3072 sc1 lds
buffer_store_dwordx4 v[80:83], v7, s[4:7], s58 offen offset:0 sc1
buffer_store_dwordx4 v[84:87], v7, s[4:7], s58 offen offset:1024 sc1
s_add_u32 s55, s59, 458752
s_mov_b32 s57, 64
v_add_u32 v11, -0x10000, v11
s_waitcnt vmcnt(10)
s_barrier
ds_read_b128 v[16:19], v11 offset:0
ds_read_b128 v[20:23], v11 offset:1024
ds_read_b128 v[24:27], v11 offset:2048
ds_read_b128 v[28:31], v11 offset:3072
ds_read_b128 v[32:35], v11 offset:4096
ds_read_b128 v[36:39], v11 offset:5120
ds_read_b128 v[40:43], v11 offset:6144
s_waitcnt lgkmcnt(5)
v_mfma_f32_16x16x32_bf16 v[64:67], v[128:131], v[16:19], 0
ds_read_b128 v[44:47], v11 offset:7168
v_mfma_f32_16x16x32_bf16 v[68:71], v[192:195], v[16:19], 0
v_mfma_f32_16x16x32_bf16 v[72:75], v[128:131], v[20:23], 0
ds_read_b128 v[16:19], v11 offset:8192
v_mfma_f32_16x16x32_bf16 v[76:79], v[192:195], v[20:23], 0
s_waitcnt lgkmcnt(5)
v_mfma_f32_16x16x32_bf16 v[64:67], v[132:135], v[24:27], v[64:67]
ds_read_b128 v[20:23], v11 offset:9216
v_mfma_f32_16x16x32_bf16 v[68:71], v[196:199], v[24:27], v[68:71]
v_mfma_f32_16x16x32_bf16 v[72:75], v[132:135], v[28:31], v[72:75]
ds_read_b128 v[24:27], v11 offset:10240
v_mfma_f32_16x16x32_bf16 v[76:79], v[196:199], v[28:31], v[76:79]
s_waitcnt lgkmcnt(5)
v_mfma_f32_16x16x32_bf16 v[64:67], v[136:139], v[32:35], v[64:67]
ds_read_b128 v[28:31], v11 offset:11264
v_mfma_f32_16x16x32_bf16 v[68:71], v[200:203], v[32:35], v[68:71]
v_mfma_f32_16x16x32_bf16 v[72:75], v[136:139], v[36:39], v[72:75]
ds_read_b128 v[32:35], v11 offset:12288
v_mfma_f32_16x16x32_bf16 v[76:79], v[200:203], v[36:39], v[76:79]
s_waitcnt lgkmcnt(5)
v_mfma_f32_16x16x32_bf16 v[64:67], v[140:143], v[40:43], v[64:67]
ds_read_b128 v[36:39], v11 offset:13312
v_mfma_f32_16x16x32_bf16 v[68:71], v[204:207], v[40:43], v[68:71]
v_mfma_f32_16x16x32_bf16 v[72:75], v[140:143], v[44:47], v[72:75]
ds_read_b128 v[40:43], v11 offset:14336
v_mfma_f32_16x16x32_bf16 v[76:79], v[204:207], v[44:47], v[76:79]
s_waitcnt lgkmcnt(5)
v_mfma_f32_16x16x32_bf16 v[64:67], v[144:147], v[16:19], v[64:67]
ds_read_b128 v[44:47], v11 offset:15360
v_mfma_f32_16x16x32_bf16 v[68:71], v[208:211], v[16:19], v[68:71]
v_mfma_f32_16x16x32_bf16 v[72:75], v[144:147], v[20:23], v[72:75]
ds_read_b128 v[16:19], v11 offset:16384
v_mfma_f32_16x16x32_bf16 v[76:79], v[208:211], v[20:23], v[76:79]
s_waitcnt lgkmcnt(5)
v_mfma_f32_16x16x32_bf16 v[64:67], v[148:151], v[24:27], v[64:67]
ds_read_b128 v[20:23], v11 offset:17408
v_mfma_f32_16x16x32_bf16 v[68:71], v[212:215], v[24:27], v[68:71]
v_mfma_f32_16x16x32_bf16 v[72:75], v[148:151], v[28:31], v[72:75]
ds_read_b128 v[24:27], v11 offset:18432
v_mfma_f32_16x16x32_bf16 v[76:79], v[212:215], v[28:31], v[76:79]
s_waitcnt lgkmcnt(5)
v_mfma_f32_16x16x32_bf16 v[64:67], v[152:155], v[32:35], v[64:67]
ds_read_b128 v[28:31], v11 offset:19456
buffer_load_dword v13, v12, s[4:7], s61 offen sc1
v_mfma_f32_16x16x32_bf16 v[68:71], v[216:219], v[32:35], v[68:71]
v_mfma_f32_16x16x32_bf16 v[72:75], v[152:155], v[36:39], v[72:75]
ds_read_b128 v[32:35], v11 offset:20480
v_mfma_f32_16x16x32_bf16 v[76:79], v[216:219], v[36:39], v[76:79]
s_waitcnt lgkmcnt(5)
v_mfma_f32_16x16x32_bf16 v[64:67], v[156:159], v[40:43], v[64:67]
ds_read_b128 v[36:39], v11 offset:21504
v_mfma_f32_16x16x32_bf16 v[68:71], v[220:223], v[40:43], v[68:71]
v_mfma_f32_16x16x32_bf16 v[72:75], v[156:159], v[44:47], v[72:75]
ds_read_b128 v[40:43], v11 offset:22528
v_mfma_f32_16x16x32_bf16 v[76:79], v[220:223], v[44:47], v[76:79]
s_waitcnt lgkmcnt(5)
v_mfma_f32_16x16x32_bf16 v[64:67], v[160:163], v[16:19], v[64:67]
ds_read_b128 v[44:47], v11 offset:23552
v_mfma_f32_16x16x32_bf16 v[68:71], v[224:227], v[16:19], v[68:71]
v_mfma_f32_16x16x32_bf16 v[72:75], v[160:163], v[20:23], v[72:75]
ds_read_b128 v[16:19], v11 offset:24576
v_mfma_f32_16x16x32_bf16 v[76:79], v[224:227], v[20:23], v[76:79]
s_waitcnt lgkmcnt(5)
v_mfma_f32_16x16x32_bf16 v[64:67], v[164:167], v[24:27], v[64:67]
ds_read_b128 v[20:23], v11 offset:25600
v_mfma_f32_16x16x32_bf16 v[68:71], v[228:231], v[24:27], v[68:71]
v_mfma_f32_16x16x32_bf16 v[72:75], v[164:167], v[28:31], v[72:75]
ds_read_b128 v[24:27], v11 offset:26624
v_mfma_f32_16x16x32_bf16 v[76:79], v[228:231], v[28:31], v[76:79]
s_waitcnt lgkmcnt(5)
v_mfma_f32_16x16x32_bf16 v[64:67], v[168:171], v[32:35], v[64:67]
ds_read_b128 v[28:31], v11 offset:27648
v_mfma_f32_16x16x32_bf16 v[68:71], v[232:235], v[32:35], v[68:71]
v_mfma_f32_16x16x32_bf16 v[72:75], v[168:171], v[36:39], v[72:75]
ds_read_b128 v[32:35], v11 offset:28672
v_mfma_f32_16x16x32_bf16 v[76:79], v[232:235], v[36:39], v[76:79]
s_waitcnt lgkmcnt(5)
v_mfma_f32_16x16x32_bf16 v[64:67], v[172:175], v[40:43], v[64:67]
ds_read_b128 v[36:39], v11 offset:29696
v_mfma_f32_16x16x32_bf16 v[68:71], v[236:239], v[40:43], v[68:71]
v_mfma_f32_16x16x32_bf16 v[72:75], v[172:175], v[44:47], v[72:75]
ds_read_b128 v[40:43], v11 offset:30720
v_mfma_f32_16x16x32_bf16 v[76:79], v[236:239], v[44:47], v[76:79]
s_waitcnt lgkmcnt(5)
v_mfma_f32_16x16x32_bf16 v[64:67], v[176:179], v[16:19], v[64:67]
ds_read_b128 v[44:47], v11 offset:31744
v_mfma_f32_16x16x32_bf16 v[68:71], v[240:243], v[16:19], v[68:71]
v_mfma_f32_16x16x32_bf16 v[72:75], v[176:179], v[20:23], v[72:75]
v_mfma_f32_16x16x32_bf16 v[76:79], v[240:243], v[20:23], v[76:79]
s_waitcnt lgkmcnt(4)
v_mfma_f32_16x16x32_bf16 v[64:67], v[180:183], v[24:27], v[64:67]
v_mfma_f32_16x16x32_bf16 v[68:71], v[244:247], v[24:27], v[68:71]
v_mfma_f32_16x16x32_bf16 v[72:75], v[180:183], v[28:31], v[72:75]
v_mfma_f32_16x16x32_bf16 v[76:79], v[244:247], v[28:31], v[76:79]
s_waitcnt lgkmcnt(2)
v_mfma_f32_16x16x32_bf16 v[64:67], v[184:187], v[32:35], v[64:67]
v_mfma_f32_16x16x32_bf16 v[68:71], v[248:251], v[32:35], v[68:71]
v_mfma_f32_16x16x32_bf16 v[72:75], v[184:187], v[36:39], v[72:75]
v_mfma_f32_16x16x32_bf16 v[76:79], v[248:251], v[36:39], v[76:79]
s_waitcnt lgkmcnt(0)
v_mfma_f32_16x16x32_bf16 v[64:67], v[188:191], v[40:43], v[64:67]
v_mfma_f32_16x16x32_bf16 v[68:71], v[252:255], v[40:43], v[68:71]
v_mfma_f32_16x16x32_bf16 v[72:75], v[188:191], v[44:47], v[72:75]
v_mfma_f32_16x16x32_bf16 v[76:79], v[252:255], v[44:47], v[76:79]
s_cmp_ge_u32 s36, 3
s_cselect_b32 s58, s62, 0x70000000
s_add_u32 s49, s49, 229376
s_add_u32 s62, s62, 65536
s_add_u32 s59, s59, 229376
s_add_u32 s36, s36, 1
v_add_u32 v11, 0x8000, v11
s_nop 0
v_cvt_pk_bf16_f32 v80, v64, v65
v_cvt_pk_bf16_f32 v81, v66, v67
v_cvt_pk_bf16_f32 v82, v68, v69
v_cvt_pk_bf16_f32 v83, v70, v71
v_cvt_pk_bf16_f32 v84, v72, v73
v_cvt_pk_bf16_f32 v85, v74, v75
v_cvt_pk_bf16_f32 v86, v76, v77
v_cvt_pk_bf16_f32 v87, v78, v79
s_waitcnt vmcnt(0)
v_cmp_gt_u32 vcc, s57, v13
s_mov_b32 s56, 0
s_cbranch_vccnz Lfn_621
s_mov_b32 s56, 1
s_add_u32 m0, s60, 131072
s_add_u32 s39, s55, 0
buffer_load_dwordx4 v0, s[4:7], s39 offen offset:0 sc1 lds
buffer_load_dwordx4 v0, s[4:7], s39 offen offset:1024 sc1 lds
buffer_load_dwordx4 v0, s[4:7], s39 offen offset:2048 sc1 lds
buffer_load_dwordx4 v0, s[4:7], s39 offen offset:3072 sc1 lds
s_add_u32 m0, s60, 147456
s_add_u32 s39, s55, 16384
buffer_load_dwordx4 v0, s[4:7], s39 offen offset:0 sc1 lds
buffer_load_dwordx4 v0, s[4:7], s39 offen offset:1024 sc1 lds
buffer_load_dwordx4 v0, s[4:7], s39 offen offset:2048 sc1 lds
buffer_load_dwordx4 v0, s[4:7], s39 offen offset:3072 sc1 lds
Lfn_621:
buffer_store_dwordx4 v[80:83], v7, s[4:7], s58 offen offset:0 sc1
buffer_store_dwordx4 v[84:87], v7, s[4:7], s58 offen offset:1024 sc1
s_barrier
ds_read_b128 v[16:19], v11 offset:0
ds_read_b128 v[20:23], v11 offset:1024
ds_read_b128 v[24:27], v11 offset:2048
ds_read_b128 v[28:31], v11 offset:3072
ds_read_b128 v[32:35], v11 offset:4096
ds_read_b128 v[36:39], v11 offset:5120
ds_read_b128 v[40:43], v11 offset:6144
s_waitcnt lgkmcnt(5)
v_mfma_f32_16x16x32_bf16 v[64:67], v[128:131], v[16:19], 0
ds_read_b128 v[44:47], v11 offset:7168
v_mfma_f32_16x16x32_bf16 v[68:71], v[192:195], v[16:19], 0
v_mfma_f32_16x16x32_bf16 v[72:75], v[128:131], v[20:23], 0
ds_read_b128 v[16:19], v11 offset:8192
v_mfma_f32_16x16x32_bf16 v[76:79], v[192:195], v[20:23], 0
s_waitcnt lgkmcnt(5)
v_mfma_f32_16x16x32_bf16 v[64:67], v[132:135], v[24:27], v[64:67]
ds_read_b128 v[20:23], v11 offset:9216
v_mfma_f32_16x16x32_bf16 v[68:71], v[196:199], v[24:27], v[68:71]
v_mfma_f32_16x16x32_bf16 v[72:75], v[132:135], v[28:31], v[72:75]
ds_read_b128 v[24:27], v11 offset:10240
v_mfma_f32_16x16x32_bf16 v[76:79], v[196:199], v[28:31], v[76:79]
s_waitcnt lgkmcnt(5)
v_mfma_f32_16x16x32_bf16 v[64:67], v[136:139], v[32:35], v[64:67]
ds_read_b128 v[28:31], v11 offset:11264
v_mfma_f32_16x16x32_bf16 v[68:71], v[200:203], v[32:35], v[68:71]
v_mfma_f32_16x16x32_bf16 v[72:75], v[136:139], v[36:39], v[72:75]
ds_read_b128 v[32:35], v11 offset:12288
v_mfma_f32_16x16x32_bf16 v[76:79], v[200:203], v[36:39], v[76:79]
s_waitcnt lgkmcnt(5)
v_mfma_f32_16x16x32_bf16 v[64:67], v[140:143], v[40:43], v[64:67]
ds_read_b128 v[36:39], v11 offset:13312
v_mfma_f32_16x16x32_bf16 v[68:71], v[204:207], v[40:43], v[68:71]
v_mfma_f32_16x16x32_bf16 v[72:75], v[140:143], v[44:47], v[72:75]
ds_read_b128 v[40:43], v11 offset:14336
v_mfma_f32_16x16x32_bf16 v[76:79], v[204:207], v[44:47], v[76:79]
s_waitcnt lgkmcnt(5)
v_mfma_f32_16x16x32_bf16 v[64:67], v[144:147], v[16:19], v[64:67]
ds_read_b128 v[44:47], v11 offset:15360
v_mfma_f32_16x16x32_bf16 v[68:71], v[208:211], v[16:19], v[68:71]
v_mfma_f32_16x16x32_bf16 v[72:75], v[144:147], v[20:23], v[72:75]
ds_read_b128 v[16:19], v11 offset:16384
v_mfma_f32_16x16x32_bf16 v[76:79], v[208:211], v[20:23], v[76:79]
s_waitcnt lgkmcnt(5)
v_mfma_f32_16x16x32_bf16 v[64:67], v[148:151], v[24:27], v[64:67]
ds_read_b128 v[20:23], v11 offset:17408
v_mfma_f32_16x16x32_bf16 v[68:71], v[212:215], v[24:27], v[68:71]
v_mfma_f32_16x16x32_bf16 v[72:75], v[148:151], v[28:31], v[72:75]
ds_read_b128 v[24:27], v11 offset:18432
v_mfma_f32_16x16x32_bf16 v[76:79], v[212:215], v[28:31], v[76:79]
s_waitcnt lgkmcnt(5)
v_mfma_f32_16x16x32_bf16 v[64:67], v[152:155], v[32:35], v[64:67]
ds_read_b128 v[28:31], v11 offset:19456
v_mfma_f32_16x16x32_bf16 v[68:71], v[216:219], v[32:35], v[68:71]
v_mfma_f32_16x16x32_bf16 v[72:75], v[152:155], v[36:39], v[72:75]
ds_read_b128 v[32:35], v11 offset:20480
v_mfma_f32_16x16x32_bf16 v[76:79], v[216:219], v[36:39], v[76:79]
s_waitcnt lgkmcnt(5)
v_mfma_f32_16x16x32_bf16 v[64:67], v[156:159], v[40:43], v[64:67]
ds_read_b128 v[36:39], v11 offset:21504
v_mfma_f32_16x16x32_bf16 v[68:71], v[220:223], v[40:43], v[68:71]
v_mfma_f32_16x16x32_bf16 v[72:75], v[156:159], v[44:47], v[72:75]
ds_read_b128 v[40:43], v11 offset:22528
v_mfma_f32_16x16x32_bf16 v[76:79], v[220:223], v[44:47], v[76:79]
s_waitcnt lgkmcnt(5)
v_mfma_f32_16x16x32_bf16 v[64:67], v[160:163], v[16:19], v[64:67]
ds_read_b128 v[44:47], v11 offset:23552
v_mfma_f32_16x16x32_bf16 v[68:71], v[224:227], v[16:19], v[68:71]
v_mfma_f32_16x16x32_bf16 v[72:75], v[160:163], v[20:23], v[72:75]
ds_read_b128 v[16:19], v11 offset:24576
v_mfma_f32_16x16x32_bf16 v[76:79], v[224:227], v[20:23], v[76:79]
s_waitcnt lgkmcnt(5)
v_mfma_f32_16x16x32_bf16 v[64:67], v[164:167], v[24:27], v[64:67]
ds_read_b128 v[20:23], v11 offset:25600
v_mfma_f32_16x16x32_bf16 v[68:71], v[228:231], v[24:27], v[68:71]
v_mfma_f32_16x16x32_bf16 v[72:75], v[164:167], v[28:31], v[72:75]
ds_read_b128 v[24:27], v11 offset:26624
v_mfma_f32_16x16x32_bf16 v[76:79], v[228:231], v[28:31], v[76:79]
s_waitcnt lgkmcnt(5)
v_mfma_f32_16x16x32_bf16 v[64:67], v[168:171], v[32:35], v[64:67]
ds_read_b128 v[28:31], v11 offset:27648
v_mfma_f32_16x16x32_bf16 v[68:71], v[232:235], v[32:35], v[68:71]
v_mfma_f32_16x16x32_bf16 v[72:75], v[168:171], v[36:39], v[72:75]
ds_read_b128 v[32:35], v11 offset:28672
v_mfma_f32_16x16x32_bf16 v[76:79], v[232:235], v[36:39], v[76:79]
s_waitcnt lgkmcnt(5)
v_mfma_f32_16x16x32_bf16 v[64:67], v[172:175], v[40:43], v[64:67]
ds_read_b128 v[36:39], v11 offset:29696
v_mfma_f32_16x16x32_bf16 v[68:71], v[236:239], v[40:43], v[68:71]
v_mfma_f32_16x16x32_bf16 v[72:75], v[172:175], v[44:47], v[72:75]
ds_read_b128 v[40:43], v11 offset:30720
v_mfma_f32_16x16x32_bf16 v[76:79], v[236:239], v[44:47], v[76:79]
s_waitcnt lgkmcnt(5)
v_mfma_f32_16x16x32_bf16 v[64:67], v[176:179], v[16:19], v[64:67]
ds_read_b128 v[44:47], v11 offset:31744
v_mfma_f32_16x16x32_bf16 v[68:71], v[240:243], v[16:19], v[68:71]
v_mfma_f32_16x16x32_bf16 v[72:75], v[176:179], v[20:23], v[72:75]
v_mfma_f32_16x16x32_bf16 v[76:79], v[240:243], v[20:23], v[76:79]
s_waitcnt lgkmcnt(4)
v_mfma_f32_16x16x32_bf16 v[64:67], v[180:183], v[24:27], v[64:67]
v_mfma_f32_16x16x32_bf16 v[68:71], v[244:247], v[24:27], v[68:71]
v_mfma_f32_16x16x32_bf16 v[72:75], v[180:183], v[28:31], v[72:75]
v_mfma_f32_16x16x32_bf16 v[76:79], v[244:247], v[28:31], v[76:79]
s_waitcnt lgkmcnt(2)
v_mfma_f32_16x16x32_bf16 v[64:67], v[184:187], v[32:35], v[64:67]
v_mfma_f32_16x16x32_bf16 v[68:71], v[248:251], v[32:35], v[68:71]
v_mfma_f32_16x16x32_bf16 v[72:75], v[184:187], v[36:39], v[72:75]
v_mfma_f32_16x16x32_bf16 v[76:79], v[248:251], v[36:39], v[76:79]
s_waitcnt lgkmcnt(0)
v_mfma_f32_16x16x32_bf16 v[64:67], v[188:191], v[40:43], v[64:67]
v_mfma_f32_16x16x32_bf16 v[68:71], v[252:255], v[40:43], v[68:71]
v_mfma_f32_16x16x32_bf16 v[72:75], v[188:191], v[44:47], v[72:75]
v_mfma_f32_16x16x32_bf16 v[76:79], v[252:255], v[44:47], v[76:79]
s_cmp_ge_u32 s36, 3
s_cselect_b32 s58, s62, 0x70000000
s_add_u32 s49, s49, 229376
s_add_u32 s62, s62, 65536
s_add_u32 s59, s59, 229376
s_add_u32 s36, s36, 1
v_add_u32 v11, 0x8000, v11
s_nop 0
v_cvt_pk_bf16_f32 v80, v64, v65
v_cvt_pk_bf16_f32 v81, v66, v67
v_cvt_pk_bf16_f32 v82, v68, v69
v_cvt_pk_bf16_f32 v83, v70, v71
v_cvt_pk_bf16_f32 v84, v72, v73
v_cvt_pk_bf16_f32 v85, v74, v75
v_cvt_pk_bf16_f32 v86, v76, v77
v_cvt_pk_bf16_f32 v87, v78, v79
s_cmp_lg_u32 s56, 0
s_cbranch_scc1 Lfy_622
Lbw_625:
buffer_load_dword v13, v12, s[4:7], s61 offen sc1
s_waitcnt vmcnt(0)
v_cmp_gt_u32 vcc, s57, v13
s_cbranch_vccz Lbo_626
s_sub_u32 s37, s37, 1
s_cbranch_scc1 Lend_7
s_sleep 1
s_branch Lbw_625
Lbo_626:
s_add_u32 m0, s60, 131072
s_add_u32 s39, s55, 0
buffer_load_dwordx4 v0, s[4:7], s39 offen offset:0 sc1 lds
buffer_load_dwordx4 v0, s[4:7], s39 offen offset:1024 sc1 lds
buffer_load_dwordx4 v0, s[4:7], s39 offen offset:2048 sc1 lds
buffer_load_dwordx4 v0, s[4:7], s39 offen offset:3072 sc1 lds
s_add_u32 m0, s60, 147456
s_add_u32 s39, s55, 16384
buffer_load_dwordx4 v0, s[4:7], s39 offen offset:0 sc1 lds
buffer_load_dwordx4 v0, s[4:7], s39 offen offset:1024 sc1 lds
buffer_load_dwordx4 v0, s[4:7], s39 offen offset:2048 sc1 lds
buffer_load_dwordx4 v0, s[4:7], s39 offen offset:3072 sc1 lds
Lfy_622:
buffer_store_dwordx4 v[80:83], v7, s[4:7], s58 offen offset:0 sc1
buffer_store_dwordx4 v[84:87], v7, s[4:7], s58 offen offset:1024 sc1
s_waitcnt vmcnt(2)
s_barrier
ds_read_b128 v[16:19], v11 offset:0
ds_read_b128 v[20:23], v11 offset:1024
ds_read_b128 v[24:27], v11 offset:2048
ds_read_b128 v[28:31], v11 offset:3072
ds_read_b128 v[32:35], v11 offset:4096
ds_read_b128 v[36:39], v11 offset:5120
ds_read_b128 v[40:43], v11 offset:6144
s_waitcnt lgkmcnt(5)
v_mfma_f32_16x16x32_bf16 v[64:67], v[128:131], v[16:19], 0
ds_read_b128 v[44:47], v11 offset:7168
v_mfma_f32_16x16x32_bf16 v[68:71], v[192:195], v[16:19], 0
v_mfma_f32_16x16x32_bf16 v[72:75], v[128:131], v[20:23], 0
ds_read_b128 v[16:19], v11 offset:8192
v_mfma_f32_16x16x32_bf16 v[76:79], v[192:195], v[20:23], 0
s_waitcnt lgkmcnt(5)
v_mfma_f32_16x16x32_bf16 v[64:67], v[132:135], v[24:27], v[64:67]
ds_read_b128 v[20:23], v11 offset:9216
v_mfma_f32_16x16x32_bf16 v[68:71], v[196:199], v[24:27], v[68:71]
v_mfma_f32_16x16x32_bf16 v[72:75], v[132:135], v[28:31], v[72:75]
ds_read_b128 v[24:27], v11 offset:10240
v_mfma_f32_16x16x32_bf16 v[76:79], v[196:199], v[28:31], v[76:79]
s_waitcnt lgkmcnt(5)
v_mfma_f32_16x16x32_bf16 v[64:67], v[136:139], v[32:35], v[64:67]
ds_read_b128 v[28:31], v11 offset:11264
v_mfma_f32_16x16x32_bf16 v[68:71], v[200:203], v[32:35], v[68:71]
v_mfma_f32_16x16x32_bf16 v[72:75], v[136:139], v[36:39], v[72:75]
ds_read_b128 v[32:35], v11 offset:12288
v_mfma_f32_16x16x32_bf16 v[76:79], v[200:203], v[36:39], v[76:79]
s_waitcnt lgkmcnt(5)
v_mfma_f32_16x16x32_bf16 v[64:67], v[140:143], v[40:43], v[64:67]
ds_read_b128 v[36:39], v11 offset:13312
v_mfma_f32_16x16x32_bf16 v[68:71], v[204:207], v[40:43], v[68:71]
v_mfma_f32_16x16x32_bf16 v[72:75], v[140:143], v[44:47], v[72:75]
ds_read_b128 v[40:43], v11 offset:14336
v_mfma_f32_16x16x32_bf16 v[76:79], v[204:207], v[44:47], v[76:79]
s_waitcnt lgkmcnt(5)
v_mfma_f32_16x16x32_bf16 v[64:67], v[144:147], v[16:19], v[64:67]
ds_read_b128 v[44:47], v11 offset:15360
v_mfma_f32_16x16x32_bf16 v[68:71], v[208:211], v[16:19], v[68:71]
v_mfma_f32_16x16x32_bf16 v[72:75], v[144:147], v[20:23], v[72:75]
ds_read_b128 v[16:19], v11 offset:16384
v_mfma_f32_16x16x32_bf16 v[76:79], v[208:211], v[20:23], v[76:79]
s_waitcnt lgkmcnt(5)
v_mfma_f32_16x16x32_bf16 v[64:67], v[148:151], v[24:27], v[64:67]
ds_read_b128 v[20:23], v11 offset:17408
v_mfma_f32_16x16x32_bf16 v[68:71], v[212:215], v[24:27], v[68:71]
v_mfma_f32_16x16x32_bf16 v[72:75], v[148:151], v[28:31], v[72:75]
ds_read_b128 v[24:27], v11 offset:18432
v_mfma_f32_16x16x32_bf16 v[76:79], v[212:215], v[28:31], v[76:79]
s_waitcnt lgkmcnt(5)
v_mfma_f32_16x16x32_bf16 v[64:67], v[152:155], v[32:35], v[64:67]
ds_read_b128 v[28:31], v11 offset:19456
v_mfma_f32_16x16x32_bf16 v[68:71], v[216:219], v[32:35], v[68:71]
v_mfma_f32_16x16x32_bf16 v[72:75], v[152:155], v[36:39], v[72:75]
ds_read_b128 v[32:35], v11 offset:20480
v_mfma_f32_16x16x32_bf16 v[76:79], v[216:219], v[36:39], v[76:79]
s_waitcnt lgkmcnt(5)
v_mfma_f32_16x16x32_bf16 v[64:67], v[156:159], v[40:43], v[64:67]
ds_read_b128 v[36:39], v11 offset:21504
v_mfma_f32_16x16x32_bf16 v[68:71], v[220:223], v[40:43], v[68:71]
v_mfma_f32_16x16x32_bf16 v[72:75], v[156:159], v[44:47], v[72:75]
ds_read_b128 v[40:43], v11 offset:22528
v_mfma_f32_16x16x32_bf16 v[76:79], v[220:223], v[44:47], v[76:79]
s_waitcnt lgkmcnt(5)
v_mfma_f32_16x16x32_bf16 v[64:67], v[160:163], v[16:19], v[64:67]
ds_read_b128 v[44:47], v11 offset:23552
v_mfma_f32_16x16x32_bf16 v[68:71], v[224:227], v[16:19], v[68:71]
v_mfma_f32_16x16x32_bf16 v[72:75], v[160:163], v[20:23], v[72:75]
ds_read_b128 v[16:19], v11 offset:24576
v_mfma_f32_16x16x32_bf16 v[76:79], v[224:227], v[20:23], v[76:79]
s_waitcnt lgkmcnt(5)
v_mfma_f32_16x16x32_bf16 v[64:67], v[164:167], v[24:27], v[64:67]
ds_read_b128 v[20:23], v11 offset:25600
v_mfma_f32_16x16x32_bf16 v[68:71], v[228:231], v[24:27], v[68:71]
v_mfma_f32_16x16x32_bf16 v[72:75], v[164:167], v[28:31], v[72:75]
ds_read_b128 v[24:27], v11 offset:26624
v_mfma_f32_16x16x32_bf16 v[76:79], v[228:231], v[28:31], v[76:79]
s_waitcnt lgkmcnt(5)
v_mfma_f32_16x16x32_bf16 v[64:67], v[168:171], v[32:35], v[64:67]
ds_read_b128 v[28:31], v11 offset:27648
v_mfma_f32_16x16x32_bf16 v[68:71], v[232:235], v[32:35], v[68:71]
v_mfma_f32_16x16x32_bf16 v[72:75], v[168:171], v[36:39], v[72:75]
ds_read_b128 v[32:35], v11 offset:28672
v_mfma_f32_16x16x32_bf16 v[76:79], v[232:235], v[36:39], v[76:79]
s_waitcnt lgkmcnt(5)
v_mfma_f32_16x16x32_bf16 v[64:67], v[172:175], v[40:43], v[64:67]
ds_read_b128 v[36:39], v11 offset:29696
v_mfma_f32_16x16x32_bf16 v[68:71], v[236:239], v[40:43], v[68:71]
v_mfma_f32_16x16x32_bf16 v[72:75], v[172:175], v[44:47], v[72:75]
ds_read_b128 v[40:43], v11 offset:30720
v_mfma_f32_16x16x32_bf16 v[76:79], v[236:239], v[44:47], v[76:79]
s_waitcnt lgkmcnt(5)
v_mfma_f32_16x16x32_bf16 v[64:67], v[176:179], v[16:19], v[64:67]
ds_read_b128 v[44:47], v11 offset:31744
v_mfma_f32_16x16x32_bf16 v[68:71], v[240:243], v[16:19], v[68:71]
v_mfma_f32_16x16x32_bf16 v[72:75], v[176:179], v[20:23], v[72:75]
v_mfma_f32_16x16x32_bf16 v[76:79], v[240:243], v[20:23], v[76:79]
s_waitcnt lgkmcnt(4)
v_mfma_f32_16x16x32_bf16 v[64:67], v[180:183], v[24:27], v[64:67]
v_mfma_f32_16x16x32_bf16 v[68:71], v[244:247], v[24:27], v[68:71]
v_mfma_f32_16x16x32_bf16 v[72:75], v[180:183], v[28:31], v[72:75]
v_mfma_f32_16x16x32_bf16 v[76:79], v[244:247], v[28:31], v[76:79]
s_waitcnt lgkmcnt(2)
v_mfma_f32_16x16x32_bf16 v[64:67], v[184:187], v[32:35], v[64:67]
v_mfma_f32_16x16x32_bf16 v[68:71], v[248:251], v[32:35], v[68:71]
v_mfma_f32_16x16x32_bf16 v[72:75], v[184:187], v[36:39], v[72:75]
v_mfma_f32_16x16x32_bf16 v[76:79], v[248:251], v[36:39], v[76:79]
s_waitcnt lgkmcnt(0)
v_mfma_f32_16x16x32_bf16 v[64:67], v[188:191], v[40:43], v[64:67]
v_mfma_f32_16x16x32_bf16 v[68:71], v[252:255], v[40:43], v[68:71]
v_mfma_f32_16x16x32_bf16 v[72:75], v[188:191], v[44:47], v[72:75]
v_mfma_f32_16x16x32_bf16 v[76:79], v[252:255], v[44:47], v[76:79]
s_cmp_ge_u32 s36, 3
s_cselect_b32 s58, s62, 0x70000000
s_add_u32 s49, s49, 229376
s_add_u32 s62, s62, 65536
s_add_u32 s59, s59, 229376
s_add_u32 s36, s36, 1
v_add_u32 v11, 0x8000, v11
s_nop 0
v_cvt_pk_bf16_f32 v80, v64, v65
v_cvt_pk_bf16_f32 v81, v66, v67
v_cvt_pk_bf16_f32 v82, v68, v69
v_cvt_pk_bf16_f32 v83, v70, v71
v_cvt_pk_bf16_f32 v84, v72, v73
v_cvt_pk_bf16_f32 v85, v74, v75
v_cvt_pk_bf16_f32 v86, v76, v77
v_cvt_pk_bf16_f32 v87, v78, v79
buffer_store_dwordx4 v[80:83], v7, s[4:7], s58 offen offset:0 sc1
buffer_store_dwordx4 v[84:87], v7, s[4:7], s58 offen offset:1024 sc1
s_waitcnt vmcnt(0)
s_barrier
v_min_u32 v100, s36, 64
s_sub_u32 s38, s36, 3
v_max_i32 v101, s38, 0
buffer_store_dwordx2 v[100:101], v4, s[4:7], 0 offen sc1
s_endpgm
Lln_6:
s_sub_u32 s26, s44, 56
s_and_b32 s52, s26, 3
s_lshl_b32 s53, s32, 2
v_lshrrev_b32 v80, 3, v9
v_and_b32 v81, 7, v9
s_lshr_b32 s38, s52, 1
s_lshl_b32 s38, s38, 10
s_and_b32 s39, s52, 1
s_lshl_b32 s39, s39, 7
s_add_u32 s38, s38, s39
s_lshl_b32 s39, s53, 12
s_add_u32 s38, s38, s39
v_lshl_add_u32 v6, v81, 4, s38
v_and_b32 v82, 3, v80
v_lshl_add_u32 v6, v82, 8, v6
v_lshrrev_b32 v82, 2, v80
v_lshl_add_u32 v6, v82, 11, v6
s_lshl_b32 s38, s52, 14
s_lshl_b32 s39, s53, 7
s_add_u32 s38, s38, s39
v_lshl_add_u32 v7, v81, 11, s38
v_lshl_add_u32 v7, v80, 4, v7
s_lshl_b32 s38, s53, 8
v_lshl_add_u32 v8, v80, 5, s38
v_and_b32 v12, 7, v9
v_lshlrev_b32 v12, 4, v12
s_lshl_b32 s38, s32, 2
v_add_u32 v11, s38, v12
s_mov_b32 s60, 0x00003f80
s_mov_b32 s61, 0x3f800000
v_min_u32 v2, 31, v9
v_lshlrev_b32 v2, 7, v2
s_lshr_b32 s47, s26, 2
s_xor_b32 s47, s47, 1
s_lshl_b32 s47, s47, 12
s_add_u32 s47, s47, 3440640
Lst_627:
buffer_load_dword v48, off, s[12:15], 0 offset:32 sc1
buffer_load_dword v49, off, s[12:15], 0 offset:160 sc1
s_waitcnt vmcnt(0)
v_add_u32 v48, v48, v49
s_nop 0
v_readfirstlane_b32 s38, v48
s_nop 3
s_and_b32 s39, s38, 0xffff
s_cmp_eq_u32 s39, 0x100
s_cbranch_scc1 Lso_628
s_sub_u32 s37, s37, 1
s_cbranch_scc1 Lend_7
s_sleep 8
s_branch Lst_627
Lso_628:
s_bfe_u32 s35, s38, 0x80010
s_bfe_u32 s46, s38, 0x10018
s_lshl_b32 s46, s46, 13
s_barrier
v_lshlrev_b32 v80, 7, v9
s_mov_b32 s38, 3424256
Lbw_629:
buffer_load_dword v81, v80, s[4:7], s38 offen sc1
s_waitcnt vmcnt(0)
v_cmp_gt_u32 vcc, 4, v81
s_cbranch_vccz Lbo_630
s_sub_u32 s37, s37, 1
s_cbranch_scc1 Lend_7
s_sleep 2
s_branch Lbw_629
Lbo_630:
s_mov_b32 s38, 3153920
buffer_load_dwordx4 v[128:131], v8, s[4:7], s38 offen offset:0 sc1
buffer_load_dwordx4 v[132:135], v8, s[4:7], s38 offen offset:16 sc1
buffer_load_dwordx4 v[136:139], v8, s[4:7], s38 offen offset:256 sc1
buffer_load_dwordx4 v[140:143], v8, s[4:7], s38 offen offset:272 sc1
buffer_load_dwordx4 v[144:147], v8, s[4:7], s38 offen offset:512 sc1
buffer_load_dwordx4 v[148:151], v8, s[4:7], s38 offen offset:528 sc1
buffer_load_dwordx4 v[152:155], v8, s[4:7], s38 offen offset:768 sc1
buffer_load_dwordx4 v[156:159], v8, s[4:7], s38 offen offset:784 sc1
s_mov_b32 s38, 3158016
buffer_load_dwordx4 v[192:195], v8, s[4:7], s38 offen offset:0 sc1
buffer_load_dwordx4 v[196:199], v8, s[4:7], s38 offen offset:16 sc1
buffer_load_dwordx4 v[200:203], v8, s[4:7], s38 offen offset:256 sc1
buffer_load_dwordx4 v[204:207], v8, s[4:7], s38 offen offset:272 sc1
buffer_load_dwordx4 v[208:211], v8, s[4:7], s38 offen offset:512 sc1
buffer_load_dwordx4 v[212:215], v8, s[4:7], s38 offen offset:528 sc1
buffer_load_dwordx4 v[216:219], v8, s[4:7], s38 offen offset:768 sc1
buffer_load_dwordx4 v[220:223], v8, s[4:7], s38 offen offset:784 sc1
s_mov_b32 s38, 3162112
buffer_load_dwordx4 v[160:163], v8, s[4:7], s38 offen offset:0 sc1
buffer_load_dwordx4 v[164:167], v8, s[4:7], s38 offen offset:16 sc1
buffer_load_dwordx4 v[168:171], v8, s[4:7], s38 offen offset:256 sc1
buffer_load_dwordx4 v[172:175], v8, s[4:7], s38 offen offset:272 sc1
buffer_load_dwordx4 v[176:179], v8, s[4:7], s38 offen offset:512 sc1
buffer_load_dwordx4 v[180:183], v8, s[4:7], s38 offen offset:528 sc1
buffer_load_dwordx4 v[184:187], v8, s[4:7], s38 offen offset:768 sc1
buffer_load_dwordx4 v[188:191], v8, s[4:7], s38 offen offset:784 sc1
s_waitcnt vmcnt(0)
v_pk_add_f32 v[160:161], v[160:161], 1.0 op_sel_hi:[1,0]
v_pk_add_f32 v[162:163], v[162:163], 1.0 op_sel_hi:[1,0]
v_pk_add_f32 v[164:165], v[164:165], 1.0 op_sel_hi:[1,0]
v_pk_add_f32 v[166:167], v[166:167], 1.0 op_sel_hi:[1,0]
v_pk_add_f32 v[168:169], v[168:169], 1.0 op_sel_hi:[1,0]
v_pk_add_f32 v[170:171], v[170:171], 1.0 op_sel_hi:[1,0]
v_pk_add_f32 v[172:173], v[172:173], 1.0 op_sel_hi:[1,0]
v_pk_add_f32 v[174:175], v[174:175], 1.0 op_sel_hi:[1,0]
v_pk_add_f32 v[176:177], v[176:177], 1.0 op_sel_hi:[1,0]
v_pk_add_f32 v[178:179], v[178:179], 1.0 op_sel_hi:[1,0]
v_pk_add_f32 v[180:181], v[180:181], 1.0 op_sel_hi:[1,0]
v_pk_add_f32 v[182:183], v[182:183], 1.0 op_sel_hi:[1,0]
v_pk_add_f32 v[184:185], v[184:185], 1.0 op_sel_hi:[1,0]
v_pk_add_f32 v[186:187], v[186:187], 1.0 op_sel_hi:[1,0]
v_pk_add_f32 v[188:189], v[188:189], 1.0 op_sel_hi:[1,0]
v_pk_add_f32 v[190:191], v[190:191], 1.0 op_sel_hi:[1,0]
s_lshr_b32 s36, s26, 2
Lln_631:
s_lshl_b32 s49, s36, 16
buffer_load_dwordx4 v[80:83], v7, s[88:91], s49 offen offset:0
buffer_load_dwordx4 v[84:87], v7, s[88:91], s49 offen offset:128
buffer_load_dwordx4 v[88:91], v7, s[88:91], s49 offen offset:256
buffer_load_dwordx4 v[92:95], v7, s[88:91], s49 offen offset:384
s_add_u32 s48, s36, 1
Lbw_632:
buffer_load_dword v3, v2, s[4:7], s47 offen sc1
s_waitcnt vmcnt(0)
v_cmp_gt_u32 vcc, s48, v3
s_cbranch_vccz Lbo_633
s_sub_u32 s37, s37, 1
s_cbranch_scc1 Lend_7
s_sleep 2
s_branch Lbw_632
Lbo_633:
s_add_u32 s39, s49, 117440512
buffer_load_dwordx4 v[16:19], v6, s[4:7], s39 offen sc1
s_add_u32 s39, s49, 121634816
buffer_load_dwordx4 v[20:23], v6, s[4:7], s39 offen sc1
s_add_u32 s39, s49, 125829120
buffer_load_dwordx4 v[24:27], v6, s[4:7], s39 offen sc1
s_add_u32 s39, s49, 130023424
buffer_load_dwordx4 v[28:31], v6, s[4:7], s39 offen sc1
s_add_u32 s39, s49, 117444608
buffer_load_dwordx4 v[32:35], v6, s[4:7], s39 offen sc1
s_add_u32 s39, s49, 121638912
buffer_load_dwordx4 v[36:39], v6, s[4:7], s39 offen sc1
s_add_u32 s39, s49, 125833216
buffer_load_dwordx4 v[40:43], v6, s[4:7], s39 offen sc1
s_add_u32 s39, s49, 130027520
buffer_load_dwordx4 v[44:47], v6, s[4:7], s39 offen sc1
s_add_u32 s39, s49, 117448704
buffer_load_dwordx4 v[48:51], v6, s[4:7], s39 offen sc1
s_add_u32 s39, s49, 121643008
buffer_load_dwordx4 v[52:55], v6, s[4:7], s39 offen sc1
s_add_u32 s39, s49, 125837312
buffer_load_dwordx4 v[56:59], v6, s[4:7], s39 offen sc1
s_add_u32 s39, s49, 130031616
buffer_load_dwordx4 v[60:63], v6, s[4:7], s39 offen sc1
s_add_u32 s39, s49, 117452800
buffer_load_dwordx4 v[64:67], v6, s[4:7], s39 offen sc1
s_add_u32 s39, s49, 121647104
buffer_load_dwordx4 v[68:71], v6, s[4:7], s39 offen sc1
s_add_u32 s39, s49, 125841408
buffer_load_dwordx4 v[72:75], v6, s[4:7], s39 offen sc1
s_add_u32 s39, s49, 130035712
buffer_load_dwordx4 v[76:79], v6, s[4:7], s39 offen sc1
v_lshlrev_b32 v96, 16, v80
v_and_b32 v97, 0xffff0000, v80
v_lshlrev_b32 v98, 16, v81
v_and_b32 v99, 0xffff0000, v81
v_lshlrev_b32 v100, 16, v82
v_and_b32 v101, 0xffff0000, v82
v_lshlrev_b32 v102, 16, v83
v_and_b32 v103, 0xffff0000, v83
v_lshlrev_b32 v104, 16, v84
v_and_b32 v105, 0xffff0000, v84
v_lshlrev_b32 v106, 16, v85
v_and_b32 v107, 0xffff0000, v85
v_lshlrev_b32 v108, 16, v86
v_and_b32 v109, 0xffff0000, v86
v_lshlrev_b32 v110, 16, v87
v_and_b32 v111, 0xffff0000, v87
v_lshlrev_b32 v112, 16, v88
v_and_b32 v113, 0xffff0000, v88
v_lshlrev_b32 v114, 16, v89
v_and_b32 v115, 0xffff0000, v89
v_lshlrev_b32 v116, 16, v90
v_and_b32 v117, 0xffff0000, v90
v_lshlrev_b32 v118, 16, v91
v_and_b32 v119, 0xffff0000, v91
v_lshlrev_b32 v120, 16, v92
v_and_b32 v121, 0xffff0000, v92
v_lshlrev_b32 v122, 16, v93
v_and_b32 v123, 0xffff0000, v93
v_lshlrev_b32 v124, 16, v94
v_and_b32 v125, 0xffff0000, v94
v_lshlrev_b32 v126, 16, v95
v_and_b32 v127, 0xffff0000, v95
s_waitcnt vmcnt(12)
v_dot2_f32_bf16 v224, v16, s60, 0
v_dot2_f32_bf16 v225, v16, s61, 0
v_dot2_f32_bf16 v226, v17, s60, 0
v_dot2_f32_bf16 v227, v17, s61, 0
v_dot2_f32_bf16 v228, v18, s60, 0
v_dot2_f32_bf16 v229, v18, s61, 0
v_dot2_f32_bf16 v230, v19, s60, 0
v_dot2_f32_bf16 v231, v19, s61, 0
v_dot2_f32_bf16 v224, v20, s60, v224
v_dot2_f32_bf16 v225, v20, s61, v225
v_dot2_f32_bf16 v226, v21, s60, v226
v_dot2_f32_bf16 v227, v21, s61, v227
v_dot2_f32_bf16 v228, v22, s60, v228
v_dot2_f32_bf16 v229, v22, s61, v229
v_dot2_f32_bf16 v230, v23, s60, v230
v_dot2_f32_bf16 v231, v23, s61, v231
v_dot2_f32_bf16 v224, v24, s60, v224
v_dot2_f32_bf16 v225, v24, s61, v225
v_dot2_f32_bf16 v226, v25, s60, v226
v_dot2_f32_bf16 v227, v25, s61, v227
v_dot2_f32_bf16 v228, v26, s60, v228
v_dot2_f32_bf16 v229, v26, s61, v229
v_dot2_f32_bf16 v230, v27, s60, v230
v_dot2_f32_bf16 v231, v27, s61, v231
v_dot2_f32_bf16 v224, v28, s60, v224
v_dot2_f32_bf16 v225, v28, s61, v225
v_dot2_f32_bf16 v226, v29, s60, v226
v_dot2_f32_bf16 v227, v29, s61, v227
v_dot2_f32_bf16 v228, v30, s60, v228
v_dot2_f32_bf16 v229, v30, s61, v229
v_dot2_f32_bf16 v230, v31, s60, v230
v_dot2_f32_bf16 v231, v31, s61, v231
s_nop 1
v_pk_fma_f32 v[96:97], v[224:225], v[128:129], v[96:97]
v_pk_fma_f32 v[98:99], v[226:227], v[130:131], v[98:99]
v_pk_fma_f32 v[100:101], v[228:229], v[132:133], v[100:101]
v_pk_fma_f32 v[102:103], v[230:231], v[134:135], v[102:103]
v_cvt_pk_bf16_f32 v80, v96, v97
v_cvt_pk_bf16_f32 v81, v98, v99
v_cvt_pk_bf16_f32 v82, v100, v101
v_cvt_pk_bf16_f32 v83, v102, v103
s_add_u32 s39, s49, 12582912
buffer_store_dwordx4 v[80:83], v6, s[4:7], s39 offen sc1
v_lshlrev_b32 v96, 16, v80
v_and_b32 v97, 0xffff0000, v80
v_lshlrev_b32 v98, 16, v81
v_and_b32 v99, 0xffff0000, v81
v_lshlrev_b32 v100, 16, v82
v_and_b32 v101, 0xffff0000, v82
v_lshlrev_b32 v102, 16, v83
v_and_b32 v103, 0xffff0000, v83
s_waitcnt vmcnt(9)
v_dot2_f32_bf16 v224, v32, s60, 0
v_dot2_f32_bf16 v225, v32, s61, 0
v_dot2_f32_bf16 v226, v33, s60, 0
v_dot2_f32_bf16 v227, v33, s61, 0
v_dot2_f32_bf16 v228, v34, s60, 0
v_dot2_f32_bf16 v229, v34, s61, 0
v_dot2_f32_bf16 v230, v35, s60, 0
v_dot2_f32_bf16 v231, v35, s61, 0
v_dot2_f32_bf16 v224, v36, s60, v224
v_dot2_f32_bf16 v225, v36, s61, v225
v_dot2_f32_bf16 v226, v37, s60, v226
v_dot2_f32_bf16 v227, v37, s61, v227
v_dot2_f32_bf16 v228, v38, s60, v228
v_dot2_f32_bf16 v229, v38, s61, v229
v_dot2_f32_bf16 v230, v39, s60, v230
v_dot2_f32_bf16 v231, v39, s61, v231
v_dot2_f32_bf16 v224, v40, s60, v224
v_dot2_f32_bf16 v225, v40, s61, v225
v_dot2_f32_bf16 v226, v41, s60, v226
v_dot2_f32_bf16 v227, v41, s61, v227
v_dot2_f32_bf16 v228, v42, s60, v228
v_dot2_f32_bf16 v229, v42, s61, v229
v_dot2_f32_bf16 v230, v43, s60, v230
v_dot2_f32_bf16 v231, v43, s61, v231
v_dot2_f32_bf16 v224, v44, s60, v224
v_dot2_f32_bf16 v225, v44, s61, v225
v_dot2_f32_bf16 v226, v45, s60, v226
v_dot2_f32_bf16 v227, v45, s61, v227
v_dot2_f32_bf16 v228, v46, s60, v228
v_dot2_f32_bf16 v229, v46, s61, v229
v_dot2_f32_bf16 v230, v47, s60, v230
v_dot2_f32_bf16 v231, v47, s61, v231
s_nop 1
v_pk_fma_f32 v[104:105], v[224:225], v[136:137], v[104:105]
v_pk_fma_f32 v[106:107], v[226:227], v[138:139], v[106:107]
v_pk_fma_f32 v[108:109], v[228:229], v[140:141], v[108:109]
v_pk_fma_f32 v[110:111], v[230:231], v[142:143], v[110:111]
v_cvt_pk_bf16_f32 v84, v104, v105
v_cvt_pk_bf16_f32 v85, v106, v107
v_cvt_pk_bf16_f32 v86, v108, v109
v_cvt_pk_bf16_f32 v87, v110, v111
s_add_u32 s39, s49, 12587008
buffer_store_dwordx4 v[84:87], v6, s[4:7], s39 offen sc1
v_lshlrev_b32 v104, 16, v84
v_and_b32 v105, 0xffff0000, v84
v_lshlrev_b32 v106, 16, v85
v_and_b32 v107, 0xffff0000, v85
v_lshlrev_b32 v108, 16, v86
v_and_b32 v109, 0xffff0000, v86
v_lshlrev_b32 v110, 16, v87
v_and_b32 v111, 0xffff0000, v87
s_waitcnt vmcnt(6)
v_dot2_f32_bf16 v224, v48, s60, 0
v_dot2_f32_bf16 v225, v48, s61, 0
v_dot2_f32_bf16 v226, v49, s60, 0
v_dot2_f32_bf16 v227, v49, s61, 0
v_dot2_f32_bf16 v228, v50, s60, 0
v_dot2_f32_bf16 v229, v50, s61, 0
v_dot2_f32_bf16 v230, v51, s60, 0
v_dot2_f32_bf16 v231, v51, s61, 0
v_dot2_f32_bf16 v224, v52, s60, v224
v_dot2_f32_bf16 v225, v52, s61, v225
v_dot2_f32_bf16 v226, v53, s60, v226
v_dot2_f32_bf16 v227, v53, s61, v227
v_dot2_f32_bf16 v228, v54, s60, v228
v_dot2_f32_bf16 v229, v54, s61, v229
v_dot2_f32_bf16 v230, v55, s60, v230
v_dot2_f32_bf16 v231, v55, s61, v231
v_dot2_f32_bf16 v224, v56, s60, v224
v_dot2_f32_bf16 v225, v56, s61, v225
v_dot2_f32_bf16 v226, v57, s60, v226
v_dot2_f32_bf16 v227, v57, s61, v227
v_dot2_f32_bf16 v228, v58, s60, v228
v_dot2_f32_bf16 v229, v58, s61, v229
v_dot2_f32_bf16 v230, v59, s60, v230
v_dot2_f32_bf16 v231, v59, s61, v231
v_dot2_f32_bf16 v224, v60, s60, v224
v_dot2_f32_bf16 v225, v60, s61, v225
v_dot2_f32_bf16 v226, v61, s60, v226
v_dot2_f32_bf16 v227, v61, s61, v227
v_dot2_f32_bf16 v228, v62, s60, v228
v_dot2_f32_bf16 v229, v62, s61, v229
v_dot2_f32_bf16 v230, v63, s60, v230
v_dot2_f32_bf16 v231, v63, s61, v231
s_nop 1
v_pk_fma_f32 v[112:113], v[224:225], v[144:145], v[112:113]
v_pk_fma_f32 v[114:115], v[226:227], v[146:147], v[114:115]
v_pk_fma_f32 v[116:117], v[228:229], v[148:149], v[116:117]
v_pk_fma_f32 v[118:119], v[230:231], v[150:151], v[118:119]
v_cvt_pk_bf16_f32 v88, v112, v113
v_cvt_pk_bf16_f32 v89, v114, v115
v_cvt_pk_bf16_f32 v90, v116, v117
v_cvt_pk_bf16_f32 v91, v118, v119
s_add_u32 s39, s49, 12591104
buffer_store_dwordx4 v[88:91], v6, s[4:7], s39 offen sc1
v_lshlrev_b32 v112, 16, v88
v_and_b32 v113, 0xffff0000, v88
v_lshlrev_b32 v114, 16, v89
v_and_b32 v115, 0xffff0000, v89
v_lshlrev_b32 v116, 16, v90
v_and_b32 v117, 0xffff0000, v90
v_lshlrev_b32 v118, 16, v91
v_and_b32 v119, 0xffff0000, v91
s_waitcnt vmcnt(3)
v_dot2_f32_bf16 v224, v64, s60, 0
v_dot2_f32_bf16 v225, v64, s61, 0
v_dot2_f32_bf16 v226, v65, s60, 0
v_dot2_f32_bf16 v227, v65, s61, 0
v_dot2_f32_bf16 v228, v66, s60, 0
v_dot2_f32_bf16 v229, v66, s61, 0
v_dot2_f32_bf16 v230, v67, s60, 0
v_dot2_f32_bf16 v231, v67, s61, 0
v_dot2_f32_bf16 v224, v68, s60, v224
v_dot2_f32_bf16 v225, v68, s61, v225
v_dot2_f32_bf16 v226, v69, s60, v226
v_dot2_f32_bf16 v227, v69, s61, v227
v_dot2_f32_bf16 v228, v70, s60, v228
v_dot2_f32_bf16 v229, v70, s61, v229
v_dot2_f32_bf16 v230, v71, s60, v230
v_dot2_f32_bf16 v231, v71, s61, v231
v_dot2_f32_bf16 v224, v72, s60, v224
v_dot2_f32_bf16 v225, v72, s61, v225
v_dot2_f32_bf16 v226, v73, s60, v226
v_dot2_f32_bf16 v227, v73, s61, v227
v_dot2_f32_bf16 v228, v74, s60, v228
v_dot2_f32_bf16 v229, v74, s61, v229
v_dot2_f32_bf16 v230, v75, s60, v230
v_dot2_f32_bf16 v231, v75, s61, v231
v_dot2_f32_bf16 v224, v76, s60, v224
v_dot2_f32_bf16 v225, v76, s61, v225
v_dot2_f32_bf16 v226, v77, s60, v226
v_dot2_f32_bf16 v227, v77, s61, v227
v_dot2_f32_bf16 v228, v78, s60, v228
v_dot2_f32_bf16 v229, v78, s61, v229
v_dot2_f32_bf16 v230, v79, s60, v230
v_dot2_f32_bf16 v231, v79, s61, v231
s_nop 1
v_pk_fma_f32 v[120:121], v[224:225], v[152:153], v[120:121]
v_pk_fma_f32 v[122:123], v[226:227], v[154:155], v[122:123]
v_pk_fma_f32 v[124:125], v[228:229], v[156:157], v[124:125]
v_pk_fma_f32 v[126:127], v[230:231], v[158:159], v[126:127]
v_cvt_pk_bf16_f32 v92, v120, v121
v_cvt_pk_bf16_f32 v93, v122, v123
v_cvt_pk_bf16_f32 v94, v124, v125
v_cvt_pk_bf16_f32 v95, v126, v127
s_add_u32 s39, s49, 12595200
buffer_store_dwordx4 v[92:95], v6, s[4:7], s39 offen sc1
v_lshlrev_b32 v120, 16, v92
v_and_b32 v121, 0xffff0000, v92
v_lshlrev_b32 v122, 16, v93
v_and_b32 v123, 0xffff0000, v93
v_lshlrev_b32 v124, 16, v94
v_and_b32 v125, 0xffff0000, v94
v_lshlrev_b32 v126, 16, v95
v_and_b32 v127, 0xffff0000, v95
v_pk_add_f32 v[224:225], v[96:97], v[98:99]
v_pk_add_f32 v[224:225], v[224:225], v[100:101]
v_pk_add_f32 v[224:225], v[224:225], v[102:103]
v_pk_add_f32 v[224:225], v[224:225], v[104:105]
v_pk_add_f32 v[224:225], v[224:225], v[106:107]
v_pk_add_f32 v[224:225], v[224:225], v[108:109]
v_pk_add_f32 v[224:225], v[224:225], v[110:111]
v_pk_add_f32 v[224:225], v[224:225], v[112:113]
v_pk_add_f32 v[224:225], v[224:225], v[114:115]
v_pk_add_f32 v[224:225], v[224:225], v[116:117]
v_pk_add_f32 v[224:225], v[224:225], v[118:119]
v_pk_add_f32 v[224:225], v[224:225], v[120:121]
v_pk_add_f32 v[224:225], v[224:225], v[122:123]
v_pk_add_f32 v[224:225], v[224:225], v[124:125]
v_pk_add_f32 v[224:225], v[224:225], v[126:127]
v_add_f32 v224, v224, v225
s_nop 1
v_add_f32_dpp v224, v224, v224 row_ror:8 row_mask:0xf bank_mask:0xf
v_mov_b32 v225, v224
s_nop 1
v_permlane16_swap_b32 v224, v225
s_nop 0
v_add_f32 v224, v224, v225
v_mov_b32 v225, v224
s_nop 1
v_permlane32_swap_b32 v224, v225
s_nop 0
v_add_f32 v224, v224, v225
ds_write_b32 v11, v224 offset:512
s_waitcnt lgkmcnt(0)
s_barrier
ds_read_b128 v[224:227], v12 offset:512
s_waitcnt lgkmcnt(0)
v_pk_add_f32 v[224:225], v[224:225], v[226:227]
v_add_f32 v224, v224, v225
v_mul_f32 v224, 0x3a800000, v224
v_pk_add_f32 v[96:97], v[96:97], v[224:225] op_sel_hi:[1,0] neg_lo:[0,1] neg_hi:[0,1]
v_pk_add_f32 v[98:99], v[98:99], v[224:225] op_sel_hi:[1,0] neg_lo:[0,1] neg_hi:[0,1]
v_pk_add_f32 v[100:101], v[100:101], v[224:225] op_sel_hi:[1,0] neg_lo:[0,1] neg_hi:[0,1]
v_pk_add_f32 v[102:103], v[102:103], v[224:225] op_sel_hi:[1,0] neg_lo:[0,1] neg_hi:[0,1]
v_pk_add_f32 v[104:105], v[104:105], v[224:225] op_sel_hi:[1,0] neg_lo:[0,1] neg_hi:[0,1]
v_pk_add_f32 v[106:107], v[106:107], v[224:225] op_sel_hi:[1,0] neg_lo:[0,1] neg_hi:[0,1]
v_pk_add_f32 v[108:109], v[108:109], v[224:225] op_sel_hi:[1,0] neg_lo:[0,1] neg_hi:[0,1]
v_pk_add_f32 v[110:111], v[110:111], v[224:225] op_sel_hi:[1,0] neg_lo:[0,1] neg_hi:[0,1]
v_pk_add_f32 v[112:113], v[112:113], v[224:225] op_sel_hi:[1,0] neg_lo:[0,1] neg_hi:[0,1]
v_pk_add_f32 v[114:115], v[114:115], v[224:225] op_sel_hi:[1,0] neg_lo:[0,1] neg_hi:[0,1]
v_pk_add_f32 v[116:117], v[116:117], v[224:225] op_sel_hi:[1,0] neg_lo:[0,1] neg_hi:[0,1]
v_pk_add_f32 v[118:119], v[118:119], v[224:225] op_sel_hi:[1,0] neg_lo:[0,1] neg_hi:[0,1]
v_pk_add_f32 v[120:121], v[120:121], v[224:225] op_sel_hi:[1,0] neg_lo:[0,1] neg_hi:[0,1]
v_pk_add_f32 v[122:123], v[122:123], v[224:225] op_sel_hi:[1,0] neg_lo:[0,1] neg_hi:[0,1]
v_pk_add_f32 v[124:125], v[124:125], v[224:225] op_sel_hi:[1,0] neg_lo:[0,1] neg_hi:[0,1]
v_pk_add_f32 v[126:127], v[126:127], v[224:225] op_sel_hi:[1,0] neg_lo:[0,1] neg_hi:[0,1]
v_pk_mul_f32 v[224:225], v[96:97], v[96:97]
v_pk_fma_f32 v[224:225], v[98:99], v[98:99], v[224:225]
v_pk_fma_f32 v[224:225], v[100:101], v[100:101], v[224:225]
v_pk_fma_f32 v[224:225], v[102:103], v[102:103], v[224:225]
v_pk_fma_f32 v[224:225], v[104:105], v[104:105], v[224:225]
v_pk_fma_f32 v[224:225], v[106:107], v[106:107], v[224:225]
v_pk_fma_f32 v[224:225], v[108:109], v[108:109], v[224:225]
v_pk_fma_f32 v[224:225], v[110:111], v[110:111], v[224:225]
v_pk_fma_f32 v[224:225], v[112:113], v[112:113], v[224:225]
v_pk_fma_f32 v[224:225], v[114:115], v[114:115], v[224:225]
v_pk_fma_f32 v[224:225], v[116:117], v[116:117], v[224:225]
v_pk_fma_f32 v[224:225], v[118:119], v[118:119], v[224:225]
v_pk_fma_f32 v[224:225], v[120:121], v[120:121], v[224:225]
v_pk_fma_f32 v[224:225], v[122:123], v[122:123], v[224:225]
v_pk_fma_f32 v[224:225], v[124:125], v[124:125], v[224:225]
v_pk_fma_f32 v[224:225], v[126:127], v[126:127], v[224:225]
v_add_f32 v224, v224, v225
s_nop 1
v_add_f32_dpp v224, v224, v224 row_ror:8 row_mask:0xf bank_mask:0xf
v_mov_b32 v225, v224
s_nop 1
v_permlane16_swap_b32 v224, v225
s_nop 0
v_add_f32 v224, v224, v225
v_mov_b32 v225, v224
s_nop 1
v_permlane32_swap_b32 v224, v225
s_nop 0
v_add_f32 v224, v224, v225
ds_write_b32 v11, v224 offset:768
s_waitcnt lgkmcnt(0)
s_barrier
ds_read_b128 v[224:227], v12 offset:768
s_waitcnt lgkmcnt(0)
v_pk_add_f32 v[224:225], v[224:225], v[226:227]
v_add_f32 v224, v224, v225
v_mul_f32 v224, 0x3a800000, v224
v_add_f32 v224, 0x3727c5ac, v224
v_rsq_f32 v224, v224
s_nop 0
v_pk_mul_f32 v[96:97], v[96:97], v[224:225] op_sel_hi:[1,0]
v_pk_mul_f32 v[98:99], v[98:99], v[224:225] op_sel_hi:[1,0]
v_pk_mul_f32 v[100:101], v[100:101], v[224:225] op_sel_hi:[1,0]
v_pk_mul_f32 v[102:103], v[102:103], v[224:225] op_sel_hi:[1,0]
v_pk_mul_f32 v[104:105], v[104:105], v[224:225] op_sel_hi:[1,0]
v_pk_mul_f32 v[106:107], v[106:107], v[224:225] op_sel_hi:[1,0]
v_pk_mul_f32 v[108:109], v[108:109], v[224:225] op_sel_hi:[1,0]
v_pk_mul_f32 v[110:111], v[110:111], v[224:225] op_sel_hi:[1,0]
v_pk_mul_f32 v[112:113], v[112:113], v[224:225] op_sel_hi:[1,0]
v_pk_mul_f32 v[114:115], v[114:115], v[224:225] op_sel_hi:[1,0]
v_pk_mul_f32 v[116:117], v[116:117], v[224:225] op_sel_hi:[1,0]
v_pk_mul_f32 v[118:119], v[118:119], v[224:225] op_sel_hi:[1,0]
v_pk_mul_f32 v[120:121], v[120:121], v[224:225] op_sel_hi:[1,0]
v_pk_mul_f32 v[122:123], v[122:123], v[224:225] op_sel_hi:[1,0]
v_pk_mul_f32 v[124:125], v[124:125], v[224:225] op_sel_hi:[1,0]
v_pk_mul_f32 v[126:127], v[126:127], v[224:225] op_sel_hi:[1,0]
v_pk_fma_f32 v[96:97], v[96:97], v[160:161], v[192:193]
v_pk_fma_f32 v[98:99], v[98:99], v[162:163], v[194:195]
v_pk_fma_f32 v[100:101], v[100:101], v[164:165], v[196:197]
v_pk_fma_f32 v[102:103], v[102:103], v[166:167], v[198:199]
v_cvt_pk_bf16_f32 v16, v96, v97
v_cvt_pk_bf16_f32 v17, v98, v99
v_cvt_pk_bf16_f32 v18, v100, v101
v_cvt_pk_bf16_f32 v19, v102, v103
s_add_u32 s39, s49, 16777216
buffer_store_dwordx4 v[16:19], v6, s[4:7], s39 offen sc1
v_pk_fma_f32 v[104:105], v[104:105], v[168:169], v[200:201]
v_pk_fma_f32 v[106:107], v[106:107], v[170:171], v[202:203]
v_pk_fma_f32 v[108:109], v[108:109], v[172:173], v[204:205]
v_pk_fma_f32 v[110:111], v[110:111], v[174:175], v[206:207]
v_cvt_pk_bf16_f32 v20, v104, v105
v_cvt_pk_bf16_f32 v21, v106, v107
v_cvt_pk_bf16_f32 v22, v108, v109
v_cvt_pk_bf16_f32 v23, v110, v111
s_add_u32 s39, s49, 16781312
buffer_store_dwordx4 v[20:23], v6, s[4:7], s39 offen sc1
v_pk_fma_f32 v[112:113], v[112:113], v[176:177], v[208:209]
v_pk_fma_f32 v[114:115], v[114:115], v[178:179], v[210:211]
v_pk_fma_f32 v[116:117], v[116:117], v[180:181], v[212:213]
v_pk_fma_f32 v[118:119], v[118:119], v[182:183], v[214:215]
v_cvt_pk_bf16_f32 v24, v112, v113
v_cvt_pk_bf16_f32 v25, v114, v115
v_cvt_pk_bf16_f32 v26, v116, v117
v_cvt_pk_bf16_f32 v27, v118, v119
s_add_u32 s39, s49, 16785408
buffer_store_dwordx4 v[24:27], v6, s[4:7], s39 offen sc1
v_pk_fma_f32 v[120:121], v[120:121], v[184:185], v[216:217]
v_pk_fma_f32 v[122:123], v[122:123], v[186:187], v[218:219]
v_pk_fma_f32 v[124:125], v[124:125], v[188:189], v[220:221]
v_pk_fma_f32 v[126:127], v[126:127], v[190:191], v[222:223]
v_cvt_pk_bf16_f32 v28, v120, v121
v_cvt_pk_bf16_f32 v29, v122, v123
v_cvt_pk_bf16_f32 v30, v124, v125
v_cvt_pk_bf16_f32 v31, v126, v127
s_add_u32 s39, s49, 16789504
buffer_store_dwordx4 v[28:31], v6, s[4:7], s39 offen sc1
v_mov_b32 v5, s48
s_waitcnt vmcnt(0)
s_barrier
buffer_store_dword v5, v4, s[4:7], 0 offen sc1
s_add_u32 s36, s36, 2
s_cmp_lt_u32 s36, 64
s_cbranch_scc1 Lln_631
s_endpgm
Lcode_end:

.section .rodata,"a"
.p2align 6
.amdhsa_kernel adaLN_cond__memory_aug_recurrent_mem_tr__glu_gated_swiglu__prompt_kernel
  .amdhsa_next_free_vgpr 512
  .amdhsa_next_free_sgpr 102
  .amdhsa_accum_offset 256
  .amdhsa_group_segment_fixed_size 0
  .amdhsa_kernarg_size 128
  .amdhsa_user_sgpr_count 2
  .amdhsa_user_sgpr_kernarg_segment_ptr 1
  .amdhsa_system_sgpr_workgroup_id_x 1
  .amdhsa_float_denorm_mode_32 3
.end_amdhsa_kernel
```

```asm
; @launch grid=(256,1,1) block=(256,1,1) lds=163840
.amdgcn_target "amdgcn-amd-amdhsa--gfx950"
.text
.globl adaLN_cond__memory_aug_recurrent_mem_tr__glu_gated_swiglu__prompt_kernel
.p2align 8
.type adaLN_cond__memory_aug_recurrent_mem_tr__glu_gated_swiglu__prompt_kernel,@function
adaLN_cond__memory_aug_recurrent_mem_tr__glu_gated_swiglu__prompt_kernel:
s_cmp_ge_u32 s2, 256
s_cbranch_scc1 Lend_1
s_load_dwordx8 s[16:23], s[0:1], 8
s_load_dwordx2 s[24:25], s[0:1], 40
s_load_dwordx4 s[28:31], s[0:1], 112
s_getreg_b32 s51, hwreg(HW_REG_XCC_ID, 0, 4)
s_and_b32 s51, s51, 7
v_lshrrev_b32 v1, 6, v0
s_nop 0
v_readfirstlane_b32 s32, v1
v_and_b32 v1, 63, v0
s_waitcnt lgkmcnt(0)
s_mov_b32 s4, s30
s_and_b32 s5, s31, 0xffff
s_mov_b32 s6, 0x10000000
s_mov_b32 s7, 0x20000
s_mov_b32 s12, s28
s_and_b32 s13, s29, 0xffff
s_mov_b32 s14, 0x100
s_mov_b32 s15, 0x20000
s_mov_b32 s37, 200000
s_mov_b32 s80, 0
s_mov_b32 s81, 0
s_mov_b32 s82, 0
s_mov_b32 s83, 0
s_cmp_lg_u32 s32, 0
s_cbranch_scc1 Lrs_10
s_mov_b32 s33, s51
s_mov_b32 s35, 0
s_mov_b64 exec, 1
Lrl_9:
v_lshlrev_b32 v2, 5, s33
v_mov_b32 v3, 1
buffer_atomic_add v3, v2, s[12:15], 0 offen sc0 sc1
s_waitcnt vmcnt(0)
v_readfirstlane_b32 s34, v3
s_nop 3
s_cmp_lt_u32 s34, 32
s_cbranch_scc1 Lrg_8
s_add_u32 s33, s33, 1
s_and_b32 s33, s33, 7
s_add_u32 s35, s35, 1
s_cmp_lt_u32 s35, 8
s_cbranch_scc1 Lrl_9
Lrg_8:
s_lshl_b32 s38, s33, 8
s_min_u32 s34, s34, 255
s_or_b32 s38, s38, s34
s_lshl_b32 s39, s35, 16
s_or_b32 s38, s38, s39
v_mov_b32 v3, s38
v_mov_b32 v2, 0
ds_write_b32 v2, v3
s_mov_b64 exec, -1
Lrs_10:
s_waitcnt lgkmcnt(0)
s_barrier
v_mov_b32 v2, 0
ds_read_b32 v3, v2
s_waitcnt lgkmcnt(0)
v_readfirstlane_b32 s38, v3
s_barrier
s_and_b32 s34, s38, 255
s_bfe_u32 s33, s38, 0x80008
s_lshr_b32 s35, s38, 16
s_min_u32 s35, s35, 1
s_cmp_ge_u32 s34, 32
s_cbranch_scc1 Lend_1
s_cmp_ge_u32 s33, 4
s_cselect_b32 s38, 0, 8
s_add_u32 s34, s34, s38
s_and_b32 s34, s34, 31
s_getpc_b64 s[40:41]
Lcode_here:
s_lshl_b32 s42, s34, 12
v_lshl_add_u32 v2, v0, 4, s42
v_min_u32 v2, Lcode_end-Lcode_here-16, v2
v_mov_b32 v3, s41
v_add_co_u32 v2, vcc, s40, v2
s_nop 1
v_addc_co_u32 v3, vcc, 0, v3, vcc
global_load_dword v255, v[2:3], off
s_cmp_ge_u32 s33, 4
s_cbranch_scc1 Lhi_4
s_cmp_ge_u32 s34, 24
s_cbranch_scc1 Lg3_3
s_cmp_ge_u32 s34, 8
s_cbranch_scc1 Lkvo_2
v_mov_b32 v48, v0
v_mov_b32 v50, v1
s_lshl_b32 s54, s33, 3
s_add_u32 s54, s54, s34
s_and_b32 s55, s32, 1
s_lshr_b32 s56, s32, 1
s_lshl_b32 s45, s33, 18
s_add_u32 s45, s45, 2097152
s_lshl_b32 s38, s32, 12
v_lshl_add_u32 v10, v50, 4, s38
s_lshl_b32 s38, s34, 11
s_add_u32 s39, s38, 16384
v_lshl_add_u32 v11, v50, 4, s39
s_lshl_b32 s39, s56, 10
s_add_u32 s38, s38, s39
s_lshl_b32 s39, s55, 9
s_add_u32 s39, s39, s38
s_add_u32 s39, s39, 32768
v_lshl_add_u32 v12, v50, 3, s39
v_xor_b32 v13, 512, v12
s_add_u32 s39, s39, 16384
v_mov_b32 v14, s39
v_bfe_u32 v51, v50, 5, 1
v_lshl_add_u32 v14, v51, 8, v14
v_bfe_u32 v51, v50, 1, 2
v_lshl_add_u32 v14, v51, 6, v14
v_bfe_u32 v51, v50, 4, 1
v_lshl_add_u32 v14, v51, 5, v14
v_bfe_u32 v51, v50, 0, 1
v_lshl_add_u32 v14, v51, 4, v14
v_bfe_u32 v51, v50, 3, 1
v_lshl_add_u32 v14, v51, 30, v14
v_bfe_u32 v15, v50, 1, 1
v_mul_u32_u24 v15, 0xaaaa, v15
v_add_u32 v15, 0x4444, v15
v_mov_b32 v200, 0
v_mov_b32 v201, 0
v_mov_b32 v202, 0
v_mov_b32 v203, 0
v_mov_b32 v204, 0
v_mov_b32 v205, 0
v_mov_b32 v206, 0
v_mov_b32 v207, 0
s_xor_b32 s38, s32, 3
s_mul_i32 s38, s38, 3072
s_add_u32 s38, s38, 0
v_lshl_add_u32 v211, v50, 4, s38
s_xor_b32 s38, s32, 2
s_mul_i32 s38, s38, 3072
s_add_u32 s38, s38, 1024
v_lshl_add_u32 v212, v50, 4, s38
s_xor_b32 s38, s32, 1
s_mul_i32 s38, s38, 3072
s_add_u32 s38, s38, 2048
v_lshl_add_u32 v213, v50, 4, s38
s_mul_i32 s38, s32, 3072
v_lshl_add_u32 v18, v50, 4, s38
s_lshl_b32 s38, s32, 9
v_and_b32 v51, 15, v50
v_lshl_add_u32 v19, v51, 4, s38
v_lshrrev_b32 v51, 4, v50
v_lshl_add_u32 v19, v51, 2, v19
v_lshrrev_b32 v51, 2, v50
v_and_b32 v52, 1, v50
v_lshlrev_b32 v52, 3, v52
v_lshl_add_u32 v20, v51, 4, v52
v_lshlrev_b32 v51, 4, v50
s_mul_i32 s38, s32, 6144
v_add_u32 v21, s38, v51
s_add_u32 s57, s38, 32768
v_add_u32 v22, 40960, v51
s_lshl_b32 s38, s55, 12
s_add_u32 s38, s38, 32768
v_add_u32 v23, s38, v51
s_lshl_b32 s38, s32, 11
s_add_u32 s38, s38, 49152
v_add_u32 v24, s38, v51
v_xor_b32 v25, 2048, v24
s_lshl_b32 s59, s33, 12
s_add_u32 s59, s59, 3276800
s_lshl_b32 s38, s32, 8
v_lshl_add_u32 v192, v50, 2, s38
s_lshr_b32 s38, s34, 1
s_lshl_b32 s38, s38, 8
s_and_b32 s39, s34, 1
s_lshl_b32 s39, s39, 2
s_add_u32 s38, s38, s39
s_add_u32 s38, s38, 2048
v_min_u32 v52, 1, v48
v_lshl_add_u32 v193, v52, 30, s38
v_mov_b32 v197, 0
buffer_store_dword v197, v193, s[4:7], s59 offen sc1
s_lshr_b32 s38, s34, 2
s_lshl_b32 s38, s38, 14
s_and_b32 s39, s34, 3
s_lshl_b32 s39, s39, 11
s_add_u32 s38, s38, s39
s_lshl_b32 s39, s33, 16
s_add_u32 s38, s38, s39
v_lshl_add_u32 v198, v48, 3, s38
s_lshl_b32 s38, s54, 2
s_add_u32 s38, s38, s32
s_lshl_b32 s38, s38, 11
s_lshl_b32 s39, s55, 10
s_add_u32 s38, s38, s39
v_add_u32 v26, s38, v51
v_xor_b32 v27, 2048, v26
s_lshl_b32 s38, s54, 5
s_add_u32 s38, s38, s32
s_lshl_b32 s38, s38, 2
s_add_u32 s38, s38, 3432448
v_min_u32 v52, 1, v50
v_lshl_add_u32 v199, v52, 30, s38
buffer_store_dword v197, v199, s[4:7], 0 offen sc1
v_min_u32 v53, 15, v50
v_lshlrev_b32 v53, 7, v53
s_lshr_b32 s38, s54, 2
s_lshl_b32 s38, s38, 10
s_add_u32 s38, s38, 3407872
v_add_u32 v208, s38, v53
s_lshl_b32 s38, s33, 10
s_add_u32 s38, s38, 3435520
v_add_u32 v53, s38, v53
v_cmp_lt_u32 vcc, 7, v50
s_nop 1
v_cndmask_b32 v208, v208, v53, vcc
v_cndmask_b32 v210, 0, 8, vcc
v_mov_b32 v28, -1
v_mov_b32 v32, 0x3f803f80
v_mov_b32 v29, -1
v_mov_b32 v33, 0x3f803f80
v_mov_b32 v30, -1
v_mov_b32 v34, 0x3f803f80
v_mov_b32 v31, -1
v_mov_b32 v35, 0x3f803f80
v_and_b32 v51, 15, v50
s_lshl_b32 s38, s55, 4
v_add_u32 v51, s38, v51
v_lshrrev_b32 v52, 4, v50
v_lshlrev_b32 v52, 2, v52
v_mov_b32 v54, 0xf149f2ca
v_add_u32 v53, 0, v52
v_cmp_gt_u32 vcc, v53, v51
s_nop 1
v_cndmask_b32 v36, 0, v54, vcc
v_add_u32 v53, 1, v52
v_cmp_gt_u32 vcc, v53, v51
s_nop 1
v_cndmask_b32 v37, 0, v54, vcc
v_add_u32 v53, 2, v52
v_cmp_gt_u32 vcc, v53, v51
s_nop 1
v_cndmask_b32 v38, 0, v54, vcc
v_add_u32 v53, 3, v52
v_cmp_gt_u32 vcc, v53, v51
s_nop 1
v_cndmask_b32 v39, 0, v54, vcc
v_add_u32 v53, 16, v52
v_cmp_gt_u32 vcc, v53, v51
s_nop 1
v_cndmask_b32 v40, 0, v54, vcc
v_add_u32 v53, 17, v52
v_cmp_gt_u32 vcc, v53, v51
s_nop 1
v_cndmask_b32 v41, 0, v54, vcc
v_add_u32 v53, 18, v52
v_cmp_gt_u32 vcc, v53, v51
s_nop 1
v_cndmask_b32 v42, 0, v54, vcc
v_add_u32 v53, 19, v52
v_cmp_gt_u32 vcc, v53, v51
s_nop 1
v_cndmask_b32 v43, 0, v54, vcc
v_mov_b32 v0, 0
v_mov_b32 v1, 0
v_mov_b32 v2, 0
v_mov_b32 v3, 0
v_mov_b32 v4, 0
v_mov_b32 v5, 0
v_mov_b32 v6, 0
v_mov_b32 v7, 0
v_mov_b32 v8, 0
v_mov_b32 v9, 0
s_mov_b32 s48, 0x3e0293ee
s_mov_b32 s49, 0xbe0293ee
s_add_u32 s38, s45, 0
buffer_store_dwordx4 v[28:31], v14, s[4:7], s38 offen sc1
s_add_u32 s38, s45, 65536
buffer_store_dwordx4 v[28:31], v14, s[4:7], s38 offen sc1
s_add_u32 s38, s45, 131072
buffer_store_dwordx4 v[28:31], v14, s[4:7], s38 offen sc1
s_add_u32 s38, s45, 196608
buffer_store_dwordx4 v[28:31], v14, s[4:7], s38 offen sc1
s_lshl_b32 s52, s35, 16
s_or_b32 s52, s52, 1
s_waitcnt vmcnt(0)
s_barrier
s_cmp_lg_u32 s32, 0
s_cbranch_scc1 Lar_11
s_mov_b64 exec, 1
v_mov_b32 v48, 16
v_mov_b32 v49, s52
buffer_atomic_add v49, v48, s[12:15], 0 offen sc1
s_mov_b64 exec, -1
Lar_11:
s_xor_b32 s52, s32, 3
s_lshl_b32 s52, s52, 6
v_and_b32 v54, 7, v50
v_lshlrev_b32 v54, 4, v54
v_xor_b32 v54, s52, v54
v_lshrrev_b32 v51, 3, v50
v_lshl_add_u32 v51, v51, 13, v54
s_xor_b32 s52, s32, 1
s_lshl_b32 s52, s52, 6
v_and_b32 v54, 7, v50
v_lshlrev_b32 v54, 4, v54
v_xor_b32 v54, s52, v54
v_lshrrev_b32 v52, 3, v50
v_lshl_add_u32 v52, v52, 13, v54
v_bfe_u32 v53, v50, 2, 1
v_bfe_u32 v54, v50, 5, 1
v_lshl_add_u32 v53, v54, 4, v53
v_bfe_u32 v54, v50, 4, 1
v_lshl_add_u32 v53, v54, 2, v53
v_bfe_u32 v54, v50, 3, 1
v_lshl_add_u32 v53, v54, 3, v53
s_mul_i32 s38, s32, 40960
v_lshl_add_u32 v53, v53, 7, s38
v_bfe_u32 v54, v50, 0, 1
v_lshl_add_u32 v53, v54, 3, v53
v_bfe_u32 v54, v50, 1, 1
v_lshl_add_u32 v53, v54, 4, v53
s_mov_b32 s8, s18
s_and_b32 s9, s19, 0xffff
s_mov_b32 s10, 0x800000
s_mov_b32 s11, 0x20000
s_lshl_b32 s39, s32, 21
s_lshl_b32 s38, s54, 8
s_add_u32 s39, s39, s38
s_add_u32 s39, s39, 1572864
s_mul_i32 s38, s32, 40960
s_add_u32 m0, s38, 0
s_nop 0
buffer_load_dwordx4 v52, s[8:11], s39 offen lds
s_add_u32 m0, m0, 1024
s_add_u32 s39, s39, 65536
buffer_load_dwordx4 v52, s[8:11], s39 offen lds
s_add_u32 m0, m0, 1024
s_add_u32 s39, s39, 65536
buffer_load_dwordx4 v52, s[8:11], s39 offen lds
s_add_u32 m0, m0, 1024
s_add_u32 s39, s39, 65536
buffer_load_dwordx4 v52, s[8:11], s39 offen lds
s_add_u32 m0, m0, 1024
s_add_u32 s39, s39, 65536
buffer_load_dwordx4 v52, s[8:11], s39 offen lds
s_add_u32 m0, m0, 1024
s_add_u32 s39, s39, 65536
buffer_load_dwordx4 v52, s[8:11], s39 offen lds
s_add_u32 m0, m0, 1024
s_add_u32 s39, s39, 65536
buffer_load_dwordx4 v52, s[8:11], s39 offen lds
s_add_u32 m0, m0, 1024
s_add_u32 s39, s39, 65536
buffer_load_dwordx4 v52, s[8:11], s39 offen lds
s_lshl_b32 s39, s32, 21
s_lshl_b32 s38, s54, 8
s_add_u32 s39, s39, s38
s_add_u32 s39, s39, 1572864
s_mul_i32 s38, s32, 40960
s_add_u32 m0, s38, 8192
s_nop 0
buffer_load_dwordx4 v51, s[8:11], s39 offen lds
s_add_u32 m0, m0, 1024
s_add_u32 s39, s39, 65536
buffer_load_dwordx4 v51, s[8:11], s39 offen lds
s_add_u32 m0, m0, 1024
s_add_u32 s39, s39, 65536
buffer_load_dwordx4 v51, s[8:11], s39 offen lds
s_add_u32 m0, m0, 1024
s_add_u32 s39, s39, 65536
buffer_load_dwordx4 v51, s[8:11], s39 offen lds
s_add_u32 m0, m0, 1024
s_add_u32 s39, s39, 65536
buffer_load_dwordx4 v51, s[8:11], s39 offen lds
s_add_u32 m0, m0, 1024
s_add_u32 s39, s39, 65536
buffer_load_dwordx4 v51, s[8:11], s39 offen lds
s_add_u32 m0, m0, 1024
s_add_u32 s39, s39, 65536
buffer_load_dwordx4 v51, s[8:11], s39 offen lds
s_add_u32 m0, m0, 1024
s_add_u32 s39, s39, 65536
buffer_load_dwordx4 v51, s[8:11], s39 offen lds
s_lshl_b32 s39, s32, 21
s_lshl_b32 s38, s54, 8
s_add_u32 s39, s39, s38
s_add_u32 s39, s39, 1048576
s_mul_i32 s38, s32, 40960
s_add_u32 m0, s38, 16384
s_nop 0
buffer_load_dwordx4 v52, s[8:11], s39 offen lds
s_add_u32 m0, m0, 1024
s_add_u32 s39, s39, 65536
buffer_load_dwordx4 v52, s[8:11], s39 offen lds
s_add_u32 m0, m0, 1024
s_add_u32 s39, s39, 65536
buffer_load_dwordx4 v52, s[8:11], s39 offen lds
s_add_u32 m0, m0, 1024
s_add_u32 s39, s39, 65536
buffer_load_dwordx4 v52, s[8:11], s39 offen lds
s_add_u32 m0, m0, 1024
s_add_u32 s39, s39, 65536
buffer_load_dwordx4 v52, s[8:11], s39 offen lds
s_add_u32 m0, m0, 1024
s_add_u32 s39, s39, 65536
buffer_load_dwordx4 v52, s[8:11], s39 offen lds
s_add_u32 m0, m0, 1024
s_add_u32 s39, s39, 65536
buffer_load_dwordx4 v52, s[8:11], s39 offen lds
s_add_u32 m0, m0, 1024
s_add_u32 s39, s39, 65536
buffer_load_dwordx4 v52, s[8:11], s39 offen lds
s_lshl_b32 s39, s32, 21
s_lshl_b32 s38, s54, 8
s_add_u32 s39, s39, s38
s_add_u32 s39, s39, 1048576
s_mul_i32 s38, s32, 40960
s_add_u32 m0, s38, 24576
s_nop 0
buffer_load_dwordx4 v51, s[8:11], s39 offen lds
s_add_u32 m0, m0, 1024
s_add_u32 s39, s39, 65536
buffer_load_dwordx4 v51, s[8:11], s39 offen lds
s_add_u32 m0, m0, 1024
s_add_u32 s39, s39, 65536
buffer_load_dwordx4 v51, s[8:11], s39 offen lds
s_add_u32 m0, m0, 1024
s_add_u32 s39, s39, 65536
buffer_load_dwordx4 v51, s[8:11], s39 offen lds
s_add_u32 m0, m0, 1024
s_add_u32 s39, s39, 65536
buffer_load_dwordx4 v51, s[8:11], s39 offen lds
s_add_u32 m0, m0, 1024
s_add_u32 s39, s39, 65536
buffer_load_dwordx4 v51, s[8:11], s39 offen lds
s_add_u32 m0, m0, 1024
s_add_u32 s39, s39, 65536
buffer_load_dwordx4 v51, s[8:11], s39 offen lds
s_add_u32 m0, m0, 1024
s_add_u32 s39, s39, 65536
buffer_load_dwordx4 v51, s[8:11], s39 offen lds
s_lshl_b32 s39, s32, 21
s_lshl_b32 s38, s54, 8
s_add_u32 s39, s39, s38
s_add_u32 s39, s39, 524288
s_mul_i32 s38, s32, 40960
s_add_u32 m0, s38, 32768
s_nop 0
buffer_load_dwordx4 v52, s[8:11], s39 offen lds
s_add_u32 m0, m0, 1024
s_add_u32 s39, s39, 65536
buffer_load_dwordx4 v52, s[8:11], s39 offen lds
s_add_u32 m0, m0, 1024
s_add_u32 s39, s39, 65536
buffer_load_dwordx4 v52, s[8:11], s39 offen lds
s_add_u32 m0, m0, 1024
s_add_u32 s39, s39, 65536
buffer_load_dwordx4 v52, s[8:11], s39 offen lds
s_add_u32 m0, m0, 1024
s_add_u32 s39, s39, 65536
buffer_load_dwordx4 v52, s[8:11], s39 offen lds
s_add_u32 m0, m0, 1024
s_add_u32 s39, s39, 65536
buffer_load_dwordx4 v52, s[8:11], s39 offen lds
s_add_u32 m0, m0, 1024
s_add_u32 s39, s39, 65536
buffer_load_dwordx4 v52, s[8:11], s39 offen lds
s_add_u32 m0, m0, 1024
s_add_u32 s39, s39, 65536
buffer_load_dwordx4 v52, s[8:11], s39 offen lds
s_waitcnt vmcnt(32)
ds_read_b64_tr_b16 a[224:225], v53 offset:0
ds_read_b64_tr_b16 a[226:227], v53 offset:256
ds_read_b64_tr_b16 a[228:229], v53 offset:4096
ds_read_b64_tr_b16 a[230:231], v53 offset:4352
ds_read_b64_tr_b16 a[232:233], v53 offset:32
ds_read_b64_tr_b16 a[234:235], v53 offset:288
ds_read_b64_tr_b16 a[236:237], v53 offset:4128
ds_read_b64_tr_b16 a[238:239], v53 offset:4384
ds_read_b64_tr_b16 a[240:241], v53 offset:64
ds_read_b64_tr_b16 a[242:243], v53 offset:320
ds_read_b64_tr_b16 a[244:245], v53 offset:4160
ds_read_b64_tr_b16 a[246:247], v53 offset:4416
ds_read_b64_tr_b16 a[248:249], v53 offset:96
ds_read_b64_tr_b16 a[250:251], v53 offset:352
ds_read_b64_tr_b16 a[252:253], v53 offset:4192
ds_read_b64_tr_b16 a[254:255], v53 offset:4448
s_waitcnt lgkmcnt(0)
s_lshl_b32 s39, s32, 21
s_lshl_b32 s38, s54, 8
s_add_u32 s39, s39, s38
s_add_u32 s39, s39, 524288
s_mul_i32 s38, s32, 40960
s_add_u32 m0, s38, 0
s_nop 0
buffer_load_dwordx4 v51, s[8:11], s39 offen lds
s_add_u32 m0, m0, 1024
s_add_u32 s39, s39, 65536
buffer_load_dwordx4 v51, s[8:11], s39 offen lds
s_add_u32 m0, m0, 1024
s_add_u32 s39, s39, 65536
buffer_load_dwordx4 v51, s[8:11], s39 offen lds
s_add_u32 m0, m0, 1024
s_add_u32 s39, s39, 65536
buffer_load_dwordx4 v51, s[8:11], s39 offen lds
s_add_u32 m0, m0, 1024
s_add_u32 s39, s39, 65536
buffer_load_dwordx4 v51, s[8:11], s39 offen lds
s_add_u32 m0, m0, 1024
s_add_u32 s39, s39, 65536
buffer_load_dwordx4 v51, s[8:11], s39 offen lds
s_add_u32 m0, m0, 1024
s_add_u32 s39, s39, 65536
buffer_load_dwordx4 v51, s[8:11], s39 offen lds
s_add_u32 m0, m0, 1024
s_add_u32 s39, s39, 65536
buffer_load_dwordx4 v51, s[8:11], s39 offen lds
s_waitcnt vmcnt(32)
ds_read_b64_tr_b16 a[192:193], v53 offset:8192
ds_read_b64_tr_b16 a[194:195], v53 offset:8448
ds_read_b64_tr_b16 a[196:197], v53 offset:12288
ds_read_b64_tr_b16 a[198:199], v53 offset:12544
ds_read_b64_tr_b16 a[200:201], v53 offset:8224
ds_read_b64_tr_b16 a[202:203], v53 offset:8480
ds_read_b64_tr_b16 a[204:205], v53 offset:12320
ds_read_b64_tr_b16 a[206:207], v53 offset:12576
ds_read_b64_tr_b16 a[208:209], v53 offset:8256
ds_read_b64_tr_b16 a[210:211], v53 offset:8512
ds_read_b64_tr_b16 a[212:213], v53 offset:12352
ds_read_b64_tr_b16 a[214:215], v53 offset:12608
ds_read_b64_tr_b16 a[216:217], v53 offset:8288
ds_read_b64_tr_b16 a[218:219], v53 offset:8544
ds_read_b64_tr_b16 a[220:221], v53 offset:12384
ds_read_b64_tr_b16 a[222:223], v53 offset:12640
s_waitcnt lgkmcnt(0)
s_lshl_b32 s39, s32, 21
s_lshl_b32 s38, s54, 8
s_add_u32 s39, s39, s38
s_add_u32 s39, s39, 0
s_mul_i32 s38, s32, 40960
s_add_u32 m0, s38, 8192
s_nop 0
buffer_load_dwordx4 v52, s[8:11], s39 offen lds
s_add_u32 m0, m0, 1024
s_add_u32 s39, s39, 65536
buffer_load_dwordx4 v52, s[8:11], s39 offen lds
s_add_u32 m0, m0, 1024
s_add_u32 s39, s39, 65536
buffer_load_dwordx4 v52, s[8:11], s39 offen lds
s_add_u32 m0, m0, 1024
s_add_u32 s39, s39, 65536
buffer_load_dwordx4 v52, s[8:11], s39 offen lds
s_add_u32 m0, m0, 1024
s_add_u32 s39, s39, 65536
buffer_load_dwordx4 v52, s[8:11], s39 offen lds
s_add_u32 m0, m0, 1024
s_add_u32 s39, s39, 65536
buffer_load_dwordx4 v52, s[8:11], s39 offen lds
s_add_u32 m0, m0, 1024
s_add_u32 s39, s39, 65536
buffer_load_dwordx4 v52, s[8:11], s39 offen lds
s_add_u32 m0, m0, 1024
s_add_u32 s39, s39, 65536
buffer_load_dwordx4 v52, s[8:11], s39 offen lds
s_waitcnt vmcnt(32)
ds_read_b64_tr_b16 a[160:161], v53 offset:16384
ds_read_b64_tr_b16 a[162:163], v53 offset:16640
ds_read_b64_tr_b16 a[164:165], v53 offset:20480
ds_read_b64_tr_b16 a[166:167], v53 offset:20736
ds_read_b64_tr_b16 a[168:169], v53 offset:16416
ds_read_b64_tr_b16 a[170:171], v53 offset:16672
ds_read_b64_tr_b16 a[172:173], v53 offset:20512
ds_read_b64_tr_b16 a[174:175], v53 offset:20768
ds_read_b64_tr_b16 a[176:177], v53 offset:16448
ds_read_b64_tr_b16 a[178:179], v53 offset:16704
ds_read_b64_tr_b16 a[180:181], v53 offset:20544
ds_read_b64_tr_b16 a[182:183], v53 offset:20800
ds_read_b64_tr_b16 a[184:185], v53 offset:16480
ds_read_b64_tr_b16 a[186:187], v53 offset:16736
ds_read_b64_tr_b16 a[188:189], v53 offset:20576
ds_read_b64_tr_b16 a[190:191], v53 offset:20832
s_waitcnt lgkmcnt(0)
s_lshl_b32 s39, s32, 21
s_lshl_b32 s38, s54, 8
s_add_u32 s39, s39, s38
s_add_u32 s39, s39, 0
s_mul_i32 s38, s32, 40960
s_add_u32 m0, s38, 16384
s_nop 0
buffer_load_dwordx4 v51, s[8:11], s39 offen lds
s_add_u32 m0, m0, 1024
s_add_u32 s39, s39, 65536
buffer_load_dwordx4 v51, s[8:11], s39 offen lds
s_add_u32 m0, m0, 1024
s_add_u32 s39, s39, 65536
buffer_load_dwordx4 v51, s[8:11], s39 offen lds
s_add_u32 m0, m0, 1024
s_add_u32 s39, s39, 65536
buffer_load_dwordx4 v51, s[8:11], s39 offen lds
s_add_u32 m0, m0, 1024
s_add_u32 s39, s39, 65536
buffer_load_dwordx4 v51, s[8:11], s39 offen lds
s_add_u32 m0, m0, 1024
s_add_u32 s39, s39, 65536
buffer_load_dwordx4 v51, s[8:11], s39 offen lds
s_add_u32 m0, m0, 1024
s_add_u32 s39, s39, 65536
buffer_load_dwordx4 v51, s[8:11], s39 offen lds
s_add_u32 m0, m0, 1024
s_add_u32 s39, s39, 65536
buffer_load_dwordx4 v51, s[8:11], s39 offen lds
s_waitcnt vmcnt(32)
ds_read_b64_tr_b16 a[128:129], v53 offset:24576
ds_read_b64_tr_b16 a[130:131], v53 offset:24832
ds_read_b64_tr_b16 a[132:133], v53 offset:28672
ds_read_b64_tr_b16 a[134:135], v53 offset:28928
ds_read_b64_tr_b16 a[136:137], v53 offset:24608
ds_read_b64_tr_b16 a[138:139], v53 offset:24864
ds_read_b64_tr_b16 a[140:141], v53 offset:28704
ds_read_b64_tr_b16 a[142:143], v53 offset:28960
ds_read_b64_tr_b16 a[144:145], v53 offset:24640
ds_read_b64_tr_b16 a[146:147], v53 offset:24896
ds_read_b64_tr_b16 a[148:149], v53 offset:28736
ds_read_b64_tr_b16 a[150:151], v53 offset:28992
ds_read_b64_tr_b16 a[152:153], v53 offset:24672
ds_read_b64_tr_b16 a[154:155], v53 offset:24928
ds_read_b64_tr_b16 a[156:157], v53 offset:28768
ds_read_b64_tr_b16 a[158:159], v53 offset:29024
s_waitcnt lgkmcnt(0)
s_waitcnt vmcnt(24)
ds_read_b64_tr_b16 a[96:97], v53 offset:32768
ds_read_b64_tr_b16 a[98:99], v53 offset:33024
ds_read_b64_tr_b16 a[100:101], v53 offset:36864
ds_read_b64_tr_b16 a[102:103], v53 offset:37120
ds_read_b64_tr_b16 a[104:105], v53 offset:32800
ds_read_b64_tr_b16 a[106:107], v53 offset:33056
ds_read_b64_tr_b16 a[108:109], v53 offset:36896
ds_read_b64_tr_b16 a[110:111], v53 offset:37152
ds_read_b64_tr_b16 a[112:113], v53 offset:32832
ds_read_b64_tr_b16 a[114:115], v53 offset:33088
ds_read_b64_tr_b16 a[116:117], v53 offset:36928
ds_read_b64_tr_b16 a[118:119], v53 offset:37184
ds_read_b64_tr_b16 a[120:121], v53 offset:32864
ds_read_b64_tr_b16 a[122:123], v53 offset:33120
ds_read_b64_tr_b16 a[124:125], v53 offset:36960
ds_read_b64_tr_b16 a[126:127], v53 offset:37216
s_waitcnt lgkmcnt(0)
s_waitcnt vmcnt(16)
ds_read_b64_tr_b16 a[64:65], v53 offset:0
ds_read_b64_tr_b16 a[66:67], v53 offset:256
ds_read_b64_tr_b16 a[68:69], v53 offset:4096
ds_read_b64_tr_b16 a[70:71], v53 offset:4352
ds_read_b64_tr_b16 a[72:73], v53 offset:32
ds_read_b64_tr_b16 a[74:75], v53 offset:288
ds_read_b64_tr_b16 a[76:77], v53 offset:4128
ds_read_b64_tr_b16 a[78:79], v53 offset:4384
ds_read_b64_tr_b16 a[80:81], v53 offset:64
ds_read_b64_tr_b16 a[82:83], v53 offset:320
ds_read_b64_tr_b16 a[84:85], v53 offset:4160
ds_read_b64_tr_b16 a[86:87], v53 offset:4416
ds_read_b64_tr_b16 a[88:89], v53 offset:96
ds_read_b64_tr_b16 a[90:91], v53 offset:352
ds_read_b64_tr_b16 a[92:93], v53 offset:4192
ds_read_b64_tr_b16 a[94:95], v53 offset:4448
s_waitcnt lgkmcnt(0)
s_waitcnt vmcnt(8)
ds_read_b64_tr_b16 a[32:33], v53 offset:8192
ds_read_b64_tr_b16 a[34:35], v53 offset:8448
ds_read_b64_tr_b16 a[36:37], v53 offset:12288
ds_read_b64_tr_b16 a[38:39], v53 offset:12544
ds_read_b64_tr_b16 a[40:41], v53 offset:8224
ds_read_b64_tr_b16 a[42:43], v53 offset:8480
ds_read_b64_tr_b16 a[44:45], v53 offset:12320
ds_read_b64_tr_b16 a[46:47], v53 offset:12576
ds_read_b64_tr_b16 a[48:49], v53 offset:8256
ds_read_b64_tr_b16 a[50:51], v53 offset:8512
ds_read_b64_tr_b16 a[52:53], v53 offset:12352
ds_read_b64_tr_b16 a[54:55], v53 offset:12608
ds_read_b64_tr_b16 a[56:57], v53 offset:8288
ds_read_b64_tr_b16 a[58:59], v53 offset:8544
ds_read_b64_tr_b16 a[60:61], v53 offset:12384
ds_read_b64_tr_b16 a[62:63], v53 offset:12640
s_waitcnt lgkmcnt(0)
s_waitcnt vmcnt(0)
ds_read_b64_tr_b16 a[0:1], v53 offset:16384
ds_read_b64_tr_b16 a[2:3], v53 offset:16640
ds_read_b64_tr_b16 a[4:5], v53 offset:20480
ds_read_b64_tr_b16 a[6:7], v53 offset:20736
ds_read_b64_tr_b16 a[8:9], v53 offset:16416
ds_read_b64_tr_b16 a[10:11], v53 offset:16672
ds_read_b64_tr_b16 a[12:13], v53 offset:20512
ds_read_b64_tr_b16 a[14:15], v53 offset:20768
ds_read_b64_tr_b16 a[16:17], v53 offset:16448
ds_read_b64_tr_b16 a[18:19], v53 offset:16704
ds_read_b64_tr_b16 a[20:21], v53 offset:20544
ds_read_b64_tr_b16 a[22:23], v53 offset:20800
ds_read_b64_tr_b16 a[24:25], v53 offset:16480
ds_read_b64_tr_b16 a[26:27], v53 offset:16736
ds_read_b64_tr_b16 a[28:29], v53 offset:20576
ds_read_b64_tr_b16 a[30:31], v53 offset:20832
s_waitcnt lgkmcnt(0)
s_cmp_lg_u32 s54, 0
s_cbranch_scc1 Lnp_12
s_barrier
s_mov_b32 s52, 0x2000000
s_cmp_lg_u32 s32, 0
s_cbranch_scc1 Lpb_13
v_lshlrev_b32 v52, 8, v50
v_mov_b32 v53, -1
s_mov_b32 s53, 32768
buffer_store_dword v53, v52, s[4:7], s53 offen sc1
s_waitcnt vmcnt(0)
s_mov_b64 exec, 1
s_mov_b32 s60, -1
s_mov_b32 s61, -1
v_mov_b32 v52, 0
s_mov_b32 s66, 5
Lpl_14:
s_memtime s[62:63]
s_waitcnt lgkmcnt(0)
buffer_load_dword v53, v52, s[4:7], s53 offen sc1
s_waitcnt vmcnt(0)
s_memtime s[64:65]
s_waitcnt lgkmcnt(0)
s_sub_u32 s62, s64, s62
s_min_u32 s60, s60, s62
v_add_u32 v52, 8192, v52
s_memtime s[62:63]
s_waitcnt lgkmcnt(0)
buffer_load_dword v53, v52, s[4:7], s53 offen sc1
s_waitcnt vmcnt(0)
s_memtime s[64:65]
s_waitcnt lgkmcnt(0)
s_sub_u32 s62, s64, s62
s_min_u32 s61, s61, s62
v_add_u32 v52, -6912, v52
s_sub_u32 s66, s66, 1
s_cmp_lg_u32 s66, 0
s_cbranch_scc1 Lpl_14
s_mov_b64 exec, -1
s_cmp_lt_u32 s61, s60
s_cselect_b32 s62, 1, 0
s_lshr_b32 s63, s51, 2
s_xor_b32 s62, s62, s63
s_lshl_b32 s62, s62, 24
s_or_b32 s52, s52, s62
Lpb_13:
s_waitcnt vmcnt(0)
s_barrier
s_cmp_lg_u32 s32, 0
s_cbranch_scc1 Lar_15
s_mov_b64 exec, 1
v_mov_b32 v48, 16
v_mov_b32 v49, s52
buffer_atomic_add v49, v48, s[12:15], 0 offen sc1
s_mov_b64 exec, -1
Lar_15:
Lnp_12:
Lst_16:
buffer_load_dword v48, off, s[12:15], 0 offset:16 sc1
buffer_load_dword v49, off, s[12:15], 0 offset:144 sc1
s_waitcnt vmcnt(0)
v_add_u32 v48, v48, v49
s_nop 0
v_readfirstlane_b32 s38, v48
s_nop 3
s_and_b32 s39, s38, 0x200ffff
s_cmp_eq_u32 s39, 0x2000100
s_cbranch_scc1 Lso_17
s_sub_u32 s37, s37, 1
s_cbranch_scc1 Lend_1
s_sleep 8
s_branch Lst_16
Lso_17:
s_bfe_u32 s35, s38, 0x80010
s_bfe_u32 s46, s38, 0x10018
s_lshl_b32 s46, s46, 13
s_barrier
s_mul_i32 s47, s54, 24576
s_add_u32 s47, s47, 33554432
s_mov_b32 s36, 0
s_mov_b32 s27, 1
Lbw_18:
buffer_load_dword v209, v208, s[4:7], 0 offen sc1
s_waitcnt vmcnt(0)
v_add_u32 v44, v209, v210
v_cmp_gt_u32 vcc, s27, v44
s_cbranch_vccz Lbo_19
s_sub_u32 s37, s37, 1
s_cbranch_scc1 Lend_1
s_sleep 2
s_branch Lbw_18
Lbo_19:
s_mov_b32 m0, s57
s_add_u32 s52, s47, 3072
buffer_load_dwordx4 v21, s[4:7], s47 offen offset:0 sc1 lds
buffer_load_dwordx4 v21, s[4:7], s47 offen offset:1024 sc1 lds
buffer_load_dwordx4 v21, s[4:7], s47 offen offset:2048 sc1 lds
s_add_u32 m0, s57, 3072
s_xor_b32 s57, s57, 98304
buffer_load_dwordx4 v21, s[4:7], s52 offen offset:0 sc1 lds
buffer_load_dwordx4 v21, s[4:7], s52 offen offset:1024 sc1 lds
buffer_load_dwordx4 v21, s[4:7], s52 offen offset:2048 sc1 lds
s_add_u32 s47, s47, 786432
s_cmp_lg_u32 s35, 0
s_cbranch_scc1 Lq_sc1_20
Lq_21:
s_cmp_gt_u32 s36, 3
s_cbranch_scc1 Lqf_22
s_waitcnt vmcnt(0)
s_barrier
Lqf_22:
ds_read_b128 v[128:131], v22 offset:0
ds_read_b128 v[132:135], v22 offset:1024
ds_read_b128 v[136:139], v22 offset:2048
ds_read_b128 v[140:143], v22 offset:3072
ds_read_b128 v[144:147], v22 offset:4096
ds_read_b128 v[148:151], v22 offset:5120
ds_read_b128 v[152:155], v22 offset:6144
ds_read_b128 v[156:159], v22 offset:7168
ds_read_b128 v[160:163], v24 offset:0
ds_read_b128 v[164:167], v24 offset:1024
ds_read_b128 v[168:171], v25 offset:0
ds_read_b128 v[172:175], v25 offset:1024
ds_read_b128 v[176:179], v23 offset:0
ds_read_b128 v[180:183], v23 offset:1024
ds_read_b128 v[184:187], v23 offset:2048
ds_read_b128 v[188:191], v23 offset:3072
v_xor_b32 v22, 98304, v22
v_xor_b32 v24, 98304, v24
v_xor_b32 v25, 98304, v25
v_xor_b32 v23, 98304, v23
s_and_b32 s38, s36, 3
s_lshl_b32 s39, s38, 16
s_add_u32 s40, s39, s45
s_xor_b32 s42, s40, 0x20000
s_add_u32 s26, s36, 1
v_pk_mul_f32 v[64:65], 0, 0
v_pk_mul_f32 v[66:67], 0, 0
v_pk_mul_f32 v[68:69], 0, 0
v_pk_mul_f32 v[70:71], 0, 0
v_pk_mul_f32 v[72:73], 0, 0
v_pk_mul_f32 v[74:75], 0, 0
v_pk_mul_f32 v[76:77], 0, 0
v_pk_mul_f32 v[78:79], 0, 0
v_pk_mul_f32 v[80:81], 0, 0
v_pk_mul_f32 v[82:83], 0, 0
v_pk_mul_f32 v[84:85], 0, 0
v_pk_mul_f32 v[86:87], 0, 0
v_pk_mul_f32 v[88:89], 0, 0
v_pk_mul_f32 v[90:91], 0, 0
v_pk_mul_f32 v[92:93], 0, 0
v_pk_mul_f32 v[94:95], 0, 0
v_mov_b32 v214, v197
s_waitcnt vmcnt(0)
buffer_store_dword v214, v199, s[4:7], 0 offen
v_add_u32 v197, 1, v197
s_cmp_eq_u32 s36, 63
s_cbranch_scc1 Lqz_23
s_mov_b64 exec, 15
buffer_load_dword v216, v192, s[4:7], s59 offen sc1
s_nop 5
buffer_load_dword v217, v192, s[4:7], s59 offen sc1
s_nop 5
buffer_load_dword v218, v192, s[4:7], s59 offen sc1
Lft_25:
s_waitcnt vmcnt(2)
v_cmp_gt_u32 vcc, s26, v216
buffer_load_dword v216, v192, s[4:7], s59 offen sc1
s_cbranch_vccz Lfg_24
s_waitcnt vmcnt(2)
v_cmp_gt_u32 vcc, s26, v217
buffer_load_dword v217, v192, s[4:7], s59 offen sc1
s_cbranch_vccz Lfg_24
s_waitcnt vmcnt(2)
v_cmp_gt_u32 vcc, s26, v218
buffer_load_dword v218, v192, s[4:7], s59 offen sc1
s_cbranch_vccz Lfg_24
s_sub_u32 s37, s37, 1
s_cbranch_scc1 Lend_1
s_branch Lft_25
Lfg_24:
s_mov_b64 exec, -1
buffer_load_dwordx4 v[48:51], v10, s[4:7], s40 offen offset:0 sc1
s_nop 11
buffer_load_dwordx4 v[52:55], v10, s[4:7], s40 offen offset:1024 sc1
s_nop 11
buffer_load_dwordx4 v[56:59], v10, s[4:7], s40 offen offset:2048 sc1
s_nop 11
buffer_load_dwordx4 v[60:63], v10, s[4:7], s40 offen offset:3072 sc1
s_nop 11
s_waitcnt vmcnt(3)
v_max3_u32 v44, v48, v49, v50
v_max_u32 v44, v44, v51
v_cmp_eq_u32 vcc, -1, v44
s_cbranch_vccnz Lpf_27
v_smfmac_f32_16x16x64_bf16 v[64:67], v[48:51], a[0:7], v15
v_smfmac_f32_16x16x64_bf16 v[68:71], v[48:51], a[8:15], v15
v_smfmac_f32_16x16x64_bf16 v[72:75], v[48:51], a[16:23], v15
s_waitcnt vmcnt(2)
v_max3_u32 v44, v52, v53, v54
v_max_u32 v44, v44, v55
v_cmp_eq_u32 vcc, -1, v44
v_smfmac_f32_16x16x64_bf16 v[76:79], v[48:51], a[24:31], v15
v_smfmac_f32_16x16x64_bf16 v[80:83], v[48:51], a[32:39], v15
v_smfmac_f32_16x16x64_bf16 v[84:87], v[48:51], a[40:47], v15
s_cbranch_vccnz Lpf_28
v_smfmac_f32_16x16x64_bf16 v[64:67], v[52:55], a[64:71], v15
v_smfmac_f32_16x16x64_bf16 v[68:71], v[52:55], a[72:79], v15
v_smfmac_f32_16x16x64_bf16 v[72:75], v[52:55], a[80:87], v15
s_waitcnt vmcnt(0)
v_max3_u32 v44, v56, v57, v58
v_max3_u32 v44, v44, v59, v60
v_max3_u32 v44, v44, v61, v62
v_max_u32 v44, v44, v63
v_cmp_eq_u32 vcc, -1, v44
v_smfmac_f32_16x16x64_bf16 v[76:79], v[52:55], a[88:95], v15
v_smfmac_f32_16x16x64_bf16 v[80:83], v[52:55], a[96:103], v15
v_smfmac_f32_16x16x64_bf16 v[84:87], v[52:55], a[104:111], v15
s_cbranch_vccnz Lpj_29
v_smfmac_f32_16x16x64_bf16 v[64:67], v[56:59], a[128:135], v15
s_nop 1
v_smfmac_f32_16x16x64_bf16 v[64:67], v[60:63], a[192:199], v15
s_nop 1
v_smfmac_f32_16x16x64_bf16 v[68:71], v[56:59], a[136:143], v15
s_nop 1
v_smfmac_f32_16x16x64_bf16 v[68:71], v[60:63], a[200:207], v15
s_nop 1
v_smfmac_f32_16x16x64_bf16 v[72:75], v[56:59], a[144:151], v15
v_add_f32 v96, v64, v66
v_add_f32 v97, v65, v67
v_smfmac_f32_16x16x64_bf16 v[72:75], v[60:63], a[208:215], v15
s_nop 1
v_smfmac_f32_16x16x64_bf16 v[76:79], v[56:59], a[152:159], v15
v_add_f32 v98, v68, v70
v_add_f32 v99, v69, v71
v_smfmac_f32_16x16x64_bf16 v[76:79], v[60:63], a[216:223], v15
ds_write_b128 v211, v[96:99] offset:0
s_nop 0
v_smfmac_f32_16x16x64_bf16 v[80:83], v[56:59], a[160:167], v15
v_add_f32 v100, v72, v74
v_add_f32 v101, v73, v75
v_smfmac_f32_16x16x64_bf16 v[80:83], v[60:63], a[224:231], v15
s_nop 1
v_smfmac_f32_16x16x64_bf16 v[84:87], v[56:59], a[168:175], v15
v_add_f32 v102, v76, v78
v_add_f32 v103, v77, v79
v_smfmac_f32_16x16x64_bf16 v[84:87], v[60:63], a[232:239], v15
ds_write_b128 v212, v[100:103] offset:0
s_nop 0
v_smfmac_f32_16x16x64_bf16 v[88:91], v[48:51], a[48:55], v15
v_add_f32 v104, v80, v82
v_add_f32 v105, v81, v83
v_smfmac_f32_16x16x64_bf16 v[88:91], v[52:55], a[112:119], v15
s_nop 1
v_add_f32 v106, v84, v86
v_add_f32 v107, v85, v87
ds_write_b128 v213, v[104:107] offset:0
Lpd_26:
v_smfmac_f32_16x16x64_bf16 v[88:91], v[56:59], a[176:183], v15
v_smfmac_f32_16x16x64_bf16 v[88:91], v[60:63], a[240:247], v15
v_smfmac_f32_16x16x64_bf16 v[92:95], v[48:51], a[56:63], v15
v_smfmac_f32_16x16x64_bf16 v[92:95], v[52:55], a[120:127], v15
s_waitcnt lgkmcnt(0)
s_barrier
ds_read_b128 v[76:79], v18 offset:0
ds_read_b128 v[80:83], v18 offset:1024
ds_read_b128 v[84:87], v18 offset:2048
v_smfmac_f32_16x16x64_bf16 v[92:95], v[56:59], a[184:191], v15
v_smfmac_f32_16x16x64_bf16 v[92:95], v[60:63], a[248:255], v15
v_mov_b32 v72, 0
v_mov_b32 v73, 0
v_mov_b32 v74, 0
v_mov_b32 v75, 0
v_add_f32 v108, v88, v90
v_add_f32 v109, v89, v91
s_nop 1
v_add_f32 v110, v92, v94
v_add_f32 v111, v93, v95
s_waitcnt lgkmcnt(0)
v_pk_add_f32 v[76:77], v[76:77], v[108:109]
v_pk_add_f32 v[80:81], v[80:81], v[84:85]
v_pk_add_f32 v[78:79], v[78:79], v[110:111]
v_pk_add_f32 v[82:83], v[82:83], v[86:87]
v_pk_add_f32 v[76:77], v[76:77], v[80:81]
v_pk_add_f32 v[78:79], v[78:79], v[82:83]
v_cvt_pk_bf16_f32 v76, v76, v77
v_cvt_pk_bf16_f32 v77, v78, v79
ds_write2st64_b32 v19, v76, v77 offset0:48 offset1:49
buffer_load_dwordx4 v[112:115], v11, s[4:7], s40 offen offset:0 sc1
buffer_load_dwordx4 v[116:119], v11, s[4:7], s40 offen offset:1024 sc1
s_waitcnt lgkmcnt(0)
s_barrier
ds_read_b64_tr_b16 v[96:97], v20 offset:12288
ds_read_b64_tr_b16 v[98:99], v20 offset:12544
ds_read_b64_tr_b16 v[100:101], v20 offset:12800
ds_read_b64_tr_b16 v[102:103], v20 offset:13056
ds_read_b64_tr_b16 v[104:105], v20 offset:13312
ds_read_b64_tr_b16 v[106:107], v20 offset:13568
ds_read_b64_tr_b16 v[108:109], v20 offset:13824
ds_read_b64_tr_b16 v[110:111], v20 offset:14080
s_waitcnt lgkmcnt(6)
v_mfma_f32_16x16x32_bf16 v[64:67], v[128:131], v[96:99], 0
v_mfma_f32_16x16x32_bf16 v[68:71], v[144:147], v[96:99], 0
s_waitcnt lgkmcnt(4)
buffer_load_dwordx4 v[48:51], v11, s[4:7], s40 offen offset:0 sc1
v_mfma_f32_16x16x32_bf16 v[64:67], v[132:135], v[100:103], v[64:67]
v_mfma_f32_16x16x32_bf16 v[68:71], v[148:151], v[100:103], v[68:71]
s_waitcnt lgkmcnt(2)
buffer_load_dwordx4 v[52:55], v11, s[4:7], s40 offen offset:1024 sc1
v_mfma_f32_16x16x32_bf16 v[64:67], v[136:139], v[104:107], v[64:67]
v_mfma_f32_16x16x32_bf16 v[68:71], v[152:155], v[104:107], v[68:71]
s_waitcnt lgkmcnt(0)
s_waitcnt vmcnt(2)
v_max3_u32 v44, v112, v113, v114
v_max3_u32 v44, v44, v115, v116
v_max3_u32 v44, v44, v117, v118
v_max_u32 v44, v44, v119
v_cmp_eq_u32 vcc, -1, v44
v_mfma_f32_16x16x32_bf16 v[64:67], v[140:143], v[108:111], v[64:67]
v_mfma_f32_16x16x32_bf16 v[68:71], v[156:159], v[108:111], v[68:71]
s_cbranch_vccnz Lkr_30
v_smfmac_f32_16x16x64_bf16 v[72:75], v[112:115], v[96:103], v15
v_smfmac_f32_16x16x64_bf16 v[72:75], v[116:119], v[104:111], v15
Lko_31:
s_nop 3
v_max3_f32 v45, v64, v65, v66
v_max3_f32 v45, v45, v67, v68
v_max3_f32 v45, v45, v69, v70
v_max_f32 v45, v45, v71
v_pk_add_f32 v[72:73], v[72:73], v[74:75]
v_max3_f32 v46, v45, v72, v73
v_max3_f32 v47, v45, v72, v73
buffer_load_dwordx2 v[120:121], v12, s[4:7], s40 offen sc1
buffer_load_dwordx2 v[122:123], v13, s[4:7], s40 offen sc1
v_permlane32_swap_b32 v46, v47
v_max_f32 v45, v46, v47
v_max_f32 v46, v46, v47
s_nop 1
v_permlane16_swap_b32 v45, v46
v_max_f32 v45, v45, v46
v_mul_f32 v46, s49, v45
v_pk_fma_f32 v[64:65], v[64:65], s[48:49], v[46:47] op_sel_hi:[1,0,0]
v_pk_fma_f32 v[66:67], v[66:67], s[48:49], v[46:47] op_sel_hi:[1,0,0]
v_pk_fma_f32 v[68:69], v[68:69], s[48:49], v[46:47] op_sel_hi:[1,0,0]
v_pk_fma_f32 v[70:71], v[70:71], s[48:49], v[46:47] op_sel_hi:[1,0,0]
v_pk_fma_f32 v[72:73], v[72:73], s[48:49], v[46:47] op_sel_hi:[1,0,0]
v_exp_f32 v64, v64
v_exp_f32 v65, v65
v_exp_f32 v66, v66
v_exp_f32 v67, v67
v_exp_f32 v68, v68
v_exp_f32 v69, v69
v_exp_f32 v70, v70
v_exp_f32 v71, v71
v_exp_f32 v72, v72
v_exp_f32 v73, v73
buffer_store_dword v197, v193, s[4:7], s59 offen
v_cvt_pk_bf16_f32 v76, v64, v65
v_cvt_pk_bf16_f32 v77, v66, v67
v_cvt_pk_bf16_f32 v78, v68, v69
v_cvt_pk_bf16_f32 v79, v70, v71
v_cvt_pk_bf16_f32 v2, v72, v73
v_cvt_pk_bf16_f32 v7, v72, v73
v_mfma_f32_16x16x32_bf16 v[84:87], v[32:35], v[76:79], 0
v_mfma_f32_16x16x32_bf16 v[84:87], v[32:35], v[2:5], v[84:87]
v_mfma_f32_16x16x32_bf16 v[96:99], v[160:163], v[76:79], 0
s_waitcnt vmcnt(1)
v_max3_u32 v44, v120, v121, v122
v_max_u32 v44, v44, v123
v_cmp_eq_u32 vcc, -1, v44
v_mfma_f32_16x16x32_bf16 v[100:103], v[164:167], v[76:79], 0
s_cbranch_vccnz Lvr_32
Lvo_33:
v_mfma_f32_16x16x32_bf16 v[96:99], v[120:123], v[2:5], v[96:99]
v_mfma_f32_16x16x32_bf16 v[100:103], v[120:123], v[6:9], v[100:103]
v_rcp_f32 v46, v84
s_nop 5
v_pk_mul_f32 v[96:97], v[96:97], v[46:47] op_sel_hi:[1,0]
v_pk_mul_f32 v[98:99], v[98:99], v[46:47] op_sel_hi:[1,0]
v_pk_mul_f32 v[100:101], v[100:101], v[46:47] op_sel_hi:[1,0]
v_pk_mul_f32 v[102:103], v[102:103], v[46:47] op_sel_hi:[1,0]
v_cvt_pk_bf16_f32 v124, v96, v97
v_cvt_pk_bf16_f32 v125, v98, v99
v_cvt_pk_bf16_f32 v126, v100, v101
v_cvt_pk_bf16_f32 v127, v102, v103
buffer_store_dwordx4 v[124:127], v14, s[4:7], s40 offen
s_barrier
buffer_store_dwordx4 v[28:31], v14, s[4:7], s42 offen
s_cmp_eq_u32 s36, 2
s_cbranch_scc1 Lp2_36
Lp1_37:
s_add_u32 s27, s27, 1
s_min_u32 s27, s27, 64
v_add_u32 v44, v209, v210
v_cmp_gt_u32 vcc, s27, v44
v_mov_b32 v72, 0
v_mov_b32 v73, 0
v_mov_b32 v74, 0
v_mov_b32 v75, 0
s_add_u32 s38, s36, 2
s_and_b32 s38, s38, 3
s_lshl_b32 s88, s38, 18
s_add_u32 s88, s88, s46
s_add_u32 s89, s88, 0x100000
s_cmp_lt_u32 s36, 62
s_cselect_b32 s53, s47, 0x70000000
s_cbranch_vccnz Lpw_34
Lpk_35:
buffer_store_dwordx2 v[28:29], v198, s[4:7], s88 offen sc1
buffer_store_dwordx2 v[28:29], v198, s[4:7], s89 offen sc1
v_mfma_f32_16x16x32_bf16 v[64:67], v[128:131], v[176:179], v[36:39]
v_mfma_f32_16x16x32_bf16 v[68:71], v[144:147], v[176:179], v[40:43]
s_mov_b32 m0, s57
s_add_u32 s52, s53, 3072
buffer_load_dwordx4 v21, s[4:7], s53 offen offset:0 sc1 lds
v_mfma_f32_16x16x32_bf16 v[64:67], v[132:135], v[180:183], v[64:67]
v_mfma_f32_16x16x32_bf16 v[68:71], v[148:151], v[180:183], v[68:71]
v_mfma_f32_16x16x32_bf16 v[64:67], v[136:139], v[184:187], v[64:67]
v_mfma_f32_16x16x32_bf16 v[68:71], v[152:155], v[184:187], v[68:71]
buffer_load_dwordx4 v21, s[4:7], s53 offen offset:1024 sc1 lds
v_mfma_f32_16x16x32_bf16 v[64:67], v[140:143], v[188:191], v[64:67]
v_mfma_f32_16x16x32_bf16 v[68:71], v[156:159], v[188:191], v[68:71]
v_smfmac_f32_16x16x64_bf16 v[72:75], v[112:115], v[176:183], v15
v_smfmac_f32_16x16x64_bf16 v[72:75], v[116:119], v[184:191], v15
s_and_b32 s38, s36, 7
s_lshl_b32 s38, s38, 18
s_add_u32 s50, s38, 83886080
buffer_load_dwordx4 v21, s[4:7], s53 offen offset:2048 sc1 lds
s_nop 1
v_max3_f32 v45, v64, v65, v66
v_max3_f32 v45, v45, v67, v68
v_max3_f32 v45, v45, v69, v70
v_max_f32 v45, v45, v71
v_pk_add_f32 v[72:73], v[72:73], v[74:75]
v_max3_f32 v46, v45, v72, v73
v_max3_f32 v47, v45, v72, v73
s_nop 1
v_permlane32_swap_b32 v46, v47
v_max_f32 v45, v46, v47
v_max_f32 v46, v46, v47
s_nop 1
v_permlane16_swap_b32 v45, v46
v_max_f32 v45, v45, v46
v_mul_f32 v46, s49, v45
s_add_u32 m0, s57, 3072
s_xor_b32 s57, s57, 98304
buffer_load_dwordx4 v21, s[4:7], s52 offen offset:0 sc1 lds
v_pk_fma_f32 v[64:65], v[64:65], s[48:49], v[46:47] op_sel_hi:[1,0,0]
v_pk_fma_f32 v[66:67], v[66:67], s[48:49], v[46:47] op_sel_hi:[1,0,0]
v_pk_fma_f32 v[68:69], v[68:69], s[48:49], v[46:47] op_sel_hi:[1,0,0]
v_pk_fma_f32 v[70:71], v[70:71], s[48:49], v[46:47] op_sel_hi:[1,0,0]
v_pk_fma_f32 v[72:73], v[72:73], s[48:49], v[46:47] op_sel_hi:[1,0,0]
v_exp_f32 v64, v64
v_exp_f32 v65, v65
v_exp_f32 v66, v66
v_exp_f32 v67, v67
v_exp_f32 v68, v68
buffer_load_dwordx4 v21, s[4:7], s52 offen offset:1024 sc1 lds
v_exp_f32 v69, v69
v_exp_f32 v70, v70
v_exp_f32 v71, v71
v_exp_f32 v72, v72
v_exp_f32 v73, v73
buffer_load_dwordx4 v21, s[4:7], s52 offen offset:2048 sc1 lds
s_add_u32 s47, s47, 786432
buffer_load_dword v209, v208, s[4:7], 0 offen sc1
v_cvt_pk_bf16_f32 v76, v64, v65
v_cvt_pk_bf16_f32 v77, v66, v67
v_cvt_pk_bf16_f32 v78, v68, v69
v_cvt_pk_bf16_f32 v79, v70, v71
v_cvt_pk_bf16_f32 v2, v72, v73
v_cvt_pk_bf16_f32 v7, v72, v73
v_mfma_f32_16x16x32_bf16 v[84:87], v[32:35], v[76:79], 0
v_mfma_f32_16x16x32_bf16 v[84:87], v[32:35], v[2:5], v[84:87]
v_mfma_f32_16x16x32_bf16 v[96:99], v[160:163], v[76:79], 0
v_mfma_f32_16x16x32_bf16 v[100:103], v[164:167], v[76:79], 0
v_mfma_f32_16x16x32_bf16 v[104:107], v[168:171], v[76:79], 0
v_mfma_f32_16x16x32_bf16 v[108:111], v[172:175], v[76:79], 0
v_mfma_f32_16x16x32_bf16 v[96:99], v[120:123], v[2:5], v[96:99]
v_mfma_f32_16x16x32_bf16 v[100:103], v[120:123], v[6:9], v[100:103]
v_mfma_f32_16x16x32_bf16 v[104:107], v[120:123], v[0:3], v[104:107]
v_mfma_f32_16x16x32_bf16 v[108:111], v[120:123], v[4:7], v[108:111]
v_rcp_f32 v46, v84
s_nop 3
v_pk_mul_f32 v[96:97], v[96:97], v[46:47] op_sel_hi:[1,0]
v_pk_mul_f32 v[98:99], v[98:99], v[46:47] op_sel_hi:[1,0]
v_pk_mul_f32 v[100:101], v[100:101], v[46:47] op_sel_hi:[1,0]
v_pk_mul_f32 v[102:103], v[102:103], v[46:47] op_sel_hi:[1,0]
v_pk_mul_f32 v[104:105], v[104:105], v[46:47] op_sel_hi:[1,0]
v_pk_mul_f32 v[106:107], v[106:107], v[46:47] op_sel_hi:[1,0]
v_pk_mul_f32 v[108:109], v[108:109], v[46:47] op_sel_hi:[1,0]
v_pk_mul_f32 v[110:111], v[110:111], v[46:47] op_sel_hi:[1,0]
v_cvt_pk_bf16_f32 v96, v96, v97
v_cvt_pk_bf16_f32 v97, v98, v99
v_cvt_pk_bf16_f32 v98, v100, v101
v_cvt_pk_bf16_f32 v99, v102, v103
v_cvt_pk_bf16_f32 v100, v104, v105
v_cvt_pk_bf16_f32 v101, v106, v107
v_cvt_pk_bf16_f32 v102, v108, v109
v_cvt_pk_bf16_f32 v103, v110, v111
buffer_store_dwordx4 v[96:99], v26, s[4:7], s50 offen
buffer_store_dwordx4 v[100:103], v27, s[4:7], s50 offen
s_add_u32 s36, s36, 1
s_cmp_lt_u32 s36, 64
s_cbranch_scc1 Lq_21
s_waitcnt vmcnt(0)
buffer_store_dword v197, v199, s[4:7], 0 offen
s_branch Lend_1
Lqz_23:
Lbw_38:
buffer_load_dwordx4 v[112:115], v11, s[4:7], s40 offen offset:0 sc1
buffer_load_dwordx4 v[116:119], v11, s[4:7], s40 offen offset:1024 sc1
buffer_load_dwordx2 v[120:121], v12, s[4:7], s40 offen sc1
buffer_load_dwordx2 v[122:123], v13, s[4:7], s40 offen sc1
s_waitcnt vmcnt(0)
v_max3_u32 v44, v112, v113, v114
v_max3_u32 v44, v44, v115, v116
v_max3_u32 v44, v44, v117, v118
v_max3_u32 v44, v44, v119, v120
v_max3_u32 v44, v44, v121, v122
v_max_u32 v44, v44, v123
v_cmp_eq_u32 vcc, -1, v44
s_cbranch_vccz Lbo_39
s_sub_u32 s37, s37, 1
s_cbranch_scc1 Lend_1
s_branch Lbw_38
Lbo_39:
s_waitcnt lgkmcnt(0)
s_barrier
s_branch Lp1_37
Lp2_36:
s_add_u32 s27, s27, 1
Lbw_40:
buffer_load_dword v209, v208, s[4:7], 0 offen sc1
s_waitcnt vmcnt(0)
v_add_u32 v44, v209, v210
v_cmp_gt_u32 vcc, s27, v44
s_cbranch_vccz Lbo_41
s_sub_u32 s37, s37, 1
s_cbranch_scc1 Lend_1
s_sleep 2
s_branch Lbw_40
Lbo_41:
s_mov_b32 m0, s57
s_add_u32 s52, s47, 3072
buffer_load_dwordx4 v21, s[4:7], s47 offen offset:0 sc1 lds
buffer_load_dwordx4 v21, s[4:7], s47 offen offset:1024 sc1 lds
buffer_load_dwordx4 v21, s[4:7], s47 offen offset:2048 sc1 lds
s_add_u32 m0, s57, 3072
s_xor_b32 s57, s57, 98304
buffer_load_dwordx4 v21, s[4:7], s52 offen offset:0 sc1 lds
buffer_load_dwordx4 v21, s[4:7], s52 offen offset:1024 sc1 lds
buffer_load_dwordx4 v21, s[4:7], s52 offen offset:2048 sc1 lds
s_add_u32 s47, s47, 786432
s_branch Lp1_37
Lpw_34:
Lbw_42:
buffer_load_dword v209, v208, s[4:7], 0 offen sc1
s_waitcnt vmcnt(0)
v_add_u32 v44, v209, v210
v_cmp_gt_u32 vcc, s27, v44
s_cbranch_vccz Lbo_43
s_sub_u32 s37, s37, 1
s_cbranch_scc1 Lend_1
s_sleep 2
s_branch Lbw_42
Lbo_43:
s_branch Lpk_35
Lpj_29:
buffer_load_dwordx4 v[56:59], v10, s[4:7], s40 offen offset:2048 sc1
buffer_load_dwordx4 v[60:63], v10, s[4:7], s40 offen offset:3072 sc1
s_sub_u32 s37, s37, 1
s_cbranch_scc1 Lend_1
s_branch Lps_44
Lpf_27:
buffer_load_dwordx4 v[48:51], v10, s[4:7], s40 offen offset:0 sc1
s_sub_u32 s37, s37, 1
s_cbranch_scc1 Lend_1
Lps_45:
s_waitcnt vmcnt(3)
v_max3_u32 v44, v52, v53, v54
v_max_u32 v44, v44, v55
v_cmp_eq_u32 vcc, -1, v44
s_cbranch_vccnz Lpf_46
v_smfmac_f32_16x16x64_bf16 v[64:67], v[52:55], a[64:71], v15
v_smfmac_f32_16x16x64_bf16 v[68:71], v[52:55], a[72:79], v15
v_smfmac_f32_16x16x64_bf16 v[72:75], v[52:55], a[80:87], v15
v_smfmac_f32_16x16x64_bf16 v[76:79], v[52:55], a[88:95], v15
v_smfmac_f32_16x16x64_bf16 v[80:83], v[52:55], a[96:103], v15
v_smfmac_f32_16x16x64_bf16 v[84:87], v[52:55], a[104:111], v15
Lps_47:
s_waitcnt vmcnt(2)
v_max3_u32 v44, v56, v57, v58
v_max_u32 v44, v44, v59
v_cmp_eq_u32 vcc, -1, v44
s_cbranch_vccnz Lpf_48
v_smfmac_f32_16x16x64_bf16 v[64:67], v[56:59], a[128:135], v15
v_smfmac_f32_16x16x64_bf16 v[68:71], v[56:59], a[136:143], v15
v_smfmac_f32_16x16x64_bf16 v[72:75], v[56:59], a[144:151], v15
v_smfmac_f32_16x16x64_bf16 v[76:79], v[56:59], a[152:159], v15
v_smfmac_f32_16x16x64_bf16 v[80:83], v[56:59], a[160:167], v15
v_smfmac_f32_16x16x64_bf16 v[84:87], v[56:59], a[168:175], v15
Lps_49:
s_waitcnt vmcnt(1)
v_max3_u32 v44, v60, v61, v62
v_max_u32 v44, v44, v63
v_cmp_eq_u32 vcc, -1, v44
s_cbranch_vccnz Lpf_50
v_smfmac_f32_16x16x64_bf16 v[64:67], v[60:63], a[192:199], v15
v_smfmac_f32_16x16x64_bf16 v[68:71], v[60:63], a[200:207], v15
v_smfmac_f32_16x16x64_bf16 v[72:75], v[60:63], a[208:215], v15
v_smfmac_f32_16x16x64_bf16 v[76:79], v[60:63], a[216:223], v15
v_smfmac_f32_16x16x64_bf16 v[80:83], v[60:63], a[224:231], v15
v_smfmac_f32_16x16x64_bf16 v[84:87], v[60:63], a[232:239], v15
Lps_51:
s_waitcnt vmcnt(0)
v_max3_u32 v44, v48, v49, v50
v_max_u32 v44, v44, v51
v_cmp_eq_u32 vcc, -1, v44
s_cbranch_vccnz Lpf_52
v_smfmac_f32_16x16x64_bf16 v[64:67], v[48:51], a[0:7], v15
s_nop 1
v_smfmac_f32_16x16x64_bf16 v[68:71], v[48:51], a[8:15], v15
s_nop 1
v_smfmac_f32_16x16x64_bf16 v[72:75], v[48:51], a[16:23], v15
s_nop 1
v_smfmac_f32_16x16x64_bf16 v[76:79], v[48:51], a[24:31], v15
v_add_f32 v96, v64, v66
v_add_f32 v97, v65, v67
v_smfmac_f32_16x16x64_bf16 v[80:83], v[48:51], a[32:39], v15
v_add_f32 v98, v68, v70
v_add_f32 v99, v69, v71
v_smfmac_f32_16x16x64_bf16 v[84:87], v[48:51], a[40:47], v15
v_add_f32 v100, v72, v74
v_add_f32 v101, v73, v75
ds_write_b128 v211, v[96:99] offset:0
v_smfmac_f32_16x16x64_bf16 v[88:91], v[48:51], a[48:55], v15
v_add_f32 v102, v76, v78
v_add_f32 v103, v77, v79
v_add_f32 v104, v80, v82
v_add_f32 v105, v81, v83
ds_write_b128 v212, v[100:103] offset:0
v_smfmac_f32_16x16x64_bf16 v[88:91], v[52:55], a[112:119], v15
v_add_f32 v106, v84, v86
v_add_f32 v107, v85, v87
ds_write_b128 v213, v[104:107] offset:0
s_branch Lpd_26
Lpf_28:
buffer_load_dwordx4 v[52:55], v10, s[4:7], s40 offen offset:1024 sc1
s_sub_u32 s37, s37, 1
s_cbranch_scc1 Lend_1
Lps_53:
s_waitcnt vmcnt(2)
v_max3_u32 v44, v56, v57, v58
v_max_u32 v44, v44, v59
v_cmp_eq_u32 vcc, -1, v44
s_cbranch_vccnz Lpf_54
v_smfmac_f32_16x16x64_bf16 v[64:67], v[56:59], a[128:135], v15
v_smfmac_f32_16x16x64_bf16 v[68:71], v[56:59], a[136:143], v15
v_smfmac_f32_16x16x64_bf16 v[72:75], v[56:59], a[144:151], v15
v_smfmac_f32_16x16x64_bf16 v[76:79], v[56:59], a[152:159], v15
v_smfmac_f32_16x16x64_bf16 v[80:83], v[56:59], a[160:167], v15
v_smfmac_f32_16x16x64_bf16 v[84:87], v[56:59], a[168:175], v15
Lps_55:
s_waitcnt vmcnt(1)
v_max3_u32 v44, v60, v61, v62
v_max_u32 v44, v44, v63
v_cmp_eq_u32 vcc, -1, v44
s_cbranch_vccnz Lpf_56
v_smfmac_f32_16x16x64_bf16 v[64:67], v[60:63], a[192:199], v15
v_smfmac_f32_16x16x64_bf16 v[68:71], v[60:63], a[200:207], v15
v_smfmac_f32_16x16x64_bf16 v[72:75], v[60:63], a[208:215], v15
v_smfmac_f32_16x16x64_bf16 v[76:79], v[60:63], a[216:223], v15
v_smfmac_f32_16x16x64_bf16 v[80:83], v[60:63], a[224:231], v15
v_smfmac_f32_16x16x64_bf16 v[84:87], v[60:63], a[232:239], v15
Lps_57:
s_waitcnt vmcnt(0)
v_max3_u32 v44, v52, v53, v54
v_max_u32 v44, v44, v55
v_cmp_eq_u32 vcc, -1, v44
s_cbranch_vccnz Lpf_58
v_smfmac_f32_16x16x64_bf16 v[64:67], v[52:55], a[64:71], v15
s_nop 1
v_smfmac_f32_16x16x64_bf16 v[68:71], v[52:55], a[72:79], v15
s_nop 1
v_smfmac_f32_16x16x64_bf16 v[72:75], v[52:55], a[80:87], v15
s_nop 1
v_smfmac_f32_16x16x64_bf16 v[76:79], v[52:55], a[88:95], v15
v_add_f32 v96, v64, v66
v_add_f32 v97, v65, v67
v_smfmac_f32_16x16x64_bf16 v[80:83], v[52:55], a[96:103], v15
v_add_f32 v98, v68, v70
v_add_f32 v99, v69, v71
v_smfmac_f32_16x16x64_bf16 v[84:87], v[52:55], a[104:111], v15
v_add_f32 v100, v72, v74
v_add_f32 v101, v73, v75
ds_write_b128 v211, v[96:99] offset:0
v_smfmac_f32_16x16x64_bf16 v[88:91], v[48:51], a[48:55], v15
v_add_f32 v102, v76, v78
v_add_f32 v103, v77, v79
v_add_f32 v104, v80, v82
v_add_f32 v105, v81, v83
ds_write_b128 v212, v[100:103] offset:0
v_smfmac_f32_16x16x64_bf16 v[88:91], v[52:55], a[112:119], v15
v_add_f32 v106, v84, v86
v_add_f32 v107, v85, v87
ds_write_b128 v213, v[104:107] offset:0
s_branch Lpd_26
Lpf_46:
buffer_load_dwordx4 v[52:55], v10, s[4:7], s40 offen offset:1024 sc1
Lps_59:
s_waitcnt vmcnt(3)
v_max3_u32 v44, v56, v57, v58
v_max_u32 v44, v44, v59
v_cmp_eq_u32 vcc, -1, v44
s_cbranch_vccnz Lpf_60
v_smfmac_f32_16x16x64_bf16 v[64:67], v[56:59], a[128:135], v15
v_smfmac_f32_16x16x64_bf16 v[68:71], v[56:59], a[136:143], v15
v_smfmac_f32_16x16x64_bf16 v[72:75], v[56:59], a[144:151], v15
v_smfmac_f32_16x16x64_bf16 v[76:79], v[56:59], a[152:159], v15
v_smfmac_f32_16x16x64_bf16 v[80:83], v[56:59], a[160:167], v15
v_smfmac_f32_16x16x64_bf16 v[84:87], v[56:59], a[168:175], v15
Lps_61:
s_waitcnt vmcnt(2)
v_max3_u32 v44, v60, v61, v62
v_max_u32 v44, v44, v63
v_cmp_eq_u32 vcc, -1, v44
s_cbranch_vccnz Lpf_62
v_smfmac_f32_16x16x64_bf16 v[64:67], v[60:63], a[192:199], v15
v_smfmac_f32_16x16x64_bf16 v[68:71], v[60:63], a[200:207], v15
v_smfmac_f32_16x16x64_bf16 v[72:75], v[60:63], a[208:215], v15
v_smfmac_f32_16x16x64_bf16 v[76:79], v[60:63], a[216:223], v15
v_smfmac_f32_16x16x64_bf16 v[80:83], v[60:63], a[224:231], v15
v_smfmac_f32_16x16x64_bf16 v[84:87], v[60:63], a[232:239], v15
Lps_63:
s_waitcnt vmcnt(1)
v_max3_u32 v44, v48, v49, v50
v_max_u32 v44, v44, v51
v_cmp_eq_u32 vcc, -1, v44
s_cbranch_vccnz Lpf_64
v_smfmac_f32_16x16x64_bf16 v[64:67], v[48:51], a[0:7], v15
v_smfmac_f32_16x16x64_bf16 v[68:71], v[48:51], a[8:15], v15
v_smfmac_f32_16x16x64_bf16 v[72:75], v[48:51], a[16:23], v15
v_smfmac_f32_16x16x64_bf16 v[76:79], v[48:51], a[24:31], v15
v_smfmac_f32_16x16x64_bf16 v[80:83], v[48:51], a[32:39], v15
v_smfmac_f32_16x16x64_bf16 v[84:87], v[48:51], a[40:47], v15
s_branch Lps_57
Lpf_48:
buffer_load_dwordx4 v[56:59], v10, s[4:7], s40 offen offset:2048 sc1
Lps_65:
s_waitcnt vmcnt(2)
v_max3_u32 v44, v60, v61, v62
v_max_u32 v44, v44, v63
v_cmp_eq_u32 vcc, -1, v44
s_cbranch_vccnz Lpf_66
v_smfmac_f32_16x16x64_bf16 v[64:67], v[60:63], a[192:199], v15
v_smfmac_f32_16x16x64_bf16 v[68:71], v[60:63], a[200:207], v15
v_smfmac_f32_16x16x64_bf16 v[72:75], v[60:63], a[208:215], v15
v_smfmac_f32_16x16x64_bf16 v[76:79], v[60:63], a[216:223], v15
v_smfmac_f32_16x16x64_bf16 v[80:83], v[60:63], a[224:231], v15
v_smfmac_f32_16x16x64_bf16 v[84:87], v[60:63], a[232:239], v15
Lps_67:
s_waitcnt vmcnt(1)
v_max3_u32 v44, v48, v49, v50
v_max_u32 v44, v44, v51
v_cmp_eq_u32 vcc, -1, v44
s_cbranch_vccnz Lpf_68
v_smfmac_f32_16x16x64_bf16 v[64:67], v[48:51], a[0:7], v15
v_smfmac_f32_16x16x64_bf16 v[68:71], v[48:51], a[8:15], v15
v_smfmac_f32_16x16x64_bf16 v[72:75], v[48:51], a[16:23], v15
v_smfmac_f32_16x16x64_bf16 v[76:79], v[48:51], a[24:31], v15
v_smfmac_f32_16x16x64_bf16 v[80:83], v[48:51], a[32:39], v15
v_smfmac_f32_16x16x64_bf16 v[84:87], v[48:51], a[40:47], v15
Lps_69:
s_waitcnt vmcnt(0)
v_max3_u32 v44, v56, v57, v58
v_max_u32 v44, v44, v59
v_cmp_eq_u32 vcc, -1, v44
s_cbranch_vccnz Lpf_70
v_smfmac_f32_16x16x64_bf16 v[64:67], v[56:59], a[128:135], v15
s_nop 1
v_smfmac_f32_16x16x64_bf16 v[68:71], v[56:59], a[136:143], v15
s_nop 1
v_smfmac_f32_16x16x64_bf16 v[72:75], v[56:59], a[144:151], v15
s_nop 1
v_smfmac_f32_16x16x64_bf16 v[76:79], v[56:59], a[152:159], v15
v_add_f32 v96, v64, v66
v_add_f32 v97, v65, v67
v_smfmac_f32_16x16x64_bf16 v[80:83], v[56:59], a[160:167], v15
v_add_f32 v98, v68, v70
v_add_f32 v99, v69, v71
v_smfmac_f32_16x16x64_bf16 v[84:87], v[56:59], a[168:175], v15
v_add_f32 v100, v72, v74
v_add_f32 v101, v73, v75
ds_write_b128 v211, v[96:99] offset:0
v_smfmac_f32_16x16x64_bf16 v[88:91], v[48:51], a[48:55], v15
v_add_f32 v102, v76, v78
v_add_f32 v103, v77, v79
v_add_f32 v104, v80, v82
v_add_f32 v105, v81, v83
ds_write_b128 v212, v[100:103] offset:0
v_smfmac_f32_16x16x64_bf16 v[88:91], v[52:55], a[112:119], v15
v_add_f32 v106, v84, v86
v_add_f32 v107, v85, v87
ds_write_b128 v213, v[104:107] offset:0
s_branch Lpd_26
Lpf_50:
buffer_load_dwordx4 v[60:63], v10, s[4:7], s40 offen offset:3072 sc1
Lps_71:
s_waitcnt vmcnt(1)
v_max3_u32 v44, v48, v49, v50
v_max_u32 v44, v44, v51
v_cmp_eq_u32 vcc, -1, v44
s_cbranch_vccnz Lpf_72
v_smfmac_f32_16x16x64_bf16 v[64:67], v[48:51], a[0:7], v15
v_smfmac_f32_16x16x64_bf16 v[68:71], v[48:51], a[8:15], v15
v_smfmac_f32_16x16x64_bf16 v[72:75], v[48:51], a[16:23], v15
v_smfmac_f32_16x16x64_bf16 v[76:79], v[48:51], a[24:31], v15
v_smfmac_f32_16x16x64_bf16 v[80:83], v[48:51], a[32:39], v15
v_smfmac_f32_16x16x64_bf16 v[84:87], v[48:51], a[40:47], v15
Lps_73:
s_waitcnt vmcnt(0)
v_max3_u32 v44, v60, v61, v62
v_max_u32 v44, v44, v63
v_cmp_eq_u32 vcc, -1, v44
s_cbranch_vccnz Lpf_74
v_smfmac_f32_16x16x64_bf16 v[64:67], v[60:63], a[192:199], v15
s_nop 1
v_smfmac_f32_16x16x64_bf16 v[68:71], v[60:63], a[200:207], v15
s_nop 1
v_smfmac_f32_16x16x64_bf16 v[72:75], v[60:63], a[208:215], v15
s_nop 1
v_smfmac_f32_16x16x64_bf16 v[76:79], v[60:63], a[216:223], v15
v_add_f32 v96, v64, v66
v_add_f32 v97, v65, v67
v_smfmac_f32_16x16x64_bf16 v[80:83], v[60:63], a[224:231], v15
v_add_f32 v98, v68, v70
v_add_f32 v99, v69, v71
v_smfmac_f32_16x16x64_bf16 v[84:87], v[60:63], a[232:239], v15
v_add_f32 v100, v72, v74
v_add_f32 v101, v73, v75
ds_write_b128 v211, v[96:99] offset:0
v_smfmac_f32_16x16x64_bf16 v[88:91], v[48:51], a[48:55], v15
v_add_f32 v102, v76, v78
v_add_f32 v103, v77, v79
v_add_f32 v104, v80, v82
v_add_f32 v105, v81, v83
ds_write_b128 v212, v[100:103] offset:0
v_smfmac_f32_16x16x64_bf16 v[88:91], v[52:55], a[112:119], v15
v_add_f32 v106, v84, v86
v_add_f32 v107, v85, v87
ds_write_b128 v213, v[104:107] offset:0
s_branch Lpd_26
Lpf_52:
buffer_load_dwordx4 v[48:51], v10, s[4:7], s40 offen offset:0 sc1
s_sub_u32 s37, s37, 1
s_cbranch_scc1 Lend_1
s_branch Lps_51
Lpf_54:
buffer_load_dwordx4 v[56:59], v10, s[4:7], s40 offen offset:2048 sc1
Lps_75:
s_waitcnt vmcnt(2)
v_max3_u32 v44, v60, v61, v62
v_max_u32 v44, v44, v63
v_cmp_eq_u32 vcc, -1, v44
s_cbranch_vccnz Lpf_76
v_smfmac_f32_16x16x64_bf16 v[64:67], v[60:63], a[192:199], v15
v_smfmac_f32_16x16x64_bf16 v[68:71], v[60:63], a[200:207], v15
v_smfmac_f32_16x16x64_bf16 v[72:75], v[60:63], a[208:215], v15
v_smfmac_f32_16x16x64_bf16 v[76:79], v[60:63], a[216:223], v15
v_smfmac_f32_16x16x64_bf16 v[80:83], v[60:63], a[224:231], v15
v_smfmac_f32_16x16x64_bf16 v[84:87], v[60:63], a[232:239], v15
Lps_77:
s_waitcnt vmcnt(1)
v_max3_u32 v44, v52, v53, v54
v_max_u32 v44, v44, v55
v_cmp_eq_u32 vcc, -1, v44
s_cbranch_vccnz Lpf_78
v_smfmac_f32_16x16x64_bf16 v[64:67], v[52:55], a[64:71], v15
v_smfmac_f32_16x16x64_bf16 v[68:71], v[52:55], a[72:79], v15
v_smfmac_f32_16x16x64_bf16 v[72:75], v[52:55], a[80:87], v15
v_smfmac_f32_16x16x64_bf16 v[76:79], v[52:55], a[88:95], v15
v_smfmac_f32_16x16x64_bf16 v[80:83], v[52:55], a[96:103], v15
v_smfmac_f32_16x16x64_bf16 v[84:87], v[52:55], a[104:111], v15
s_branch Lps_69
Lpf_56:
buffer_load_dwordx4 v[60:63], v10, s[4:7], s40 offen offset:3072 sc1
Lps_79:
s_waitcnt vmcnt(1)
v_max3_u32 v44, v52, v53, v54
v_max_u32 v44, v44, v55
v_cmp_eq_u32 vcc, -1, v44
s_cbranch_vccnz Lpf_80
v_smfmac_f32_16x16x64_bf16 v[64:67], v[52:55], a[64:71], v15
v_smfmac_f32_16x16x64_bf16 v[68:71], v[52:55], a[72:79], v15
v_smfmac_f32_16x16x64_bf16 v[72:75], v[52:55], a[80:87], v15
v_smfmac_f32_16x16x64_bf16 v[76:79], v[52:55], a[88:95], v15
v_smfmac_f32_16x16x64_bf16 v[80:83], v[52:55], a[96:103], v15
v_smfmac_f32_16x16x64_bf16 v[84:87], v[52:55], a[104:111], v15
s_branch Lps_73
Lpf_58:
buffer_load_dwordx4 v[52:55], v10, s[4:7], s40 offen offset:1024 sc1
s_sub_u32 s37, s37, 1
s_cbranch_scc1 Lend_1
s_branch Lps_57
Lpf_60:
buffer_load_dwordx4 v[56:59], v10, s[4:7], s40 offen offset:2048 sc1
Lps_81:
s_waitcnt vmcnt(3)
v_max3_u32 v44, v60, v61, v62
v_max_u32 v44, v44, v63
v_cmp_eq_u32 vcc, -1, v44
s_cbranch_vccnz Lpf_82
v_smfmac_f32_16x16x64_bf16 v[64:67], v[60:63], a[192:199], v15
v_smfmac_f32_16x16x64_bf16 v[68:71], v[60:63], a[200:207], v15
v_smfmac_f32_16x16x64_bf16 v[72:75], v[60:63], a[208:215], v15
v_smfmac_f32_16x16x64_bf16 v[76:79], v[60:63], a[216:223], v15
v_smfmac_f32_16x16x64_bf16 v[80:83], v[60:63], a[224:231], v15
v_smfmac_f32_16x16x64_bf16 v[84:87], v[60:63], a[232:239], v15
Lps_83:
s_waitcnt vmcnt(2)
v_max3_u32 v44, v48, v49, v50
v_max_u32 v44, v44, v51
v_cmp_eq_u32 vcc, -1, v44
s_cbranch_vccnz Lpf_84
v_smfmac_f32_16x16x64_bf16 v[64:67], v[48:51], a[0:7], v15
v_smfmac_f32_16x16x64_bf16 v[68:71], v[48:51], a[8:15], v15
v_smfmac_f32_16x16x64_bf16 v[72:75], v[48:51], a[16:23], v15
v_smfmac_f32_16x16x64_bf16 v[76:79], v[48:51], a[24:31], v15
v_smfmac_f32_16x16x64_bf16 v[80:83], v[48:51], a[32:39], v15
v_smfmac_f32_16x16x64_bf16 v[84:87], v[48:51], a[40:47], v15
s_branch Lps_77
Lpf_62:
buffer_load_dwordx4 v[60:63], v10, s[4:7], s40 offen offset:3072 sc1
Lps_85:
s_waitcnt vmcnt(2)
v_max3_u32 v44, v48, v49, v50
v_max_u32 v44, v44, v51
v_cmp_eq_u32 vcc, -1, v44
s_cbranch_vccnz Lpf_86
v_smfmac_f32_16x16x64_bf16 v[64:67], v[48:51], a[0:7], v15
v_smfmac_f32_16x16x64_bf16 v[68:71], v[48:51], a[8:15], v15
v_smfmac_f32_16x16x64_bf16 v[72:75], v[48:51], a[16:23], v15
v_smfmac_f32_16x16x64_bf16 v[76:79], v[48:51], a[24:31], v15
v_smfmac_f32_16x16x64_bf16 v[80:83], v[48:51], a[32:39], v15
v_smfmac_f32_16x16x64_bf16 v[84:87], v[48:51], a[40:47], v15
s_branch Lps_79
Lpf_64:
buffer_load_dwordx4 v[48:51], v10, s[4:7], s40 offen offset:0 sc1
s_sub_u32 s37, s37, 1
s_cbranch_scc1 Lend_1
Lps_87:
s_waitcnt vmcnt(1)
v_max3_u32 v44, v52, v53, v54
v_max_u32 v44, v44, v55
v_cmp_eq_u32 vcc, -1, v44
s_cbranch_vccnz Lpf_88
v_smfmac_f32_16x16x64_bf16 v[64:67], v[52:55], a[64:71], v15
v_smfmac_f32_16x16x64_bf16 v[68:71], v[52:55], a[72:79], v15
v_smfmac_f32_16x16x64_bf16 v[72:75], v[52:55], a[80:87], v15
v_smfmac_f32_16x16x64_bf16 v[76:79], v[52:55], a[88:95], v15
v_smfmac_f32_16x16x64_bf16 v[80:83], v[52:55], a[96:103], v15
v_smfmac_f32_16x16x64_bf16 v[84:87], v[52:55], a[104:111], v15
s_branch Lps_51
Lpf_66:
buffer_load_dwordx4 v[60:63], v10, s[4:7], s40 offen offset:3072 sc1
Lps_89:
s_waitcnt vmcnt(2)
v_max3_u32 v44, v48, v49, v50
v_max_u32 v44, v44, v51
v_cmp_eq_u32 vcc, -1, v44
s_cbranch_vccnz Lpf_90
v_smfmac_f32_16x16x64_bf16 v[64:67], v[48:51], a[0:7], v15
v_smfmac_f32_16x16x64_bf16 v[68:71], v[48:51], a[8:15], v15
v_smfmac_f32_16x16x64_bf16 v[72:75], v[48:51], a[16:23], v15
v_smfmac_f32_16x16x64_bf16 v[76:79], v[48:51], a[24:31], v15
v_smfmac_f32_16x16x64_bf16 v[80:83], v[48:51], a[32:39], v15
v_smfmac_f32_16x16x64_bf16 v[84:87], v[48:51], a[40:47], v15
Lps_44:
s_waitcnt vmcnt(1)
v_max3_u32 v44, v56, v57, v58
v_max_u32 v44, v44, v59
v_cmp_eq_u32 vcc, -1, v44
s_cbranch_vccnz Lpf_91
v_smfmac_f32_16x16x64_bf16 v[64:67], v[56:59], a[128:135], v15
v_smfmac_f32_16x16x64_bf16 v[68:71], v[56:59], a[136:143], v15
v_smfmac_f32_16x16x64_bf16 v[72:75], v[56:59], a[144:151], v15
v_smfmac_f32_16x16x64_bf16 v[76:79], v[56:59], a[152:159], v15
v_smfmac_f32_16x16x64_bf16 v[80:83], v[56:59], a[160:167], v15
v_smfmac_f32_16x16x64_bf16 v[84:87], v[56:59], a[168:175], v15
s_branch Lps_73
Lpf_68:
buffer_load_dwordx4 v[48:51], v10, s[4:7], s40 offen offset:0 sc1
s_sub_u32 s37, s37, 1
s_cbranch_scc1 Lend_1
Lps_92:
s_waitcnt vmcnt(1)
v_max3_u32 v44, v56, v57, v58
v_max_u32 v44, v44, v59
v_cmp_eq_u32 vcc, -1, v44
s_cbranch_vccnz Lpf_93
v_smfmac_f32_16x16x64_bf16 v[64:67], v[56:59], a[128:135], v15
v_smfmac_f32_16x16x64_bf16 v[68:71], v[56:59], a[136:143], v15
v_smfmac_f32_16x16x64_bf16 v[72:75], v[56:59], a[144:151], v15
v_smfmac_f32_16x16x64_bf16 v[76:79], v[56:59], a[152:159], v15
v_smfmac_f32_16x16x64_bf16 v[80:83], v[56:59], a[160:167], v15
v_smfmac_f32_16x16x64_bf16 v[84:87], v[56:59], a[168:175], v15
s_branch Lps_51
Lpf_70:
buffer_load_dwordx4 v[56:59], v10, s[4:7], s40 offen offset:2048 sc1
s_sub_u32 s37, s37, 1
s_cbranch_scc1 Lend_1
s_branch Lps_69
Lpf_72:
buffer_load_dwordx4 v[48:51], v10, s[4:7], s40 offen offset:0 sc1
s_sub_u32 s37, s37, 1
s_cbranch_scc1 Lend_1
s_branch Lps_49
Lpf_74:
buffer_load_dwordx4 v[60:63], v10, s[4:7], s40 offen offset:3072 sc1
s_sub_u32 s37, s37, 1
s_cbranch_scc1 Lend_1
s_branch Lps_73
Lpf_76:
buffer_load_dwordx4 v[60:63], v10, s[4:7], s40 offen offset:3072 sc1
Lps_94:
s_waitcnt vmcnt(2)
v_max3_u32 v44, v52, v53, v54
v_max_u32 v44, v44, v55
v_cmp_eq_u32 vcc, -1, v44
s_cbranch_vccnz Lpf_95
v_smfmac_f32_16x16x64_bf16 v[64:67], v[52:55], a[64:71], v15
v_smfmac_f32_16x16x64_bf16 v[68:71], v[52:55], a[72:79], v15
v_smfmac_f32_16x16x64_bf16 v[72:75], v[52:55], a[80:87], v15
v_smfmac_f32_16x16x64_bf16 v[76:79], v[52:55], a[88:95], v15
v_smfmac_f32_16x16x64_bf16 v[80:83], v[52:55], a[96:103], v15
v_smfmac_f32_16x16x64_bf16 v[84:87], v[52:55], a[104:111], v15
s_branch Lps_44
Lpf_78:
buffer_load_dwordx4 v[52:55], v10, s[4:7], s40 offen offset:1024 sc1
s_sub_u32 s37, s37, 1
s_cbranch_scc1 Lend_1
Lps_96:
s_waitcnt vmcnt(1)
v_max3_u32 v44, v56, v57, v58
v_max_u32 v44, v44, v59
v_cmp_eq_u32 vcc, -1, v44
s_cbranch_vccnz Lpf_97
v_smfmac_f32_16x16x64_bf16 v[64:67], v[56:59], a[128:135], v15
v_smfmac_f32_16x16x64_bf16 v[68:71], v[56:59], a[136:143], v15
v_smfmac_f32_16x16x64_bf16 v[72:75], v[56:59], a[144:151], v15
v_smfmac_f32_16x16x64_bf16 v[76:79], v[56:59], a[152:159], v15
v_smfmac_f32_16x16x64_bf16 v[80:83], v[56:59], a[160:167], v15
v_smfmac_f32_16x16x64_bf16 v[84:87], v[56:59], a[168:175], v15
s_branch Lps_57
Lpf_80:
buffer_load_dwordx4 v[52:55], v10, s[4:7], s40 offen offset:1024 sc1
s_sub_u32 s37, s37, 1
s_cbranch_scc1 Lend_1
s_branch Lps_55
Lpf_82:
buffer_load_dwordx4 v[60:63], v10, s[4:7], s40 offen offset:3072 sc1
Lps_98:
s_waitcnt vmcnt(3)
v_max3_u32 v44, v48, v49, v50
v_max_u32 v44, v44, v51
v_cmp_eq_u32 vcc, -1, v44
s_cbranch_vccnz Lpf_99
v_smfmac_f32_16x16x64_bf16 v[64:67], v[48:51], a[0:7], v15
v_smfmac_f32_16x16x64_bf16 v[68:71], v[48:51], a[8:15], v15
v_smfmac_f32_16x16x64_bf16 v[72:75], v[48:51], a[16:23], v15
v_smfmac_f32_16x16x64_bf16 v[76:79], v[48:51], a[24:31], v15
v_smfmac_f32_16x16x64_bf16 v[80:83], v[48:51], a[32:39], v15
v_smfmac_f32_16x16x64_bf16 v[84:87], v[48:51], a[40:47], v15
s_branch Lps_94
Lpf_84:
buffer_load_dwordx4 v[48:51], v10, s[4:7], s40 offen offset:0 sc1
s_sub_u32 s37, s37, 1
s_cbranch_scc1 Lend_1
Lps_100:
s_waitcnt vmcnt(2)
v_max3_u32 v44, v52, v53, v54
v_max_u32 v44, v44, v55
v_cmp_eq_u32 vcc, -1, v44
s_cbranch_vccnz Lpf_101
v_smfmac_f32_16x16x64_bf16 v[64:67], v[52:55], a[64:71], v15
v_smfmac_f32_16x16x64_bf16 v[68:71], v[52:55], a[72:79], v15
v_smfmac_f32_16x16x64_bf16 v[72:75], v[52:55], a[80:87], v15
v_smfmac_f32_16x16x64_bf16 v[76:79], v[52:55], a[88:95], v15
v_smfmac_f32_16x16x64_bf16 v[80:83], v[52:55], a[96:103], v15
v_smfmac_f32_16x16x64_bf16 v[84:87], v[52:55], a[104:111], v15
s_branch Lps_92
Lpf_86:
buffer_load_dwordx4 v[48:51], v10, s[4:7], s40 offen offset:0 sc1
s_sub_u32 s37, s37, 1
s_cbranch_scc1 Lend_1
Lps_102:
s_waitcnt vmcnt(2)
v_max3_u32 v44, v52, v53, v54
v_max_u32 v44, v44, v55
v_cmp_eq_u32 vcc, -1, v44
s_cbranch_vccnz Lpf_103
v_smfmac_f32_16x16x64_bf16 v[64:67], v[52:55], a[64:71], v15
v_smfmac_f32_16x16x64_bf16 v[68:71], v[52:55], a[72:79], v15
v_smfmac_f32_16x16x64_bf16 v[72:75], v[52:55], a[80:87], v15
v_smfmac_f32_16x16x64_bf16 v[76:79], v[52:55], a[88:95], v15
v_smfmac_f32_16x16x64_bf16 v[80:83], v[52:55], a[96:103], v15
v_smfmac_f32_16x16x64_bf16 v[84:87], v[52:55], a[104:111], v15
s_branch Lps_49
Lpf_88:
buffer_load_dwordx4 v[52:55], v10, s[4:7], s40 offen offset:1024 sc1
s_branch Lps_63
Lpf_90:
buffer_load_dwordx4 v[48:51], v10, s[4:7], s40 offen offset:0 sc1
s_sub_u32 s37, s37, 1
s_cbranch_scc1 Lend_1
s_branch Lps_47
Lpf_91:
buffer_load_dwordx4 v[56:59], v10, s[4:7], s40 offen offset:2048 sc1
s_sub_u32 s37, s37, 1
s_cbranch_scc1 Lend_1
Lps_104:
s_waitcnt vmcnt(1)
v_max3_u32 v44, v60, v61, v62
v_max_u32 v44, v44, v63
v_cmp_eq_u32 vcc, -1, v44
s_cbranch_vccnz Lpf_105
v_smfmac_f32_16x16x64_bf16 v[64:67], v[60:63], a[192:199], v15
v_smfmac_f32_16x16x64_bf16 v[68:71], v[60:63], a[200:207], v15
v_smfmac_f32_16x16x64_bf16 v[72:75], v[60:63], a[208:215], v15
v_smfmac_f32_16x16x64_bf16 v[76:79], v[60:63], a[216:223], v15
v_smfmac_f32_16x16x64_bf16 v[80:83], v[60:63], a[224:231], v15
v_smfmac_f32_16x16x64_bf16 v[84:87], v[60:63], a[232:239], v15
s_branch Lps_69
Lpf_93:
buffer_load_dwordx4 v[56:59], v10, s[4:7], s40 offen offset:2048 sc1
s_branch Lps_67
Lpf_95:
buffer_load_dwordx4 v[52:55], v10, s[4:7], s40 offen offset:1024 sc1
s_sub_u32 s37, s37, 1
s_cbranch_scc1 Lend_1
s_branch Lps_53
Lpf_97:
buffer_load_dwordx4 v[56:59], v10, s[4:7], s40 offen offset:2048 sc1
s_branch Lps_77
Lpf_99:
buffer_load_dwordx4 v[48:51], v10, s[4:7], s40 offen offset:0 sc1
s_sub_u32 s37, s37, 1
s_cbranch_scc1 Lend_1
s_branch Lps_45
Lpf_101:
buffer_load_dwordx4 v[52:55], v10, s[4:7], s40 offen offset:1024 sc1
Lps_106:
s_waitcnt vmcnt(2)
v_max3_u32 v44, v56, v57, v58
v_max_u32 v44, v44, v59
v_cmp_eq_u32 vcc, -1, v44
s_cbranch_vccnz Lpf_107
v_smfmac_f32_16x16x64_bf16 v[64:67], v[56:59], a[128:135], v15
v_smfmac_f32_16x16x64_bf16 v[68:71], v[56:59], a[136:143], v15
v_smfmac_f32_16x16x64_bf16 v[72:75], v[56:59], a[144:151], v15
v_smfmac_f32_16x16x64_bf16 v[76:79], v[56:59], a[152:159], v15
v_smfmac_f32_16x16x64_bf16 v[80:83], v[56:59], a[160:167], v15
v_smfmac_f32_16x16x64_bf16 v[84:87], v[56:59], a[168:175], v15
s_branch Lps_63
Lpf_103:
buffer_load_dwordx4 v[52:55], v10, s[4:7], s40 offen offset:1024 sc1
s_branch Lps_61
Lpf_105:
buffer_load_dwordx4 v[60:63], v10, s[4:7], s40 offen offset:3072 sc1
s_branch Lps_44
Lpf_107:
buffer_load_dwordx4 v[56:59], v10, s[4:7], s40 offen offset:2048 sc1
s_branch Lps_83
Lkr_30:
buffer_load_dwordx4 v[56:59], v11, s[4:7], s40 offen offset:0 sc1
buffer_load_dwordx4 v[60:63], v11, s[4:7], s40 offen offset:1024 sc1
Lps_109:
s_waitcnt vmcnt(3)
v_max3_u32 v44, v48, v49, v50
v_max_u32 v44, v44, v51
v_cmp_eq_u32 vcc, -1, v44
s_cbranch_vccnz Lpf_110
v_smfmac_f32_16x16x64_bf16 v[72:75], v[48:51], v[96:103], v15
v_mov_b32 v112, v48
v_mov_b32 v113, v49
v_mov_b32 v114, v50
v_mov_b32 v115, v51
Lps_111:
s_waitcnt vmcnt(2)
v_max3_u32 v44, v52, v53, v54
v_max_u32 v44, v44, v55
v_cmp_eq_u32 vcc, -1, v44
s_cbranch_vccnz Lpf_112
v_smfmac_f32_16x16x64_bf16 v[72:75], v[52:55], v[104:111], v15
v_mov_b32 v116, v52
v_mov_b32 v117, v53
v_mov_b32 v118, v54
v_mov_b32 v119, v55
Lpd_108:
s_branch Lko_31
Lpf_110:
buffer_load_dwordx4 v[48:51], v11, s[4:7], s40 offen offset:0 sc1
s_sub_u32 s37, s37, 1
s_cbranch_scc1 Lend_1
Lps_113:
s_waitcnt vmcnt(3)
v_max3_u32 v44, v52, v53, v54
v_max_u32 v44, v44, v55
v_cmp_eq_u32 vcc, -1, v44
s_cbranch_vccnz Lpf_114
v_smfmac_f32_16x16x64_bf16 v[72:75], v[52:55], v[104:111], v15
v_mov_b32 v116, v52
v_mov_b32 v117, v53
v_mov_b32 v118, v54
v_mov_b32 v119, v55
Lps_115:
s_waitcnt vmcnt(2)
v_max3_u32 v44, v56, v57, v58
v_max_u32 v44, v44, v59
v_cmp_eq_u32 vcc, -1, v44
s_cbranch_vccnz Lpf_116
v_smfmac_f32_16x16x64_bf16 v[72:75], v[56:59], v[96:103], v15
v_mov_b32 v112, v56
v_mov_b32 v113, v57
v_mov_b32 v114, v58
v_mov_b32 v115, v59
s_branch Lpd_108
Lpf_112:
buffer_load_dwordx4 v[52:55], v11, s[4:7], s40 offen offset:1024 sc1
s_sub_u32 s37, s37, 1
s_cbranch_scc1 Lend_1
Lps_117:
s_waitcnt vmcnt(2)
v_max3_u32 v44, v56, v57, v58
v_max_u32 v44, v44, v59
v_cmp_eq_u32 vcc, -1, v44
s_cbranch_vccnz Lpf_118
Lps_119:
s_waitcnt vmcnt(1)
v_max3_u32 v44, v60, v61, v62
v_max_u32 v44, v44, v63
v_cmp_eq_u32 vcc, -1, v44
s_cbranch_vccnz Lpf_120
v_smfmac_f32_16x16x64_bf16 v[72:75], v[60:63], v[104:111], v15
v_mov_b32 v116, v60
v_mov_b32 v117, v61
v_mov_b32 v118, v62
v_mov_b32 v119, v63
s_branch Lpd_108
Lpf_114:
buffer_load_dwordx4 v[52:55], v11, s[4:7], s40 offen offset:1024 sc1
Lps_121:
s_waitcnt vmcnt(3)
v_max3_u32 v44, v56, v57, v58
v_max_u32 v44, v44, v59
v_cmp_eq_u32 vcc, -1, v44
s_cbranch_vccnz Lpf_122
v_smfmac_f32_16x16x64_bf16 v[72:75], v[56:59], v[96:103], v15
v_mov_b32 v112, v56
v_mov_b32 v113, v57
v_mov_b32 v114, v58
v_mov_b32 v115, v59
Lps_123:
s_waitcnt vmcnt(2)
v_max3_u32 v44, v60, v61, v62
v_max_u32 v44, v44, v63
v_cmp_eq_u32 vcc, -1, v44
s_cbranch_vccnz Lpf_124
v_smfmac_f32_16x16x64_bf16 v[72:75], v[60:63], v[104:111], v15
v_mov_b32 v116, v60
v_mov_b32 v117, v61
v_mov_b32 v118, v62
v_mov_b32 v119, v63
s_branch Lpd_108
Lpf_116:
buffer_load_dwordx4 v[56:59], v11, s[4:7], s40 offen offset:0 sc1
Lps_125:
s_waitcnt vmcnt(2)
v_max3_u32 v44, v60, v61, v62
v_max_u32 v44, v44, v63
v_cmp_eq_u32 vcc, -1, v44
s_cbranch_vccnz Lpf_126
Lps_127:
s_waitcnt vmcnt(1)
v_max3_u32 v44, v48, v49, v50
v_max_u32 v44, v44, v51
v_cmp_eq_u32 vcc, -1, v44
s_cbranch_vccnz Lpf_128
v_smfmac_f32_16x16x64_bf16 v[72:75], v[48:51], v[96:103], v15
v_mov_b32 v112, v48
v_mov_b32 v113, v49
v_mov_b32 v114, v50
v_mov_b32 v115, v51
s_branch Lpd_108
Lpf_118:
buffer_load_dwordx4 v[56:59], v11, s[4:7], s40 offen offset:0 sc1
Lps_129:
s_waitcnt vmcnt(2)
v_max3_u32 v44, v60, v61, v62
v_max_u32 v44, v44, v63
v_cmp_eq_u32 vcc, -1, v44
s_cbranch_vccnz Lpf_130
v_smfmac_f32_16x16x64_bf16 v[72:75], v[60:63], v[104:111], v15
v_mov_b32 v116, v60
v_mov_b32 v117, v61
v_mov_b32 v118, v62
v_mov_b32 v119, v63
s_branch Lpd_108
Lpf_120:
buffer_load_dwordx4 v[60:63], v11, s[4:7], s40 offen offset:1024 sc1
Lps_131:
s_waitcnt vmcnt(1)
v_max3_u32 v44, v52, v53, v54
v_max_u32 v44, v44, v55
v_cmp_eq_u32 vcc, -1, v44
s_cbranch_vccnz Lpf_132
v_smfmac_f32_16x16x64_bf16 v[72:75], v[52:55], v[104:111], v15
v_mov_b32 v116, v52
v_mov_b32 v117, v53
v_mov_b32 v118, v54
v_mov_b32 v119, v55
s_branch Lpd_108
Lpf_122:
buffer_load_dwordx4 v[56:59], v11, s[4:7], s40 offen offset:0 sc1
Lps_133:
s_waitcnt vmcnt(3)
v_max3_u32 v44, v60, v61, v62
v_max_u32 v44, v44, v63
v_cmp_eq_u32 vcc, -1, v44
s_cbranch_vccnz Lpf_134
v_smfmac_f32_16x16x64_bf16 v[72:75], v[60:63], v[104:111], v15
v_mov_b32 v116, v60
v_mov_b32 v117, v61
v_mov_b32 v118, v62
v_mov_b32 v119, v63
Lps_135:
s_waitcnt vmcnt(2)
v_max3_u32 v44, v48, v49, v50
v_max_u32 v44, v44, v51
v_cmp_eq_u32 vcc, -1, v44
s_cbranch_vccnz Lpf_136
v_smfmac_f32_16x16x64_bf16 v[72:75], v[48:51], v[96:103], v15
v_mov_b32 v112, v48
v_mov_b32 v113, v49
v_mov_b32 v114, v50
v_mov_b32 v115, v51
s_branch Lpd_108
Lpf_124:
buffer_load_dwordx4 v[60:63], v11, s[4:7], s40 offen offset:1024 sc1
Lps_137:
s_waitcnt vmcnt(2)
v_max3_u32 v44, v48, v49, v50
v_max_u32 v44, v44, v51
v_cmp_eq_u32 vcc, -1, v44
s_cbranch_vccnz Lpf_138
s_branch Lps_131
Lpf_126:
buffer_load_dwordx4 v[60:63], v11, s[4:7], s40 offen offset:1024 sc1
Lps_139:
s_waitcnt vmcnt(2)
v_max3_u32 v44, v48, v49, v50
v_max_u32 v44, v44, v51
v_cmp_eq_u32 vcc, -1, v44
s_cbranch_vccnz Lpf_140
v_smfmac_f32_16x16x64_bf16 v[72:75], v[48:51], v[96:103], v15
v_mov_b32 v112, v48
v_mov_b32 v113, v49
v_mov_b32 v114, v50
v_mov_b32 v115, v51
s_branch Lpd_108
Lpf_128:
buffer_load_dwordx4 v[48:51], v11, s[4:7], s40 offen offset:0 sc1
s_sub_u32 s37, s37, 1
s_cbranch_scc1 Lend_1
Lps_141:
s_waitcnt vmcnt(1)
v_max3_u32 v44, v56, v57, v58
v_max_u32 v44, v44, v59
v_cmp_eq_u32 vcc, -1, v44
s_cbranch_vccnz Lpf_142
v_smfmac_f32_16x16x64_bf16 v[72:75], v[56:59], v[96:103], v15
v_mov_b32 v112, v56
v_mov_b32 v113, v57
v_mov_b32 v114, v58
v_mov_b32 v115, v59
s_branch Lpd_108
Lpf_130:
buffer_load_dwordx4 v[60:63], v11, s[4:7], s40 offen offset:1024 sc1
s_branch Lps_111
Lpf_132:
buffer_load_dwordx4 v[52:55], v11, s[4:7], s40 offen offset:1024 sc1
s_sub_u32 s37, s37, 1
s_cbranch_scc1 Lend_1
s_branch Lps_119
Lpf_134:
buffer_load_dwordx4 v[60:63], v11, s[4:7], s40 offen offset:1024 sc1
s_branch Lps_109
Lpf_136:
buffer_load_dwordx4 v[48:51], v11, s[4:7], s40 offen offset:0 sc1
s_sub_u32 s37, s37, 1
s_cbranch_scc1 Lend_1
Lps_143:
s_waitcnt vmcnt(2)
v_max3_u32 v44, v52, v53, v54
v_max_u32 v44, v44, v55
v_cmp_eq_u32 vcc, -1, v44
s_cbranch_vccnz Lpf_144
s_branch Lps_141
Lpf_138:
buffer_load_dwordx4 v[48:51], v11, s[4:7], s40 offen offset:0 sc1
s_sub_u32 s37, s37, 1
s_cbranch_scc1 Lend_1
Lps_145:
s_waitcnt vmcnt(2)
v_max3_u32 v44, v52, v53, v54
v_max_u32 v44, v44, v55
v_cmp_eq_u32 vcc, -1, v44
s_cbranch_vccnz Lpf_146
v_smfmac_f32_16x16x64_bf16 v[72:75], v[52:55], v[104:111], v15
v_mov_b32 v116, v52
v_mov_b32 v117, v53
v_mov_b32 v118, v54
v_mov_b32 v119, v55
s_branch Lpd_108
Lpf_140:
buffer_load_dwordx4 v[48:51], v11, s[4:7], s40 offen offset:0 sc1
s_sub_u32 s37, s37, 1
s_cbranch_scc1 Lend_1
s_branch Lps_115
Lpf_142:
buffer_load_dwordx4 v[56:59], v11, s[4:7], s40 offen offset:0 sc1
s_branch Lps_127
Lpf_144:
buffer_load_dwordx4 v[52:55], v11, s[4:7], s40 offen offset:1024 sc1
Lps_147:
s_waitcnt vmcnt(2)
v_max3_u32 v44, v56, v57, v58
v_max_u32 v44, v44, v59
v_cmp_eq_u32 vcc, -1, v44
s_cbranch_vccnz Lpf_148
v_smfmac_f32_16x16x64_bf16 v[72:75], v[56:59], v[96:103], v15
v_mov_b32 v112, v56
v_mov_b32 v113, v57
v_mov_b32 v114, v58
v_mov_b32 v115, v59
s_branch Lpd_108
Lpf_146:
buffer_load_dwordx4 v[52:55], v11, s[4:7], s40 offen offset:1024 sc1
s_branch Lps_123
Lpf_148:
buffer_load_dwordx4 v[56:59], v11, s[4:7], s40 offen offset:0 sc1
s_branch Lps_135
Lvr_32:
buffer_load_dwordx2 v[120:121], v12, s[4:7], s40 offen sc1
buffer_load_dwordx2 v[122:123], v13, s[4:7], s40 offen sc1
s_sub_u32 s37, s37, 1
s_cbranch_scc1 Lend_1
s_waitcnt vmcnt(0)
v_max3_u32 v44, v120, v121, v122
v_max_u32 v44, v44, v123
v_cmp_eq_u32 vcc, -1, v44
s_cbranch_vccnz Lvr_32
s_branch Lvo_33
Lq_sc1_20:
Lq_149:
s_cmp_gt_u32 s36, 3
s_cbranch_scc1 Lqf_150
s_waitcnt vmcnt(0)
s_barrier
Lqf_150:
ds_read_b128 v[128:131], v22 offset:0
ds_read_b128 v[132:135], v22 offset:1024
ds_read_b128 v[136:139], v22 offset:2048
ds_read_b128 v[140:143], v22 offset:3072
ds_read_b128 v[144:147], v22 offset:4096
ds_read_b128 v[148:151], v22 offset:5120
ds_read_b128 v[152:155], v22 offset:6144
ds_read_b128 v[156:159], v22 offset:7168
ds_read_b128 v[160:163], v24 offset:0
ds_read_b128 v[164:167], v24 offset:1024
ds_read_b128 v[168:171], v25 offset:0
ds_read_b128 v[172:175], v25 offset:1024
ds_read_b128 v[176:179], v23 offset:0
ds_read_b128 v[180:183], v23 offset:1024
ds_read_b128 v[184:187], v23 offset:2048
ds_read_b128 v[188:191], v23 offset:3072
v_xor_b32 v22, 98304, v22
v_xor_b32 v24, 98304, v24
v_xor_b32 v25, 98304, v25
v_xor_b32 v23, 98304, v23
s_and_b32 s38, s36, 3
s_lshl_b32 s39, s38, 16
s_add_u32 s40, s39, s45
s_xor_b32 s42, s40, 0x20000
s_add_u32 s26, s36, 1
v_pk_mul_f32 v[64:65], 0, 0
v_pk_mul_f32 v[66:67], 0, 0
v_pk_mul_f32 v[68:69], 0, 0
v_pk_mul_f32 v[70:71], 0, 0
v_pk_mul_f32 v[72:73], 0, 0
v_pk_mul_f32 v[74:75], 0, 0
v_pk_mul_f32 v[76:77], 0, 0
v_pk_mul_f32 v[78:79], 0, 0
v_pk_mul_f32 v[80:81], 0, 0
v_pk_mul_f32 v[82:83], 0, 0
v_pk_mul_f32 v[84:85], 0, 0
v_pk_mul_f32 v[86:87], 0, 0
v_pk_mul_f32 v[88:89], 0, 0
v_pk_mul_f32 v[90:91], 0, 0
v_pk_mul_f32 v[92:93], 0, 0
v_pk_mul_f32 v[94:95], 0, 0
v_mov_b32 v214, v197
s_waitcnt vmcnt(0)
buffer_store_dword v214, v199, s[4:7], 0 offen sc1
v_add_u32 v197, 1, v197
s_cmp_eq_u32 s36, 63
s_cbranch_scc1 Lqz_151
s_mov_b64 exec, 15
buffer_load_dword v216, v192, s[4:7], s59 offen sc1
s_nop 5
buffer_load_dword v217, v192, s[4:7], s59 offen sc1
s_nop 5
buffer_load_dword v218, v192, s[4:7], s59 offen sc1
Lft_153:
s_waitcnt vmcnt(2)
v_cmp_gt_u32 vcc, s26, v216
buffer_load_dword v216, v192, s[4:7], s59 offen sc1
s_cbranch_vccz Lfg_152
s_waitcnt vmcnt(2)
v_cmp_gt_u32 vcc, s26, v217
buffer_load_dword v217, v192, s[4:7], s59 offen sc1
s_cbranch_vccz Lfg_152
s_waitcnt vmcnt(2)
v_cmp_gt_u32 vcc, s26, v218
buffer_load_dword v218, v192, s[4:7], s59 offen sc1
s_cbranch_vccz Lfg_152
s_sub_u32 s37, s37, 1
s_cbranch_scc1 Lend_1
s_branch Lft_153
Lfg_152:
s_mov_b64 exec, -1
buffer_load_dwordx4 v[48:51], v10, s[4:7], s40 offen offset:0 sc1
s_nop 11
buffer_load_dwordx4 v[52:55], v10, s[4:7], s40 offen offset:1024 sc1
s_nop 11
buffer_load_dwordx4 v[56:59], v10, s[4:7], s40 offen offset:2048 sc1
s_nop 11
buffer_load_dwordx4 v[60:63], v10, s[4:7], s40 offen offset:3072 sc1
s_nop 11
s_waitcnt vmcnt(3)
v_max3_u32 v44, v48, v49, v50
v_max_u32 v44, v44, v51
v_cmp_eq_u32 vcc, -1, v44
s_cbranch_vccnz Lpf_155
v_smfmac_f32_16x16x64_bf16 v[64:67], v[48:51], a[0:7], v15
v_smfmac_f32_16x16x64_bf16 v[68:71], v[48:51], a[8:15], v15
v_smfmac_f32_16x16x64_bf16 v[72:75], v[48:51], a[16:23], v15
s_waitcnt vmcnt(2)
v_max3_u32 v44, v52, v53, v54
v_max_u32 v44, v44, v55
v_cmp_eq_u32 vcc, -1, v44
v_smfmac_f32_16x16x64_bf16 v[76:79], v[48:51], a[24:31], v15
v_smfmac_f32_16x16x64_bf16 v[80:83], v[48:51], a[32:39], v15
v_smfmac_f32_16x16x64_bf16 v[84:87], v[48:51], a[40:47], v15
s_cbranch_vccnz Lpf_156
v_smfmac_f32_16x16x64_bf16 v[64:67], v[52:55], a[64:71], v15
v_smfmac_f32_16x16x64_bf16 v[68:71], v[52:55], a[72:79], v15
v_smfmac_f32_16x16x64_bf16 v[72:75], v[52:55], a[80:87], v15
s_waitcnt vmcnt(0)
v_max3_u32 v44, v56, v57, v58
v_max3_u32 v44, v44, v59, v60
v_max3_u32 v44, v44, v61, v62
v_max_u32 v44, v44, v63
v_cmp_eq_u32 vcc, -1, v44
v_smfmac_f32_16x16x64_bf16 v[76:79], v[52:55], a[88:95], v15
v_smfmac_f32_16x16x64_bf16 v[80:83], v[52:55], a[96:103], v15
v_smfmac_f32_16x16x64_bf16 v[84:87], v[52:55], a[104:111], v15
s_cbranch_vccnz Lpj_157
v_smfmac_f32_16x16x64_bf16 v[64:67], v[56:59], a[128:135], v15
s_nop 1
v_smfmac_f32_16x16x64_bf16 v[64:67], v[60:63], a[192:199], v15
s_nop 1
v_smfmac_f32_16x16x64_bf16 v[68:71], v[56:59], a[136:143], v15
s_nop 1
v_smfmac_f32_16x16x64_bf16 v[68:71], v[60:63], a[200:207], v15
s_nop 1
v_smfmac_f32_16x16x64_bf16 v[72:75], v[56:59], a[144:151], v15
v_add_f32 v96, v64, v66
v_add_f32 v97, v65, v67
v_smfmac_f32_16x16x64_bf16 v[72:75], v[60:63], a[208:215], v15
s_nop 1
v_smfmac_f32_16x16x64_bf16 v[76:79], v[56:59], a[152:159], v15
v_add_f32 v98, v68, v70
v_add_f32 v99, v69, v71
v_smfmac_f32_16x16x64_bf16 v[76:79], v[60:63], a[216:223], v15
ds_write_b128 v211, v[96:99] offset:0
s_nop 0
v_smfmac_f32_16x16x64_bf16 v[80:83], v[56:59], a[160:167], v15
v_add_f32 v100, v72, v74
v_add_f32 v101, v73, v75
v_smfmac_f32_16x16x64_bf16 v[80:83], v[60:63], a[224:231], v15
s_nop 1
v_smfmac_f32_16x16x64_bf16 v[84:87], v[56:59], a[168:175], v15
v_add_f32 v102, v76, v78
v_add_f32 v103, v77, v79
v_smfmac_f32_16x16x64_bf16 v[84:87], v[60:63], a[232:239], v15
ds_write_b128 v212, v[100:103] offset:0
s_nop 0
v_smfmac_f32_16x16x64_bf16 v[88:91], v[48:51], a[48:55], v15
v_add_f32 v104, v80, v82
v_add_f32 v105, v81, v83
v_smfmac_f32_16x16x64_bf16 v[88:91], v[52:55], a[112:119], v15
s_nop 1
v_add_f32 v106, v84, v86
v_add_f32 v107, v85, v87
ds_write_b128 v213, v[104:107] offset:0
Lpd_154:
v_smfmac_f32_16x16x64_bf16 v[88:91], v[56:59], a[176:183], v15
v_smfmac_f32_16x16x64_bf16 v[88:91], v[60:63], a[240:247], v15
v_smfmac_f32_16x16x64_bf16 v[92:95], v[48:51], a[56:63], v15
v_smfmac_f32_16x16x64_bf16 v[92:95], v[52:55], a[120:127], v15
s_waitcnt lgkmcnt(0)
s_barrier
ds_read_b128 v[76:79], v18 offset:0
ds_read_b128 v[80:83], v18 offset:1024
ds_read_b128 v[84:87], v18 offset:2048
v_smfmac_f32_16x16x64_bf16 v[92:95], v[56:59], a[184:191], v15
v_smfmac_f32_16x16x64_bf16 v[92:95], v[60:63], a[248:255], v15
v_mov_b32 v72, 0
v_mov_b32 v73, 0
v_mov_b32 v74, 0
v_mov_b32 v75, 0
v_add_f32 v108, v88, v90
v_add_f32 v109, v89, v91
s_nop 1
v_add_f32 v110, v92, v94
v_add_f32 v111, v93, v95
s_waitcnt lgkmcnt(0)
v_pk_add_f32 v[76:77], v[76:77], v[108:109]
v_pk_add_f32 v[80:81], v[80:81], v[84:85]
v_pk_add_f32 v[78:79], v[78:79], v[110:111]
v_pk_add_f32 v[82:83], v[82:83], v[86:87]
v_pk_add_f32 v[76:77], v[76:77], v[80:81]
v_pk_add_f32 v[78:79], v[78:79], v[82:83]
v_cvt_pk_bf16_f32 v76, v76, v77
v_cvt_pk_bf16_f32 v77, v78, v79
ds_write2st64_b32 v19, v76, v77 offset0:48 offset1:49
buffer_load_dwordx4 v[112:115], v11, s[4:7], s40 offen offset:0 sc1
buffer_load_dwordx4 v[116:119], v11, s[4:7], s40 offen offset:1024 sc1
s_waitcnt lgkmcnt(0)
s_barrier
ds_read_b64_tr_b16 v[96:97], v20 offset:12288
ds_read_b64_tr_b16 v[98:99], v20 offset:12544
ds_read_b64_tr_b16 v[100:101], v20 offset:12800
ds_read_b64_tr_b16 v[102:103], v20 offset:13056
ds_read_b64_tr_b16 v[104:105], v20 offset:13312
ds_read_b64_tr_b16 v[106:107], v20 offset:13568
ds_read_b64_tr_b16 v[108:109], v20 offset:13824
ds_read_b64_tr_b16 v[110:111], v20 offset:14080
s_waitcnt lgkmcnt(6)
v_mfma_f32_16x16x32_bf16 v[64:67], v[128:131], v[96:99], 0
v_mfma_f32_16x16x32_bf16 v[68:71], v[144:147], v[96:99], 0
s_waitcnt lgkmcnt(4)
buffer_load_dwordx4 v[48:51], v11, s[4:7], s40 offen offset:0 sc1
v_mfma_f32_16x16x32_bf16 v[64:67], v[132:135], v[100:103], v[64:67]
v_mfma_f32_16x16x32_bf16 v[68:71], v[148:151], v[100:103], v[68:71]
s_waitcnt lgkmcnt(2)
buffer_load_dwordx4 v[52:55], v11, s[4:7], s40 offen offset:1024 sc1
v_mfma_f32_16x16x32_bf16 v[64:67], v[136:139], v[104:107], v[64:67]
v_mfma_f32_16x16x32_bf16 v[68:71], v[152:155], v[104:107], v[68:71]
s_waitcnt lgkmcnt(0)
s_waitcnt vmcnt(2)
v_max3_u32 v44, v112, v113, v114
v_max3_u32 v44, v44, v115, v116
v_max3_u32 v44, v44, v117, v118
v_max_u32 v44, v44, v119
v_cmp_eq_u32 vcc, -1, v44
v_mfma_f32_16x16x32_bf16 v[64:67], v[140:143], v[108:111], v[64:67]
v_mfma_f32_16x16x32_bf16 v[68:71], v[156:159], v[108:111], v[68:71]
s_cbranch_vccnz Lkr_158
v_smfmac_f32_16x16x64_bf16 v[72:75], v[112:115], v[96:103], v15
v_smfmac_f32_16x16x64_bf16 v[72:75], v[116:119], v[104:111], v15
Lko_159:
s_nop 3
v_max3_f32 v45, v64, v65, v66
v_max3_f32 v45, v45, v67, v68
v_max3_f32 v45, v45, v69, v70
v_max_f32 v45, v45, v71
v_pk_add_f32 v[72:73], v[72:73], v[74:75]
v_max3_f32 v46, v45, v72, v73
v_max3_f32 v47, v45, v72, v73
buffer_load_dwordx2 v[120:121], v12, s[4:7], s40 offen sc1
buffer_load_dwordx2 v[122:123], v13, s[4:7], s40 offen sc1
v_permlane32_swap_b32 v46, v47
v_max_f32 v45, v46, v47
v_max_f32 v46, v46, v47
s_nop 1
v_permlane16_swap_b32 v45, v46
v_max_f32 v45, v45, v46
v_mul_f32 v46, s49, v45
v_pk_fma_f32 v[64:65], v[64:65], s[48:49], v[46:47] op_sel_hi:[1,0,0]
v_pk_fma_f32 v[66:67], v[66:67], s[48:49], v[46:47] op_sel_hi:[1,0,0]
v_pk_fma_f32 v[68:69], v[68:69], s[48:49], v[46:47] op_sel_hi:[1,0,0]
v_pk_fma_f32 v[70:71], v[70:71], s[48:49], v[46:47] op_sel_hi:[1,0,0]
v_pk_fma_f32 v[72:73], v[72:73], s[48:49], v[46:47] op_sel_hi:[1,0,0]
v_exp_f32 v64, v64
v_exp_f32 v65, v65
v_exp_f32 v66, v66
v_exp_f32 v67, v67
v_exp_f32 v68, v68
v_exp_f32 v69, v69
v_exp_f32 v70, v70
v_exp_f32 v71, v71
v_exp_f32 v72, v72
v_exp_f32 v73, v73
buffer_store_dword v197, v193, s[4:7], s59 offen sc1
v_cvt_pk_bf16_f32 v76, v64, v65
v_cvt_pk_bf16_f32 v77, v66, v67
v_cvt_pk_bf16_f32 v78, v68, v69
v_cvt_pk_bf16_f32 v79, v70, v71
v_cvt_pk_bf16_f32 v2, v72, v73
v_cvt_pk_bf16_f32 v7, v72, v73
v_mfma_f32_16x16x32_bf16 v[84:87], v[32:35], v[76:79], 0
v_mfma_f32_16x16x32_bf16 v[84:87], v[32:35], v[2:5], v[84:87]
v_mfma_f32_16x16x32_bf16 v[96:99], v[160:163], v[76:79], 0
s_waitcnt vmcnt(1)
v_max3_u32 v44, v120, v121, v122
v_max_u32 v44, v44, v123
v_cmp_eq_u32 vcc, -1, v44
v_mfma_f32_16x16x32_bf16 v[100:103], v[164:167], v[76:79], 0
s_cbranch_vccnz Lvr_160
Lvo_161:
v_mfma_f32_16x16x32_bf16 v[96:99], v[120:123], v[2:5], v[96:99]
v_mfma_f32_16x16x32_bf16 v[100:103], v[120:123], v[6:9], v[100:103]
v_rcp_f32 v46, v84
s_nop 5
v_pk_mul_f32 v[96:97], v[96:97], v[46:47] op_sel_hi:[1,0]
v_pk_mul_f32 v[98:99], v[98:99], v[46:47] op_sel_hi:[1,0]
v_pk_mul_f32 v[100:101], v[100:101], v[46:47] op_sel_hi:[1,0]
v_pk_mul_f32 v[102:103], v[102:103], v[46:47] op_sel_hi:[1,0]
v_cvt_pk_bf16_f32 v124, v96, v97
v_cvt_pk_bf16_f32 v125, v98, v99
v_cvt_pk_bf16_f32 v126, v100, v101
v_cvt_pk_bf16_f32 v127, v102, v103
buffer_store_dwordx4 v[124:127], v14, s[4:7], s40 offen sc1
s_barrier
buffer_store_dwordx4 v[28:31], v14, s[4:7], s42 offen sc1
s_cmp_eq_u32 s36, 2
s_cbranch_scc1 Lp2_164
Lp1_165:
s_add_u32 s27, s27, 1
s_min_u32 s27, s27, 64
v_add_u32 v44, v209, v210
v_cmp_gt_u32 vcc, s27, v44
v_mov_b32 v72, 0
v_mov_b32 v73, 0
v_mov_b32 v74, 0
v_mov_b32 v75, 0
s_add_u32 s38, s36, 2
s_and_b32 s38, s38, 3
s_lshl_b32 s88, s38, 18
s_add_u32 s88, s88, s46
s_add_u32 s89, s88, 0x100000
s_cmp_lt_u32 s36, 62
s_cselect_b32 s53, s47, 0x70000000
s_cbranch_vccnz Lpw_162
Lpk_163:
buffer_store_dwordx2 v[28:29], v198, s[4:7], s88 offen sc1
buffer_store_dwordx2 v[28:29], v198, s[4:7], s89 offen sc1
v_mfma_f32_16x16x32_bf16 v[64:67], v[128:131], v[176:179], v[36:39]
v_mfma_f32_16x16x32_bf16 v[68:71], v[144:147], v[176:179], v[40:43]
s_mov_b32 m0, s57
s_add_u32 s52, s53, 3072
buffer_load_dwordx4 v21, s[4:7], s53 offen offset:0 sc1 lds
v_mfma_f32_16x16x32_bf16 v[64:67], v[132:135], v[180:183], v[64:67]
v_mfma_f32_16x16x32_bf16 v[68:71], v[148:151], v[180:183], v[68:71]
v_mfma_f32_16x16x32_bf16 v[64:67], v[136:139], v[184:187], v[64:67]
v_mfma_f32_16x16x32_bf16 v[68:71], v[152:155], v[184:187], v[68:71]
buffer_load_dwordx4 v21, s[4:7], s53 offen offset:1024 sc1 lds
v_mfma_f32_16x16x32_bf16 v[64:67], v[140:143], v[188:191], v[64:67]
v_mfma_f32_16x16x32_bf16 v[68:71], v[156:159], v[188:191], v[68:71]
v_smfmac_f32_16x16x64_bf16 v[72:75], v[112:115], v[176:183], v15
v_smfmac_f32_16x16x64_bf16 v[72:75], v[116:119], v[184:191], v15
s_and_b32 s38, s36, 7
s_lshl_b32 s38, s38, 18
s_add_u32 s50, s38, 83886080
buffer_load_dwordx4 v21, s[4:7], s53 offen offset:2048 sc1 lds
s_nop 1
v_max3_f32 v45, v64, v65, v66
v_max3_f32 v45, v45, v67, v68
v_max3_f32 v45, v45, v69, v70
v_max_f32 v45, v45, v71
v_pk_add_f32 v[72:73], v[72:73], v[74:75]
v_max3_f32 v46, v45, v72, v73
v_max3_f32 v47, v45, v72, v73
s_nop 1
v_permlane32_swap_b32 v46, v47
v_max_f32 v45, v46, v47
v_max_f32 v46, v46, v47
s_nop 1
v_permlane16_swap_b32 v45, v46
v_max_f32 v45, v45, v46
v_mul_f32 v46, s49, v45
s_add_u32 m0, s57, 3072
s_xor_b32 s57, s57, 98304
buffer_load_dwordx4 v21, s[4:7], s52 offen offset:0 sc1 lds
v_pk_fma_f32 v[64:65], v[64:65], s[48:49], v[46:47] op_sel_hi:[1,0,0]
v_pk_fma_f32 v[66:67], v[66:67], s[48:49], v[46:47] op_sel_hi:[1,0,0]
v_pk_fma_f32 v[68:69], v[68:69], s[48:49], v[46:47] op_sel_hi:[1,0,0]
v_pk_fma_f32 v[70:71], v[70:71], s[48:49], v[46:47] op_sel_hi:[1,0,0]
v_pk_fma_f32 v[72:73], v[72:73], s[48:49], v[46:47] op_sel_hi:[1,0,0]
v_exp_f32 v64, v64
v_exp_f32 v65, v65
v_exp_f32 v66, v66
v_exp_f32 v67, v67
v_exp_f32 v68, v68
buffer_load_dwordx4 v21, s[4:7], s52 offen offset:1024 sc1 lds
v_exp_f32 v69, v69
v_exp_f32 v70, v70
v_exp_f32 v71, v71
v_exp_f32 v72, v72
v_exp_f32 v73, v73
buffer_load_dwordx4 v21, s[4:7], s52 offen offset:2048 sc1 lds
s_add_u32 s47, s47, 786432
buffer_load_dword v209, v208, s[4:7], 0 offen sc1
v_cvt_pk_bf16_f32 v76, v64, v65
v_cvt_pk_bf16_f32 v77, v66, v67
v_cvt_pk_bf16_f32 v78, v68, v69
v_cvt_pk_bf16_f32 v79, v70, v71
v_cvt_pk_bf16_f32 v2, v72, v73
v_cvt_pk_bf16_f32 v7, v72, v73
v_mfma_f32_16x16x32_bf16 v[84:87], v[32:35], v[76:79], 0
v_mfma_f32_16x16x32_bf16 v[84:87], v[32:35], v[2:5], v[84:87]
v_mfma_f32_16x16x32_bf16 v[96:99], v[160:163], v[76:79], 0
v_mfma_f32_16x16x32_bf16 v[100:103], v[164:167], v[76:79], 0
v_mfma_f32_16x16x32_bf16 v[104:107], v[168:171], v[76:79], 0
v_mfma_f32_16x16x32_bf16 v[108:111], v[172:175], v[76:79], 0
v_mfma_f32_16x16x32_bf16 v[96:99], v[120:123], v[2:5], v[96:99]
v_mfma_f32_16x16x32_bf16 v[100:103], v[120:123], v[6:9], v[100:103]
v_mfma_f32_16x16x32_bf16 v[104:107], v[120:123], v[0:3], v[104:107]
v_mfma_f32_16x16x32_bf16 v[108:111], v[120:123], v[4:7], v[108:111]
v_rcp_f32 v46, v84
s_nop 3
v_pk_mul_f32 v[96:97], v[96:97], v[46:47] op_sel_hi:[1,0]
v_pk_mul_f32 v[98:99], v[98:99], v[46:47] op_sel_hi:[1,0]
v_pk_mul_f32 v[100:101], v[100:101], v[46:47] op_sel_hi:[1,0]
v_pk_mul_f32 v[102:103], v[102:103], v[46:47] op_sel_hi:[1,0]
v_pk_mul_f32 v[104:105], v[104:105], v[46:47] op_sel_hi:[1,0]
v_pk_mul_f32 v[106:107], v[106:107], v[46:47] op_sel_hi:[1,0]
v_pk_mul_f32 v[108:109], v[108:109], v[46:47] op_sel_hi:[1,0]
v_pk_mul_f32 v[110:111], v[110:111], v[46:47] op_sel_hi:[1,0]
v_cvt_pk_bf16_f32 v96, v96, v97
v_cvt_pk_bf16_f32 v97, v98, v99
v_cvt_pk_bf16_f32 v98, v100, v101
v_cvt_pk_bf16_f32 v99, v102, v103
v_cvt_pk_bf16_f32 v100, v104, v105
v_cvt_pk_bf16_f32 v101, v106, v107
v_cvt_pk_bf16_f32 v102, v108, v109
v_cvt_pk_bf16_f32 v103, v110, v111
buffer_store_dwordx4 v[96:99], v26, s[4:7], s50 offen sc1
buffer_store_dwordx4 v[100:103], v27, s[4:7], s50 offen sc1
s_add_u32 s36, s36, 1
s_cmp_lt_u32 s36, 64
s_cbranch_scc1 Lq_149
s_waitcnt vmcnt(0)
buffer_store_dword v197, v199, s[4:7], 0 offen sc1
s_branch Lend_1
Lqz_151:
Lbw_166:
buffer_load_dwordx4 v[112:115], v11, s[4:7], s40 offen offset:0 sc1
buffer_load_dwordx4 v[116:119], v11, s[4:7], s40 offen offset:1024 sc1
buffer_load_dwordx2 v[120:121], v12, s[4:7], s40 offen sc1
buffer_load_dwordx2 v[122:123], v13, s[4:7], s40 offen sc1
s_waitcnt vmcnt(0)
v_max3_u32 v44, v112, v113, v114
v_max3_u32 v44, v44, v115, v116
v_max3_u32 v44, v44, v117, v118
v_max3_u32 v44, v44, v119, v120
v_max3_u32 v44, v44, v121, v122
v_max_u32 v44, v44, v123
v_cmp_eq_u32 vcc, -1, v44
s_cbranch_vccz Lbo_167
s_sub_u32 s37, s37, 1
s_cbranch_scc1 Lend_1
s_branch Lbw_166
Lbo_167:
s_waitcnt lgkmcnt(0)
s_barrier
s_branch Lp1_165
Lp2_164:
s_add_u32 s27, s27, 1
Lbw_168:
buffer_load_dword v209, v208, s[4:7], 0 offen sc1
s_waitcnt vmcnt(0)
v_add_u32 v44, v209, v210
v_cmp_gt_u32 vcc, s27, v44
s_cbranch_vccz Lbo_169
s_sub_u32 s37, s37, 1
s_cbranch_scc1 Lend_1
s_sleep 2
s_branch Lbw_168
Lbo_169:
s_mov_b32 m0, s57
s_add_u32 s52, s47, 3072
buffer_load_dwordx4 v21, s[4:7], s47 offen offset:0 sc1 lds
buffer_load_dwordx4 v21, s[4:7], s47 offen offset:1024 sc1 lds
buffer_load_dwordx4 v21, s[4:7], s47 offen offset:2048 sc1 lds
s_add_u32 m0, s57, 3072
s_xor_b32 s57, s57, 98304
buffer_load_dwordx4 v21, s[4:7], s52 offen offset:0 sc1 lds
buffer_load_dwordx4 v21, s[4:7], s52 offen offset:1024 sc1 lds
buffer_load_dwordx4 v21, s[4:7], s52 offen offset:2048 sc1 lds
s_add_u32 s47, s47, 786432
s_branch Lp1_165
Lpw_162:
Lbw_170:
buffer_load_dword v209, v208, s[4:7], 0 offen sc1
s_waitcnt vmcnt(0)
v_add_u32 v44, v209, v210
v_cmp_gt_u32 vcc, s27, v44
s_cbranch_vccz Lbo_171
s_sub_u32 s37, s37, 1
s_cbranch_scc1 Lend_1
s_sleep 2
s_branch Lbw_170
Lbo_171:
s_branch Lpk_163
Lpj_157:
buffer_load_dwordx4 v[56:59], v10, s[4:7], s40 offen offset:2048 sc1
buffer_load_dwordx4 v[60:63], v10, s[4:7], s40 offen offset:3072 sc1
s_sub_u32 s37, s37, 1
s_cbranch_scc1 Lend_1
s_branch Lps_172
Lpf_155:
buffer_load_dwordx4 v[48:51], v10, s[4:7], s40 offen offset:0 sc1
s_sub_u32 s37, s37, 1
s_cbranch_scc1 Lend_1
Lps_173:
s_waitcnt vmcnt(3)
v_max3_u32 v44, v52, v53, v54
v_max_u32 v44, v44, v55
v_cmp_eq_u32 vcc, -1, v44
s_cbranch_vccnz Lpf_174
v_smfmac_f32_16x16x64_bf16 v[64:67], v[52:55], a[64:71], v15
v_smfmac_f32_16x16x64_bf16 v[68:71], v[52:55], a[72:79], v15
v_smfmac_f32_16x16x64_bf16 v[72:75], v[52:55], a[80:87], v15
v_smfmac_f32_16x16x64_bf16 v[76:79], v[52:55], a[88:95], v15
v_smfmac_f32_16x16x64_bf16 v[80:83], v[52:55], a[96:103], v15
v_smfmac_f32_16x16x64_bf16 v[84:87], v[52:55], a[104:111], v15
Lps_175:
s_waitcnt vmcnt(2)
v_max3_u32 v44, v56, v57, v58
v_max_u32 v44, v44, v59
v_cmp_eq_u32 vcc, -1, v44
s_cbranch_vccnz Lpf_176
v_smfmac_f32_16x16x64_bf16 v[64:67], v[56:59], a[128:135], v15
v_smfmac_f32_16x16x64_bf16 v[68:71], v[56:59], a[136:143], v15
v_smfmac_f32_16x16x64_bf16 v[72:75], v[56:59], a[144:151], v15
v_smfmac_f32_16x16x64_bf16 v[76:79], v[56:59], a[152:159], v15
v_smfmac_f32_16x16x64_bf16 v[80:83], v[56:59], a[160:167], v15
v_smfmac_f32_16x16x64_bf16 v[84:87], v[56:59], a[168:175], v15
Lps_177:
s_waitcnt vmcnt(1)
v_max3_u32 v44, v60, v61, v62
v_max_u32 v44, v44, v63
v_cmp_eq_u32 vcc, -1, v44
s_cbranch_vccnz Lpf_178
v_smfmac_f32_16x16x64_bf16 v[64:67], v[60:63], a[192:199], v15
v_smfmac_f32_16x16x64_bf16 v[68:71], v[60:63], a[200:207], v15
v_smfmac_f32_16x16x64_bf16 v[72:75], v[60:63], a[208:215], v15
v_smfmac_f32_16x16x64_bf16 v[76:79], v[60:63], a[216:223], v15
v_smfmac_f32_16x16x64_bf16 v[80:83], v[60:63], a[224:231], v15
v_smfmac_f32_16x16x64_bf16 v[84:87], v[60:63], a[232:239], v15
Lps_179:
s_waitcnt vmcnt(0)
v_max3_u32 v44, v48, v49, v50
v_max_u32 v44, v44, v51
v_cmp_eq_u32 vcc, -1, v44
s_cbranch_vccnz Lpf_180
v_smfmac_f32_16x16x64_bf16 v[64:67], v[48:51], a[0:7], v15
s_nop 1
v_smfmac_f32_16x16x64_bf16 v[68:71], v[48:51], a[8:15], v15
s_nop 1
v_smfmac_f32_16x16x64_bf16 v[72:75], v[48:51], a[16:23], v15
s_nop 1
v_smfmac_f32_16x16x64_bf16 v[76:79], v[48:51], a[24:31], v15
v_add_f32 v96, v64, v66
v_add_f32 v97, v65, v67
v_smfmac_f32_16x16x64_bf16 v[80:83], v[48:51], a[32:39], v15
v_add_f32 v98, v68, v70
v_add_f32 v99, v69, v71
v_smfmac_f32_16x16x64_bf16 v[84:87], v[48:51], a[40:47], v15
v_add_f32 v100, v72, v74
v_add_f32 v101, v73, v75
ds_write_b128 v211, v[96:99] offset:0
v_smfmac_f32_16x16x64_bf16 v[88:91], v[48:51], a[48:55], v15
v_add_f32 v102, v76, v78
v_add_f32 v103, v77, v79
v_add_f32 v104, v80, v82
v_add_f32 v105, v81, v83
ds_write_b128 v212, v[100:103] offset:0
v_smfmac_f32_16x16x64_bf16 v[88:91], v[52:55], a[112:119], v15
v_add_f32 v106, v84, v86
v_add_f32 v107, v85, v87
ds_write_b128 v213, v[104:107] offset:0
s_branch Lpd_154
Lpf_156:
buffer_load_dwordx4 v[52:55], v10, s[4:7], s40 offen offset:1024 sc1
s_sub_u32 s37, s37, 1
s_cbranch_scc1 Lend_1
Lps_181:
s_waitcnt vmcnt(2)
v_max3_u32 v44, v56, v57, v58
v_max_u32 v44, v44, v59
v_cmp_eq_u32 vcc, -1, v44
s_cbranch_vccnz Lpf_182
v_smfmac_f32_16x16x64_bf16 v[64:67], v[56:59], a[128:135], v15
v_smfmac_f32_16x16x64_bf16 v[68:71], v[56:59], a[136:143], v15
v_smfmac_f32_16x16x64_bf16 v[72:75], v[56:59], a[144:151], v15
v_smfmac_f32_16x16x64_bf16 v[76:79], v[56:59], a[152:159], v15
v_smfmac_f32_16x16x64_bf16 v[80:83], v[56:59], a[160:167], v15
v_smfmac_f32_16x16x64_bf16 v[84:87], v[56:59], a[168:175], v15
Lps_183:
s_waitcnt vmcnt(1)
v_max3_u32 v44, v60, v61, v62
v_max_u32 v44, v44, v63
v_cmp_eq_u32 vcc, -1, v44
s_cbranch_vccnz Lpf_184
v_smfmac_f32_16x16x64_bf16 v[64:67], v[60:63], a[192:199], v15
v_smfmac_f32_16x16x64_bf16 v[68:71], v[60:63], a[200:207], v15
v_smfmac_f32_16x16x64_bf16 v[72:75], v[60:63], a[208:215], v15
v_smfmac_f32_16x16x64_bf16 v[76:79], v[60:63], a[216:223], v15
v_smfmac_f32_16x16x64_bf16 v[80:83], v[60:63], a[224:231], v15
v_smfmac_f32_16x16x64_bf16 v[84:87], v[60:63], a[232:239], v15
Lps_185:
s_waitcnt vmcnt(0)
v_max3_u32 v44, v52, v53, v54
v_max_u32 v44, v44, v55
v_cmp_eq_u32 vcc, -1, v44
s_cbranch_vccnz Lpf_186
v_smfmac_f32_16x16x64_bf16 v[64:67], v[52:55], a[64:71], v15
s_nop 1
v_smfmac_f32_16x16x64_bf16 v[68:71], v[52:55], a[72:79], v15
s_nop 1
v_smfmac_f32_16x16x64_bf16 v[72:75], v[52:55], a[80:87], v15
s_nop 1
v_smfmac_f32_16x16x64_bf16 v[76:79], v[52:55], a[88:95], v15
v_add_f32 v96, v64, v66
v_add_f32 v97, v65, v67
v_smfmac_f32_16x16x64_bf16 v[80:83], v[52:55], a[96:103], v15
v_add_f32 v98, v68, v70
v_add_f32 v99, v69, v71
v_smfmac_f32_16x16x64_bf16 v[84:87], v[52:55], a[104:111], v15
v_add_f32 v100, v72, v74
v_add_f32 v101, v73, v75
ds_write_b128 v211, v[96:99] offset:0
v_smfmac_f32_16x16x64_bf16 v[88:91], v[48:51], a[48:55], v15
v_add_f32 v102, v76, v78
v_add_f32 v103, v77, v79
v_add_f32 v104, v80, v82
v_add_f32 v105, v81, v83
ds_write_b128 v212, v[100:103] offset:0
v_smfmac_f32_16x16x64_bf16 v[88:91], v[52:55], a[112:119], v15
v_add_f32 v106, v84, v86
v_add_f32 v107, v85, v87
ds_write_b128 v213, v[104:107] offset:0
s_branch Lpd_154
Lpf_174:
buffer_load_dwordx4 v[52:55], v10, s[4:7], s40 offen offset:1024 sc1
Lps_187:
s_waitcnt vmcnt(3)
v_max3_u32 v44, v56, v57, v58
v_max_u32 v44, v44, v59
v_cmp_eq_u32 vcc, -1, v44
s_cbranch_vccnz Lpf_188
v_smfmac_f32_16x16x64_bf16 v[64:67], v[56:59], a[128:135], v15
v_smfmac_f32_16x16x64_bf16 v[68:71], v[56:59], a[136:143], v15
v_smfmac_f32_16x16x64_bf16 v[72:75], v[56:59], a[144:151], v15
v_smfmac_f32_16x16x64_bf16 v[76:79], v[56:59], a[152:159], v15
v_smfmac_f32_16x16x64_bf16 v[80:83], v[56:59], a[160:167], v15
v_smfmac_f32_16x16x64_bf16 v[84:87], v[56:59], a[168:175], v15
Lps_189:
s_waitcnt vmcnt(2)
v_max3_u32 v44, v60, v61, v62
v_max_u32 v44, v44, v63
v_cmp_eq_u32 vcc, -1, v44
s_cbranch_vccnz Lpf_190
v_smfmac_f32_16x16x64_bf16 v[64:67], v[60:63], a[192:199], v15
v_smfmac_f32_16x16x64_bf16 v[68:71], v[60:63], a[200:207], v15
v_smfmac_f32_16x16x64_bf16 v[72:75], v[60:63], a[208:215], v15
v_smfmac_f32_16x16x64_bf16 v[76:79], v[60:63], a[216:223], v15
v_smfmac_f32_16x16x64_bf16 v[80:83], v[60:63], a[224:231], v15
v_smfmac_f32_16x16x64_bf16 v[84:87], v[60:63], a[232:239], v15
Lps_191:
s_waitcnt vmcnt(1)
v_max3_u32 v44, v48, v49, v50
v_max_u32 v44, v44, v51
v_cmp_eq_u32 vcc, -1, v44
s_cbranch_vccnz Lpf_192
v_smfmac_f32_16x16x64_bf16 v[64:67], v[48:51], a[0:7], v15
v_smfmac_f32_16x16x64_bf16 v[68:71], v[48:51], a[8:15], v15
v_smfmac_f32_16x16x64_bf16 v[72:75], v[48:51], a[16:23], v15
v_smfmac_f32_16x16x64_bf16 v[76:79], v[48:51], a[24:31], v15
v_smfmac_f32_16x16x64_bf16 v[80:83], v[48:51], a[32:39], v15
v_smfmac_f32_16x16x64_bf16 v[84:87], v[48:51], a[40:47], v15
s_branch Lps_185
Lpf_176:
buffer_load_dwordx4 v[56:59], v10, s[4:7], s40 offen offset:2048 sc1
Lps_193:
s_waitcnt vmcnt(2)
v_max3_u32 v44, v60, v61, v62
v_max_u32 v44, v44, v63
v_cmp_eq_u32 vcc, -1, v44
s_cbranch_vccnz Lpf_194
v_smfmac_f32_16x16x64_bf16 v[64:67], v[60:63], a[192:199], v15
v_smfmac_f32_16x16x64_bf16 v[68:71], v[60:63], a[200:207], v15
v_smfmac_f32_16x16x64_bf16 v[72:75], v[60:63], a[208:215], v15
v_smfmac_f32_16x16x64_bf16 v[76:79], v[60:63], a[216:223], v15
v_smfmac_f32_16x16x64_bf16 v[80:83], v[60:63], a[224:231], v15
v_smfmac_f32_16x16x64_bf16 v[84:87], v[60:63], a[232:239], v15
Lps_195:
s_waitcnt vmcnt(1)
v_max3_u32 v44, v48, v49, v50
v_max_u32 v44, v44, v51
v_cmp_eq_u32 vcc, -1, v44
s_cbranch_vccnz Lpf_196
v_smfmac_f32_16x16x64_bf16 v[64:67], v[48:51], a[0:7], v15
v_smfmac_f32_16x16x64_bf16 v[68:71], v[48:51], a[8:15], v15
v_smfmac_f32_16x16x64_bf16 v[72:75], v[48:51], a[16:23], v15
v_smfmac_f32_16x16x64_bf16 v[76:79], v[48:51], a[24:31], v15
v_smfmac_f32_16x16x64_bf16 v[80:83], v[48:51], a[32:39], v15
v_smfmac_f32_16x16x64_bf16 v[84:87], v[48:51], a[40:47], v15
Lps_197:
s_waitcnt vmcnt(0)
v_max3_u32 v44, v56, v57, v58
v_max_u32 v44, v44, v59
v_cmp_eq_u32 vcc, -1, v44
s_cbranch_vccnz Lpf_198
v_smfmac_f32_16x16x64_bf16 v[64:67], v[56:59], a[128:135], v15
s_nop 1
v_smfmac_f32_16x16x64_bf16 v[68:71], v[56:59], a[136:143], v15
s_nop 1
v_smfmac_f32_16x16x64_bf16 v[72:75], v[56:59], a[144:151], v15
s_nop 1
v_smfmac_f32_16x16x64_bf16 v[76:79], v[56:59], a[152:159], v15
v_add_f32 v96, v64, v66
v_add_f32 v97, v65, v67
v_smfmac_f32_16x16x64_bf16 v[80:83], v[56:59], a[160:167], v15
v_add_f32 v98, v68, v70
v_add_f32 v99, v69, v71
v_smfmac_f32_16x16x64_bf16 v[84:87], v[56:59], a[168:175], v15
v_add_f32 v100, v72, v74
v_add_f32 v101, v73, v75
ds_write_b128 v211, v[96:99] offset:0
v_smfmac_f32_16x16x64_bf16 v[88:91], v[48:51], a[48:55], v15
v_add_f32 v102, v76, v78
v_add_f32 v103, v77, v79
v_add_f32 v104, v80, v82
v_add_f32 v105, v81, v83
ds_write_b128 v212, v[100:103] offset:0
v_smfmac_f32_16x16x64_bf16 v[88:91], v[52:55], a[112:119], v15
v_add_f32 v106, v84, v86
v_add_f32 v107, v85, v87
ds_write_b128 v213, v[104:107] offset:0
s_branch Lpd_154
Lpf_178:
buffer_load_dwordx4 v[60:63], v10, s[4:7], s40 offen offset:3072 sc1
Lps_199:
s_waitcnt vmcnt(1)
v_max3_u32 v44, v48, v49, v50
v_max_u32 v44, v44, v51
v_cmp_eq_u32 vcc, -1, v44
s_cbranch_vccnz Lpf_200
v_smfmac_f32_16x16x64_bf16 v[64:67], v[48:51], a[0:7], v15
v_smfmac_f32_16x16x64_bf16 v[68:71], v[48:51], a[8:15], v15
v_smfmac_f32_16x16x64_bf16 v[72:75], v[48:51], a[16:23], v15
v_smfmac_f32_16x16x64_bf16 v[76:79], v[48:51], a[24:31], v15
v_smfmac_f32_16x16x64_bf16 v[80:83], v[48:51], a[32:39], v15
v_smfmac_f32_16x16x64_bf16 v[84:87], v[48:51], a[40:47], v15
Lps_201:
s_waitcnt vmcnt(0)
v_max3_u32 v44, v60, v61, v62
v_max_u32 v44, v44, v63
v_cmp_eq_u32 vcc, -1, v44
s_cbranch_vccnz Lpf_202
v_smfmac_f32_16x16x64_bf16 v[64:67], v[60:63], a[192:199], v15
s_nop 1
v_smfmac_f32_16x16x64_bf16 v[68:71], v[60:63], a[200:207], v15
s_nop 1
v_smfmac_f32_16x16x64_bf16 v[72:75], v[60:63], a[208:215], v15
s_nop 1
v_smfmac_f32_16x16x64_bf16 v[76:79], v[60:63], a[216:223], v15
v_add_f32 v96, v64, v66
v_add_f32 v97, v65, v67
v_smfmac_f32_16x16x64_bf16 v[80:83], v[60:63], a[224:231], v15
v_add_f32 v98, v68, v70
v_add_f32 v99, v69, v71
v_smfmac_f32_16x16x64_bf16 v[84:87], v[60:63], a[232:239], v15
v_add_f32 v100, v72, v74
v_add_f32 v101, v73, v75
ds_write_b128 v211, v[96:99] offset:0
v_smfmac_f32_16x16x64_bf16 v[88:91], v[48:51], a[48:55], v15
v_add_f32 v102, v76, v78
v_add_f32 v103, v77, v79
v_add_f32 v104, v80, v82
v_add_f32 v105, v81, v83
ds_write_b128 v212, v[100:103] offset:0
v_smfmac_f32_16x16x64_bf16 v[88:91], v[52:55], a[112:119], v15
v_add_f32 v106, v84, v86
v_add_f32 v107, v85, v87
ds_write_b128 v213, v[104:107] offset:0
s_branch Lpd_154
Lpf_180:
buffer_load_dwordx4 v[48:51], v10, s[4:7], s40 offen offset:0 sc1
s_sub_u32 s37, s37, 1
s_cbranch_scc1 Lend_1
s_branch Lps_179
Lpf_182:
buffer_load_dwordx4 v[56:59], v10, s[4:7], s40 offen offset:2048 sc1
Lps_203:
s_waitcnt vmcnt(2)
v_max3_u32 v44, v60, v61, v62
v_max_u32 v44, v44, v63
v_cmp_eq_u32 vcc, -1, v44
s_cbranch_vccnz Lpf_204
v_smfmac_f32_16x16x64_bf16 v[64:67], v[60:63], a[192:199], v15
v_smfmac_f32_16x16x64_bf16 v[68:71], v[60:63], a[200:207], v15
v_smfmac_f32_16x16x64_bf16 v[72:75], v[60:63], a[208:215], v15
v_smfmac_f32_16x16x64_bf16 v[76:79], v[60:63], a[216:223], v15
v_smfmac_f32_16x16x64_bf16 v[80:83], v[60:63], a[224:231], v15
v_smfmac_f32_16x16x64_bf16 v[84:87], v[60:63], a[232:239], v15
Lps_205:
s_waitcnt vmcnt(1)
v_max3_u32 v44, v52, v53, v54
v_max_u32 v44, v44, v55
v_cmp_eq_u32 vcc, -1, v44
s_cbranch_vccnz Lpf_206
v_smfmac_f32_16x16x64_bf16 v[64:67], v[52:55], a[64:71], v15
v_smfmac_f32_16x16x64_bf16 v[68:71], v[52:55], a[72:79], v15
v_smfmac_f32_16x16x64_bf16 v[72:75], v[52:55], a[80:87], v15
v_smfmac_f32_16x16x64_bf16 v[76:79], v[52:55], a[88:95], v15
v_smfmac_f32_16x16x64_bf16 v[80:83], v[52:55], a[96:103], v15
v_smfmac_f32_16x16x64_bf16 v[84:87], v[52:55], a[104:111], v15
s_branch Lps_197
Lpf_184:
buffer_load_dwordx4 v[60:63], v10, s[4:7], s40 offen offset:3072 sc1
Lps_207:
s_waitcnt vmcnt(1)
v_max3_u32 v44, v52, v53, v54
v_max_u32 v44, v44, v55
v_cmp_eq_u32 vcc, -1, v44
s_cbranch_vccnz Lpf_208
v_smfmac_f32_16x16x64_bf16 v[64:67], v[52:55], a[64:71], v15
v_smfmac_f32_16x16x64_bf16 v[68:71], v[52:55], a[72:79], v15
v_smfmac_f32_16x16x64_bf16 v[72:75], v[52:55], a[80:87], v15
v_smfmac_f32_16x16x64_bf16 v[76:79], v[52:55], a[88:95], v15
v_smfmac_f32_16x16x64_bf16 v[80:83], v[52:55], a[96:103], v15
v_smfmac_f32_16x16x64_bf16 v[84:87], v[52:55], a[104:111], v15
s_branch Lps_201
Lpf_186:
buffer_load_dwordx4 v[52:55], v10, s[4:7], s40 offen offset:1024 sc1
s_sub_u32 s37, s37, 1
s_cbranch_scc1 Lend_1
s_branch Lps_185
Lpf_188:
buffer_load_dwordx4 v[56:59], v10, s[4:7], s40 offen offset:2048 sc1
Lps_209:
s_waitcnt vmcnt(3)
v_max3_u32 v44, v60, v61, v62
v_max_u32 v44, v44, v63
v_cmp_eq_u32 vcc, -1, v44
s_cbranch_vccnz Lpf_210
v_smfmac_f32_16x16x64_bf16 v[64:67], v[60:63], a[192:199], v15
v_smfmac_f32_16x16x64_bf16 v[68:71], v[60:63], a[200:207], v15
v_smfmac_f32_16x16x64_bf16 v[72:75], v[60:63], a[208:215], v15
v_smfmac_f32_16x16x64_bf16 v[76:79], v[60:63], a[216:223], v15
v_smfmac_f32_16x16x64_bf16 v[80:83], v[60:63], a[224:231], v15
v_smfmac_f32_16x16x64_bf16 v[84:87], v[60:63], a[232:239], v15
Lps_211:
s_waitcnt vmcnt(2)
v_max3_u32 v44, v48, v49, v50
v_max_u32 v44, v44, v51
v_cmp_eq_u32 vcc, -1, v44
s_cbranch_vccnz Lpf_212
v_smfmac_f32_16x16x64_bf16 v[64:67], v[48:51], a[0:7], v15
v_smfmac_f32_16x16x64_bf16 v[68:71], v[48:51], a[8:15], v15
v_smfmac_f32_16x16x64_bf16 v[72:75], v[48:51], a[16:23], v15
v_smfmac_f32_16x16x64_bf16 v[76:79], v[48:51], a[24:31], v15
v_smfmac_f32_16x16x64_bf16 v[80:83], v[48:51], a[32:39], v15
v_smfmac_f32_16x16x64_bf16 v[84:87], v[48:51], a[40:47], v15
s_branch Lps_205
Lpf_190:
buffer_load_dwordx4 v[60:63], v10, s[4:7], s40 offen offset:3072 sc1
Lps_213:
s_waitcnt vmcnt(2)
v_max3_u32 v44, v48, v49, v50
v_max_u32 v44, v44, v51
v_cmp_eq_u32 vcc, -1, v44
s_cbranch_vccnz Lpf_214
v_smfmac_f32_16x16x64_bf16 v[64:67], v[48:51], a[0:7], v15
v_smfmac_f32_16x16x64_bf16 v[68:71], v[48:51], a[8:15], v15
v_smfmac_f32_16x16x64_bf16 v[72:75], v[48:51], a[16:23], v15
v_smfmac_f32_16x16x64_bf16 v[76:79], v[48:51], a[24:31], v15
v_smfmac_f32_16x16x64_bf16 v[80:83], v[48:51], a[32:39], v15
v_smfmac_f32_16x16x64_bf16 v[84:87], v[48:51], a[40:47], v15
s_branch Lps_207
Lpf_192:
buffer_load_dwordx4 v[48:51], v10, s[4:7], s40 offen offset:0 sc1
s_sub_u32 s37, s37, 1
s_cbranch_scc1 Lend_1
Lps_215:
s_waitcnt vmcnt(1)
v_max3_u32 v44, v52, v53, v54
v_max_u32 v44, v44, v55
v_cmp_eq_u32 vcc, -1, v44
s_cbranch_vccnz Lpf_216
v_smfmac_f32_16x16x64_bf16 v[64:67], v[52:55], a[64:71], v15
v_smfmac_f32_16x16x64_bf16 v[68:71], v[52:55], a[72:79], v15
v_smfmac_f32_16x16x64_bf16 v[72:75], v[52:55], a[80:87], v15
v_smfmac_f32_16x16x64_bf16 v[76:79], v[52:55], a[88:95], v15
v_smfmac_f32_16x16x64_bf16 v[80:83], v[52:55], a[96:103], v15
v_smfmac_f32_16x16x64_bf16 v[84:87], v[52:55], a[104:111], v15
s_branch Lps_179
Lpf_194:
buffer_load_dwordx4 v[60:63], v10, s[4:7], s40 offen offset:3072 sc1
Lps_217:
s_waitcnt vmcnt(2)
v_max3_u32 v44, v48, v49, v50
v_max_u32 v44, v44, v51
v_cmp_eq_u32 vcc, -1, v44
s_cbranch_vccnz Lpf_218
v_smfmac_f32_16x16x64_bf16 v[64:67], v[48:51], a[0:7], v15
v_smfmac_f32_16x16x64_bf16 v[68:71], v[48:51], a[8:15], v15
v_smfmac_f32_16x16x64_bf16 v[72:75], v[48:51], a[16:23], v15
v_smfmac_f32_16x16x64_bf16 v[76:79], v[48:51], a[24:31], v15
v_smfmac_f32_16x16x64_bf16 v[80:83], v[48:51], a[32:39], v15
v_smfmac_f32_16x16x64_bf16 v[84:87], v[48:51], a[40:47], v15
Lps_172:
s_waitcnt vmcnt(1)
v_max3_u32 v44, v56, v57, v58
v_max_u32 v44, v44, v59
v_cmp_eq_u32 vcc, -1, v44
s_cbranch_vccnz Lpf_219
v_smfmac_f32_16x16x64_bf16 v[64:67], v[56:59], a[128:135], v15
v_smfmac_f32_16x16x64_bf16 v[68:71], v[56:59], a[136:143], v15
v_smfmac_f32_16x16x64_bf16 v[72:75], v[56:59], a[144:151], v15
v_smfmac_f32_16x16x64_bf16 v[76:79], v[56:59], a[152:159], v15
v_smfmac_f32_16x16x64_bf16 v[80:83], v[56:59], a[160:167], v15
v_smfmac_f32_16x16x64_bf16 v[84:87], v[56:59], a[168:175], v15
s_branch Lps_201
Lpf_196:
buffer_load_dwordx4 v[48:51], v10, s[4:7], s40 offen offset:0 sc1
s_sub_u32 s37, s37, 1
s_cbranch_scc1 Lend_1
Lps_220:
s_waitcnt vmcnt(1)
v_max3_u32 v44, v56, v57, v58
v_max_u32 v44, v44, v59
v_cmp_eq_u32 vcc, -1, v44
s_cbranch_vccnz Lpf_221
v_smfmac_f32_16x16x64_bf16 v[64:67], v[56:59], a[128:135], v15
v_smfmac_f32_16x16x64_bf16 v[68:71], v[56:59], a[136:143], v15
v_smfmac_f32_16x16x64_bf16 v[72:75], v[56:59], a[144:151], v15
v_smfmac_f32_16x16x64_bf16 v[76:79], v[56:59], a[152:159], v15
v_smfmac_f32_16x16x64_bf16 v[80:83], v[56:59], a[160:167], v15
v_smfmac_f32_16x16x64_bf16 v[84:87], v[56:59], a[168:175], v15
s_branch Lps_179
Lpf_198:
buffer_load_dwordx4 v[56:59], v10, s[4:7], s40 offen offset:2048 sc1
s_sub_u32 s37, s37, 1
s_cbranch_scc1 Lend_1
s_branch Lps_197
Lpf_200:
buffer_load_dwordx4 v[48:51], v10, s[4:7], s40 offen offset:0 sc1
s_sub_u32 s37, s37, 1
s_cbranch_scc1 Lend_1
s_branch Lps_177
Lpf_202:
buffer_load_dwordx4 v[60:63], v10, s[4:7], s40 offen offset:3072 sc1
s_sub_u32 s37, s37, 1
s_cbranch_scc1 Lend_1
s_branch Lps_201
Lpf_204:
buffer_load_dwordx4 v[60:63], v10, s[4:7], s40 offen offset:3072 sc1
Lps_222:
s_waitcnt vmcnt(2)
v_max3_u32 v44, v52, v53, v54
v_max_u32 v44, v44, v55
v_cmp_eq_u32 vcc, -1, v44
s_cbranch_vccnz Lpf_223
v_smfmac_f32_16x16x64_bf16 v[64:67], v[52:55], a[64:71], v15
v_smfmac_f32_16x16x64_bf16 v[68:71], v[52:55], a[72:79], v15
v_smfmac_f32_16x16x64_bf16 v[72:75], v[52:55], a[80:87], v15
v_smfmac_f32_16x16x64_bf16 v[76:79], v[52:55], a[88:95], v15
v_smfmac_f32_16x16x64_bf16 v[80:83], v[52:55], a[96:103], v15
v_smfmac_f32_16x16x64_bf16 v[84:87], v[52:55], a[104:111], v15
s_branch Lps_172
Lpf_206:
buffer_load_dwordx4 v[52:55], v10, s[4:7], s40 offen offset:1024 sc1
s_sub_u32 s37, s37, 1
s_cbranch_scc1 Lend_1
Lps_224:
s_waitcnt vmcnt(1)
v_max3_u32 v44, v56, v57, v58
v_max_u32 v44, v44, v59
v_cmp_eq_u32 vcc, -1, v44
s_cbranch_vccnz Lpf_225
v_smfmac_f32_16x16x64_bf16 v[64:67], v[56:59], a[128:135], v15
v_smfmac_f32_16x16x64_bf16 v[68:71], v[56:59], a[136:143], v15
v_smfmac_f32_16x16x64_bf16 v[72:75], v[56:59], a[144:151], v15
v_smfmac_f32_16x16x64_bf16 v[76:79], v[56:59], a[152:159], v15
v_smfmac_f32_16x16x64_bf16 v[80:83], v[56:59], a[160:167], v15
v_smfmac_f32_16x16x64_bf16 v[84:87], v[56:59], a[168:175], v15
s_branch Lps_185
Lpf_208:
buffer_load_dwordx4 v[52:55], v10, s[4:7], s40 offen offset:1024 sc1
s_sub_u32 s37, s37, 1
s_cbranch_scc1 Lend_1
s_branch Lps_183
Lpf_210:
buffer_load_dwordx4 v[60:63], v10, s[4:7], s40 offen offset:3072 sc1
Lps_226:
s_waitcnt vmcnt(3)
v_max3_u32 v44, v48, v49, v50
v_max_u32 v44, v44, v51
v_cmp_eq_u32 vcc, -1, v44
s_cbranch_vccnz Lpf_227
v_smfmac_f32_16x16x64_bf16 v[64:67], v[48:51], a[0:7], v15
v_smfmac_f32_16x16x64_bf16 v[68:71], v[48:51], a[8:15], v15
v_smfmac_f32_16x16x64_bf16 v[72:75], v[48:51], a[16:23], v15
v_smfmac_f32_16x16x64_bf16 v[76:79], v[48:51], a[24:31], v15
v_smfmac_f32_16x16x64_bf16 v[80:83], v[48:51], a[32:39], v15
v_smfmac_f32_16x16x64_bf16 v[84:87], v[48:51], a[40:47], v15
s_branch Lps_222
Lpf_212:
buffer_load_dwordx4 v[48:51], v10, s[4:7], s40 offen offset:0 sc1
s_sub_u32 s37, s37, 1
s_cbranch_scc1 Lend_1
Lps_228:
s_waitcnt vmcnt(2)
v_max3_u32 v44, v52, v53, v54
v_max_u32 v44, v44, v55
v_cmp_eq_u32 vcc, -1, v44
s_cbranch_vccnz Lpf_229
v_smfmac_f32_16x16x64_bf16 v[64:67], v[52:55], a[64:71], v15
v_smfmac_f32_16x16x64_bf16 v[68:71], v[52:55], a[72:79], v15
v_smfmac_f32_16x16x64_bf16 v[72:75], v[52:55], a[80:87], v15
v_smfmac_f32_16x16x64_bf16 v[76:79], v[52:55], a[88:95], v15
v_smfmac_f32_16x16x64_bf16 v[80:83], v[52:55], a[96:103], v15
v_smfmac_f32_16x16x64_bf16 v[84:87], v[52:55], a[104:111], v15
s_branch Lps_220
Lpf_214:
buffer_load_dwordx4 v[48:51], v10, s[4:7], s40 offen offset:0 sc1
s_sub_u32 s37, s37, 1
s_cbranch_scc1 Lend_1
Lps_230:
s_waitcnt vmcnt(2)
v_max3_u32 v44, v52, v53, v54
v_max_u32 v44, v44, v55
v_cmp_eq_u32 vcc, -1, v44
s_cbranch_vccnz Lpf_231
v_smfmac_f32_16x16x64_bf16 v[64:67], v[52:55], a[64:71], v15
v_smfmac_f32_16x16x64_bf16 v[68:71], v[52:55], a[72:79], v15
v_smfmac_f32_16x16x64_bf16 v[72:75], v[52:55], a[80:87], v15
v_smfmac_f32_16x16x64_bf16 v[76:79], v[52:55], a[88:95], v15
v_smfmac_f32_16x16x64_bf16 v[80:83], v[52:55], a[96:103], v15
v_smfmac_f32_16x16x64_bf16 v[84:87], v[52:55], a[104:111], v15
s_branch Lps_177
Lpf_216:
buffer_load_dwordx4 v[52:55], v10, s[4:7], s40 offen offset:1024 sc1
s_branch Lps_191
Lpf_218:
buffer_load_dwordx4 v[48:51], v10, s[4:7], s40 offen offset:0 sc1
s_sub_u32 s37, s37, 1
s_cbranch_scc1 Lend_1
s_branch Lps_175
Lpf_219:
buffer_load_dwordx4 v[56:59], v10, s[4:7], s40 offen offset:2048 sc1
s_sub_u32 s37, s37, 1
s_cbranch_scc1 Lend_1
Lps_232:
s_waitcnt vmcnt(1)
v_max3_u32 v44, v60, v61, v62
v_max_u32 v44, v44, v63
v_cmp_eq_u32 vcc, -1, v44
s_cbranch_vccnz Lpf_233
v_smfmac_f32_16x16x64_bf16 v[64:67], v[60:63], a[192:199], v15
v_smfmac_f32_16x16x64_bf16 v[68:71], v[60:63], a[200:207], v15
v_smfmac_f32_16x16x64_bf16 v[72:75], v[60:63], a[208:215], v15
v_smfmac_f32_16x16x64_bf16 v[76:79], v[60:63], a[216:223], v15
v_smfmac_f32_16x16x64_bf16 v[80:83], v[60:63], a[224:231], v15
v_smfmac_f32_16x16x64_bf16 v[84:87], v[60:63], a[232:239], v15
s_branch Lps_197
Lpf_221:
buffer_load_dwordx4 v[56:59], v10, s[4:7], s40 offen offset:2048 sc1
s_branch Lps_195
Lpf_223:
buffer_load_dwordx4 v[52:55], v10, s[4:7], s40 offen offset:1024 sc1
s_sub_u32 s37, s37, 1
s_cbranch_scc1 Lend_1
s_branch Lps_181
Lpf_225:
buffer_load_dwordx4 v[56:59], v10, s[4:7], s40 offen offset:2048 sc1
s_branch Lps_205
Lpf_227:
buffer_load_dwordx4 v[48:51], v10, s[4:7], s40 offen offset:0 sc1
s_sub_u32 s37, s37, 1
s_cbranch_scc1 Lend_1
s_branch Lps_173
Lpf_229:
buffer_load_dwordx4 v[52:55], v10, s[4:7], s40 offen offset:1024 sc1
Lps_234:
s_waitcnt vmcnt(2)
v_max3_u32 v44, v56, v57, v58
v_max_u32 v44, v44, v59
v_cmp_eq_u32 vcc, -1, v44
s_cbranch_vccnz Lpf_235
v_smfmac_f32_16x16x64_bf16 v[64:67], v[56:59], a[128:135], v15
v_smfmac_f32_16x16x64_bf16 v[68:71], v[56:59], a[136:143], v15
v_smfmac_f32_16x16x64_bf16 v[72:75], v[56:59], a[144:151], v15
v_smfmac_f32_16x16x64_bf16 v[76:79], v[56:59], a[152:159], v15
v_smfmac_f32_16x16x64_bf16 v[80:83], v[56:59], a[160:167], v15
v_smfmac_f32_16x16x64_bf16 v[84:87], v[56:59], a[168:175], v15
s_branch Lps_191
Lpf_231:
buffer_load_dwordx4 v[52:55], v10, s[4:7], s40 offen offset:1024 sc1
s_branch Lps_189
Lpf_233:
buffer_load_dwordx4 v[60:63], v10, s[4:7], s40 offen offset:3072 sc1
s_branch Lps_172
Lpf_235:
buffer_load_dwordx4 v[56:59], v10, s[4:7], s40 offen offset:2048 sc1
s_branch Lps_211
Lkr_158:
buffer_load_dwordx4 v[56:59], v11, s[4:7], s40 offen offset:0 sc1
buffer_load_dwordx4 v[60:63], v11, s[4:7], s40 offen offset:1024 sc1
Lps_237:
s_waitcnt vmcnt(3)
v_max3_u32 v44, v48, v49, v50
v_max_u32 v44, v44, v51
v_cmp_eq_u32 vcc, -1, v44
s_cbranch_vccnz Lpf_238
v_smfmac_f32_16x16x64_bf16 v[72:75], v[48:51], v[96:103], v15
v_mov_b32 v112, v48
v_mov_b32 v113, v49
v_mov_b32 v114, v50
v_mov_b32 v115, v51
Lps_239:
s_waitcnt vmcnt(2)
v_max3_u32 v44, v52, v53, v54
v_max_u32 v44, v44, v55
v_cmp_eq_u32 vcc, -1, v44
s_cbranch_vccnz Lpf_240
v_smfmac_f32_16x16x64_bf16 v[72:75], v[52:55], v[104:111], v15
v_mov_b32 v116, v52
v_mov_b32 v117, v53
v_mov_b32 v118, v54
v_mov_b32 v119, v55
Lpd_236:
s_branch Lko_159
Lpf_238:
buffer_load_dwordx4 v[48:51], v11, s[4:7], s40 offen offset:0 sc1
s_sub_u32 s37, s37, 1
s_cbranch_scc1 Lend_1
Lps_241:
s_waitcnt vmcnt(3)
v_max3_u32 v44, v52, v53, v54
v_max_u32 v44, v44, v55
v_cmp_eq_u32 vcc, -1, v44
s_cbranch_vccnz Lpf_242
v_smfmac_f32_16x16x64_bf16 v[72:75], v[52:55], v[104:111], v15
v_mov_b32 v116, v52
v_mov_b32 v117, v53
v_mov_b32 v118, v54
v_mov_b32 v119, v55
Lps_243:
s_waitcnt vmcnt(2)
v_max3_u32 v44, v56, v57, v58
v_max_u32 v44, v44, v59
v_cmp_eq_u32 vcc, -1, v44
s_cbranch_vccnz Lpf_244
v_smfmac_f32_16x16x64_bf16 v[72:75], v[56:59], v[96:103], v15
v_mov_b32 v112, v56
v_mov_b32 v113, v57
v_mov_b32 v114, v58
v_mov_b32 v115, v59
s_branch Lpd_236
Lpf_240:
buffer_load_dwordx4 v[52:55], v11, s[4:7], s40 offen offset:1024 sc1
s_sub_u32 s37, s37, 1
s_cbranch_scc1 Lend_1
Lps_245:
s_waitcnt vmcnt(2)
v_max3_u32 v44, v56, v57, v58
v_max_u32 v44, v44, v59
v_cmp_eq_u32 vcc, -1, v44
s_cbranch_vccnz Lpf_246
Lps_247:
s_waitcnt vmcnt(1)
v_max3_u32 v44, v60, v61, v62
v_max_u32 v44, v44, v63
v_cmp_eq_u32 vcc, -1, v44
s_cbranch_vccnz Lpf_248
v_smfmac_f32_16x16x64_bf16 v[72:75], v[60:63], v[104:111], v15
v_mov_b32 v116, v60
v_mov_b32 v117, v61
v_mov_b32 v118, v62
v_mov_b32 v119, v63
s_branch Lpd_236
Lpf_242:
buffer_load_dwordx4 v[52:55], v11, s[4:7], s40 offen offset:1024 sc1
Lps_249:
s_waitcnt vmcnt(3)
v_max3_u32 v44, v56, v57, v58
v_max_u32 v44, v44, v59
v_cmp_eq_u32 vcc, -1, v44
s_cbranch_vccnz Lpf_250
v_smfmac_f32_16x16x64_bf16 v[72:75], v[56:59], v[96:103], v15
v_mov_b32 v112, v56
v_mov_b32 v113, v57
v_mov_b32 v114, v58
v_mov_b32 v115, v59
Lps_251:
s_waitcnt vmcnt(2)
v_max3_u32 v44, v60, v61, v62
v_max_u32 v44, v44, v63
v_cmp_eq_u32 vcc, -1, v44
s_cbranch_vccnz Lpf_252
v_smfmac_f32_16x16x64_bf16 v[72:75], v[60:63], v[104:111], v15
v_mov_b32 v116, v60
v_mov_b32 v117, v61
v_mov_b32 v118, v62
v_mov_b32 v119, v63
s_branch Lpd_236
Lpf_244:
buffer_load_dwordx4 v[56:59], v11, s[4:7], s40 offen offset:0 sc1
Lps_253:
s_waitcnt vmcnt(2)
v_max3_u32 v44, v60, v61, v62
v_max_u32 v44, v44, v63
v_cmp_eq_u32 vcc, -1, v44
s_cbranch_vccnz Lpf_254
Lps_255:
s_waitcnt vmcnt(1)
v_max3_u32 v44, v48, v49, v50
v_max_u32 v44, v44, v51
v_cmp_eq_u32 vcc, -1, v44
s_cbranch_vccnz Lpf_256
v_smfmac_f32_16x16x64_bf16 v[72:75], v[48:51], v[96:103], v15
v_mov_b32 v112, v48
v_mov_b32 v113, v49
v_mov_b32 v114, v50
v_mov_b32 v115, v51
s_branch Lpd_236
Lpf_246:
buffer_load_dwordx4 v[56:59], v11, s[4:7], s40 offen offset:0 sc1
Lps_257:
s_waitcnt vmcnt(2)
v_max3_u32 v44, v60, v61, v62
v_max_u32 v44, v44, v63
v_cmp_eq_u32 vcc, -1, v44
s_cbranch_vccnz Lpf_258
v_smfmac_f32_16x16x64_bf16 v[72:75], v[60:63], v[104:111], v15
v_mov_b32 v116, v60
v_mov_b32 v117, v61
v_mov_b32 v118, v62
v_mov_b32 v119, v63
s_branch Lpd_236
Lpf_248:
buffer_load_dwordx4 v[60:63], v11, s[4:7], s40 offen offset:1024 sc1
Lps_259:
s_waitcnt vmcnt(1)
v_max3_u32 v44, v52, v53, v54
v_max_u32 v44, v44, v55
v_cmp_eq_u32 vcc, -1, v44
s_cbranch_vccnz Lpf_260
v_smfmac_f32_16x16x64_bf16 v[72:75], v[52:55], v[104:111], v15
v_mov_b32 v116, v52
v_mov_b32 v117, v53
v_mov_b32 v118, v54
v_mov_b32 v119, v55
s_branch Lpd_236
Lpf_250:
buffer_load_dwordx4 v[56:59], v11, s[4:7], s40 offen offset:0 sc1
Lps_261:
s_waitcnt vmcnt(3)
v_max3_u32 v44, v60, v61, v62
v_max_u32 v44, v44, v63
v_cmp_eq_u32 vcc, -1, v44
s_cbranch_vccnz Lpf_262
v_smfmac_f32_16x16x64_bf16 v[72:75], v[60:63], v[104:111], v15
v_mov_b32 v116, v60
v_mov_b32 v117, v61
v_mov_b32 v118, v62
v_mov_b32 v119, v63
Lps_263:
s_waitcnt vmcnt(2)
v_max3_u32 v44, v48, v49, v50
v_max_u32 v44, v44, v51
v_cmp_eq_u32 vcc, -1, v44
s_cbranch_vccnz Lpf_264
v_smfmac_f32_16x16x64_bf16 v[72:75], v[48:51], v[96:103], v15
v_mov_b32 v112, v48
v_mov_b32 v113, v49
v_mov_b32 v114, v50
v_mov_b32 v115, v51
s_branch Lpd_236
Lpf_252:
buffer_load_dwordx4 v[60:63], v11, s[4:7], s40 offen offset:1024 sc1
Lps_265:
s_waitcnt vmcnt(2)
v_max3_u32 v44, v48, v49, v50
v_max_u32 v44, v44, v51
v_cmp_eq_u32 vcc, -1, v44
s_cbranch_vccnz Lpf_266
s_branch Lps_259
Lpf_254:
buffer_load_dwordx4 v[60:63], v11, s[4:7], s40 offen offset:1024 sc1
Lps_267:
s_waitcnt vmcnt(2)
v_max3_u32 v44, v48, v49, v50
v_max_u32 v44, v44, v51
v_cmp_eq_u32 vcc, -1, v44
s_cbranch_vccnz Lpf_268
v_smfmac_f32_16x16x64_bf16 v[72:75], v[48:51], v[96:103], v15
v_mov_b32 v112, v48
v_mov_b32 v113, v49
v_mov_b32 v114, v50
v_mov_b32 v115, v51
s_branch Lpd_236
Lpf_256:
buffer_load_dwordx4 v[48:51], v11, s[4:7], s40 offen offset:0 sc1
s_sub_u32 s37, s37, 1
s_cbranch_scc1 Lend_1
Lps_269:
s_waitcnt vmcnt(1)
v_max3_u32 v44, v56, v57, v58
v_max_u32 v44, v44, v59
v_cmp_eq_u32 vcc, -1, v44
s_cbranch_vccnz Lpf_270
v_smfmac_f32_16x16x64_bf16 v[72:75], v[56:59], v[96:103], v15
v_mov_b32 v112, v56
v_mov_b32 v113, v57
v_mov_b32 v114, v58
v_mov_b32 v115, v59
s_branch Lpd_236
Lpf_258:
buffer_load_dwordx4 v[60:63], v11, s[4:7], s40 offen offset:1024 sc1
s_branch Lps_239
Lpf_260:
buffer_load_dwordx4 v[52:55], v11, s[4:7], s40 offen offset:1024 sc1
s_sub_u32 s37, s37, 1
s_cbranch_scc1 Lend_1
s_branch Lps_247
Lpf_262:
buffer_load_dwordx4 v[60:63], v11, s[4:7], s40 offen offset:1024 sc1
s_branch Lps_237
Lpf_264:
buffer_load_dwordx4 v[48:51], v11, s[4:7], s40 offen offset:0 sc1
s_sub_u32 s37, s37, 1
s_cbranch_scc1 Lend_1
Lps_271:
s_waitcnt vmcnt(2)
v_max3_u32 v44, v52, v53, v54
v_max_u32 v44, v44, v55
v_cmp_eq_u32 vcc, -1, v44
s_cbranch_vccnz Lpf_272
s_branch Lps_269
Lpf_266:
buffer_load_dwordx4 v[48:51], v11, s[4:7], s40 offen offset:0 sc1
s_sub_u32 s37, s37, 1
s_cbranch_scc1 Lend_1
Lps_273:
s_waitcnt vmcnt(2)
v_max3_u32 v44, v52, v53, v54
v_max_u32 v44, v44, v55
v_cmp_eq_u32 vcc, -1, v44
s_cbranch_vccnz Lpf_274
v_smfmac_f32_16x16x64_bf16 v[72:75], v[52:55], v[104:111], v15
v_mov_b32 v116, v52
v_mov_b32 v117, v53
v_mov_b32 v118, v54
v_mov_b32 v119, v55
s_branch Lpd_236
Lpf_268:
buffer_load_dwordx4 v[48:51], v11, s[4:7], s40 offen offset:0 sc1
s_sub_u32 s37, s37, 1
s_cbranch_scc1 Lend_1
s_branch Lps_243
Lpf_270:
buffer_load_dwordx4 v[56:59], v11, s[4:7], s40 offen offset:0 sc1
s_branch Lps_255
Lpf_272:
buffer_load_dwordx4 v[52:55], v11, s[4:7], s40 offen offset:1024 sc1
Lps_275:
s_waitcnt vmcnt(2)
v_max3_u32 v44, v56, v57, v58
v_max_u32 v44, v44, v59
v_cmp_eq_u32 vcc, -1, v44
s_cbranch_vccnz Lpf_276
v_smfmac_f32_16x16x64_bf16 v[72:75], v[56:59], v[96:103], v15
v_mov_b32 v112, v56
v_mov_b32 v113, v57
v_mov_b32 v114, v58
v_mov_b32 v115, v59
s_branch Lpd_236
Lpf_274:
buffer_load_dwordx4 v[52:55], v11, s[4:7], s40 offen offset:1024 sc1
s_branch Lps_251
Lpf_276:
buffer_load_dwordx4 v[56:59], v11, s[4:7], s40 offen offset:0 sc1
s_branch Lps_263
Lvr_160:
buffer_load_dwordx2 v[120:121], v12, s[4:7], s40 offen sc1
buffer_load_dwordx2 v[122:123], v13, s[4:7], s40 offen sc1
s_sub_u32 s37, s37, 1
s_cbranch_scc1 Lend_1
s_waitcnt vmcnt(0)
v_max3_u32 v44, v120, v121, v122
v_max_u32 v44, v44, v123
v_cmp_eq_u32 vcc, -1, v44
s_cbranch_vccnz Lvr_160
s_branch Lvo_161
Lend_1:
s_endpgm
Lkvo_2:
v_mov_b32 v44, v0
v_mov_b32 v45, v1
s_sub_u32 s54, s34, 8
s_xor_b32 s57, s32, 3
s_lshl_b32 s45, s33, 18
s_add_u32 s45, s45, 2097152
s_lshl_b32 s59, s33, 12
s_add_u32 s59, s59, 3276800
s_lshl_b32 s38, s32, 12
v_lshl_add_u32 v8, v45, 4, s38
v_add_u32 v9, 49152, v8
s_lshl_b32 s38, s54, 10
s_lshl_b32 s39, s32, 8
s_add_u32 s39, s39, s38
v_mov_b32 v10, s39
v_bfe_u32 v46, v45, 1, 2
v_lshl_add_u32 v10, v46, 6, v10
v_bfe_u32 v46, v45, 5, 1
v_lshl_add_u32 v10, v46, 5, v10
v_bfe_u32 v46, v45, 0, 1
v_lshl_add_u32 v10, v46, 4, v10
v_bfe_u32 v46, v45, 4, 1
v_lshl_add_u32 v10, v46, 3, v10
v_bfe_u32 v46, v45, 3, 1
v_lshl_add_u32 v10, v46, 30, v10
v_and_b32 v46, 0xf0, v44
v_lshl_add_u32 v11, v46, 2, s38
v_and_b32 v46, 3, v45
v_lshl_add_u32 v11, v46, 4, v11
v_and_b32 v46, 12, v45
v_add_u32 v11, v11, v46
v_xor_b32 v11, 20480, v11
s_lshr_b32 s39, s32, 1
s_lshl_b32 s39, s39, 9
s_add_u32 s38, s38, s39
s_and_b32 s39, s32, 1
s_lshl_b32 s39, s39, 2
s_add_u32 s38, s38, s39
s_xor_b32 s38, s38, 34816
v_lshl_add_u32 v27, v45, 3, s38
s_lshl_b32 s38, s32, 8
s_add_u32 s38, s38, 2048
v_lshl_add_u32 v1, v45, 2, s38
s_lshr_b32 s38, s54, 2
s_lshl_b32 s38, s38, 8
s_and_b32 s39, s54, 3
s_lshl_b32 s39, s39, 2
s_add_u32 s38, s38, s39
v_min_u32 v46, 1, v44
v_lshl_add_u32 v2, v46, 30, s38
s_lshr_b32 s38, s54, 3
s_lshl_b32 s38, s38, 14
s_and_b32 s39, s54, 7
s_lshl_b32 s39, s39, 10
s_add_u32 s38, s38, s39
s_lshl_b32 s39, s33, 16
s_add_u32 s38, s38, s39
v_lshl_add_u32 v12, v44, 2, s38
v_xor_b32 v13, 0x10000, v12
v_xor_b32 v14, 0x20000, v12
v_xor_b32 v15, 0x30000, v12
v_bfe_u32 v126, v45, 1, 1
v_mul_u32_u24 v126, 0xaaaa, v126
v_add_u32 v126, 0x4444, v126
s_xor_b32 s38, s57, 0
s_mul_i32 s38, s38, 1536
s_add_u32 s38, s38, 0
v_lshl_add_u32 v24, v45, 3, s38
s_xor_b32 s38, s57, 1
s_mul_i32 s38, s38, 1536
s_add_u32 s38, s38, 512
v_lshl_add_u32 v25, v45, 3, s38
s_xor_b32 s38, s57, 2
s_mul_i32 s38, s38, 1536
s_add_u32 s38, s38, 1024
v_lshl_add_u32 v26, v45, 3, s38
s_mul_i32 s38, s32, 1536
v_lshl_add_u32 v0, v45, 3, s38
v_and_b32 v46, 1, v45
v_mov_b32 v3, 0x05040100
v_mov_b32 v47, 0x03020706
v_cmp_eq_u32 vcc, 1, v46
s_nop 1
v_cndmask_b32 v3, v3, v47, vcc
v_and_b32 v46, 7, v45
v_lshrrev_b32 v47, 4, v45
v_lshlrev_b32 v50, 3, v47
v_lshl_add_u32 v57, v46, 11, v50
s_mov_b32 s8, s16
s_and_b32 s9, s17, 0xffff
s_mov_b32 s10, 0x4000
s_mov_b32 s11, 0x20000
v_bfe_u32 v46, v45, 1, 3
v_cmp_eq_u32 vcc, v46, v47
v_and_b32 v46, 1, v45
v_lshlrev_b32 v46, 4, v46
v_mov_b32 v47, 0x3f80
v_lshlrev_b32 v46, v46, v47
v_cndmask_b32 v20, 0, v46, vcc
v_cndmask_b32 v21, 0, v46, vcc
v_cndmask_b32 v22, 0, v46, vcc
v_cndmask_b32 v23, 0, v46, vcc
v_mov_b32 v4, -1
v_mov_b32 v5, -1
s_add_u32 s38, s45, 0
buffer_store_dwordx2 v[4:5], v10, s[4:7], s38 offen sc1
buffer_store_dword v4, v11, s[4:7], s38 offen sc1
buffer_store_dword v4, v27, s[4:7], s38 offen sc1
s_mov_b32 s39, 0
buffer_store_dword v4, v12, s[4:7], s39 offen sc1
s_mov_b32 s39, 8192
buffer_store_dword v4, v12, s[4:7], s39 offen sc1
s_mov_b32 s39, 1048576
buffer_store_dword v4, v12, s[4:7], s39 offen sc1
s_mov_b32 s39, 1056768
buffer_store_dword v4, v12, s[4:7], s39 offen sc1
s_add_u32 s38, s45, 65536
buffer_store_dwordx2 v[4:5], v10, s[4:7], s38 offen sc1
buffer_store_dword v4, v11, s[4:7], s38 offen sc1
buffer_store_dword v4, v27, s[4:7], s38 offen sc1
s_mov_b32 s39, 262144
buffer_store_dword v4, v12, s[4:7], s39 offen sc1
s_mov_b32 s39, 270336
buffer_store_dword v4, v12, s[4:7], s39 offen sc1
s_mov_b32 s39, 1310720
buffer_store_dword v4, v12, s[4:7], s39 offen sc1
s_mov_b32 s39, 1318912
buffer_store_dword v4, v12, s[4:7], s39 offen sc1
s_add_u32 s38, s45, 131072
buffer_store_dwordx2 v[4:5], v10, s[4:7], s38 offen sc1
buffer_store_dword v4, v11, s[4:7], s38 offen sc1
buffer_store_dword v4, v27, s[4:7], s38 offen sc1
s_mov_b32 s39, 524288
buffer_store_dword v4, v12, s[4:7], s39 offen sc1
s_mov_b32 s39, 532480
buffer_store_dword v4, v12, s[4:7], s39 offen sc1
s_mov_b32 s39, 1572864
buffer_store_dword v4, v12, s[4:7], s39 offen sc1
s_mov_b32 s39, 1581056
buffer_store_dword v4, v12, s[4:7], s39 offen sc1
s_add_u32 s38, s45, 196608
buffer_store_dwordx2 v[4:5], v10, s[4:7], s38 offen sc1
buffer_store_dword v4, v11, s[4:7], s38 offen sc1
buffer_store_dword v4, v27, s[4:7], s38 offen sc1
s_mov_b32 s39, 786432
buffer_store_dword v4, v12, s[4:7], s39 offen sc1
s_mov_b32 s39, 794624
buffer_store_dword v4, v12, s[4:7], s39 offen sc1
s_mov_b32 s39, 1835008
buffer_store_dword v4, v12, s[4:7], s39 offen sc1
s_mov_b32 s39, 1843200
buffer_store_dword v4, v12, s[4:7], s39 offen sc1
v_mov_b32 v7, 1
buffer_store_dword v7, v2, s[4:7], s59 offen sc1
s_lshl_b32 s52, s35, 16
s_or_b32 s52, s52, 1
s_waitcnt vmcnt(0)
s_barrier
s_cmp_lg_u32 s32, 0
s_cbranch_scc1 Lar_277
s_mov_b64 exec, 1
v_mov_b32 v48, 16
v_mov_b32 v49, s52
buffer_atomic_add v49, v48, s[12:15], 0 offen sc1
s_mov_b64 exec, -1
Lar_277:
s_lshl_b32 s38, s54, 2
s_add_u32 s38, s38, s32
s_lshl_b32 s38, s38, 5
buffer_load_dwordx2 v[58:59], v57, s[8:11], s38 offen
s_lshl_b32 s52, s57, 5
v_and_b32 v46, 7, v45
v_lshlrev_b32 v46, 4, v46
v_xor_b32 v46, s52, v46
v_lshrrev_b32 v52, 3, v45
v_lshl_add_u32 v52, v52, 13, v46
v_and_b32 v46, 7, v45
v_lshlrev_b32 v46, 4, v46
v_xor_b32 v46, s52, v46
v_lshrrev_b32 v53, 3, v45
v_lshl_add_u32 v53, v53, 11, v46
s_and_b32 s53, s52, 32
s_lshr_b32 s53, s53, 1
s_and_b32 s52, s52, 64
s_or_b32 s52, s52, s53
v_and_b32 v46, 7, v45
v_lshlrev_b32 v46, 4, v46
v_xor_b32 v46, s52, v46
v_lshrrev_b32 v51, 3, v45
v_lshl_add_u32 v51, v51, 13, v46
v_bfe_u32 v54, v45, 2, 1
v_bfe_u32 v46, v45, 5, 1
v_lshl_add_u32 v54, v46, 4, v54
v_bfe_u32 v46, v45, 4, 1
v_lshl_add_u32 v54, v46, 2, v54
v_bfe_u32 v46, v45, 3, 1
v_lshl_add_u32 v54, v46, 3, v54
s_mul_i32 s38, s32, 40960
v_lshl_add_u32 v54, v54, 7, s38
v_bfe_u32 v46, v45, 0, 1
v_lshl_add_u32 v54, v46, 5, v54
v_bfe_u32 v46, v45, 1, 1
v_lshl_add_u32 v54, v46, 3, v54
v_bfe_u32 v55, v45, 2, 1
v_bfe_u32 v46, v45, 5, 1
v_lshl_add_u32 v55, v46, 4, v55
v_bfe_u32 v46, v45, 4, 1
v_lshl_add_u32 v55, v46, 2, v55
v_bfe_u32 v46, v45, 3, 1
v_lshl_add_u32 v55, v46, 3, v55
s_mul_i32 s38, s32, 40960
v_lshl_add_u32 v55, v55, 7, s38
v_bfe_u32 v46, v45, 0, 1
v_lshl_add_u32 v55, v46, 3, v55
v_bfe_u32 v46, v45, 1, 1
v_lshl_add_u32 v55, v46, 4, v55
v_bfe_u32 v56, v45, 2, 1
v_bfe_u32 v46, v45, 4, 1
v_lshl_add_u32 v56, v46, 4, v56
v_bfe_u32 v46, v45, 5, 1
v_lshl_add_u32 v56, v46, 3, v56
v_bfe_u32 v46, v45, 3, 1
v_lshl_add_u32 v56, v46, 2, v56
s_mul_i32 s38, s32, 40960
v_lshl_add_u32 v56, v56, 7, s38
v_bfe_u32 v46, v45, 0, 1
v_lshl_add_u32 v56, v46, 3, v56
v_bfe_u32 v46, v45, 1, 1
v_lshl_add_u32 v56, v46, 4, v56
s_mov_b32 s8, s20
s_and_b32 s9, s21, 0xffff
s_mov_b32 s10, 0x800000
s_mov_b32 s11, 0x20000
s_lshl_b32 s39, s32, 21
s_lshl_b32 s38, s33, 4
s_add_u32 s38, s38, s54
s_xor_b32 s38, s38, 4
s_lshl_b32 s38, s38, 7
s_add_u32 s39, s39, s38
s_add_u32 s39, s39, 1572864
s_mul_i32 s38, s32, 40960
s_add_u32 m0, s38, 0
s_nop 0
buffer_load_dwordx4 v51, s[8:11], s39 offen lds
s_add_u32 m0, m0, 1024
s_add_u32 s39, s39, 65536
buffer_load_dwordx4 v51, s[8:11], s39 offen lds
s_add_u32 m0, m0, 1024
s_add_u32 s39, s39, 65536
buffer_load_dwordx4 v51, s[8:11], s39 offen lds
s_add_u32 m0, m0, 1024
s_add_u32 s39, s39, 65536
buffer_load_dwordx4 v51, s[8:11], s39 offen lds
s_add_u32 m0, m0, 1024
s_add_u32 s39, s39, 65536
buffer_load_dwordx4 v51, s[8:11], s39 offen lds
s_add_u32 m0, m0, 1024
s_add_u32 s39, s39, 65536
buffer_load_dwordx4 v51, s[8:11], s39 offen lds
s_add_u32 m0, m0, 1024
s_add_u32 s39, s39, 65536
buffer_load_dwordx4 v51, s[8:11], s39 offen lds
s_add_u32 m0, m0, 1024
s_add_u32 s39, s39, 65536
buffer_load_dwordx4 v51, s[8:11], s39 offen lds
s_mov_b32 s8, s22
s_and_b32 s9, s23, 0xffff
s_mov_b32 s10, 0x800000
s_mov_b32 s11, 0x20000
s_lshl_b32 s39, s32, 21
s_lshl_b32 s38, s33, 4
s_add_u32 s38, s38, s54
s_xor_b32 s38, s38, 2
s_lshl_b32 s38, s38, 7
s_add_u32 s39, s39, s38
s_add_u32 s39, s39, 1572864
s_mul_i32 s38, s32, 40960
s_add_u32 m0, s38, 8192
s_nop 0
buffer_load_dwordx4 v52, s[8:11], s39 offen lds
s_add_u32 m0, m0, 1024
s_add_u32 s39, s39, 65536
buffer_load_dwordx4 v52, s[8:11], s39 offen lds
s_add_u32 m0, m0, 1024
s_add_u32 s39, s39, 65536
buffer_load_dwordx4 v52, s[8:11], s39 offen lds
s_add_u32 m0, m0, 1024
s_add_u32 s39, s39, 65536
buffer_load_dwordx4 v52, s[8:11], s39 offen lds
s_add_u32 m0, m0, 1024
s_add_u32 s39, s39, 65536
buffer_load_dwordx4 v52, s[8:11], s39 offen lds
s_add_u32 m0, m0, 1024
s_add_u32 s39, s39, 65536
buffer_load_dwordx4 v52, s[8:11], s39 offen lds
s_add_u32 m0, m0, 1024
s_add_u32 s39, s39, 65536
buffer_load_dwordx4 v52, s[8:11], s39 offen lds
s_add_u32 m0, m0, 1024
s_add_u32 s39, s39, 65536
buffer_load_dwordx4 v52, s[8:11], s39 offen lds
s_mov_b32 s8, s20
s_and_b32 s9, s21, 0xffff
s_mov_b32 s10, 0x800000
s_mov_b32 s11, 0x20000
s_lshl_b32 s39, s32, 21
s_lshl_b32 s38, s33, 4
s_add_u32 s38, s38, s54
s_xor_b32 s38, s38, 4
s_lshl_b32 s38, s38, 7
s_add_u32 s39, s39, s38
s_add_u32 s39, s39, 1048576
s_mul_i32 s38, s32, 40960
s_add_u32 m0, s38, 16384
s_nop 0
buffer_load_dwordx4 v51, s[8:11], s39 offen lds
s_add_u32 m0, m0, 1024
s_add_u32 s39, s39, 65536
buffer_load_dwordx4 v51, s[8:11], s39 offen lds
s_add_u32 m0, m0, 1024
s_add_u32 s39, s39, 65536
buffer_load_dwordx4 v51, s[8:11], s39 offen lds
s_add_u32 m0, m0, 1024
s_add_u32 s39, s39, 65536
buffer_load_dwordx4 v51, s[8:11], s39 offen lds
s_add_u32 m0, m0, 1024
s_add_u32 s39, s39, 65536
buffer_load_dwordx4 v51, s[8:11], s39 offen lds
s_add_u32 m0, m0, 1024
s_add_u32 s39, s39, 65536
buffer_load_dwordx4 v51, s[8:11], s39 offen lds
s_add_u32 m0, m0, 1024
s_add_u32 s39, s39, 65536
buffer_load_dwordx4 v51, s[8:11], s39 offen lds
s_add_u32 m0, m0, 1024
s_add_u32 s39, s39, 65536
buffer_load_dwordx4 v51, s[8:11], s39 offen lds
s_mov_b32 s8, s22
s_and_b32 s9, s23, 0xffff
s_mov_b32 s10, 0x800000
s_mov_b32 s11, 0x20000
s_lshl_b32 s39, s32, 21
s_lshl_b32 s38, s33, 4
s_add_u32 s38, s38, s54
s_xor_b32 s38, s38, 2
s_lshl_b32 s38, s38, 7
s_add_u32 s39, s39, s38
s_add_u32 s39, s39, 1048576
s_mul_i32 s38, s32, 40960
s_add_u32 m0, s38, 24576
s_nop 0
buffer_load_dwordx4 v52, s[8:11], s39 offen lds
s_add_u32 m0, m0, 1024
s_add_u32 s39, s39, 65536
buffer_load_dwordx4 v52, s[8:11], s39 offen lds
s_add_u32 m0, m0, 1024
s_add_u32 s39, s39, 65536
buffer_load_dwordx4 v52, s[8:11], s39 offen lds
s_add_u32 m0, m0, 1024
s_add_u32 s39, s39, 65536
buffer_load_dwordx4 v52, s[8:11], s39 offen lds
s_add_u32 m0, m0, 1024
s_add_u32 s39, s39, 65536
buffer_load_dwordx4 v52, s[8:11], s39 offen lds
s_add_u32 m0, m0, 1024
s_add_u32 s39, s39, 65536
buffer_load_dwordx4 v52, s[8:11], s39 offen lds
s_add_u32 m0, m0, 1024
s_add_u32 s39, s39, 65536
buffer_load_dwordx4 v52, s[8:11], s39 offen lds
s_add_u32 m0, m0, 1024
s_add_u32 s39, s39, 65536
buffer_load_dwordx4 v52, s[8:11], s39 offen lds
s_mov_b32 s8, s20
s_and_b32 s9, s21, 0xffff
s_mov_b32 s10, 0x800000
s_mov_b32 s11, 0x20000
s_lshl_b32 s39, s32, 21
s_lshl_b32 s38, s33, 4
s_add_u32 s38, s38, s54
s_xor_b32 s38, s38, 4
s_lshl_b32 s38, s38, 7
s_add_u32 s39, s39, s38
s_add_u32 s39, s39, 524288
s_mul_i32 s38, s32, 40960
s_add_u32 m0, s38, 32768
s_nop 0
buffer_load_dwordx4 v51, s[8:11], s39 offen lds
s_add_u32 m0, m0, 1024
s_add_u32 s39, s39, 65536
buffer_load_dwordx4 v51, s[8:11], s39 offen lds
s_add_u32 m0, m0, 1024
s_add_u32 s39, s39, 65536
buffer_load_dwordx4 v51, s[8:11], s39 offen lds
s_add_u32 m0, m0, 1024
s_add_u32 s39, s39, 65536
buffer_load_dwordx4 v51, s[8:11], s39 offen lds
s_add_u32 m0, m0, 1024
s_add_u32 s39, s39, 65536
buffer_load_dwordx4 v51, s[8:11], s39 offen lds
s_add_u32 m0, m0, 1024
s_add_u32 s39, s39, 65536
buffer_load_dwordx4 v51, s[8:11], s39 offen lds
s_add_u32 m0, m0, 1024
s_add_u32 s39, s39, 65536
buffer_load_dwordx4 v51, s[8:11], s39 offen lds
s_add_u32 m0, m0, 1024
s_add_u32 s39, s39, 65536
buffer_load_dwordx4 v51, s[8:11], s39 offen lds
s_waitcnt vmcnt(32)
v_min_u32 v58, -2, v58
v_min_u32 v59, -2, v59
buffer_store_dwordx2 v[58:59], v10, s[4:7], s45 offen sc1
ds_read_b64_tr_b16 a[96:97], v54 offset:0
ds_read_b64_tr_b16 a[98:99], v54 offset:256
ds_read_b64_tr_b16 a[100:101], v54 offset:4096
ds_read_b64_tr_b16 a[102:103], v54 offset:4352
ds_read_b64_tr_b16 a[104:105], v54 offset:16
ds_read_b64_tr_b16 a[106:107], v54 offset:272
ds_read_b64_tr_b16 a[108:109], v54 offset:4112
ds_read_b64_tr_b16 a[110:111], v54 offset:4368
ds_read_b64_tr_b16 a[112:113], v54 offset:64
ds_read_b64_tr_b16 a[114:115], v54 offset:320
ds_read_b64_tr_b16 a[116:117], v54 offset:4160
ds_read_b64_tr_b16 a[118:119], v54 offset:4416
ds_read_b64_tr_b16 a[120:121], v54 offset:80
ds_read_b64_tr_b16 a[122:123], v54 offset:336
ds_read_b64_tr_b16 a[124:125], v54 offset:4176
ds_read_b64_tr_b16 a[126:127], v54 offset:4432
s_waitcnt lgkmcnt(0)
s_mov_b32 s8, s22
s_and_b32 s9, s23, 0xffff
s_mov_b32 s10, 0x800000
s_mov_b32 s11, 0x20000
s_lshl_b32 s39, s32, 21
s_lshl_b32 s38, s33, 4
s_add_u32 s38, s38, s54
s_xor_b32 s38, s38, 2
s_lshl_b32 s38, s38, 7
s_add_u32 s39, s39, s38
s_add_u32 s39, s39, 524288
s_mul_i32 s38, s32, 40960
s_add_u32 m0, s38, 0
s_nop 0
buffer_load_dwordx4 v52, s[8:11], s39 offen lds
s_add_u32 m0, m0, 1024
s_add_u32 s39, s39, 65536
buffer_load_dwordx4 v52, s[8:11], s39 offen lds
s_add_u32 m0, m0, 1024
s_add_u32 s39, s39, 65536
buffer_load_dwordx4 v52, s[8:11], s39 offen lds
s_add_u32 m0, m0, 1024
s_add_u32 s39, s39, 65536
buffer_load_dwordx4 v52, s[8:11], s39 offen lds
s_add_u32 m0, m0, 1024
s_add_u32 s39, s39, 65536
buffer_load_dwordx4 v52, s[8:11], s39 offen lds
s_add_u32 m0, m0, 1024
s_add_u32 s39, s39, 65536
buffer_load_dwordx4 v52, s[8:11], s39 offen lds
s_add_u32 m0, m0, 1024
s_add_u32 s39, s39, 65536
buffer_load_dwordx4 v52, s[8:11], s39 offen lds
s_add_u32 m0, m0, 1024
s_add_u32 s39, s39, 65536
buffer_load_dwordx4 v52, s[8:11], s39 offen lds
s_waitcnt vmcnt(32)
ds_read_b64_tr_b16 v[224:225], v55 offset:8192
ds_read_b64_tr_b16 v[226:227], v55 offset:8448
ds_read_b64_tr_b16 v[228:229], v55 offset:12288
ds_read_b64_tr_b16 v[230:231], v55 offset:12544
ds_read_b64_tr_b16 v[232:233], v55 offset:8224
ds_read_b64_tr_b16 v[234:235], v55 offset:8480
ds_read_b64_tr_b16 v[236:237], v55 offset:12320
ds_read_b64_tr_b16 v[238:239], v55 offset:12576
ds_read_b64_tr_b16 v[240:241], v55 offset:8256
ds_read_b64_tr_b16 v[242:243], v55 offset:8512
ds_read_b64_tr_b16 v[244:245], v55 offset:12352
ds_read_b64_tr_b16 v[246:247], v55 offset:12608
ds_read_b64_tr_b16 v[248:249], v55 offset:8288
ds_read_b64_tr_b16 v[250:251], v55 offset:8544
ds_read_b64_tr_b16 v[252:253], v55 offset:12384
ds_read_b64_tr_b16 v[254:255], v55 offset:12640
s_waitcnt lgkmcnt(0)
s_mov_b32 s8, s20
s_and_b32 s9, s21, 0xffff
s_mov_b32 s10, 0x800000
s_mov_b32 s11, 0x20000
s_lshl_b32 s39, s32, 21
s_lshl_b32 s38, s33, 4
s_add_u32 s38, s38, s54
s_xor_b32 s38, s38, 4
s_lshl_b32 s38, s38, 7
s_add_u32 s39, s39, s38
s_add_u32 s39, s39, 0
s_mul_i32 s38, s32, 40960
s_add_u32 m0, s38, 8192
s_nop 0
buffer_load_dwordx4 v51, s[8:11], s39 offen lds
s_add_u32 m0, m0, 1024
s_add_u32 s39, s39, 65536
buffer_load_dwordx4 v51, s[8:11], s39 offen lds
s_add_u32 m0, m0, 1024
s_add_u32 s39, s39, 65536
buffer_load_dwordx4 v51, s[8:11], s39 offen lds
s_add_u32 m0, m0, 1024
s_add_u32 s39, s39, 65536
buffer_load_dwordx4 v51, s[8:11], s39 offen lds
s_add_u32 m0, m0, 1024
s_add_u32 s39, s39, 65536
buffer_load_dwordx4 v51, s[8:11], s39 offen lds
s_add_u32 m0, m0, 1024
s_add_u32 s39, s39, 65536
buffer_load_dwordx4 v51, s[8:11], s39 offen lds
s_add_u32 m0, m0, 1024
s_add_u32 s39, s39, 65536
buffer_load_dwordx4 v51, s[8:11], s39 offen lds
s_add_u32 m0, m0, 1024
s_add_u32 s39, s39, 65536
buffer_load_dwordx4 v51, s[8:11], s39 offen lds
s_waitcnt vmcnt(32)
ds_read_b64_tr_b16 a[64:65], v54 offset:16384
ds_read_b64_tr_b16 a[66:67], v54 offset:16640
ds_read_b64_tr_b16 a[68:69], v54 offset:20480
ds_read_b64_tr_b16 a[70:71], v54 offset:20736
ds_read_b64_tr_b16 a[72:73], v54 offset:16400
ds_read_b64_tr_b16 a[74:75], v54 offset:16656
ds_read_b64_tr_b16 a[76:77], v54 offset:20496
ds_read_b64_tr_b16 a[78:79], v54 offset:20752
ds_read_b64_tr_b16 a[80:81], v54 offset:16448
ds_read_b64_tr_b16 a[82:83], v54 offset:16704
ds_read_b64_tr_b16 a[84:85], v54 offset:20544
ds_read_b64_tr_b16 a[86:87], v54 offset:20800
ds_read_b64_tr_b16 a[88:89], v54 offset:16464
ds_read_b64_tr_b16 a[90:91], v54 offset:16720
ds_read_b64_tr_b16 a[92:93], v54 offset:20560
ds_read_b64_tr_b16 a[94:95], v54 offset:20816
s_waitcnt lgkmcnt(0)
s_mov_b32 s8, s22
s_and_b32 s9, s23, 0xffff
s_mov_b32 s10, 0x800000
s_mov_b32 s11, 0x20000
s_lshl_b32 s39, s32, 21
s_lshl_b32 s38, s33, 4
s_add_u32 s38, s38, s54
s_xor_b32 s38, s38, 2
s_lshl_b32 s38, s38, 7
s_add_u32 s39, s39, s38
s_add_u32 s39, s39, 0
s_mul_i32 s38, s32, 40960
s_add_u32 m0, s38, 16384
s_nop 0
buffer_load_dwordx4 v52, s[8:11], s39 offen lds
s_add_u32 m0, m0, 1024
s_add_u32 s39, s39, 65536
buffer_load_dwordx4 v52, s[8:11], s39 offen lds
s_add_u32 m0, m0, 1024
s_add_u32 s39, s39, 65536
buffer_load_dwordx4 v52, s[8:11], s39 offen lds
s_add_u32 m0, m0, 1024
s_add_u32 s39, s39, 65536
buffer_load_dwordx4 v52, s[8:11], s39 offen lds
s_add_u32 m0, m0, 1024
s_add_u32 s39, s39, 65536
buffer_load_dwordx4 v52, s[8:11], s39 offen lds
s_add_u32 m0, m0, 1024
s_add_u32 s39, s39, 65536
buffer_load_dwordx4 v52, s[8:11], s39 offen lds
s_add_u32 m0, m0, 1024
s_add_u32 s39, s39, 65536
buffer_load_dwordx4 v52, s[8:11], s39 offen lds
s_add_u32 m0, m0, 1024
s_add_u32 s39, s39, 65536
buffer_load_dwordx4 v52, s[8:11], s39 offen lds
s_waitcnt vmcnt(32)
ds_read_b64_tr_b16 v[192:193], v55 offset:24576
ds_read_b64_tr_b16 v[194:195], v55 offset:24832
ds_read_b64_tr_b16 v[196:197], v55 offset:28672
ds_read_b64_tr_b16 v[198:199], v55 offset:28928
ds_read_b64_tr_b16 v[200:201], v55 offset:24608
ds_read_b64_tr_b16 v[202:203], v55 offset:24864
ds_read_b64_tr_b16 v[204:205], v55 offset:28704
ds_read_b64_tr_b16 v[206:207], v55 offset:28960
ds_read_b64_tr_b16 v[208:209], v55 offset:24640
ds_read_b64_tr_b16 v[210:211], v55 offset:24896
ds_read_b64_tr_b16 v[212:213], v55 offset:28736
ds_read_b64_tr_b16 v[214:215], v55 offset:28992
ds_read_b64_tr_b16 v[216:217], v55 offset:24672
ds_read_b64_tr_b16 v[218:219], v55 offset:24928
ds_read_b64_tr_b16 v[220:221], v55 offset:28768
ds_read_b64_tr_b16 v[222:223], v55 offset:29024
s_waitcnt lgkmcnt(0)
s_mov_b32 s8, s24
s_and_b32 s9, s25, 0xffff
s_mov_b32 s10, 0x800000
s_mov_b32 s11, 0x20000
s_lshl_b32 s39, s33, 2
s_add_u32 s39, s39, s32
s_lshl_b32 s39, s39, 19
s_lshl_b32 s38, s54, 7
s_add_u32 s39, s39, s38
s_add_u32 s39, s39, 0
s_mul_i32 s38, s32, 40960
s_add_u32 m0, s38, 24576
s_nop 0
buffer_load_dwordx4 v53, s[8:11], s39 offen lds
s_add_u32 m0, m0, 1024
s_add_u32 s39, s39, 16384
buffer_load_dwordx4 v53, s[8:11], s39 offen lds
s_add_u32 m0, m0, 1024
s_add_u32 s39, s39, 16384
buffer_load_dwordx4 v53, s[8:11], s39 offen lds
s_add_u32 m0, m0, 1024
s_add_u32 s39, s39, 16384
buffer_load_dwordx4 v53, s[8:11], s39 offen lds
s_add_u32 m0, m0, 1024
s_add_u32 s39, s39, 16384
buffer_load_dwordx4 v53, s[8:11], s39 offen lds
s_add_u32 m0, m0, 1024
s_add_u32 s39, s39, 16384
buffer_load_dwordx4 v53, s[8:11], s39 offen lds
s_add_u32 m0, m0, 1024
s_add_u32 s39, s39, 16384
buffer_load_dwordx4 v53, s[8:11], s39 offen lds
s_add_u32 m0, m0, 1024
s_add_u32 s39, s39, 16384
buffer_load_dwordx4 v53, s[8:11], s39 offen lds
s_waitcnt vmcnt(32)
ds_read_b64_tr_b16 a[32:33], v54 offset:32768
ds_read_b64_tr_b16 a[34:35], v54 offset:33024
ds_read_b64_tr_b16 a[36:37], v54 offset:36864
ds_read_b64_tr_b16 a[38:39], v54 offset:37120
ds_read_b64_tr_b16 a[40:41], v54 offset:32784
ds_read_b64_tr_b16 a[42:43], v54 offset:33040
ds_read_b64_tr_b16 a[44:45], v54 offset:36880
ds_read_b64_tr_b16 a[46:47], v54 offset:37136
ds_read_b64_tr_b16 a[48:49], v54 offset:32832
ds_read_b64_tr_b16 a[50:51], v54 offset:33088
ds_read_b64_tr_b16 a[52:53], v54 offset:36928
ds_read_b64_tr_b16 a[54:55], v54 offset:37184
ds_read_b64_tr_b16 a[56:57], v54 offset:32848
ds_read_b64_tr_b16 a[58:59], v54 offset:33104
ds_read_b64_tr_b16 a[60:61], v54 offset:36944
ds_read_b64_tr_b16 a[62:63], v54 offset:37200
s_waitcnt lgkmcnt(0)
s_mov_b32 s8, s24
s_and_b32 s9, s25, 0xffff
s_mov_b32 s10, 0x800000
s_mov_b32 s11, 0x20000
s_lshl_b32 s39, s33, 2
s_add_u32 s39, s39, s32
s_lshl_b32 s39, s39, 19
s_lshl_b32 s38, s54, 7
s_add_u32 s39, s39, s38
s_add_u32 s39, s39, 131072
s_mul_i32 s38, s32, 40960
s_add_u32 m0, s38, 32768
s_nop 0
buffer_load_dwordx4 v53, s[8:11], s39 offen lds
s_add_u32 m0, m0, 1024
s_add_u32 s39, s39, 16384
buffer_load_dwordx4 v53, s[8:11], s39 offen lds
s_add_u32 m0, m0, 1024
s_add_u32 s39, s39, 16384
buffer_load_dwordx4 v53, s[8:11], s39 offen lds
s_add_u32 m0, m0, 1024
s_add_u32 s39, s39, 16384
buffer_load_dwordx4 v53, s[8:11], s39 offen lds
s_add_u32 m0, m0, 1024
s_add_u32 s39, s39, 16384
buffer_load_dwordx4 v53, s[8:11], s39 offen lds
s_add_u32 m0, m0, 1024
s_add_u32 s39, s39, 16384
buffer_load_dwordx4 v53, s[8:11], s39 offen lds
s_add_u32 m0, m0, 1024
s_add_u32 s39, s39, 16384
buffer_load_dwordx4 v53, s[8:11], s39 offen lds
s_add_u32 m0, m0, 1024
s_add_u32 s39, s39, 16384
buffer_load_dwordx4 v53, s[8:11], s39 offen lds
s_waitcnt vmcnt(32)
ds_read_b64_tr_b16 v[160:161], v55 offset:0
ds_read_b64_tr_b16 v[162:163], v55 offset:256
ds_read_b64_tr_b16 v[164:165], v55 offset:4096
ds_read_b64_tr_b16 v[166:167], v55 offset:4352
ds_read_b64_tr_b16 v[168:169], v55 offset:32
ds_read_b64_tr_b16 v[170:171], v55 offset:288
ds_read_b64_tr_b16 v[172:173], v55 offset:4128
ds_read_b64_tr_b16 v[174:175], v55 offset:4384
ds_read_b64_tr_b16 v[176:177], v55 offset:64
ds_read_b64_tr_b16 v[178:179], v55 offset:320
ds_read_b64_tr_b16 v[180:181], v55 offset:4160
ds_read_b64_tr_b16 v[182:183], v55 offset:4416
ds_read_b64_tr_b16 v[184:185], v55 offset:96
ds_read_b64_tr_b16 v[186:187], v55 offset:352
ds_read_b64_tr_b16 v[188:189], v55 offset:4192
ds_read_b64_tr_b16 v[190:191], v55 offset:4448
s_waitcnt lgkmcnt(0)
s_mov_b32 s8, s24
s_and_b32 s9, s25, 0xffff
s_mov_b32 s10, 0x800000
s_mov_b32 s11, 0x20000
s_lshl_b32 s39, s33, 2
s_add_u32 s39, s39, s32
s_lshl_b32 s39, s39, 19
s_lshl_b32 s38, s54, 7
s_add_u32 s39, s39, s38
s_add_u32 s39, s39, 262144
s_mul_i32 s38, s32, 40960
s_add_u32 m0, s38, 0
s_nop 0
buffer_load_dwordx4 v53, s[8:11], s39 offen lds
s_add_u32 m0, m0, 1024
s_add_u32 s39, s39, 16384
buffer_load_dwordx4 v53, s[8:11], s39 offen lds
s_add_u32 m0, m0, 1024
s_add_u32 s39, s39, 16384
buffer_load_dwordx4 v53, s[8:11], s39 offen lds
s_add_u32 m0, m0, 1024
s_add_u32 s39, s39, 16384
buffer_load_dwordx4 v53, s[8:11], s39 offen lds
s_add_u32 m0, m0, 1024
s_add_u32 s39, s39, 16384
buffer_load_dwordx4 v53, s[8:11], s39 offen lds
s_add_u32 m0, m0, 1024
s_add_u32 s39, s39, 16384
buffer_load_dwordx4 v53, s[8:11], s39 offen lds
s_add_u32 m0, m0, 1024
s_add_u32 s39, s39, 16384
buffer_load_dwordx4 v53, s[8:11], s39 offen lds
s_add_u32 m0, m0, 1024
s_add_u32 s39, s39, 16384
buffer_load_dwordx4 v53, s[8:11], s39 offen lds
s_waitcnt vmcnt(32)
ds_read_b64_tr_b16 a[0:1], v54 offset:8192
ds_read_b64_tr_b16 a[2:3], v54 offset:8448
ds_read_b64_tr_b16 a[4:5], v54 offset:12288
ds_read_b64_tr_b16 a[6:7], v54 offset:12544
ds_read_b64_tr_b16 a[8:9], v54 offset:8208
ds_read_b64_tr_b16 a[10:11], v54 offset:8464
ds_read_b64_tr_b16 a[12:13], v54 offset:12304
ds_read_b64_tr_b16 a[14:15], v54 offset:12560
ds_read_b64_tr_b16 a[16:17], v54 offset:8256
ds_read_b64_tr_b16 a[18:19], v54 offset:8512
ds_read_b64_tr_b16 a[20:21], v54 offset:12352
ds_read_b64_tr_b16 a[22:23], v54 offset:12608
ds_read_b64_tr_b16 a[24:25], v54 offset:8272
ds_read_b64_tr_b16 a[26:27], v54 offset:8528
ds_read_b64_tr_b16 a[28:29], v54 offset:12368
ds_read_b64_tr_b16 a[30:31], v54 offset:12624
s_waitcnt lgkmcnt(0)
s_mov_b32 s8, s24
s_and_b32 s9, s25, 0xffff
s_mov_b32 s10, 0x800000
s_mov_b32 s11, 0x20000
s_lshl_b32 s39, s33, 2
s_add_u32 s39, s39, s32
s_lshl_b32 s39, s39, 19
s_lshl_b32 s38, s54, 7
s_add_u32 s39, s39, s38
s_add_u32 s39, s39, 393216
s_mul_i32 s38, s32, 40960
s_add_u32 m0, s38, 8192
s_nop 0
buffer_load_dwordx4 v53, s[8:11], s39 offen lds
s_add_u32 m0, m0, 1024
s_add_u32 s39, s39, 16384
buffer_load_dwordx4 v53, s[8:11], s39 offen lds
s_add_u32 m0, m0, 1024
s_add_u32 s39, s39, 16384
buffer_load_dwordx4 v53, s[8:11], s39 offen lds
s_add_u32 m0, m0, 1024
s_add_u32 s39, s39, 16384
buffer_load_dwordx4 v53, s[8:11], s39 offen lds
s_add_u32 m0, m0, 1024
s_add_u32 s39, s39, 16384
buffer_load_dwordx4 v53, s[8:11], s39 offen lds
s_add_u32 m0, m0, 1024
s_add_u32 s39, s39, 16384
buffer_load_dwordx4 v53, s[8:11], s39 offen lds
s_add_u32 m0, m0, 1024
s_add_u32 s39, s39, 16384
buffer_load_dwordx4 v53, s[8:11], s39 offen lds
s_add_u32 m0, m0, 1024
s_add_u32 s39, s39, 16384
buffer_load_dwordx4 v53, s[8:11], s39 offen lds
s_waitcnt vmcnt(32)
ds_read_b64_tr_b16 v[128:129], v55 offset:16384
ds_read_b64_tr_b16 v[130:131], v55 offset:16640
ds_read_b64_tr_b16 v[132:133], v55 offset:20480
ds_read_b64_tr_b16 v[134:135], v55 offset:20736
ds_read_b64_tr_b16 v[136:137], v55 offset:16416
ds_read_b64_tr_b16 v[138:139], v55 offset:16672
ds_read_b64_tr_b16 v[140:141], v55 offset:20512
ds_read_b64_tr_b16 v[142:143], v55 offset:20768
ds_read_b64_tr_b16 v[144:145], v55 offset:16448
ds_read_b64_tr_b16 v[146:147], v55 offset:16704
ds_read_b64_tr_b16 v[148:149], v55 offset:20544
ds_read_b64_tr_b16 v[150:151], v55 offset:20800
ds_read_b64_tr_b16 v[152:153], v55 offset:16480
ds_read_b64_tr_b16 v[154:155], v55 offset:16736
ds_read_b64_tr_b16 v[156:157], v55 offset:20576
ds_read_b64_tr_b16 v[158:159], v55 offset:20832
s_waitcnt lgkmcnt(0)
s_waitcnt vmcnt(24)
ds_read_b64_tr_b16 a[128:129], v56 offset:24576
ds_read_b64_tr_b16 a[130:131], v56 offset:24832
ds_read_b64_tr_b16 a[132:133], v56 offset:28672
ds_read_b64_tr_b16 a[134:135], v56 offset:28928
ds_read_b64_tr_b16 a[136:137], v56 offset:24608
ds_read_b64_tr_b16 a[138:139], v56 offset:24864
ds_read_b64_tr_b16 a[140:141], v56 offset:28704
ds_read_b64_tr_b16 a[142:143], v56 offset:28960
ds_read_b64_tr_b16 a[144:145], v56 offset:24640
ds_read_b64_tr_b16 a[146:147], v56 offset:24896
ds_read_b64_tr_b16 a[148:149], v56 offset:28736
ds_read_b64_tr_b16 a[150:151], v56 offset:28992
ds_read_b64_tr_b16 a[152:153], v56 offset:24672
ds_read_b64_tr_b16 a[154:155], v56 offset:24928
ds_read_b64_tr_b16 a[156:157], v56 offset:28768
ds_read_b64_tr_b16 a[158:159], v56 offset:29024
s_waitcnt lgkmcnt(0)
s_waitcnt vmcnt(16)
ds_read_b64_tr_b16 a[160:161], v56 offset:32768
ds_read_b64_tr_b16 a[162:163], v56 offset:33024
ds_read_b64_tr_b16 a[164:165], v56 offset:36864
ds_read_b64_tr_b16 a[166:167], v56 offset:37120
ds_read_b64_tr_b16 a[168:169], v56 offset:32800
ds_read_b64_tr_b16 a[170:171], v56 offset:33056
ds_read_b64_tr_b16 a[172:173], v56 offset:36896
ds_read_b64_tr_b16 a[174:175], v56 offset:37152
ds_read_b64_tr_b16 a[176:177], v56 offset:32832
ds_read_b64_tr_b16 a[178:179], v56 offset:33088
ds_read_b64_tr_b16 a[180:181], v56 offset:36928
ds_read_b64_tr_b16 a[182:183], v56 offset:37184
ds_read_b64_tr_b16 a[184:185], v56 offset:32864
ds_read_b64_tr_b16 a[186:187], v56 offset:33120
ds_read_b64_tr_b16 a[188:189], v56 offset:36960
ds_read_b64_tr_b16 a[190:191], v56 offset:37216
s_waitcnt lgkmcnt(0)
s_waitcnt vmcnt(8)
ds_read_b64_tr_b16 a[192:193], v56 offset:0
ds_read_b64_tr_b16 a[194:195], v56 offset:256
ds_read_b64_tr_b16 a[196:197], v56 offset:4096
ds_read_b64_tr_b16 a[198:199], v56 offset:4352
ds_read_b64_tr_b16 a[200:201], v56 offset:32
ds_read_b64_tr_b16 a[202:203], v56 offset:288
ds_read_b64_tr_b16 a[204:205], v56 offset:4128
ds_read_b64_tr_b16 a[206:207], v56 offset:4384
ds_read_b64_tr_b16 a[208:209], v56 offset:64
ds_read_b64_tr_b16 a[210:211], v56 offset:320
ds_read_b64_tr_b16 a[212:213], v56 offset:4160
ds_read_b64_tr_b16 a[214:215], v56 offset:4416
ds_read_b64_tr_b16 a[216:217], v56 offset:96
ds_read_b64_tr_b16 a[218:219], v56 offset:352
ds_read_b64_tr_b16 a[220:221], v56 offset:4192
ds_read_b64_tr_b16 a[222:223], v56 offset:4448
s_waitcnt lgkmcnt(0)
s_waitcnt vmcnt(0)
ds_read_b64_tr_b16 a[224:225], v56 offset:8192
ds_read_b64_tr_b16 a[226:227], v56 offset:8448
ds_read_b64_tr_b16 a[228:229], v56 offset:12288
ds_read_b64_tr_b16 a[230:231], v56 offset:12544
ds_read_b64_tr_b16 a[232:233], v56 offset:8224
ds_read_b64_tr_b16 a[234:235], v56 offset:8480
ds_read_b64_tr_b16 a[236:237], v56 offset:12320
ds_read_b64_tr_b16 a[238:239], v56 offset:12576
ds_read_b64_tr_b16 a[240:241], v56 offset:8256
ds_read_b64_tr_b16 a[242:243], v56 offset:8512
ds_read_b64_tr_b16 a[244:245], v56 offset:12352
ds_read_b64_tr_b16 a[246:247], v56 offset:12608
ds_read_b64_tr_b16 a[248:249], v56 offset:8288
ds_read_b64_tr_b16 a[250:251], v56 offset:8544
ds_read_b64_tr_b16 a[252:253], v56 offset:12384
ds_read_b64_tr_b16 a[254:255], v56 offset:12640
s_waitcnt lgkmcnt(0)
Lst_278:
buffer_load_dword v48, off, s[12:15], 0 offset:16 sc1
buffer_load_dword v49, off, s[12:15], 0 offset:144 sc1
s_waitcnt vmcnt(0)
v_add_u32 v48, v48, v49
s_nop 0
v_readfirstlane_b32 s38, v48
s_nop 3
s_and_b32 s39, s38, 0x200ffff
s_cmp_eq_u32 s39, 0x2000100
s_cbranch_scc1 Lso_279
s_sub_u32 s37, s37, 1
s_cbranch_scc1 Lend_1
s_sleep 8
s_branch Lst_278
Lso_279:
s_bfe_u32 s35, s38, 0x80010
s_bfe_u32 s46, s38, 0x10018
s_lshl_b32 s46, s46, 13
s_barrier
s_lshl_b32 s38, s54, 14
s_add_u32 s38, s38, s45
buffer_load_dwordx4 v[28:31], v8, s[4:7], s38 offen offset:0 sc1
buffer_load_dwordx4 v[32:35], v8, s[4:7], s38 offen offset:1024 sc1
buffer_load_dwordx4 v[36:39], v8, s[4:7], s38 offen offset:2048 sc1
buffer_load_dwordx4 v[40:43], v8, s[4:7], s38 offen offset:3072 sc1
v_mov_b32 v44, 0
v_mov_b32 v45, 0
v_mov_b32 v46, 0
v_mov_b32 v47, 0
v_mov_b32 v48, 0
v_mov_b32 v49, 0
v_mov_b32 v50, 0
v_mov_b32 v51, 0
v_mov_b32 v52, 0
v_mov_b32 v53, 0
v_mov_b32 v54, 0
v_mov_b32 v55, 0
v_mov_b32 v56, 0
v_mov_b32 v57, 0
v_mov_b32 v58, 0
v_mov_b32 v59, 0
v_mov_b32 v60, 0
v_mov_b32 v61, 0
v_mov_b32 v62, 0
v_mov_b32 v63, 0
v_mov_b32 v64, 0
v_mov_b32 v65, 0
v_mov_b32 v66, 0
v_mov_b32 v67, 0
v_mov_b32 v68, 0
v_mov_b32 v69, 0
v_mov_b32 v70, 0
v_mov_b32 v71, 0
v_mov_b32 v72, 0
v_mov_b32 v73, 0
v_mov_b32 v74, 0
v_mov_b32 v75, 0
v_mov_b32 v76, 0
v_mov_b32 v77, 0
v_mov_b32 v78, 0
v_mov_b32 v79, 0
v_mov_b32 v80, 0
v_mov_b32 v81, 0
v_mov_b32 v82, 0
v_mov_b32 v83, 0
v_mov_b32 v84, 0
v_mov_b32 v85, 0
v_mov_b32 v86, 0
v_mov_b32 v87, 0
v_mov_b32 v88, 0
v_mov_b32 v89, 0
v_mov_b32 v90, 0
v_mov_b32 v91, 0
s_mov_b32 s36, 0
s_and_b32 s38, s36, 3
s_lshl_b32 s39, s38, 16
s_add_u32 s40, s39, s45
s_xor_b32 s42, s40, 0x20000
s_add_u32 s26, s36, 1
s_cmp_lg_u32 s35, 0
s_cbranch_scc1 Lkvo_sc1_280
Lkvo_281:
buffer_load_dwordx4 v[28:31], v8, s[4:7], s40 offen offset:0 sc1
s_nop 11
buffer_load_dwordx4 v[32:35], v8, s[4:7], s40 offen offset:1024 sc1
s_nop 11
buffer_load_dwordx4 v[36:39], v8, s[4:7], s40 offen offset:2048 sc1
s_nop 11
buffer_load_dwordx4 v[40:43], v8, s[4:7], s40 offen offset:3072 sc1
s_nop 11
s_waitcnt vmcnt(3)
v_max3_u32 v110, v28, v29, v30
v_max_u32 v110, v110, v31
v_cmp_eq_u32 vcc, -1, v110
s_cbranch_vccnz Lpf_283
v_smfmac_f32_16x16x64_bf16 v[44:47], v[28:31], a[0:7], v126
v_smfmac_f32_16x16x64_bf16 v[48:51], v[28:31], a[8:15], v126
s_waitcnt vmcnt(2)
v_max3_u32 v110, v32, v33, v34
v_max_u32 v110, v110, v35
v_cmp_eq_u32 vcc, -1, v110
v_smfmac_f32_16x16x64_bf16 v[52:55], v[28:31], a[16:23], v126
v_smfmac_f32_16x16x64_bf16 v[60:63], v[28:31], v[128:135], v126
s_cbranch_vccnz Lpf_284
v_smfmac_f32_16x16x64_bf16 v[44:47], v[32:35], a[32:39], v126
v_smfmac_f32_16x16x64_bf16 v[48:51], v[32:35], a[40:47], v126
s_waitcnt vmcnt(1)
v_max3_u32 v110, v36, v37, v38
v_max_u32 v110, v110, v39
v_cmp_eq_u32 vcc, -1, v110
v_smfmac_f32_16x16x64_bf16 v[52:55], v[32:35], a[48:55], v126
v_smfmac_f32_16x16x64_bf16 v[60:63], v[32:35], v[160:167], v126
s_cbranch_vccnz Lpf_285
v_smfmac_f32_16x16x64_bf16 v[44:47], v[36:39], a[64:71], v126
v_smfmac_f32_16x16x64_bf16 v[48:51], v[36:39], a[72:79], v126
s_waitcnt vmcnt(0)
v_max3_u32 v110, v40, v41, v42
v_max_u32 v110, v110, v43
v_cmp_eq_u32 vcc, -1, v110
v_smfmac_f32_16x16x64_bf16 v[52:55], v[36:39], a[80:87], v126
v_smfmac_f32_16x16x64_bf16 v[60:63], v[36:39], v[192:199], v126
s_cbranch_vccnz Lpf_286
v_smfmac_f32_16x16x64_bf16 v[44:47], v[40:43], a[96:103], v126
s_nop 1
v_smfmac_f32_16x16x64_bf16 v[48:51], v[40:43], a[104:111], v126
s_nop 1
v_smfmac_f32_16x16x64_bf16 v[52:55], v[40:43], a[112:119], v126
s_nop 1
v_add_f32 v92, v44, v46
v_add_f32 v93, v45, v47
v_smfmac_f32_16x16x64_bf16 v[56:59], v[28:31], a[24:31], v126
v_add_f32 v94, v48, v50
v_add_f32 v95, v49, v51
ds_write_b64 v24, v[92:93] offset:0
v_add_f32 v96, v52, v54
v_add_f32 v97, v53, v55
ds_write_b64 v25, v[94:95] offset:0
v_smfmac_f32_16x16x64_bf16 v[56:59], v[32:35], a[56:63], v126
ds_write_b64 v26, v[96:97] offset:0
v_smfmac_f32_16x16x64_bf16 v[56:59], v[36:39], a[88:95], v126
v_smfmac_f32_16x16x64_bf16 v[56:59], v[40:43], a[120:127], v126
v_smfmac_f32_16x16x64_bf16 v[60:63], v[40:43], v[224:231], v126
Lpd_282:
v_smfmac_f32_16x16x64_bf16 v[64:67], v[28:31], v[136:143], v126
v_smfmac_f32_16x16x64_bf16 v[64:67], v[32:35], v[168:175], v126
s_waitcnt lgkmcnt(0)
s_barrier
ds_read_b64 v[100:101], v0 offset:0
ds_read_b64 v[102:103], v0 offset:512
ds_read_b64 v[104:105], v0 offset:1024
s_nop 2
v_add_f32 v98, v56, v58
v_add_f32 v99, v57, v59
v_smfmac_f32_16x16x64_bf16 v[64:67], v[36:39], v[200:207], v126
v_smfmac_f32_16x16x64_bf16 v[64:67], v[40:43], v[232:239], v126
v_smfmac_f32_16x16x64_bf16 v[68:71], v[28:31], v[144:151], v126
v_smfmac_f32_16x16x64_bf16 v[68:71], v[32:35], v[176:183], v126
s_waitcnt lgkmcnt(0)
v_add_f32 v100, v100, v98
v_add_f32 v102, v102, v104
v_add_f32 v101, v101, v99
v_add_f32 v103, v103, v105
v_add_f32 v100, v100, v102
v_add_f32 v101, v101, v103
v_cvt_pk_bf16_f32 v108, v100, v101
s_nop 1
v_mov_b32_dpp v109, v108 quad_perm:[1,0,3,2] row_mask:0xf bank_mask:0xf
v_perm_b32 v109, v109, v108, v3
buffer_store_dword v109, v11, s[4:7], s40 offen
v_smfmac_f32_16x16x64_bf16 v[68:71], v[36:39], v[208:215], v126
v_smfmac_f32_16x16x64_bf16 v[68:71], v[40:43], v[240:247], v126
s_nop 3
v_smfmac_f32_16x16x64_bf16 v[72:75], v[28:31], v[152:159], v126
v_add_f32 v92, v60, v62
v_add_f32 v93, v61, v63
v_smfmac_f32_16x16x64_bf16 v[72:75], v[32:35], v[184:191], v126
v_add_f32 v94, v64, v66
v_add_f32 v95, v65, v67
ds_write_b64 v24, v[92:93] offset:6144
v_smfmac_f32_16x16x64_bf16 v[72:75], v[36:39], v[216:223], v126
v_add_f32 v96, v68, v70
v_add_f32 v97, v69, v71
ds_write_b64 v25, v[94:95] offset:6144
ds_write_b64 v26, v[96:97] offset:6144
v_smfmac_f32_16x16x64_bf16 v[72:75], v[40:43], v[248:255], v126
s_waitcnt lgkmcnt(0)
s_barrier
ds_read_b64 v[100:101], v0 offset:6144
ds_read_b64 v[102:103], v0 offset:6656
ds_read_b64 v[104:105], v0 offset:7168
s_nop 2
v_add_f32 v98, v72, v74
v_add_f32 v99, v73, v75
s_waitcnt lgkmcnt(0)
v_pk_add_f32 v[100:101], v[100:101], v[98:99]
v_pk_add_f32 v[102:103], v[102:103], v[104:105]
v_pk_add_f32 v[100:101], v[100:101], v[102:103]
v_cvt_pk_bf16_f32 v108, v100, v101
buffer_store_dword v108, v27, s[4:7], s40 offen
s_cmp_eq_u32 s36, 63
s_cbranch_scc1 Lend_1
v_add_u32 v7, 1, v7
s_and_b32 s38, s36, 3
s_lshl_b32 s84, s38, 18
s_add_u32 s84, s84, s46
s_add_u32 s85, s84, 0x100000
s_mov_b64 exec, 3
buffer_load_dword v112, v1, s[4:7], s59 offen sc1
s_nop 5
buffer_load_dword v113, v1, s[4:7], s59 offen sc1
s_nop 5
buffer_load_dword v114, v1, s[4:7], s59 offen sc1
Lft_288:
s_waitcnt vmcnt(2)
v_cmp_gt_u32 vcc, s26, v112
buffer_load_dword v112, v1, s[4:7], s59 offen sc1
s_cbranch_vccz Lfg_287
s_waitcnt vmcnt(2)
v_cmp_gt_u32 vcc, s26, v113
buffer_load_dword v113, v1, s[4:7], s59 offen sc1
s_cbranch_vccz Lfg_287
s_waitcnt vmcnt(2)
v_cmp_gt_u32 vcc, s26, v114
buffer_load_dword v114, v1, s[4:7], s59 offen sc1
s_cbranch_vccz Lfg_287
s_sub_u32 s37, s37, 1
s_cbranch_scc1 Lend_1
s_branch Lft_288
Lfg_287:
s_mov_b64 exec, -1
buffer_load_dwordx4 v[28:31], v9, s[4:7], s40 offen offset:0 sc1
s_nop 11
buffer_load_dwordx4 v[32:35], v9, s[4:7], s40 offen offset:1024 sc1
s_nop 11
buffer_load_dwordx4 v[36:39], v9, s[4:7], s40 offen offset:2048 sc1
s_nop 11
buffer_load_dwordx4 v[40:43], v9, s[4:7], s40 offen offset:3072 sc1
s_nop 11
s_waitcnt vmcnt(3)
v_max3_u32 v110, v28, v29, v30
v_max_u32 v110, v110, v31
v_cmp_eq_u32 vcc, -1, v110
s_cbranch_vccnz Lpf_290
v_smfmac_f32_16x16x64_bf16 v[76:79], v[28:31], a[128:135], v126
s_waitcnt vmcnt(2)
v_max3_u32 v110, v32, v33, v34
v_max_u32 v110, v110, v35
v_cmp_eq_u32 vcc, -1, v110
v_smfmac_f32_16x16x64_bf16 v[80:83], v[28:31], a[136:143], v126
v_smfmac_f32_16x16x64_bf16 v[84:87], v[28:31], a[144:151], v126
s_cbranch_vccnz Lpf_291
v_smfmac_f32_16x16x64_bf16 v[76:79], v[32:35], a[160:167], v126
s_waitcnt vmcnt(1)
v_max3_u32 v110, v36, v37, v38
v_max_u32 v110, v110, v39
v_cmp_eq_u32 vcc, -1, v110
v_smfmac_f32_16x16x64_bf16 v[80:83], v[32:35], a[168:175], v126
v_smfmac_f32_16x16x64_bf16 v[84:87], v[32:35], a[176:183], v126
s_cbranch_vccnz Lpf_292
v_smfmac_f32_16x16x64_bf16 v[76:79], v[36:39], a[192:199], v126
s_waitcnt vmcnt(0)
v_max3_u32 v110, v40, v41, v42
v_max_u32 v110, v110, v43
v_cmp_eq_u32 vcc, -1, v110
v_smfmac_f32_16x16x64_bf16 v[80:83], v[36:39], a[200:207], v126
v_smfmac_f32_16x16x64_bf16 v[84:87], v[36:39], a[208:215], v126
s_cbranch_vccnz Lpf_293
v_smfmac_f32_16x16x64_bf16 v[76:79], v[40:43], a[224:231], v126
s_nop 1
v_smfmac_f32_16x16x64_bf16 v[80:83], v[40:43], a[232:239], v126
s_nop 1
v_smfmac_f32_16x16x64_bf16 v[84:87], v[40:43], a[240:247], v126
s_nop 1
v_add_f32 v92, v76, v78
v_add_f32 v93, v77, v79
v_smfmac_f32_16x16x64_bf16 v[88:91], v[28:31], a[152:159], v126
v_add_f32 v94, v80, v82
v_add_f32 v95, v81, v83
ds_write_b64 v24, v[92:93] offset:12288
v_add_f32 v96, v84, v86
v_add_f32 v97, v85, v87
ds_write_b64 v25, v[94:95] offset:12288
v_smfmac_f32_16x16x64_bf16 v[88:91], v[32:35], a[184:191], v126
ds_write_b64 v26, v[96:97] offset:12288
v_smfmac_f32_16x16x64_bf16 v[88:91], v[36:39], a[216:223], v126
v_smfmac_f32_16x16x64_bf16 v[88:91], v[40:43], a[248:255], v126
Lpd_289:
s_waitcnt lgkmcnt(0)
s_barrier
ds_read_b64 v[100:101], v0 offset:12288
ds_read_b64 v[102:103], v0 offset:12800
ds_read_b64 v[104:105], v0 offset:13312
s_nop 2
v_add_f32 v98, v88, v90
v_add_f32 v99, v89, v91
s_waitcnt lgkmcnt(0)
v_pk_add_f32 v[100:101], v[100:101], v[98:99]
v_pk_add_f32 v[102:103], v[102:103], v[104:105]
v_pk_add_f32 v[100:101], v[100:101], v[102:103]
v_cvt_pk_bf16_f32 v108, v100, v101
buffer_store_dword v108, v12, s[4:7], s84 offen sc1
buffer_store_dword v108, v12, s[4:7], s85 offen sc1
s_waitcnt vmcnt(2)
buffer_store_dwordx2 v[4:5], v10, s[4:7], s42 offen
buffer_store_dword v4, v11, s[4:7], s42 offen
buffer_store_dword v4, v27, s[4:7], s42 offen
v_mov_b32 v112, v108
v_mov_b32 v116, v108
v_mov_b32 v120, v108
s_add_u32 s36, s36, 1
s_and_b32 s38, s36, 3
s_lshl_b32 s39, s38, 16
s_add_u32 s40, s39, s45
s_xor_b32 s42, s40, 0x20000
s_add_u32 s26, s36, 1
s_nop 15
s_nop 15
s_nop 15
s_nop 15
s_nop 15
buffer_load_dword v113, v13, s[4:7], s84 offen sc1
buffer_load_dword v114, v14, s[4:7], s84 offen sc1
buffer_load_dword v115, v15, s[4:7], s84 offen sc1
v_pk_mul_f32 v[44:45], 0, 0
v_pk_mul_f32 v[46:47], 0, 0
v_pk_mul_f32 v[48:49], 0, 0
v_pk_mul_f32 v[50:51], 0, 0
v_pk_mul_f32 v[52:53], 0, 0
v_pk_mul_f32 v[54:55], 0, 0
v_pk_mul_f32 v[56:57], 0, 0
v_pk_mul_f32 v[58:59], 0, 0
v_pk_mul_f32 v[60:61], 0, 0
v_pk_mul_f32 v[62:63], 0, 0
v_pk_mul_f32 v[64:65], 0, 0
v_pk_mul_f32 v[66:67], 0, 0
v_pk_mul_f32 v[68:69], 0, 0
v_pk_mul_f32 v[70:71], 0, 0
v_pk_mul_f32 v[72:73], 0, 0
v_pk_mul_f32 v[74:75], 0, 0
v_pk_mul_f32 v[76:77], 0, 0
v_pk_mul_f32 v[78:79], 0, 0
v_pk_mul_f32 v[80:81], 0, 0
v_pk_mul_f32 v[82:83], 0, 0
v_pk_mul_f32 v[84:85], 0, 0
v_pk_mul_f32 v[86:87], 0, 0
v_pk_mul_f32 v[88:89], 0, 0
v_pk_mul_f32 v[90:91], 0, 0
buffer_load_dword v117, v13, s[4:7], s85 offen sc1
buffer_load_dword v118, v14, s[4:7], s85 offen sc1
buffer_load_dword v119, v15, s[4:7], s85 offen sc1
buffer_store_dword v7, v2, s[4:7], s59 offen
s_nop 15
s_nop 15
s_nop 15
buffer_load_dword v121, v13, s[4:7], s84 offen sc1
buffer_load_dword v122, v14, s[4:7], s84 offen sc1
buffer_load_dword v123, v15, s[4:7], s84 offen sc1
s_waitcnt vmcnt(7)
v_mfma_f32_16x16x32_bf16 v[100:103], v[112:115], v[20:23], 0
v_max3_u32 v110, v113, v114, v115
v_cmp_eq_u32 vcc, -1, v110
s_nop 5
v_cvt_pk_bf16_f32 v106, v100, v101
v_cvt_pk_bf16_f32 v107, v102, v103
s_cbranch_vccnz Lx2_294
Lxs_295:
buffer_store_dwordx2 v[106:107], v10, s[4:7], s40 offen
s_nop 15
s_nop 15
s_nop 11
s_branch Lkvo_281
Lx2_294:
buffer_load_dword v113, v13, s[4:7], s85 offen sc1
buffer_load_dword v114, v14, s[4:7], s85 offen sc1
buffer_load_dword v115, v15, s[4:7], s85 offen sc1
s_waitcnt vmcnt(6)
v_mfma_f32_16x16x32_bf16 v[100:103], v[116:119], v[20:23], 0
v_max3_u32 v110, v117, v118, v119
v_cmp_eq_u32 vcc, -1, v110
s_nop 5
v_cvt_pk_bf16_f32 v106, v100, v101
v_cvt_pk_bf16_f32 v107, v102, v103
s_cbranch_vccz Lxs_295
buffer_load_dword v117, v13, s[4:7], s84 offen sc1
buffer_load_dword v118, v14, s[4:7], s84 offen sc1
buffer_load_dword v119, v15, s[4:7], s84 offen sc1
s_waitcnt vmcnt(6)
v_mfma_f32_16x16x32_bf16 v[100:103], v[120:123], v[20:23], 0
v_max3_u32 v110, v121, v122, v123
v_cmp_eq_u32 vcc, -1, v110
s_nop 5
v_cvt_pk_bf16_f32 v106, v100, v101
v_cvt_pk_bf16_f32 v107, v102, v103
s_cbranch_vccz Lxs_295
buffer_load_dword v121, v13, s[4:7], s85 offen sc1
buffer_load_dword v122, v14, s[4:7], s85 offen sc1
buffer_load_dword v123, v15, s[4:7], s85 offen sc1
s_waitcnt vmcnt(6)
v_mfma_f32_16x16x32_bf16 v[100:103], v[112:115], v[20:23], 0
v_max3_u32 v110, v113, v114, v115
v_cmp_eq_u32 vcc, -1, v110
s_nop 5
v_cvt_pk_bf16_f32 v106, v100, v101
v_cvt_pk_bf16_f32 v107, v102, v103
s_cbranch_vccz Lxs_295
buffer_load_dword v113, v13, s[4:7], s84 offen sc1
buffer_load_dword v114, v14, s[4:7], s84 offen sc1
buffer_load_dword v115, v15, s[4:7], s84 offen sc1
s_waitcnt vmcnt(6)
v_mfma_f32_16x16x32_bf16 v[100:103], v[116:119], v[20:23], 0
v_max3_u32 v110, v117, v118, v119
v_cmp_eq_u32 vcc, -1, v110
s_nop 5
v_cvt_pk_bf16_f32 v106, v100, v101
v_cvt_pk_bf16_f32 v107, v102, v103
s_cbranch_vccz Lxs_295
buffer_load_dword v117, v13, s[4:7], s85 offen sc1
buffer_load_dword v118, v14, s[4:7], s85 offen sc1
buffer_load_dword v119, v15, s[4:7], s85 offen sc1
s_waitcnt vmcnt(6)
v_mfma_f32_16x16x32_bf16 v[100:103], v[120:123], v[20:23], 0
v_max3_u32 v110, v121, v122, v123
v_cmp_eq_u32 vcc, -1, v110
s_nop 5
v_cvt_pk_bf16_f32 v106, v100, v101
v_cvt_pk_bf16_f32 v107, v102, v103
s_cbranch_vccz Lxs_295
buffer_load_dword v121, v13, s[4:7], s84 offen sc1
buffer_load_dword v122, v14, s[4:7], s84 offen sc1
buffer_load_dword v123, v15, s[4:7], s84 offen sc1
s_waitcnt vmcnt(6)
v_mfma_f32_16x16x32_bf16 v[100:103], v[112:115], v[20:23], 0
v_max3_u32 v110, v113, v114, v115
v_cmp_eq_u32 vcc, -1, v110
s_nop 5
v_cvt_pk_bf16_f32 v106, v100, v101
v_cvt_pk_bf16_f32 v107, v102, v103
s_cbranch_vccz Lxs_295
s_sub_u32 s37, s37, 1
s_cbranch_scc1 Lend_1
s_branch Lx2_294
Lpf_283:
buffer_load_dwordx4 v[28:31], v8, s[4:7], s40 offen offset:0 sc1
s_sub_u32 s37, s37, 1
s_cbranch_scc1 Lend_1
Lps_296:
s_waitcnt vmcnt(3)
v_max3_u32 v110, v32, v33, v34
v_max_u32 v110, v110, v35
v_cmp_eq_u32 vcc, -1, v110
s_cbranch_vccnz Lpf_297
v_smfmac_f32_16x16x64_bf16 v[44:47], v[32:35], a[32:39], v126
v_smfmac_f32_16x16x64_bf16 v[48:51], v[32:35], a[40:47], v126
v_smfmac_f32_16x16x64_bf16 v[52:55], v[32:35], a[48:55], v126
v_smfmac_f32_16x16x64_bf16 v[60:63], v[32:35], v[160:167], v126
Lps_298:
s_waitcnt vmcnt(2)
v_max3_u32 v110, v36, v37, v38
v_max_u32 v110, v110, v39
v_cmp_eq_u32 vcc, -1, v110
s_cbranch_vccnz Lpf_299
v_smfmac_f32_16x16x64_bf16 v[44:47], v[36:39], a[64:71], v126
v_smfmac_f32_16x16x64_bf16 v[48:51], v[36:39], a[72:79], v126
v_smfmac_f32_16x16x64_bf16 v[52:55], v[36:39], a[80:87], v126
v_smfmac_f32_16x16x64_bf16 v[60:63], v[36:39], v[192:199], v126
Lps_300:
s_waitcnt vmcnt(1)
v_max3_u32 v110, v40, v41, v42
v_max_u32 v110, v110, v43
v_cmp_eq_u32 vcc, -1, v110
s_cbranch_vccnz Lpf_301
v_smfmac_f32_16x16x64_bf16 v[44:47], v[40:43], a[96:103], v126
v_smfmac_f32_16x16x64_bf16 v[48:51], v[40:43], a[104:111], v126
v_smfmac_f32_16x16x64_bf16 v[52:55], v[40:43], a[112:119], v126
v_smfmac_f32_16x16x64_bf16 v[60:63], v[40:43], v[224:231], v126
Lps_302:
s_waitcnt vmcnt(0)
v_max3_u32 v110, v28, v29, v30
v_max_u32 v110, v110, v31
v_cmp_eq_u32 vcc, -1, v110
s_cbranch_vccnz Lpf_303
v_smfmac_f32_16x16x64_bf16 v[44:47], v[28:31], a[0:7], v126
s_nop 1
v_smfmac_f32_16x16x64_bf16 v[48:51], v[28:31], a[8:15], v126
s_nop 1
v_smfmac_f32_16x16x64_bf16 v[52:55], v[28:31], a[16:23], v126
s_nop 1
v_add_f32 v92, v44, v46
v_add_f32 v93, v45, v47
v_smfmac_f32_16x16x64_bf16 v[56:59], v[28:31], a[24:31], v126
v_add_f32 v94, v48, v50
v_add_f32 v95, v49, v51
ds_write_b64 v24, v[92:93] offset:0
v_add_f32 v96, v52, v54
v_add_f32 v97, v53, v55
ds_write_b64 v25, v[94:95] offset:0
v_smfmac_f32_16x16x64_bf16 v[56:59], v[32:35], a[56:63], v126
ds_write_b64 v26, v[96:97] offset:0
v_smfmac_f32_16x16x64_bf16 v[56:59], v[36:39], a[88:95], v126
v_smfmac_f32_16x16x64_bf16 v[56:59], v[40:43], a[120:127], v126
v_smfmac_f32_16x16x64_bf16 v[60:63], v[28:31], v[128:135], v126
s_branch Lpd_282
Lpf_284:
buffer_load_dwordx4 v[32:35], v8, s[4:7], s40 offen offset:1024 sc1
s_sub_u32 s37, s37, 1
s_cbranch_scc1 Lend_1
Lps_304:
s_waitcnt vmcnt(2)
v_max3_u32 v110, v36, v37, v38
v_max_u32 v110, v110, v39
v_cmp_eq_u32 vcc, -1, v110
s_cbranch_vccnz Lpf_305
v_smfmac_f32_16x16x64_bf16 v[44:47], v[36:39], a[64:71], v126
v_smfmac_f32_16x16x64_bf16 v[48:51], v[36:39], a[72:79], v126
v_smfmac_f32_16x16x64_bf16 v[52:55], v[36:39], a[80:87], v126
v_smfmac_f32_16x16x64_bf16 v[60:63], v[36:39], v[192:199], v126
Lps_306:
s_waitcnt vmcnt(1)
v_max3_u32 v110, v40, v41, v42
v_max_u32 v110, v110, v43
v_cmp_eq_u32 vcc, -1, v110
s_cbranch_vccnz Lpf_307
v_smfmac_f32_16x16x64_bf16 v[44:47], v[40:43], a[96:103], v126
v_smfmac_f32_16x16x64_bf16 v[48:51], v[40:43], a[104:111], v126
v_smfmac_f32_16x16x64_bf16 v[52:55], v[40:43], a[112:119], v126
v_smfmac_f32_16x16x64_bf16 v[60:63], v[40:43], v[224:231], v126
Lps_308:
s_waitcnt vmcnt(0)
v_max3_u32 v110, v32, v33, v34
v_max_u32 v110, v110, v35
v_cmp_eq_u32 vcc, -1, v110
s_cbranch_vccnz Lpf_309
v_smfmac_f32_16x16x64_bf16 v[44:47], v[32:35], a[32:39], v126
s_nop 1
v_smfmac_f32_16x16x64_bf16 v[48:51], v[32:35], a[40:47], v126
s_nop 1
v_smfmac_f32_16x16x64_bf16 v[52:55], v[32:35], a[48:55], v126
s_nop 1
v_add_f32 v92, v44, v46
v_add_f32 v93, v45, v47
v_smfmac_f32_16x16x64_bf16 v[56:59], v[28:31], a[24:31], v126
v_add_f32 v94, v48, v50
v_add_f32 v95, v49, v51
ds_write_b64 v24, v[92:93] offset:0
v_add_f32 v96, v52, v54
v_add_f32 v97, v53, v55
ds_write_b64 v25, v[94:95] offset:0
v_smfmac_f32_16x16x64_bf16 v[56:59], v[32:35], a[56:63], v126
ds_write_b64 v26, v[96:97] offset:0
v_smfmac_f32_16x16x64_bf16 v[56:59], v[36:39], a[88:95], v126
v_smfmac_f32_16x16x64_bf16 v[56:59], v[40:43], a[120:127], v126
v_smfmac_f32_16x16x64_bf16 v[60:63], v[32:35], v[160:167], v126
s_branch Lpd_282
Lpf_285:
buffer_load_dwordx4 v[36:39], v8, s[4:7], s40 offen offset:2048 sc1
s_sub_u32 s37, s37, 1
s_cbranch_scc1 Lend_1
Lps_310:
s_waitcnt vmcnt(1)
v_max3_u32 v110, v40, v41, v42
v_max_u32 v110, v110, v43
v_cmp_eq_u32 vcc, -1, v110
s_cbranch_vccnz Lpf_311
v_smfmac_f32_16x16x64_bf16 v[44:47], v[40:43], a[96:103], v126
v_smfmac_f32_16x16x64_bf16 v[48:51], v[40:43], a[104:111], v126
v_smfmac_f32_16x16x64_bf16 v[52:55], v[40:43], a[112:119], v126
v_smfmac_f32_16x16x64_bf16 v[60:63], v[40:43], v[224:231], v126
Lps_312:
s_waitcnt vmcnt(0)
v_max3_u32 v110, v36, v37, v38
v_max_u32 v110, v110, v39
v_cmp_eq_u32 vcc, -1, v110
s_cbranch_vccnz Lpf_313
v_smfmac_f32_16x16x64_bf16 v[44:47], v[36:39], a[64:71], v126
s_nop 1
v_smfmac_f32_16x16x64_bf16 v[48:51], v[36:39], a[72:79], v126
s_nop 1
v_smfmac_f32_16x16x64_bf16 v[52:55], v[36:39], a[80:87], v126
s_nop 1
v_add_f32 v92, v44, v46
v_add_f32 v93, v45, v47
v_smfmac_f32_16x16x64_bf16 v[56:59], v[28:31], a[24:31], v126
v_add_f32 v94, v48, v50
v_add_f32 v95, v49, v51
ds_write_b64 v24, v[92:93] offset:0
v_add_f32 v96, v52, v54
v_add_f32 v97, v53, v55
ds_write_b64 v25, v[94:95] offset:0
v_smfmac_f32_16x16x64_bf16 v[56:59], v[32:35], a[56:63], v126
ds_write_b64 v26, v[96:97] offset:0
v_smfmac_f32_16x16x64_bf16 v[56:59], v[36:39], a[88:95], v126
v_smfmac_f32_16x16x64_bf16 v[56:59], v[40:43], a[120:127], v126
v_smfmac_f32_16x16x64_bf16 v[60:63], v[36:39], v[192:199], v126
s_branch Lpd_282
Lpf_286:
buffer_load_dwordx4 v[40:43], v8, s[4:7], s40 offen offset:3072 sc1
s_sub_u32 s37, s37, 1
s_cbranch_scc1 Lend_1
Lps_314:
s_waitcnt vmcnt(0)
v_max3_u32 v110, v40, v41, v42
v_max_u32 v110, v110, v43
v_cmp_eq_u32 vcc, -1, v110
s_cbranch_vccnz Lpf_315
v_smfmac_f32_16x16x64_bf16 v[44:47], v[40:43], a[96:103], v126
s_nop 1
v_smfmac_f32_16x16x64_bf16 v[48:51], v[40:43], a[104:111], v126
s_nop 1
v_smfmac_f32_16x16x64_bf16 v[52:55], v[40:43], a[112:119], v126
s_nop 1
v_add_f32 v92, v44, v46
v_add_f32 v93, v45, v47
v_smfmac_f32_16x16x64_bf16 v[56:59], v[28:31], a[24:31], v126
v_add_f32 v94, v48, v50
v_add_f32 v95, v49, v51
ds_write_b64 v24, v[92:93] offset:0
v_add_f32 v96, v52, v54
v_add_f32 v97, v53, v55
ds_write_b64 v25, v[94:95] offset:0
v_smfmac_f32_16x16x64_bf16 v[56:59], v[32:35], a[56:63], v126
ds_write_b64 v26, v[96:97] offset:0
v_smfmac_f32_16x16x64_bf16 v[56:59], v[36:39], a[88:95], v126
v_smfmac_f32_16x16x64_bf16 v[56:59], v[40:43], a[120:127], v126
v_smfmac_f32_16x16x64_bf16 v[60:63], v[40:43], v[224:231], v126
s_branch Lpd_282
Lpf_297:
buffer_load_dwordx4 v[32:35], v8, s[4:7], s40 offen offset:1024 sc1
Lps_316:
s_waitcnt vmcnt(3)
v_max3_u32 v110, v36, v37, v38
v_max_u32 v110, v110, v39
v_cmp_eq_u32 vcc, -1, v110
s_cbranch_vccnz Lpf_317
v_smfmac_f32_16x16x64_bf16 v[44:47], v[36:39], a[64:71], v126
v_smfmac_f32_16x16x64_bf16 v[48:51], v[36:39], a[72:79], v126
v_smfmac_f32_16x16x64_bf16 v[52:55], v[36:39], a[80:87], v126
v_smfmac_f32_16x16x64_bf16 v[60:63], v[36:39], v[192:199], v126
Lps_318:
s_waitcnt vmcnt(2)
v_max3_u32 v110, v40, v41, v42
v_max_u32 v110, v110, v43
v_cmp_eq_u32 vcc, -1, v110
s_cbranch_vccnz Lpf_319
v_smfmac_f32_16x16x64_bf16 v[44:47], v[40:43], a[96:103], v126
v_smfmac_f32_16x16x64_bf16 v[48:51], v[40:43], a[104:111], v126
v_smfmac_f32_16x16x64_bf16 v[52:55], v[40:43], a[112:119], v126
v_smfmac_f32_16x16x64_bf16 v[60:63], v[40:43], v[224:231], v126
Lps_320:
s_waitcnt vmcnt(1)
v_max3_u32 v110, v28, v29, v30
v_max_u32 v110, v110, v31
v_cmp_eq_u32 vcc, -1, v110
s_cbranch_vccnz Lpf_321
v_smfmac_f32_16x16x64_bf16 v[44:47], v[28:31], a[0:7], v126
v_smfmac_f32_16x16x64_bf16 v[48:51], v[28:31], a[8:15], v126
v_smfmac_f32_16x16x64_bf16 v[52:55], v[28:31], a[16:23], v126
v_smfmac_f32_16x16x64_bf16 v[60:63], v[28:31], v[128:135], v126
s_branch Lps_308
Lpf_299:
buffer_load_dwordx4 v[36:39], v8, s[4:7], s40 offen offset:2048 sc1
Lps_322:
s_waitcnt vmcnt(2)
v_max3_u32 v110, v40, v41, v42
v_max_u32 v110, v110, v43
v_cmp_eq_u32 vcc, -1, v110
s_cbranch_vccnz Lpf_323
v_smfmac_f32_16x16x64_bf16 v[44:47], v[40:43], a[96:103], v126
v_smfmac_f32_16x16x64_bf16 v[48:51], v[40:43], a[104:111], v126
v_smfmac_f32_16x16x64_bf16 v[52:55], v[40:43], a[112:119], v126
v_smfmac_f32_16x16x64_bf16 v[60:63], v[40:43], v[224:231], v126
Lps_324:
s_waitcnt vmcnt(1)
v_max3_u32 v110, v28, v29, v30
v_max_u32 v110, v110, v31
v_cmp_eq_u32 vcc, -1, v110
s_cbranch_vccnz Lpf_325
v_smfmac_f32_16x16x64_bf16 v[44:47], v[28:31], a[0:7], v126
v_smfmac_f32_16x16x64_bf16 v[48:51], v[28:31], a[8:15], v126
v_smfmac_f32_16x16x64_bf16 v[52:55], v[28:31], a[16:23], v126
v_smfmac_f32_16x16x64_bf16 v[60:63], v[28:31], v[128:135], v126
s_branch Lps_312
Lpf_301:
buffer_load_dwordx4 v[40:43], v8, s[4:7], s40 offen offset:3072 sc1
Lps_326:
s_waitcnt vmcnt(1)
v_max3_u32 v110, v28, v29, v30
v_max_u32 v110, v110, v31
v_cmp_eq_u32 vcc, -1, v110
s_cbranch_vccnz Lpf_327
v_smfmac_f32_16x16x64_bf16 v[44:47], v[28:31], a[0:7], v126
v_smfmac_f32_16x16x64_bf16 v[48:51], v[28:31], a[8:15], v126
v_smfmac_f32_16x16x64_bf16 v[52:55], v[28:31], a[16:23], v126
v_smfmac_f32_16x16x64_bf16 v[60:63], v[28:31], v[128:135], v126
s_branch Lps_314
Lpf_303:
buffer_load_dwordx4 v[28:31], v8, s[4:7], s40 offen offset:0 sc1
s_sub_u32 s37, s37, 1
s_cbranch_scc1 Lend_1
s_branch Lps_302
Lpf_305:
buffer_load_dwordx4 v[36:39], v8, s[4:7], s40 offen offset:2048 sc1
Lps_328:
s_waitcnt vmcnt(2)
v_max3_u32 v110, v40, v41, v42
v_max_u32 v110, v110, v43
v_cmp_eq_u32 vcc, -1, v110
s_cbranch_vccnz Lpf_329
v_smfmac_f32_16x16x64_bf16 v[44:47], v[40:43], a[96:103], v126
v_smfmac_f32_16x16x64_bf16 v[48:51], v[40:43], a[104:111], v126
v_smfmac_f32_16x16x64_bf16 v[52:55], v[40:43], a[112:119], v126
v_smfmac_f32_16x16x64_bf16 v[60:63], v[40:43], v[224:231], v126
Lps_330:
s_waitcnt vmcnt(1)
v_max3_u32 v110, v32, v33, v34
v_max_u32 v110, v110, v35
v_cmp_eq_u32 vcc, -1, v110
s_cbranch_vccnz Lpf_331
v_smfmac_f32_16x16x64_bf16 v[44:47], v[32:35], a[32:39], v126
v_smfmac_f32_16x16x64_bf16 v[48:51], v[32:35], a[40:47], v126
v_smfmac_f32_16x16x64_bf16 v[52:55], v[32:35], a[48:55], v126
v_smfmac_f32_16x16x64_bf16 v[60:63], v[32:35], v[160:167], v126
s_branch Lps_312
Lpf_307:
buffer_load_dwordx4 v[40:43], v8, s[4:7], s40 offen offset:3072 sc1
Lps_332:
s_waitcnt vmcnt(1)
v_max3_u32 v110, v32, v33, v34
v_max_u32 v110, v110, v35
v_cmp_eq_u32 vcc, -1, v110
s_cbranch_vccnz Lpf_333
v_smfmac_f32_16x16x64_bf16 v[44:47], v[32:35], a[32:39], v126
v_smfmac_f32_16x16x64_bf16 v[48:51], v[32:35], a[40:47], v126
v_smfmac_f32_16x16x64_bf16 v[52:55], v[32:35], a[48:55], v126
v_smfmac_f32_16x16x64_bf16 v[60:63], v[32:35], v[160:167], v126
s_branch Lps_314
Lpf_309:
buffer_load_dwordx4 v[32:35], v8, s[4:7], s40 offen offset:1024 sc1
s_sub_u32 s37, s37, 1
s_cbranch_scc1 Lend_1
s_branch Lps_308
Lpf_311:
buffer_load_dwordx4 v[40:43], v8, s[4:7], s40 offen offset:3072 sc1
Lps_334:
s_waitcnt vmcnt(1)
v_max3_u32 v110, v36, v37, v38
v_max_u32 v110, v110, v39
v_cmp_eq_u32 vcc, -1, v110
s_cbranch_vccnz Lpf_335
v_smfmac_f32_16x16x64_bf16 v[44:47], v[36:39], a[64:71], v126
v_smfmac_f32_16x16x64_bf16 v[48:51], v[36:39], a[72:79], v126
v_smfmac_f32_16x16x64_bf16 v[52:55], v[36:39], a[80:87], v126
v_smfmac_f32_16x16x64_bf16 v[60:63], v[36:39], v[192:199], v126
s_branch Lps_314
Lpf_313:
buffer_load_dwordx4 v[36:39], v8, s[4:7], s40 offen offset:2048 sc1
s_sub_u32 s37, s37, 1
s_cbranch_scc1 Lend_1
s_branch Lps_312
Lpf_315:
buffer_load_dwordx4 v[40:43], v8, s[4:7], s40 offen offset:3072 sc1
s_sub_u32 s37, s37, 1
s_cbranch_scc1 Lend_1
s_branch Lps_314
Lpf_317:
buffer_load_dwordx4 v[36:39], v8, s[4:7], s40 offen offset:2048 sc1
Lps_336:
s_waitcnt vmcnt(3)
v_max3_u32 v110, v40, v41, v42
v_max_u32 v110, v110, v43
v_cmp_eq_u32 vcc, -1, v110
s_cbranch_vccnz Lpf_337
v_smfmac_f32_16x16x64_bf16 v[44:47], v[40:43], a[96:103], v126
v_smfmac_f32_16x16x64_bf16 v[48:51], v[40:43], a[104:111], v126
v_smfmac_f32_16x16x64_bf16 v[52:55], v[40:43], a[112:119], v126
v_smfmac_f32_16x16x64_bf16 v[60:63], v[40:43], v[224:231], v126
Lps_338:
s_waitcnt vmcnt(2)
v_max3_u32 v110, v28, v29, v30
v_max_u32 v110, v110, v31
v_cmp_eq_u32 vcc, -1, v110
s_cbranch_vccnz Lpf_339
v_smfmac_f32_16x16x64_bf16 v[44:47], v[28:31], a[0:7], v126
v_smfmac_f32_16x16x64_bf16 v[48:51], v[28:31], a[8:15], v126
v_smfmac_f32_16x16x64_bf16 v[52:55], v[28:31], a[16:23], v126
v_smfmac_f32_16x16x64_bf16 v[60:63], v[28:31], v[128:135], v126
s_branch Lps_330
Lpf_319:
buffer_load_dwordx4 v[40:43], v8, s[4:7], s40 offen offset:3072 sc1
Lps_340:
s_waitcnt vmcnt(2)
v_max3_u32 v110, v28, v29, v30
v_max_u32 v110, v110, v31
v_cmp_eq_u32 vcc, -1, v110
s_cbranch_vccnz Lpf_341
v_smfmac_f32_16x16x64_bf16 v[44:47], v[28:31], a[0:7], v126
v_smfmac_f32_16x16x64_bf16 v[48:51], v[28:31], a[8:15], v126
v_smfmac_f32_16x16x64_bf16 v[52:55], v[28:31], a[16:23], v126
v_smfmac_f32_16x16x64_bf16 v[60:63], v[28:31], v[128:135], v126
s_branch Lps_332
Lpf_321:
buffer_load_dwordx4 v[28:31], v8, s[4:7], s40 offen offset:0 sc1
s_sub_u32 s37, s37, 1
s_cbranch_scc1 Lend_1
Lps_342:
s_waitcnt vmcnt(1)
v_max3_u32 v110, v32, v33, v34
v_max_u32 v110, v110, v35
v_cmp_eq_u32 vcc, -1, v110
s_cbranch_vccnz Lpf_343
v_smfmac_f32_16x16x64_bf16 v[44:47], v[32:35], a[32:39], v126
v_smfmac_f32_16x16x64_bf16 v[48:51], v[32:35], a[40:47], v126
v_smfmac_f32_16x16x64_bf16 v[52:55], v[32:35], a[48:55], v126
v_smfmac_f32_16x16x64_bf16 v[60:63], v[32:35], v[160:167], v126
s_branch Lps_302
Lpf_323:
buffer_load_dwordx4 v[40:43], v8, s[4:7], s40 offen offset:3072 sc1
Lps_344:
s_waitcnt vmcnt(2)
v_max3_u32 v110, v28, v29, v30
v_max_u32 v110, v110, v31
v_cmp_eq_u32 vcc, -1, v110
s_cbranch_vccnz Lpf_345
v_smfmac_f32_16x16x64_bf16 v[44:47], v[28:31], a[0:7], v126
v_smfmac_f32_16x16x64_bf16 v[48:51], v[28:31], a[8:15], v126
v_smfmac_f32_16x16x64_bf16 v[52:55], v[28:31], a[16:23], v126
v_smfmac_f32_16x16x64_bf16 v[60:63], v[28:31], v[128:135], v126
s_branch Lps_334
Lpf_325:
buffer_load_dwordx4 v[28:31], v8, s[4:7], s40 offen offset:0 sc1
s_sub_u32 s37, s37, 1
s_cbranch_scc1 Lend_1
Lps_346:
s_waitcnt vmcnt(1)
v_max3_u32 v110, v36, v37, v38
v_max_u32 v110, v110, v39
v_cmp_eq_u32 vcc, -1, v110
s_cbranch_vccnz Lpf_347
v_smfmac_f32_16x16x64_bf16 v[44:47], v[36:39], a[64:71], v126
v_smfmac_f32_16x16x64_bf16 v[48:51], v[36:39], a[72:79], v126
v_smfmac_f32_16x16x64_bf16 v[52:55], v[36:39], a[80:87], v126
v_smfmac_f32_16x16x64_bf16 v[60:63], v[36:39], v[192:199], v126
s_branch Lps_302
Lpf_327:
buffer_load_dwordx4 v[28:31], v8, s[4:7], s40 offen offset:0 sc1
s_sub_u32 s37, s37, 1
s_cbranch_scc1 Lend_1
s_branch Lps_300
Lpf_329:
buffer_load_dwordx4 v[40:43], v8, s[4:7], s40 offen offset:3072 sc1
Lps_348:
s_waitcnt vmcnt(2)
v_max3_u32 v110, v32, v33, v34
v_max_u32 v110, v110, v35
v_cmp_eq_u32 vcc, -1, v110
s_cbranch_vccnz Lpf_349
v_smfmac_f32_16x16x64_bf16 v[44:47], v[32:35], a[32:39], v126
v_smfmac_f32_16x16x64_bf16 v[48:51], v[32:35], a[40:47], v126
v_smfmac_f32_16x16x64_bf16 v[52:55], v[32:35], a[48:55], v126
v_smfmac_f32_16x16x64_bf16 v[60:63], v[32:35], v[160:167], v126
s_branch Lps_334
Lpf_331:
buffer_load_dwordx4 v[32:35], v8, s[4:7], s40 offen offset:1024 sc1
s_sub_u32 s37, s37, 1
s_cbranch_scc1 Lend_1
Lps_350:
s_waitcnt vmcnt(1)
v_max3_u32 v110, v36, v37, v38
v_max_u32 v110, v110, v39
v_cmp_eq_u32 vcc, -1, v110
s_cbranch_vccnz Lpf_351
v_smfmac_f32_16x16x64_bf16 v[44:47], v[36:39], a[64:71], v126
v_smfmac_f32_16x16x64_bf16 v[48:51], v[36:39], a[72:79], v126
v_smfmac_f32_16x16x64_bf16 v[52:55], v[36:39], a[80:87], v126
v_smfmac_f32_16x16x64_bf16 v[60:63], v[36:39], v[192:199], v126
s_branch Lps_308
Lpf_333:
buffer_load_dwordx4 v[32:35], v8, s[4:7], s40 offen offset:1024 sc1
s_sub_u32 s37, s37, 1
s_cbranch_scc1 Lend_1
s_branch Lps_306
Lpf_335:
buffer_load_dwordx4 v[36:39], v8, s[4:7], s40 offen offset:2048 sc1
s_sub_u32 s37, s37, 1
s_cbranch_scc1 Lend_1
s_branch Lps_310
Lpf_337:
buffer_load_dwordx4 v[40:43], v8, s[4:7], s40 offen offset:3072 sc1
Lps_352:
s_waitcnt vmcnt(3)
v_max3_u32 v110, v28, v29, v30
v_max_u32 v110, v110, v31
v_cmp_eq_u32 vcc, -1, v110
s_cbranch_vccnz Lpf_353
v_smfmac_f32_16x16x64_bf16 v[44:47], v[28:31], a[0:7], v126
v_smfmac_f32_16x16x64_bf16 v[48:51], v[28:31], a[8:15], v126
v_smfmac_f32_16x16x64_bf16 v[52:55], v[28:31], a[16:23], v126
v_smfmac_f32_16x16x64_bf16 v[60:63], v[28:31], v[128:135], v126
s_branch Lps_348
Lpf_339:
buffer_load_dwordx4 v[28:31], v8, s[4:7], s40 offen offset:0 sc1
s_sub_u32 s37, s37, 1
s_cbranch_scc1 Lend_1
Lps_354:
s_waitcnt vmcnt(2)
v_max3_u32 v110, v32, v33, v34
v_max_u32 v110, v110, v35
v_cmp_eq_u32 vcc, -1, v110
s_cbranch_vccnz Lpf_355
v_smfmac_f32_16x16x64_bf16 v[44:47], v[32:35], a[32:39], v126
v_smfmac_f32_16x16x64_bf16 v[48:51], v[32:35], a[40:47], v126
v_smfmac_f32_16x16x64_bf16 v[52:55], v[32:35], a[48:55], v126
v_smfmac_f32_16x16x64_bf16 v[60:63], v[32:35], v[160:167], v126
s_branch Lps_346
Lpf_341:
buffer_load_dwordx4 v[28:31], v8, s[4:7], s40 offen offset:0 sc1
s_sub_u32 s37, s37, 1
s_cbranch_scc1 Lend_1
Lps_356:
s_waitcnt vmcnt(2)
v_max3_u32 v110, v32, v33, v34
v_max_u32 v110, v110, v35
v_cmp_eq_u32 vcc, -1, v110
s_cbranch_vccnz Lpf_357
v_smfmac_f32_16x16x64_bf16 v[44:47], v[32:35], a[32:39], v126
v_smfmac_f32_16x16x64_bf16 v[48:51], v[32:35], a[40:47], v126
v_smfmac_f32_16x16x64_bf16 v[52:55], v[32:35], a[48:55], v126
v_smfmac_f32_16x16x64_bf16 v[60:63], v[32:35], v[160:167], v126
s_branch Lps_300
Lpf_343:
buffer_load_dwordx4 v[32:35], v8, s[4:7], s40 offen offset:1024 sc1
s_branch Lps_320
Lpf_345:
buffer_load_dwordx4 v[28:31], v8, s[4:7], s40 offen offset:0 sc1
s_sub_u32 s37, s37, 1
s_cbranch_scc1 Lend_1
s_branch Lps_298
Lpf_347:
buffer_load_dwordx4 v[36:39], v8, s[4:7], s40 offen offset:2048 sc1
s_branch Lps_324
Lpf_349:
buffer_load_dwordx4 v[32:35], v8, s[4:7], s40 offen offset:1024 sc1
s_sub_u32 s37, s37, 1
s_cbranch_scc1 Lend_1
s_branch Lps_304
Lpf_351:
buffer_load_dwordx4 v[36:39], v8, s[4:7], s40 offen offset:2048 sc1
s_branch Lps_330
Lpf_353:
buffer_load_dwordx4 v[28:31], v8, s[4:7], s40 offen offset:0 sc1
s_sub_u32 s37, s37, 1
s_cbranch_scc1 Lend_1
s_branch Lps_296
Lpf_355:
buffer_load_dwordx4 v[32:35], v8, s[4:7], s40 offen offset:1024 sc1
Lps_358:
s_waitcnt vmcnt(2)
v_max3_u32 v110, v36, v37, v38
v_max_u32 v110, v110, v39
v_cmp_eq_u32 vcc, -1, v110
s_cbranch_vccnz Lpf_359
v_smfmac_f32_16x16x64_bf16 v[44:47], v[36:39], a[64:71], v126
v_smfmac_f32_16x16x64_bf16 v[48:51], v[36:39], a[72:79], v126
v_smfmac_f32_16x16x64_bf16 v[52:55], v[36:39], a[80:87], v126
v_smfmac_f32_16x16x64_bf16 v[60:63], v[36:39], v[192:199], v126
s_branch Lps_320
Lpf_357:
buffer_load_dwordx4 v[32:35], v8, s[4:7], s40 offen offset:1024 sc1
s_branch Lps_318
Lpf_359:
buffer_load_dwordx4 v[36:39], v8, s[4:7], s40 offen offset:2048 sc1
s_branch Lps_338
Lpf_290:
buffer_load_dwordx4 v[28:31], v9, s[4:7], s40 offen offset:0 sc1
s_sub_u32 s37, s37, 1
s_cbranch_scc1 Lend_1
Lps_360:
s_waitcnt vmcnt(3)
v_max3_u32 v110, v32, v33, v34
v_max_u32 v110, v110, v35
v_cmp_eq_u32 vcc, -1, v110
s_cbranch_vccnz Lpf_361
v_smfmac_f32_16x16x64_bf16 v[76:79], v[32:35], a[160:167], v126
v_smfmac_f32_16x16x64_bf16 v[80:83], v[32:35], a[168:175], v126
v_smfmac_f32_16x16x64_bf16 v[84:87], v[32:35], a[176:183], v126
Lps_362:
s_waitcnt vmcnt(2)
v_max3_u32 v110, v36, v37, v38
v_max_u32 v110, v110, v39
v_cmp_eq_u32 vcc, -1, v110
s_cbranch_vccnz Lpf_363
v_smfmac_f32_16x16x64_bf16 v[76:79], v[36:39], a[192:199], v126
v_smfmac_f32_16x16x64_bf16 v[80:83], v[36:39], a[200:207], v126
v_smfmac_f32_16x16x64_bf16 v[84:87], v[36:39], a[208:215], v126
Lps_364:
s_waitcnt vmcnt(1)
v_max3_u32 v110, v40, v41, v42
v_max_u32 v110, v110, v43
v_cmp_eq_u32 vcc, -1, v110
s_cbranch_vccnz Lpf_365
v_smfmac_f32_16x16x64_bf16 v[76:79], v[40:43], a[224:231], v126
v_smfmac_f32_16x16x64_bf16 v[80:83], v[40:43], a[232:239], v126
v_smfmac_f32_16x16x64_bf16 v[84:87], v[40:43], a[240:247], v126
Lps_366:
s_waitcnt vmcnt(0)
v_max3_u32 v110, v28, v29, v30
v_max_u32 v110, v110, v31
v_cmp_eq_u32 vcc, -1, v110
s_cbranch_vccnz Lpf_367
v_smfmac_f32_16x16x64_bf16 v[76:79], v[28:31], a[128:135], v126
s_nop 1
v_smfmac_f32_16x16x64_bf16 v[80:83], v[28:31], a[136:143], v126
s_nop 1
v_smfmac_f32_16x16x64_bf16 v[84:87], v[28:31], a[144:151], v126
s_nop 1
v_add_f32 v92, v76, v78
v_add_f32 v93, v77, v79
v_smfmac_f32_16x16x64_bf16 v[88:91], v[28:31], a[152:159], v126
v_add_f32 v94, v80, v82
v_add_f32 v95, v81, v83
ds_write_b64 v24, v[92:93] offset:12288
v_add_f32 v96, v84, v86
v_add_f32 v97, v85, v87
ds_write_b64 v25, v[94:95] offset:12288
v_smfmac_f32_16x16x64_bf16 v[88:91], v[32:35], a[184:191], v126
ds_write_b64 v26, v[96:97] offset:12288
v_smfmac_f32_16x16x64_bf16 v[88:91], v[36:39], a[216:223], v126
v_smfmac_f32_16x16x64_bf16 v[88:91], v[40:43], a[248:255], v126
s_branch Lpd_289
Lpf_291:
buffer_load_dwordx4 v[32:35], v9, s[4:7], s40 offen offset:1024 sc1
s_sub_u32 s37, s37, 1
s_cbranch_scc1 Lend_1
Lps_368:
s_waitcnt vmcnt(2)
v_max3_u32 v110, v36, v37, v38
v_max_u32 v110, v110, v39
v_cmp_eq_u32 vcc, -1, v110
s_cbranch_vccnz Lpf_369
v_smfmac_f32_16x16x64_bf16 v[76:79], v[36:39], a[192:199], v126
v_smfmac_f32_16x16x64_bf16 v[80:83], v[36:39], a[200:207], v126
v_smfmac_f32_16x16x64_bf16 v[84:87], v[36:39], a[208:215], v126
Lps_370:
s_waitcnt vmcnt(1)
v_max3_u32 v110, v40, v41, v42
v_max_u32 v110, v110, v43
v_cmp_eq_u32 vcc, -1, v110
s_cbranch_vccnz Lpf_371
v_smfmac_f32_16x16x64_bf16 v[76:79], v[40:43], a[224:231], v126
v_smfmac_f32_16x16x64_bf16 v[80:83], v[40:43], a[232:239], v126
v_smfmac_f32_16x16x64_bf16 v[84:87], v[40:43], a[240:247], v126
Lps_372:
s_waitcnt vmcnt(0)
v_max3_u32 v110, v32, v33, v34
v_max_u32 v110, v110, v35
v_cmp_eq_u32 vcc, -1, v110
s_cbranch_vccnz Lpf_373
v_smfmac_f32_16x16x64_bf16 v[76:79], v[32:35], a[160:167], v126
s_nop 1
v_smfmac_f32_16x16x64_bf16 v[80:83], v[32:35], a[168:175], v126
s_nop 1
v_smfmac_f32_16x16x64_bf16 v[84:87], v[32:35], a[176:183], v126
s_nop 1
v_add_f32 v92, v76, v78
v_add_f32 v93, v77, v79
v_smfmac_f32_16x16x64_bf16 v[88:91], v[28:31], a[152:159], v126
v_add_f32 v94, v80, v82
v_add_f32 v95, v81, v83
ds_write_b64 v24, v[92:93] offset:12288
v_add_f32 v96, v84, v86
v_add_f32 v97, v85, v87
ds_write_b64 v25, v[94:95] offset:12288
v_smfmac_f32_16x16x64_bf16 v[88:91], v[32:35], a[184:191], v126
ds_write_b64 v26, v[96:97] offset:12288
v_smfmac_f32_16x16x64_bf16 v[88:91], v[36:39], a[216:223], v126
v_smfmac_f32_16x16x64_bf16 v[88:91], v[40:43], a[248:255], v126
s_branch Lpd_289
Lpf_292:
buffer_load_dwordx4 v[36:39], v9, s[4:7], s40 offen offset:2048 sc1
s_sub_u32 s37, s37, 1
s_cbranch_scc1 Lend_1
Lps_374:
s_waitcnt vmcnt(1)
v_max3_u32 v110, v40, v41, v42
v_max_u32 v110, v110, v43
v_cmp_eq_u32 vcc, -1, v110
s_cbranch_vccnz Lpf_375
v_smfmac_f32_16x16x64_bf16 v[76:79], v[40:43], a[224:231], v126
v_smfmac_f32_16x16x64_bf16 v[80:83], v[40:43], a[232:239], v126
v_smfmac_f32_16x16x64_bf16 v[84:87], v[40:43], a[240:247], v126
Lps_376:
s_waitcnt vmcnt(0)
v_max3_u32 v110, v36, v37, v38
v_max_u32 v110, v110, v39
v_cmp_eq_u32 vcc, -1, v110
s_cbranch_vccnz Lpf_377
v_smfmac_f32_16x16x64_bf16 v[76:79], v[36:39], a[192:199], v126
s_nop 1
v_smfmac_f32_16x16x64_bf16 v[80:83], v[36:39], a[200:207], v126
s_nop 1
v_smfmac_f32_16x16x64_bf16 v[84:87], v[36:39], a[208:215], v126
s_nop 1
v_add_f32 v92, v76, v78
v_add_f32 v93, v77, v79
v_smfmac_f32_16x16x64_bf16 v[88:91], v[28:31], a[152:159], v126
v_add_f32 v94, v80, v82
v_add_f32 v95, v81, v83
ds_write_b64 v24, v[92:93] offset:12288
v_add_f32 v96, v84, v86
v_add_f32 v97, v85, v87
ds_write_b64 v25, v[94:95] offset:12288
v_smfmac_f32_16x16x64_bf16 v[88:91], v[32:35], a[184:191], v126
ds_write_b64 v26, v[96:97] offset:12288
v_smfmac_f32_16x16x64_bf16 v[88:91], v[36:39], a[216:223], v126
v_smfmac_f32_16x16x64_bf16 v[88:91], v[40:43], a[248:255], v126
s_branch Lpd_289
Lpf_293:
buffer_load_dwordx4 v[40:43], v9, s[4:7], s40 offen offset:3072 sc1
s_sub_u32 s37, s37, 1
s_cbranch_scc1 Lend_1
Lps_378:
s_waitcnt vmcnt(0)
v_max3_u32 v110, v40, v41, v42
v_max_u32 v110, v110, v43
v_cmp_eq_u32 vcc, -1, v110
s_cbranch_vccnz Lpf_379
v_smfmac_f32_16x16x64_bf16 v[76:79], v[40:43], a[224:231], v126
s_nop 1
v_smfmac_f32_16x16x64_bf16 v[80:83], v[40:43], a[232:239], v126
s_nop 1
v_smfmac_f32_16x16x64_bf16 v[84:87], v[40:43], a[240:247], v126
s_nop 1
v_add_f32 v92, v76, v78
v_add_f32 v93, v77, v79
v_smfmac_f32_16x16x64_bf16 v[88:91], v[28:31], a[152:159], v126
v_add_f32 v94, v80, v82
v_add_f32 v95, v81, v83
ds_write_b64 v24, v[92:93] offset:12288
v_add_f32 v96, v84, v86
v_add_f32 v97, v85, v87
ds_write_b64 v25, v[94:95] offset:12288
v_smfmac_f32_16x16x64_bf16 v[88:91], v[32:35], a[184:191], v126
ds_write_b64 v26, v[96:97] offset:12288
v_smfmac_f32_16x16x64_bf16 v[88:91], v[36:39], a[216:223], v126
v_smfmac_f32_16x16x64_bf16 v[88:91], v[40:43], a[248:255], v126
s_branch Lpd_289
Lpf_361:
buffer_load_dwordx4 v[32:35], v9, s[4:7], s40 offen offset:1024 sc1
Lps_380:
s_waitcnt vmcnt(3)
v_max3_u32 v110, v36, v37, v38
v_max_u32 v110, v110, v39
v_cmp_eq_u32 vcc, -1, v110
s_cbranch_vccnz Lpf_381
v_smfmac_f32_16x16x64_bf16 v[76:79], v[36:39], a[192:199], v126
v_smfmac_f32_16x16x64_bf16 v[80:83], v[36:39], a[200:207], v126
v_smfmac_f32_16x16x64_bf16 v[84:87], v[36:39], a[208:215], v126
Lps_382:
s_waitcnt vmcnt(2)
v_max3_u32 v110, v40, v41, v42
v_max_u32 v110, v110, v43
v_cmp_eq_u32 vcc, -1, v110
s_cbranch_vccnz Lpf_383
v_smfmac_f32_16x16x64_bf16 v[76:79], v[40:43], a[224:231], v126
v_smfmac_f32_16x16x64_bf16 v[80:83], v[40:43], a[232:239], v126
v_smfmac_f32_16x16x64_bf16 v[84:87], v[40:43], a[240:247], v126
Lps_384:
s_waitcnt vmcnt(1)
v_max3_u32 v110, v28, v29, v30
v_max_u32 v110, v110, v31
v_cmp_eq_u32 vcc, -1, v110
s_cbranch_vccnz Lpf_385
v_smfmac_f32_16x16x64_bf16 v[76:79], v[28:31], a[128:135], v126
v_smfmac_f32_16x16x64_bf16 v[80:83], v[28:31], a[136:143], v126
v_smfmac_f32_16x16x64_bf16 v[84:87], v[28:31], a[144:151], v126
s_branch Lps_372
Lpf_363:
buffer_load_dwordx4 v[36:39], v9, s[4:7], s40 offen offset:2048 sc1
Lps_386:
s_waitcnt vmcnt(2)
v_max3_u32 v110, v40, v41, v42
v_max_u32 v110, v110, v43
v_cmp_eq_u32 vcc, -1, v110
s_cbranch_vccnz Lpf_387
v_smfmac_f32_16x16x64_bf16 v[76:79], v[40:43], a[224:231], v126
v_smfmac_f32_16x16x64_bf16 v[80:83], v[40:43], a[232:239], v126
v_smfmac_f32_16x16x64_bf16 v[84:87], v[40:43], a[240:247], v126
Lps_388:
s_waitcnt vmcnt(1)
v_max3_u32 v110, v28, v29, v30
v_max_u32 v110, v110, v31
v_cmp_eq_u32 vcc, -1, v110
s_cbranch_vccnz Lpf_389
v_smfmac_f32_16x16x64_bf16 v[76:79], v[28:31], a[128:135], v126
v_smfmac_f32_16x16x64_bf16 v[80:83], v[28:31], a[136:143], v126
v_smfmac_f32_16x16x64_bf16 v[84:87], v[28:31], a[144:151], v126
s_branch Lps_376
Lpf_365:
buffer_load_dwordx4 v[40:43], v9, s[4:7], s40 offen offset:3072 sc1
Lps_390:
s_waitcnt vmcnt(1)
v_max3_u32 v110, v28, v29, v30
v_max_u32 v110, v110, v31
v_cmp_eq_u32 vcc, -1, v110
s_cbranch_vccnz Lpf_391
v_smfmac_f32_16x16x64_bf16 v[76:79], v[28:31], a[128:135], v126
v_smfmac_f32_16x16x64_bf16 v[80:83], v[28:31], a[136:143], v126
v_smfmac_f32_16x16x64_bf16 v[84:87], v[28:31], a[144:151], v126
s_branch Lps_378
Lpf_367:
buffer_load_dwordx4 v[28:31], v9, s[4:7], s40 offen offset:0 sc1
s_sub_u32 s37, s37, 1
s_cbranch_scc1 Lend_1
s_branch Lps_366
Lpf_369:
buffer_load_dwordx4 v[36:39], v9, s[4:7], s40 offen offset:2048 sc1
Lps_392:
s_waitcnt vmcnt(2)
v_max3_u32 v110, v40, v41, v42
v_max_u32 v110, v110, v43
v_cmp_eq_u32 vcc, -1, v110
s_cbranch_vccnz Lpf_393
v_smfmac_f32_16x16x64_bf16 v[76:79], v[40:43], a[224:231], v126
v_smfmac_f32_16x16x64_bf16 v[80:83], v[40:43], a[232:239], v126
v_smfmac_f32_16x16x64_bf16 v[84:87], v[40:43], a[240:247], v126
Lps_394:
s_waitcnt vmcnt(1)
v_max3_u32 v110, v32, v33, v34
v_max_u32 v110, v110, v35
v_cmp_eq_u32 vcc, -1, v110
s_cbranch_vccnz Lpf_395
v_smfmac_f32_16x16x64_bf16 v[76:79], v[32:35], a[160:167], v126
v_smfmac_f32_16x16x64_bf16 v[80:83], v[32:35], a[168:175], v126
v_smfmac_f32_16x16x64_bf16 v[84:87], v[32:35], a[176:183], v126
s_branch Lps_376
Lpf_371:
buffer_load_dwordx4 v[40:43], v9, s[4:7], s40 offen offset:3072 sc1
Lps_396:
s_waitcnt vmcnt(1)
v_max3_u32 v110, v32, v33, v34
v_max_u32 v110, v110, v35
v_cmp_eq_u32 vcc, -1, v110
s_cbranch_vccnz Lpf_397
v_smfmac_f32_16x16x64_bf16 v[76:79], v[32:35], a[160:167], v126
v_smfmac_f32_16x16x64_bf16 v[80:83], v[32:35], a[168:175], v126
v_smfmac_f32_16x16x64_bf16 v[84:87], v[32:35], a[176:183], v126
s_branch Lps_378
Lpf_373:
buffer_load_dwordx4 v[32:35], v9, s[4:7], s40 offen offset:1024 sc1
s_sub_u32 s37, s37, 1
s_cbranch_scc1 Lend_1
s_branch Lps_372
Lpf_375:
buffer_load_dwordx4 v[40:43], v9, s[4:7], s40 offen offset:3072 sc1
Lps_398:
s_waitcnt vmcnt(1)
v_max3_u32 v110, v36, v37, v38
v_max_u32 v110, v110, v39
v_cmp_eq_u32 vcc, -1, v110
s_cbranch_vccnz Lpf_399
v_smfmac_f32_16x16x64_bf16 v[76:79], v[36:39], a[192:199], v126
v_smfmac_f32_16x16x64_bf16 v[80:83], v[36:39], a[200:207], v126
v_smfmac_f32_16x16x64_bf16 v[84:87], v[36:39], a[208:215], v126
s_branch Lps_378
Lpf_377:
buffer_load_dwordx4 v[36:39], v9, s[4:7], s40 offen offset:2048 sc1
s_sub_u32 s37, s37, 1
s_cbranch_scc1 Lend_1
s_branch Lps_376
Lpf_379:
buffer_load_dwordx4 v[40:43], v9, s[4:7], s40 offen offset:3072 sc1
s_sub_u32 s37, s37, 1
s_cbranch_scc1 Lend_1
s_branch Lps_378
Lpf_381:
buffer_load_dwordx4 v[36:39], v9, s[4:7], s40 offen offset:2048 sc1
Lps_400:
s_waitcnt vmcnt(3)
v_max3_u32 v110, v40, v41, v42
v_max_u32 v110, v110, v43
v_cmp_eq_u32 vcc, -1, v110
s_cbranch_vccnz Lpf_401
v_smfmac_f32_16x16x64_bf16 v[76:79], v[40:43], a[224:231], v126
v_smfmac_f32_16x16x64_bf16 v[80:83], v[40:43], a[232:239], v126
v_smfmac_f32_16x16x64_bf16 v[84:87], v[40:43], a[240:247], v126
Lps_402:
s_waitcnt vmcnt(2)
v_max3_u32 v110, v28, v29, v30
v_max_u32 v110, v110, v31
v_cmp_eq_u32 vcc, -1, v110
s_cbranch_vccnz Lpf_403
v_smfmac_f32_16x16x64_bf16 v[76:79], v[28:31], a[128:135], v126
v_smfmac_f32_16x16x64_bf16 v[80:83], v[28:31], a[136:143], v126
v_smfmac_f32_16x16x64_bf16 v[84:87], v[28:31], a[144:151], v126
s_branch Lps_394
Lpf_383:
buffer_load_dwordx4 v[40:43], v9, s[4:7], s40 offen offset:3072 sc1
Lps_404:
s_waitcnt vmcnt(2)
v_max3_u32 v110, v28, v29, v30
v_max_u32 v110, v110, v31
v_cmp_eq_u32 vcc, -1, v110
s_cbranch_vccnz Lpf_405
v_smfmac_f32_16x16x64_bf16 v[76:79], v[28:31], a[128:135], v126
v_smfmac_f32_16x16x64_bf16 v[80:83], v[28:31], a[136:143], v126
v_smfmac_f32_16x16x64_bf16 v[84:87], v[28:31], a[144:151], v126
s_branch Lps_396
Lpf_385:
buffer_load_dwordx4 v[28:31], v9, s[4:7], s40 offen offset:0 sc1
s_sub_u32 s37, s37, 1
s_cbranch_scc1 Lend_1
Lps_406:
s_waitcnt vmcnt(1)
v_max3_u32 v110, v32, v33, v34
v_max_u32 v110, v110, v35
v_cmp_eq_u32 vcc, -1, v110
s_cbranch_vccnz Lpf_407
v_smfmac_f32_16x16x64_bf16 v[76:79], v[32:35], a[160:167], v126
v_smfmac_f32_16x16x64_bf16 v[80:83], v[32:35], a[168:175], v126
v_smfmac_f32_16x16x64_bf16 v[84:87], v[32:35], a[176:183], v126
s_branch Lps_366
Lpf_387:
buffer_load_dwordx4 v[40:43], v9, s[4:7], s40 offen offset:3072 sc1
Lps_408:
s_waitcnt vmcnt(2)
v_max3_u32 v110, v28, v29, v30
v_max_u32 v110, v110, v31
v_cmp_eq_u32 vcc, -1, v110
s_cbranch_vccnz Lpf_409
v_smfmac_f32_16x16x64_bf16 v[76:79], v[28:31], a[128:135], v126
v_smfmac_f32_16x16x64_bf16 v[80:83], v[28:31], a[136:143], v126
v_smfmac_f32_16x16x64_bf16 v[84:87], v[28:31], a[144:151], v126
s_branch Lps_398
Lpf_389:
buffer_load_dwordx4 v[28:31], v9, s[4:7], s40 offen offset:0 sc1
s_sub_u32 s37, s37, 1
s_cbranch_scc1 Lend_1
Lps_410:
s_waitcnt vmcnt(1)
v_max3_u32 v110, v36, v37, v38
v_max_u32 v110, v110, v39
v_cmp_eq_u32 vcc, -1, v110
s_cbranch_vccnz Lpf_411
v_smfmac_f32_16x16x64_bf16 v[76:79], v[36:39], a[192:199], v126
v_smfmac_f32_16x16x64_bf16 v[80:83], v[36:39], a[200:207], v126
v_smfmac_f32_16x16x64_bf16 v[84:87], v[36:39], a[208:215], v126
s_branch Lps_366
Lpf_391:
buffer_load_dwordx4 v[28:31], v9, s[4:7], s40 offen offset:0 sc1
s_sub_u32 s37, s37, 1
s_cbranch_scc1 Lend_1
s_branch Lps_364
Lpf_393:
buffer_load_dwordx4 v[40:43], v9, s[4:7], s40 offen offset:3072 sc1
Lps_412:
s_waitcnt vmcnt(2)
v_max3_u32 v110, v32, v33, v34
v_max_u32 v110, v110, v35
v_cmp_eq_u32 vcc, -1, v110
s_cbranch_vccnz Lpf_413
v_smfmac_f32_16x16x64_bf16 v[76:79], v[32:35], a[160:167], v126
v_smfmac_f32_16x16x64_bf16 v[80:83], v[32:35], a[168:175], v126
v_smfmac_f32_16x16x64_bf16 v[84:87], v[32:35], a[176:183], v126
s_branch Lps_398
Lpf_395:
buffer_load_dwordx4 v[32:35], v9, s[4:7], s40 offen offset:1024 sc1
s_sub_u32 s37, s37, 1
s_cbranch_scc1 Lend_1
Lps_414:
s_waitcnt vmcnt(1)
v_max3_u32 v110, v36, v37, v38
v_max_u32 v110, v110, v39
v_cmp_eq_u32 vcc, -1, v110
s_cbranch_vccnz Lpf_415
v_smfmac_f32_16x16x64_bf16 v[76:79], v[36:39], a[192:199], v126
v_smfmac_f32_16x16x64_bf16 v[80:83], v[36:39], a[200:207], v126
v_smfmac_f32_16x16x64_bf16 v[84:87], v[36:39], a[208:215], v126
s_branch Lps_372
Lpf_397:
buffer_load_dwordx4 v[32:35], v9, s[4:7], s40 offen offset:1024 sc1
s_sub_u32 s37, s37, 1
s_cbranch_scc1 Lend_1
s_branch Lps_370
Lpf_399:
buffer_load_dwordx4 v[36:39], v9, s[4:7], s40 offen offset:2048 sc1
s_sub_u32 s37, s37, 1
s_cbranch_scc1 Lend_1
s_branch Lps_374
Lpf_401:
buffer_load_dwordx4 v[40:43], v9, s[4:7], s40 offen offset:3072 sc1
Lps_416:
s_waitcnt vmcnt(3)
v_max3_u32 v110, v28, v29, v30
v_max_u32 v110, v110, v31
v_cmp_eq_u32 vcc, -1, v110
s_cbranch_vccnz Lpf_417
v_smfmac_f32_16x16x64_bf16 v[76:79], v[28:31], a[128:135], v126
v_smfmac_f32_16x16x64_bf16 v[80:83], v[28:31], a[136:143], v126
v_smfmac_f32_16x16x64_bf16 v[84:87], v[28:31], a[144:151], v126
s_branch Lps_412
Lpf_403:
buffer_load_dwordx4 v[28:31], v9, s[4:7], s40 offen offset:0 sc1
s_sub_u32 s37, s37, 1
s_cbranch_scc1 Lend_1
Lps_418:
s_waitcnt vmcnt(2)
v_max3_u32 v110, v32, v33, v34
v_max_u32 v110, v110, v35
v_cmp_eq_u32 vcc, -1, v110
s_cbranch_vccnz Lpf_419
v_smfmac_f32_16x16x64_bf16 v[76:79], v[32:35], a[160:167], v126
v_smfmac_f32_16x16x64_bf16 v[80:83], v[32:35], a[168:175], v126
v_smfmac_f32_16x16x64_bf16 v[84:87], v[32:35], a[176:183], v126
s_branch Lps_410
Lpf_405:
buffer_load_dwordx4 v[28:31], v9, s[4:7], s40 offen offset:0 sc1
s_sub_u32 s37, s37, 1
s_cbranch_scc1 Lend_1
Lps_420:
s_waitcnt vmcnt(2)
v_max3_u32 v110, v32, v33, v34
v_max_u32 v110, v110, v35
v_cmp_eq_u32 vcc, -1, v110
s_cbranch_vccnz Lpf_421
v_smfmac_f32_16x16x64_bf16 v[76:79], v[32:35], a[160:167], v126
v_smfmac_f32_16x16x64_bf16 v[80:83], v[32:35], a[168:175], v126
v_smfmac_f32_16x16x64_bf16 v[84:87], v[32:35], a[176:183], v126
s_branch Lps_364
Lpf_407:
buffer_load_dwordx4 v[32:35], v9, s[4:7], s40 offen offset:1024 sc1
s_branch Lps_384
Lpf_409:
buffer_load_dwordx4 v[28:31], v9, s[4:7], s40 offen offset:0 sc1
s_sub_u32 s37, s37, 1
s_cbranch_scc1 Lend_1
s_branch Lps_362
Lpf_411:
buffer_load_dwordx4 v[36:39], v9, s[4:7], s40 offen offset:2048 sc1
s_branch Lps_388
Lpf_413:
buffer_load_dwordx4 v[32:35], v9, s[4:7], s40 offen offset:1024 sc1
s_sub_u32 s37, s37, 1
s_cbranch_scc1 Lend_1
s_branch Lps_368
Lpf_415:
buffer_load_dwordx4 v[36:39], v9, s[4:7], s40 offen offset:2048 sc1
s_branch Lps_394
Lpf_417:
buffer_load_dwordx4 v[28:31], v9, s[4:7], s40 offen offset:0 sc1
s_sub_u32 s37, s37, 1
s_cbranch_scc1 Lend_1
s_branch Lps_360
Lpf_419:
buffer_load_dwordx4 v[32:35], v9, s[4:7], s40 offen offset:1024 sc1
Lps_422:
s_waitcnt vmcnt(2)
v_max3_u32 v110, v36, v37, v38
v_max_u32 v110, v110, v39
v_cmp_eq_u32 vcc, -1, v110
s_cbranch_vccnz Lpf_423
v_smfmac_f32_16x16x64_bf16 v[76:79], v[36:39], a[192:199], v126
v_smfmac_f32_16x16x64_bf16 v[80:83], v[36:39], a[200:207], v126
v_smfmac_f32_16x16x64_bf16 v[84:87], v[36:39], a[208:215], v126
s_branch Lps_384
Lpf_421:
buffer_load_dwordx4 v[32:35], v9, s[4:7], s40 offen offset:1024 sc1
s_branch Lps_382
Lpf_423:
buffer_load_dwordx4 v[36:39], v9, s[4:7], s40 offen offset:2048 sc1
s_branch Lps_402
Lkvo_sc1_280:
Lkvo_424:
buffer_load_dwordx4 v[28:31], v8, s[4:7], s40 offen offset:0 sc1
s_nop 11
buffer_load_dwordx4 v[32:35], v8, s[4:7], s40 offen offset:1024 sc1
s_nop 11
buffer_load_dwordx4 v[36:39], v8, s[4:7], s40 offen offset:2048 sc1
s_nop 11
buffer_load_dwordx4 v[40:43], v8, s[4:7], s40 offen offset:3072 sc1
s_nop 11
s_waitcnt vmcnt(3)
v_max3_u32 v110, v28, v29, v30
v_max_u32 v110, v110, v31
v_cmp_eq_u32 vcc, -1, v110
s_cbranch_vccnz Lpf_426
v_smfmac_f32_16x16x64_bf16 v[44:47], v[28:31], a[0:7], v126
v_smfmac_f32_16x16x64_bf16 v[48:51], v[28:31], a[8:15], v126
s_waitcnt vmcnt(2)
v_max3_u32 v110, v32, v33, v34
v_max_u32 v110, v110, v35
v_cmp_eq_u32 vcc, -1, v110
v_smfmac_f32_16x16x64_bf16 v[52:55], v[28:31], a[16:23], v126
v_smfmac_f32_16x16x64_bf16 v[60:63], v[28:31], v[128:135], v126
s_cbranch_vccnz Lpf_427
v_smfmac_f32_16x16x64_bf16 v[44:47], v[32:35], a[32:39], v126
v_smfmac_f32_16x16x64_bf16 v[48:51], v[32:35], a[40:47], v126
s_waitcnt vmcnt(1)
v_max3_u32 v110, v36, v37, v38
v_max_u32 v110, v110, v39
v_cmp_eq_u32 vcc, -1, v110
v_smfmac_f32_16x16x64_bf16 v[52:55], v[32:35], a[48:55], v126
v_smfmac_f32_16x16x64_bf16 v[60:63], v[32:35], v[160:167], v126
s_cbranch_vccnz Lpf_428
v_smfmac_f32_16x16x64_bf16 v[44:47], v[36:39], a[64:71], v126
v_smfmac_f32_16x16x64_bf16 v[48:51], v[36:39], a[72:79], v126
s_waitcnt vmcnt(0)
v_max3_u32 v110, v40, v41, v42
v_max_u32 v110, v110, v43
v_cmp_eq_u32 vcc, -1, v110
v_smfmac_f32_16x16x64_bf16 v[52:55], v[36:39], a[80:87], v126
v_smfmac_f32_16x16x64_bf16 v[60:63], v[36:39], v[192:199], v126
s_cbranch_vccnz Lpf_429
v_smfmac_f32_16x16x64_bf16 v[44:47], v[40:43], a[96:103], v126
s_nop 1
v_smfmac_f32_16x16x64_bf16 v[48:51], v[40:43], a[104:111], v126
s_nop 1
v_smfmac_f32_16x16x64_bf16 v[52:55], v[40:43], a[112:119], v126
s_nop 1
v_add_f32 v92, v44, v46
v_add_f32 v93, v45, v47
v_smfmac_f32_16x16x64_bf16 v[56:59], v[28:31], a[24:31], v126
v_add_f32 v94, v48, v50
v_add_f32 v95, v49, v51
ds_write_b64 v24, v[92:93] offset:0
v_add_f32 v96, v52, v54
v_add_f32 v97, v53, v55
ds_write_b64 v25, v[94:95] offset:0
v_smfmac_f32_16x16x64_bf16 v[56:59], v[32:35], a[56:63], v126
ds_write_b64 v26, v[96:97] offset:0
v_smfmac_f32_16x16x64_bf16 v[56:59], v[36:39], a[88:95], v126
v_smfmac_f32_16x16x64_bf16 v[56:59], v[40:43], a[120:127], v126
v_smfmac_f32_16x16x64_bf16 v[60:63], v[40:43], v[224:231], v126
Lpd_425:
v_smfmac_f32_16x16x64_bf16 v[64:67], v[28:31], v[136:143], v126
v_smfmac_f32_16x16x64_bf16 v[64:67], v[32:35], v[168:175], v126
s_waitcnt lgkmcnt(0)
s_barrier
ds_read_b64 v[100:101], v0 offset:0
ds_read_b64 v[102:103], v0 offset:512
ds_read_b64 v[104:105], v0 offset:1024
s_nop 2
v_add_f32 v98, v56, v58
v_add_f32 v99, v57, v59
v_smfmac_f32_16x16x64_bf16 v[64:67], v[36:39], v[200:207], v126
v_smfmac_f32_16x16x64_bf16 v[64:67], v[40:43], v[232:239], v126
v_smfmac_f32_16x16x64_bf16 v[68:71], v[28:31], v[144:151], v126
v_smfmac_f32_16x16x64_bf16 v[68:71], v[32:35], v[176:183], v126
s_waitcnt lgkmcnt(0)
v_add_f32 v100, v100, v98
v_add_f32 v102, v102, v104
v_add_f32 v101, v101, v99
v_add_f32 v103, v103, v105
v_add_f32 v100, v100, v102
v_add_f32 v101, v101, v103
v_cvt_pk_bf16_f32 v108, v100, v101
s_nop 1
v_mov_b32_dpp v109, v108 quad_perm:[1,0,3,2] row_mask:0xf bank_mask:0xf
v_perm_b32 v109, v109, v108, v3
buffer_store_dword v109, v11, s[4:7], s40 offen sc1
v_smfmac_f32_16x16x64_bf16 v[68:71], v[36:39], v[208:215], v126
v_smfmac_f32_16x16x64_bf16 v[68:71], v[40:43], v[240:247], v126
s_nop 3
v_smfmac_f32_16x16x64_bf16 v[72:75], v[28:31], v[152:159], v126
v_add_f32 v92, v60, v62
v_add_f32 v93, v61, v63
v_smfmac_f32_16x16x64_bf16 v[72:75], v[32:35], v[184:191], v126
v_add_f32 v94, v64, v66
v_add_f32 v95, v65, v67
ds_write_b64 v24, v[92:93] offset:6144
v_smfmac_f32_16x16x64_bf16 v[72:75], v[36:39], v[216:223], v126
v_add_f32 v96, v68, v70
v_add_f32 v97, v69, v71
ds_write_b64 v25, v[94:95] offset:6144
ds_write_b64 v26, v[96:97] offset:6144
v_smfmac_f32_16x16x64_bf16 v[72:75], v[40:43], v[248:255], v126
s_waitcnt lgkmcnt(0)
s_barrier
ds_read_b64 v[100:101], v0 offset:6144
ds_read_b64 v[102:103], v0 offset:6656
ds_read_b64 v[104:105], v0 offset:7168
s_nop 2
v_add_f32 v98, v72, v74
v_add_f32 v99, v73, v75
s_waitcnt lgkmcnt(0)
v_pk_add_f32 v[100:101], v[100:101], v[98:99]
v_pk_add_f32 v[102:103], v[102:103], v[104:105]
v_pk_add_f32 v[100:101], v[100:101], v[102:103]
v_cvt_pk_bf16_f32 v108, v100, v101
buffer_store_dword v108, v27, s[4:7], s40 offen sc1
s_cmp_eq_u32 s36, 63
s_cbranch_scc1 Lend_1
v_add_u32 v7, 1, v7
s_and_b32 s38, s36, 3
s_lshl_b32 s84, s38, 18
s_add_u32 s84, s84, s46
s_add_u32 s85, s84, 0x100000
s_mov_b64 exec, 3
buffer_load_dword v112, v1, s[4:7], s59 offen sc1
s_nop 5
buffer_load_dword v113, v1, s[4:7], s59 offen sc1
s_nop 5
buffer_load_dword v114, v1, s[4:7], s59 offen sc1
Lft_431:
s_waitcnt vmcnt(2)
v_cmp_gt_u32 vcc, s26, v112
buffer_load_dword v112, v1, s[4:7], s59 offen sc1
s_cbranch_vccz Lfg_430
s_waitcnt vmcnt(2)
v_cmp_gt_u32 vcc, s26, v113
buffer_load_dword v113, v1, s[4:7], s59 offen sc1
s_cbranch_vccz Lfg_430
s_waitcnt vmcnt(2)
v_cmp_gt_u32 vcc, s26, v114
buffer_load_dword v114, v1, s[4:7], s59 offen sc1
s_cbranch_vccz Lfg_430
s_sub_u32 s37, s37, 1
s_cbranch_scc1 Lend_1
s_branch Lft_431
Lfg_430:
s_mov_b64 exec, -1
buffer_load_dwordx4 v[28:31], v9, s[4:7], s40 offen offset:0 sc1
s_nop 11
buffer_load_dwordx4 v[32:35], v9, s[4:7], s40 offen offset:1024 sc1
s_nop 11
buffer_load_dwordx4 v[36:39], v9, s[4:7], s40 offen offset:2048 sc1
s_nop 11
buffer_load_dwordx4 v[40:43], v9, s[4:7], s40 offen offset:3072 sc1
s_nop 11
s_waitcnt vmcnt(3)
v_max3_u32 v110, v28, v29, v30
v_max_u32 v110, v110, v31
v_cmp_eq_u32 vcc, -1, v110
s_cbranch_vccnz Lpf_433
v_smfmac_f32_16x16x64_bf16 v[76:79], v[28:31], a[128:135], v126
s_waitcnt vmcnt(2)
v_max3_u32 v110, v32, v33, v34
v_max_u32 v110, v110, v35
v_cmp_eq_u32 vcc, -1, v110
v_smfmac_f32_16x16x64_bf16 v[80:83], v[28:31], a[136:143], v126
v_smfmac_f32_16x16x64_bf16 v[84:87], v[28:31], a[144:151], v126
s_cbranch_vccnz Lpf_434
v_smfmac_f32_16x16x64_bf16 v[76:79], v[32:35], a[160:167], v126
s_waitcnt vmcnt(1)
v_max3_u32 v110, v36, v37, v38
v_max_u32 v110, v110, v39
v_cmp_eq_u32 vcc, -1, v110
v_smfmac_f32_16x16x64_bf16 v[80:83], v[32:35], a[168:175], v126
v_smfmac_f32_16x16x64_bf16 v[84:87], v[32:35], a[176:183], v126
s_cbranch_vccnz Lpf_435
v_smfmac_f32_16x16x64_bf16 v[76:79], v[36:39], a[192:199], v126
s_waitcnt vmcnt(0)
v_max3_u32 v110, v40, v41, v42
v_max_u32 v110, v110, v43
v_cmp_eq_u32 vcc, -1, v110
v_smfmac_f32_16x16x64_bf16 v[80:83], v[36:39], a[200:207], v126
v_smfmac_f32_16x16x64_bf16 v[84:87], v[36:39], a[208:215], v126
s_cbranch_vccnz Lpf_436
v_smfmac_f32_16x16x64_bf16 v[76:79], v[40:43], a[224:231], v126
s_nop 1
v_smfmac_f32_16x16x64_bf16 v[80:83], v[40:43], a[232:239], v126
s_nop 1
v_smfmac_f32_16x16x64_bf16 v[84:87], v[40:43], a[240:247], v126
s_nop 1
v_add_f32 v92, v76, v78
v_add_f32 v93, v77, v79
v_smfmac_f32_16x16x64_bf16 v[88:91], v[28:31], a[152:159], v126
v_add_f32 v94, v80, v82
v_add_f32 v95, v81, v83
ds_write_b64 v24, v[92:93] offset:12288
v_add_f32 v96, v84, v86
v_add_f32 v97, v85, v87
ds_write_b64 v25, v[94:95] offset:12288
v_smfmac_f32_16x16x64_bf16 v[88:91], v[32:35], a[184:191], v126
ds_write_b64 v26, v[96:97] offset:12288
v_smfmac_f32_16x16x64_bf16 v[88:91], v[36:39], a[216:223], v126
v_smfmac_f32_16x16x64_bf16 v[88:91], v[40:43], a[248:255], v126
Lpd_432:
s_waitcnt lgkmcnt(0)
s_barrier
ds_read_b64 v[100:101], v0 offset:12288
ds_read_b64 v[102:103], v0 offset:12800
ds_read_b64 v[104:105], v0 offset:13312
s_nop 2
v_add_f32 v98, v88, v90
v_add_f32 v99, v89, v91
s_waitcnt lgkmcnt(0)
v_pk_add_f32 v[100:101], v[100:101], v[98:99]
v_pk_add_f32 v[102:103], v[102:103], v[104:105]
v_pk_add_f32 v[100:101], v[100:101], v[102:103]
v_cvt_pk_bf16_f32 v108, v100, v101
buffer_store_dword v108, v12, s[4:7], s84 offen sc1
buffer_store_dword v108, v12, s[4:7], s85 offen sc1
s_waitcnt vmcnt(2)
buffer_store_dwordx2 v[4:5], v10, s[4:7], s42 offen sc1
buffer_store_dword v4, v11, s[4:7], s42 offen sc1
buffer_store_dword v4, v27, s[4:7], s42 offen sc1
v_mov_b32 v112, v108
v_mov_b32 v116, v108
v_mov_b32 v120, v108
s_add_u32 s36, s36, 1
s_and_b32 s38, s36, 3
s_lshl_b32 s39, s38, 16
s_add_u32 s40, s39, s45
s_xor_b32 s42, s40, 0x20000
s_add_u32 s26, s36, 1
s_nop 15
s_nop 15
s_nop 15
s_nop 15
s_nop 15
buffer_load_dword v113, v13, s[4:7], s84 offen sc1
buffer_load_dword v114, v14, s[4:7], s84 offen sc1
buffer_load_dword v115, v15, s[4:7], s84 offen sc1
v_pk_mul_f32 v[44:45], 0, 0
v_pk_mul_f32 v[46:47], 0, 0
v_pk_mul_f32 v[48:49], 0, 0
v_pk_mul_f32 v[50:51], 0, 0
v_pk_mul_f32 v[52:53], 0, 0
v_pk_mul_f32 v[54:55], 0, 0
v_pk_mul_f32 v[56:57], 0, 0
v_pk_mul_f32 v[58:59], 0, 0
v_pk_mul_f32 v[60:61], 0, 0
v_pk_mul_f32 v[62:63], 0, 0
v_pk_mul_f32 v[64:65], 0, 0
v_pk_mul_f32 v[66:67], 0, 0
v_pk_mul_f32 v[68:69], 0, 0
v_pk_mul_f32 v[70:71], 0, 0
v_pk_mul_f32 v[72:73], 0, 0
v_pk_mul_f32 v[74:75], 0, 0
v_pk_mul_f32 v[76:77], 0, 0
v_pk_mul_f32 v[78:79], 0, 0
v_pk_mul_f32 v[80:81], 0, 0
v_pk_mul_f32 v[82:83], 0, 0
v_pk_mul_f32 v[84:85], 0, 0
v_pk_mul_f32 v[86:87], 0, 0
v_pk_mul_f32 v[88:89], 0, 0
v_pk_mul_f32 v[90:91], 0, 0
buffer_load_dword v117, v13, s[4:7], s85 offen sc1
buffer_load_dword v118, v14, s[4:7], s85 offen sc1
buffer_load_dword v119, v15, s[4:7], s85 offen sc1
buffer_store_dword v7, v2, s[4:7], s59 offen sc1
s_nop 15
s_nop 15
s_nop 15
buffer_load_dword v121, v13, s[4:7], s84 offen sc1
buffer_load_dword v122, v14, s[4:7], s84 offen sc1
buffer_load_dword v123, v15, s[4:7], s84 offen sc1
s_waitcnt vmcnt(7)
v_mfma_f32_16x16x32_bf16 v[100:103], v[112:115], v[20:23], 0
v_max3_u32 v110, v113, v114, v115
v_cmp_eq_u32 vcc, -1, v110
s_nop 5
v_cvt_pk_bf16_f32 v106, v100, v101
v_cvt_pk_bf16_f32 v107, v102, v103
s_cbranch_vccnz Lx2_437
Lxs_438:
buffer_store_dwordx2 v[106:107], v10, s[4:7], s40 offen sc1
s_nop 15
s_nop 15
s_nop 11
s_branch Lkvo_424
Lx2_437:
buffer_load_dword v113, v13, s[4:7], s85 offen sc1
buffer_load_dword v114, v14, s[4:7], s85 offen sc1
buffer_load_dword v115, v15, s[4:7], s85 offen sc1
s_waitcnt vmcnt(6)
v_mfma_f32_16x16x32_bf16 v[100:103], v[116:119], v[20:23], 0
v_max3_u32 v110, v117, v118, v119
v_cmp_eq_u32 vcc, -1, v110
s_nop 5
v_cvt_pk_bf16_f32 v106, v100, v101
v_cvt_pk_bf16_f32 v107, v102, v103
s_cbranch_vccz Lxs_438
buffer_load_dword v117, v13, s[4:7], s84 offen sc1
buffer_load_dword v118, v14, s[4:7], s84 offen sc1
buffer_load_dword v119, v15, s[4:7], s84 offen sc1
s_waitcnt vmcnt(6)
v_mfma_f32_16x16x32_bf16 v[100:103], v[120:123], v[20:23], 0
v_max3_u32 v110, v121, v122, v123
v_cmp_eq_u32 vcc, -1, v110
s_nop 5
v_cvt_pk_bf16_f32 v106, v100, v101
v_cvt_pk_bf16_f32 v107, v102, v103
s_cbranch_vccz Lxs_438
buffer_load_dword v121, v13, s[4:7], s85 offen sc1
buffer_load_dword v122, v14, s[4:7], s85 offen sc1
buffer_load_dword v123, v15, s[4:7], s85 offen sc1
s_waitcnt vmcnt(6)
v_mfma_f32_16x16x32_bf16 v[100:103], v[112:115], v[20:23], 0
v_max3_u32 v110, v113, v114, v115
v_cmp_eq_u32 vcc, -1, v110
s_nop 5
v_cvt_pk_bf16_f32 v106, v100, v101
v_cvt_pk_bf16_f32 v107, v102, v103
s_cbranch_vccz Lxs_438
buffer_load_dword v113, v13, s[4:7], s84 offen sc1
buffer_load_dword v114, v14, s[4:7], s84 offen sc1
buffer_load_dword v115, v15, s[4:7], s84 offen sc1
s_waitcnt vmcnt(6)
v_mfma_f32_16x16x32_bf16 v[100:103], v[116:119], v[20:23], 0
v_max3_u32 v110, v117, v118, v119
v_cmp_eq_u32 vcc, -1, v110
s_nop 5
v_cvt_pk_bf16_f32 v106, v100, v101
v_cvt_pk_bf16_f32 v107, v102, v103
s_cbranch_vccz Lxs_438
buffer_load_dword v117, v13, s[4:7], s85 offen sc1
buffer_load_dword v118, v14, s[4:7], s85 offen sc1
buffer_load_dword v119, v15, s[4:7], s85 offen sc1
s_waitcnt vmcnt(6)
v_mfma_f32_16x16x32_bf16 v[100:103], v[120:123], v[20:23], 0
v_max3_u32 v110, v121, v122, v123
v_cmp_eq_u32 vcc, -1, v110
s_nop 5
v_cvt_pk_bf16_f32 v106, v100, v101
v_cvt_pk_bf16_f32 v107, v102, v103
s_cbranch_vccz Lxs_438
buffer_load_dword v121, v13, s[4:7], s84 offen sc1
buffer_load_dword v122, v14, s[4:7], s84 offen sc1
buffer_load_dword v123, v15, s[4:7], s84 offen sc1
s_waitcnt vmcnt(6)
v_mfma_f32_16x16x32_bf16 v[100:103], v[112:115], v[20:23], 0
v_max3_u32 v110, v113, v114, v115
v_cmp_eq_u32 vcc, -1, v110
s_nop 5
v_cvt_pk_bf16_f32 v106, v100, v101
v_cvt_pk_bf16_f32 v107, v102, v103
s_cbranch_vccz Lxs_438
s_sub_u32 s37, s37, 1
s_cbranch_scc1 Lend_1
s_branch Lx2_437
Lpf_426:
buffer_load_dwordx4 v[28:31], v8, s[4:7], s40 offen offset:0 sc1
s_sub_u32 s37, s37, 1
s_cbranch_scc1 Lend_1
Lps_439:
s_waitcnt vmcnt(3)
v_max3_u32 v110, v32, v33, v34
v_max_u32 v110, v110, v35
v_cmp_eq_u32 vcc, -1, v110
s_cbranch_vccnz Lpf_440
v_smfmac_f32_16x16x64_bf16 v[44:47], v[32:35], a[32:39], v126
v_smfmac_f32_16x16x64_bf16 v[48:51], v[32:35], a[40:47], v126
v_smfmac_f32_16x16x64_bf16 v[52:55], v[32:35], a[48:55], v126
v_smfmac_f32_16x16x64_bf16 v[60:63], v[32:35], v[160:167], v126
Lps_441:
s_waitcnt vmcnt(2)
v_max3_u32 v110, v36, v37, v38
v_max_u32 v110, v110, v39
v_cmp_eq_u32 vcc, -1, v110
s_cbranch_vccnz Lpf_442
v_smfmac_f32_16x16x64_bf16 v[44:47], v[36:39], a[64:71], v126
v_smfmac_f32_16x16x64_bf16 v[48:51], v[36:39], a[72:79], v126
v_smfmac_f32_16x16x64_bf16 v[52:55], v[36:39], a[80:87], v126
v_smfmac_f32_16x16x64_bf16 v[60:63], v[36:39], v[192:199], v126
Lps_443:
s_waitcnt vmcnt(1)
v_max3_u32 v110, v40, v41, v42
v_max_u32 v110, v110, v43
v_cmp_eq_u32 vcc, -1, v110
s_cbranch_vccnz Lpf_444
v_smfmac_f32_16x16x64_bf16 v[44:47], v[40:43], a[96:103], v126
v_smfmac_f32_16x16x64_bf16 v[48:51], v[40:43], a[104:111], v126
v_smfmac_f32_16x16x64_bf16 v[52:55], v[40:43], a[112:119], v126
v_smfmac_f32_16x16x64_bf16 v[60:63], v[40:43], v[224:231], v126
Lps_445:
s_waitcnt vmcnt(0)
v_max3_u32 v110, v28, v29, v30
v_max_u32 v110, v110, v31
v_cmp_eq_u32 vcc, -1, v110
s_cbranch_vccnz Lpf_446
v_smfmac_f32_16x16x64_bf16 v[44:47], v[28:31], a[0:7], v126
s_nop 1
v_smfmac_f32_16x16x64_bf16 v[48:51], v[28:31], a[8:15], v126
s_nop 1
v_smfmac_f32_16x16x64_bf16 v[52:55], v[28:31], a[16:23], v126
s_nop 1
v_add_f32 v92, v44, v46
v_add_f32 v93, v45, v47
v_smfmac_f32_16x16x64_bf16 v[56:59], v[28:31], a[24:31], v126
v_add_f32 v94, v48, v50
v_add_f32 v95, v49, v51
ds_write_b64 v24, v[92:93] offset:0
v_add_f32 v96, v52, v54
v_add_f32 v97, v53, v55
ds_write_b64 v25, v[94:95] offset:0
v_smfmac_f32_16x16x64_bf16 v[56:59], v[32:35], a[56:63], v126
ds_write_b64 v26, v[96:97] offset:0
v_smfmac_f32_16x16x64_bf16 v[56:59], v[36:39], a[88:95], v126
v_smfmac_f32_16x16x64_bf16 v[56:59], v[40:43], a[120:127], v126
v_smfmac_f32_16x16x64_bf16 v[60:63], v[28:31], v[128:135], v126
s_branch Lpd_425
Lpf_427:
buffer_load_dwordx4 v[32:35], v8, s[4:7], s40 offen offset:1024 sc1
s_sub_u32 s37, s37, 1
s_cbranch_scc1 Lend_1
Lps_447:
s_waitcnt vmcnt(2)
v_max3_u32 v110, v36, v37, v38
v_max_u32 v110, v110, v39
v_cmp_eq_u32 vcc, -1, v110
s_cbranch_vccnz Lpf_448
v_smfmac_f32_16x16x64_bf16 v[44:47], v[36:39], a[64:71], v126
v_smfmac_f32_16x16x64_bf16 v[48:51], v[36:39], a[72:79], v126
v_smfmac_f32_16x16x64_bf16 v[52:55], v[36:39], a[80:87], v126
v_smfmac_f32_16x16x64_bf16 v[60:63], v[36:39], v[192:199], v126
Lps_449:
s_waitcnt vmcnt(1)
v_max3_u32 v110, v40, v41, v42
v_max_u32 v110, v110, v43
v_cmp_eq_u32 vcc, -1, v110
s_cbranch_vccnz Lpf_450
v_smfmac_f32_16x16x64_bf16 v[44:47], v[40:43], a[96:103], v126
v_smfmac_f32_16x16x64_bf16 v[48:51], v[40:43], a[104:111], v126
v_smfmac_f32_16x16x64_bf16 v[52:55], v[40:43], a[112:119], v126
v_smfmac_f32_16x16x64_bf16 v[60:63], v[40:43], v[224:231], v126
Lps_451:
s_waitcnt vmcnt(0)
v_max3_u32 v110, v32, v33, v34
v_max_u32 v110, v110, v35
v_cmp_eq_u32 vcc, -1, v110
s_cbranch_vccnz Lpf_452
v_smfmac_f32_16x16x64_bf16 v[44:47], v[32:35], a[32:39], v126
s_nop 1
v_smfmac_f32_16x16x64_bf16 v[48:51], v[32:35], a[40:47], v126
s_nop 1
v_smfmac_f32_16x16x64_bf16 v[52:55], v[32:35], a[48:55], v126
s_nop 1
v_add_f32 v92, v44, v46
v_add_f32 v93, v45, v47
v_smfmac_f32_16x16x64_bf16 v[56:59], v[28:31], a[24:31], v126
v_add_f32 v94, v48, v50
v_add_f32 v95, v49, v51
ds_write_b64 v24, v[92:93] offset:0
v_add_f32 v96, v52, v54
v_add_f32 v97, v53, v55
ds_write_b64 v25, v[94:95] offset:0
v_smfmac_f32_16x16x64_bf16 v[56:59], v[32:35], a[56:63], v126
ds_write_b64 v26, v[96:97] offset:0
v_smfmac_f32_16x16x64_bf16 v[56:59], v[36:39], a[88:95], v126
v_smfmac_f32_16x16x64_bf16 v[56:59], v[40:43], a[120:127], v126
v_smfmac_f32_16x16x64_bf16 v[60:63], v[32:35], v[160:167], v126
s_branch Lpd_425
Lpf_428:
buffer_load_dwordx4 v[36:39], v8, s[4:7], s40 offen offset:2048 sc1
s_sub_u32 s37, s37, 1
s_cbranch_scc1 Lend_1
Lps_453:
s_waitcnt vmcnt(1)
v_max3_u32 v110, v40, v41, v42
v_max_u32 v110, v110, v43
v_cmp_eq_u32 vcc, -1, v110
s_cbranch_vccnz Lpf_454
v_smfmac_f32_16x16x64_bf16 v[44:47], v[40:43], a[96:103], v126
v_smfmac_f32_16x16x64_bf16 v[48:51], v[40:43], a[104:111], v126
v_smfmac_f32_16x16x64_bf16 v[52:55], v[40:43], a[112:119], v126
v_smfmac_f32_16x16x64_bf16 v[60:63], v[40:43], v[224:231], v126
Lps_455:
s_waitcnt vmcnt(0)
v_max3_u32 v110, v36, v37, v38
v_max_u32 v110, v110, v39
v_cmp_eq_u32 vcc, -1, v110
s_cbranch_vccnz Lpf_456
v_smfmac_f32_16x16x64_bf16 v[44:47], v[36:39], a[64:71], v126
s_nop 1
v_smfmac_f32_16x16x64_bf16 v[48:51], v[36:39], a[72:79], v126
s_nop 1
v_smfmac_f32_16x16x64_bf16 v[52:55], v[36:39], a[80:87], v126
s_nop 1
v_add_f32 v92, v44, v46
v_add_f32 v93, v45, v47
v_smfmac_f32_16x16x64_bf16 v[56:59], v[28:31], a[24:31], v126
v_add_f32 v94, v48, v50
v_add_f32 v95, v49, v51
ds_write_b64 v24, v[92:93] offset:0
v_add_f32 v96, v52, v54
v_add_f32 v97, v53, v55
ds_write_b64 v25, v[94:95] offset:0
v_smfmac_f32_16x16x64_bf16 v[56:59], v[32:35], a[56:63], v126
ds_write_b64 v26, v[96:97] offset:0
v_smfmac_f32_16x16x64_bf16 v[56:59], v[36:39], a[88:95], v126
v_smfmac_f32_16x16x64_bf16 v[56:59], v[40:43], a[120:127], v126
v_smfmac_f32_16x16x64_bf16 v[60:63], v[36:39], v[192:199], v126
s_branch Lpd_425
Lpf_429:
buffer_load_dwordx4 v[40:43], v8, s[4:7], s40 offen offset:3072 sc1
s_sub_u32 s37, s37, 1
s_cbranch_scc1 Lend_1
Lps_457:
s_waitcnt vmcnt(0)
v_max3_u32 v110, v40, v41, v42
v_max_u32 v110, v110, v43
v_cmp_eq_u32 vcc, -1, v110
s_cbranch_vccnz Lpf_458
v_smfmac_f32_16x16x64_bf16 v[44:47], v[40:43], a[96:103], v126
s_nop 1
v_smfmac_f32_16x16x64_bf16 v[48:51], v[40:43], a[104:111], v126
s_nop 1
v_smfmac_f32_16x16x64_bf16 v[52:55], v[40:43], a[112:119], v126
s_nop 1
v_add_f32 v92, v44, v46
v_add_f32 v93, v45, v47
v_smfmac_f32_16x16x64_bf16 v[56:59], v[28:31], a[24:31], v126
v_add_f32 v94, v48, v50
v_add_f32 v95, v49, v51
ds_write_b64 v24, v[92:93] offset:0
v_add_f32 v96, v52, v54
v_add_f32 v97, v53, v55
ds_write_b64 v25, v[94:95] offset:0
v_smfmac_f32_16x16x64_bf16 v[56:59], v[32:35], a[56:63], v126
ds_write_b64 v26, v[96:97] offset:0
v_smfmac_f32_16x16x64_bf16 v[56:59], v[36:39], a[88:95], v126
v_smfmac_f32_16x16x64_bf16 v[56:59], v[40:43], a[120:127], v126
v_smfmac_f32_16x16x64_bf16 v[60:63], v[40:43], v[224:231], v126
s_branch Lpd_425
Lpf_440:
buffer_load_dwordx4 v[32:35], v8, s[4:7], s40 offen offset:1024 sc1
Lps_459:
s_waitcnt vmcnt(3)
v_max3_u32 v110, v36, v37, v38
v_max_u32 v110, v110, v39
v_cmp_eq_u32 vcc, -1, v110
s_cbranch_vccnz Lpf_460
v_smfmac_f32_16x16x64_bf16 v[44:47], v[36:39], a[64:71], v126
v_smfmac_f32_16x16x64_bf16 v[48:51], v[36:39], a[72:79], v126
v_smfmac_f32_16x16x64_bf16 v[52:55], v[36:39], a[80:87], v126
v_smfmac_f32_16x16x64_bf16 v[60:63], v[36:39], v[192:199], v126
Lps_461:
s_waitcnt vmcnt(2)
v_max3_u32 v110, v40, v41, v42
v_max_u32 v110, v110, v43
v_cmp_eq_u32 vcc, -1, v110
s_cbranch_vccnz Lpf_462
v_smfmac_f32_16x16x64_bf16 v[44:47], v[40:43], a[96:103], v126
v_smfmac_f32_16x16x64_bf16 v[48:51], v[40:43], a[104:111], v126
v_smfmac_f32_16x16x64_bf16 v[52:55], v[40:43], a[112:119], v126
v_smfmac_f32_16x16x64_bf16 v[60:63], v[40:43], v[224:231], v126
Lps_463:
s_waitcnt vmcnt(1)
v_max3_u32 v110, v28, v29, v30
v_max_u32 v110, v110, v31
v_cmp_eq_u32 vcc, -1, v110
s_cbranch_vccnz Lpf_464
v_smfmac_f32_16x16x64_bf16 v[44:47], v[28:31], a[0:7], v126
v_smfmac_f32_16x16x64_bf16 v[48:51], v[28:31], a[8:15], v126
v_smfmac_f32_16x16x64_bf16 v[52:55], v[28:31], a[16:23], v126
v_smfmac_f32_16x16x64_bf16 v[60:63], v[28:31], v[128:135], v126
s_branch Lps_451
Lpf_442:
buffer_load_dwordx4 v[36:39], v8, s[4:7], s40 offen offset:2048 sc1
Lps_465:
s_waitcnt vmcnt(2)
v_max3_u32 v110, v40, v41, v42
v_max_u32 v110, v110, v43
v_cmp_eq_u32 vcc, -1, v110
s_cbranch_vccnz Lpf_466
v_smfmac_f32_16x16x64_bf16 v[44:47], v[40:43], a[96:103], v126
v_smfmac_f32_16x16x64_bf16 v[48:51], v[40:43], a[104:111], v126
v_smfmac_f32_16x16x64_bf16 v[52:55], v[40:43], a[112:119], v126
v_smfmac_f32_16x16x64_bf16 v[60:63], v[40:43], v[224:231], v126
Lps_467:
s_waitcnt vmcnt(1)
v_max3_u32 v110, v28, v29, v30
v_max_u32 v110, v110, v31
v_cmp_eq_u32 vcc, -1, v110
s_cbranch_vccnz Lpf_468
v_smfmac_f32_16x16x64_bf16 v[44:47], v[28:31], a[0:7], v126
v_smfmac_f32_16x16x64_bf16 v[48:51], v[28:31], a[8:15], v126
v_smfmac_f32_16x16x64_bf16 v[52:55], v[28:31], a[16:23], v126
v_smfmac_f32_16x16x64_bf16 v[60:63], v[28:31], v[128:135], v126
s_branch Lps_455
Lpf_444:
buffer_load_dwordx4 v[40:43], v8, s[4:7], s40 offen offset:3072 sc1
Lps_469:
s_waitcnt vmcnt(1)
v_max3_u32 v110, v28, v29, v30
v_max_u32 v110, v110, v31
v_cmp_eq_u32 vcc, -1, v110
s_cbranch_vccnz Lpf_470
v_smfmac_f32_16x16x64_bf16 v[44:47], v[28:31], a[0:7], v126
v_smfmac_f32_16x16x64_bf16 v[48:51], v[28:31], a[8:15], v126
v_smfmac_f32_16x16x64_bf16 v[52:55], v[28:31], a[16:23], v126
v_smfmac_f32_16x16x64_bf16 v[60:63], v[28:31], v[128:135], v126
s_branch Lps_457
Lpf_446:
buffer_load_dwordx4 v[28:31], v8, s[4:7], s40 offen offset:0 sc1
s_sub_u32 s37, s37, 1
s_cbranch_scc1 Lend_1
s_branch Lps_445
Lpf_448:
buffer_load_dwordx4 v[36:39], v8, s[4:7], s40 offen offset:2048 sc1
Lps_471:
s_waitcnt vmcnt(2)
v_max3_u32 v110, v40, v41, v42
v_max_u32 v110, v110, v43
v_cmp_eq_u32 vcc, -1, v110
s_cbranch_vccnz Lpf_472
v_smfmac_f32_16x16x64_bf16 v[44:47], v[40:43], a[96:103], v126
v_smfmac_f32_16x16x64_bf16 v[48:51], v[40:43], a[104:111], v126
v_smfmac_f32_16x16x64_bf16 v[52:55], v[40:43], a[112:119], v126
v_smfmac_f32_16x16x64_bf16 v[60:63], v[40:43], v[224:231], v126
Lps_473:
s_waitcnt vmcnt(1)
v_max3_u32 v110, v32, v33, v34
v_max_u32 v110, v110, v35
v_cmp_eq_u32 vcc, -1, v110
s_cbranch_vccnz Lpf_474
v_smfmac_f32_16x16x64_bf16 v[44:47], v[32:35], a[32:39], v126
v_smfmac_f32_16x16x64_bf16 v[48:51], v[32:35], a[40:47], v126
v_smfmac_f32_16x16x64_bf16 v[52:55], v[32:35], a[48:55], v126
v_smfmac_f32_16x16x64_bf16 v[60:63], v[32:35], v[160:167], v126
s_branch Lps_455
Lpf_450:
buffer_load_dwordx4 v[40:43], v8, s[4:7], s40 offen offset:3072 sc1
Lps_475:
s_waitcnt vmcnt(1)
v_max3_u32 v110, v32, v33, v34
v_max_u32 v110, v110, v35
v_cmp_eq_u32 vcc, -1, v110
s_cbranch_vccnz Lpf_476
v_smfmac_f32_16x16x64_bf16 v[44:47], v[32:35], a[32:39], v126
v_smfmac_f32_16x16x64_bf16 v[48:51], v[32:35], a[40:47], v126
v_smfmac_f32_16x16x64_bf16 v[52:55], v[32:35], a[48:55], v126
v_smfmac_f32_16x16x64_bf16 v[60:63], v[32:35], v[160:167], v126
s_branch Lps_457
Lpf_452:
buffer_load_dwordx4 v[32:35], v8, s[4:7], s40 offen offset:1024 sc1
s_sub_u32 s37, s37, 1
s_cbranch_scc1 Lend_1
s_branch Lps_451
Lpf_454:
buffer_load_dwordx4 v[40:43], v8, s[4:7], s40 offen offset:3072 sc1
Lps_477:
s_waitcnt vmcnt(1)
v_max3_u32 v110, v36, v37, v38
v_max_u32 v110, v110, v39
v_cmp_eq_u32 vcc, -1, v110
s_cbranch_vccnz Lpf_478
v_smfmac_f32_16x16x64_bf16 v[44:47], v[36:39], a[64:71], v126
v_smfmac_f32_16x16x64_bf16 v[48:51], v[36:39], a[72:79], v126
v_smfmac_f32_16x16x64_bf16 v[52:55], v[36:39], a[80:87], v126
v_smfmac_f32_16x16x64_bf16 v[60:63], v[36:39], v[192:199], v126
s_branch Lps_457
Lpf_456:
buffer_load_dwordx4 v[36:39], v8, s[4:7], s40 offen offset:2048 sc1
s_sub_u32 s37, s37, 1
s_cbranch_scc1 Lend_1
s_branch Lps_455
Lpf_458:
buffer_load_dwordx4 v[40:43], v8, s[4:7], s40 offen offset:3072 sc1
s_sub_u32 s37, s37, 1
s_cbranch_scc1 Lend_1
s_branch Lps_457
Lpf_460:
buffer_load_dwordx4 v[36:39], v8, s[4:7], s40 offen offset:2048 sc1
Lps_479:
s_waitcnt vmcnt(3)
v_max3_u32 v110, v40, v41, v42
v_max_u32 v110, v110, v43
v_cmp_eq_u32 vcc, -1, v110
s_cbranch_vccnz Lpf_480
v_smfmac_f32_16x16x64_bf16 v[44:47], v[40:43], a[96:103], v126
v_smfmac_f32_16x16x64_bf16 v[48:51], v[40:43], a[104:111], v126
v_smfmac_f32_16x16x64_bf16 v[52:55], v[40:43], a[112:119], v126
v_smfmac_f32_16x16x64_bf16 v[60:63], v[40:43], v[224:231], v126
Lps_481:
s_waitcnt vmcnt(2)
v_max3_u32 v110, v28, v29, v30
v_max_u32 v110, v110, v31
v_cmp_eq_u32 vcc, -1, v110
s_cbranch_vccnz Lpf_482
v_smfmac_f32_16x16x64_bf16 v[44:47], v[28:31], a[0:7], v126
v_smfmac_f32_16x16x64_bf16 v[48:51], v[28:31], a[8:15], v126
v_smfmac_f32_16x16x64_bf16 v[52:55], v[28:31], a[16:23], v126
v_smfmac_f32_16x16x64_bf16 v[60:63], v[28:31], v[128:135], v126
s_branch Lps_473
Lpf_462:
buffer_load_dwordx4 v[40:43], v8, s[4:7], s40 offen offset:3072 sc1
Lps_483:
s_waitcnt vmcnt(2)
v_max3_u32 v110, v28, v29, v30
v_max_u32 v110, v110, v31
v_cmp_eq_u32 vcc, -1, v110
s_cbranch_vccnz Lpf_484
v_smfmac_f32_16x16x64_bf16 v[44:47], v[28:31], a[0:7], v126
v_smfmac_f32_16x16x64_bf16 v[48:51], v[28:31], a[8:15], v126
v_smfmac_f32_16x16x64_bf16 v[52:55], v[28:31], a[16:23], v126
v_smfmac_f32_16x16x64_bf16 v[60:63], v[28:31], v[128:135], v126
s_branch Lps_475
Lpf_464:
buffer_load_dwordx4 v[28:31], v8, s[4:7], s40 offen offset:0 sc1
s_sub_u32 s37, s37, 1
s_cbranch_scc1 Lend_1
Lps_485:
s_waitcnt vmcnt(1)
v_max3_u32 v110, v32, v33, v34
v_max_u32 v110, v110, v35
v_cmp_eq_u32 vcc, -1, v110
s_cbranch_vccnz Lpf_486
v_smfmac_f32_16x16x64_bf16 v[44:47], v[32:35], a[32:39], v126
v_smfmac_f32_16x16x64_bf16 v[48:51], v[32:35], a[40:47], v126
v_smfmac_f32_16x16x64_bf16 v[52:55], v[32:35], a[48:55], v126
v_smfmac_f32_16x16x64_bf16 v[60:63], v[32:35], v[160:167], v126
s_branch Lps_445
Lpf_466:
buffer_load_dwordx4 v[40:43], v8, s[4:7], s40 offen offset:3072 sc1
Lps_487:
s_waitcnt vmcnt(2)
v_max3_u32 v110, v28, v29, v30
v_max_u32 v110, v110, v31
v_cmp_eq_u32 vcc, -1, v110
s_cbranch_vccnz Lpf_488
v_smfmac_f32_16x16x64_bf16 v[44:47], v[28:31], a[0:7], v126
v_smfmac_f32_16x16x64_bf16 v[48:51], v[28:31], a[8:15], v126
v_smfmac_f32_16x16x64_bf16 v[52:55], v[28:31], a[16:23], v126
v_smfmac_f32_16x16x64_bf16 v[60:63], v[28:31], v[128:135], v126
s_branch Lps_477
Lpf_468:
buffer_load_dwordx4 v[28:31], v8, s[4:7], s40 offen offset:0 sc1
s_sub_u32 s37, s37, 1
s_cbranch_scc1 Lend_1
Lps_489:
s_waitcnt vmcnt(1)
v_max3_u32 v110, v36, v37, v38
v_max_u32 v110, v110, v39
v_cmp_eq_u32 vcc, -1, v110
s_cbranch_vccnz Lpf_490
v_smfmac_f32_16x16x64_bf16 v[44:47], v[36:39], a[64:71], v126
v_smfmac_f32_16x16x64_bf16 v[48:51], v[36:39], a[72:79], v126
v_smfmac_f32_16x16x64_bf16 v[52:55], v[36:39], a[80:87], v126
v_smfmac_f32_16x16x64_bf16 v[60:63], v[36:39], v[192:199], v126
s_branch Lps_445
Lpf_470:
buffer_load_dwordx4 v[28:31], v8, s[4:7], s40 offen offset:0 sc1
s_sub_u32 s37, s37, 1
s_cbranch_scc1 Lend_1
s_branch Lps_443
Lpf_472:
buffer_load_dwordx4 v[40:43], v8, s[4:7], s40 offen offset:3072 sc1
Lps_491:
s_waitcnt vmcnt(2)
v_max3_u32 v110, v32, v33, v34
v_max_u32 v110, v110, v35
v_cmp_eq_u32 vcc, -1, v110
s_cbranch_vccnz Lpf_492
v_smfmac_f32_16x16x64_bf16 v[44:47], v[32:35], a[32:39], v126
v_smfmac_f32_16x16x64_bf16 v[48:51], v[32:35], a[40:47], v126
v_smfmac_f32_16x16x64_bf16 v[52:55], v[32:35], a[48:55], v126
v_smfmac_f32_16x16x64_bf16 v[60:63], v[32:35], v[160:167], v126
s_branch Lps_477
Lpf_474:
buffer_load_dwordx4 v[32:35], v8, s[4:7], s40 offen offset:1024 sc1
s_sub_u32 s37, s37, 1
s_cbranch_scc1 Lend_1
Lps_493:
s_waitcnt vmcnt(1)
v_max3_u32 v110, v36, v37, v38
v_max_u32 v110, v110, v39
v_cmp_eq_u32 vcc, -1, v110
s_cbranch_vccnz Lpf_494
v_smfmac_f32_16x16x64_bf16 v[44:47], v[36:39], a[64:71], v126
v_smfmac_f32_16x16x64_bf16 v[48:51], v[36:39], a[72:79], v126
v_smfmac_f32_16x16x64_bf16 v[52:55], v[36:39], a[80:87], v126
v_smfmac_f32_16x16x64_bf16 v[60:63], v[36:39], v[192:199], v126
s_branch Lps_451
Lpf_476:
buffer_load_dwordx4 v[32:35], v8, s[4:7], s40 offen offset:1024 sc1
s_sub_u32 s37, s37, 1
s_cbranch_scc1 Lend_1
s_branch Lps_449
Lpf_478:
buffer_load_dwordx4 v[36:39], v8, s[4:7], s40 offen offset:2048 sc1
s_sub_u32 s37, s37, 1
s_cbranch_scc1 Lend_1
s_branch Lps_453
Lpf_480:
buffer_load_dwordx4 v[40:43], v8, s[4:7], s40 offen offset:3072 sc1
Lps_495:
s_waitcnt vmcnt(3)
v_max3_u32 v110, v28, v29, v30
v_max_u32 v110, v110, v31
v_cmp_eq_u32 vcc, -1, v110
s_cbranch_vccnz Lpf_496
v_smfmac_f32_16x16x64_bf16 v[44:47], v[28:31], a[0:7], v126
v_smfmac_f32_16x16x64_bf16 v[48:51], v[28:31], a[8:15], v126
v_smfmac_f32_16x16x64_bf16 v[52:55], v[28:31], a[16:23], v126
v_smfmac_f32_16x16x64_bf16 v[60:63], v[28:31], v[128:135], v126
s_branch Lps_491
Lpf_482:
buffer_load_dwordx4 v[28:31], v8, s[4:7], s40 offen offset:0 sc1
s_sub_u32 s37, s37, 1
s_cbranch_scc1 Lend_1
Lps_497:
s_waitcnt vmcnt(2)
v_max3_u32 v110, v32, v33, v34
v_max_u32 v110, v110, v35
v_cmp_eq_u32 vcc, -1, v110
s_cbranch_vccnz Lpf_498
v_smfmac_f32_16x16x64_bf16 v[44:47], v[32:35], a[32:39], v126
v_smfmac_f32_16x16x64_bf16 v[48:51], v[32:35], a[40:47], v126
v_smfmac_f32_16x16x64_bf16 v[52:55], v[32:35], a[48:55], v126
v_smfmac_f32_16x16x64_bf16 v[60:63], v[32:35], v[160:167], v126
s_branch Lps_489
Lpf_484:
buffer_load_dwordx4 v[28:31], v8, s[4:7], s40 offen offset:0 sc1
s_sub_u32 s37, s37, 1
s_cbranch_scc1 Lend_1
Lps_499:
s_waitcnt vmcnt(2)
v_max3_u32 v110, v32, v33, v34
v_max_u32 v110, v110, v35
v_cmp_eq_u32 vcc, -1, v110
s_cbranch_vccnz Lpf_500
v_smfmac_f32_16x16x64_bf16 v[44:47], v[32:35], a[32:39], v126
v_smfmac_f32_16x16x64_bf16 v[48:51], v[32:35], a[40:47], v126
v_smfmac_f32_16x16x64_bf16 v[52:55], v[32:35], a[48:55], v126
v_smfmac_f32_16x16x64_bf16 v[60:63], v[32:35], v[160:167], v126
s_branch Lps_443
Lpf_486:
buffer_load_dwordx4 v[32:35], v8, s[4:7], s40 offen offset:1024 sc1
s_branch Lps_463
Lpf_488:
buffer_load_dwordx4 v[28:31], v8, s[4:7], s40 offen offset:0 sc1
s_sub_u32 s37, s37, 1
s_cbranch_scc1 Lend_1
s_branch Lps_441
Lpf_490:
buffer_load_dwordx4 v[36:39], v8, s[4:7], s40 offen offset:2048 sc1
s_branch Lps_467
Lpf_492:
buffer_load_dwordx4 v[32:35], v8, s[4:7], s40 offen offset:1024 sc1
s_sub_u32 s37, s37, 1
s_cbranch_scc1 Lend_1
s_branch Lps_447
Lpf_494:
buffer_load_dwordx4 v[36:39], v8, s[4:7], s40 offen offset:2048 sc1
s_branch Lps_473
Lpf_496:
buffer_load_dwordx4 v[28:31], v8, s[4:7], s40 offen offset:0 sc1
s_sub_u32 s37, s37, 1
s_cbranch_scc1 Lend_1
s_branch Lps_439
Lpf_498:
buffer_load_dwordx4 v[32:35], v8, s[4:7], s40 offen offset:1024 sc1
Lps_501:
s_waitcnt vmcnt(2)
v_max3_u32 v110, v36, v37, v38
v_max_u32 v110, v110, v39
v_cmp_eq_u32 vcc, -1, v110
s_cbranch_vccnz Lpf_502
v_smfmac_f32_16x16x64_bf16 v[44:47], v[36:39], a[64:71], v126
v_smfmac_f32_16x16x64_bf16 v[48:51], v[36:39], a[72:79], v126
v_smfmac_f32_16x16x64_bf16 v[52:55], v[36:39], a[80:87], v126
v_smfmac_f32_16x16x64_bf16 v[60:63], v[36:39], v[192:199], v126
s_branch Lps_463
Lpf_500:
buffer_load_dwordx4 v[32:35], v8, s[4:7], s40 offen offset:1024 sc1
s_branch Lps_461
Lpf_502:
buffer_load_dwordx4 v[36:39], v8, s[4:7], s40 offen offset:2048 sc1
s_branch Lps_481
Lpf_433:
buffer_load_dwordx4 v[28:31], v9, s[4:7], s40 offen offset:0 sc1
s_sub_u32 s37, s37, 1
s_cbranch_scc1 Lend_1
Lps_503:
s_waitcnt vmcnt(3)
v_max3_u32 v110, v32, v33, v34
v_max_u32 v110, v110, v35
v_cmp_eq_u32 vcc, -1, v110
s_cbranch_vccnz Lpf_504
v_smfmac_f32_16x16x64_bf16 v[76:79], v[32:35], a[160:167], v126
v_smfmac_f32_16x16x64_bf16 v[80:83], v[32:35], a[168:175], v126
v_smfmac_f32_16x16x64_bf16 v[84:87], v[32:35], a[176:183], v126
Lps_505:
s_waitcnt vmcnt(2)
v_max3_u32 v110, v36, v37, v38
v_max_u32 v110, v110, v39
v_cmp_eq_u32 vcc, -1, v110
s_cbranch_vccnz Lpf_506
v_smfmac_f32_16x16x64_bf16 v[76:79], v[36:39], a[192:199], v126
v_smfmac_f32_16x16x64_bf16 v[80:83], v[36:39], a[200:207], v126
v_smfmac_f32_16x16x64_bf16 v[84:87], v[36:39], a[208:215], v126
Lps_507:
s_waitcnt vmcnt(1)
v_max3_u32 v110, v40, v41, v42
v_max_u32 v110, v110, v43
v_cmp_eq_u32 vcc, -1, v110
s_cbranch_vccnz Lpf_508
v_smfmac_f32_16x16x64_bf16 v[76:79], v[40:43], a[224:231], v126
v_smfmac_f32_16x16x64_bf16 v[80:83], v[40:43], a[232:239], v126
v_smfmac_f32_16x16x64_bf16 v[84:87], v[40:43], a[240:247], v126
Lps_509:
s_waitcnt vmcnt(0)
v_max3_u32 v110, v28, v29, v30
v_max_u32 v110, v110, v31
v_cmp_eq_u32 vcc, -1, v110
s_cbranch_vccnz Lpf_510
v_smfmac_f32_16x16x64_bf16 v[76:79], v[28:31], a[128:135], v126
s_nop 1
v_smfmac_f32_16x16x64_bf16 v[80:83], v[28:31], a[136:143], v126
s_nop 1
v_smfmac_f32_16x16x64_bf16 v[84:87], v[28:31], a[144:151], v126
s_nop 1
v_add_f32 v92, v76, v78
v_add_f32 v93, v77, v79
v_smfmac_f32_16x16x64_bf16 v[88:91], v[28:31], a[152:159], v126
v_add_f32 v94, v80, v82
v_add_f32 v95, v81, v83
ds_write_b64 v24, v[92:93] offset:12288
v_add_f32 v96, v84, v86
v_add_f32 v97, v85, v87
ds_write_b64 v25, v[94:95] offset:12288
v_smfmac_f32_16x16x64_bf16 v[88:91], v[32:35], a[184:191], v126
ds_write_b64 v26, v[96:97] offset:12288
v_smfmac_f32_16x16x64_bf16 v[88:91], v[36:39], a[216:223], v126
v_smfmac_f32_16x16x64_bf16 v[88:91], v[40:43], a[248:255], v126
s_branch Lpd_432
Lpf_434:
buffer_load_dwordx4 v[32:35], v9, s[4:7], s40 offen offset:1024 sc1
s_sub_u32 s37, s37, 1
s_cbranch_scc1 Lend_1
Lps_511:
s_waitcnt vmcnt(2)
v_max3_u32 v110, v36, v37, v38
v_max_u32 v110, v110, v39
v_cmp_eq_u32 vcc, -1, v110
s_cbranch_vccnz Lpf_512
v_smfmac_f32_16x16x64_bf16 v[76:79], v[36:39], a[192:199], v126
v_smfmac_f32_16x16x64_bf16 v[80:83], v[36:39], a[200:207], v126
v_smfmac_f32_16x16x64_bf16 v[84:87], v[36:39], a[208:215], v126
Lps_513:
s_waitcnt vmcnt(1)
v_max3_u32 v110, v40, v41, v42
v_max_u32 v110, v110, v43
v_cmp_eq_u32 vcc, -1, v110
s_cbranch_vccnz Lpf_514
v_smfmac_f32_16x16x64_bf16 v[76:79], v[40:43], a[224:231], v126
v_smfmac_f32_16x16x64_bf16 v[80:83], v[40:43], a[232:239], v126
v_smfmac_f32_16x16x64_bf16 v[84:87], v[40:43], a[240:247], v126
Lps_515:
s_waitcnt vmcnt(0)
v_max3_u32 v110, v32, v33, v34
v_max_u32 v110, v110, v35
v_cmp_eq_u32 vcc, -1, v110
s_cbranch_vccnz Lpf_516
v_smfmac_f32_16x16x64_bf16 v[76:79], v[32:35], a[160:167], v126
s_nop 1
v_smfmac_f32_16x16x64_bf16 v[80:83], v[32:35], a[168:175], v126
s_nop 1
v_smfmac_f32_16x16x64_bf16 v[84:87], v[32:35], a[176:183], v126
s_nop 1
v_add_f32 v92, v76, v78
v_add_f32 v93, v77, v79
v_smfmac_f32_16x16x64_bf16 v[88:91], v[28:31], a[152:159], v126
v_add_f32 v94, v80, v82
v_add_f32 v95, v81, v83
ds_write_b64 v24, v[92:93] offset:12288
v_add_f32 v96, v84, v86
v_add_f32 v97, v85, v87
ds_write_b64 v25, v[94:95] offset:12288
v_smfmac_f32_16x16x64_bf16 v[88:91], v[32:35], a[184:191], v126
ds_write_b64 v26, v[96:97] offset:12288
v_smfmac_f32_16x16x64_bf16 v[88:91], v[36:39], a[216:223], v126
v_smfmac_f32_16x16x64_bf16 v[88:91], v[40:43], a[248:255], v126
s_branch Lpd_432
Lpf_435:
buffer_load_dwordx4 v[36:39], v9, s[4:7], s40 offen offset:2048 sc1
s_sub_u32 s37, s37, 1
s_cbranch_scc1 Lend_1
Lps_517:
s_waitcnt vmcnt(1)
v_max3_u32 v110, v40, v41, v42
v_max_u32 v110, v110, v43
v_cmp_eq_u32 vcc, -1, v110
s_cbranch_vccnz Lpf_518
v_smfmac_f32_16x16x64_bf16 v[76:79], v[40:43], a[224:231], v126
v_smfmac_f32_16x16x64_bf16 v[80:83], v[40:43], a[232:239], v126
v_smfmac_f32_16x16x64_bf16 v[84:87], v[40:43], a[240:247], v126
Lps_519:
s_waitcnt vmcnt(0)
v_max3_u32 v110, v36, v37, v38
v_max_u32 v110, v110, v39
v_cmp_eq_u32 vcc, -1, v110
s_cbranch_vccnz Lpf_520
v_smfmac_f32_16x16x64_bf16 v[76:79], v[36:39], a[192:199], v126
s_nop 1
v_smfmac_f32_16x16x64_bf16 v[80:83], v[36:39], a[200:207], v126
s_nop 1
v_smfmac_f32_16x16x64_bf16 v[84:87], v[36:39], a[208:215], v126
s_nop 1
v_add_f32 v92, v76, v78
v_add_f32 v93, v77, v79
v_smfmac_f32_16x16x64_bf16 v[88:91], v[28:31], a[152:159], v126
v_add_f32 v94, v80, v82
v_add_f32 v95, v81, v83
ds_write_b64 v24, v[92:93] offset:12288
v_add_f32 v96, v84, v86
v_add_f32 v97, v85, v87
ds_write_b64 v25, v[94:95] offset:12288
v_smfmac_f32_16x16x64_bf16 v[88:91], v[32:35], a[184:191], v126
ds_write_b64 v26, v[96:97] offset:12288
v_smfmac_f32_16x16x64_bf16 v[88:91], v[36:39], a[216:223], v126
v_smfmac_f32_16x16x64_bf16 v[88:91], v[40:43], a[248:255], v126
s_branch Lpd_432
Lpf_436:
buffer_load_dwordx4 v[40:43], v9, s[4:7], s40 offen offset:3072 sc1
s_sub_u32 s37, s37, 1
s_cbranch_scc1 Lend_1
Lps_521:
s_waitcnt vmcnt(0)
v_max3_u32 v110, v40, v41, v42
v_max_u32 v110, v110, v43
v_cmp_eq_u32 vcc, -1, v110
s_cbranch_vccnz Lpf_522
v_smfmac_f32_16x16x64_bf16 v[76:79], v[40:43], a[224:231], v126
s_nop 1
v_smfmac_f32_16x16x64_bf16 v[80:83], v[40:43], a[232:239], v126
s_nop 1
v_smfmac_f32_16x16x64_bf16 v[84:87], v[40:43], a[240:247], v126
s_nop 1
v_add_f32 v92, v76, v78
v_add_f32 v93, v77, v79
v_smfmac_f32_16x16x64_bf16 v[88:91], v[28:31], a[152:159], v126
v_add_f32 v94, v80, v82
v_add_f32 v95, v81, v83
ds_write_b64 v24, v[92:93] offset:12288
v_add_f32 v96, v84, v86
v_add_f32 v97, v85, v87
ds_write_b64 v25, v[94:95] offset:12288
v_smfmac_f32_16x16x64_bf16 v[88:91], v[32:35], a[184:191], v126
ds_write_b64 v26, v[96:97] offset:12288
v_smfmac_f32_16x16x64_bf16 v[88:91], v[36:39], a[216:223], v126
v_smfmac_f32_16x16x64_bf16 v[88:91], v[40:43], a[248:255], v126
s_branch Lpd_432
Lpf_504:
buffer_load_dwordx4 v[32:35], v9, s[4:7], s40 offen offset:1024 sc1
Lps_523:
s_waitcnt vmcnt(3)
v_max3_u32 v110, v36, v37, v38
v_max_u32 v110, v110, v39
v_cmp_eq_u32 vcc, -1, v110
s_cbranch_vccnz Lpf_524
v_smfmac_f32_16x16x64_bf16 v[76:79], v[36:39], a[192:199], v126
v_smfmac_f32_16x16x64_bf16 v[80:83], v[36:39], a[200:207], v126
v_smfmac_f32_16x16x64_bf16 v[84:87], v[36:39], a[208:215], v126
Lps_525:
s_waitcnt vmcnt(2)
v_max3_u32 v110, v40, v41, v42
v_max_u32 v110, v110, v43
v_cmp_eq_u32 vcc, -1, v110
s_cbranch_vccnz Lpf_526
v_smfmac_f32_16x16x64_bf16 v[76:79], v[40:43], a[224:231], v126
v_smfmac_f32_16x16x64_bf16 v[80:83], v[40:43], a[232:239], v126
v_smfmac_f32_16x16x64_bf16 v[84:87], v[40:43], a[240:247], v126
Lps_527:
s_waitcnt vmcnt(1)
v_max3_u32 v110, v28, v29, v30
v_max_u32 v110, v110, v31
v_cmp_eq_u32 vcc, -1, v110
s_cbranch_vccnz Lpf_528
v_smfmac_f32_16x16x64_bf16 v[76:79], v[28:31], a[128:135], v126
v_smfmac_f32_16x16x64_bf16 v[80:83], v[28:31], a[136:143], v126
v_smfmac_f32_16x16x64_bf16 v[84:87], v[28:31], a[144:151], v126
s_branch Lps_515
Lpf_506:
buffer_load_dwordx4 v[36:39], v9, s[4:7], s40 offen offset:2048 sc1
Lps_529:
s_waitcnt vmcnt(2)
v_max3_u32 v110, v40, v41, v42
v_max_u32 v110, v110, v43
v_cmp_eq_u32 vcc, -1, v110
s_cbranch_vccnz Lpf_530
v_smfmac_f32_16x16x64_bf16 v[76:79], v[40:43], a[224:231], v126
v_smfmac_f32_16x16x64_bf16 v[80:83], v[40:43], a[232:239], v126
v_smfmac_f32_16x16x64_bf16 v[84:87], v[40:43], a[240:247], v126
Lps_531:
s_waitcnt vmcnt(1)
v_max3_u32 v110, v28, v29, v30
v_max_u32 v110, v110, v31
v_cmp_eq_u32 vcc, -1, v110
s_cbranch_vccnz Lpf_532
v_smfmac_f32_16x16x64_bf16 v[76:79], v[28:31], a[128:135], v126
v_smfmac_f32_16x16x64_bf16 v[80:83], v[28:31], a[136:143], v126
v_smfmac_f32_16x16x64_bf16 v[84:87], v[28:31], a[144:151], v126
s_branch Lps_519
Lpf_508:
buffer_load_dwordx4 v[40:43], v9, s[4:7], s40 offen offset:3072 sc1
Lps_533:
s_waitcnt vmcnt(1)
v_max3_u32 v110, v28, v29, v30
v_max_u32 v110, v110, v31
v_cmp_eq_u32 vcc, -1, v110
s_cbranch_vccnz Lpf_534
v_smfmac_f32_16x16x64_bf16 v[76:79], v[28:31], a[128:135], v126
v_smfmac_f32_16x16x64_bf16 v[80:83], v[28:31], a[136:143], v126
v_smfmac_f32_16x16x64_bf16 v[84:87], v[28:31], a[144:151], v126
s_branch Lps_521
Lpf_510:
buffer_load_dwordx4 v[28:31], v9, s[4:7], s40 offen offset:0 sc1
s_sub_u32 s37, s37, 1
s_cbranch_scc1 Lend_1
s_branch Lps_509
Lpf_512:
buffer_load_dwordx4 v[36:39], v9, s[4:7], s40 offen offset:2048 sc1
Lps_535:
s_waitcnt vmcnt(2)
v_max3_u32 v110, v40, v41, v42
v_max_u32 v110, v110, v43
v_cmp_eq_u32 vcc, -1, v110
s_cbranch_vccnz Lpf_536
v_smfmac_f32_16x16x64_bf16 v[76:79], v[40:43], a[224:231], v126
v_smfmac_f32_16x16x64_bf16 v[80:83], v[40:43], a[232:239], v126
v_smfmac_f32_16x16x64_bf16 v[84:87], v[40:43], a[240:247], v126
Lps_537:
s_waitcnt vmcnt(1)
v_max3_u32 v110, v32, v33, v34
v_max_u32 v110, v110, v35
v_cmp_eq_u32 vcc, -1, v110
s_cbranch_vccnz Lpf_538
v_smfmac_f32_16x16x64_bf16 v[76:79], v[32:35], a[160:167], v126
v_smfmac_f32_16x16x64_bf16 v[80:83], v[32:35], a[168:175], v126
v_smfmac_f32_16x16x64_bf16 v[84:87], v[32:35], a[176:183], v126
s_branch Lps_519
Lpf_514:
buffer_load_dwordx4 v[40:43], v9, s[4:7], s40 offen offset:3072 sc1
Lps_539:
s_waitcnt vmcnt(1)
v_max3_u32 v110, v32, v33, v34
v_max_u32 v110, v110, v35
v_cmp_eq_u32 vcc, -1, v110
s_cbranch_vccnz Lpf_540
v_smfmac_f32_16x16x64_bf16 v[76:79], v[32:35], a[160:167], v126
v_smfmac_f32_16x16x64_bf16 v[80:83], v[32:35], a[168:175], v126
v_smfmac_f32_16x16x64_bf16 v[84:87], v[32:35], a[176:183], v126
s_branch Lps_521
Lpf_516:
buffer_load_dwordx4 v[32:35], v9, s[4:7], s40 offen offset:1024 sc1
s_sub_u32 s37, s37, 1
s_cbranch_scc1 Lend_1
s_branch Lps_515
Lpf_518:
buffer_load_dwordx4 v[40:43], v9, s[4:7], s40 offen offset:3072 sc1
Lps_541:
s_waitcnt vmcnt(1)
v_max3_u32 v110, v36, v37, v38
v_max_u32 v110, v110, v39
v_cmp_eq_u32 vcc, -1, v110
s_cbranch_vccnz Lpf_542
v_smfmac_f32_16x16x64_bf16 v[76:79], v[36:39], a[192:199], v126
v_smfmac_f32_16x16x64_bf16 v[80:83], v[36:39], a[200:207], v126
v_smfmac_f32_16x16x64_bf16 v[84:87], v[36:39], a[208:215], v126
s_branch Lps_521
Lpf_520:
buffer_load_dwordx4 v[36:39], v9, s[4:7], s40 offen offset:2048 sc1
s_sub_u32 s37, s37, 1
s_cbranch_scc1 Lend_1
s_branch Lps_519
Lpf_522:
buffer_load_dwordx4 v[40:43], v9, s[4:7], s40 offen offset:3072 sc1
s_sub_u32 s37, s37, 1
s_cbranch_scc1 Lend_1
s_branch Lps_521
Lpf_524:
buffer_load_dwordx4 v[36:39], v9, s[4:7], s40 offen offset:2048 sc1
Lps_543:
s_waitcnt vmcnt(3)
v_max3_u32 v110, v40, v41, v42
v_max_u32 v110, v110, v43
v_cmp_eq_u32 vcc, -1, v110
s_cbranch_vccnz Lpf_544
v_smfmac_f32_16x16x64_bf16 v[76:79], v[40:43], a[224:231], v126
v_smfmac_f32_16x16x64_bf16 v[80:83], v[40:43], a[232:239], v126
v_smfmac_f32_16x16x64_bf16 v[84:87], v[40:43], a[240:247], v126
Lps_545:
s_waitcnt vmcnt(2)
v_max3_u32 v110, v28, v29, v30
v_max_u32 v110, v110, v31
v_cmp_eq_u32 vcc, -1, v110
s_cbranch_vccnz Lpf_546
v_smfmac_f32_16x16x64_bf16 v[76:79], v[28:31], a[128:135], v126
v_smfmac_f32_16x16x64_bf16 v[80:83], v[28:31], a[136:143], v126
v_smfmac_f32_16x16x64_bf16 v[84:87], v[28:31], a[144:151], v126
s_branch Lps_537
Lpf_526:
buffer_load_dwordx4 v[40:43], v9, s[4:7], s40 offen offset:3072 sc1
Lps_547:
s_waitcnt vmcnt(2)
v_max3_u32 v110, v28, v29, v30
v_max_u32 v110, v110, v31
v_cmp_eq_u32 vcc, -1, v110
s_cbranch_vccnz Lpf_548
v_smfmac_f32_16x16x64_bf16 v[76:79], v[28:31], a[128:135], v126
v_smfmac_f32_16x16x64_bf16 v[80:83], v[28:31], a[136:143], v126
v_smfmac_f32_16x16x64_bf16 v[84:87], v[28:31], a[144:151], v126
s_branch Lps_539
Lpf_528:
buffer_load_dwordx4 v[28:31], v9, s[4:7], s40 offen offset:0 sc1
s_sub_u32 s37, s37, 1
s_cbranch_scc1 Lend_1
Lps_549:
s_waitcnt vmcnt(1)
v_max3_u32 v110, v32, v33, v34
v_max_u32 v110, v110, v35
v_cmp_eq_u32 vcc, -1, v110
s_cbranch_vccnz Lpf_550
v_smfmac_f32_16x16x64_bf16 v[76:79], v[32:35], a[160:167], v126
v_smfmac_f32_16x16x64_bf16 v[80:83], v[32:35], a[168:175], v126
v_smfmac_f32_16x16x64_bf16 v[84:87], v[32:35], a[176:183], v126
s_branch Lps_509
Lpf_530:
buffer_load_dwordx4 v[40:43], v9, s[4:7], s40 offen offset:3072 sc1
Lps_551:
s_waitcnt vmcnt(2)
v_max3_u32 v110, v28, v29, v30
v_max_u32 v110, v110, v31
v_cmp_eq_u32 vcc, -1, v110
s_cbranch_vccnz Lpf_552
v_smfmac_f32_16x16x64_bf16 v[76:79], v[28:31], a[128:135], v126
v_smfmac_f32_16x16x64_bf16 v[80:83], v[28:31], a[136:143], v126
v_smfmac_f32_16x16x64_bf16 v[84:87], v[28:31], a[144:151], v126
s_branch Lps_541
Lpf_532:
buffer_load_dwordx4 v[28:31], v9, s[4:7], s40 offen offset:0 sc1
s_sub_u32 s37, s37, 1
s_cbranch_scc1 Lend_1
Lps_553:
s_waitcnt vmcnt(1)
v_max3_u32 v110, v36, v37, v38
v_max_u32 v110, v110, v39
v_cmp_eq_u32 vcc, -1, v110
s_cbranch_vccnz Lpf_554
v_smfmac_f32_16x16x64_bf16 v[76:79], v[36:39], a[192:199], v126
v_smfmac_f32_16x16x64_bf16 v[80:83], v[36:39], a[200:207], v126
v_smfmac_f32_16x16x64_bf16 v[84:87], v[36:39], a[208:215], v126
s_branch Lps_509
Lpf_534:
buffer_load_dwordx4 v[28:31], v9, s[4:7], s40 offen offset:0 sc1
s_sub_u32 s37, s37, 1
s_cbranch_scc1 Lend_1
s_branch Lps_507
Lpf_536:
buffer_load_dwordx4 v[40:43], v9, s[4:7], s40 offen offset:3072 sc1
Lps_555:
s_waitcnt vmcnt(2)
v_max3_u32 v110, v32, v33, v34
v_max_u32 v110, v110, v35
v_cmp_eq_u32 vcc, -1, v110
s_cbranch_vccnz Lpf_556
v_smfmac_f32_16x16x64_bf16 v[76:79], v[32:35], a[160:167], v126
v_smfmac_f32_16x16x64_bf16 v[80:83], v[32:35], a[168:175], v126
v_smfmac_f32_16x16x64_bf16 v[84:87], v[32:35], a[176:183], v126
s_branch Lps_541
Lpf_538:
buffer_load_dwordx4 v[32:35], v9, s[4:7], s40 offen offset:1024 sc1
s_sub_u32 s37, s37, 1
s_cbranch_scc1 Lend_1
Lps_557:
s_waitcnt vmcnt(1)
v_max3_u32 v110, v36, v37, v38
v_max_u32 v110, v110, v39
v_cmp_eq_u32 vcc, -1, v110
s_cbranch_vccnz Lpf_558
v_smfmac_f32_16x16x64_bf16 v[76:79], v[36:39], a[192:199], v126
v_smfmac_f32_16x16x64_bf16 v[80:83], v[36:39], a[200:207], v126
v_smfmac_f32_16x16x64_bf16 v[84:87], v[36:39], a[208:215], v126
s_branch Lps_515
Lpf_540:
buffer_load_dwordx4 v[32:35], v9, s[4:7], s40 offen offset:1024 sc1
s_sub_u32 s37, s37, 1
s_cbranch_scc1 Lend_1
s_branch Lps_513
Lpf_542:
buffer_load_dwordx4 v[36:39], v9, s[4:7], s40 offen offset:2048 sc1
s_sub_u32 s37, s37, 1
s_cbranch_scc1 Lend_1
s_branch Lps_517
Lpf_544:
buffer_load_dwordx4 v[40:43], v9, s[4:7], s40 offen offset:3072 sc1
Lps_559:
s_waitcnt vmcnt(3)
v_max3_u32 v110, v28, v29, v30
v_max_u32 v110, v110, v31
v_cmp_eq_u32 vcc, -1, v110
s_cbranch_vccnz Lpf_560
v_smfmac_f32_16x16x64_bf16 v[76:79], v[28:31], a[128:135], v126
v_smfmac_f32_16x16x64_bf16 v[80:83], v[28:31], a[136:143], v126
v_smfmac_f32_16x16x64_bf16 v[84:87], v[28:31], a[144:151], v126
s_branch Lps_555
Lpf_546:
buffer_load_dwordx4 v[28:31], v9, s[4:7], s40 offen offset:0 sc1
s_sub_u32 s37, s37, 1
s_cbranch_scc1 Lend_1
Lps_561:
s_waitcnt vmcnt(2)
v_max3_u32 v110, v32, v33, v34
v_max_u32 v110, v110, v35
v_cmp_eq_u32 vcc, -1, v110
s_cbranch_vccnz Lpf_562
v_smfmac_f32_16x16x64_bf16 v[76:79], v[32:35], a[160:167], v126
v_smfmac_f32_16x16x64_bf16 v[80:83], v[32:35], a[168:175], v126
v_smfmac_f32_16x16x64_bf16 v[84:87], v[32:35], a[176:183], v126
s_branch Lps_553
Lpf_548:
buffer_load_dwordx4 v[28:31], v9, s[4:7], s40 offen offset:0 sc1
s_sub_u32 s37, s37, 1
s_cbranch_scc1 Lend_1
Lps_563:
s_waitcnt vmcnt(2)
v_max3_u32 v110, v32, v33, v34
v_max_u32 v110, v110, v35
v_cmp_eq_u32 vcc, -1, v110
s_cbranch_vccnz Lpf_564
v_smfmac_f32_16x16x64_bf16 v[76:79], v[32:35], a[160:167], v126
v_smfmac_f32_16x16x64_bf16 v[80:83], v[32:35], a[168:175], v126
v_smfmac_f32_16x16x64_bf16 v[84:87], v[32:35], a[176:183], v126
s_branch Lps_507
Lpf_550:
buffer_load_dwordx4 v[32:35], v9, s[4:7], s40 offen offset:1024 sc1
s_branch Lps_527
Lpf_552:
buffer_load_dwordx4 v[28:31], v9, s[4:7], s40 offen offset:0 sc1
s_sub_u32 s37, s37, 1
s_cbranch_scc1 Lend_1
s_branch Lps_505
Lpf_554:
buffer_load_dwordx4 v[36:39], v9, s[4:7], s40 offen offset:2048 sc1
s_branch Lps_531
Lpf_556:
buffer_load_dwordx4 v[32:35], v9, s[4:7], s40 offen offset:1024 sc1
s_sub_u32 s37, s37, 1
s_cbranch_scc1 Lend_1
s_branch Lps_511
Lpf_558:
buffer_load_dwordx4 v[36:39], v9, s[4:7], s40 offen offset:2048 sc1
s_branch Lps_537
Lpf_560:
buffer_load_dwordx4 v[28:31], v9, s[4:7], s40 offen offset:0 sc1
s_sub_u32 s37, s37, 1
s_cbranch_scc1 Lend_1
s_branch Lps_503
Lpf_562:
buffer_load_dwordx4 v[32:35], v9, s[4:7], s40 offen offset:1024 sc1
Lps_565:
s_waitcnt vmcnt(2)
v_max3_u32 v110, v36, v37, v38
v_max_u32 v110, v110, v39
v_cmp_eq_u32 vcc, -1, v110
s_cbranch_vccnz Lpf_566
v_smfmac_f32_16x16x64_bf16 v[76:79], v[36:39], a[192:199], v126
v_smfmac_f32_16x16x64_bf16 v[80:83], v[36:39], a[200:207], v126
v_smfmac_f32_16x16x64_bf16 v[84:87], v[36:39], a[208:215], v126
s_branch Lps_527
Lpf_564:
buffer_load_dwordx4 v[32:35], v9, s[4:7], s40 offen offset:1024 sc1
s_branch Lps_525
Lpf_566:
buffer_load_dwordx4 v[36:39], v9, s[4:7], s40 offen offset:2048 sc1
s_branch Lps_545
Lg3_3:
v_mov_b32 v9, v1
s_sub_u32 s26, s34, 24
s_lshl_b32 s44, s33, 3
s_add_u32 s44, s44, s26
s_lshl_b32 s38, s44, 7
s_add_u32 s38, s38, 3440640
v_min_u32 v80, 1, v0
v_lshl_add_u32 v4, v80, 30, s38
v_mov_b32 v5, 0
buffer_store_dword v5, v4, s[4:7], 0 offen sc1
s_mov_b32 s52, 1
s_mov_b32 s38, 4096
buffer_store_dword v5, v4, s[4:7], s38 offen sc1
s_mov_b32 s38, 8192
buffer_store_dword v5, v4, s[4:7], s38 offen sc1
s_lshl_b32 s38, s44, 7
s_add_u32 s38, s38, 3436544
v_min_u32 v80, 1, v0
v_lshl_add_u32 v7, v80, 30, s38
buffer_store_dword v5, v7, s[4:7], 0 offen sc1
s_lshl_b32 s38, s35, 16
s_or_b32 s52, s52, s38
s_waitcnt vmcnt(0)
s_cmp_lg_u32 s32, 0
s_cbranch_scc1 Lar_568
s_mov_b64 exec, 1
v_mov_b32 v48, 16
v_mov_b32 v49, s52
buffer_atomic_add v49, v48, s[12:15], 0 offen sc1
s_mov_b64 exec, -1
Lar_568:
s_mov_b32 s8, s24
s_and_b32 s9, s25, 0xffff
s_mov_b32 s10, 0x800000
s_mov_b32 s11, 0x20000
s_lshl_b32 s60, s33, 21
s_lshl_b32 s38, s26, 8
s_add_u32 s60, s60, s38
s_add_u32 s61, s60, 128
s_lshr_b32 s52, s32, 1
s_lshl_b32 s52, s52, 14
s_and_b32 s53, s32, 1
s_lshl_b32 s53, s53, 6
s_add_u32 s52, s52, s53
v_bfe_u32 v84, v9, 2, 2
v_lshrrev_b32 v85, 4, v9
v_lshl_add_u32 v84, v85, 2, v84
v_lshl_add_u32 v84, v84, 7, s52
v_and_b32 v85, 3, v9
v_lshl_add_u32 v84, v85, 4, v84
v_add_u32 v80, 0, v84
v_bfe_u32 v84, v9, 2, 2
v_lshrrev_b32 v85, 4, v9
v_lshl_add_u32 v84, v85, 2, v84
v_lshl_add_u32 v84, v84, 7, s52
v_and_b32 v85, 3, v9
v_lshl_add_u32 v84, v85, 4, v84
v_add_u32 v81, 8, v84
v_lshrrev_b32 v84, 3, v9
s_mul_i32 s38, s32, 256
v_add_u32 v84, s38, v84
v_mul_u32_u24 v84, 2048, v84
v_and_b32 v85, 7, v9
v_lshl_add_u32 v84, v85, 4, v84
s_lshl_b32 s38, s32, 12
s_barrier
s_add_u32 m0, s38, 0
s_add_u32 s39, s60, 0
buffer_load_dwordx4 v84, s[8:11], s39 offen lds
s_add_u32 m0, s38, 1024
s_add_u32 s39, s60, 16384
buffer_load_dwordx4 v84, s[8:11], s39 offen lds
s_add_u32 m0, s38, 2048
s_add_u32 s39, s60, 32768
buffer_load_dwordx4 v84, s[8:11], s39 offen lds
s_add_u32 m0, s38, 3072
s_add_u32 s39, s60, 49152
buffer_load_dwordx4 v84, s[8:11], s39 offen lds
s_add_u32 m0, s38, 16384
s_add_u32 s39, s61, 0
buffer_load_dwordx4 v84, s[8:11], s39 offen lds
s_add_u32 m0, s38, 17408
s_add_u32 s39, s61, 16384
buffer_load_dwordx4 v84, s[8:11], s39 offen lds
s_add_u32 m0, s38, 18432
s_add_u32 s39, s61, 32768
buffer_load_dwordx4 v84, s[8:11], s39 offen lds
s_add_u32 m0, s38, 19456
s_add_u32 s39, s61, 49152
buffer_load_dwordx4 v84, s[8:11], s39 offen lds
s_add_u32 m0, s38, 32768
s_add_u32 s39, s60, 65536
buffer_load_dwordx4 v84, s[8:11], s39 offen lds
s_add_u32 m0, s38, 33792
s_add_u32 s39, s60, 81920
buffer_load_dwordx4 v84, s[8:11], s39 offen lds
s_add_u32 m0, s38, 34816
s_add_u32 s39, s60, 98304
buffer_load_dwordx4 v84, s[8:11], s39 offen lds
s_add_u32 m0, s38, 35840
s_add_u32 s39, s60, 114688
buffer_load_dwordx4 v84, s[8:11], s39 offen lds
s_add_u32 m0, s38, 49152
s_add_u32 s39, s61, 65536
buffer_load_dwordx4 v84, s[8:11], s39 offen lds
s_add_u32 m0, s38, 50176
s_add_u32 s39, s61, 81920
buffer_load_dwordx4 v84, s[8:11], s39 offen lds
s_add_u32 m0, s38, 51200
s_add_u32 s39, s61, 98304
buffer_load_dwordx4 v84, s[8:11], s39 offen lds
s_add_u32 m0, s38, 52224
s_add_u32 s39, s61, 114688
buffer_load_dwordx4 v84, s[8:11], s39 offen lds
s_add_u32 m0, s38, 65536
s_add_u32 s39, s60, 131072
buffer_load_dwordx4 v84, s[8:11], s39 offen lds
s_add_u32 m0, s38, 66560
s_add_u32 s39, s60, 147456
buffer_load_dwordx4 v84, s[8:11], s39 offen lds
s_add_u32 m0, s38, 67584
s_add_u32 s39, s60, 163840
buffer_load_dwordx4 v84, s[8:11], s39 offen lds
s_add_u32 m0, s38, 68608
s_add_u32 s39, s60, 180224
buffer_load_dwordx4 v84, s[8:11], s39 offen lds
s_add_u32 m0, s38, 81920
s_add_u32 s39, s61, 131072
buffer_load_dwordx4 v84, s[8:11], s39 offen lds
s_add_u32 m0, s38, 82944
s_add_u32 s39, s61, 147456
buffer_load_dwordx4 v84, s[8:11], s39 offen lds
s_add_u32 m0, s38, 83968
s_add_u32 s39, s61, 163840
buffer_load_dwordx4 v84, s[8:11], s39 offen lds
s_add_u32 m0, s38, 84992
s_add_u32 s39, s61, 180224
buffer_load_dwordx4 v84, s[8:11], s39 offen lds
s_add_u32 m0, s38, 98304
s_add_u32 s39, s60, 196608
buffer_load_dwordx4 v84, s[8:11], s39 offen lds
s_add_u32 m0, s38, 99328
s_add_u32 s39, s60, 212992
buffer_load_dwordx4 v84, s[8:11], s39 offen lds
s_add_u32 m0, s38, 100352
s_add_u32 s39, s60, 229376
buffer_load_dwordx4 v84, s[8:11], s39 offen lds
s_add_u32 m0, s38, 101376
s_add_u32 s39, s60, 245760
buffer_load_dwordx4 v84, s[8:11], s39 offen lds
s_add_u32 m0, s38, 114688
s_add_u32 s39, s61, 196608
buffer_load_dwordx4 v84, s[8:11], s39 offen lds
s_add_u32 m0, s38, 115712
s_add_u32 s39, s61, 212992
buffer_load_dwordx4 v84, s[8:11], s39 offen lds
s_add_u32 m0, s38, 116736
s_add_u32 s39, s61, 229376
buffer_load_dwordx4 v84, s[8:11], s39 offen lds
s_add_u32 m0, s38, 117760
s_add_u32 s39, s61, 245760
buffer_load_dwordx4 v84, s[8:11], s39 offen lds
s_add_u32 m0, s38, 131072
s_add_u32 s39, s60, 262144
buffer_load_dwordx4 v84, s[8:11], s39 offen lds
s_add_u32 m0, s38, 132096
s_add_u32 s39, s60, 278528
buffer_load_dwordx4 v84, s[8:11], s39 offen lds
s_add_u32 m0, s38, 133120
s_add_u32 s39, s60, 294912
buffer_load_dwordx4 v84, s[8:11], s39 offen lds
s_add_u32 m0, s38, 134144
s_add_u32 s39, s60, 311296
buffer_load_dwordx4 v84, s[8:11], s39 offen lds
s_add_u32 m0, s38, 147456
s_add_u32 s39, s61, 262144
buffer_load_dwordx4 v84, s[8:11], s39 offen lds
s_add_u32 m0, s38, 148480
s_add_u32 s39, s61, 278528
buffer_load_dwordx4 v84, s[8:11], s39 offen lds
s_add_u32 m0, s38, 149504
s_add_u32 s39, s61, 294912
buffer_load_dwordx4 v84, s[8:11], s39 offen lds
s_add_u32 m0, s38, 150528
s_add_u32 s39, s61, 311296
buffer_load_dwordx4 v84, s[8:11], s39 offen lds
s_waitcnt vmcnt(32)
s_barrier
ds_read_b64_tr_b16 a[0:1], v80 offset:0
ds_read_b64_tr_b16 a[2:3], v80 offset:2048
ds_read_b64_tr_b16 a[32:33], v80 offset:4096
ds_read_b64_tr_b16 a[34:35], v80 offset:6144
ds_read_b64_tr_b16 a[64:65], v80 offset:8192
ds_read_b64_tr_b16 a[66:67], v80 offset:10240
ds_read_b64_tr_b16 a[96:97], v80 offset:12288
ds_read_b64_tr_b16 a[98:99], v80 offset:14336
ds_read_b64_tr_b16 a[128:129], v81 offset:0
ds_read_b64_tr_b16 a[130:131], v81 offset:2048
ds_read_b64_tr_b16 a[160:161], v81 offset:4096
ds_read_b64_tr_b16 a[162:163], v81 offset:6144
ds_read_b64_tr_b16 a[192:193], v81 offset:8192
ds_read_b64_tr_b16 a[194:195], v81 offset:10240
ds_read_b64_tr_b16 a[224:225], v81 offset:12288
ds_read_b64_tr_b16 a[226:227], v81 offset:14336
v_add_u32 v80, 32768, v80
v_add_u32 v81, 32768, v81
s_waitcnt lgkmcnt(0)
s_barrier
s_add_u32 m0, s38, 0
s_add_u32 s39, s60, 327680
buffer_load_dwordx4 v84, s[8:11], s39 offen lds
s_add_u32 m0, s38, 1024
s_add_u32 s39, s60, 344064
buffer_load_dwordx4 v84, s[8:11], s39 offen lds
s_add_u32 m0, s38, 2048
s_add_u32 s39, s60, 360448
buffer_load_dwordx4 v84, s[8:11], s39 offen lds
s_add_u32 m0, s38, 3072
s_add_u32 s39, s60, 376832
buffer_load_dwordx4 v84, s[8:11], s39 offen lds
s_add_u32 m0, s38, 16384
s_add_u32 s39, s61, 327680
buffer_load_dwordx4 v84, s[8:11], s39 offen lds
s_add_u32 m0, s38, 17408
s_add_u32 s39, s61, 344064
buffer_load_dwordx4 v84, s[8:11], s39 offen lds
s_add_u32 m0, s38, 18432
s_add_u32 s39, s61, 360448
buffer_load_dwordx4 v84, s[8:11], s39 offen lds
s_add_u32 m0, s38, 19456
s_add_u32 s39, s61, 376832
buffer_load_dwordx4 v84, s[8:11], s39 offen lds
s_waitcnt vmcnt(32)
s_barrier
ds_read_b64_tr_b16 a[4:5], v80 offset:0
ds_read_b64_tr_b16 a[6:7], v80 offset:2048
ds_read_b64_tr_b16 a[36:37], v80 offset:4096
ds_read_b64_tr_b16 a[38:39], v80 offset:6144
ds_read_b64_tr_b16 a[68:69], v80 offset:8192
ds_read_b64_tr_b16 a[70:71], v80 offset:10240
ds_read_b64_tr_b16 a[100:101], v80 offset:12288
ds_read_b64_tr_b16 a[102:103], v80 offset:14336
ds_read_b64_tr_b16 a[132:133], v81 offset:0
ds_read_b64_tr_b16 a[134:135], v81 offset:2048
ds_read_b64_tr_b16 a[164:165], v81 offset:4096
ds_read_b64_tr_b16 a[166:167], v81 offset:6144
ds_read_b64_tr_b16 a[196:197], v81 offset:8192
ds_read_b64_tr_b16 a[198:199], v81 offset:10240
ds_read_b64_tr_b16 a[228:229], v81 offset:12288
ds_read_b64_tr_b16 a[230:231], v81 offset:14336
v_add_u32 v80, 32768, v80
v_add_u32 v81, 32768, v81
s_waitcnt lgkmcnt(0)
s_barrier
s_add_u32 m0, s38, 32768
s_add_u32 s39, s60, 393216
buffer_load_dwordx4 v84, s[8:11], s39 offen lds
s_add_u32 m0, s38, 33792
s_add_u32 s39, s60, 409600
buffer_load_dwordx4 v84, s[8:11], s39 offen lds
s_add_u32 m0, s38, 34816
s_add_u32 s39, s60, 425984
buffer_load_dwordx4 v84, s[8:11], s39 offen lds
s_add_u32 m0, s38, 35840
s_add_u32 s39, s60, 442368
buffer_load_dwordx4 v84, s[8:11], s39 offen lds
s_add_u32 m0, s38, 49152
s_add_u32 s39, s61, 393216
buffer_load_dwordx4 v84, s[8:11], s39 offen lds
s_add_u32 m0, s38, 50176
s_add_u32 s39, s61, 409600
buffer_load_dwordx4 v84, s[8:11], s39 offen lds
s_add_u32 m0, s38, 51200
s_add_u32 s39, s61, 425984
buffer_load_dwordx4 v84, s[8:11], s39 offen lds
s_add_u32 m0, s38, 52224
s_add_u32 s39, s61, 442368
buffer_load_dwordx4 v84, s[8:11], s39 offen lds
s_waitcnt vmcnt(32)
s_barrier
ds_read_b64_tr_b16 a[8:9], v80 offset:0
ds_read_b64_tr_b16 a[10:11], v80 offset:2048
ds_read_b64_tr_b16 a[40:41], v80 offset:4096
ds_read_b64_tr_b16 a[42:43], v80 offset:6144
ds_read_b64_tr_b16 a[72:73], v80 offset:8192
ds_read_b64_tr_b16 a[74:75], v80 offset:10240
ds_read_b64_tr_b16 a[104:105], v80 offset:12288
ds_read_b64_tr_b16 a[106:107], v80 offset:14336
ds_read_b64_tr_b16 a[136:137], v81 offset:0
ds_read_b64_tr_b16 a[138:139], v81 offset:2048
ds_read_b64_tr_b16 a[168:169], v81 offset:4096
ds_read_b64_tr_b16 a[170:171], v81 offset:6144
ds_read_b64_tr_b16 a[200:201], v81 offset:8192
ds_read_b64_tr_b16 a[202:203], v81 offset:10240
ds_read_b64_tr_b16 a[232:233], v81 offset:12288
ds_read_b64_tr_b16 a[234:235], v81 offset:14336
v_add_u32 v80, 32768, v80
v_add_u32 v81, 32768, v81
s_waitcnt lgkmcnt(0)
s_barrier
s_add_u32 m0, s38, 65536
s_add_u32 s39, s60, 458752
buffer_load_dwordx4 v84, s[8:11], s39 offen lds
s_add_u32 m0, s38, 66560
s_add_u32 s39, s60, 475136
buffer_load_dwordx4 v84, s[8:11], s39 offen lds
s_add_u32 m0, s38, 67584
s_add_u32 s39, s60, 491520
buffer_load_dwordx4 v84, s[8:11], s39 offen lds
s_add_u32 m0, s38, 68608
s_add_u32 s39, s60, 507904
buffer_load_dwordx4 v84, s[8:11], s39 offen lds
s_add_u32 m0, s38, 81920
s_add_u32 s39, s61, 458752
buffer_load_dwordx4 v84, s[8:11], s39 offen lds
s_add_u32 m0, s38, 82944
s_add_u32 s39, s61, 475136
buffer_load_dwordx4 v84, s[8:11], s39 offen lds
s_add_u32 m0, s38, 83968
s_add_u32 s39, s61, 491520
buffer_load_dwordx4 v84, s[8:11], s39 offen lds
s_add_u32 m0, s38, 84992
s_add_u32 s39, s61, 507904
buffer_load_dwordx4 v84, s[8:11], s39 offen lds
s_waitcnt vmcnt(32)
s_barrier
ds_read_b64_tr_b16 a[12:13], v80 offset:0
ds_read_b64_tr_b16 a[14:15], v80 offset:2048
ds_read_b64_tr_b16 a[44:45], v80 offset:4096
ds_read_b64_tr_b16 a[46:47], v80 offset:6144
ds_read_b64_tr_b16 a[76:77], v80 offset:8192
ds_read_b64_tr_b16 a[78:79], v80 offset:10240
ds_read_b64_tr_b16 a[108:109], v80 offset:12288
ds_read_b64_tr_b16 a[110:111], v80 offset:14336
ds_read_b64_tr_b16 a[140:141], v81 offset:0
ds_read_b64_tr_b16 a[142:143], v81 offset:2048
ds_read_b64_tr_b16 a[172:173], v81 offset:4096
ds_read_b64_tr_b16 a[174:175], v81 offset:6144
ds_read_b64_tr_b16 a[204:205], v81 offset:8192
ds_read_b64_tr_b16 a[206:207], v81 offset:10240
ds_read_b64_tr_b16 a[236:237], v81 offset:12288
ds_read_b64_tr_b16 a[238:239], v81 offset:14336
v_add_u32 v80, 32768, v80
v_add_u32 v81, 32768, v81
s_waitcnt lgkmcnt(0)
s_barrier
s_waitcnt vmcnt(24)
s_barrier
ds_read_b64_tr_b16 a[16:17], v80 offset:0
ds_read_b64_tr_b16 a[18:19], v80 offset:2048
ds_read_b64_tr_b16 a[48:49], v80 offset:4096
ds_read_b64_tr_b16 a[50:51], v80 offset:6144
ds_read_b64_tr_b16 a[80:81], v80 offset:8192
ds_read_b64_tr_b16 a[82:83], v80 offset:10240
ds_read_b64_tr_b16 a[112:113], v80 offset:12288
ds_read_b64_tr_b16 a[114:115], v80 offset:14336
ds_read_b64_tr_b16 a[144:145], v81 offset:0
ds_read_b64_tr_b16 a[146:147], v81 offset:2048
ds_read_b64_tr_b16 a[176:177], v81 offset:4096
ds_read_b64_tr_b16 a[178:179], v81 offset:6144
ds_read_b64_tr_b16 a[208:209], v81 offset:8192
ds_read_b64_tr_b16 a[210:211], v81 offset:10240
ds_read_b64_tr_b16 a[240:241], v81 offset:12288
ds_read_b64_tr_b16 a[242:243], v81 offset:14336
v_add_u32 v80, -131072, v80
v_add_u32 v81, -131072, v81
s_waitcnt lgkmcnt(0)
s_barrier
s_waitcnt vmcnt(16)
s_barrier
ds_read_b64_tr_b16 a[20:21], v80 offset:0
ds_read_b64_tr_b16 a[22:23], v80 offset:2048
ds_read_b64_tr_b16 a[52:53], v80 offset:4096
ds_read_b64_tr_b16 a[54:55], v80 offset:6144
ds_read_b64_tr_b16 a[84:85], v80 offset:8192
ds_read_b64_tr_b16 a[86:87], v80 offset:10240
ds_read_b64_tr_b16 a[116:117], v80 offset:12288
ds_read_b64_tr_b16 a[118:119], v80 offset:14336
ds_read_b64_tr_b16 a[148:149], v81 offset:0
ds_read_b64_tr_b16 a[150:151], v81 offset:2048
ds_read_b64_tr_b16 a[180:181], v81 offset:4096
ds_read_b64_tr_b16 a[182:183], v81 offset:6144
ds_read_b64_tr_b16 a[212:213], v81 offset:8192
ds_read_b64_tr_b16 a[214:215], v81 offset:10240
ds_read_b64_tr_b16 a[244:245], v81 offset:12288
ds_read_b64_tr_b16 a[246:247], v81 offset:14336
v_add_u32 v80, 32768, v80
v_add_u32 v81, 32768, v81
s_waitcnt lgkmcnt(0)
s_barrier
s_waitcnt vmcnt(8)
s_barrier
ds_read_b64_tr_b16 a[24:25], v80 offset:0
ds_read_b64_tr_b16 a[26:27], v80 offset:2048
ds_read_b64_tr_b16 a[56:57], v80 offset:4096
ds_read_b64_tr_b16 a[58:59], v80 offset:6144
ds_read_b64_tr_b16 a[88:89], v80 offset:8192
ds_read_b64_tr_b16 a[90:91], v80 offset:10240
ds_read_b64_tr_b16 a[120:121], v80 offset:12288
ds_read_b64_tr_b16 a[122:123], v80 offset:14336
ds_read_b64_tr_b16 a[152:153], v81 offset:0
ds_read_b64_tr_b16 a[154:155], v81 offset:2048
ds_read_b64_tr_b16 a[184:185], v81 offset:4096
ds_read_b64_tr_b16 a[186:187], v81 offset:6144
ds_read_b64_tr_b16 a[216:217], v81 offset:8192
ds_read_b64_tr_b16 a[218:219], v81 offset:10240
ds_read_b64_tr_b16 a[248:249], v81 offset:12288
ds_read_b64_tr_b16 a[250:251], v81 offset:14336
v_add_u32 v80, 32768, v80
v_add_u32 v81, 32768, v81
s_waitcnt lgkmcnt(0)
s_barrier
s_waitcnt vmcnt(0)
s_barrier
ds_read_b64_tr_b16 a[28:29], v80 offset:0
ds_read_b64_tr_b16 a[30:31], v80 offset:2048
ds_read_b64_tr_b16 a[60:61], v80 offset:4096
ds_read_b64_tr_b16 a[62:63], v80 offset:6144
ds_read_b64_tr_b16 a[92:93], v80 offset:8192
ds_read_b64_tr_b16 a[94:95], v80 offset:10240
ds_read_b64_tr_b16 a[124:125], v80 offset:12288
ds_read_b64_tr_b16 a[126:127], v80 offset:14336
ds_read_b64_tr_b16 a[156:157], v81 offset:0
ds_read_b64_tr_b16 a[158:159], v81 offset:2048
ds_read_b64_tr_b16 a[188:189], v81 offset:4096
ds_read_b64_tr_b16 a[190:191], v81 offset:6144
ds_read_b64_tr_b16 a[220:221], v81 offset:8192
ds_read_b64_tr_b16 a[222:223], v81 offset:10240
ds_read_b64_tr_b16 a[252:253], v81 offset:12288
ds_read_b64_tr_b16 a[254:255], v81 offset:14336
v_add_u32 v80, 32768, v80
v_add_u32 v81, 32768, v81
s_waitcnt lgkmcnt(0)
s_barrier
s_load_dwordx2 s[16:17], s[0:1], 96
s_load_dwordx2 s[18:19], s[0:1], 88
v_mov_b32 v10, v4
s_add_u32 s60, s44, 32
s_waitcnt lgkmcnt(0)
s_mov_b32 s8, s16
s_and_b32 s9, s17, 0xffff
s_mov_b32 s10, 0xc00000
s_mov_b32 s11, 0x20000
s_mov_b32 s84, s18
s_and_b32 s85, s19, 0xffff
s_mov_b32 s86, 0x800
s_mov_b32 s87, 0x20000
v_lshrrev_b32 v2, 3, v0
v_and_b32 v3, 7, v0
v_mul_u32_u24 v4, 12288, v2
v_lshl_add_u32 v4, v3, 4, v4
v_lshlrev_b32 v5, 1, v2
v_mov_b32 v96, 0
v_mov_b32 v97, 0
v_mov_b32 v98, 0
v_mov_b32 v99, 0
v_mov_b32 v100, 0
v_mov_b32 v101, 0
v_mov_b32 v102, 0
v_mov_b32 v103, 0
buffer_load_ushort v32, v5, s[84:87], 0 offen offset:0
buffer_load_ushort v33, v5, s[84:87], 0 offen offset:64
buffer_load_ushort v34, v5, s[84:87], 0 offen offset:128
buffer_load_ushort v35, v5, s[84:87], 0 offen offset:192
buffer_load_ushort v36, v5, s[84:87], 0 offen offset:256
buffer_load_ushort v37, v5, s[84:87], 0 offen offset:320
buffer_load_ushort v38, v5, s[84:87], 0 offen offset:384
buffer_load_ushort v39, v5, s[84:87], 0 offen offset:448
buffer_load_ushort v40, v5, s[84:87], 0 offen offset:512
buffer_load_ushort v41, v5, s[84:87], 0 offen offset:576
buffer_load_ushort v42, v5, s[84:87], 0 offen offset:640
buffer_load_ushort v43, v5, s[84:87], 0 offen offset:704
buffer_load_ushort v44, v5, s[84:87], 0 offen offset:768
buffer_load_ushort v45, v5, s[84:87], 0 offen offset:832
buffer_load_ushort v46, v5, s[84:87], 0 offen offset:896
buffer_load_ushort v47, v5, s[84:87], 0 offen offset:960
buffer_load_ushort v48, v5, s[84:87], 0 offen offset:1024
buffer_load_ushort v49, v5, s[84:87], 0 offen offset:1088
buffer_load_ushort v50, v5, s[84:87], 0 offen offset:1152
buffer_load_ushort v51, v5, s[84:87], 0 offen offset:1216
buffer_load_ushort v52, v5, s[84:87], 0 offen offset:1280
buffer_load_ushort v53, v5, s[84:87], 0 offen offset:1344
buffer_load_ushort v54, v5, s[84:87], 0 offen offset:1408
buffer_load_ushort v55, v5, s[84:87], 0 offen offset:1472
buffer_load_ushort v56, v5, s[84:87], 0 offen offset:1536
buffer_load_ushort v57, v5, s[84:87], 0 offen offset:1600
buffer_load_ushort v58, v5, s[84:87], 0 offen offset:1664
buffer_load_ushort v59, v5, s[84:87], 0 offen offset:1728
buffer_load_ushort v60, v5, s[84:87], 0 offen offset:1792
buffer_load_ushort v61, v5, s[84:87], 0 offen offset:1856
buffer_load_ushort v62, v5, s[84:87], 0 offen offset:1920
buffer_load_ushort v63, v5, s[84:87], 0 offen offset:1984
s_lshl_b32 s43, s60, 7
s_waitcnt vmcnt(1)
buffer_load_dwordx4 v[128:131], v4, s[8:11], s43 offen
s_add_u32 s43, s43, 393216
buffer_load_dwordx4 v[132:135], v4, s[8:11], s43 offen
s_add_u32 s43, s43, 393216
buffer_load_dwordx4 v[136:139], v4, s[8:11], s43 offen
s_add_u32 s43, s43, 393216
buffer_load_dwordx4 v[140:143], v4, s[8:11], s43 offen
s_add_u32 s43, s43, 393216
buffer_load_dwordx4 v[144:147], v4, s[8:11], s43 offen
s_add_u32 s43, s43, 393216
buffer_load_dwordx4 v[148:151], v4, s[8:11], s43 offen
s_add_u32 s43, s43, 393216
buffer_load_dwordx4 v[152:155], v4, s[8:11], s43 offen
s_add_u32 s43, s43, 393216
buffer_load_dwordx4 v[156:159], v4, s[8:11], s43 offen
s_add_u32 s43, s43, 393216
buffer_load_dwordx4 v[160:163], v4, s[8:11], s43 offen
s_add_u32 s43, s43, 393216
buffer_load_dwordx4 v[164:167], v4, s[8:11], s43 offen
s_add_u32 s43, s43, 393216
buffer_load_dwordx4 v[168:171], v4, s[8:11], s43 offen
s_add_u32 s43, s43, 393216
buffer_load_dwordx4 v[172:175], v4, s[8:11], s43 offen
s_add_u32 s43, s43, 393216
buffer_load_dwordx4 v[176:179], v4, s[8:11], s43 offen
s_add_u32 s43, s43, 393216
buffer_load_dwordx4 v[180:183], v4, s[8:11], s43 offen
s_add_u32 s43, s43, 393216
buffer_load_dwordx4 v[184:187], v4, s[8:11], s43 offen
s_add_u32 s43, s43, 393216
buffer_load_dwordx4 v[188:191], v4, s[8:11], s43 offen
s_add_u32 s43, s43, 393216
buffer_load_dwordx4 v[192:195], v4, s[8:11], s43 offen
s_add_u32 s43, s43, 393216
buffer_load_dwordx4 v[196:199], v4, s[8:11], s43 offen
s_add_u32 s43, s43, 393216
buffer_load_dwordx4 v[200:203], v4, s[8:11], s43 offen
s_add_u32 s43, s43, 393216
buffer_load_dwordx4 v[204:207], v4, s[8:11], s43 offen
s_add_u32 s43, s43, 393216
buffer_load_dwordx4 v[208:211], v4, s[8:11], s43 offen
s_add_u32 s43, s43, 393216
buffer_load_dwordx4 v[212:215], v4, s[8:11], s43 offen
s_add_u32 s43, s43, 393216
buffer_load_dwordx4 v[216:219], v4, s[8:11], s43 offen
s_add_u32 s43, s43, 393216
buffer_load_dwordx4 v[220:223], v4, s[8:11], s43 offen
s_add_u32 s43, s43, 393216
buffer_load_dwordx4 v[224:227], v4, s[8:11], s43 offen
s_add_u32 s43, s43, 393216
buffer_load_dwordx4 v[228:231], v4, s[8:11], s43 offen
s_add_u32 s43, s43, 393216
buffer_load_dwordx4 v[232:235], v4, s[8:11], s43 offen
s_add_u32 s43, s43, 393216
buffer_load_dwordx4 v[236:239], v4, s[8:11], s43 offen
s_add_u32 s43, s43, 393216
buffer_load_dwordx4 v[240:243], v4, s[8:11], s43 offen
s_add_u32 s43, s43, 393216
buffer_load_dwordx4 v[244:247], v4, s[8:11], s43 offen
s_add_u32 s43, s43, 393216
buffer_load_dwordx4 v[248:251], v4, s[8:11], s43 offen
s_add_u32 s43, s43, 393216
buffer_load_dwordx4 v[252:255], v4, s[8:11], s43 offen
s_add_u32 s43, s43, 393216
s_waitcnt vmcnt(32)
v_lshlrev_b32 v32, 16, v32
v_mul_f32 v104, 0xbfb8aa3b, v32
v_exp_f32 v104, v104
s_nop 0
v_add_f32 v104, 1.0, v104
v_rcp_f32 v104, v104
s_nop 0
v_mul_f32 v104, v104, v32
v_cvt_pk_bf16_f32 v32, 0, v104
v_lshlrev_b32 v33, 16, v33
v_mul_f32 v104, 0xbfb8aa3b, v33
v_exp_f32 v104, v104
s_nop 0
v_add_f32 v104, 1.0, v104
v_rcp_f32 v104, v104
s_nop 0
v_mul_f32 v104, v104, v33
v_cvt_pk_bf16_f32 v33, 0, v104
v_lshlrev_b32 v34, 16, v34
v_mul_f32 v104, 0xbfb8aa3b, v34
v_exp_f32 v104, v104
s_nop 0
v_add_f32 v104, 1.0, v104
v_rcp_f32 v104, v104
s_nop 0
v_mul_f32 v104, v104, v34
v_cvt_pk_bf16_f32 v34, 0, v104
v_lshlrev_b32 v35, 16, v35
v_mul_f32 v104, 0xbfb8aa3b, v35
v_exp_f32 v104, v104
s_nop 0
v_add_f32 v104, 1.0, v104
v_rcp_f32 v104, v104
s_nop 0
v_mul_f32 v104, v104, v35
v_cvt_pk_bf16_f32 v35, 0, v104
v_lshlrev_b32 v36, 16, v36
v_mul_f32 v104, 0xbfb8aa3b, v36
v_exp_f32 v104, v104
s_nop 0
v_add_f32 v104, 1.0, v104
v_rcp_f32 v104, v104
s_nop 0
v_mul_f32 v104, v104, v36
v_cvt_pk_bf16_f32 v36, 0, v104
v_lshlrev_b32 v37, 16, v37
v_mul_f32 v104, 0xbfb8aa3b, v37
v_exp_f32 v104, v104
s_nop 0
v_add_f32 v104, 1.0, v104
v_rcp_f32 v104, v104
s_nop 0
v_mul_f32 v104, v104, v37
v_cvt_pk_bf16_f32 v37, 0, v104
v_lshlrev_b32 v38, 16, v38
v_mul_f32 v104, 0xbfb8aa3b, v38
v_exp_f32 v104, v104
s_nop 0
v_add_f32 v104, 1.0, v104
v_rcp_f32 v104, v104
s_nop 0
v_mul_f32 v104, v104, v38
v_cvt_pk_bf16_f32 v38, 0, v104
v_lshlrev_b32 v39, 16, v39
v_mul_f32 v104, 0xbfb8aa3b, v39
v_exp_f32 v104, v104
s_nop 0
v_add_f32 v104, 1.0, v104
v_rcp_f32 v104, v104
s_nop 0
v_mul_f32 v104, v104, v39
v_cvt_pk_bf16_f32 v39, 0, v104
v_lshlrev_b32 v40, 16, v40
v_mul_f32 v104, 0xbfb8aa3b, v40
v_exp_f32 v104, v104
s_nop 0
v_add_f32 v104, 1.0, v104
v_rcp_f32 v104, v104
s_nop 0
v_mul_f32 v104, v104, v40
v_cvt_pk_bf16_f32 v40, 0, v104
v_lshlrev_b32 v41, 16, v41
v_mul_f32 v104, 0xbfb8aa3b, v41
v_exp_f32 v104, v104
s_nop 0
v_add_f32 v104, 1.0, v104
v_rcp_f32 v104, v104
s_nop 0
v_mul_f32 v104, v104, v41
v_cvt_pk_bf16_f32 v41, 0, v104
v_lshlrev_b32 v42, 16, v42
v_mul_f32 v104, 0xbfb8aa3b, v42
v_exp_f32 v104, v104
s_nop 0
v_add_f32 v104, 1.0, v104
v_rcp_f32 v104, v104
s_nop 0
v_mul_f32 v104, v104, v42
v_cvt_pk_bf16_f32 v42, 0, v104
v_lshlrev_b32 v43, 16, v43
v_mul_f32 v104, 0xbfb8aa3b, v43
v_exp_f32 v104, v104
s_nop 0
v_add_f32 v104, 1.0, v104
v_rcp_f32 v104, v104
s_nop 0
v_mul_f32 v104, v104, v43
v_cvt_pk_bf16_f32 v43, 0, v104
v_lshlrev_b32 v44, 16, v44
v_mul_f32 v104, 0xbfb8aa3b, v44
v_exp_f32 v104, v104
s_nop 0
v_add_f32 v104, 1.0, v104
v_rcp_f32 v104, v104
s_nop 0
v_mul_f32 v104, v104, v44
v_cvt_pk_bf16_f32 v44, 0, v104
v_lshlrev_b32 v45, 16, v45
v_mul_f32 v104, 0xbfb8aa3b, v45
v_exp_f32 v104, v104
s_nop 0
v_add_f32 v104, 1.0, v104
v_rcp_f32 v104, v104
s_nop 0
v_mul_f32 v104, v104, v45
v_cvt_pk_bf16_f32 v45, 0, v104
v_lshlrev_b32 v46, 16, v46
v_mul_f32 v104, 0xbfb8aa3b, v46
v_exp_f32 v104, v104
s_nop 0
v_add_f32 v104, 1.0, v104
v_rcp_f32 v104, v104
s_nop 0
v_mul_f32 v104, v104, v46
v_cvt_pk_bf16_f32 v46, 0, v104
v_lshlrev_b32 v47, 16, v47
v_mul_f32 v104, 0xbfb8aa3b, v47
v_exp_f32 v104, v104
s_nop 0
v_add_f32 v104, 1.0, v104
v_rcp_f32 v104, v104
s_nop 0
v_mul_f32 v104, v104, v47
v_cvt_pk_bf16_f32 v47, 0, v104
v_lshlrev_b32 v48, 16, v48
v_mul_f32 v104, 0xbfb8aa3b, v48
v_exp_f32 v104, v104
s_nop 0
v_add_f32 v104, 1.0, v104
v_rcp_f32 v104, v104
s_nop 0
v_mul_f32 v104, v104, v48
v_cvt_pk_bf16_f32 v48, 0, v104
v_lshlrev_b32 v49, 16, v49
v_mul_f32 v104, 0xbfb8aa3b, v49
v_exp_f32 v104, v104
s_nop 0
v_add_f32 v104, 1.0, v104
v_rcp_f32 v104, v104
s_nop 0
v_mul_f32 v104, v104, v49
v_cvt_pk_bf16_f32 v49, 0, v104
v_lshlrev_b32 v50, 16, v50
v_mul_f32 v104, 0xbfb8aa3b, v50
v_exp_f32 v104, v104
s_nop 0
v_add_f32 v104, 1.0, v104
v_rcp_f32 v104, v104
s_nop 0
v_mul_f32 v104, v104, v50
v_cvt_pk_bf16_f32 v50, 0, v104
v_lshlrev_b32 v51, 16, v51
v_mul_f32 v104, 0xbfb8aa3b, v51
v_exp_f32 v104, v104
s_nop 0
v_add_f32 v104, 1.0, v104
v_rcp_f32 v104, v104
s_nop 0
v_mul_f32 v104, v104, v51
v_cvt_pk_bf16_f32 v51, 0, v104
v_lshlrev_b32 v52, 16, v52
v_mul_f32 v104, 0xbfb8aa3b, v52
v_exp_f32 v104, v104
s_nop 0
v_add_f32 v104, 1.0, v104
v_rcp_f32 v104, v104
s_nop 0
v_mul_f32 v104, v104, v52
v_cvt_pk_bf16_f32 v52, 0, v104
v_lshlrev_b32 v53, 16, v53
v_mul_f32 v104, 0xbfb8aa3b, v53
v_exp_f32 v104, v104
s_nop 0
v_add_f32 v104, 1.0, v104
v_rcp_f32 v104, v104
s_nop 0
v_mul_f32 v104, v104, v53
v_cvt_pk_bf16_f32 v53, 0, v104
v_lshlrev_b32 v54, 16, v54
v_mul_f32 v104, 0xbfb8aa3b, v54
v_exp_f32 v104, v104
s_nop 0
v_add_f32 v104, 1.0, v104
v_rcp_f32 v104, v104
s_nop 0
v_mul_f32 v104, v104, v54
v_cvt_pk_bf16_f32 v54, 0, v104
v_lshlrev_b32 v55, 16, v55
v_mul_f32 v104, 0xbfb8aa3b, v55
v_exp_f32 v104, v104
s_nop 0
v_add_f32 v104, 1.0, v104
v_rcp_f32 v104, v104
s_nop 0
v_mul_f32 v104, v104, v55
v_cvt_pk_bf16_f32 v55, 0, v104
v_lshlrev_b32 v56, 16, v56
v_mul_f32 v104, 0xbfb8aa3b, v56
v_exp_f32 v104, v104
s_nop 0
v_add_f32 v104, 1.0, v104
v_rcp_f32 v104, v104
s_nop 0
v_mul_f32 v104, v104, v56
v_cvt_pk_bf16_f32 v56, 0, v104
v_lshlrev_b32 v57, 16, v57
v_mul_f32 v104, 0xbfb8aa3b, v57
v_exp_f32 v104, v104
s_nop 0
v_add_f32 v104, 1.0, v104
v_rcp_f32 v104, v104
s_nop 0
v_mul_f32 v104, v104, v57
v_cvt_pk_bf16_f32 v57, 0, v104
v_lshlrev_b32 v58, 16, v58
v_mul_f32 v104, 0xbfb8aa3b, v58
v_exp_f32 v104, v104
s_nop 0
v_add_f32 v104, 1.0, v104
v_rcp_f32 v104, v104
s_nop 0
v_mul_f32 v104, v104, v58
v_cvt_pk_bf16_f32 v58, 0, v104
v_lshlrev_b32 v59, 16, v59
v_mul_f32 v104, 0xbfb8aa3b, v59
v_exp_f32 v104, v104
s_nop 0
v_add_f32 v104, 1.0, v104
v_rcp_f32 v104, v104
s_nop 0
v_mul_f32 v104, v104, v59
v_cvt_pk_bf16_f32 v59, 0, v104
v_lshlrev_b32 v60, 16, v60
v_mul_f32 v104, 0xbfb8aa3b, v60
v_exp_f32 v104, v104
s_nop 0
v_add_f32 v104, 1.0, v104
v_rcp_f32 v104, v104
s_nop 0
v_mul_f32 v104, v104, v60
v_cvt_pk_bf16_f32 v60, 0, v104
v_lshlrev_b32 v61, 16, v61
v_mul_f32 v104, 0xbfb8aa3b, v61
v_exp_f32 v104, v104
s_nop 0
v_add_f32 v104, 1.0, v104
v_rcp_f32 v104, v104
s_nop 0
v_mul_f32 v104, v104, v61
v_cvt_pk_bf16_f32 v61, 0, v104
v_lshlrev_b32 v62, 16, v62
v_mul_f32 v104, 0xbfb8aa3b, v62
v_exp_f32 v104, v104
s_nop 0
v_add_f32 v104, 1.0, v104
v_rcp_f32 v104, v104
s_nop 0
v_mul_f32 v104, v104, v62
v_cvt_pk_bf16_f32 v62, 0, v104
v_lshlrev_b32 v63, 16, v63
v_mul_f32 v104, 0xbfb8aa3b, v63
v_exp_f32 v104, v104
s_nop 0
v_add_f32 v104, 1.0, v104
v_rcp_f32 v104, v104
s_nop 0
v_mul_f32 v104, v104, v63
v_cvt_pk_bf16_f32 v63, 0, v104
s_xor_b32 s43, s60, 0x62
s_lshl_b32 s43, s43, 7
s_waitcnt vmcnt(31)
v_lshlrev_b32 v104, 16, v128
v_and_b32 v105, 0xffff0000, v128
v_fmac_f32 v96, v104, v32
v_fmac_f32 v97, v105, v32
v_lshlrev_b32 v104, 16, v129
v_and_b32 v105, 0xffff0000, v129
v_fmac_f32 v98, v104, v32
v_fmac_f32 v99, v105, v32
v_lshlrev_b32 v104, 16, v130
v_and_b32 v105, 0xffff0000, v130
v_fmac_f32 v100, v104, v32
v_fmac_f32 v101, v105, v32
v_lshlrev_b32 v104, 16, v131
v_and_b32 v105, 0xffff0000, v131
v_fmac_f32 v102, v104, v32
v_fmac_f32 v103, v105, v32
buffer_load_dwordx4 v[128:131], v4, s[8:11], s43 offen
s_add_u32 s43, s43, 393216
s_waitcnt vmcnt(31)
v_lshlrev_b32 v104, 16, v132
v_and_b32 v105, 0xffff0000, v132
v_fmac_f32 v96, v104, v33
v_fmac_f32 v97, v105, v33
v_lshlrev_b32 v104, 16, v133
v_and_b32 v105, 0xffff0000, v133
v_fmac_f32 v98, v104, v33
v_fmac_f32 v99, v105, v33
v_lshlrev_b32 v104, 16, v134
v_and_b32 v105, 0xffff0000, v134
v_fmac_f32 v100, v104, v33
v_fmac_f32 v101, v105, v33
v_lshlrev_b32 v104, 16, v135
v_and_b32 v105, 0xffff0000, v135
v_fmac_f32 v102, v104, v33
v_fmac_f32 v103, v105, v33
buffer_load_dwordx4 v[132:135], v4, s[8:11], s43 offen
s_add_u32 s43, s43, 393216
s_waitcnt vmcnt(31)
v_lshlrev_b32 v104, 16, v136
v_and_b32 v105, 0xffff0000, v136
v_fmac_f32 v96, v104, v34
v_fmac_f32 v97, v105, v34
v_lshlrev_b32 v104, 16, v137
v_and_b32 v105, 0xffff0000, v137
v_fmac_f32 v98, v104, v34
v_fmac_f32 v99, v105, v34
v_lshlrev_b32 v104, 16, v138
v_and_b32 v105, 0xffff0000, v138
v_fmac_f32 v100, v104, v34
v_fmac_f32 v101, v105, v34
v_lshlrev_b32 v104, 16, v139
v_and_b32 v105, 0xffff0000, v139
v_fmac_f32 v102, v104, v34
v_fmac_f32 v103, v105, v34
buffer_load_dwordx4 v[136:139], v4, s[8:11], s43 offen
s_add_u32 s43, s43, 393216
s_waitcnt vmcnt(31)
v_lshlrev_b32 v104, 16, v140
v_and_b32 v105, 0xffff0000, v140
v_fmac_f32 v96, v104, v35
v_fmac_f32 v97, v105, v35
v_lshlrev_b32 v104, 16, v141
v_and_b32 v105, 0xffff0000, v141
v_fmac_f32 v98, v104, v35
v_fmac_f32 v99, v105, v35
v_lshlrev_b32 v104, 16, v142
v_and_b32 v105, 0xffff0000, v142
v_fmac_f32 v100, v104, v35
v_fmac_f32 v101, v105, v35
v_lshlrev_b32 v104, 16, v143
v_and_b32 v105, 0xffff0000, v143
v_fmac_f32 v102, v104, v35
v_fmac_f32 v103, v105, v35
buffer_load_dwordx4 v[140:143], v4, s[8:11], s43 offen
s_add_u32 s43, s43, 393216
s_waitcnt vmcnt(31)
v_lshlrev_b32 v104, 16, v144
v_and_b32 v105, 0xffff0000, v144
v_fmac_f32 v96, v104, v36
v_fmac_f32 v97, v105, v36
v_lshlrev_b32 v104, 16, v145
v_and_b32 v105, 0xffff0000, v145
v_fmac_f32 v98, v104, v36
v_fmac_f32 v99, v105, v36
v_lshlrev_b32 v104, 16, v146
v_and_b32 v105, 0xffff0000, v146
v_fmac_f32 v100, v104, v36
v_fmac_f32 v101, v105, v36
v_lshlrev_b32 v104, 16, v147
v_and_b32 v105, 0xffff0000, v147
v_fmac_f32 v102, v104, v36
v_fmac_f32 v103, v105, v36
buffer_load_dwordx4 v[144:147], v4, s[8:11], s43 offen
s_add_u32 s43, s43, 393216
s_waitcnt vmcnt(31)
v_lshlrev_b32 v104, 16, v148
v_and_b32 v105, 0xffff0000, v148
v_fmac_f32 v96, v104, v37
v_fmac_f32 v97, v105, v37
v_lshlrev_b32 v104, 16, v149
v_and_b32 v105, 0xffff0000, v149
v_fmac_f32 v98, v104, v37
v_fmac_f32 v99, v105, v37
v_lshlrev_b32 v104, 16, v150
v_and_b32 v105, 0xffff0000, v150
v_fmac_f32 v100, v104, v37
v_fmac_f32 v101, v105, v37
v_lshlrev_b32 v104, 16, v151
v_and_b32 v105, 0xffff0000, v151
v_fmac_f32 v102, v104, v37
v_fmac_f32 v103, v105, v37
buffer_load_dwordx4 v[148:151], v4, s[8:11], s43 offen
s_add_u32 s43, s43, 393216
s_waitcnt vmcnt(31)
v_lshlrev_b32 v104, 16, v152
v_and_b32 v105, 0xffff0000, v152
v_fmac_f32 v96, v104, v38
v_fmac_f32 v97, v105, v38
v_lshlrev_b32 v104, 16, v153
v_and_b32 v105, 0xffff0000, v153
v_fmac_f32 v98, v104, v38
v_fmac_f32 v99, v105, v38
v_lshlrev_b32 v104, 16, v154
v_and_b32 v105, 0xffff0000, v154
v_fmac_f32 v100, v104, v38
v_fmac_f32 v101, v105, v38
v_lshlrev_b32 v104, 16, v155
v_and_b32 v105, 0xffff0000, v155
v_fmac_f32 v102, v104, v38
v_fmac_f32 v103, v105, v38
buffer_load_dwordx4 v[152:155], v4, s[8:11], s43 offen
s_add_u32 s43, s43, 393216
s_waitcnt vmcnt(31)
v_lshlrev_b32 v104, 16, v156
v_and_b32 v105, 0xffff0000, v156
v_fmac_f32 v96, v104, v39
v_fmac_f32 v97, v105, v39
v_lshlrev_b32 v104, 16, v157
v_and_b32 v105, 0xffff0000, v157
v_fmac_f32 v98, v104, v39
v_fmac_f32 v99, v105, v39
v_lshlrev_b32 v104, 16, v158
v_and_b32 v105, 0xffff0000, v158
v_fmac_f32 v100, v104, v39
v_fmac_f32 v101, v105, v39
v_lshlrev_b32 v104, 16, v159
v_and_b32 v105, 0xffff0000, v159
v_fmac_f32 v102, v104, v39
v_fmac_f32 v103, v105, v39
buffer_load_dwordx4 v[156:159], v4, s[8:11], s43 offen
s_add_u32 s43, s43, 393216
s_waitcnt vmcnt(31)
v_lshlrev_b32 v104, 16, v160
v_and_b32 v105, 0xffff0000, v160
v_fmac_f32 v96, v104, v40
v_fmac_f32 v97, v105, v40
v_lshlrev_b32 v104, 16, v161
v_and_b32 v105, 0xffff0000, v161
v_fmac_f32 v98, v104, v40
v_fmac_f32 v99, v105, v40
v_lshlrev_b32 v104, 16, v162
v_and_b32 v105, 0xffff0000, v162
v_fmac_f32 v100, v104, v40
v_fmac_f32 v101, v105, v40
v_lshlrev_b32 v104, 16, v163
v_and_b32 v105, 0xffff0000, v163
v_fmac_f32 v102, v104, v40
v_fmac_f32 v103, v105, v40
buffer_load_dwordx4 v[160:163], v4, s[8:11], s43 offen
s_add_u32 s43, s43, 393216
s_waitcnt vmcnt(31)
v_lshlrev_b32 v104, 16, v164
v_and_b32 v105, 0xffff0000, v164
v_fmac_f32 v96, v104, v41
v_fmac_f32 v97, v105, v41
v_lshlrev_b32 v104, 16, v165
v_and_b32 v105, 0xffff0000, v165
v_fmac_f32 v98, v104, v41
v_fmac_f32 v99, v105, v41
v_lshlrev_b32 v104, 16, v166
v_and_b32 v105, 0xffff0000, v166
v_fmac_f32 v100, v104, v41
v_fmac_f32 v101, v105, v41
v_lshlrev_b32 v104, 16, v167
v_and_b32 v105, 0xffff0000, v167
v_fmac_f32 v102, v104, v41
v_fmac_f32 v103, v105, v41
buffer_load_dwordx4 v[164:167], v4, s[8:11], s43 offen
s_add_u32 s43, s43, 393216
s_waitcnt vmcnt(31)
v_lshlrev_b32 v104, 16, v168
v_and_b32 v105, 0xffff0000, v168
v_fmac_f32 v96, v104, v42
v_fmac_f32 v97, v105, v42
v_lshlrev_b32 v104, 16, v169
v_and_b32 v105, 0xffff0000, v169
v_fmac_f32 v98, v104, v42
v_fmac_f32 v99, v105, v42
v_lshlrev_b32 v104, 16, v170
v_and_b32 v105, 0xffff0000, v170
v_fmac_f32 v100, v104, v42
v_fmac_f32 v101, v105, v42
v_lshlrev_b32 v104, 16, v171
v_and_b32 v105, 0xffff0000, v171
v_fmac_f32 v102, v104, v42
v_fmac_f32 v103, v105, v42
buffer_load_dwordx4 v[168:171], v4, s[8:11], s43 offen
s_add_u32 s43, s43, 393216
s_waitcnt vmcnt(31)
v_lshlrev_b32 v104, 16, v172
v_and_b32 v105, 0xffff0000, v172
v_fmac_f32 v96, v104, v43
v_fmac_f32 v97, v105, v43
v_lshlrev_b32 v104, 16, v173
v_and_b32 v105, 0xffff0000, v173
v_fmac_f32 v98, v104, v43
v_fmac_f32 v99, v105, v43
v_lshlrev_b32 v104, 16, v174
v_and_b32 v105, 0xffff0000, v174
v_fmac_f32 v100, v104, v43
v_fmac_f32 v101, v105, v43
v_lshlrev_b32 v104, 16, v175
v_and_b32 v105, 0xffff0000, v175
v_fmac_f32 v102, v104, v43
v_fmac_f32 v103, v105, v43
buffer_load_dwordx4 v[172:175], v4, s[8:11], s43 offen
s_add_u32 s43, s43, 393216
s_waitcnt vmcnt(31)
v_lshlrev_b32 v104, 16, v176
v_and_b32 v105, 0xffff0000, v176
v_fmac_f32 v96, v104, v44
v_fmac_f32 v97, v105, v44
v_lshlrev_b32 v104, 16, v177
v_and_b32 v105, 0xffff0000, v177
v_fmac_f32 v98, v104, v44
v_fmac_f32 v99, v105, v44
v_lshlrev_b32 v104, 16, v178
v_and_b32 v105, 0xffff0000, v178
v_fmac_f32 v100, v104, v44
v_fmac_f32 v101, v105, v44
v_lshlrev_b32 v104, 16, v179
v_and_b32 v105, 0xffff0000, v179
v_fmac_f32 v102, v104, v44
v_fmac_f32 v103, v105, v44
buffer_load_dwordx4 v[176:179], v4, s[8:11], s43 offen
s_add_u32 s43, s43, 393216
s_waitcnt vmcnt(31)
v_lshlrev_b32 v104, 16, v180
v_and_b32 v105, 0xffff0000, v180
v_fmac_f32 v96, v104, v45
v_fmac_f32 v97, v105, v45
v_lshlrev_b32 v104, 16, v181
v_and_b32 v105, 0xffff0000, v181
v_fmac_f32 v98, v104, v45
v_fmac_f32 v99, v105, v45
v_lshlrev_b32 v104, 16, v182
v_and_b32 v105, 0xffff0000, v182
v_fmac_f32 v100, v104, v45
v_fmac_f32 v101, v105, v45
v_lshlrev_b32 v104, 16, v183
v_and_b32 v105, 0xffff0000, v183
v_fmac_f32 v102, v104, v45
v_fmac_f32 v103, v105, v45
buffer_load_dwordx4 v[180:183], v4, s[8:11], s43 offen
s_add_u32 s43, s43, 393216
s_waitcnt vmcnt(31)
v_lshlrev_b32 v104, 16, v184
v_and_b32 v105, 0xffff0000, v184
v_fmac_f32 v96, v104, v46
v_fmac_f32 v97, v105, v46
v_lshlrev_b32 v104, 16, v185
v_and_b32 v105, 0xffff0000, v185
v_fmac_f32 v98, v104, v46
v_fmac_f32 v99, v105, v46
v_lshlrev_b32 v104, 16, v186
v_and_b32 v105, 0xffff0000, v186
v_fmac_f32 v100, v104, v46
v_fmac_f32 v101, v105, v46
v_lshlrev_b32 v104, 16, v187
v_and_b32 v105, 0xffff0000, v187
v_fmac_f32 v102, v104, v46
v_fmac_f32 v103, v105, v46
buffer_load_dwordx4 v[184:187], v4, s[8:11], s43 offen
s_add_u32 s43, s43, 393216
s_waitcnt vmcnt(31)
v_lshlrev_b32 v104, 16, v188
v_and_b32 v105, 0xffff0000, v188
v_fmac_f32 v96, v104, v47
v_fmac_f32 v97, v105, v47
v_lshlrev_b32 v104, 16, v189
v_and_b32 v105, 0xffff0000, v189
v_fmac_f32 v98, v104, v47
v_fmac_f32 v99, v105, v47
v_lshlrev_b32 v104, 16, v190
v_and_b32 v105, 0xffff0000, v190
v_fmac_f32 v100, v104, v47
v_fmac_f32 v101, v105, v47
v_lshlrev_b32 v104, 16, v191
v_and_b32 v105, 0xffff0000, v191
v_fmac_f32 v102, v104, v47
v_fmac_f32 v103, v105, v47
buffer_load_dwordx4 v[188:191], v4, s[8:11], s43 offen
s_add_u32 s43, s43, 393216
s_waitcnt vmcnt(31)
v_lshlrev_b32 v104, 16, v192
v_and_b32 v105, 0xffff0000, v192
v_fmac_f32 v96, v104, v48
v_fmac_f32 v97, v105, v48
v_lshlrev_b32 v104, 16, v193
v_and_b32 v105, 0xffff0000, v193
v_fmac_f32 v98, v104, v48
v_fmac_f32 v99, v105, v48
v_lshlrev_b32 v104, 16, v194
v_and_b32 v105, 0xffff0000, v194
v_fmac_f32 v100, v104, v48
v_fmac_f32 v101, v105, v48
v_lshlrev_b32 v104, 16, v195
v_and_b32 v105, 0xffff0000, v195
v_fmac_f32 v102, v104, v48
v_fmac_f32 v103, v105, v48
buffer_load_dwordx4 v[192:195], v4, s[8:11], s43 offen
s_add_u32 s43, s43, 393216
s_waitcnt vmcnt(31)
v_lshlrev_b32 v104, 16, v196
v_and_b32 v105, 0xffff0000, v196
v_fmac_f32 v96, v104, v49
v_fmac_f32 v97, v105, v49
v_lshlrev_b32 v104, 16, v197
v_and_b32 v105, 0xffff0000, v197
v_fmac_f32 v98, v104, v49
v_fmac_f32 v99, v105, v49
v_lshlrev_b32 v104, 16, v198
v_and_b32 v105, 0xffff0000, v198
v_fmac_f32 v100, v104, v49
v_fmac_f32 v101, v105, v49
v_lshlrev_b32 v104, 16, v199
v_and_b32 v105, 0xffff0000, v199
v_fmac_f32 v102, v104, v49
v_fmac_f32 v103, v105, v49
buffer_load_dwordx4 v[196:199], v4, s[8:11], s43 offen
s_add_u32 s43, s43, 393216
s_waitcnt vmcnt(31)
v_lshlrev_b32 v104, 16, v200
v_and_b32 v105, 0xffff0000, v200
v_fmac_f32 v96, v104, v50
v_fmac_f32 v97, v105, v50
v_lshlrev_b32 v104, 16, v201
v_and_b32 v105, 0xffff0000, v201
v_fmac_f32 v98, v104, v50
v_fmac_f32 v99, v105, v50
v_lshlrev_b32 v104, 16, v202
v_and_b32 v105, 0xffff0000, v202
v_fmac_f32 v100, v104, v50
v_fmac_f32 v101, v105, v50
v_lshlrev_b32 v104, 16, v203
v_and_b32 v105, 0xffff0000, v203
v_fmac_f32 v102, v104, v50
v_fmac_f32 v103, v105, v50
buffer_load_dwordx4 v[200:203], v4, s[8:11], s43 offen
s_add_u32 s43, s43, 393216
s_waitcnt vmcnt(31)
v_lshlrev_b32 v104, 16, v204
v_and_b32 v105, 0xffff0000, v204
v_fmac_f32 v96, v104, v51
v_fmac_f32 v97, v105, v51
v_lshlrev_b32 v104, 16, v205
v_and_b32 v105, 0xffff0000, v205
v_fmac_f32 v98, v104, v51
v_fmac_f32 v99, v105, v51
v_lshlrev_b32 v104, 16, v206
v_and_b32 v105, 0xffff0000, v206
v_fmac_f32 v100, v104, v51
v_fmac_f32 v101, v105, v51
v_lshlrev_b32 v104, 16, v207
v_and_b32 v105, 0xffff0000, v207
v_fmac_f32 v102, v104, v51
v_fmac_f32 v103, v105, v51
buffer_load_dwordx4 v[204:207], v4, s[8:11], s43 offen
s_add_u32 s43, s43, 393216
s_waitcnt vmcnt(31)
v_lshlrev_b32 v104, 16, v208
v_and_b32 v105, 0xffff0000, v208
v_fmac_f32 v96, v104, v52
v_fmac_f32 v97, v105, v52
v_lshlrev_b32 v104, 16, v209
v_and_b32 v105, 0xffff0000, v209
v_fmac_f32 v98, v104, v52
v_fmac_f32 v99, v105, v52
v_lshlrev_b32 v104, 16, v210
v_and_b32 v105, 0xffff0000, v210
v_fmac_f32 v100, v104, v52
v_fmac_f32 v101, v105, v52
v_lshlrev_b32 v104, 16, v211
v_and_b32 v105, 0xffff0000, v211
v_fmac_f32 v102, v104, v52
v_fmac_f32 v103, v105, v52
buffer_load_dwordx4 v[208:211], v4, s[8:11], s43 offen
s_add_u32 s43, s43, 393216
s_waitcnt vmcnt(31)
v_lshlrev_b32 v104, 16, v212
v_and_b32 v105, 0xffff0000, v212
v_fmac_f32 v96, v104, v53
v_fmac_f32 v97, v105, v53
v_lshlrev_b32 v104, 16, v213
v_and_b32 v105, 0xffff0000, v213
v_fmac_f32 v98, v104, v53
v_fmac_f32 v99, v105, v53
v_lshlrev_b32 v104, 16, v214
v_and_b32 v105, 0xffff0000, v214
v_fmac_f32 v100, v104, v53
v_fmac_f32 v101, v105, v53
v_lshlrev_b32 v104, 16, v215
v_and_b32 v105, 0xffff0000, v215
v_fmac_f32 v102, v104, v53
v_fmac_f32 v103, v105, v53
buffer_load_dwordx4 v[212:215], v4, s[8:11], s43 offen
s_add_u32 s43, s43, 393216
s_waitcnt vmcnt(31)
v_lshlrev_b32 v104, 16, v216
v_and_b32 v105, 0xffff0000, v216
v_fmac_f32 v96, v104, v54
v_fmac_f32 v97, v105, v54
v_lshlrev_b32 v104, 16, v217
v_and_b32 v105, 0xffff0000, v217
v_fmac_f32 v98, v104, v54
v_fmac_f32 v99, v105, v54
v_lshlrev_b32 v104, 16, v218
v_and_b32 v105, 0xffff0000, v218
v_fmac_f32 v100, v104, v54
v_fmac_f32 v101, v105, v54
v_lshlrev_b32 v104, 16, v219
v_and_b32 v105, 0xffff0000, v219
v_fmac_f32 v102, v104, v54
v_fmac_f32 v103, v105, v54
buffer_load_dwordx4 v[216:219], v4, s[8:11], s43 offen
s_add_u32 s43, s43, 393216
s_waitcnt vmcnt(31)
v_lshlrev_b32 v104, 16, v220
v_and_b32 v105, 0xffff0000, v220
v_fmac_f32 v96, v104, v55
v_fmac_f32 v97, v105, v55
v_lshlrev_b32 v104, 16, v221
v_and_b32 v105, 0xffff0000, v221
v_fmac_f32 v98, v104, v55
v_fmac_f32 v99, v105, v55
v_lshlrev_b32 v104, 16, v222
v_and_b32 v105, 0xffff0000, v222
v_fmac_f32 v100, v104, v55
v_fmac_f32 v101, v105, v55
v_lshlrev_b32 v104, 16, v223
v_and_b32 v105, 0xffff0000, v223
v_fmac_f32 v102, v104, v55
v_fmac_f32 v103, v105, v55
buffer_load_dwordx4 v[220:223], v4, s[8:11], s43 offen
s_add_u32 s43, s43, 393216
s_waitcnt vmcnt(31)
v_lshlrev_b32 v104, 16, v224
v_and_b32 v105, 0xffff0000, v224
v_fmac_f32 v96, v104, v56
v_fmac_f32 v97, v105, v56
v_lshlrev_b32 v104, 16, v225
v_and_b32 v105, 0xffff0000, v225
v_fmac_f32 v98, v104, v56
v_fmac_f32 v99, v105, v56
v_lshlrev_b32 v104, 16, v226
v_and_b32 v105, 0xffff0000, v226
v_fmac_f32 v100, v104, v56
v_fmac_f32 v101, v105, v56
v_lshlrev_b32 v104, 16, v227
v_and_b32 v105, 0xffff0000, v227
v_fmac_f32 v102, v104, v56
v_fmac_f32 v103, v105, v56
buffer_load_dwordx4 v[224:227], v4, s[8:11], s43 offen
s_add_u32 s43, s43, 393216
s_waitcnt vmcnt(31)
v_lshlrev_b32 v104, 16, v228
v_and_b32 v105, 0xffff0000, v228
v_fmac_f32 v96, v104, v57
v_fmac_f32 v97, v105, v57
v_lshlrev_b32 v104, 16, v229
v_and_b32 v105, 0xffff0000, v229
v_fmac_f32 v98, v104, v57
v_fmac_f32 v99, v105, v57
v_lshlrev_b32 v104, 16, v230
v_and_b32 v105, 0xffff0000, v230
v_fmac_f32 v100, v104, v57
v_fmac_f32 v101, v105, v57
v_lshlrev_b32 v104, 16, v231
v_and_b32 v105, 0xffff0000, v231
v_fmac_f32 v102, v104, v57
v_fmac_f32 v103, v105, v57
buffer_load_dwordx4 v[228:231], v4, s[8:11], s43 offen
s_add_u32 s43, s43, 393216
s_waitcnt vmcnt(31)
v_lshlrev_b32 v104, 16, v232
v_and_b32 v105, 0xffff0000, v232
v_fmac_f32 v96, v104, v58
v_fmac_f32 v97, v105, v58
v_lshlrev_b32 v104, 16, v233
v_and_b32 v105, 0xffff0000, v233
v_fmac_f32 v98, v104, v58
v_fmac_f32 v99, v105, v58
v_lshlrev_b32 v104, 16, v234
v_and_b32 v105, 0xffff0000, v234
v_fmac_f32 v100, v104, v58
v_fmac_f32 v101, v105, v58
v_lshlrev_b32 v104, 16, v235
v_and_b32 v105, 0xffff0000, v235
v_fmac_f32 v102, v104, v58
v_fmac_f32 v103, v105, v58
buffer_load_dwordx4 v[232:235], v4, s[8:11], s43 offen
s_add_u32 s43, s43, 393216
s_waitcnt vmcnt(31)
v_lshlrev_b32 v104, 16, v236
v_and_b32 v105, 0xffff0000, v236
v_fmac_f32 v96, v104, v59
v_fmac_f32 v97, v105, v59
v_lshlrev_b32 v104, 16, v237
v_and_b32 v105, 0xffff0000, v237
v_fmac_f32 v98, v104, v59
v_fmac_f32 v99, v105, v59
v_lshlrev_b32 v104, 16, v238
v_and_b32 v105, 0xffff0000, v238
v_fmac_f32 v100, v104, v59
v_fmac_f32 v101, v105, v59
v_lshlrev_b32 v104, 16, v239
v_and_b32 v105, 0xffff0000, v239
v_fmac_f32 v102, v104, v59
v_fmac_f32 v103, v105, v59
buffer_load_dwordx4 v[236:239], v4, s[8:11], s43 offen
s_add_u32 s43, s43, 393216
s_waitcnt vmcnt(31)
v_lshlrev_b32 v104, 16, v240
v_and_b32 v105, 0xffff0000, v240
v_fmac_f32 v96, v104, v60
v_fmac_f32 v97, v105, v60
v_lshlrev_b32 v104, 16, v241
v_and_b32 v105, 0xffff0000, v241
v_fmac_f32 v98, v104, v60
v_fmac_f32 v99, v105, v60
v_lshlrev_b32 v104, 16, v242
v_and_b32 v105, 0xffff0000, v242
v_fmac_f32 v100, v104, v60
v_fmac_f32 v101, v105, v60
v_lshlrev_b32 v104, 16, v243
v_and_b32 v105, 0xffff0000, v243
v_fmac_f32 v102, v104, v60
v_fmac_f32 v103, v105, v60
buffer_load_dwordx4 v[240:243], v4, s[8:11], s43 offen
s_add_u32 s43, s43, 393216
s_waitcnt vmcnt(31)
v_lshlrev_b32 v104, 16, v244
v_and_b32 v105, 0xffff0000, v244
v_fmac_f32 v96, v104, v61
v_fmac_f32 v97, v105, v61
v_lshlrev_b32 v104, 16, v245
v_and_b32 v105, 0xffff0000, v245
v_fmac_f32 v98, v104, v61
v_fmac_f32 v99, v105, v61
v_lshlrev_b32 v104, 16, v246
v_and_b32 v105, 0xffff0000, v246
v_fmac_f32 v100, v104, v61
v_fmac_f32 v101, v105, v61
v_lshlrev_b32 v104, 16, v247
v_and_b32 v105, 0xffff0000, v247
v_fmac_f32 v102, v104, v61
v_fmac_f32 v103, v105, v61
buffer_load_dwordx4 v[244:247], v4, s[8:11], s43 offen
s_add_u32 s43, s43, 393216
s_waitcnt vmcnt(31)
v_lshlrev_b32 v104, 16, v248
v_and_b32 v105, 0xffff0000, v248
v_fmac_f32 v96, v104, v62
v_fmac_f32 v97, v105, v62
v_lshlrev_b32 v104, 16, v249
v_and_b32 v105, 0xffff0000, v249
v_fmac_f32 v98, v104, v62
v_fmac_f32 v99, v105, v62
v_lshlrev_b32 v104, 16, v250
v_and_b32 v105, 0xffff0000, v250
v_fmac_f32 v100, v104, v62
v_fmac_f32 v101, v105, v62
v_lshlrev_b32 v104, 16, v251
v_and_b32 v105, 0xffff0000, v251
v_fmac_f32 v102, v104, v62
v_fmac_f32 v103, v105, v62
buffer_load_dwordx4 v[248:251], v4, s[8:11], s43 offen
s_add_u32 s43, s43, 393216
s_waitcnt vmcnt(31)
v_lshlrev_b32 v104, 16, v252
v_and_b32 v105, 0xffff0000, v252
v_fmac_f32 v96, v104, v63
v_fmac_f32 v97, v105, v63
v_lshlrev_b32 v104, 16, v253
v_and_b32 v105, 0xffff0000, v253
v_fmac_f32 v98, v104, v63
v_fmac_f32 v99, v105, v63
v_lshlrev_b32 v104, 16, v254
v_and_b32 v105, 0xffff0000, v254
v_fmac_f32 v100, v104, v63
v_fmac_f32 v101, v105, v63
v_lshlrev_b32 v104, 16, v255
v_and_b32 v105, 0xffff0000, v255
v_fmac_f32 v102, v104, v63
v_fmac_f32 v103, v105, v63
buffer_load_dwordx4 v[252:255], v4, s[8:11], s43 offen
s_add_u32 s43, s43, 393216
s_lshl_b32 s62, s60, 8
s_add_u32 s62, s62, 3145728
s_nop 1
v_add_f32_dpp v96, v96, v96 row_ror:8 row_mask:0xf bank_mask:0xf
v_add_f32_dpp v97, v97, v97 row_ror:8 row_mask:0xf bank_mask:0xf
v_add_f32_dpp v98, v98, v98 row_ror:8 row_mask:0xf bank_mask:0xf
v_add_f32_dpp v99, v99, v99 row_ror:8 row_mask:0xf bank_mask:0xf
v_add_f32_dpp v100, v100, v100 row_ror:8 row_mask:0xf bank_mask:0xf
v_add_f32_dpp v101, v101, v101 row_ror:8 row_mask:0xf bank_mask:0xf
v_add_f32_dpp v102, v102, v102 row_ror:8 row_mask:0xf bank_mask:0xf
v_add_f32_dpp v103, v103, v103 row_ror:8 row_mask:0xf bank_mask:0xf
v_mov_b32 v16, v96
v_mov_b32 v17, v97
v_mov_b32 v18, v98
v_mov_b32 v19, v99
v_mov_b32 v20, v100
v_mov_b32 v21, v101
v_mov_b32 v22, v102
v_mov_b32 v23, v103
v_permlane16_swap_b32 v96, v16
v_permlane16_swap_b32 v97, v17
v_permlane16_swap_b32 v98, v18
v_permlane16_swap_b32 v99, v19
v_permlane16_swap_b32 v100, v20
v_permlane16_swap_b32 v101, v21
v_permlane16_swap_b32 v102, v22
v_permlane16_swap_b32 v103, v23
v_add_f32 v96, v96, v16
v_add_f32 v97, v97, v17
v_add_f32 v98, v98, v18
v_add_f32 v99, v99, v19
v_add_f32 v100, v100, v20
v_add_f32 v101, v101, v21
v_add_f32 v102, v102, v22
v_add_f32 v103, v103, v23
v_mov_b32 v16, v96
v_mov_b32 v17, v97
v_mov_b32 v18, v98
v_mov_b32 v19, v99
v_mov_b32 v20, v100
v_mov_b32 v21, v101
v_mov_b32 v22, v102
v_mov_b32 v23, v103
v_permlane32_swap_b32 v96, v16
v_permlane32_swap_b32 v97, v17
v_permlane32_swap_b32 v98, v18
v_permlane32_swap_b32 v99, v19
v_permlane32_swap_b32 v100, v20
v_permlane32_swap_b32 v101, v21
v_permlane32_swap_b32 v102, v22
v_permlane32_swap_b32 v103, v23
v_add_f32 v96, v96, v16
v_add_f32 v97, v97, v17
v_add_f32 v98, v98, v18
v_add_f32 v99, v99, v19
v_add_f32 v100, v100, v20
v_add_f32 v101, v101, v21
v_add_f32 v102, v102, v22
v_add_f32 v103, v103, v23
s_lshl_b32 s40, s32, 8
v_lshl_add_u32 v2, v3, 5, s40
ds_write_b128 v2, v[96:99] offset:1024
ds_write_b128 v2, v[100:103] offset:1040
s_waitcnt lgkmcnt(0)
s_barrier
v_and_b32 v2, 63, v0
v_lshlrev_b32 v2, 2, v2
ds_read_b32 v96, v2 offset:1024
ds_read_b32 v97, v2 offset:1280
ds_read_b32 v98, v2 offset:1536
ds_read_b32 v99, v2 offset:1792
s_min_u32 s40, s32, 1
s_lshl_b32 s40, s40, 30
s_add_u32 s40, s40, s62
s_waitcnt lgkmcnt(0)
v_add_f32 v96, v96, v97
v_add_f32 v98, v98, v99
v_add_f32 v96, v96, v98
v_cvt_pk_bf16_f32 v96, 0, v96
buffer_store_dword v96, v2, s[4:7], s40 offen sc1
s_xor_b32 s60, s60, 0x62
s_nop 0
v_mov_b32 v96, 0
v_mov_b32 v97, 0
v_mov_b32 v98, 0
v_mov_b32 v99, 0
v_mov_b32 v100, 0
v_mov_b32 v101, 0
v_mov_b32 v102, 0
v_mov_b32 v103, 0
s_waitcnt vmcnt(32)
v_lshlrev_b32 v104, 16, v128
v_and_b32 v105, 0xffff0000, v128
v_fmac_f32 v96, v104, v32
v_fmac_f32 v97, v105, v32
v_lshlrev_b32 v104, 16, v129
v_and_b32 v105, 0xffff0000, v129
v_fmac_f32 v98, v104, v32
v_fmac_f32 v99, v105, v32
v_lshlrev_b32 v104, 16, v130
v_and_b32 v105, 0xffff0000, v130
v_fmac_f32 v100, v104, v32
v_fmac_f32 v101, v105, v32
v_lshlrev_b32 v104, 16, v131
v_and_b32 v105, 0xffff0000, v131
v_fmac_f32 v102, v104, v32
v_fmac_f32 v103, v105, v32
s_waitcnt vmcnt(31)
v_lshlrev_b32 v104, 16, v132
v_and_b32 v105, 0xffff0000, v132
v_fmac_f32 v96, v104, v33
v_fmac_f32 v97, v105, v33
v_lshlrev_b32 v104, 16, v133
v_and_b32 v105, 0xffff0000, v133
v_fmac_f32 v98, v104, v33
v_fmac_f32 v99, v105, v33
v_lshlrev_b32 v104, 16, v134
v_and_b32 v105, 0xffff0000, v134
v_fmac_f32 v100, v104, v33
v_fmac_f32 v101, v105, v33
v_lshlrev_b32 v104, 16, v135
v_and_b32 v105, 0xffff0000, v135
v_fmac_f32 v102, v104, v33
v_fmac_f32 v103, v105, v33
s_waitcnt vmcnt(30)
v_lshlrev_b32 v104, 16, v136
v_and_b32 v105, 0xffff0000, v136
v_fmac_f32 v96, v104, v34
v_fmac_f32 v97, v105, v34
v_lshlrev_b32 v104, 16, v137
v_and_b32 v105, 0xffff0000, v137
v_fmac_f32 v98, v104, v34
v_fmac_f32 v99, v105, v34
v_lshlrev_b32 v104, 16, v138
v_and_b32 v105, 0xffff0000, v138
v_fmac_f32 v100, v104, v34
v_fmac_f32 v101, v105, v34
v_lshlrev_b32 v104, 16, v139
v_and_b32 v105, 0xffff0000, v139
v_fmac_f32 v102, v104, v34
v_fmac_f32 v103, v105, v34
s_waitcnt vmcnt(29)
v_lshlrev_b32 v104, 16, v140
v_and_b32 v105, 0xffff0000, v140
v_fmac_f32 v96, v104, v35
v_fmac_f32 v97, v105, v35
v_lshlrev_b32 v104, 16, v141
v_and_b32 v105, 0xffff0000, v141
v_fmac_f32 v98, v104, v35
v_fmac_f32 v99, v105, v35
v_lshlrev_b32 v104, 16, v142
v_and_b32 v105, 0xffff0000, v142
v_fmac_f32 v100, v104, v35
v_fmac_f32 v101, v105, v35
v_lshlrev_b32 v104, 16, v143
v_and_b32 v105, 0xffff0000, v143
v_fmac_f32 v102, v104, v35
v_fmac_f32 v103, v105, v35
s_waitcnt vmcnt(28)
v_lshlrev_b32 v104, 16, v144
v_and_b32 v105, 0xffff0000, v144
v_fmac_f32 v96, v104, v36
v_fmac_f32 v97, v105, v36
v_lshlrev_b32 v104, 16, v145
v_and_b32 v105, 0xffff0000, v145
v_fmac_f32 v98, v104, v36
v_fmac_f32 v99, v105, v36
v_lshlrev_b32 v104, 16, v146
v_and_b32 v105, 0xffff0000, v146
v_fmac_f32 v100, v104, v36
v_fmac_f32 v101, v105, v36
v_lshlrev_b32 v104, 16, v147
v_and_b32 v105, 0xffff0000, v147
v_fmac_f32 v102, v104, v36
v_fmac_f32 v103, v105, v36
s_waitcnt vmcnt(27)
v_lshlrev_b32 v104, 16, v148
v_and_b32 v105, 0xffff0000, v148
v_fmac_f32 v96, v104, v37
v_fmac_f32 v97, v105, v37
v_lshlrev_b32 v104, 16, v149
v_and_b32 v105, 0xffff0000, v149
v_fmac_f32 v98, v104, v37
v_fmac_f32 v99, v105, v37
v_lshlrev_b32 v104, 16, v150
v_and_b32 v105, 0xffff0000, v150
v_fmac_f32 v100, v104, v37
v_fmac_f32 v101, v105, v37
v_lshlrev_b32 v104, 16, v151
v_and_b32 v105, 0xffff0000, v151
v_fmac_f32 v102, v104, v37
v_fmac_f32 v103, v105, v37
s_waitcnt vmcnt(26)
v_lshlrev_b32 v104, 16, v152
v_and_b32 v105, 0xffff0000, v152
v_fmac_f32 v96, v104, v38
v_fmac_f32 v97, v105, v38
v_lshlrev_b32 v104, 16, v153
v_and_b32 v105, 0xffff0000, v153
v_fmac_f32 v98, v104, v38
v_fmac_f32 v99, v105, v38
v_lshlrev_b32 v104, 16, v154
v_and_b32 v105, 0xffff0000, v154
v_fmac_f32 v100, v104, v38
v_fmac_f32 v101, v105, v38
v_lshlrev_b32 v104, 16, v155
v_and_b32 v105, 0xffff0000, v155
v_fmac_f32 v102, v104, v38
v_fmac_f32 v103, v105, v38
s_waitcnt vmcnt(25)
v_lshlrev_b32 v104, 16, v156
v_and_b32 v105, 0xffff0000, v156
v_fmac_f32 v96, v104, v39
v_fmac_f32 v97, v105, v39
v_lshlrev_b32 v104, 16, v157
v_and_b32 v105, 0xffff0000, v157
v_fmac_f32 v98, v104, v39
v_fmac_f32 v99, v105, v39
v_lshlrev_b32 v104, 16, v158
v_and_b32 v105, 0xffff0000, v158
v_fmac_f32 v100, v104, v39
v_fmac_f32 v101, v105, v39
v_lshlrev_b32 v104, 16, v159
v_and_b32 v105, 0xffff0000, v159
v_fmac_f32 v102, v104, v39
v_fmac_f32 v103, v105, v39
s_waitcnt vmcnt(24)
v_lshlrev_b32 v104, 16, v160
v_and_b32 v105, 0xffff0000, v160
v_fmac_f32 v96, v104, v40
v_fmac_f32 v97, v105, v40
v_lshlrev_b32 v104, 16, v161
v_and_b32 v105, 0xffff0000, v161
v_fmac_f32 v98, v104, v40
v_fmac_f32 v99, v105, v40
v_lshlrev_b32 v104, 16, v162
v_and_b32 v105, 0xffff0000, v162
v_fmac_f32 v100, v104, v40
v_fmac_f32 v101, v105, v40
v_lshlrev_b32 v104, 16, v163
v_and_b32 v105, 0xffff0000, v163
v_fmac_f32 v102, v104, v40
v_fmac_f32 v103, v105, v40
s_waitcnt vmcnt(23)
v_lshlrev_b32 v104, 16, v164
v_and_b32 v105, 0xffff0000, v164
v_fmac_f32 v96, v104, v41
v_fmac_f32 v97, v105, v41
v_lshlrev_b32 v104, 16, v165
v_and_b32 v105, 0xffff0000, v165
v_fmac_f32 v98, v104, v41
v_fmac_f32 v99, v105, v41
v_lshlrev_b32 v104, 16, v166
v_and_b32 v105, 0xffff0000, v166
v_fmac_f32 v100, v104, v41
v_fmac_f32 v101, v105, v41
v_lshlrev_b32 v104, 16, v167
v_and_b32 v105, 0xffff0000, v167
v_fmac_f32 v102, v104, v41
v_fmac_f32 v103, v105, v41
s_waitcnt vmcnt(22)
v_lshlrev_b32 v104, 16, v168
v_and_b32 v105, 0xffff0000, v168
v_fmac_f32 v96, v104, v42
v_fmac_f32 v97, v105, v42
v_lshlrev_b32 v104, 16, v169
v_and_b32 v105, 0xffff0000, v169
v_fmac_f32 v98, v104, v42
v_fmac_f32 v99, v105, v42
v_lshlrev_b32 v104, 16, v170
v_and_b32 v105, 0xffff0000, v170
v_fmac_f32 v100, v104, v42
v_fmac_f32 v101, v105, v42
v_lshlrev_b32 v104, 16, v171
v_and_b32 v105, 0xffff0000, v171
v_fmac_f32 v102, v104, v42
v_fmac_f32 v103, v105, v42
s_waitcnt vmcnt(21)
v_lshlrev_b32 v104, 16, v172
v_and_b32 v105, 0xffff0000, v172
v_fmac_f32 v96, v104, v43
v_fmac_f32 v97, v105, v43
v_lshlrev_b32 v104, 16, v173
v_and_b32 v105, 0xffff0000, v173
v_fmac_f32 v98, v104, v43
v_fmac_f32 v99, v105, v43
v_lshlrev_b32 v104, 16, v174
v_and_b32 v105, 0xffff0000, v174
v_fmac_f32 v100, v104, v43
v_fmac_f32 v101, v105, v43
v_lshlrev_b32 v104, 16, v175
v_and_b32 v105, 0xffff0000, v175
v_fmac_f32 v102, v104, v43
v_fmac_f32 v103, v105, v43
s_waitcnt vmcnt(20)
v_lshlrev_b32 v104, 16, v176
v_and_b32 v105, 0xffff0000, v176
v_fmac_f32 v96, v104, v44
v_fmac_f32 v97, v105, v44
v_lshlrev_b32 v104, 16, v177
v_and_b32 v105, 0xffff0000, v177
v_fmac_f32 v98, v104, v44
v_fmac_f32 v99, v105, v44
v_lshlrev_b32 v104, 16, v178
v_and_b32 v105, 0xffff0000, v178
v_fmac_f32 v100, v104, v44
v_fmac_f32 v101, v105, v44
v_lshlrev_b32 v104, 16, v179
v_and_b32 v105, 0xffff0000, v179
v_fmac_f32 v102, v104, v44
v_fmac_f32 v103, v105, v44
s_waitcnt vmcnt(19)
v_lshlrev_b32 v104, 16, v180
v_and_b32 v105, 0xffff0000, v180
v_fmac_f32 v96, v104, v45
v_fmac_f32 v97, v105, v45
v_lshlrev_b32 v104, 16, v181
v_and_b32 v105, 0xffff0000, v181
v_fmac_f32 v98, v104, v45
v_fmac_f32 v99, v105, v45
v_lshlrev_b32 v104, 16, v182
v_and_b32 v105, 0xffff0000, v182
v_fmac_f32 v100, v104, v45
v_fmac_f32 v101, v105, v45
v_lshlrev_b32 v104, 16, v183
v_and_b32 v105, 0xffff0000, v183
v_fmac_f32 v102, v104, v45
v_fmac_f32 v103, v105, v45
s_waitcnt vmcnt(18)
v_lshlrev_b32 v104, 16, v184
v_and_b32 v105, 0xffff0000, v184
v_fmac_f32 v96, v104, v46
v_fmac_f32 v97, v105, v46
v_lshlrev_b32 v104, 16, v185
v_and_b32 v105, 0xffff0000, v185
v_fmac_f32 v98, v104, v46
v_fmac_f32 v99, v105, v46
v_lshlrev_b32 v104, 16, v186
v_and_b32 v105, 0xffff0000, v186
v_fmac_f32 v100, v104, v46
v_fmac_f32 v101, v105, v46
v_lshlrev_b32 v104, 16, v187
v_and_b32 v105, 0xffff0000, v187
v_fmac_f32 v102, v104, v46
v_fmac_f32 v103, v105, v46
s_waitcnt vmcnt(17)
v_lshlrev_b32 v104, 16, v188
v_and_b32 v105, 0xffff0000, v188
v_fmac_f32 v96, v104, v47
v_fmac_f32 v97, v105, v47
v_lshlrev_b32 v104, 16, v189
v_and_b32 v105, 0xffff0000, v189
v_fmac_f32 v98, v104, v47
v_fmac_f32 v99, v105, v47
v_lshlrev_b32 v104, 16, v190
v_and_b32 v105, 0xffff0000, v190
v_fmac_f32 v100, v104, v47
v_fmac_f32 v101, v105, v47
v_lshlrev_b32 v104, 16, v191
v_and_b32 v105, 0xffff0000, v191
v_fmac_f32 v102, v104, v47
v_fmac_f32 v103, v105, v47
s_waitcnt vmcnt(16)
v_lshlrev_b32 v104, 16, v192
v_and_b32 v105, 0xffff0000, v192
v_fmac_f32 v96, v104, v48
v_fmac_f32 v97, v105, v48
v_lshlrev_b32 v104, 16, v193
v_and_b32 v105, 0xffff0000, v193
v_fmac_f32 v98, v104, v48
v_fmac_f32 v99, v105, v48
v_lshlrev_b32 v104, 16, v194
v_and_b32 v105, 0xffff0000, v194
v_fmac_f32 v100, v104, v48
v_fmac_f32 v101, v105, v48
v_lshlrev_b32 v104, 16, v195
v_and_b32 v105, 0xffff0000, v195
v_fmac_f32 v102, v104, v48
v_fmac_f32 v103, v105, v48
s_waitcnt vmcnt(15)
v_lshlrev_b32 v104, 16, v196
v_and_b32 v105, 0xffff0000, v196
v_fmac_f32 v96, v104, v49
v_fmac_f32 v97, v105, v49
v_lshlrev_b32 v104, 16, v197
v_and_b32 v105, 0xffff0000, v197
v_fmac_f32 v98, v104, v49
v_fmac_f32 v99, v105, v49
v_lshlrev_b32 v104, 16, v198
v_and_b32 v105, 0xffff0000, v198
v_fmac_f32 v100, v104, v49
v_fmac_f32 v101, v105, v49
v_lshlrev_b32 v104, 16, v199
v_and_b32 v105, 0xffff0000, v199
v_fmac_f32 v102, v104, v49
v_fmac_f32 v103, v105, v49
s_waitcnt vmcnt(14)
v_lshlrev_b32 v104, 16, v200
v_and_b32 v105, 0xffff0000, v200
v_fmac_f32 v96, v104, v50
v_fmac_f32 v97, v105, v50
v_lshlrev_b32 v104, 16, v201
v_and_b32 v105, 0xffff0000, v201
v_fmac_f32 v98, v104, v50
v_fmac_f32 v99, v105, v50
v_lshlrev_b32 v104, 16, v202
v_and_b32 v105, 0xffff0000, v202
v_fmac_f32 v100, v104, v50
v_fmac_f32 v101, v105, v50
v_lshlrev_b32 v104, 16, v203
v_and_b32 v105, 0xffff0000, v203
v_fmac_f32 v102, v104, v50
v_fmac_f32 v103, v105, v50
s_waitcnt vmcnt(13)
v_lshlrev_b32 v104, 16, v204
v_and_b32 v105, 0xffff0000, v204
v_fmac_f32 v96, v104, v51
v_fmac_f32 v97, v105, v51
v_lshlrev_b32 v104, 16, v205
v_and_b32 v105, 0xffff0000, v205
v_fmac_f32 v98, v104, v51
v_fmac_f32 v99, v105, v51
v_lshlrev_b32 v104, 16, v206
v_and_b32 v105, 0xffff0000, v206
v_fmac_f32 v100, v104, v51
v_fmac_f32 v101, v105, v51
v_lshlrev_b32 v104, 16, v207
v_and_b32 v105, 0xffff0000, v207
v_fmac_f32 v102, v104, v51
v_fmac_f32 v103, v105, v51
s_waitcnt vmcnt(12)
v_lshlrev_b32 v104, 16, v208
v_and_b32 v105, 0xffff0000, v208
v_fmac_f32 v96, v104, v52
v_fmac_f32 v97, v105, v52
v_lshlrev_b32 v104, 16, v209
v_and_b32 v105, 0xffff0000, v209
v_fmac_f32 v98, v104, v52
v_fmac_f32 v99, v105, v52
v_lshlrev_b32 v104, 16, v210
v_and_b32 v105, 0xffff0000, v210
v_fmac_f32 v100, v104, v52
v_fmac_f32 v101, v105, v52
v_lshlrev_b32 v104, 16, v211
v_and_b32 v105, 0xffff0000, v211
v_fmac_f32 v102, v104, v52
v_fmac_f32 v103, v105, v52
s_waitcnt vmcnt(11)
v_lshlrev_b32 v104, 16, v212
v_and_b32 v105, 0xffff0000, v212
v_fmac_f32 v96, v104, v53
v_fmac_f32 v97, v105, v53
v_lshlrev_b32 v104, 16, v213
v_and_b32 v105, 0xffff0000, v213
v_fmac_f32 v98, v104, v53
v_fmac_f32 v99, v105, v53
v_lshlrev_b32 v104, 16, v214
v_and_b32 v105, 0xffff0000, v214
v_fmac_f32 v100, v104, v53
v_fmac_f32 v101, v105, v53
v_lshlrev_b32 v104, 16, v215
v_and_b32 v105, 0xffff0000, v215
v_fmac_f32 v102, v104, v53
v_fmac_f32 v103, v105, v53
s_waitcnt vmcnt(10)
v_lshlrev_b32 v104, 16, v216
v_and_b32 v105, 0xffff0000, v216
v_fmac_f32 v96, v104, v54
v_fmac_f32 v97, v105, v54
v_lshlrev_b32 v104, 16, v217
v_and_b32 v105, 0xffff0000, v217
v_fmac_f32 v98, v104, v54
v_fmac_f32 v99, v105, v54
v_lshlrev_b32 v104, 16, v218
v_and_b32 v105, 0xffff0000, v218
v_fmac_f32 v100, v104, v54
v_fmac_f32 v101, v105, v54
v_lshlrev_b32 v104, 16, v219
v_and_b32 v105, 0xffff0000, v219
v_fmac_f32 v102, v104, v54
v_fmac_f32 v103, v105, v54
s_waitcnt vmcnt(9)
v_lshlrev_b32 v104, 16, v220
v_and_b32 v105, 0xffff0000, v220
v_fmac_f32 v96, v104, v55
v_fmac_f32 v97, v105, v55
v_lshlrev_b32 v104, 16, v221
v_and_b32 v105, 0xffff0000, v221
v_fmac_f32 v98, v104, v55
v_fmac_f32 v99, v105, v55
v_lshlrev_b32 v104, 16, v222
v_and_b32 v105, 0xffff0000, v222
v_fmac_f32 v100, v104, v55
v_fmac_f32 v101, v105, v55
v_lshlrev_b32 v104, 16, v223
v_and_b32 v105, 0xffff0000, v223
v_fmac_f32 v102, v104, v55
v_fmac_f32 v103, v105, v55
s_waitcnt vmcnt(8)
v_lshlrev_b32 v104, 16, v224
v_and_b32 v105, 0xffff0000, v224
v_fmac_f32 v96, v104, v56
v_fmac_f32 v97, v105, v56
v_lshlrev_b32 v104, 16, v225
v_and_b32 v105, 0xffff0000, v225
v_fmac_f32 v98, v104, v56
v_fmac_f32 v99, v105, v56
v_lshlrev_b32 v104, 16, v226
v_and_b32 v105, 0xffff0000, v226
v_fmac_f32 v100, v104, v56
v_fmac_f32 v101, v105, v56
v_lshlrev_b32 v104, 16, v227
v_and_b32 v105, 0xffff0000, v227
v_fmac_f32 v102, v104, v56
v_fmac_f32 v103, v105, v56
s_waitcnt vmcnt(7)
v_lshlrev_b32 v104, 16, v228
v_and_b32 v105, 0xffff0000, v228
v_fmac_f32 v96, v104, v57
v_fmac_f32 v97, v105, v57
v_lshlrev_b32 v104, 16, v229
v_and_b32 v105, 0xffff0000, v229
v_fmac_f32 v98, v104, v57
v_fmac_f32 v99, v105, v57
v_lshlrev_b32 v104, 16, v230
v_and_b32 v105, 0xffff0000, v230
v_fmac_f32 v100, v104, v57
v_fmac_f32 v101, v105, v57
v_lshlrev_b32 v104, 16, v231
v_and_b32 v105, 0xffff0000, v231
v_fmac_f32 v102, v104, v57
v_fmac_f32 v103, v105, v57
s_waitcnt vmcnt(6)
v_lshlrev_b32 v104, 16, v232
v_and_b32 v105, 0xffff0000, v232
v_fmac_f32 v96, v104, v58
v_fmac_f32 v97, v105, v58
v_lshlrev_b32 v104, 16, v233
v_and_b32 v105, 0xffff0000, v233
v_fmac_f32 v98, v104, v58
v_fmac_f32 v99, v105, v58
v_lshlrev_b32 v104, 16, v234
v_and_b32 v105, 0xffff0000, v234
v_fmac_f32 v100, v104, v58
v_fmac_f32 v101, v105, v58
v_lshlrev_b32 v104, 16, v235
v_and_b32 v105, 0xffff0000, v235
v_fmac_f32 v102, v104, v58
v_fmac_f32 v103, v105, v58
s_waitcnt vmcnt(5)
v_lshlrev_b32 v104, 16, v236
v_and_b32 v105, 0xffff0000, v236
v_fmac_f32 v96, v104, v59
v_fmac_f32 v97, v105, v59
v_lshlrev_b32 v104, 16, v237
v_and_b32 v105, 0xffff0000, v237
v_fmac_f32 v98, v104, v59
v_fmac_f32 v99, v105, v59
v_lshlrev_b32 v104, 16, v238
v_and_b32 v105, 0xffff0000, v238
v_fmac_f32 v100, v104, v59
v_fmac_f32 v101, v105, v59
v_lshlrev_b32 v104, 16, v239
v_and_b32 v105, 0xffff0000, v239
v_fmac_f32 v102, v104, v59
v_fmac_f32 v103, v105, v59
s_waitcnt vmcnt(4)
v_lshlrev_b32 v104, 16, v240
v_and_b32 v105, 0xffff0000, v240
v_fmac_f32 v96, v104, v60
v_fmac_f32 v97, v105, v60
v_lshlrev_b32 v104, 16, v241
v_and_b32 v105, 0xffff0000, v241
v_fmac_f32 v98, v104, v60
v_fmac_f32 v99, v105, v60
v_lshlrev_b32 v104, 16, v242
v_and_b32 v105, 0xffff0000, v242
v_fmac_f32 v100, v104, v60
v_fmac_f32 v101, v105, v60
v_lshlrev_b32 v104, 16, v243
v_and_b32 v105, 0xffff0000, v243
v_fmac_f32 v102, v104, v60
v_fmac_f32 v103, v105, v60
s_waitcnt vmcnt(3)
v_lshlrev_b32 v104, 16, v244
v_and_b32 v105, 0xffff0000, v244
v_fmac_f32 v96, v104, v61
v_fmac_f32 v97, v105, v61
v_lshlrev_b32 v104, 16, v245
v_and_b32 v105, 0xffff0000, v245
v_fmac_f32 v98, v104, v61
v_fmac_f32 v99, v105, v61
v_lshlrev_b32 v104, 16, v246
v_and_b32 v105, 0xffff0000, v246
v_fmac_f32 v100, v104, v61
v_fmac_f32 v101, v105, v61
v_lshlrev_b32 v104, 16, v247
v_and_b32 v105, 0xffff0000, v247
v_fmac_f32 v102, v104, v61
v_fmac_f32 v103, v105, v61
s_waitcnt vmcnt(2)
v_lshlrev_b32 v104, 16, v248
v_and_b32 v105, 0xffff0000, v248
v_fmac_f32 v96, v104, v62
v_fmac_f32 v97, v105, v62
v_lshlrev_b32 v104, 16, v249
v_and_b32 v105, 0xffff0000, v249
v_fmac_f32 v98, v104, v62
v_fmac_f32 v99, v105, v62
v_lshlrev_b32 v104, 16, v250
v_and_b32 v105, 0xffff0000, v250
v_fmac_f32 v100, v104, v62
v_fmac_f32 v101, v105, v62
v_lshlrev_b32 v104, 16, v251
v_and_b32 v105, 0xffff0000, v251
v_fmac_f32 v102, v104, v62
v_fmac_f32 v103, v105, v62
s_waitcnt vmcnt(1)
v_lshlrev_b32 v104, 16, v252
v_and_b32 v105, 0xffff0000, v252
v_fmac_f32 v96, v104, v63
v_fmac_f32 v97, v105, v63
v_lshlrev_b32 v104, 16, v253
v_and_b32 v105, 0xffff0000, v253
v_fmac_f32 v98, v104, v63
v_fmac_f32 v99, v105, v63
v_lshlrev_b32 v104, 16, v254
v_and_b32 v105, 0xffff0000, v254
v_fmac_f32 v100, v104, v63
v_fmac_f32 v101, v105, v63
v_lshlrev_b32 v104, 16, v255
v_and_b32 v105, 0xffff0000, v255
v_fmac_f32 v102, v104, v63
v_fmac_f32 v103, v105, v63
s_barrier
s_lshl_b32 s62, s60, 8
s_add_u32 s62, s62, 3145728
s_nop 1
v_add_f32_dpp v96, v96, v96 row_ror:8 row_mask:0xf bank_mask:0xf
v_add_f32_dpp v97, v97, v97 row_ror:8 row_mask:0xf bank_mask:0xf
v_add_f32_dpp v98, v98, v98 row_ror:8 row_mask:0xf bank_mask:0xf
v_add_f32_dpp v99, v99, v99 row_ror:8 row_mask:0xf bank_mask:0xf
v_add_f32_dpp v100, v100, v100 row_ror:8 row_mask:0xf bank_mask:0xf
v_add_f32_dpp v101, v101, v101 row_ror:8 row_mask:0xf bank_mask:0xf
v_add_f32_dpp v102, v102, v102 row_ror:8 row_mask:0xf bank_mask:0xf
v_add_f32_dpp v103, v103, v103 row_ror:8 row_mask:0xf bank_mask:0xf
v_mov_b32 v16, v96
v_mov_b32 v17, v97
v_mov_b32 v18, v98
v_mov_b32 v19, v99
v_mov_b32 v20, v100
v_mov_b32 v21, v101
v_mov_b32 v22, v102
v_mov_b32 v23, v103
v_permlane16_swap_b32 v96, v16
v_permlane16_swap_b32 v97, v17
v_permlane16_swap_b32 v98, v18
v_permlane16_swap_b32 v99, v19
v_permlane16_swap_b32 v100, v20
v_permlane16_swap_b32 v101, v21
v_permlane16_swap_b32 v102, v22
v_permlane16_swap_b32 v103, v23
v_add_f32 v96, v96, v16
v_add_f32 v97, v97, v17
v_add_f32 v98, v98, v18
v_add_f32 v99, v99, v19
v_add_f32 v100, v100, v20
v_add_f32 v101, v101, v21
v_add_f32 v102, v102, v22
v_add_f32 v103, v103, v23
v_mov_b32 v16, v96
v_mov_b32 v17, v97
v_mov_b32 v18, v98
v_mov_b32 v19, v99
v_mov_b32 v20, v100
v_mov_b32 v21, v101
v_mov_b32 v22, v102
v_mov_b32 v23, v103
v_permlane32_swap_b32 v96, v16
v_permlane32_swap_b32 v97, v17
v_permlane32_swap_b32 v98, v18
v_permlane32_swap_b32 v99, v19
v_permlane32_swap_b32 v100, v20
v_permlane32_swap_b32 v101, v21
v_permlane32_swap_b32 v102, v22
v_permlane32_swap_b32 v103, v23
v_add_f32 v96, v96, v16
v_add_f32 v97, v97, v17
v_add_f32 v98, v98, v18
v_add_f32 v99, v99, v19
v_add_f32 v100, v100, v20
v_add_f32 v101, v101, v21
v_add_f32 v102, v102, v22
v_add_f32 v103, v103, v23
s_lshl_b32 s40, s32, 8
v_lshl_add_u32 v2, v3, 5, s40
ds_write_b128 v2, v[96:99] offset:1024
ds_write_b128 v2, v[100:103] offset:1040
s_waitcnt lgkmcnt(0)
s_barrier
v_and_b32 v2, 63, v0
v_lshlrev_b32 v2, 2, v2
ds_read_b32 v96, v2 offset:1024
ds_read_b32 v97, v2 offset:1280
ds_read_b32 v98, v2 offset:1536
ds_read_b32 v99, v2 offset:1792
s_min_u32 s40, s32, 1
s_lshl_b32 s40, s40, 30
s_add_u32 s40, s40, s62
s_waitcnt lgkmcnt(0)
v_add_f32 v96, v96, v97
v_add_f32 v98, v98, v99
v_add_f32 v96, v96, v98
v_cvt_pk_bf16_f32 v96, 0, v96
buffer_store_dword v96, v2, s[4:7], s40 offen sc1
v_mov_b32 v4, v10
v_mov_b32 v5, 1
s_mov_b32 s38, 8192
s_waitcnt vmcnt(0)
buffer_store_dword v5, v4, s[4:7], s38 offen sc1
Lst_569:
buffer_load_dword v48, off, s[12:15], 0 offset:16 sc1
buffer_load_dword v49, off, s[12:15], 0 offset:144 sc1
s_waitcnt vmcnt(0)
v_add_u32 v48, v48, v49
s_nop 0
v_readfirstlane_b32 s38, v48
s_nop 3
s_and_b32 s39, s38, 0x200ffff
s_cmp_eq_u32 s39, 0x2000100
s_cbranch_scc1 Lso_570
s_sub_u32 s37, s37, 1
s_cbranch_scc1 Lend_7
s_sleep 8
s_branch Lst_569
Lso_570:
s_bfe_u32 s35, s38, 0x80010
s_bfe_u32 s46, s38, 0x10018
s_lshl_b32 s46, s46, 13
s_barrier
s_mul_i32 s50, s32, 4096
v_lshlrev_b32 v1, 4, v9
v_add_u32 v0, s50, v1
v_lshrrev_b32 v80, 2, v9
v_min_u32 v80, 7, v80
v_lshlrev_b32 v80, 7, v80
v_and_b32 v2, 3, v9
v_lshl_add_u32 v2, v2, 2, v80
s_lshl_b32 s47, s33, 10
s_add_u32 s47, s47, 3432448
v_mov_b32 v6, v1
s_lshl_b32 s38, s26, 2
s_add_u32 s38, s38, s32
s_lshl_b32 s38, s38, 11
s_lshl_b32 s49, s33, 22
s_add_u32 s49, s49, s38
s_add_u32 s49, s49, 117374976
s_lshl_b32 s54, s33, 16
s_add_u32 s54, s54, 83886080
s_lshl_b32 s45, s26, 18
s_add_u32 s45, s45, s54
s_add_u32 m0, s50, 0
s_add_u32 s39, s45, 0
buffer_load_dwordx4 v0, s[4:7], s39 offen offset:0 sc1 lds
buffer_load_dwordx4 v0, s[4:7], s39 offen offset:1024 sc1 lds
buffer_load_dwordx4 v0, s[4:7], s39 offen offset:2048 sc1 lds
buffer_load_dwordx4 v0, s[4:7], s39 offen offset:3072 sc1 lds
s_add_u32 m0, s50, 16384
s_add_u32 s39, s45, 16384
buffer_load_dwordx4 v0, s[4:7], s39 offen offset:0 sc1 lds
buffer_load_dwordx4 v0, s[4:7], s39 offen offset:1024 sc1 lds
buffer_load_dwordx4 v0, s[4:7], s39 offen offset:2048 sc1 lds
buffer_load_dwordx4 v0, s[4:7], s39 offen offset:3072 sc1 lds
s_add_u32 m0, s50, 32768
s_add_u32 s39, s45, 32768
buffer_load_dwordx4 v0, s[4:7], s39 offen offset:0 sc1 lds
buffer_load_dwordx4 v0, s[4:7], s39 offen offset:1024 sc1 lds
buffer_load_dwordx4 v0, s[4:7], s39 offen offset:2048 sc1 lds
buffer_load_dwordx4 v0, s[4:7], s39 offen offset:3072 sc1 lds
s_add_u32 m0, s50, 49152
s_add_u32 s39, s45, 49152
buffer_load_dwordx4 v0, s[4:7], s39 offen offset:0 sc1 lds
buffer_load_dwordx4 v0, s[4:7], s39 offen offset:1024 sc1 lds
buffer_load_dwordx4 v0, s[4:7], s39 offen offset:2048 sc1 lds
buffer_load_dwordx4 v0, s[4:7], s39 offen offset:3072 sc1 lds
v_mov_b32 v8, 0
v_mov_b32 v80, -1
v_mov_b32 v81, -1
v_mov_b32 v82, -1
v_mov_b32 v83, -1
s_add_u32 s38, s49, 3997696
buffer_store_dwordx4 v[80:83], v6, s[4:7], s38 offen offset:0 sc1
buffer_store_dwordx4 v[80:83], v6, s[4:7], s38 offen offset:1024 sc1
s_add_u32 s38, s49, 4063232
buffer_store_dwordx4 v[80:83], v6, s[4:7], s38 offen offset:0 sc1
buffer_store_dwordx4 v[80:83], v6, s[4:7], s38 offen offset:1024 sc1
s_add_u32 s38, s49, 4128768
buffer_store_dwordx4 v[80:83], v6, s[4:7], s38 offen offset:0 sc1
buffer_store_dwordx4 v[80:83], v6, s[4:7], s38 offen offset:1024 sc1
s_add_u32 s38, s49, 4194304
buffer_store_dwordx4 v[80:83], v6, s[4:7], s38 offen offset:0 sc1
buffer_store_dwordx4 v[80:83], v6, s[4:7], s38 offen offset:1024 sc1
s_mov_b32 s36, 0
s_add_u32 s48, s36, 1
Lsw_571:
Lbw_576:
buffer_load_dword v3, v2, s[4:7], s47 offen sc1
s_waitcnt vmcnt(0)
v_cmp_gt_u32 vcc, s48, v3
s_cbranch_vccz Lbo_577
s_sub_u32 s37, s37, 1
s_cbranch_scc1 Lend_7
s_sleep 1
s_branch Lbw_576
Lbo_577:
s_add_u32 m0, s50, 0
s_add_u32 s39, s54, 0
buffer_load_dwordx4 v0, s[4:7], s39 offen offset:0 sc1 lds
buffer_load_dwordx4 v0, s[4:7], s39 offen offset:1024 sc1 lds
buffer_load_dwordx4 v0, s[4:7], s39 offen offset:2048 sc1 lds
buffer_load_dwordx4 v0, s[4:7], s39 offen offset:3072 sc1 lds
s_add_u32 m0, s50, 16384
s_add_u32 s39, s54, 16384
buffer_load_dwordx4 v0, s[4:7], s39 offen offset:0 sc1 lds
buffer_load_dwordx4 v0, s[4:7], s39 offen offset:1024 sc1 lds
buffer_load_dwordx4 v0, s[4:7], s39 offen offset:2048 sc1 lds
buffer_load_dwordx4 v0, s[4:7], s39 offen offset:3072 sc1 lds
s_add_u32 m0, s50, 32768
s_add_u32 s39, s54, 32768
buffer_load_dwordx4 v0, s[4:7], s39 offen offset:0 sc1 lds
buffer_load_dwordx4 v0, s[4:7], s39 offen offset:1024 sc1 lds
buffer_load_dwordx4 v0, s[4:7], s39 offen offset:2048 sc1 lds
buffer_load_dwordx4 v0, s[4:7], s39 offen offset:3072 sc1 lds
s_add_u32 m0, s50, 49152
s_add_u32 s39, s54, 49152
buffer_load_dwordx4 v0, s[4:7], s39 offen offset:0 sc1 lds
buffer_load_dwordx4 v0, s[4:7], s39 offen offset:1024 sc1 lds
buffer_load_dwordx4 v0, s[4:7], s39 offen offset:2048 sc1 lds
buffer_load_dwordx4 v0, s[4:7], s39 offen offset:3072 sc1 lds
buffer_load_dword v3, v2, s[4:7], s47 offen sc1
Lse_572:
s_waitcnt vmcnt(13)
s_barrier
ds_read_b128 v[16:19], v1 offset:0
ds_read_b128 v[20:23], v1 offset:1024
ds_read_b128 v[24:27], v1 offset:2048
ds_read_b128 v[28:31], v1 offset:3072
ds_read_b128 v[32:35], v1 offset:4096
ds_read_b128 v[36:39], v1 offset:5120
ds_read_b128 v[40:43], v1 offset:6144
s_add_u32 s54, s54, 262144
s_bitset0_b32 s54, 21
s_xor_b32 s50, s50, 0x10000
s_add_u32 s49, s49, 65536
s_add_u32 s36, s36, 1
s_add_u32 s48, s36, 1
s_waitcnt lgkmcnt(5)
v_mfma_f32_16x16x32_bf16 v[48:51], a[0:3], v[16:19], 0
ds_read_b128 v[44:47], v1 offset:7168
v_mfma_f32_16x16x32_bf16 v[52:55], a[128:131], v[16:19], 0
v_mfma_f32_16x16x32_bf16 v[56:59], a[0:3], v[20:23], 0
ds_read_b128 v[16:19], v1 offset:8192
v_mfma_f32_16x16x32_bf16 v[60:63], a[128:131], v[20:23], 0
s_waitcnt lgkmcnt(5)
v_mfma_f32_16x16x32_bf16 v[48:51], a[4:7], v[24:27], v[48:51]
ds_read_b128 v[20:23], v1 offset:9216
v_mfma_f32_16x16x32_bf16 v[52:55], a[132:135], v[24:27], v[52:55]
v_mfma_f32_16x16x32_bf16 v[56:59], a[4:7], v[28:31], v[56:59]
ds_read_b128 v[24:27], v1 offset:10240
v_mfma_f32_16x16x32_bf16 v[60:63], a[132:135], v[28:31], v[60:63]
s_waitcnt lgkmcnt(5)
v_mfma_f32_16x16x32_bf16 v[48:51], a[8:11], v[32:35], v[48:51]
ds_read_b128 v[28:31], v1 offset:11264
v_mfma_f32_16x16x32_bf16 v[52:55], a[136:139], v[32:35], v[52:55]
v_mfma_f32_16x16x32_bf16 v[56:59], a[8:11], v[36:39], v[56:59]
ds_read_b128 v[32:35], v1 offset:12288
v_mfma_f32_16x16x32_bf16 v[60:63], a[136:139], v[36:39], v[60:63]
s_waitcnt lgkmcnt(5)
v_mfma_f32_16x16x32_bf16 v[48:51], a[12:15], v[40:43], v[48:51]
ds_read_b128 v[36:39], v1 offset:13312
v_mfma_f32_16x16x32_bf16 v[52:55], a[140:143], v[40:43], v[52:55]
v_mfma_f32_16x16x32_bf16 v[56:59], a[12:15], v[44:47], v[56:59]
ds_read_b128 v[40:43], v1 offset:14336
v_mfma_f32_16x16x32_bf16 v[60:63], a[140:143], v[44:47], v[60:63]
s_waitcnt lgkmcnt(5)
v_mfma_f32_16x16x32_bf16 v[48:51], a[16:19], v[16:19], v[48:51]
ds_read_b128 v[44:47], v1 offset:15360
v_mfma_f32_16x16x32_bf16 v[52:55], a[144:147], v[16:19], v[52:55]
v_mfma_f32_16x16x32_bf16 v[56:59], a[16:19], v[20:23], v[56:59]
s_waitcnt vmcnt(9)
s_barrier
ds_read_b128 v[16:19], v1 offset:16384
v_mfma_f32_16x16x32_bf16 v[60:63], a[144:147], v[20:23], v[60:63]
s_waitcnt lgkmcnt(5)
v_mfma_f32_16x16x32_bf16 v[48:51], a[20:23], v[24:27], v[48:51]
ds_read_b128 v[20:23], v1 offset:17408
v_mfma_f32_16x16x32_bf16 v[52:55], a[148:151], v[24:27], v[52:55]
v_mfma_f32_16x16x32_bf16 v[56:59], a[20:23], v[28:31], v[56:59]
ds_read_b128 v[24:27], v1 offset:18432
v_mfma_f32_16x16x32_bf16 v[60:63], a[148:151], v[28:31], v[60:63]
s_waitcnt lgkmcnt(5)
v_mfma_f32_16x16x32_bf16 v[48:51], a[24:27], v[32:35], v[48:51]
ds_read_b128 v[28:31], v1 offset:19456
v_mfma_f32_16x16x32_bf16 v[52:55], a[152:155], v[32:35], v[52:55]
v_mfma_f32_16x16x32_bf16 v[56:59], a[24:27], v[36:39], v[56:59]
ds_read_b128 v[32:35], v1 offset:20480
v_mfma_f32_16x16x32_bf16 v[60:63], a[152:155], v[36:39], v[60:63]
s_waitcnt lgkmcnt(5)
v_mfma_f32_16x16x32_bf16 v[48:51], a[28:31], v[40:43], v[48:51]
ds_read_b128 v[36:39], v1 offset:21504
v_mfma_f32_16x16x32_bf16 v[52:55], a[156:159], v[40:43], v[52:55]
v_mfma_f32_16x16x32_bf16 v[56:59], a[28:31], v[44:47], v[56:59]
ds_read_b128 v[40:43], v1 offset:22528
v_mfma_f32_16x16x32_bf16 v[60:63], a[156:159], v[44:47], v[60:63]
s_waitcnt lgkmcnt(5)
v_mfma_f32_16x16x32_bf16 v[48:51], a[32:35], v[16:19], v[48:51]
ds_read_b128 v[44:47], v1 offset:23552
v_mfma_f32_16x16x32_bf16 v[52:55], a[160:163], v[16:19], v[52:55]
v_mfma_f32_16x16x32_bf16 v[56:59], a[32:35], v[20:23], v[56:59]
ds_read_b128 v[16:19], v1 offset:24576
v_mfma_f32_16x16x32_bf16 v[60:63], a[160:163], v[20:23], v[60:63]
s_waitcnt lgkmcnt(5)
v_mfma_f32_16x16x32_bf16 v[48:51], a[36:39], v[24:27], v[48:51]
ds_read_b128 v[20:23], v1 offset:25600
v_mfma_f32_16x16x32_bf16 v[52:55], a[164:167], v[24:27], v[52:55]
v_mfma_f32_16x16x32_bf16 v[56:59], a[36:39], v[28:31], v[56:59]
ds_read_b128 v[24:27], v1 offset:26624
v_mfma_f32_16x16x32_bf16 v[60:63], a[164:167], v[28:31], v[60:63]
s_waitcnt lgkmcnt(5)
v_mfma_f32_16x16x32_bf16 v[48:51], a[40:43], v[32:35], v[48:51]
ds_read_b128 v[28:31], v1 offset:27648
v_mfma_f32_16x16x32_bf16 v[52:55], a[168:171], v[32:35], v[52:55]
v_mfma_f32_16x16x32_bf16 v[56:59], a[40:43], v[36:39], v[56:59]
ds_read_b128 v[32:35], v1 offset:28672
v_mfma_f32_16x16x32_bf16 v[60:63], a[168:171], v[36:39], v[60:63]
s_waitcnt lgkmcnt(5)
v_mfma_f32_16x16x32_bf16 v[48:51], a[44:47], v[40:43], v[48:51]
ds_read_b128 v[36:39], v1 offset:29696
v_mfma_f32_16x16x32_bf16 v[52:55], a[172:175], v[40:43], v[52:55]
v_mfma_f32_16x16x32_bf16 v[56:59], a[44:47], v[44:47], v[56:59]
ds_read_b128 v[40:43], v1 offset:30720
v_mfma_f32_16x16x32_bf16 v[60:63], a[172:175], v[44:47], v[60:63]
s_waitcnt lgkmcnt(5)
v_mfma_f32_16x16x32_bf16 v[48:51], a[48:51], v[16:19], v[48:51]
ds_read_b128 v[44:47], v1 offset:31744
v_mfma_f32_16x16x32_bf16 v[52:55], a[176:179], v[16:19], v[52:55]
v_mfma_f32_16x16x32_bf16 v[56:59], a[48:51], v[20:23], v[56:59]
s_waitcnt vmcnt(5)
s_barrier
ds_read_b128 v[16:19], v1 offset:32768
v_mfma_f32_16x16x32_bf16 v[60:63], a[176:179], v[20:23], v[60:63]
s_waitcnt lgkmcnt(5)
v_mfma_f32_16x16x32_bf16 v[48:51], a[52:55], v[24:27], v[48:51]
ds_read_b128 v[20:23], v1 offset:33792
v_mfma_f32_16x16x32_bf16 v[52:55], a[180:183], v[24:27], v[52:55]
v_mfma_f32_16x16x32_bf16 v[56:59], a[52:55], v[28:31], v[56:59]
ds_read_b128 v[24:27], v1 offset:34816
v_mfma_f32_16x16x32_bf16 v[60:63], a[180:183], v[28:31], v[60:63]
s_waitcnt lgkmcnt(5)
v_mfma_f32_16x16x32_bf16 v[48:51], a[56:59], v[32:35], v[48:51]
ds_read_b128 v[28:31], v1 offset:35840
v_mfma_f32_16x16x32_bf16 v[52:55], a[184:187], v[32:35], v[52:55]
v_mfma_f32_16x16x32_bf16 v[56:59], a[56:59], v[36:39], v[56:59]
ds_read_b128 v[32:35], v1 offset:36864
v_mfma_f32_16x16x32_bf16 v[60:63], a[184:187], v[36:39], v[60:63]
s_waitcnt lgkmcnt(5)
v_mfma_f32_16x16x32_bf16 v[48:51], a[60:63], v[40:43], v[48:51]
ds_read_b128 v[36:39], v1 offset:37888
v_mfma_f32_16x16x32_bf16 v[52:55], a[188:191], v[40:43], v[52:55]
v_mfma_f32_16x16x32_bf16 v[56:59], a[60:63], v[44:47], v[56:59]
ds_read_b128 v[40:43], v1 offset:38912
v_mfma_f32_16x16x32_bf16 v[60:63], a[188:191], v[44:47], v[60:63]
s_waitcnt lgkmcnt(5)
v_mfma_f32_16x16x32_bf16 v[48:51], a[64:67], v[16:19], v[48:51]
ds_read_b128 v[44:47], v1 offset:39936
v_mfma_f32_16x16x32_bf16 v[52:55], a[192:195], v[16:19], v[52:55]
v_mfma_f32_16x16x32_bf16 v[56:59], a[64:67], v[20:23], v[56:59]
ds_read_b128 v[16:19], v1 offset:40960
v_mfma_f32_16x16x32_bf16 v[60:63], a[192:195], v[20:23], v[60:63]
s_waitcnt lgkmcnt(5)
v_mfma_f32_16x16x32_bf16 v[48:51], a[68:71], v[24:27], v[48:51]
ds_read_b128 v[20:23], v1 offset:41984
v_mfma_f32_16x16x32_bf16 v[52:55], a[196:199], v[24:27], v[52:55]
v_mfma_f32_16x16x32_bf16 v[56:59], a[68:71], v[28:31], v[56:59]
ds_read_b128 v[24:27], v1 offset:43008
v_mfma_f32_16x16x32_bf16 v[60:63], a[196:199], v[28:31], v[60:63]
s_waitcnt lgkmcnt(5)
v_mfma_f32_16x16x32_bf16 v[48:51], a[72:75], v[32:35], v[48:51]
ds_read_b128 v[28:31], v1 offset:44032
v_mfma_f32_16x16x32_bf16 v[52:55], a[200:203], v[32:35], v[52:55]
v_mfma_f32_16x16x32_bf16 v[56:59], a[72:75], v[36:39], v[56:59]
ds_read_b128 v[32:35], v1 offset:45056
v_mfma_f32_16x16x32_bf16 v[60:63], a[200:203], v[36:39], v[60:63]
s_waitcnt lgkmcnt(5)
v_mfma_f32_16x16x32_bf16 v[48:51], a[76:79], v[40:43], v[48:51]
ds_read_b128 v[36:39], v1 offset:46080
v_mfma_f32_16x16x32_bf16 v[52:55], a[204:207], v[40:43], v[52:55]
v_mfma_f32_16x16x32_bf16 v[56:59], a[76:79], v[44:47], v[56:59]
ds_read_b128 v[40:43], v1 offset:47104
v_mfma_f32_16x16x32_bf16 v[60:63], a[204:207], v[44:47], v[60:63]
s_waitcnt lgkmcnt(5)
v_mfma_f32_16x16x32_bf16 v[48:51], a[80:83], v[16:19], v[48:51]
ds_read_b128 v[44:47], v1 offset:48128
v_mfma_f32_16x16x32_bf16 v[52:55], a[208:211], v[16:19], v[52:55]
v_mfma_f32_16x16x32_bf16 v[56:59], a[80:83], v[20:23], v[56:59]
s_waitcnt vmcnt(1)
s_barrier
ds_read_b128 v[16:19], v1 offset:49152
v_mfma_f32_16x16x32_bf16 v[60:63], a[208:211], v[20:23], v[60:63]
s_waitcnt lgkmcnt(5)
buffer_load_dword v3, v2, s[4:7], s47 offen sc1
v_mfma_f32_16x16x32_bf16 v[48:51], a[84:87], v[24:27], v[48:51]
ds_read_b128 v[20:23], v1 offset:50176
v_mfma_f32_16x16x32_bf16 v[52:55], a[212:215], v[24:27], v[52:55]
v_mfma_f32_16x16x32_bf16 v[56:59], a[84:87], v[28:31], v[56:59]
ds_read_b128 v[24:27], v1 offset:51200
v_mfma_f32_16x16x32_bf16 v[60:63], a[212:215], v[28:31], v[60:63]
s_waitcnt lgkmcnt(5)
v_mfma_f32_16x16x32_bf16 v[48:51], a[88:91], v[32:35], v[48:51]
ds_read_b128 v[28:31], v1 offset:52224
v_mov_b32 v10, s36
v_mfma_f32_16x16x32_bf16 v[52:55], a[216:219], v[32:35], v[52:55]
s_and_b32 s38, s36, 1
s_lshl_b32 s38, s38, 12
s_cmp_gt_u32 s36, 60
v_mfma_f32_16x16x32_bf16 v[56:59], a[88:91], v[36:39], v[56:59]
s_cselect_b32 s38, s38, 0x70000000
ds_read_b128 v[32:35], v1 offset:53248
buffer_store_dword v10, v4, s[4:7], s38 offen sc1
v_mfma_f32_16x16x32_bf16 v[60:63], a[216:219], v[36:39], v[60:63]
s_waitcnt lgkmcnt(5)
v_mfma_f32_16x16x32_bf16 v[48:51], a[92:95], v[40:43], v[48:51]
ds_read_b128 v[36:39], v1 offset:54272
v_mfma_f32_16x16x32_bf16 v[52:55], a[220:223], v[40:43], v[52:55]
v_mfma_f32_16x16x32_bf16 v[56:59], a[92:95], v[44:47], v[56:59]
ds_read_b128 v[40:43], v1 offset:55296
v_mfma_f32_16x16x32_bf16 v[60:63], a[220:223], v[44:47], v[60:63]
s_waitcnt lgkmcnt(5)
v_mfma_f32_16x16x32_bf16 v[48:51], a[96:99], v[16:19], v[48:51]
ds_read_b128 v[44:47], v1 offset:56320
v_mfma_f32_16x16x32_bf16 v[52:55], a[224:227], v[16:19], v[52:55]
v_mfma_f32_16x16x32_bf16 v[56:59], a[96:99], v[20:23], v[56:59]
ds_read_b128 v[16:19], v1 offset:57344
v_mfma_f32_16x16x32_bf16 v[60:63], a[224:227], v[20:23], v[60:63]
s_waitcnt lgkmcnt(5)
v_mfma_f32_16x16x32_bf16 v[48:51], a[100:103], v[24:27], v[48:51]
ds_read_b128 v[20:23], v1 offset:58368
v_mfma_f32_16x16x32_bf16 v[52:55], a[228:231], v[24:27], v[52:55]
v_mfma_f32_16x16x32_bf16 v[56:59], a[100:103], v[28:31], v[56:59]
ds_read_b128 v[24:27], v1 offset:59392
v_mfma_f32_16x16x32_bf16 v[60:63], a[228:231], v[28:31], v[60:63]
s_waitcnt lgkmcnt(5)
v_mfma_f32_16x16x32_bf16 v[48:51], a[104:107], v[32:35], v[48:51]
ds_read_b128 v[28:31], v1 offset:60416
v_mfma_f32_16x16x32_bf16 v[52:55], a[232:235], v[32:35], v[52:55]
v_mfma_f32_16x16x32_bf16 v[56:59], a[104:107], v[36:39], v[56:59]
ds_read_b128 v[32:35], v1 offset:61440
v_mfma_f32_16x16x32_bf16 v[60:63], a[232:235], v[36:39], v[60:63]
s_waitcnt lgkmcnt(5)
v_mfma_f32_16x16x32_bf16 v[48:51], a[108:111], v[40:43], v[48:51]
ds_read_b128 v[36:39], v1 offset:62464
v_mfma_f32_16x16x32_bf16 v[52:55], a[236:239], v[40:43], v[52:55]
v_mfma_f32_16x16x32_bf16 v[56:59], a[108:111], v[44:47], v[56:59]
ds_read_b128 v[40:43], v1 offset:63488
v_mfma_f32_16x16x32_bf16 v[60:63], a[236:239], v[44:47], v[60:63]
s_waitcnt lgkmcnt(5)
v_mfma_f32_16x16x32_bf16 v[48:51], a[112:115], v[16:19], v[48:51]
ds_read_b128 v[44:47], v1 offset:64512
v_mfma_f32_16x16x32_bf16 v[52:55], a[240:243], v[16:19], v[52:55]
v_mfma_f32_16x16x32_bf16 v[56:59], a[112:115], v[20:23], v[56:59]
v_mfma_f32_16x16x32_bf16 v[60:63], a[240:243], v[20:23], v[60:63]
s_waitcnt lgkmcnt(4)
v_mfma_f32_16x16x32_bf16 v[48:51], a[116:119], v[24:27], v[48:51]
v_mfma_f32_16x16x32_bf16 v[52:55], a[244:247], v[24:27], v[52:55]
v_mfma_f32_16x16x32_bf16 v[56:59], a[116:119], v[28:31], v[56:59]
v_mfma_f32_16x16x32_bf16 v[60:63], a[244:247], v[28:31], v[60:63]
s_waitcnt lgkmcnt(2)
v_mfma_f32_16x16x32_bf16 v[48:51], a[120:123], v[32:35], v[48:51]
v_mfma_f32_16x16x32_bf16 v[52:55], a[248:251], v[32:35], v[52:55]
v_mfma_f32_16x16x32_bf16 v[56:59], a[120:123], v[36:39], v[56:59]
v_mfma_f32_16x16x32_bf16 v[60:63], a[248:251], v[36:39], v[60:63]
s_waitcnt lgkmcnt(0)
v_mfma_f32_16x16x32_bf16 v[48:51], a[124:127], v[40:43], v[48:51]
v_mfma_f32_16x16x32_bf16 v[52:55], a[252:255], v[40:43], v[52:55]
v_mfma_f32_16x16x32_bf16 v[56:59], a[124:127], v[44:47], v[56:59]
v_mfma_f32_16x16x32_bf16 v[60:63], a[252:255], v[44:47], v[60:63]
v_xor_b32 v1, 0x10000, v1
v_mov_b32 v5, s36
s_waitcnt vmcnt(1)
v_cmp_gt_u32 vcc, s48, v3
v_add_u32 v8, 1, v8
s_cmp_lg_u32 s35, 0
s_cbranch_scc1 Llf_578
buffer_store_dword v8, v7, s[4:7], 0 offen
s_branch Llo_579
Llf_578:
buffer_store_dword v8, v7, s[4:7], 0 offen sc1
Llo_579:
s_nop 3
v_cvt_pk_bf16_f32 v80, v48, v49
v_cvt_pk_bf16_f32 v81, v50, v51
v_cvt_pk_bf16_f32 v82, v52, v53
v_cvt_pk_bf16_f32 v83, v54, v55
buffer_store_dwordx4 v[80:83], v6, s[4:7], s49 offen offset:0 sc1
v_cvt_pk_bf16_f32 v84, v56, v57
v_cvt_pk_bf16_f32 v85, v58, v59
v_cvt_pk_bf16_f32 v86, v60, v61
v_cvt_pk_bf16_f32 v87, v62, v63
buffer_store_dwordx4 v[84:87], v6, s[4:7], s49 offen offset:1024 sc1
s_mov_b32 s46, 0
s_cbranch_vccnz Lsk_574
s_mov_b32 s46, 1
s_add_u32 m0, s50, 0
s_add_u32 s39, s54, 0
buffer_load_dwordx4 v0, s[4:7], s39 offen offset:0 sc1 lds
buffer_load_dwordx4 v0, s[4:7], s39 offen offset:1024 sc1 lds
buffer_load_dwordx4 v0, s[4:7], s39 offen offset:2048 sc1 lds
buffer_load_dwordx4 v0, s[4:7], s39 offen offset:3072 sc1 lds
s_add_u32 m0, s50, 16384
s_add_u32 s39, s54, 16384
buffer_load_dwordx4 v0, s[4:7], s39 offen offset:0 sc1 lds
buffer_load_dwordx4 v0, s[4:7], s39 offen offset:1024 sc1 lds
buffer_load_dwordx4 v0, s[4:7], s39 offen offset:2048 sc1 lds
buffer_load_dwordx4 v0, s[4:7], s39 offen offset:3072 sc1 lds
s_add_u32 m0, s50, 32768
s_add_u32 s39, s54, 32768
buffer_load_dwordx4 v0, s[4:7], s39 offen offset:0 sc1 lds
buffer_load_dwordx4 v0, s[4:7], s39 offen offset:1024 sc1 lds
buffer_load_dwordx4 v0, s[4:7], s39 offen offset:2048 sc1 lds
buffer_load_dwordx4 v0, s[4:7], s39 offen offset:3072 sc1 lds
s_add_u32 m0, s50, 49152
s_add_u32 s39, s54, 49152
buffer_load_dwordx4 v0, s[4:7], s39 offen offset:0 sc1 lds
buffer_load_dwordx4 v0, s[4:7], s39 offen offset:1024 sc1 lds
buffer_load_dwordx4 v0, s[4:7], s39 offen offset:2048 sc1 lds
buffer_load_dwordx4 v0, s[4:7], s39 offen offset:3072 sc1 lds
s_waitcnt vmcnt(16)
s_branch Lsj_575
Lsk_574:
s_waitcnt vmcnt(0)
Lsj_575:
s_barrier
s_and_b32 s38, s36, 1
s_lshl_b32 s38, s38, 12
buffer_store_dword v5, v4, s[4:7], s38 offen sc1
s_cmp_eq_u32 s36, 64
s_cbranch_scc1 Lso_573
s_cmp_lg_u32 s46, 0
s_cbranch_scc1 Lse_572
s_branch Lsw_571
Lso_573:
s_waitcnt vmcnt(0)
s_or_b32 s38, s26, s32
s_cbranch_scc1 Lend_7
buffer_wbl2 sc1
s_waitcnt vmcnt(0)
s_endpgm
Lhi_4:
s_cmp_ge_u32 s34, 16
s_cbranch_scc1 Lhelper_5
v_mov_b32 v9, v1
s_sub_u32 s44, s33, 4
s_lshl_b32 s44, s44, 4
s_and_b32 s38, s34, 7
s_lshl_b32 s38, s38, 1
s_add_u32 s44, s44, s38
s_lshr_b32 s38, s34, 3
s_xor_b32 s38, s38, 1
s_add_u32 s44, s44, s38
s_lshl_b32 s38, s44, 7
s_add_u32 s38, s38, 3407872
v_min_u32 v80, 1, v0
v_lshl_add_u32 v4, v80, 30, s38
v_mov_b32 v5, 0
buffer_store_dword v5, v4, s[4:7], 0 offen sc1
s_mov_b32 s52, 1
s_waitcnt vmcnt(0)
s_cmp_lg_u32 s32, 0
s_cbranch_scc1 Lar_580
s_mov_b64 exec, 1
v_mov_b32 v48, 144
v_mov_b32 v49, s52
buffer_atomic_add v49, v48, s[12:15], 0 offen sc1
s_mov_b64 exec, -1
Lar_580:
s_mov_b32 s8, s18
s_and_b32 s9, s19, 0xffff
s_mov_b32 s10, 0x800000
s_mov_b32 s11, 0x20000
s_mov_b32 s84, s20
s_and_b32 s85, s21, 0xffff
s_mov_b32 s86, 0x800000
s_mov_b32 s87, 0x20000
s_mov_b32 s88, s22
s_and_b32 s89, s23, 0xffff
s_mov_b32 s90, 0x800000
s_mov_b32 s91, 0x20000
s_lshl_b32 s60, s44, 7
s_xor_b32 s61, s60, 512
s_xor_b32 s62, s60, 256
s_and_b32 s52, s32, 1
s_lshl_b32 s52, s52, 6
v_bfe_u32 v84, v9, 2, 2
v_lshrrev_b32 v85, 4, v9
v_lshl_add_u32 v84, v85, 3, v84
v_lshl_add_u32 v84, v84, 7, s52
v_and_b32 v85, 3, v9
v_lshl_add_u32 v84, v85, 3, v84
v_add_u32 v80, 0, v84
v_bfe_u32 v84, v9, 2, 2
v_lshrrev_b32 v85, 4, v9
v_lshl_add_u32 v84, v85, 3, v84
v_lshl_add_u32 v84, v84, 7, s52
v_and_b32 v85, 3, v9
v_lshl_add_u32 v84, v85, 3, v84
v_add_u32 v81, 32, v84
s_lshl_b32 s52, s32, 5
v_bfe_u32 v84, v9, 2, 2
v_lshrrev_b32 v85, 4, v9
v_lshl_add_u32 v84, v85, 3, v84
v_lshl_add_u32 v84, v84, 7, s52
v_and_b32 v85, 3, v9
v_lshl_add_u32 v84, v85, 3, v84
v_add_u32 v82, 0, v84
s_mul_i32 s50, s32, 4096
v_lshlrev_b32 v1, 4, v9
v_add_u32 v0, s50, v1
s_xor_b32 s50, s50, 0x10000
s_mov_b32 s54, 8388608
v_lshrrev_b32 v84, 3, v9
s_lshl_b32 s38, s32, 8
v_add_u32 v84, s38, v84
v_mul_u32_u24 v84, 8192, v84
v_and_b32 v85, 7, v9
v_lshl_add_u32 v84, v85, 4, v84
s_lshl_b32 s38, s32, 13
s_barrier
s_add_u32 m0, s38, 0
s_add_u32 s39, s62, 0
buffer_load_dwordx4 v84, s[88:91], s39 offen lds
s_add_u32 m0, s38, 1024
s_add_u32 s39, s62, 65536
buffer_load_dwordx4 v84, s[88:91], s39 offen lds
s_add_u32 m0, s38, 2048
s_add_u32 s39, s62, 131072
buffer_load_dwordx4 v84, s[88:91], s39 offen lds
s_add_u32 m0, s38, 3072
s_add_u32 s39, s62, 196608
buffer_load_dwordx4 v84, s[88:91], s39 offen lds
s_add_u32 m0, s38, 4096
s_add_u32 s39, s62, 262144
buffer_load_dwordx4 v84, s[88:91], s39 offen lds
s_add_u32 m0, s38, 5120
s_add_u32 s39, s62, 327680
buffer_load_dwordx4 v84, s[88:91], s39 offen lds
s_add_u32 m0, s38, 6144
s_add_u32 s39, s62, 393216
buffer_load_dwordx4 v84, s[88:91], s39 offen lds
s_add_u32 m0, s38, 7168
s_add_u32 s39, s62, 458752
buffer_load_dwordx4 v84, s[88:91], s39 offen lds
s_add_u32 m0, s38, 32768
s_add_u32 s39, s62, 524288
buffer_load_dwordx4 v84, s[88:91], s39 offen lds
s_add_u32 m0, s38, 33792
s_add_u32 s39, s62, 589824
buffer_load_dwordx4 v84, s[88:91], s39 offen lds
s_add_u32 m0, s38, 34816
s_add_u32 s39, s62, 655360
buffer_load_dwordx4 v84, s[88:91], s39 offen lds
s_add_u32 m0, s38, 35840
s_add_u32 s39, s62, 720896
buffer_load_dwordx4 v84, s[88:91], s39 offen lds
s_add_u32 m0, s38, 36864
s_add_u32 s39, s62, 786432
buffer_load_dwordx4 v84, s[88:91], s39 offen lds
s_add_u32 m0, s38, 37888
s_add_u32 s39, s62, 851968
buffer_load_dwordx4 v84, s[88:91], s39 offen lds
s_add_u32 m0, s38, 38912
s_add_u32 s39, s62, 917504
buffer_load_dwordx4 v84, s[88:91], s39 offen lds
s_add_u32 m0, s38, 39936
s_add_u32 s39, s62, 983040
buffer_load_dwordx4 v84, s[88:91], s39 offen lds
s_add_u32 m0, s38, 65536
s_add_u32 s39, s62, 1048576
buffer_load_dwordx4 v84, s[88:91], s39 offen lds
s_add_u32 m0, s38, 66560
s_add_u32 s39, s62, 1114112
buffer_load_dwordx4 v84, s[88:91], s39 offen lds
s_add_u32 m0, s38, 67584
s_add_u32 s39, s62, 1179648
buffer_load_dwordx4 v84, s[88:91], s39 offen lds
s_add_u32 m0, s38, 68608
s_add_u32 s39, s62, 1245184
buffer_load_dwordx4 v84, s[88:91], s39 offen lds
s_add_u32 m0, s38, 69632
s_add_u32 s39, s62, 1310720
buffer_load_dwordx4 v84, s[88:91], s39 offen lds
s_add_u32 m0, s38, 70656
s_add_u32 s39, s62, 1376256
buffer_load_dwordx4 v84, s[88:91], s39 offen lds
s_add_u32 m0, s38, 71680
s_add_u32 s39, s62, 1441792
buffer_load_dwordx4 v84, s[88:91], s39 offen lds
s_add_u32 m0, s38, 72704
s_add_u32 s39, s62, 1507328
buffer_load_dwordx4 v84, s[88:91], s39 offen lds
s_add_u32 m0, s38, 98304
s_add_u32 s39, s62, 1572864
buffer_load_dwordx4 v84, s[88:91], s39 offen lds
s_add_u32 m0, s38, 99328
s_add_u32 s39, s62, 1638400
buffer_load_dwordx4 v84, s[88:91], s39 offen lds
s_add_u32 m0, s38, 100352
s_add_u32 s39, s62, 1703936
buffer_load_dwordx4 v84, s[88:91], s39 offen lds
s_add_u32 m0, s38, 101376
s_add_u32 s39, s62, 1769472
buffer_load_dwordx4 v84, s[88:91], s39 offen lds
s_add_u32 m0, s38, 102400
s_add_u32 s39, s62, 1835008
buffer_load_dwordx4 v84, s[88:91], s39 offen lds
s_add_u32 m0, s38, 103424
s_add_u32 s39, s62, 1900544
buffer_load_dwordx4 v84, s[88:91], s39 offen lds
s_add_u32 m0, s38, 104448
s_add_u32 s39, s62, 1966080
buffer_load_dwordx4 v84, s[88:91], s39 offen lds
s_add_u32 m0, s38, 105472
s_add_u32 s39, s62, 2031616
buffer_load_dwordx4 v84, s[88:91], s39 offen lds
s_add_u32 m0, s38, 131072
s_add_u32 s39, s61, 0
buffer_load_dwordx4 v84, s[84:87], s39 offen lds
s_add_u32 m0, s38, 132096
s_add_u32 s39, s61, 65536
buffer_load_dwordx4 v84, s[84:87], s39 offen lds
s_add_u32 m0, s38, 133120
s_add_u32 s39, s61, 131072
buffer_load_dwordx4 v84, s[84:87], s39 offen lds
s_add_u32 m0, s38, 134144
s_add_u32 s39, s61, 196608
buffer_load_dwordx4 v84, s[84:87], s39 offen lds
s_add_u32 m0, s38, 135168
s_add_u32 s39, s61, 262144
buffer_load_dwordx4 v84, s[84:87], s39 offen lds
s_add_u32 m0, s38, 136192
s_add_u32 s39, s61, 327680
buffer_load_dwordx4 v84, s[84:87], s39 offen lds
s_add_u32 m0, s38, 137216
s_add_u32 s39, s61, 393216
buffer_load_dwordx4 v84, s[84:87], s39 offen lds
s_add_u32 m0, s38, 138240
s_add_u32 s39, s61, 458752
buffer_load_dwordx4 v84, s[84:87], s39 offen lds
s_waitcnt vmcnt(32)
s_barrier
ds_read_b64_tr_b16 v[128:129], v82 offset:0
ds_read_b64_tr_b16 v[130:131], v82 offset:512
ds_read_b64_tr_b16 v[132:133], v82 offset:4096
ds_read_b64_tr_b16 v[134:135], v82 offset:4608
ds_read_b64_tr_b16 v[160:161], v82 offset:8192
ds_read_b64_tr_b16 v[162:163], v82 offset:8704
ds_read_b64_tr_b16 v[164:165], v82 offset:12288
ds_read_b64_tr_b16 v[166:167], v82 offset:12800
ds_read_b64_tr_b16 v[192:193], v82 offset:16384
ds_read_b64_tr_b16 v[194:195], v82 offset:16896
ds_read_b64_tr_b16 v[196:197], v82 offset:20480
ds_read_b64_tr_b16 v[198:199], v82 offset:20992
ds_read_b64_tr_b16 v[224:225], v82 offset:24576
ds_read_b64_tr_b16 v[226:227], v82 offset:25088
ds_read_b64_tr_b16 v[228:229], v82 offset:28672
ds_read_b64_tr_b16 v[230:231], v82 offset:29184
Llw_581:
v_add_u32 v80, 32768, v80
v_add_u32 v81, 32768, v81
v_add_u32 v82, 32768, v82
s_waitcnt lgkmcnt(0)
s_barrier
s_add_u32 m0, s38, 0
s_add_u32 s39, s61, 524288
buffer_load_dwordx4 v84, s[84:87], s39 offen lds
s_add_u32 m0, s38, 1024
s_add_u32 s39, s61, 589824
buffer_load_dwordx4 v84, s[84:87], s39 offen lds
s_add_u32 m0, s38, 2048
s_add_u32 s39, s61, 655360
buffer_load_dwordx4 v84, s[84:87], s39 offen lds
s_add_u32 m0, s38, 3072
s_add_u32 s39, s61, 720896
buffer_load_dwordx4 v84, s[84:87], s39 offen lds
s_add_u32 m0, s38, 4096
s_add_u32 s39, s61, 786432
buffer_load_dwordx4 v84, s[84:87], s39 offen lds
s_add_u32 m0, s38, 5120
s_add_u32 s39, s61, 851968
buffer_load_dwordx4 v84, s[84:87], s39 offen lds
s_add_u32 m0, s38, 6144
s_add_u32 s39, s61, 917504
buffer_load_dwordx4 v84, s[84:87], s39 offen lds
s_add_u32 m0, s38, 7168
s_add_u32 s39, s61, 983040
buffer_load_dwordx4 v84, s[84:87], s39 offen lds
s_waitcnt vmcnt(32)
s_barrier
ds_read_b64_tr_b16 v[136:137], v82 offset:0
ds_read_b64_tr_b16 v[138:139], v82 offset:512
ds_read_b64_tr_b16 v[140:141], v82 offset:4096
ds_read_b64_tr_b16 v[142:143], v82 offset:4608
ds_read_b64_tr_b16 v[168:169], v82 offset:8192
ds_read_b64_tr_b16 v[170:171], v82 offset:8704
ds_read_b64_tr_b16 v[172:173], v82 offset:12288
ds_read_b64_tr_b16 v[174:175], v82 offset:12800
ds_read_b64_tr_b16 v[200:201], v82 offset:16384
ds_read_b64_tr_b16 v[202:203], v82 offset:16896
ds_read_b64_tr_b16 v[204:205], v82 offset:20480
ds_read_b64_tr_b16 v[206:207], v82 offset:20992
ds_read_b64_tr_b16 v[232:233], v82 offset:24576
ds_read_b64_tr_b16 v[234:235], v82 offset:25088
ds_read_b64_tr_b16 v[236:237], v82 offset:28672
ds_read_b64_tr_b16 v[238:239], v82 offset:29184
Llw_582:
v_add_u32 v80, 32768, v80
v_add_u32 v81, 32768, v81
v_add_u32 v82, 32768, v82
s_waitcnt lgkmcnt(0)
s_barrier
buffer_load_dword v12, off, s[12:15], 0 offset:144 sc1
s_add_u32 m0, s38, 32768
s_add_u32 s39, s61, 1048576
buffer_load_dwordx4 v84, s[84:87], s39 offen lds
s_add_u32 m0, s38, 33792
s_add_u32 s39, s61, 1114112
buffer_load_dwordx4 v84, s[84:87], s39 offen lds
s_add_u32 m0, s38, 34816
s_add_u32 s39, s61, 1179648
buffer_load_dwordx4 v84, s[84:87], s39 offen lds
s_add_u32 m0, s38, 35840
s_add_u32 s39, s61, 1245184
buffer_load_dwordx4 v84, s[84:87], s39 offen lds
s_add_u32 m0, s38, 36864
s_add_u32 s39, s61, 1310720
buffer_load_dwordx4 v84, s[84:87], s39 offen lds
s_add_u32 m0, s38, 37888
s_add_u32 s39, s61, 1376256
buffer_load_dwordx4 v84, s[84:87], s39 offen lds
s_add_u32 m0, s38, 38912
s_add_u32 s39, s61, 1441792
buffer_load_dwordx4 v84, s[84:87], s39 offen lds
s_add_u32 m0, s38, 39936
s_add_u32 s39, s61, 1507328
buffer_load_dwordx4 v84, s[84:87], s39 offen lds
s_waitcnt vmcnt(32)
s_barrier
ds_read_b64_tr_b16 v[144:145], v82 offset:0
ds_read_b64_tr_b16 v[146:147], v82 offset:512
ds_read_b64_tr_b16 v[148:149], v82 offset:4096
ds_read_b64_tr_b16 v[150:151], v82 offset:4608
ds_read_b64_tr_b16 v[176:177], v82 offset:8192
ds_read_b64_tr_b16 v[178:179], v82 offset:8704
ds_read_b64_tr_b16 v[180:181], v82 offset:12288
ds_read_b64_tr_b16 v[182:183], v82 offset:12800
ds_read_b64_tr_b16 v[208:209], v82 offset:16384
ds_read_b64_tr_b16 v[210:211], v82 offset:16896
ds_read_b64_tr_b16 v[212:213], v82 offset:20480
ds_read_b64_tr_b16 v[214:215], v82 offset:20992
ds_read_b64_tr_b16 v[240:241], v82 offset:24576
ds_read_b64_tr_b16 v[242:243], v82 offset:25088
ds_read_b64_tr_b16 v[244:245], v82 offset:28672
ds_read_b64_tr_b16 v[246:247], v82 offset:29184
Llw_583:
v_add_u32 v80, 32768, v80
v_add_u32 v81, 32768, v81
v_add_u32 v82, 32768, v82
s_waitcnt lgkmcnt(0)
s_barrier
s_add_u32 m0, s38, 65536
s_add_u32 s39, s61, 1572864
buffer_load_dwordx4 v84, s[84:87], s39 offen lds
s_add_u32 m0, s38, 66560
s_add_u32 s39, s61, 1638400
buffer_load_dwordx4 v84, s[84:87], s39 offen lds
s_add_u32 m0, s38, 67584
s_add_u32 s39, s61, 1703936
buffer_load_dwordx4 v84, s[84:87], s39 offen lds
s_add_u32 m0, s38, 68608
s_add_u32 s39, s61, 1769472
buffer_load_dwordx4 v84, s[84:87], s39 offen lds
s_add_u32 m0, s38, 69632
s_add_u32 s39, s61, 1835008
buffer_load_dwordx4 v84, s[84:87], s39 offen lds
s_add_u32 m0, s38, 70656
s_add_u32 s39, s61, 1900544
buffer_load_dwordx4 v84, s[84:87], s39 offen lds
s_add_u32 m0, s38, 71680
s_add_u32 s39, s61, 1966080
buffer_load_dwordx4 v84, s[84:87], s39 offen lds
s_add_u32 m0, s38, 72704
s_add_u32 s39, s61, 2031616
buffer_load_dwordx4 v84, s[84:87], s39 offen lds
s_waitcnt vmcnt(32)
s_barrier
ds_read_b64_tr_b16 v[152:153], v82 offset:0
ds_read_b64_tr_b16 v[154:155], v82 offset:512
ds_read_b64_tr_b16 v[156:157], v82 offset:4096
ds_read_b64_tr_b16 v[158:159], v82 offset:4608
ds_read_b64_tr_b16 v[184:185], v82 offset:8192
ds_read_b64_tr_b16 v[186:187], v82 offset:8704
ds_read_b64_tr_b16 v[188:189], v82 offset:12288
ds_read_b64_tr_b16 v[190:191], v82 offset:12800
ds_read_b64_tr_b16 v[216:217], v82 offset:16384
ds_read_b64_tr_b16 v[218:219], v82 offset:16896
ds_read_b64_tr_b16 v[220:221], v82 offset:20480
ds_read_b64_tr_b16 v[222:223], v82 offset:20992
ds_read_b64_tr_b16 v[248:249], v82 offset:24576
ds_read_b64_tr_b16 v[250:251], v82 offset:25088
ds_read_b64_tr_b16 v[252:253], v82 offset:28672
ds_read_b64_tr_b16 v[254:255], v82 offset:29184
Llw_584:
v_add_u32 v80, 32768, v80
v_add_u32 v81, 32768, v81
v_add_u32 v82, 32768, v82
s_waitcnt lgkmcnt(0)
s_barrier
s_add_u32 m0, s38, 98304
s_add_u32 s39, s60, 0
buffer_load_dwordx4 v84, s[8:11], s39 offen lds
s_add_u32 m0, s38, 99328
s_add_u32 s39, s60, 65536
buffer_load_dwordx4 v84, s[8:11], s39 offen lds
s_add_u32 m0, s38, 100352
s_add_u32 s39, s60, 131072
buffer_load_dwordx4 v84, s[8:11], s39 offen lds
s_add_u32 m0, s38, 101376
s_add_u32 s39, s60, 196608
buffer_load_dwordx4 v84, s[8:11], s39 offen lds
s_add_u32 m0, s38, 102400
s_add_u32 s39, s60, 262144
buffer_load_dwordx4 v84, s[8:11], s39 offen lds
s_add_u32 m0, s38, 103424
s_add_u32 s39, s60, 327680
buffer_load_dwordx4 v84, s[8:11], s39 offen lds
s_add_u32 m0, s38, 104448
s_add_u32 s39, s60, 393216
buffer_load_dwordx4 v84, s[8:11], s39 offen lds
s_add_u32 m0, s38, 105472
s_add_u32 s39, s60, 458752
buffer_load_dwordx4 v84, s[8:11], s39 offen lds
s_waitcnt vmcnt(32)
s_barrier
s_bitcmp0_b32 s32, 1
s_cbranch_scc1 Llw_585
ds_read_b64_tr_b16 a[0:1], v80 offset:0
ds_read_b64_tr_b16 a[2:3], v80 offset:512
ds_read_b64_tr_b16 a[4:5], v80 offset:4096
ds_read_b64_tr_b16 a[6:7], v80 offset:4608
ds_read_b64_tr_b16 a[32:33], v80 offset:8192
ds_read_b64_tr_b16 a[34:35], v80 offset:8704
ds_read_b64_tr_b16 a[36:37], v80 offset:12288
ds_read_b64_tr_b16 a[38:39], v80 offset:12800
ds_read_b64_tr_b16 a[64:65], v80 offset:16384
ds_read_b64_tr_b16 a[66:67], v80 offset:16896
ds_read_b64_tr_b16 a[68:69], v80 offset:20480
ds_read_b64_tr_b16 a[70:71], v80 offset:20992
ds_read_b64_tr_b16 a[96:97], v80 offset:24576
ds_read_b64_tr_b16 a[98:99], v80 offset:25088
ds_read_b64_tr_b16 a[100:101], v80 offset:28672
ds_read_b64_tr_b16 a[102:103], v80 offset:29184
ds_read_b64_tr_b16 a[128:129], v81 offset:0
ds_read_b64_tr_b16 a[130:131], v81 offset:512
ds_read_b64_tr_b16 a[132:133], v81 offset:4096
ds_read_b64_tr_b16 a[134:135], v81 offset:4608
ds_read_b64_tr_b16 a[160:161], v81 offset:8192
ds_read_b64_tr_b16 a[162:163], v81 offset:8704
ds_read_b64_tr_b16 a[164:165], v81 offset:12288
ds_read_b64_tr_b16 a[166:167], v81 offset:12800
ds_read_b64_tr_b16 a[192:193], v81 offset:16384
ds_read_b64_tr_b16 a[194:195], v81 offset:16896
ds_read_b64_tr_b16 a[196:197], v81 offset:20480
ds_read_b64_tr_b16 a[198:199], v81 offset:20992
ds_read_b64_tr_b16 a[224:225], v81 offset:24576
ds_read_b64_tr_b16 a[226:227], v81 offset:25088
ds_read_b64_tr_b16 a[228:229], v81 offset:28672
ds_read_b64_tr_b16 a[230:231], v81 offset:29184
Llw_585:
v_add_u32 v80, -131072, v80
v_add_u32 v81, -131072, v81
v_add_u32 v82, -131072, v82
s_waitcnt lgkmcnt(0)
s_barrier
s_add_u32 m0, s38, 131072
s_add_u32 s39, s60, 524288
buffer_load_dwordx4 v84, s[8:11], s39 offen lds
s_add_u32 m0, s38, 132096
s_add_u32 s39, s60, 589824
buffer_load_dwordx4 v84, s[8:11], s39 offen lds
s_add_u32 m0, s38, 133120
s_add_u32 s39, s60, 655360
buffer_load_dwordx4 v84, s[8:11], s39 offen lds
s_add_u32 m0, s38, 134144
s_add_u32 s39, s60, 720896
buffer_load_dwordx4 v84, s[8:11], s39 offen lds
s_add_u32 m0, s38, 135168
s_add_u32 s39, s60, 786432
buffer_load_dwordx4 v84, s[8:11], s39 offen lds
s_add_u32 m0, s38, 136192
s_add_u32 s39, s60, 851968
buffer_load_dwordx4 v84, s[8:11], s39 offen lds
s_add_u32 m0, s38, 137216
s_add_u32 s39, s60, 917504
buffer_load_dwordx4 v84, s[8:11], s39 offen lds
s_add_u32 m0, s38, 138240
s_add_u32 s39, s60, 983040
buffer_load_dwordx4 v84, s[8:11], s39 offen lds
s_waitcnt vmcnt(32)
s_barrier
s_bitcmp0_b32 s32, 1
s_cbranch_scc1 Llw_586
ds_read_b64_tr_b16 a[8:9], v80 offset:0
ds_read_b64_tr_b16 a[10:11], v80 offset:512
ds_read_b64_tr_b16 a[12:13], v80 offset:4096
ds_read_b64_tr_b16 a[14:15], v80 offset:4608
ds_read_b64_tr_b16 a[40:41], v80 offset:8192
ds_read_b64_tr_b16 a[42:43], v80 offset:8704
ds_read_b64_tr_b16 a[44:45], v80 offset:12288
ds_read_b64_tr_b16 a[46:47], v80 offset:12800
ds_read_b64_tr_b16 a[72:73], v80 offset:16384
ds_read_b64_tr_b16 a[74:75], v80 offset:16896
ds_read_b64_tr_b16 a[76:77], v80 offset:20480
ds_read_b64_tr_b16 a[78:79], v80 offset:20992
ds_read_b64_tr_b16 a[104:105], v80 offset:24576
ds_read_b64_tr_b16 a[106:107], v80 offset:25088
ds_read_b64_tr_b16 a[108:109], v80 offset:28672
ds_read_b64_tr_b16 a[110:111], v80 offset:29184
ds_read_b64_tr_b16 a[136:137], v81 offset:0
ds_read_b64_tr_b16 a[138:139], v81 offset:512
ds_read_b64_tr_b16 a[140:141], v81 offset:4096
ds_read_b64_tr_b16 a[142:143], v81 offset:4608
ds_read_b64_tr_b16 a[168:169], v81 offset:8192
ds_read_b64_tr_b16 a[170:171], v81 offset:8704
ds_read_b64_tr_b16 a[172:173], v81 offset:12288
ds_read_b64_tr_b16 a[174:175], v81 offset:12800
ds_read_b64_tr_b16 a[200:201], v81 offset:16384
ds_read_b64_tr_b16 a[202:203], v81 offset:16896
ds_read_b64_tr_b16 a[204:205], v81 offset:20480
ds_read_b64_tr_b16 a[206:207], v81 offset:20992
ds_read_b64_tr_b16 a[232:233], v81 offset:24576
ds_read_b64_tr_b16 a[234:235], v81 offset:25088
ds_read_b64_tr_b16 a[236:237], v81 offset:28672
ds_read_b64_tr_b16 a[238:239], v81 offset:29184
Llw_586:
v_add_u32 v80, 32768, v80
v_add_u32 v81, 32768, v81
v_add_u32 v82, 32768, v82
s_waitcnt lgkmcnt(0)
s_barrier
s_add_u32 m0, s38, 0
s_add_u32 s39, s60, 1048576
buffer_load_dwordx4 v84, s[8:11], s39 offen lds
s_add_u32 m0, s38, 1024
s_add_u32 s39, s60, 1114112
buffer_load_dwordx4 v84, s[8:11], s39 offen lds
s_add_u32 m0, s38, 2048
s_add_u32 s39, s60, 1179648
buffer_load_dwordx4 v84, s[8:11], s39 offen lds
s_add_u32 m0, s38, 3072
s_add_u32 s39, s60, 1245184
buffer_load_dwordx4 v84, s[8:11], s39 offen lds
s_add_u32 m0, s38, 4096
s_add_u32 s39, s60, 1310720
buffer_load_dwordx4 v84, s[8:11], s39 offen lds
s_add_u32 m0, s38, 5120
s_add_u32 s39, s60, 1376256
buffer_load_dwordx4 v84, s[8:11], s39 offen lds
s_add_u32 m0, s38, 6144
s_add_u32 s39, s60, 1441792
buffer_load_dwordx4 v84, s[8:11], s39 offen lds
s_add_u32 m0, s38, 7168
s_add_u32 s39, s60, 1507328
buffer_load_dwordx4 v84, s[8:11], s39 offen lds
s_waitcnt vmcnt(32)
s_barrier
s_bitcmp0_b32 s32, 1
s_cbranch_scc1 Llw_587
ds_read_b64_tr_b16 a[16:17], v80 offset:0
ds_read_b64_tr_b16 a[18:19], v80 offset:512
ds_read_b64_tr_b16 a[20:21], v80 offset:4096
ds_read_b64_tr_b16 a[22:23], v80 offset:4608
ds_read_b64_tr_b16 a[48:49], v80 offset:8192
ds_read_b64_tr_b16 a[50:51], v80 offset:8704
ds_read_b64_tr_b16 a[52:53], v80 offset:12288
ds_read_b64_tr_b16 a[54:55], v80 offset:12800
ds_read_b64_tr_b16 a[80:81], v80 offset:16384
ds_read_b64_tr_b16 a[82:83], v80 offset:16896
ds_read_b64_tr_b16 a[84:85], v80 offset:20480
ds_read_b64_tr_b16 a[86:87], v80 offset:20992
ds_read_b64_tr_b16 a[112:113], v80 offset:24576
ds_read_b64_tr_b16 a[114:115], v80 offset:25088
ds_read_b64_tr_b16 a[116:117], v80 offset:28672
ds_read_b64_tr_b16 a[118:119], v80 offset:29184
ds_read_b64_tr_b16 a[144:145], v81 offset:0
ds_read_b64_tr_b16 a[146:147], v81 offset:512
ds_read_b64_tr_b16 a[148:149], v81 offset:4096
ds_read_b64_tr_b16 a[150:151], v81 offset:4608
ds_read_b64_tr_b16 a[176:177], v81 offset:8192
ds_read_b64_tr_b16 a[178:179], v81 offset:8704
ds_read_b64_tr_b16 a[180:181], v81 offset:12288
ds_read_b64_tr_b16 a[182:183], v81 offset:12800
ds_read_b64_tr_b16 a[208:209], v81 offset:16384
ds_read_b64_tr_b16 a[210:211], v81 offset:16896
ds_read_b64_tr_b16 a[212:213], v81 offset:20480
ds_read_b64_tr_b16 a[214:215], v81 offset:20992
ds_read_b64_tr_b16 a[240:241], v81 offset:24576
ds_read_b64_tr_b16 a[242:243], v81 offset:25088
ds_read_b64_tr_b16 a[244:245], v81 offset:28672
ds_read_b64_tr_b16 a[246:247], v81 offset:29184
Llw_587:
v_add_u32 v80, 32768, v80
v_add_u32 v81, 32768, v81
v_add_u32 v82, 32768, v82
s_waitcnt lgkmcnt(0)
s_barrier
v_lshlrev_b32 v14, 7, v9
s_mov_b32 s39, 3424256
buffer_load_dword v13, v14, s[4:7], s39 offen sc1
s_add_u32 m0, s38, 32768
s_add_u32 s39, s60, 1572864
buffer_load_dwordx4 v84, s[8:11], s39 offen lds
s_add_u32 m0, s38, 33792
s_add_u32 s39, s60, 1638400
buffer_load_dwordx4 v84, s[8:11], s39 offen lds
s_add_u32 m0, s38, 34816
s_add_u32 s39, s60, 1703936
buffer_load_dwordx4 v84, s[8:11], s39 offen lds
s_add_u32 m0, s38, 35840
s_add_u32 s39, s60, 1769472
buffer_load_dwordx4 v84, s[8:11], s39 offen lds
s_add_u32 m0, s38, 36864
s_add_u32 s39, s60, 1835008
buffer_load_dwordx4 v84, s[8:11], s39 offen lds
s_add_u32 m0, s38, 37888
s_add_u32 s39, s60, 1900544
buffer_load_dwordx4 v84, s[8:11], s39 offen lds
s_add_u32 m0, s38, 38912
s_add_u32 s39, s60, 1966080
buffer_load_dwordx4 v84, s[8:11], s39 offen lds
s_add_u32 m0, s38, 39936
s_add_u32 s39, s60, 2031616
buffer_load_dwordx4 v84, s[8:11], s39 offen lds
s_waitcnt vmcnt(32)
s_barrier
s_bitcmp0_b32 s32, 1
s_cbranch_scc1 Llw_588
ds_read_b64_tr_b16 a[24:25], v80 offset:0
ds_read_b64_tr_b16 a[26:27], v80 offset:512
ds_read_b64_tr_b16 a[28:29], v80 offset:4096
ds_read_b64_tr_b16 a[30:31], v80 offset:4608
ds_read_b64_tr_b16 a[56:57], v80 offset:8192
ds_read_b64_tr_b16 a[58:59], v80 offset:8704
ds_read_b64_tr_b16 a[60:61], v80 offset:12288
ds_read_b64_tr_b16 a[62:63], v80 offset:12800
ds_read_b64_tr_b16 a[88:89], v80 offset:16384
ds_read_b64_tr_b16 a[90:91], v80 offset:16896
ds_read_b64_tr_b16 a[92:93], v80 offset:20480
ds_read_b64_tr_b16 a[94:95], v80 offset:20992
ds_read_b64_tr_b16 a[120:121], v80 offset:24576
ds_read_b64_tr_b16 a[122:123], v80 offset:25088
ds_read_b64_tr_b16 a[124:125], v80 offset:28672
ds_read_b64_tr_b16 a[126:127], v80 offset:29184
ds_read_b64_tr_b16 a[152:153], v81 offset:0
ds_read_b64_tr_b16 a[154:155], v81 offset:512
ds_read_b64_tr_b16 a[156:157], v81 offset:4096
ds_read_b64_tr_b16 a[158:159], v81 offset:4608
ds_read_b64_tr_b16 a[184:185], v81 offset:8192
ds_read_b64_tr_b16 a[186:187], v81 offset:8704
ds_read_b64_tr_b16 a[188:189], v81 offset:12288
ds_read_b64_tr_b16 a[190:191], v81 offset:12800
ds_read_b64_tr_b16 a[216:217], v81 offset:16384
ds_read_b64_tr_b16 a[218:219], v81 offset:16896
ds_read_b64_tr_b16 a[220:221], v81 offset:20480
ds_read_b64_tr_b16 a[222:223], v81 offset:20992
ds_read_b64_tr_b16 a[248:249], v81 offset:24576
ds_read_b64_tr_b16 a[250:251], v81 offset:25088
ds_read_b64_tr_b16 a[252:253], v81 offset:28672
ds_read_b64_tr_b16 a[254:255], v81 offset:29184
Llw_588:
v_add_u32 v80, 32768, v80
v_add_u32 v81, 32768, v81
v_add_u32 v82, 32768, v82
s_waitcnt lgkmcnt(0)
s_barrier
s_waitcnt vmcnt(24)
s_barrier
s_bitcmp1_b32 s32, 1
s_cbranch_scc1 Llw_589
ds_read_b64_tr_b16 a[0:1], v80 offset:0
ds_read_b64_tr_b16 a[2:3], v80 offset:512
ds_read_b64_tr_b16 a[4:5], v80 offset:4096
ds_read_b64_tr_b16 a[6:7], v80 offset:4608
ds_read_b64_tr_b16 a[32:33], v80 offset:8192
ds_read_b64_tr_b16 a[34:35], v80 offset:8704
ds_read_b64_tr_b16 a[36:37], v80 offset:12288
ds_read_b64_tr_b16 a[38:39], v80 offset:12800
ds_read_b64_tr_b16 a[64:65], v80 offset:16384
ds_read_b64_tr_b16 a[66:67], v80 offset:16896
ds_read_b64_tr_b16 a[68:69], v80 offset:20480
ds_read_b64_tr_b16 a[70:71], v80 offset:20992
ds_read_b64_tr_b16 a[96:97], v80 offset:24576
ds_read_b64_tr_b16 a[98:99], v80 offset:25088
ds_read_b64_tr_b16 a[100:101], v80 offset:28672
ds_read_b64_tr_b16 a[102:103], v80 offset:29184
ds_read_b64_tr_b16 a[128:129], v81 offset:0
ds_read_b64_tr_b16 a[130:131], v81 offset:512
ds_read_b64_tr_b16 a[132:133], v81 offset:4096
ds_read_b64_tr_b16 a[134:135], v81 offset:4608
ds_read_b64_tr_b16 a[160:161], v81 offset:8192
ds_read_b64_tr_b16 a[162:163], v81 offset:8704
ds_read_b64_tr_b16 a[164:165], v81 offset:12288
ds_read_b64_tr_b16 a[166:167], v81 offset:12800
ds_read_b64_tr_b16 a[192:193], v81 offset:16384
ds_read_b64_tr_b16 a[194:195], v81 offset:16896
ds_read_b64_tr_b16 a[196:197], v81 offset:20480
ds_read_b64_tr_b16 a[198:199], v81 offset:20992
ds_read_b64_tr_b16 a[224:225], v81 offset:24576
ds_read_b64_tr_b16 a[226:227], v81 offset:25088
ds_read_b64_tr_b16 a[228:229], v81 offset:28672
ds_read_b64_tr_b16 a[230:231], v81 offset:29184
Llw_589:
v_add_u32 v80, 32768, v80
v_add_u32 v81, 32768, v81
v_add_u32 v82, 32768, v82
s_waitcnt lgkmcnt(0)
s_barrier
s_waitcnt vmcnt(16)
s_barrier
s_bitcmp1_b32 s32, 1
s_cbranch_scc1 Llw_590
ds_read_b64_tr_b16 a[8:9], v80 offset:0
ds_read_b64_tr_b16 a[10:11], v80 offset:512
ds_read_b64_tr_b16 a[12:13], v80 offset:4096
ds_read_b64_tr_b16 a[14:15], v80 offset:4608
ds_read_b64_tr_b16 a[40:41], v80 offset:8192
ds_read_b64_tr_b16 a[42:43], v80 offset:8704
ds_read_b64_tr_b16 a[44:45], v80 offset:12288
ds_read_b64_tr_b16 a[46:47], v80 offset:12800
ds_read_b64_tr_b16 a[72:73], v80 offset:16384
ds_read_b64_tr_b16 a[74:75], v80 offset:16896
ds_read_b64_tr_b16 a[76:77], v80 offset:20480
ds_read_b64_tr_b16 a[78:79], v80 offset:20992
ds_read_b64_tr_b16 a[104:105], v80 offset:24576
ds_read_b64_tr_b16 a[106:107], v80 offset:25088
ds_read_b64_tr_b16 a[108:109], v80 offset:28672
ds_read_b64_tr_b16 a[110:111], v80 offset:29184
ds_read_b64_tr_b16 a[136:137], v81 offset:0
ds_read_b64_tr_b16 a[138:139], v81 offset:512
ds_read_b64_tr_b16 a[140:141], v81 offset:4096
ds_read_b64_tr_b16 a[142:143], v81 offset:4608
ds_read_b64_tr_b16 a[168:169], v81 offset:8192
ds_read_b64_tr_b16 a[170:171], v81 offset:8704
ds_read_b64_tr_b16 a[172:173], v81 offset:12288
ds_read_b64_tr_b16 a[174:175], v81 offset:12800
ds_read_b64_tr_b16 a[200:201], v81 offset:16384
ds_read_b64_tr_b16 a[202:203], v81 offset:16896
ds_read_b64_tr_b16 a[204:205], v81 offset:20480
ds_read_b64_tr_b16 a[206:207], v81 offset:20992
ds_read_b64_tr_b16 a[232:233], v81 offset:24576
ds_read_b64_tr_b16 a[234:235], v81 offset:25088
ds_read_b64_tr_b16 a[236:237], v81 offset:28672
ds_read_b64_tr_b16 a[238:239], v81 offset:29184
Llw_590:
v_add_u32 v80, -131072, v80
v_add_u32 v81, -131072, v81
v_add_u32 v82, -131072, v82
s_waitcnt lgkmcnt(0)
s_barrier
s_waitcnt vmcnt(8)
v_cmp_ne_u32 vcc, 0x80, v12
s_mov_b64 s[92:93], vcc
v_cmp_gt_u32 vcc, 2, v13
s_or_b64 vcc, vcc, s[92:93]
s_cselect_b32 s46, 0, 1
s_cbranch_scc1 Lqa_591
s_add_u32 m0, s50, 0
s_add_u32 s39, s54, 0
buffer_load_dwordx4 v0, s[4:7], s39 offen offset:0 sc1 lds
buffer_load_dwordx4 v0, s[4:7], s39 offen offset:2048 sc1 lds
s_add_u32 m0, s50, 16384
s_add_u32 s39, s54, 16384
buffer_load_dwordx4 v0, s[4:7], s39 offen offset:0 sc1 lds
buffer_load_dwordx4 v0, s[4:7], s39 offen offset:2048 sc1 lds
s_add_u32 m0, s50, 32768
s_add_u32 s39, s54, 32768
buffer_load_dwordx4 v0, s[4:7], s39 offen offset:0 sc1 lds
buffer_load_dwordx4 v0, s[4:7], s39 offen offset:2048 sc1 lds
s_add_u32 m0, s50, 49152
s_add_u32 s39, s54, 49152
buffer_load_dwordx4 v0, s[4:7], s39 offen offset:0 sc1 lds
buffer_load_dwordx4 v0, s[4:7], s39 offen offset:2048 sc1 lds
s_add_u32 m0, s50, 0
s_add_u32 s39, s54, 0
buffer_load_dwordx4 v0, s[4:7], s39 offen offset:1024 sc1 lds
buffer_load_dwordx4 v0, s[4:7], s39 offen offset:3072 sc1 lds
s_add_u32 m0, s50, 16384
s_add_u32 s39, s54, 16384
buffer_load_dwordx4 v0, s[4:7], s39 offen offset:1024 sc1 lds
buffer_load_dwordx4 v0, s[4:7], s39 offen offset:3072 sc1 lds
s_add_u32 m0, s50, 32768
s_add_u32 s39, s54, 32768
buffer_load_dwordx4 v0, s[4:7], s39 offen offset:1024 sc1 lds
buffer_load_dwordx4 v0, s[4:7], s39 offen offset:3072 sc1 lds
s_add_u32 m0, s50, 49152
s_add_u32 s39, s54, 49152
buffer_load_dwordx4 v0, s[4:7], s39 offen offset:1024 sc1 lds
buffer_load_dwordx4 v0, s[4:7], s39 offen offset:3072 sc1 lds
Lqa_591:
s_barrier
s_bitcmp1_b32 s32, 1
s_cbranch_scc1 Llw_593
ds_read_b64_tr_b16 a[16:17], v80 offset:0
ds_read_b64_tr_b16 a[18:19], v80 offset:512
ds_read_b64_tr_b16 a[20:21], v80 offset:4096
ds_read_b64_tr_b16 a[22:23], v80 offset:4608
ds_read_b64_tr_b16 a[48:49], v80 offset:8192
ds_read_b64_tr_b16 a[50:51], v80 offset:8704
ds_read_b64_tr_b16 a[52:53], v80 offset:12288
ds_read_b64_tr_b16 a[54:55], v80 offset:12800
ds_read_b64_tr_b16 a[80:81], v80 offset:16384
ds_read_b64_tr_b16 a[82:83], v80 offset:16896
ds_read_b64_tr_b16 a[84:85], v80 offset:20480
ds_read_b64_tr_b16 a[86:87], v80 offset:20992
ds_read_b64_tr_b16 a[112:113], v80 offset:24576
ds_read_b64_tr_b16 a[114:115], v80 offset:25088
ds_read_b64_tr_b16 a[116:117], v80 offset:28672
ds_read_b64_tr_b16 a[118:119], v80 offset:29184
ds_read_b64_tr_b16 a[144:145], v81 offset:0
ds_read_b64_tr_b16 a[146:147], v81 offset:512
ds_read_b64_tr_b16 a[148:149], v81 offset:4096
ds_read_b64_tr_b16 a[150:151], v81 offset:4608
ds_read_b64_tr_b16 a[176:177], v81 offset:8192
ds_read_b64_tr_b16 a[178:179], v81 offset:8704
ds_read_b64_tr_b16 a[180:181], v81 offset:12288
ds_read_b64_tr_b16 a[182:183], v81 offset:12800
ds_read_b64_tr_b16 a[208:209], v81 offset:16384
ds_read_b64_tr_b16 a[210:211], v81 offset:16896
ds_read_b64_tr_b16 a[212:213], v81 offset:20480
ds_read_b64_tr_b16 a[214:215], v81 offset:20992
ds_read_b64_tr_b16 a[240:241], v81 offset:24576
ds_read_b64_tr_b16 a[242:243], v81 offset:25088
ds_read_b64_tr_b16 a[244:245], v81 offset:28672
ds_read_b64_tr_b16 a[246:247], v81 offset:29184
Llw_593:
v_add_u32 v80, 32768, v80
v_add_u32 v81, 32768, v81
v_add_u32 v82, 32768, v82
s_waitcnt lgkmcnt(0)
s_barrier
s_cmp_lg_u32 s46, 0
s_cbranch_scc1 Lqa_594
s_waitcnt vmcnt(0)
Lqa_594:
s_waitcnt vmcnt(16)
s_barrier
s_bitcmp1_b32 s32, 1
s_cbranch_scc1 Llw_596
ds_read_b64_tr_b16 a[24:25], v80 offset:0
ds_read_b64_tr_b16 a[26:27], v80 offset:512
ds_read_b64_tr_b16 a[28:29], v80 offset:4096
ds_read_b64_tr_b16 a[30:31], v80 offset:4608
ds_read_b64_tr_b16 a[56:57], v80 offset:8192
ds_read_b64_tr_b16 a[58:59], v80 offset:8704
ds_read_b64_tr_b16 a[60:61], v80 offset:12288
ds_read_b64_tr_b16 a[62:63], v80 offset:12800
ds_read_b64_tr_b16 a[88:89], v80 offset:16384
ds_read_b64_tr_b16 a[90:91], v80 offset:16896
ds_read_b64_tr_b16 a[92:93], v80 offset:20480
ds_read_b64_tr_b16 a[94:95], v80 offset:20992
ds_read_b64_tr_b16 a[120:121], v80 offset:24576
ds_read_b64_tr_b16 a[122:123], v80 offset:25088
ds_read_b64_tr_b16 a[124:125], v80 offset:28672
ds_read_b64_tr_b16 a[126:127], v80 offset:29184
ds_read_b64_tr_b16 a[152:153], v81 offset:0
ds_read_b64_tr_b16 a[154:155], v81 offset:512
ds_read_b64_tr_b16 a[156:157], v81 offset:4096
ds_read_b64_tr_b16 a[158:159], v81 offset:4608
ds_read_b64_tr_b16 a[184:185], v81 offset:8192
ds_read_b64_tr_b16 a[186:187], v81 offset:8704
ds_read_b64_tr_b16 a[188:189], v81 offset:12288
ds_read_b64_tr_b16 a[190:191], v81 offset:12800
ds_read_b64_tr_b16 a[216:217], v81 offset:16384
ds_read_b64_tr_b16 a[218:219], v81 offset:16896
ds_read_b64_tr_b16 a[220:221], v81 offset:20480
ds_read_b64_tr_b16 a[222:223], v81 offset:20992
ds_read_b64_tr_b16 a[248:249], v81 offset:24576
ds_read_b64_tr_b16 a[250:251], v81 offset:25088
ds_read_b64_tr_b16 a[252:253], v81 offset:28672
ds_read_b64_tr_b16 a[254:255], v81 offset:29184
Llw_596:
v_add_u32 v80, 32768, v80
v_add_u32 v81, 32768, v81
v_add_u32 v82, 32768, v82
s_waitcnt lgkmcnt(0)
s_barrier
s_and_b32 s52, s44, 1
s_lshr_b32 s38, s32, 1
s_lshl_b32 s38, s38, 3
s_and_b32 s39, s32, 1
s_add_u32 s38, s38, s39
s_lshl_b32 s39, s52, 1
s_add_u32 s38, s38, s39
s_lshl_b32 s38, s38, 10
s_lshr_b32 s53, s44, 1
s_and_b32 s39, s32, 2
s_xor_b32 s39, s39, s53
s_mul_i32 s39, s39, 24576
s_add_u32 s38, s38, s39
v_add_u32 v6, s38, v1
v_add_u32 v7, 4096, v6
s_lshl_b32 s38, s52, 2
s_add_u32 s38, s38, s32
s_add_u32 s38, s38, 16
s_lshl_b32 s38, s38, 10
s_xor_b32 s39, s53, 1
s_mul_i32 s39, s39, 24576
s_add_u32 s38, s38, s39
v_add_u32 v8, s38, v1
s_mov_b32 s49, 32768000
v_xor_b32 v1, 0x10000, v1
s_mov_b32 s36, 0
s_cmp_lg_u32 s46, 0
s_cbranch_scc1 Lqm_598
Lst_600:
buffer_load_dword v48, off, s[12:15], 0 offset:144 sc1
buffer_load_dword v49, off, s[12:15], 0 offset:144 sc1
s_waitcnt vmcnt(0)
v_add_u32 v48, v48, v49
s_nop 0
v_readfirstlane_b32 s38, v48
s_nop 3
s_and_b32 s39, s38, 0xffff
s_cmp_eq_u32 s39, 0x100
s_cbranch_scc1 Lso_601
s_sub_u32 s37, s37, 1
s_cbranch_scc1 Lend_7
s_sleep 8
s_branch Lst_600
Lso_601:
s_bfe_u32 s35, s38, 0x80010
s_bfe_u32 s46, s38, 0x10018
s_lshl_b32 s46, s46, 13
v_lshlrev_b32 v80, 7, v9
s_mov_b32 s38, 3424256
Lbw_602:
buffer_load_dword v81, v80, s[4:7], s38 offen sc1
s_waitcnt vmcnt(0)
v_cmp_gt_u32 vcc, 2, v81
s_cbranch_vccz Lbo_603
s_sub_u32 s37, s37, 1
s_cbranch_scc1 Lend_7
s_sleep 2
s_branch Lbw_602
Lbo_603:
s_add_u32 m0, s50, 0
s_add_u32 s39, s54, 0
buffer_load_dwordx4 v0, s[4:7], s39 offen offset:0 sc1 lds
buffer_load_dwordx4 v0, s[4:7], s39 offen offset:2048 sc1 lds
s_add_u32 m0, s50, 16384
s_add_u32 s39, s54, 16384
buffer_load_dwordx4 v0, s[4:7], s39 offen offset:0 sc1 lds
buffer_load_dwordx4 v0, s[4:7], s39 offen offset:2048 sc1 lds
s_add_u32 m0, s50, 32768
s_add_u32 s39, s54, 32768
buffer_load_dwordx4 v0, s[4:7], s39 offen offset:0 sc1 lds
buffer_load_dwordx4 v0, s[4:7], s39 offen offset:2048 sc1 lds
s_add_u32 m0, s50, 49152
s_add_u32 s39, s54, 49152
buffer_load_dwordx4 v0, s[4:7], s39 offen offset:0 sc1 lds
buffer_load_dwordx4 v0, s[4:7], s39 offen offset:2048 sc1 lds
s_add_u32 m0, s50, 0
s_add_u32 s39, s54, 0
buffer_load_dwordx4 v0, s[4:7], s39 offen offset:1024 sc1 lds
buffer_load_dwordx4 v0, s[4:7], s39 offen offset:3072 sc1 lds
s_add_u32 m0, s50, 16384
s_add_u32 s39, s54, 16384
buffer_load_dwordx4 v0, s[4:7], s39 offen offset:1024 sc1 lds
buffer_load_dwordx4 v0, s[4:7], s39 offen offset:3072 sc1 lds
s_add_u32 m0, s50, 32768
s_add_u32 s39, s54, 32768
buffer_load_dwordx4 v0, s[4:7], s39 offen offset:1024 sc1 lds
buffer_load_dwordx4 v0, s[4:7], s39 offen offset:3072 sc1 lds
s_add_u32 m0, s50, 49152
s_add_u32 s39, s54, 49152
buffer_load_dwordx4 v0, s[4:7], s39 offen offset:1024 sc1 lds
buffer_load_dwordx4 v0, s[4:7], s39 offen offset:3072 sc1 lds
Lqm_598:
s_waitcnt vmcnt(8)
s_barrier
ds_read_b128 v[16:19], v1 offset:0
ds_read_b128 v[20:23], v1 offset:2048
ds_read_b128 v[24:27], v1 offset:4096
ds_read_b128 v[28:31], v1 offset:6144
ds_read_b128 v[32:35], v1 offset:8192
ds_read_b128 v[36:39], v1 offset:10240
ds_read_b128 v[40:43], v1 offset:12288
s_mov_b32 s55, 0x70000000
s_mov_b32 s48, 28
Lql_597:
s_waitcnt lgkmcnt(5)
v_mfma_f32_16x16x32_bf16 v[48:51], a[0:3], v[16:19], 0
s_add_u32 s54, s54, 65536
ds_read_b128 v[44:47], v1 offset:14336
s_xor_b32 s50, s50, 0x10000
v_mfma_f32_16x16x32_bf16 v[52:55], a[128:131], v[16:19], 0
s_cmp_lt_u32 s36, 63
s_cselect_b32 s45, s54, 0x70000000
v_mfma_f32_16x16x32_bf16 v[64:67], v[16:19], v[128:131], 0
v_mfma_f32_16x16x32_bf16 v[48:51], a[4:7], v[20:23], v[48:51]
ds_read_b128 v[16:19], v1 offset:16384
v_mfma_f32_16x16x32_bf16 v[52:55], a[132:135], v[20:23], v[52:55]
v_mfma_f32_16x16x32_bf16 v[64:67], v[20:23], v[132:135], v[64:67]
s_waitcnt lgkmcnt(5)
v_mfma_f32_16x16x32_bf16 v[48:51], a[8:11], v[24:27], v[48:51]
ds_read_b128 v[20:23], v1 offset:18432
v_mfma_f32_16x16x32_bf16 v[52:55], a[136:139], v[24:27], v[52:55]
v_mfma_f32_16x16x32_bf16 v[64:67], v[24:27], v[136:139], v[64:67]
v_cvt_pk_bf16_f32 v84, v56, v57
v_cvt_pk_bf16_f32 v85, v58, v59
v_mfma_f32_16x16x32_bf16 v[48:51], a[12:15], v[28:31], v[48:51]
ds_read_b128 v[24:27], v1 offset:20480
v_cvt_pk_bf16_f32 v86, v60, v61
v_mfma_f32_16x16x32_bf16 v[52:55], a[140:143], v[28:31], v[52:55]
v_cvt_pk_bf16_f32 v87, v62, v63
v_cvt_pk_bf16_f32 v90, v68, v69
v_mfma_f32_16x16x32_bf16 v[64:67], v[28:31], v[140:143], v[64:67]
s_waitcnt lgkmcnt(5)
v_cvt_pk_bf16_f32 v91, v70, v71
v_mfma_f32_16x16x32_bf16 v[48:51], a[16:19], v[32:35], v[48:51]
ds_read_b128 v[28:31], v1 offset:22528
v_mfma_f32_16x16x32_bf16 v[52:55], a[144:147], v[32:35], v[52:55]
buffer_store_dwordx4 v[80:83], v6, s[4:7], s55 offen sc1
v_mfma_f32_16x16x32_bf16 v[64:67], v[32:35], v[144:147], v[64:67]
v_mfma_f32_16x16x32_bf16 v[48:51], a[20:23], v[36:39], v[48:51]
ds_read_b128 v[32:35], v1 offset:24576
v_mfma_f32_16x16x32_bf16 v[52:55], a[148:151], v[36:39], v[52:55]
v_mfma_f32_16x16x32_bf16 v[64:67], v[36:39], v[148:151], v[64:67]
s_waitcnt lgkmcnt(5)
buffer_store_dwordx4 v[84:87], v7, s[4:7], s55 offen sc1
v_mfma_f32_16x16x32_bf16 v[48:51], a[24:27], v[40:43], v[48:51]
ds_read_b128 v[36:39], v1 offset:26624
v_mfma_f32_16x16x32_bf16 v[52:55], a[152:155], v[40:43], v[52:55]
v_mfma_f32_16x16x32_bf16 v[64:67], v[40:43], v[152:155], v[64:67]
v_mfma_f32_16x16x32_bf16 v[48:51], a[28:31], v[44:47], v[48:51]
ds_read_b128 v[40:43], v1 offset:28672
v_mfma_f32_16x16x32_bf16 v[52:55], a[156:159], v[44:47], v[52:55]
buffer_store_dwordx4 v[88:91], v8, s[4:7], s55 offen sc1
v_mfma_f32_16x16x32_bf16 v[64:67], v[44:47], v[156:159], v[64:67]
s_waitcnt lgkmcnt(5)
v_mfma_f32_16x16x32_bf16 v[48:51], a[32:35], v[16:19], v[48:51]
ds_read_b128 v[44:47], v1 offset:30720
v_mfma_f32_16x16x32_bf16 v[52:55], a[160:163], v[16:19], v[52:55]
v_mfma_f32_16x16x32_bf16 v[64:67], v[16:19], v[160:163], v[64:67]
v_mov_b32 v5, s36
s_add_u32 m0, s50, 0
v_mfma_f32_16x16x32_bf16 v[48:51], a[36:39], v[20:23], v[48:51]
s_add_u32 s39, s45, 0
ds_read_b128 v[16:19], v1 offset:32768
buffer_load_dwordx4 v0, s[4:7], s39 offen offset:0 sc1 lds
v_mfma_f32_16x16x32_bf16 v[52:55], a[164:167], v[20:23], v[52:55]
v_mfma_f32_16x16x32_bf16 v[64:67], v[20:23], v[164:167], v[64:67]
s_waitcnt lgkmcnt(5)
v_mfma_f32_16x16x32_bf16 v[48:51], a[40:43], v[24:27], v[48:51]
ds_read_b128 v[20:23], v1 offset:34816
v_mfma_f32_16x16x32_bf16 v[52:55], a[168:171], v[24:27], v[52:55]
v_mfma_f32_16x16x32_bf16 v[64:67], v[24:27], v[168:171], v[64:67]
v_mfma_f32_16x16x32_bf16 v[48:51], a[44:47], v[28:31], v[48:51]
ds_read_b128 v[24:27], v1 offset:36864
v_mfma_f32_16x16x32_bf16 v[52:55], a[172:175], v[28:31], v[52:55]
v_mfma_f32_16x16x32_bf16 v[64:67], v[28:31], v[172:175], v[64:67]
s_waitcnt lgkmcnt(5)
v_mfma_f32_16x16x32_bf16 v[48:51], a[48:51], v[32:35], v[48:51]
ds_read_b128 v[28:31], v1 offset:38912
v_mfma_f32_16x16x32_bf16 v[52:55], a[176:179], v[32:35], v[52:55]
buffer_load_dwordx4 v0, s[4:7], s39 offen offset:2048 sc1 lds
s_add_u32 m0, s50, 16384
v_mfma_f32_16x16x32_bf16 v[64:67], v[32:35], v[176:179], v[64:67]
s_add_u32 s39, s45, 16384
v_mfma_f32_16x16x32_bf16 v[48:51], a[52:55], v[36:39], v[48:51]
ds_read_b128 v[32:35], v1 offset:40960
v_mfma_f32_16x16x32_bf16 v[52:55], a[180:183], v[36:39], v[52:55]
v_mfma_f32_16x16x32_bf16 v[64:67], v[36:39], v[180:183], v[64:67]
s_waitcnt lgkmcnt(5)
v_mfma_f32_16x16x32_bf16 v[48:51], a[56:59], v[40:43], v[48:51]
ds_read_b128 v[36:39], v1 offset:43008
v_mfma_f32_16x16x32_bf16 v[52:55], a[184:187], v[40:43], v[52:55]
v_mfma_f32_16x16x32_bf16 v[64:67], v[40:43], v[184:187], v[64:67]
v_mfma_f32_16x16x32_bf16 v[48:51], a[60:63], v[44:47], v[48:51]
ds_read_b128 v[40:43], v1 offset:45056
v_mfma_f32_16x16x32_bf16 v[52:55], a[188:191], v[44:47], v[52:55]
v_mfma_f32_16x16x32_bf16 v[64:67], v[44:47], v[188:191], v[64:67]
s_waitcnt lgkmcnt(5)
buffer_load_dwordx4 v0, s[4:7], s39 offen offset:0 sc1 lds
v_mfma_f32_16x16x32_bf16 v[48:51], a[64:67], v[16:19], v[48:51]
ds_read_b128 v[44:47], v1 offset:47104
v_mfma_f32_16x16x32_bf16 v[52:55], a[192:195], v[16:19], v[52:55]
v_mfma_f32_16x16x32_bf16 v[64:67], v[16:19], v[192:195], v[64:67]
v_mfma_f32_16x16x32_bf16 v[48:51], a[68:71], v[20:23], v[48:51]
ds_read_b128 v[16:19], v1 offset:49152
v_mfma_f32_16x16x32_bf16 v[52:55], a[196:199], v[20:23], v[52:55]
v_mfma_f32_16x16x32_bf16 v[64:67], v[20:23], v[196:199], v[64:67]
s_waitcnt lgkmcnt(5)
v_mfma_f32_16x16x32_bf16 v[48:51], a[72:75], v[24:27], v[48:51]
ds_read_b128 v[20:23], v1 offset:51200
v_mfma_f32_16x16x32_bf16 v[52:55], a[200:203], v[24:27], v[52:55]
v_mfma_f32_16x16x32_bf16 v[64:67], v[24:27], v[200:203], v[64:67]
v_mfma_f32_16x16x32_bf16 v[48:51], a[76:79], v[28:31], v[48:51]
ds_read_b128 v[24:27], v1 offset:53248
buffer_load_dwordx4 v0, s[4:7], s39 offen offset:2048 sc1 lds
v_mfma_f32_16x16x32_bf16 v[52:55], a[204:207], v[28:31], v[52:55]
s_add_u32 m0, s50, 32768
s_add_u32 s39, s45, 32768
v_mfma_f32_16x16x32_bf16 v[64:67], v[28:31], v[204:207], v[64:67]
s_waitcnt lgkmcnt(5)
v_mfma_f32_16x16x32_bf16 v[48:51], a[80:83], v[32:35], v[48:51]
ds_read_b128 v[28:31], v1 offset:55296
v_mfma_f32_16x16x32_bf16 v[52:55], a[208:211], v[32:35], v[52:55]
v_mfma_f32_16x16x32_bf16 v[64:67], v[32:35], v[208:211], v[64:67]
v_mfma_f32_16x16x32_bf16 v[48:51], a[84:87], v[36:39], v[48:51]
ds_read_b128 v[32:35], v1 offset:57344
v_mfma_f32_16x16x32_bf16 v[52:55], a[212:215], v[36:39], v[52:55]
v_mfma_f32_16x16x32_bf16 v[64:67], v[36:39], v[212:215], v[64:67]
s_waitcnt lgkmcnt(5)
v_mfma_f32_16x16x32_bf16 v[48:51], a[88:91], v[40:43], v[48:51]
ds_read_b128 v[36:39], v1 offset:59392
v_mfma_f32_16x16x32_bf16 v[52:55], a[216:219], v[40:43], v[52:55]
buffer_load_dwordx4 v0, s[4:7], s39 offen offset:0 sc1 lds
v_mfma_f32_16x16x32_bf16 v[64:67], v[40:43], v[216:219], v[64:67]
v_mfma_f32_16x16x32_bf16 v[48:51], a[92:95], v[44:47], v[48:51]
ds_read_b128 v[40:43], v1 offset:61440
v_mfma_f32_16x16x32_bf16 v[52:55], a[220:223], v[44:47], v[52:55]
v_mfma_f32_16x16x32_bf16 v[64:67], v[44:47], v[220:223], v[64:67]
s_waitcnt lgkmcnt(5)
v_mfma_f32_16x16x32_bf16 v[48:51], a[96:99], v[16:19], v[48:51]
ds_read_b128 v[44:47], v1 offset:63488
v_mfma_f32_16x16x32_bf16 v[52:55], a[224:227], v[16:19], v[52:55]
v_mfma_f32_16x16x32_bf16 v[64:67], v[16:19], v[224:227], v[64:67]
v_mfma_f32_16x16x32_bf16 v[48:51], a[100:103], v[20:23], v[48:51]
s_waitcnt vmcnt(5)
s_barrier
ds_read_b128 v[16:19], v1 offset:1024
v_mfma_f32_16x16x32_bf16 v[52:55], a[228:231], v[20:23], v[52:55]
buffer_store_dword v5, v4, s[4:7], 0 offen sc1
v_mfma_f32_16x16x32_bf16 v[64:67], v[20:23], v[228:231], v[64:67]
s_waitcnt lgkmcnt(5)
v_mfma_f32_16x16x32_bf16 v[48:51], a[104:107], v[24:27], v[48:51]
ds_read_b128 v[20:23], v1 offset:3072
v_mfma_f32_16x16x32_bf16 v[52:55], a[232:235], v[24:27], v[52:55]
v_mfma_f32_16x16x32_bf16 v[64:67], v[24:27], v[232:235], v[64:67]
v_mfma_f32_16x16x32_bf16 v[48:51], a[108:111], v[28:31], v[48:51]
ds_read_b128 v[24:27], v1 offset:5120
buffer_load_dwordx4 v0, s[4:7], s39 offen offset:2048 sc1 lds
v_mfma_f32_16x16x32_bf16 v[52:55], a[236:239], v[28:31], v[52:55]
s_add_u32 m0, s50, 49152
s_add_u32 s39, s45, 49152
v_mfma_f32_16x16x32_bf16 v[64:67], v[28:31], v[236:239], v[64:67]
s_waitcnt lgkmcnt(5)
v_mfma_f32_16x16x32_bf16 v[48:51], a[112:115], v[32:35], v[48:51]
ds_read_b128 v[28:31], v1 offset:7168
v_mfma_f32_16x16x32_bf16 v[52:55], a[240:243], v[32:35], v[52:55]
v_mfma_f32_16x16x32_bf16 v[64:67], v[32:35], v[240:243], v[64:67]
v_mfma_f32_16x16x32_bf16 v[48:51], a[116:119], v[36:39], v[48:51]
ds_read_b128 v[32:35], v1 offset:9216
v_mfma_f32_16x16x32_bf16 v[52:55], a[244:247], v[36:39], v[52:55]
v_mfma_f32_16x16x32_bf16 v[64:67], v[36:39], v[244:247], v[64:67]
s_waitcnt lgkmcnt(5)
v_mfma_f32_16x16x32_bf16 v[48:51], a[120:123], v[40:43], v[48:51]
ds_read_b128 v[36:39], v1 offset:11264
v_mfma_f32_16x16x32_bf16 v[52:55], a[248:251], v[40:43], v[52:55]
buffer_load_dwordx4 v0, s[4:7], s39 offen offset:0 sc1 lds
v_mfma_f32_16x16x32_bf16 v[64:67], v[40:43], v[248:251], v[64:67]
v_mfma_f32_16x16x32_bf16 v[48:51], a[124:127], v[44:47], v[48:51]
ds_read_b128 v[40:43], v1 offset:13312
v_mfma_f32_16x16x32_bf16 v[52:55], a[252:255], v[44:47], v[52:55]
v_mfma_f32_16x16x32_bf16 v[64:67], v[44:47], v[252:255], v[64:67]
s_waitcnt lgkmcnt(5)
v_mfma_f32_16x16x32_bf16 v[56:59], a[0:3], v[16:19], 0
ds_read_b128 v[44:47], v1 offset:15360
v_mfma_f32_16x16x32_bf16 v[60:63], a[128:131], v[16:19], 0
v_mfma_f32_16x16x32_bf16 v[68:71], v[16:19], v[128:131], 0
v_mfma_f32_16x16x32_bf16 v[56:59], a[4:7], v[20:23], v[56:59]
ds_read_b128 v[16:19], v1 offset:17408
v_mfma_f32_16x16x32_bf16 v[60:63], a[132:135], v[20:23], v[60:63]
v_mfma_f32_16x16x32_bf16 v[68:71], v[20:23], v[132:135], v[68:71]
s_waitcnt lgkmcnt(5)
buffer_load_dwordx4 v0, s[4:7], s39 offen offset:2048 sc1 lds
s_add_u32 m0, s50, 0
v_mfma_f32_16x16x32_bf16 v[56:59], a[8:11], v[24:27], v[56:59]
s_add_u32 s39, s45, 0
ds_read_b128 v[20:23], v1 offset:19456
v_mfma_f32_16x16x32_bf16 v[60:63], a[136:139], v[24:27], v[60:63]
v_mfma_f32_16x16x32_bf16 v[68:71], v[24:27], v[136:139], v[68:71]
v_mfma_f32_16x16x32_bf16 v[56:59], a[12:15], v[28:31], v[56:59]
ds_read_b128 v[24:27], v1 offset:21504
v_cvt_pk_bf16_f32 v80, v48, v49
v_mfma_f32_16x16x32_bf16 v[60:63], a[140:143], v[28:31], v[60:63]
v_cvt_pk_bf16_f32 v81, v50, v51
v_cvt_pk_bf16_f32 v82, v52, v53
v_mfma_f32_16x16x32_bf16 v[68:71], v[28:31], v[140:143], v[68:71]
s_waitcnt lgkmcnt(5)
v_cvt_pk_bf16_f32 v83, v54, v55
v_cvt_pk_bf16_f32 v88, v64, v65
v_mfma_f32_16x16x32_bf16 v[56:59], a[16:19], v[32:35], v[56:59]
ds_read_b128 v[28:31], v1 offset:23552
v_cvt_pk_bf16_f32 v89, v66, v67
v_mfma_f32_16x16x32_bf16 v[60:63], a[144:147], v[32:35], v[60:63]
s_add_u32 s49, s49, 786432
s_mov_b32 s55, s49
s_add_u32 s36, s36, 1
v_mfma_f32_16x16x32_bf16 v[68:71], v[32:35], v[144:147], v[68:71]
v_mfma_f32_16x16x32_bf16 v[56:59], a[20:23], v[36:39], v[56:59]
ds_read_b128 v[32:35], v1 offset:25600
buffer_load_dwordx4 v0, s[4:7], s39 offen offset:1024 sc1 lds
v_mfma_f32_16x16x32_bf16 v[60:63], a[148:151], v[36:39], v[60:63]
v_mfma_f32_16x16x32_bf16 v[68:71], v[36:39], v[148:151], v[68:71]
s_waitcnt lgkmcnt(5)
v_mfma_f32_16x16x32_bf16 v[56:59], a[24:27], v[40:43], v[56:59]
ds_read_b128 v[36:39], v1 offset:27648
v_mfma_f32_16x16x32_bf16 v[60:63], a[152:155], v[40:43], v[60:63]
v_mfma_f32_16x16x32_bf16 v[68:71], v[40:43], v[152:155], v[68:71]
v_mfma_f32_16x16x32_bf16 v[56:59], a[28:31], v[44:47], v[56:59]
ds_read_b128 v[40:43], v1 offset:29696
v_mfma_f32_16x16x32_bf16 v[60:63], a[156:159], v[44:47], v[60:63]
v_mfma_f32_16x16x32_bf16 v[68:71], v[44:47], v[156:159], v[68:71]
s_waitcnt lgkmcnt(5)
v_mfma_f32_16x16x32_bf16 v[56:59], a[32:35], v[16:19], v[56:59]
ds_read_b128 v[44:47], v1 offset:31744
v_mfma_f32_16x16x32_bf16 v[60:63], a[160:163], v[16:19], v[60:63]
buffer_load_dwordx4 v0, s[4:7], s39 offen offset:3072 sc1 lds
s_add_u32 m0, s50, 16384
v_mfma_f32_16x16x32_bf16 v[68:71], v[16:19], v[160:163], v[68:71]
s_add_u32 s39, s45, 16384
v_mfma_f32_16x16x32_bf16 v[56:59], a[36:39], v[20:23], v[56:59]
ds_read_b128 v[16:19], v1 offset:33792
v_mfma_f32_16x16x32_bf16 v[60:63], a[164:167], v[20:23], v[60:63]
v_mfma_f32_16x16x32_bf16 v[68:71], v[20:23], v[164:167], v[68:71]
s_waitcnt lgkmcnt(5)
v_mfma_f32_16x16x32_bf16 v[56:59], a[40:43], v[24:27], v[56:59]
ds_read_b128 v[20:23], v1 offset:35840
v_mfma_f32_16x16x32_bf16 v[60:63], a[168:171], v[24:27], v[60:63]
v_mfma_f32_16x16x32_bf16 v[68:71], v[24:27], v[168:171], v[68:71]
v_mfma_f32_16x16x32_bf16 v[56:59], a[44:47], v[28:31], v[56:59]
ds_read_b128 v[24:27], v1 offset:37888
v_mfma_f32_16x16x32_bf16 v[60:63], a[172:175], v[28:31], v[60:63]
v_mfma_f32_16x16x32_bf16 v[68:71], v[28:31], v[172:175], v[68:71]
s_waitcnt lgkmcnt(5)
buffer_load_dwordx4 v0, s[4:7], s39 offen offset:1024 sc1 lds
v_mfma_f32_16x16x32_bf16 v[56:59], a[48:51], v[32:35], v[56:59]
ds_read_b128 v[28:31], v1 offset:39936
v_mfma_f32_16x16x32_bf16 v[60:63], a[176:179], v[32:35], v[60:63]
v_mfma_f32_16x16x32_bf16 v[68:71], v[32:35], v[176:179], v[68:71]
v_mfma_f32_16x16x32_bf16 v[56:59], a[52:55], v[36:39], v[56:59]
ds_read_b128 v[32:35], v1 offset:41984
v_mfma_f32_16x16x32_bf16 v[60:63], a[180:183], v[36:39], v[60:63]
v_mfma_f32_16x16x32_bf16 v[68:71], v[36:39], v[180:183], v[68:71]
s_waitcnt lgkmcnt(5)
v_mfma_f32_16x16x32_bf16 v[56:59], a[56:59], v[40:43], v[56:59]
ds_read_b128 v[36:39], v1 offset:44032
v_mfma_f32_16x16x32_bf16 v[60:63], a[184:187], v[40:43], v[60:63]
v_mfma_f32_16x16x32_bf16 v[68:71], v[40:43], v[184:187], v[68:71]
v_mfma_f32_16x16x32_bf16 v[56:59], a[60:63], v[44:47], v[56:59]
ds_read_b128 v[40:43], v1 offset:46080
buffer_load_dwordx4 v0, s[4:7], s39 offen offset:3072 sc1 lds
v_mfma_f32_16x16x32_bf16 v[60:63], a[188:191], v[44:47], v[60:63]
s_add_u32 m0, s50, 32768
s_add_u32 s39, s45, 32768
v_mfma_f32_16x16x32_bf16 v[68:71], v[44:47], v[188:191], v[68:71]
s_waitcnt lgkmcnt(5)
v_mfma_f32_16x16x32_bf16 v[56:59], a[64:67], v[16:19], v[56:59]
ds_read_b128 v[44:47], v1 offset:48128
v_mfma_f32_16x16x32_bf16 v[60:63], a[192:195], v[16:19], v[60:63]
v_mfma_f32_16x16x32_bf16 v[68:71], v[16:19], v[192:195], v[68:71]
v_mfma_f32_16x16x32_bf16 v[56:59], a[68:71], v[20:23], v[56:59]
ds_read_b128 v[16:19], v1 offset:50176
v_mfma_f32_16x16x32_bf16 v[60:63], a[196:199], v[20:23], v[60:63]
v_mfma_f32_16x16x32_bf16 v[68:71], v[20:23], v[196:199], v[68:71]
s_waitcnt lgkmcnt(5)
v_mfma_f32_16x16x32_bf16 v[56:59], a[72:75], v[24:27], v[56:59]
ds_read_b128 v[20:23], v1 offset:52224
v_mfma_f32_16x16x32_bf16 v[60:63], a[200:203], v[24:27], v[60:63]
buffer_load_dwordx4 v0, s[4:7], s39 offen offset:1024 sc1 lds
v_mfma_f32_16x16x32_bf16 v[68:71], v[24:27], v[200:203], v[68:71]
v_mfma_f32_16x16x32_bf16 v[56:59], a[76:79], v[28:31], v[56:59]
ds_read_b128 v[24:27], v1 offset:54272
v_mfma_f32_16x16x32_bf16 v[60:63], a[204:207], v[28:31], v[60:63]
v_mfma_f32_16x16x32_bf16 v[68:71], v[28:31], v[204:207], v[68:71]
s_waitcnt lgkmcnt(5)
v_mfma_f32_16x16x32_bf16 v[56:59], a[80:83], v[32:35], v[56:59]
ds_read_b128 v[28:31], v1 offset:56320
v_mfma_f32_16x16x32_bf16 v[60:63], a[208:211], v[32:35], v[60:63]
v_mfma_f32_16x16x32_bf16 v[68:71], v[32:35], v[208:211], v[68:71]
v_mfma_f32_16x16x32_bf16 v[56:59], a[84:87], v[36:39], v[56:59]
ds_read_b128 v[32:35], v1 offset:58368
v_mfma_f32_16x16x32_bf16 v[60:63], a[212:215], v[36:39], v[60:63]
v_mfma_f32_16x16x32_bf16 v[68:71], v[36:39], v[212:215], v[68:71]
s_waitcnt lgkmcnt(5)
buffer_load_dwordx4 v0, s[4:7], s39 offen offset:3072 sc1 lds
s_add_u32 m0, s50, 49152
v_mfma_f32_16x16x32_bf16 v[56:59], a[88:91], v[40:43], v[56:59]
s_add_u32 s39, s45, 49152
ds_read_b128 v[36:39], v1 offset:60416
v_mfma_f32_16x16x32_bf16 v[60:63], a[216:219], v[40:43], v[60:63]
v_mfma_f32_16x16x32_bf16 v[68:71], v[40:43], v[216:219], v[68:71]
v_mfma_f32_16x16x32_bf16 v[56:59], a[92:95], v[44:47], v[56:59]
ds_read_b128 v[40:43], v1 offset:62464
v_mfma_f32_16x16x32_bf16 v[60:63], a[220:223], v[44:47], v[60:63]
v_mfma_f32_16x16x32_bf16 v[68:71], v[44:47], v[220:223], v[68:71]
s_waitcnt lgkmcnt(5)
v_mfma_f32_16x16x32_bf16 v[56:59], a[96:99], v[16:19], v[56:59]
ds_read_b128 v[44:47], v1 offset:64512
v_mfma_f32_16x16x32_bf16 v[60:63], a[224:227], v[16:19], v[60:63]
v_mfma_f32_16x16x32_bf16 v[68:71], v[16:19], v[224:227], v[68:71]
v_mfma_f32_16x16x32_bf16 v[56:59], a[100:103], v[20:23], v[56:59]
buffer_load_dwordx4 v0, s[4:7], s39 offen offset:1024 sc1 lds
v_mfma_f32_16x16x32_bf16 v[60:63], a[228:231], v[20:23], v[60:63]
v_mfma_f32_16x16x32_bf16 v[68:71], v[20:23], v[228:231], v[68:71]
s_waitcnt lgkmcnt(4)
v_mfma_f32_16x16x32_bf16 v[56:59], a[104:107], v[24:27], v[56:59]
v_mfma_f32_16x16x32_bf16 v[60:63], a[232:235], v[24:27], v[60:63]
v_mfma_f32_16x16x32_bf16 v[68:71], v[24:27], v[232:235], v[68:71]
v_xor_b32 v1, 0x10000, v1
s_waitcnt vmcnt(7) lgkmcnt(0)
s_barrier
v_mfma_f32_16x16x32_bf16 v[56:59], a[108:111], v[28:31], v[56:59]
ds_read_b128 v[16:19], v1 offset:0
ds_read_b128 v[20:23], v1 offset:2048
v_mfma_f32_16x16x32_bf16 v[60:63], a[236:239], v[28:31], v[60:63]
ds_read_b128 v[24:27], v1 offset:4096
v_mfma_f32_16x16x32_bf16 v[68:71], v[28:31], v[236:239], v[68:71]
v_mfma_f32_16x16x32_bf16 v[56:59], a[112:115], v[32:35], v[56:59]
ds_read_b128 v[28:31], v1 offset:6144
v_mfma_f32_16x16x32_bf16 v[60:63], a[240:243], v[32:35], v[60:63]
v_mfma_f32_16x16x32_bf16 v[68:71], v[32:35], v[240:243], v[68:71]
v_mfma_f32_16x16x32_bf16 v[56:59], a[116:119], v[36:39], v[56:59]
ds_read_b128 v[32:35], v1 offset:8192
v_mfma_f32_16x16x32_bf16 v[60:63], a[244:247], v[36:39], v[60:63]
buffer_load_dwordx4 v0, s[4:7], s39 offen offset:3072 sc1 lds
v_mfma_f32_16x16x32_bf16 v[68:71], v[36:39], v[244:247], v[68:71]
v_mfma_f32_16x16x32_bf16 v[56:59], a[120:123], v[40:43], v[56:59]
ds_read_b128 v[36:39], v1 offset:10240
v_mfma_f32_16x16x32_bf16 v[60:63], a[248:251], v[40:43], v[60:63]
v_mfma_f32_16x16x32_bf16 v[68:71], v[40:43], v[248:251], v[68:71]
s_cmp_lt_u32 s36, s48
v_mfma_f32_16x16x32_bf16 v[56:59], a[124:127], v[44:47], v[56:59]
ds_read_b128 v[40:43], v1 offset:12288
v_mfma_f32_16x16x32_bf16 v[60:63], a[252:255], v[44:47], v[60:63]
v_mfma_f32_16x16x32_bf16 v[68:71], v[44:47], v[252:255], v[68:71]
s_cbranch_scc1 Lql_597
s_cmp_eq_u32 s36, 64
s_cbranch_scc1 Lqe_599
v_lshlrev_b32 v14, 7, v9
s_mov_b32 s38, 3424256
Lbw_604:
buffer_load_dword v15, v14, s[4:7], s38 offen sc1
s_waitcnt vmcnt(0)
v_cmp_gt_u32 vcc, 3, v15
s_cbranch_vccz Lbo_605
s_sub_u32 s37, s37, 1
s_cbranch_scc1 Lend_7
s_sleep 2
s_branch Lbw_604
Lbo_605:
s_mov_b32 s48, 64
s_branch Lql_597
Lqe_599:
s_nop 7
v_cvt_pk_bf16_f32 v84, v56, v57
v_cvt_pk_bf16_f32 v85, v58, v59
v_cvt_pk_bf16_f32 v86, v60, v61
v_cvt_pk_bf16_f32 v87, v62, v63
v_cvt_pk_bf16_f32 v90, v68, v69
v_cvt_pk_bf16_f32 v91, v70, v71
buffer_store_dwordx4 v[80:83], v6, s[4:7], s55 offen sc1
buffer_store_dwordx4 v[84:87], v7, s[4:7], s55 offen sc1
buffer_store_dwordx4 v[88:91], v8, s[4:7], s55 offen sc1
v_mov_b32 v5, 64
s_waitcnt vmcnt(0) lgkmcnt(0)
s_barrier
buffer_store_dword v5, v4, s[4:7], 0 offen sc1
s_load_dwordx2 s[16:17], s[0:1], 104
s_and_b32 s52, s44, 3
s_lshr_b32 s53, s44, 2
v_lshrrev_b32 v80, 3, v9
v_and_b32 v81, 7, v9
s_lshr_b32 s38, s52, 1
s_lshl_b32 s38, s38, 10
s_and_b32 s39, s52, 1
s_lshl_b32 s39, s39, 7
s_add_u32 s38, s38, s39
s_lshl_b32 s39, s53, 12
s_add_u32 s38, s38, s39
v_lshl_add_u32 v6, v81, 4, s38
v_and_b32 v82, 3, v80
v_lshl_add_u32 v6, v82, 8, v6
v_lshrrev_b32 v82, 2, v80
v_lshl_add_u32 v6, v82, 11, v6
s_lshl_b32 s38, s52, 14
s_lshl_b32 s39, s53, 7
s_add_u32 s38, s38, s39
v_lshl_add_u32 v7, v81, 11, s38
v_lshl_add_u32 v7, v80, 4, v7
s_lshl_b32 s38, s53, 8
v_lshl_add_u32 v8, v80, 5, s38
v_min_u32 v2, 6, v9
v_lshlrev_b32 v2, 10, v2
s_lshr_b32 s47, s44, 3
s_lshl_b32 s47, s47, 7
s_add_u32 s47, s47, 3416068
s_mov_b32 s60, 0x00003f80
s_mov_b32 s61, 0x3f800000
s_waitcnt lgkmcnt(0)
s_mov_b32 s8, s16
s_and_b32 s9, s17, 0xffff
s_mov_b32 s10, 0x400000
s_mov_b32 s11, 0x20000
Lst_606:
buffer_load_dword v48, off, s[12:15], 0 offset:16 sc1
buffer_load_dword v49, off, s[12:15], 0 offset:144 sc1
s_waitcnt vmcnt(0)
v_add_u32 v48, v48, v49
s_nop 0
v_readfirstlane_b32 s38, v48
s_nop 3
s_and_b32 s39, s38, 0xffff
s_cmp_eq_u32 s39, 0x100
s_cbranch_scc1 Lso_607
s_sub_u32 s37, s37, 1
s_cbranch_scc1 Lend_7
s_sleep 8
s_branch Lst_606
Lso_607:
s_bfe_u32 s35, s38, 0x80010
s_bfe_u32 s46, s38, 0x10018
s_lshl_b32 s46, s46, 13
s_barrier
v_min_u32 v80, 31, v9
v_lshlrev_b32 v80, 7, v80
s_mov_b32 s38, 3448832
Lbw_608:
buffer_load_dword v81, v80, s[4:7], s38 offen sc1
s_waitcnt vmcnt(0)
v_cmp_gt_u32 vcc, 1, v81
s_cbranch_vccz Lbo_609
s_sub_u32 s37, s37, 1
s_cbranch_scc1 Lend_7
s_sleep 8
s_branch Lbw_608
Lbo_609:
s_mov_b32 s38, 3166208
buffer_load_dwordx4 v[16:19], v8, s[4:7], s38 offen offset:0 sc1
buffer_load_dwordx4 v[20:23], v8, s[4:7], s38 offen offset:16 sc1
s_mov_b32 s36, s32
Lfin_610:
s_add_u32 s48, s36, 5
Lbw_611:
buffer_load_dword v3, v2, s[4:7], s47 offen sc1
s_waitcnt vmcnt(0)
v_cmp_gt_u32 vcc, s48, v3
s_cbranch_vccz Lbo_612
s_sub_u32 s37, s37, 1
s_cbranch_scc1 Lend_7
s_sleep 32
s_branch Lbw_611
Lbo_612:
s_lshl_b32 s49, s36, 16
Lfa_613:
s_add_u32 s39, s49, 134217728
buffer_load_dwordx4 v[64:67], v6, s[4:7], s39 offen sc1
s_add_u32 s39, s49, 138412032
buffer_load_dwordx4 v[68:71], v6, s[4:7], s39 offen sc1
s_add_u32 s39, s49, 142606336
buffer_load_dwordx4 v[72:75], v6, s[4:7], s39 offen sc1
s_add_u32 s39, s49, 146800640
buffer_load_dwordx4 v[76:79], v6, s[4:7], s39 offen sc1
s_add_u32 s39, s49, 150994944
buffer_load_dwordx4 v[80:83], v6, s[4:7], s39 offen sc1
s_add_u32 s39, s49, 155189248
buffer_load_dwordx4 v[84:87], v6, s[4:7], s39 offen sc1
s_add_u32 s39, s49, 159383552
buffer_load_dwordx4 v[88:91], v6, s[4:7], s39 offen sc1
s_add_u32 s39, s49, 12582912
buffer_load_dwordx4 v[92:95], v6, s[4:7], s39 offen sc1
s_add_u32 s39, s49, 134479872
buffer_load_dwordx4 v[96:99], v6, s[4:7], s39 offen sc1
s_add_u32 s39, s49, 138674176
buffer_load_dwordx4 v[100:103], v6, s[4:7], s39 offen sc1
s_add_u32 s39, s49, 142868480
buffer_load_dwordx4 v[104:107], v6, s[4:7], s39 offen sc1
s_add_u32 s39, s49, 147062784
buffer_load_dwordx4 v[108:111], v6, s[4:7], s39 offen sc1
s_add_u32 s39, s49, 151257088
buffer_load_dwordx4 v[112:115], v6, s[4:7], s39 offen sc1
s_add_u32 s39, s49, 155451392
buffer_load_dwordx4 v[116:119], v6, s[4:7], s39 offen sc1
s_add_u32 s39, s49, 159645696
buffer_load_dwordx4 v[120:123], v6, s[4:7], s39 offen sc1
s_add_u32 s39, s49, 12845056
buffer_load_dwordx4 v[124:127], v6, s[4:7], s39 offen sc1
s_waitcnt vmcnt(8)
v_dot2_f32_bf16 v24, v64, s60, 0
v_dot2_f32_bf16 v25, v64, s61, 0
v_dot2_f32_bf16 v26, v65, s60, 0
v_dot2_f32_bf16 v27, v65, s61, 0
v_dot2_f32_bf16 v28, v66, s60, 0
v_dot2_f32_bf16 v29, v66, s61, 0
v_dot2_f32_bf16 v30, v67, s60, 0
v_dot2_f32_bf16 v31, v67, s61, 0
v_dot2_f32_bf16 v24, v68, s60, v24
v_dot2_f32_bf16 v25, v68, s61, v25
v_dot2_f32_bf16 v26, v69, s60, v26
v_dot2_f32_bf16 v27, v69, s61, v27
v_dot2_f32_bf16 v28, v70, s60, v28
v_dot2_f32_bf16 v29, v70, s61, v29
v_dot2_f32_bf16 v30, v71, s60, v30
v_dot2_f32_bf16 v31, v71, s61, v31
v_dot2_f32_bf16 v24, v72, s60, v24
v_dot2_f32_bf16 v25, v72, s61, v25
v_dot2_f32_bf16 v26, v73, s60, v26
v_dot2_f32_bf16 v27, v73, s61, v27
v_dot2_f32_bf16 v28, v74, s60, v28
v_dot2_f32_bf16 v29, v74, s61, v29
v_dot2_f32_bf16 v30, v75, s60, v30
v_dot2_f32_bf16 v31, v75, s61, v31
v_dot2_f32_bf16 v24, v76, s60, v24
v_dot2_f32_bf16 v25, v76, s61, v25
v_dot2_f32_bf16 v26, v77, s60, v26
v_dot2_f32_bf16 v27, v77, s61, v27
v_dot2_f32_bf16 v28, v78, s60, v28
v_dot2_f32_bf16 v29, v78, s61, v29
v_dot2_f32_bf16 v30, v79, s60, v30
v_dot2_f32_bf16 v31, v79, s61, v31
v_dot2_f32_bf16 v24, v80, s60, v24
v_dot2_f32_bf16 v25, v80, s61, v25
v_dot2_f32_bf16 v26, v81, s60, v26
v_dot2_f32_bf16 v27, v81, s61, v27
v_dot2_f32_bf16 v28, v82, s60, v28
v_dot2_f32_bf16 v29, v82, s61, v29
v_dot2_f32_bf16 v30, v83, s60, v30
v_dot2_f32_bf16 v31, v83, s61, v31
v_dot2_f32_bf16 v24, v84, s60, v24
v_dot2_f32_bf16 v25, v84, s61, v25
v_dot2_f32_bf16 v26, v85, s60, v26
v_dot2_f32_bf16 v27, v85, s61, v27
v_dot2_f32_bf16 v28, v86, s60, v28
v_dot2_f32_bf16 v29, v86, s61, v29
v_dot2_f32_bf16 v30, v87, s60, v30
v_dot2_f32_bf16 v31, v87, s61, v31
v_dot2_f32_bf16 v24, v88, s60, v24
v_dot2_f32_bf16 v25, v88, s61, v25
v_dot2_f32_bf16 v26, v89, s60, v26
v_dot2_f32_bf16 v27, v89, s61, v27
v_dot2_f32_bf16 v28, v90, s60, v28
v_dot2_f32_bf16 v29, v90, s61, v29
v_dot2_f32_bf16 v30, v91, s60, v30
v_dot2_f32_bf16 v31, v91, s61, v31
v_lshlrev_b32 v32, 16, v92
v_and_b32 v33, 0xffff0000, v92
v_lshlrev_b32 v34, 16, v93
v_and_b32 v35, 0xffff0000, v93
v_lshlrev_b32 v36, 16, v94
v_and_b32 v37, 0xffff0000, v94
v_lshlrev_b32 v38, 16, v95
v_and_b32 v39, 0xffff0000, v95
v_pk_fma_f32 v[32:33], v[24:25], v[16:17], v[32:33]
v_pk_fma_f32 v[34:35], v[26:27], v[18:19], v[34:35]
v_pk_fma_f32 v[36:37], v[28:29], v[20:21], v[36:37]
v_pk_fma_f32 v[38:39], v[30:31], v[22:23], v[38:39]
v_cvt_pk_bf16_f32 v40, v32, v33
v_cvt_pk_bf16_f32 v41, v34, v35
v_cvt_pk_bf16_f32 v42, v36, v37
v_cvt_pk_bf16_f32 v43, v38, v39
s_add_u32 s39, s49, 0
buffer_store_dwordx4 v[40:43], v7, s[8:11], s39 offen sc1
s_waitcnt vmcnt(1)
v_dot2_f32_bf16 v24, v96, s60, 0
v_dot2_f32_bf16 v25, v96, s61, 0
v_dot2_f32_bf16 v26, v97, s60, 0
v_dot2_f32_bf16 v27, v97, s61, 0
v_dot2_f32_bf16 v28, v98, s60, 0
v_dot2_f32_bf16 v29, v98, s61, 0
v_dot2_f32_bf16 v30, v99, s60, 0
v_dot2_f32_bf16 v31, v99, s61, 0
v_dot2_f32_bf16 v24, v100, s60, v24
v_dot2_f32_bf16 v25, v100, s61, v25
v_dot2_f32_bf16 v26, v101, s60, v26
v_dot2_f32_bf16 v27, v101, s61, v27
v_dot2_f32_bf16 v28, v102, s60, v28
v_dot2_f32_bf16 v29, v102, s61, v29
v_dot2_f32_bf16 v30, v103, s60, v30
v_dot2_f32_bf16 v31, v103, s61, v31
v_dot2_f32_bf16 v24, v104, s60, v24
v_dot2_f32_bf16 v25, v104, s61, v25
v_dot2_f32_bf16 v26, v105, s60, v26
v_dot2_f32_bf16 v27, v105, s61, v27
v_dot2_f32_bf16 v28, v106, s60, v28
v_dot2_f32_bf16 v29, v106, s61, v29
v_dot2_f32_bf16 v30, v107, s60, v30
v_dot2_f32_bf16 v31, v107, s61, v31
v_dot2_f32_bf16 v24, v108, s60, v24
v_dot2_f32_bf16 v25, v108, s61, v25
v_dot2_f32_bf16 v26, v109, s60, v26
v_dot2_f32_bf16 v27, v109, s61, v27
v_dot2_f32_bf16 v28, v110, s60, v28
v_dot2_f32_bf16 v29, v110, s61, v29
v_dot2_f32_bf16 v30, v111, s60, v30
v_dot2_f32_bf16 v31, v111, s61, v31
v_dot2_f32_bf16 v24, v112, s60, v24
v_dot2_f32_bf16 v25, v112, s61, v25
v_dot2_f32_bf16 v26, v113, s60, v26
v_dot2_f32_bf16 v27, v113, s61, v27
v_dot2_f32_bf16 v28, v114, s60, v28
v_dot2_f32_bf16 v29, v114, s61, v29
v_dot2_f32_bf16 v30, v115, s60, v30
v_dot2_f32_bf16 v31, v115, s61, v31
v_dot2_f32_bf16 v24, v116, s60, v24
v_dot2_f32_bf16 v25, v116, s61, v25
v_dot2_f32_bf16 v26, v117, s60, v26
v_dot2_f32_bf16 v27, v117, s61, v27
v_dot2_f32_bf16 v28, v118, s60, v28
v_dot2_f32_bf16 v29, v118, s61, v29
v_dot2_f32_bf16 v30, v119, s60, v30
v_dot2_f32_bf16 v31, v119, s61, v31
v_dot2_f32_bf16 v24, v120, s60, v24
v_dot2_f32_bf16 v25, v120, s61, v25
v_dot2_f32_bf16 v26, v121, s60, v26
v_dot2_f32_bf16 v27, v121, s61, v27
v_dot2_f32_bf16 v28, v122, s60, v28
v_dot2_f32_bf16 v29, v122, s61, v29
v_dot2_f32_bf16 v30, v123, s60, v30
v_dot2_f32_bf16 v31, v123, s61, v31
v_lshlrev_b32 v32, 16, v124
v_and_b32 v33, 0xffff0000, v124
v_lshlrev_b32 v34, 16, v125
v_and_b32 v35, 0xffff0000, v125
v_lshlrev_b32 v36, 16, v126
v_and_b32 v37, 0xffff0000, v126
v_lshlrev_b32 v38, 16, v127
v_and_b32 v39, 0xffff0000, v127
v_pk_fma_f32 v[32:33], v[24:25], v[16:17], v[32:33]
v_pk_fma_f32 v[34:35], v[26:27], v[18:19], v[34:35]
v_pk_fma_f32 v[36:37], v[28:29], v[20:21], v[36:37]
v_pk_fma_f32 v[38:39], v[30:31], v[22:23], v[38:39]
v_cvt_pk_bf16_f32 v44, v32, v33
v_cvt_pk_bf16_f32 v45, v34, v35
v_cvt_pk_bf16_f32 v46, v36, v37
v_cvt_pk_bf16_f32 v47, v38, v39
s_add_u32 s39, s49, 262144
buffer_store_dwordx4 v[44:47], v7, s[8:11], s39 offen sc1
s_add_u32 s36, s36, 8
s_cmp_lt_u32 s36, 48
s_cbranch_scc1 Lfin_610
Lfin_614:
s_add_u32 s48, s36, 1
Lbw_615:
buffer_load_dword v3, v2, s[4:7], s47 offen sc1
s_waitcnt vmcnt(0)
v_cmp_gt_u32 vcc, s48, v3
s_cbranch_vccz Lbo_616
s_sub_u32 s37, s37, 1
s_cbranch_scc1 Lend_7
s_sleep 4
s_branch Lbw_615
Lbo_616:
s_lshl_b32 s49, s36, 16
Lfa_617:
s_add_u32 s39, s49, 134217728
buffer_load_dwordx4 v[64:67], v6, s[4:7], s39 offen sc1
s_add_u32 s39, s49, 138412032
buffer_load_dwordx4 v[68:71], v6, s[4:7], s39 offen sc1
s_add_u32 s39, s49, 142606336
buffer_load_dwordx4 v[72:75], v6, s[4:7], s39 offen sc1
s_add_u32 s39, s49, 146800640
buffer_load_dwordx4 v[76:79], v6, s[4:7], s39 offen sc1
s_add_u32 s39, s49, 150994944
buffer_load_dwordx4 v[80:83], v6, s[4:7], s39 offen sc1
s_add_u32 s39, s49, 155189248
buffer_load_dwordx4 v[84:87], v6, s[4:7], s39 offen sc1
s_add_u32 s39, s49, 159383552
buffer_load_dwordx4 v[88:91], v6, s[4:7], s39 offen sc1
s_add_u32 s39, s49, 12582912
buffer_load_dwordx4 v[92:95], v6, s[4:7], s39 offen sc1
s_waitcnt vmcnt(0)
s_sub_u32 s37, s37, 1
s_cbranch_scc1 Lend_7
v_max3_u32 v24, v64, v65, v66
v_max3_u32 v24, v24, v67, v68
v_max3_u32 v24, v24, v69, v70
v_max3_u32 v24, v24, v71, v72
v_max3_u32 v24, v24, v73, v74
v_max3_u32 v24, v24, v75, v76
v_max3_u32 v24, v24, v77, v78
v_max3_u32 v24, v24, v79, v80
v_max3_u32 v24, v24, v81, v82
v_max3_u32 v24, v24, v83, v84
v_max3_u32 v24, v24, v85, v86
v_max3_u32 v24, v24, v87, v88
v_max3_u32 v24, v24, v89, v90
v_max_u32 v24, v24, v91
v_cmp_eq_u32 vcc, -1, v24
s_cbranch_vccnz Lfa_617
v_dot2_f32_bf16 v24, v64, s60, 0
v_dot2_f32_bf16 v25, v64, s61, 0
v_dot2_f32_bf16 v26, v65, s60, 0
v_dot2_f32_bf16 v27, v65, s61, 0
v_dot2_f32_bf16 v28, v66, s60, 0
v_dot2_f32_bf16 v29, v66, s61, 0
v_dot2_f32_bf16 v30, v67, s60, 0
v_dot2_f32_bf16 v31, v67, s61, 0
v_dot2_f32_bf16 v24, v68, s60, v24
v_dot2_f32_bf16 v25, v68, s61, v25
v_dot2_f32_bf16 v26, v69, s60, v26
v_dot2_f32_bf16 v27, v69, s61, v27
v_dot2_f32_bf16 v28, v70, s60, v28
v_dot2_f32_bf16 v29, v70, s61, v29
v_dot2_f32_bf16 v30, v71, s60, v30
v_dot2_f32_bf16 v31, v71, s61, v31
v_dot2_f32_bf16 v24, v72, s60, v24
v_dot2_f32_bf16 v25, v72, s61, v25
v_dot2_f32_bf16 v26, v73, s60, v26
v_dot2_f32_bf16 v27, v73, s61, v27
v_dot2_f32_bf16 v28, v74, s60, v28
v_dot2_f32_bf16 v29, v74, s61, v29
v_dot2_f32_bf16 v30, v75, s60, v30
v_dot2_f32_bf16 v31, v75, s61, v31
v_dot2_f32_bf16 v24, v76, s60, v24
v_dot2_f32_bf16 v25, v76, s61, v25
v_dot2_f32_bf16 v26, v77, s60, v26
v_dot2_f32_bf16 v27, v77, s61, v27
v_dot2_f32_bf16 v28, v78, s60, v28
v_dot2_f32_bf16 v29, v78, s61, v29
v_dot2_f32_bf16 v30, v79, s60, v30
v_dot2_f32_bf16 v31, v79, s61, v31
v_dot2_f32_bf16 v24, v80, s60, v24
v_dot2_f32_bf16 v25, v80, s61, v25
v_dot2_f32_bf16 v26, v81, s60, v26
v_dot2_f32_bf16 v27, v81, s61, v27
v_dot2_f32_bf16 v28, v82, s60, v28
v_dot2_f32_bf16 v29, v82, s61, v29
v_dot2_f32_bf16 v30, v83, s60, v30
v_dot2_f32_bf16 v31, v83, s61, v31
v_dot2_f32_bf16 v24, v84, s60, v24
v_dot2_f32_bf16 v25, v84, s61, v25
v_dot2_f32_bf16 v26, v85, s60, v26
v_dot2_f32_bf16 v27, v85, s61, v27
v_dot2_f32_bf16 v28, v86, s60, v28
v_dot2_f32_bf16 v29, v86, s61, v29
v_dot2_f32_bf16 v30, v87, s60, v30
v_dot2_f32_bf16 v31, v87, s61, v31
v_dot2_f32_bf16 v24, v88, s60, v24
v_dot2_f32_bf16 v25, v88, s61, v25
v_dot2_f32_bf16 v26, v89, s60, v26
v_dot2_f32_bf16 v27, v89, s61, v27
v_dot2_f32_bf16 v28, v90, s60, v28
v_dot2_f32_bf16 v29, v90, s61, v29
v_dot2_f32_bf16 v30, v91, s60, v30
v_dot2_f32_bf16 v31, v91, s61, v31
v_lshlrev_b32 v32, 16, v92
v_and_b32 v33, 0xffff0000, v92
v_lshlrev_b32 v34, 16, v93
v_and_b32 v35, 0xffff0000, v93
v_lshlrev_b32 v36, 16, v94
v_and_b32 v37, 0xffff0000, v94
v_lshlrev_b32 v38, 16, v95
v_and_b32 v39, 0xffff0000, v95
v_pk_fma_f32 v[32:33], v[24:25], v[16:17], v[32:33]
v_pk_fma_f32 v[34:35], v[26:27], v[18:19], v[34:35]
v_pk_fma_f32 v[36:37], v[28:29], v[20:21], v[36:37]
v_pk_fma_f32 v[38:39], v[30:31], v[22:23], v[38:39]
v_cvt_pk_bf16_f32 v40, v32, v33
v_cvt_pk_bf16_f32 v41, v34, v35
v_cvt_pk_bf16_f32 v42, v36, v37
v_cvt_pk_bf16_f32 v43, v38, v39
s_add_u32 s39, s49, 0
buffer_store_dwordx4 v[40:43], v7, s[8:11], s39 offen sc1
s_add_u32 s36, s36, 4
s_cmp_lt_u32 s36, 64
s_cbranch_scc1 Lfin_614
s_endpgm
Lend_7:
s_endpgm
Lhelper_5:
v_mov_b32 v9, v1
s_sub_u32 s52, s33, 4
s_lshl_b32 s26, s34, 2
s_add_u32 s26, s26, s52
s_sub_u32 s26, s26, 64
s_lshr_b32 s38, s52, 1
s_lshl_b32 s39, s38, 3
s_add_u32 s39, s39, 16
s_lshl_b32 s38, s38, 2
s_cmp_ge_u32 s34, 28
s_cselect_b32 s53, 28, 24
s_add_u32 s38, s38, s53
s_cmp_ge_u32 s34, 24
s_cselect_b32 s38, s38, s39
s_lshl_b32 s39, s52, 3
s_sub_u32 s39, s39, 16
s_bitcmp1_b32 s52, 0
s_cselect_b32 s38, s38, s39
s_add_u32 s44, s38, s34
s_load_dwordx2 s[16:17], s[0:1], 96
s_load_dwordx2 s[18:19], s[0:1], 88
s_load_dwordx2 s[20:21], s[0:1], 0
s_lshl_b32 s38, s26, 7
s_add_u32 s38, s38, 3424256
v_min_u32 v80, 1, v0
v_lshl_add_u32 v10, v80, 30, s38
s_lshl_b32 s38, s44, 7
s_add_u32 s38, s38, 3416064
v_min_u32 v80, 1, v0
v_lshl_add_u32 v8, v80, 30, s38
v_mov_b32 v14, 0
v_mov_b32 v15, 0
buffer_store_dword v14, v10, s[4:7], 0 offen sc1
buffer_store_dwordx2 v[14:15], v8, s[4:7], 0 offen sc1
s_waitcnt lgkmcnt(0)
s_mov_b32 s8, s16
s_and_b32 s9, s17, 0xffff
s_mov_b32 s10, 0xc00000
s_mov_b32 s11, 0x20000
s_mov_b32 s84, s18
s_and_b32 s85, s19, 0xffff
s_mov_b32 s86, 0x800
s_mov_b32 s87, 0x20000
s_mov_b32 s88, s20
s_and_b32 s89, s21, 0xffff
s_mov_b32 s90, 0x400000
s_mov_b32 s91, 0x20000
v_and_b32 v12, 15, v9
v_lshlrev_b32 v12, 5, v12
s_lshl_b32 s38, s32, 3
v_add_u32 v11, s38, v12
v_lshlrev_b32 v13, 4, v9
v_lshrrev_b32 v7, 4, v9
v_lshlrev_b32 v6, 6, v12
v_lshl_add_u32 v6, v7, 4, v6
v_lshlrev_b32 v7, 5, v7
s_and_b32 s60, s26, 2
s_lshl_b32 s60, s60, 3
s_lshr_b32 s61, s26, 2
s_add_u32 s60, s60, s61
s_and_b32 s61, s26, 1
s_lshl_b32 s62, s60, 8
s_lshl_b32 s38, s61, 13
s_add_u32 s62, s62, s38
s_add_u32 s62, s62, 3178496
s_min_u32 s38, s32, 1
s_lshl_b32 s38, s38, 30
s_add_u32 s38, s38, s62
v_lshlrev_b32 v2, 2, v9
v_mov_b32 v3, -1
buffer_store_dword v3, v2, s[4:7], s38 offen sc1
s_mov_b32 s52, 1
s_waitcnt vmcnt(0)
s_cmp_lg_u32 s32, 0
s_cbranch_scc1 Lar_618
s_mov_b64 exec, 1
v_mov_b32 v14, 144
v_mov_b32 v15, s52
buffer_atomic_add v15, v14, s[12:15], 0 offen sc1
s_mov_b64 exec, -1
Lar_618:
v_lshrrev_b32 v2, 3, v0
v_and_b32 v3, 7, v0
v_mul_u32_u24 v4, 12288, v2
v_lshl_add_u32 v4, v3, 4, v4
v_lshlrev_b32 v5, 1, v2
v_mov_b32 v96, 0
v_mov_b32 v97, 0
v_mov_b32 v98, 0
v_mov_b32 v99, 0
v_mov_b32 v100, 0
v_mov_b32 v101, 0
v_mov_b32 v102, 0
v_mov_b32 v103, 0
s_lshl_b32 s41, s61, 10
s_mul_i32 s40, s61, 6291456
s_lshl_b32 s42, s60, 7
s_add_u32 s40, s40, s42
buffer_load_ushort v80, v5, s[84:87], s41 offen offset:0
buffer_load_ushort v81, v5, s[84:87], s41 offen offset:64
buffer_load_ushort v82, v5, s[84:87], s41 offen offset:128
buffer_load_ushort v83, v5, s[84:87], s41 offen offset:192
buffer_load_ushort v84, v5, s[84:87], s41 offen offset:256
buffer_load_ushort v85, v5, s[84:87], s41 offen offset:320
buffer_load_ushort v86, v5, s[84:87], s41 offen offset:384
buffer_load_ushort v87, v5, s[84:87], s41 offen offset:448
buffer_load_ushort v88, v5, s[84:87], s41 offen offset:512
buffer_load_ushort v89, v5, s[84:87], s41 offen offset:576
buffer_load_ushort v90, v5, s[84:87], s41 offen offset:640
buffer_load_ushort v91, v5, s[84:87], s41 offen offset:704
buffer_load_ushort v92, v5, s[84:87], s41 offen offset:768
buffer_load_ushort v93, v5, s[84:87], s41 offen offset:832
buffer_load_ushort v94, v5, s[84:87], s41 offen offset:896
buffer_load_ushort v95, v5, s[84:87], s41 offen offset:960
buffer_load_dwordx4 v[16:19], v4, s[8:11], s40 offen
s_add_u32 s40, s40, 393216
buffer_load_dwordx4 v[20:23], v4, s[8:11], s40 offen
s_add_u32 s40, s40, 393216
buffer_load_dwordx4 v[24:27], v4, s[8:11], s40 offen
s_add_u32 s40, s40, 393216
buffer_load_dwordx4 v[28:31], v4, s[8:11], s40 offen
s_add_u32 s40, s40, 393216
buffer_load_dwordx4 v[32:35], v4, s[8:11], s40 offen
s_add_u32 s40, s40, 393216
buffer_load_dwordx4 v[36:39], v4, s[8:11], s40 offen
s_add_u32 s40, s40, 393216
buffer_load_dwordx4 v[40:43], v4, s[8:11], s40 offen
s_add_u32 s40, s40, 393216
buffer_load_dwordx4 v[44:47], v4, s[8:11], s40 offen
s_add_u32 s40, s40, 393216
buffer_load_dwordx4 v[48:51], v4, s[8:11], s40 offen
s_add_u32 s40, s40, 393216
buffer_load_dwordx4 v[52:55], v4, s[8:11], s40 offen
s_add_u32 s40, s40, 393216
buffer_load_dwordx4 v[56:59], v4, s[8:11], s40 offen
s_add_u32 s40, s40, 393216
buffer_load_dwordx4 v[60:63], v4, s[8:11], s40 offen
s_add_u32 s40, s40, 393216
buffer_load_dwordx4 v[64:67], v4, s[8:11], s40 offen
s_add_u32 s40, s40, 393216
buffer_load_dwordx4 v[68:71], v4, s[8:11], s40 offen
s_add_u32 s40, s40, 393216
buffer_load_dwordx4 v[72:75], v4, s[8:11], s40 offen
s_add_u32 s40, s40, 393216
buffer_load_dwordx4 v[76:79], v4, s[8:11], s40 offen
s_add_u32 s40, s40, 393216
s_add_u32 s52, s26, 0
s_lshl_b32 s41, s52, 15
s_lshl_b32 s42, s32, 9
s_add_u32 s41, s41, s42
buffer_load_dwordx4 a[0:3], v6, s[88:91], s41 offen offset:0
buffer_load_dwordx4 a[4:7], v6, s[88:91], s41 offen offset:64
buffer_load_dwordx4 a[8:11], v6, s[88:91], s41 offen offset:128
buffer_load_dwordx4 a[12:15], v6, s[88:91], s41 offen offset:192
buffer_load_dwordx4 a[16:19], v6, s[88:91], s41 offen offset:256
buffer_load_dwordx4 a[20:23], v6, s[88:91], s41 offen offset:320
buffer_load_dwordx4 a[24:27], v6, s[88:91], s41 offen offset:384
buffer_load_dwordx4 a[28:31], v6, s[88:91], s41 offen offset:448
s_waitcnt vmcnt(24)
v_lshlrev_b32 v80, 16, v80
v_mul_f32 v104, 0xbfb8aa3b, v80
v_exp_f32 v104, v104
s_nop 0
v_add_f32 v104, 1.0, v104
v_rcp_f32 v104, v104
s_nop 0
v_mul_f32 v104, v104, v80
v_cvt_pk_bf16_f32 v80, 0, v104
v_lshlrev_b32 v81, 16, v81
v_mul_f32 v104, 0xbfb8aa3b, v81
v_exp_f32 v104, v104
s_nop 0
v_add_f32 v104, 1.0, v104
v_rcp_f32 v104, v104
s_nop 0
v_mul_f32 v104, v104, v81
v_cvt_pk_bf16_f32 v81, 0, v104
v_lshlrev_b32 v82, 16, v82
v_mul_f32 v104, 0xbfb8aa3b, v82
v_exp_f32 v104, v104
s_nop 0
v_add_f32 v104, 1.0, v104
v_rcp_f32 v104, v104
s_nop 0
v_mul_f32 v104, v104, v82
v_cvt_pk_bf16_f32 v82, 0, v104
v_lshlrev_b32 v83, 16, v83
v_mul_f32 v104, 0xbfb8aa3b, v83
v_exp_f32 v104, v104
s_nop 0
v_add_f32 v104, 1.0, v104
v_rcp_f32 v104, v104
s_nop 0
v_mul_f32 v104, v104, v83
v_cvt_pk_bf16_f32 v83, 0, v104
v_lshlrev_b32 v84, 16, v84
v_mul_f32 v104, 0xbfb8aa3b, v84
v_exp_f32 v104, v104
s_nop 0
v_add_f32 v104, 1.0, v104
v_rcp_f32 v104, v104
s_nop 0
v_mul_f32 v104, v104, v84
v_cvt_pk_bf16_f32 v84, 0, v104
v_lshlrev_b32 v85, 16, v85
v_mul_f32 v104, 0xbfb8aa3b, v85
v_exp_f32 v104, v104
s_nop 0
v_add_f32 v104, 1.0, v104
v_rcp_f32 v104, v104
s_nop 0
v_mul_f32 v104, v104, v85
v_cvt_pk_bf16_f32 v85, 0, v104
v_lshlrev_b32 v86, 16, v86
v_mul_f32 v104, 0xbfb8aa3b, v86
v_exp_f32 v104, v104
s_nop 0
v_add_f32 v104, 1.0, v104
v_rcp_f32 v104, v104
s_nop 0
v_mul_f32 v104, v104, v86
v_cvt_pk_bf16_f32 v86, 0, v104
v_lshlrev_b32 v87, 16, v87
v_mul_f32 v104, 0xbfb8aa3b, v87
v_exp_f32 v104, v104
s_nop 0
v_add_f32 v104, 1.0, v104
v_rcp_f32 v104, v104
s_nop 0
v_mul_f32 v104, v104, v87
v_cvt_pk_bf16_f32 v87, 0, v104
v_lshlrev_b32 v88, 16, v88
v_mul_f32 v104, 0xbfb8aa3b, v88
v_exp_f32 v104, v104
s_nop 0
v_add_f32 v104, 1.0, v104
v_rcp_f32 v104, v104
s_nop 0
v_mul_f32 v104, v104, v88
v_cvt_pk_bf16_f32 v88, 0, v104
v_lshlrev_b32 v89, 16, v89
v_mul_f32 v104, 0xbfb8aa3b, v89
v_exp_f32 v104, v104
s_nop 0
v_add_f32 v104, 1.0, v104
v_rcp_f32 v104, v104
s_nop 0
v_mul_f32 v104, v104, v89
v_cvt_pk_bf16_f32 v89, 0, v104
v_lshlrev_b32 v90, 16, v90
v_mul_f32 v104, 0xbfb8aa3b, v90
v_exp_f32 v104, v104
s_nop 0
v_add_f32 v104, 1.0, v104
v_rcp_f32 v104, v104
s_nop 0
v_mul_f32 v104, v104, v90
v_cvt_pk_bf16_f32 v90, 0, v104
v_lshlrev_b32 v91, 16, v91
v_mul_f32 v104, 0xbfb8aa3b, v91
v_exp_f32 v104, v104
s_nop 0
v_add_f32 v104, 1.0, v104
v_rcp_f32 v104, v104
s_nop 0
v_mul_f32 v104, v104, v91
v_cvt_pk_bf16_f32 v91, 0, v104
v_lshlrev_b32 v92, 16, v92
v_mul_f32 v104, 0xbfb8aa3b, v92
v_exp_f32 v104, v104
s_nop 0
v_add_f32 v104, 1.0, v104
v_rcp_f32 v104, v104
s_nop 0
v_mul_f32 v104, v104, v92
v_cvt_pk_bf16_f32 v92, 0, v104
v_lshlrev_b32 v93, 16, v93
v_mul_f32 v104, 0xbfb8aa3b, v93
v_exp_f32 v104, v104
s_nop 0
v_add_f32 v104, 1.0, v104
v_rcp_f32 v104, v104
s_nop 0
v_mul_f32 v104, v104, v93
v_cvt_pk_bf16_f32 v93, 0, v104
v_lshlrev_b32 v94, 16, v94
v_mul_f32 v104, 0xbfb8aa3b, v94
v_exp_f32 v104, v104
s_nop 0
v_add_f32 v104, 1.0, v104
v_rcp_f32 v104, v104
s_nop 0
v_mul_f32 v104, v104, v94
v_cvt_pk_bf16_f32 v94, 0, v104
v_lshlrev_b32 v95, 16, v95
v_mul_f32 v104, 0xbfb8aa3b, v95
v_exp_f32 v104, v104
s_nop 0
v_add_f32 v104, 1.0, v104
v_rcp_f32 v104, v104
s_nop 0
v_mul_f32 v104, v104, v95
v_cvt_pk_bf16_f32 v95, 0, v104
s_waitcnt vmcnt(23)
v_lshlrev_b32 v104, 16, v16
v_and_b32 v105, 0xffff0000, v16
v_fmac_f32 v96, v104, v80
v_fmac_f32 v97, v105, v80
v_lshlrev_b32 v104, 16, v17
v_and_b32 v105, 0xffff0000, v17
v_fmac_f32 v98, v104, v80
v_fmac_f32 v99, v105, v80
v_lshlrev_b32 v104, 16, v18
v_and_b32 v105, 0xffff0000, v18
v_fmac_f32 v100, v104, v80
v_fmac_f32 v101, v105, v80
v_lshlrev_b32 v104, 16, v19
v_and_b32 v105, 0xffff0000, v19
v_fmac_f32 v102, v104, v80
v_fmac_f32 v103, v105, v80
s_waitcnt vmcnt(22)
v_lshlrev_b32 v104, 16, v20
v_and_b32 v105, 0xffff0000, v20
v_fmac_f32 v96, v104, v81
v_fmac_f32 v97, v105, v81
v_lshlrev_b32 v104, 16, v21
v_and_b32 v105, 0xffff0000, v21
v_fmac_f32 v98, v104, v81
v_fmac_f32 v99, v105, v81
v_lshlrev_b32 v104, 16, v22
v_and_b32 v105, 0xffff0000, v22
v_fmac_f32 v100, v104, v81
v_fmac_f32 v101, v105, v81
v_lshlrev_b32 v104, 16, v23
v_and_b32 v105, 0xffff0000, v23
v_fmac_f32 v102, v104, v81
v_fmac_f32 v103, v105, v81
s_waitcnt vmcnt(21)
v_lshlrev_b32 v104, 16, v24
v_and_b32 v105, 0xffff0000, v24
v_fmac_f32 v96, v104, v82
v_fmac_f32 v97, v105, v82
v_lshlrev_b32 v104, 16, v25
v_and_b32 v105, 0xffff0000, v25
v_fmac_f32 v98, v104, v82
v_fmac_f32 v99, v105, v82
v_lshlrev_b32 v104, 16, v26
v_and_b32 v105, 0xffff0000, v26
v_fmac_f32 v100, v104, v82
v_fmac_f32 v101, v105, v82
v_lshlrev_b32 v104, 16, v27
v_and_b32 v105, 0xffff0000, v27
v_fmac_f32 v102, v104, v82
v_fmac_f32 v103, v105, v82
s_waitcnt vmcnt(20)
v_lshlrev_b32 v104, 16, v28
v_and_b32 v105, 0xffff0000, v28
v_fmac_f32 v96, v104, v83
v_fmac_f32 v97, v105, v83
v_lshlrev_b32 v104, 16, v29
v_and_b32 v105, 0xffff0000, v29
v_fmac_f32 v98, v104, v83
v_fmac_f32 v99, v105, v83
v_lshlrev_b32 v104, 16, v30
v_and_b32 v105, 0xffff0000, v30
v_fmac_f32 v100, v104, v83
v_fmac_f32 v101, v105, v83
v_lshlrev_b32 v104, 16, v31
v_and_b32 v105, 0xffff0000, v31
v_fmac_f32 v102, v104, v83
v_fmac_f32 v103, v105, v83
s_waitcnt vmcnt(19)
v_lshlrev_b32 v104, 16, v32
v_and_b32 v105, 0xffff0000, v32
v_fmac_f32 v96, v104, v84
v_fmac_f32 v97, v105, v84
v_lshlrev_b32 v104, 16, v33
v_and_b32 v105, 0xffff0000, v33
v_fmac_f32 v98, v104, v84
v_fmac_f32 v99, v105, v84
v_lshlrev_b32 v104, 16, v34
v_and_b32 v105, 0xffff0000, v34
v_fmac_f32 v100, v104, v84
v_fmac_f32 v101, v105, v84
v_lshlrev_b32 v104, 16, v35
v_and_b32 v105, 0xffff0000, v35
v_fmac_f32 v102, v104, v84
v_fmac_f32 v103, v105, v84
s_waitcnt vmcnt(18)
v_lshlrev_b32 v104, 16, v36
v_and_b32 v105, 0xffff0000, v36
v_fmac_f32 v96, v104, v85
v_fmac_f32 v97, v105, v85
v_lshlrev_b32 v104, 16, v37
v_and_b32 v105, 0xffff0000, v37
v_fmac_f32 v98, v104, v85
v_fmac_f32 v99, v105, v85
v_lshlrev_b32 v104, 16, v38
v_and_b32 v105, 0xffff0000, v38
v_fmac_f32 v100, v104, v85
v_fmac_f32 v101, v105, v85
v_lshlrev_b32 v104, 16, v39
v_and_b32 v105, 0xffff0000, v39
v_fmac_f32 v102, v104, v85
v_fmac_f32 v103, v105, v85
s_waitcnt vmcnt(17)
v_lshlrev_b32 v104, 16, v40
v_and_b32 v105, 0xffff0000, v40
v_fmac_f32 v96, v104, v86
v_fmac_f32 v97, v105, v86
v_lshlrev_b32 v104, 16, v41
v_and_b32 v105, 0xffff0000, v41
v_fmac_f32 v98, v104, v86
v_fmac_f32 v99, v105, v86
v_lshlrev_b32 v104, 16, v42
v_and_b32 v105, 0xffff0000, v42
v_fmac_f32 v100, v104, v86
v_fmac_f32 v101, v105, v86
v_lshlrev_b32 v104, 16, v43
v_and_b32 v105, 0xffff0000, v43
v_fmac_f32 v102, v104, v86
v_fmac_f32 v103, v105, v86
s_waitcnt vmcnt(16)
v_lshlrev_b32 v104, 16, v44
v_and_b32 v105, 0xffff0000, v44
v_fmac_f32 v96, v104, v87
v_fmac_f32 v97, v105, v87
v_lshlrev_b32 v104, 16, v45
v_and_b32 v105, 0xffff0000, v45
v_fmac_f32 v98, v104, v87
v_fmac_f32 v99, v105, v87
v_lshlrev_b32 v104, 16, v46
v_and_b32 v105, 0xffff0000, v46
v_fmac_f32 v100, v104, v87
v_fmac_f32 v101, v105, v87
v_lshlrev_b32 v104, 16, v47
v_and_b32 v105, 0xffff0000, v47
v_fmac_f32 v102, v104, v87
v_fmac_f32 v103, v105, v87
s_waitcnt vmcnt(15)
v_lshlrev_b32 v104, 16, v48
v_and_b32 v105, 0xffff0000, v48
v_fmac_f32 v96, v104, v88
v_fmac_f32 v97, v105, v88
v_lshlrev_b32 v104, 16, v49
v_and_b32 v105, 0xffff0000, v49
v_fmac_f32 v98, v104, v88
v_fmac_f32 v99, v105, v88
v_lshlrev_b32 v104, 16, v50
v_and_b32 v105, 0xffff0000, v50
v_fmac_f32 v100, v104, v88
v_fmac_f32 v101, v105, v88
v_lshlrev_b32 v104, 16, v51
v_and_b32 v105, 0xffff0000, v51
v_fmac_f32 v102, v104, v88
v_fmac_f32 v103, v105, v88
s_waitcnt vmcnt(14)
v_lshlrev_b32 v104, 16, v52
v_and_b32 v105, 0xffff0000, v52
v_fmac_f32 v96, v104, v89
v_fmac_f32 v97, v105, v89
v_lshlrev_b32 v104, 16, v53
v_and_b32 v105, 0xffff0000, v53
v_fmac_f32 v98, v104, v89
v_fmac_f32 v99, v105, v89
v_lshlrev_b32 v104, 16, v54
v_and_b32 v105, 0xffff0000, v54
v_fmac_f32 v100, v104, v89
v_fmac_f32 v101, v105, v89
v_lshlrev_b32 v104, 16, v55
v_and_b32 v105, 0xffff0000, v55
v_fmac_f32 v102, v104, v89
v_fmac_f32 v103, v105, v89
s_waitcnt vmcnt(13)
v_lshlrev_b32 v104, 16, v56
v_and_b32 v105, 0xffff0000, v56
v_fmac_f32 v96, v104, v90
v_fmac_f32 v97, v105, v90
v_lshlrev_b32 v104, 16, v57
v_and_b32 v105, 0xffff0000, v57
v_fmac_f32 v98, v104, v90
v_fmac_f32 v99, v105, v90
v_lshlrev_b32 v104, 16, v58
v_and_b32 v105, 0xffff0000, v58
v_fmac_f32 v100, v104, v90
v_fmac_f32 v101, v105, v90
v_lshlrev_b32 v104, 16, v59
v_and_b32 v105, 0xffff0000, v59
v_fmac_f32 v102, v104, v90
v_fmac_f32 v103, v105, v90
s_waitcnt vmcnt(12)
v_lshlrev_b32 v104, 16, v60
v_and_b32 v105, 0xffff0000, v60
v_fmac_f32 v96, v104, v91
v_fmac_f32 v97, v105, v91
v_lshlrev_b32 v104, 16, v61
v_and_b32 v105, 0xffff0000, v61
v_fmac_f32 v98, v104, v91
v_fmac_f32 v99, v105, v91
v_lshlrev_b32 v104, 16, v62
v_and_b32 v105, 0xffff0000, v62
v_fmac_f32 v100, v104, v91
v_fmac_f32 v101, v105, v91
v_lshlrev_b32 v104, 16, v63
v_and_b32 v105, 0xffff0000, v63
v_fmac_f32 v102, v104, v91
v_fmac_f32 v103, v105, v91
s_waitcnt vmcnt(11)
v_lshlrev_b32 v104, 16, v64
v_and_b32 v105, 0xffff0000, v64
v_fmac_f32 v96, v104, v92
v_fmac_f32 v97, v105, v92
v_lshlrev_b32 v104, 16, v65
v_and_b32 v105, 0xffff0000, v65
v_fmac_f32 v98, v104, v92
v_fmac_f32 v99, v105, v92
v_lshlrev_b32 v104, 16, v66
v_and_b32 v105, 0xffff0000, v66
v_fmac_f32 v100, v104, v92
v_fmac_f32 v101, v105, v92
v_lshlrev_b32 v104, 16, v67
v_and_b32 v105, 0xffff0000, v67
v_fmac_f32 v102, v104, v92
v_fmac_f32 v103, v105, v92
s_waitcnt vmcnt(10)
v_lshlrev_b32 v104, 16, v68
v_and_b32 v105, 0xffff0000, v68
v_fmac_f32 v96, v104, v93
v_fmac_f32 v97, v105, v93
v_lshlrev_b32 v104, 16, v69
v_and_b32 v105, 0xffff0000, v69
v_fmac_f32 v98, v104, v93
v_fmac_f32 v99, v105, v93
v_lshlrev_b32 v104, 16, v70
v_and_b32 v105, 0xffff0000, v70
v_fmac_f32 v100, v104, v93
v_fmac_f32 v101, v105, v93
v_lshlrev_b32 v104, 16, v71
v_and_b32 v105, 0xffff0000, v71
v_fmac_f32 v102, v104, v93
v_fmac_f32 v103, v105, v93
s_waitcnt vmcnt(9)
v_lshlrev_b32 v104, 16, v72
v_and_b32 v105, 0xffff0000, v72
v_fmac_f32 v96, v104, v94
v_fmac_f32 v97, v105, v94
v_lshlrev_b32 v104, 16, v73
v_and_b32 v105, 0xffff0000, v73
v_fmac_f32 v98, v104, v94
v_fmac_f32 v99, v105, v94
v_lshlrev_b32 v104, 16, v74
v_and_b32 v105, 0xffff0000, v74
v_fmac_f32 v100, v104, v94
v_fmac_f32 v101, v105, v94
v_lshlrev_b32 v104, 16, v75
v_and_b32 v105, 0xffff0000, v75
v_fmac_f32 v102, v104, v94
v_fmac_f32 v103, v105, v94
s_waitcnt vmcnt(8)
v_lshlrev_b32 v104, 16, v76
v_and_b32 v105, 0xffff0000, v76
v_fmac_f32 v96, v104, v95
v_fmac_f32 v97, v105, v95
v_lshlrev_b32 v104, 16, v77
v_and_b32 v105, 0xffff0000, v77
v_fmac_f32 v98, v104, v95
v_fmac_f32 v99, v105, v95
v_lshlrev_b32 v104, 16, v78
v_and_b32 v105, 0xffff0000, v78
v_fmac_f32 v100, v104, v95
v_fmac_f32 v101, v105, v95
v_lshlrev_b32 v104, 16, v79
v_and_b32 v105, 0xffff0000, v79
v_fmac_f32 v102, v104, v95
v_fmac_f32 v103, v105, v95
s_nop 1
v_add_f32_dpp v96, v96, v96 row_ror:8 row_mask:0xf bank_mask:0xf
v_add_f32_dpp v97, v97, v97 row_ror:8 row_mask:0xf bank_mask:0xf
v_add_f32_dpp v98, v98, v98 row_ror:8 row_mask:0xf bank_mask:0xf
v_add_f32_dpp v99, v99, v99 row_ror:8 row_mask:0xf bank_mask:0xf
v_add_f32_dpp v100, v100, v100 row_ror:8 row_mask:0xf bank_mask:0xf
v_add_f32_dpp v101, v101, v101 row_ror:8 row_mask:0xf bank_mask:0xf
v_add_f32_dpp v102, v102, v102 row_ror:8 row_mask:0xf bank_mask:0xf
v_add_f32_dpp v103, v103, v103 row_ror:8 row_mask:0xf bank_mask:0xf
v_mov_b32 v16, v96
v_mov_b32 v17, v97
v_mov_b32 v18, v98
v_mov_b32 v19, v99
v_mov_b32 v20, v100
v_mov_b32 v21, v101
v_mov_b32 v22, v102
v_mov_b32 v23, v103
v_permlane16_swap_b32 v96, v16
v_permlane16_swap_b32 v97, v17
v_permlane16_swap_b32 v98, v18
v_permlane16_swap_b32 v99, v19
v_permlane16_swap_b32 v100, v20
v_permlane16_swap_b32 v101, v21
v_permlane16_swap_b32 v102, v22
v_permlane16_swap_b32 v103, v23
v_add_f32 v96, v96, v16
v_add_f32 v97, v97, v17
v_add_f32 v98, v98, v18
v_add_f32 v99, v99, v19
v_add_f32 v100, v100, v20
v_add_f32 v101, v101, v21
v_add_f32 v102, v102, v22
v_add_f32 v103, v103, v23
v_mov_b32 v16, v96
v_mov_b32 v17, v97
v_mov_b32 v18, v98
v_mov_b32 v19, v99
v_mov_b32 v20, v100
v_mov_b32 v21, v101
v_mov_b32 v22, v102
v_mov_b32 v23, v103
v_permlane32_swap_b32 v96, v16
v_permlane32_swap_b32 v97, v17
v_permlane32_swap_b32 v98, v18
v_permlane32_swap_b32 v99, v19
v_permlane32_swap_b32 v100, v20
v_permlane32_swap_b32 v101, v21
v_permlane32_swap_b32 v102, v22
v_permlane32_swap_b32 v103, v23
v_add_f32 v96, v96, v16
v_add_f32 v97, v97, v17
v_add_f32 v98, v98, v18
v_add_f32 v99, v99, v19
v_add_f32 v100, v100, v20
v_add_f32 v101, v101, v21
v_add_f32 v102, v102, v22
v_add_f32 v103, v103, v23
s_lshl_b32 s40, s32, 8
v_lshl_add_u32 v2, v3, 5, s40
ds_write_b128 v2, v[96:99] offset:1024
ds_write_b128 v2, v[100:103] offset:1040
s_waitcnt lgkmcnt(0)
s_barrier
v_and_b32 v2, 63, v0
v_lshlrev_b32 v2, 2, v2
ds_read_b32 v96, v2 offset:1024
ds_read_b32 v97, v2 offset:1280
ds_read_b32 v98, v2 offset:1536
ds_read_b32 v99, v2 offset:1792
s_min_u32 s40, s32, 1
s_lshl_b32 s40, s40, 30
s_add_u32 s40, s40, s62
s_waitcnt lgkmcnt(0)
v_add_f32 v96, v96, v97
v_add_f32 v98, v98, v99
v_add_f32 v96, v96, v98
v_min_u32 v96, -2, v96
buffer_store_dword v96, v2, s[4:7], s40 offen sc1
Lst_619:
buffer_load_dword v14, off, s[12:15], 0 offset:144 sc1
buffer_load_dword v15, off, s[12:15], 0 offset:144 sc1
s_waitcnt vmcnt(0)
v_add_u32 v14, v14, v15
s_nop 0
v_readfirstlane_b32 s38, v14
s_nop 3
s_and_b32 s39, s38, 0xffff
s_cmp_eq_u32 s39, 0x100
s_cbranch_scc1 Lso_620
s_sub_u32 s37, s37, 1
s_cbranch_scc1 Lend_7
s_sleep 8
s_branch Lst_619
Lso_620:
s_bfe_u32 s35, s38, 0x80010
s_bfe_u32 s46, s38, 0x10018
s_lshl_b32 s46, s46, 13
s_barrier
s_add_u32 s52, s26, 0
v_accvgpr_read_b32 v16, a0
v_accvgpr_read_b32 v17, a1
v_accvgpr_read_b32 v18, a2
v_accvgpr_read_b32 v19, a3
v_accvgpr_read_b32 v20, a4
v_accvgpr_read_b32 v21, a5
v_accvgpr_read_b32 v22, a6
v_accvgpr_read_b32 v23, a7
v_accvgpr_read_b32 v24, a8
v_accvgpr_read_b32 v25, a9
v_accvgpr_read_b32 v26, a10
v_accvgpr_read_b32 v27, a11
v_accvgpr_read_b32 v28, a12
v_accvgpr_read_b32 v29, a13
v_accvgpr_read_b32 v30, a14
v_accvgpr_read_b32 v31, a15
v_accvgpr_read_b32 v32, a16
v_accvgpr_read_b32 v33, a17
v_accvgpr_read_b32 v34, a18
v_accvgpr_read_b32 v35, a19
v_accvgpr_read_b32 v36, a20
v_accvgpr_read_b32 v37, a21
v_accvgpr_read_b32 v38, a22
v_accvgpr_read_b32 v39, a23
v_accvgpr_read_b32 v40, a24
v_accvgpr_read_b32 v41, a25
v_accvgpr_read_b32 v42, a26
v_accvgpr_read_b32 v43, a27
v_accvgpr_read_b32 v44, a28
v_accvgpr_read_b32 v45, a29
v_accvgpr_read_b32 v46, a30
v_accvgpr_read_b32 v47, a31
s_lshr_b32 s40, s52, 1
s_lshl_b32 s40, s40, 2
s_add_u32 s40, s40, s32
s_lshl_b32 s40, s40, 14
s_and_b32 s41, s52, 1
s_lshl_b32 s41, s41, 10
s_add_u32 s40, s40, s41
v_lshlrev_b32 v48, 16, v16
v_and_b32 v49, 0xffff0000, v16
v_lshlrev_b32 v50, 16, v17
v_and_b32 v51, 0xffff0000, v17
v_lshlrev_b32 v52, 16, v18
v_and_b32 v53, 0xffff0000, v18
v_lshlrev_b32 v54, 16, v19
v_and_b32 v55, 0xffff0000, v19
v_lshlrev_b32 v56, 16, v20
v_and_b32 v57, 0xffff0000, v20
v_lshlrev_b32 v58, 16, v21
v_and_b32 v59, 0xffff0000, v21
v_lshlrev_b32 v60, 16, v22
v_and_b32 v61, 0xffff0000, v22
v_lshlrev_b32 v62, 16, v23
v_and_b32 v63, 0xffff0000, v23
v_lshlrev_b32 v64, 16, v24
v_and_b32 v65, 0xffff0000, v24
v_lshlrev_b32 v66, 16, v25
v_and_b32 v67, 0xffff0000, v25
v_lshlrev_b32 v68, 16, v26
v_and_b32 v69, 0xffff0000, v26
v_lshlrev_b32 v70, 16, v27
v_and_b32 v71, 0xffff0000, v27
v_lshlrev_b32 v72, 16, v28
v_and_b32 v73, 0xffff0000, v28
v_lshlrev_b32 v74, 16, v29
v_and_b32 v75, 0xffff0000, v29
v_lshlrev_b32 v76, 16, v30
v_and_b32 v77, 0xffff0000, v30
v_lshlrev_b32 v78, 16, v31
v_and_b32 v79, 0xffff0000, v31
v_lshlrev_b32 v80, 16, v32
v_and_b32 v81, 0xffff0000, v32
v_lshlrev_b32 v82, 16, v33
v_and_b32 v83, 0xffff0000, v33
v_lshlrev_b32 v84, 16, v34
v_and_b32 v85, 0xffff0000, v34
v_lshlrev_b32 v86, 16, v35
v_and_b32 v87, 0xffff0000, v35
v_lshlrev_b32 v88, 16, v36
v_and_b32 v89, 0xffff0000, v36
v_lshlrev_b32 v90, 16, v37
v_and_b32 v91, 0xffff0000, v37
v_lshlrev_b32 v92, 16, v38
v_and_b32 v93, 0xffff0000, v38
v_lshlrev_b32 v94, 16, v39
v_and_b32 v95, 0xffff0000, v39
v_lshlrev_b32 v96, 16, v40
v_and_b32 v97, 0xffff0000, v40
v_lshlrev_b32 v98, 16, v41
v_and_b32 v99, 0xffff0000, v41
v_lshlrev_b32 v100, 16, v42
v_and_b32 v101, 0xffff0000, v42
v_lshlrev_b32 v102, 16, v43
v_and_b32 v103, 0xffff0000, v43
v_lshlrev_b32 v104, 16, v44
v_and_b32 v105, 0xffff0000, v44
v_lshlrev_b32 v106, 16, v45
v_and_b32 v107, 0xffff0000, v45
v_lshlrev_b32 v108, 16, v46
v_and_b32 v109, 0xffff0000, v46
v_lshlrev_b32 v110, 16, v47
v_and_b32 v111, 0xffff0000, v47
v_pk_mul_f32 v[240:241], v[48:49], 1.0 op_sel_hi:[1,0]
v_pk_mul_f32 v[242:243], v[48:49], v[48:49]
v_pk_add_f32 v[240:241], v[240:241], v[50:51]
v_pk_fma_f32 v[242:243], v[50:51], v[50:51], v[242:243]
v_pk_add_f32 v[240:241], v[240:241], v[52:53]
v_pk_fma_f32 v[242:243], v[52:53], v[52:53], v[242:243]
v_pk_add_f32 v[240:241], v[240:241], v[54:55]
v_pk_fma_f32 v[242:243], v[54:55], v[54:55], v[242:243]
v_pk_add_f32 v[240:241], v[240:241], v[56:57]
v_pk_fma_f32 v[242:243], v[56:57], v[56:57], v[242:243]
v_pk_add_f32 v[240:241], v[240:241], v[58:59]
v_pk_fma_f32 v[242:243], v[58:59], v[58:59], v[242:243]
v_pk_add_f32 v[240:241], v[240:241], v[60:61]
v_pk_fma_f32 v[242:243], v[60:61], v[60:61], v[242:243]
v_pk_add_f32 v[240:241], v[240:241], v[62:63]
v_pk_fma_f32 v[242:243], v[62:63], v[62:63], v[242:243]
v_pk_add_f32 v[240:241], v[240:241], v[64:65]
v_pk_fma_f32 v[242:243], v[64:65], v[64:65], v[242:243]
v_pk_add_f32 v[240:241], v[240:241], v[66:67]
v_pk_fma_f32 v[242:243], v[66:67], v[66:67], v[242:243]
v_pk_add_f32 v[240:241], v[240:241], v[68:69]
v_pk_fma_f32 v[242:243], v[68:69], v[68:69], v[242:243]
v_pk_add_f32 v[240:241], v[240:241], v[70:71]
v_pk_fma_f32 v[242:243], v[70:71], v[70:71], v[242:243]
v_pk_add_f32 v[240:241], v[240:241], v[72:73]
v_pk_fma_f32 v[242:243], v[72:73], v[72:73], v[242:243]
v_pk_add_f32 v[240:241], v[240:241], v[74:75]
v_pk_fma_f32 v[242:243], v[74:75], v[74:75], v[242:243]
v_pk_add_f32 v[240:241], v[240:241], v[76:77]
v_pk_fma_f32 v[242:243], v[76:77], v[76:77], v[242:243]
v_pk_add_f32 v[240:241], v[240:241], v[78:79]
v_pk_fma_f32 v[242:243], v[78:79], v[78:79], v[242:243]
v_pk_add_f32 v[240:241], v[240:241], v[80:81]
v_pk_fma_f32 v[242:243], v[80:81], v[80:81], v[242:243]
v_pk_add_f32 v[240:241], v[240:241], v[82:83]
v_pk_fma_f32 v[242:243], v[82:83], v[82:83], v[242:243]
v_pk_add_f32 v[240:241], v[240:241], v[84:85]
v_pk_fma_f32 v[242:243], v[84:85], v[84:85], v[242:243]
v_pk_add_f32 v[240:241], v[240:241], v[86:87]
v_pk_fma_f32 v[242:243], v[86:87], v[86:87], v[242:243]
v_pk_add_f32 v[240:241], v[240:241], v[88:89]
v_pk_fma_f32 v[242:243], v[88:89], v[88:89], v[242:243]
v_pk_add_f32 v[240:241], v[240:241], v[90:91]
v_pk_fma_f32 v[242:243], v[90:91], v[90:91], v[242:243]
v_pk_add_f32 v[240:241], v[240:241], v[92:93]
v_pk_fma_f32 v[242:243], v[92:93], v[92:93], v[242:243]
v_pk_add_f32 v[240:241], v[240:241], v[94:95]
v_pk_fma_f32 v[242:243], v[94:95], v[94:95], v[242:243]
v_pk_add_f32 v[240:241], v[240:241], v[96:97]
v_pk_fma_f32 v[242:243], v[96:97], v[96:97], v[242:243]
v_pk_add_f32 v[240:241], v[240:241], v[98:99]
v_pk_fma_f32 v[242:243], v[98:99], v[98:99], v[242:243]
v_pk_add_f32 v[240:241], v[240:241], v[100:101]
v_pk_fma_f32 v[242:243], v[100:101], v[100:101], v[242:243]
v_pk_add_f32 v[240:241], v[240:241], v[102:103]
v_pk_fma_f32 v[242:243], v[102:103], v[102:103], v[242:243]
v_pk_add_f32 v[240:241], v[240:241], v[104:105]
v_pk_fma_f32 v[242:243], v[104:105], v[104:105], v[242:243]
v_pk_add_f32 v[240:241], v[240:241], v[106:107]
v_pk_fma_f32 v[242:243], v[106:107], v[106:107], v[242:243]
v_pk_add_f32 v[240:241], v[240:241], v[108:109]
v_pk_fma_f32 v[242:243], v[108:109], v[108:109], v[242:243]
v_pk_add_f32 v[240:241], v[240:241], v[110:111]
v_pk_fma_f32 v[242:243], v[110:111], v[110:111], v[242:243]
v_add_f32 v240, v240, v241
v_add_f32 v241, v242, v243
v_mov_b32 v242, v240
v_mov_b32 v243, v241
s_nop 1
v_permlane16_swap_b32 v240, v242
v_permlane16_swap_b32 v241, v243
v_add_f32 v240, v240, v242
v_add_f32 v241, v241, v243
v_mov_b32 v242, v240
v_mov_b32 v243, v241
s_nop 1
v_permlane32_swap_b32 v240, v242
v_permlane32_swap_b32 v241, v243
v_add_f32 v240, v240, v242
v_add_f32 v241, v241, v243
ds_write_b64 v11, v[240:241] offset:2048
s_waitcnt lgkmcnt(0)
s_barrier
ds_read_b128 v[240:243], v12 offset:2048
ds_read_b128 v[244:247], v12 offset:2064
v_xor_b32 v11, 512, v11
v_xor_b32 v12, 512, v12
s_mov_b32 s38, 0x3a800000
s_waitcnt lgkmcnt(0)
v_pk_add_f32 v[240:241], v[240:241], v[242:243]
v_pk_add_f32 v[244:245], v[244:245], v[246:247]
v_pk_add_f32 v[240:241], v[240:241], v[244:245]
v_pk_mul_f32 v[240:241], v[240:241], s[38:39] op_sel_hi:[1,0]
v_fma_f32 v241, -v240, v240, v241
v_max_f32 v241, 0, v241
v_add_f32 v241, 0x3727c5ac, v241
v_rsq_f32 v241, v241
s_nop 0
v_mul_f32 v240, -v240, v241
v_pk_fma_f32 v[48:49], v[48:49], v[240:241], v[240:241] op_sel:[0,1,0] op_sel_hi:[1,1,0]
v_pk_fma_f32 v[50:51], v[50:51], v[240:241], v[240:241] op_sel:[0,1,0] op_sel_hi:[1,1,0]
v_pk_fma_f32 v[52:53], v[52:53], v[240:241], v[240:241] op_sel:[0,1,0] op_sel_hi:[1,1,0]
v_pk_fma_f32 v[54:55], v[54:55], v[240:241], v[240:241] op_sel:[0,1,0] op_sel_hi:[1,1,0]
v_pk_fma_f32 v[56:57], v[56:57], v[240:241], v[240:241] op_sel:[0,1,0] op_sel_hi:[1,1,0]
v_pk_fma_f32 v[58:59], v[58:59], v[240:241], v[240:241] op_sel:[0,1,0] op_sel_hi:[1,1,0]
v_pk_fma_f32 v[60:61], v[60:61], v[240:241], v[240:241] op_sel:[0,1,0] op_sel_hi:[1,1,0]
v_pk_fma_f32 v[62:63], v[62:63], v[240:241], v[240:241] op_sel:[0,1,0] op_sel_hi:[1,1,0]
v_pk_fma_f32 v[64:65], v[64:65], v[240:241], v[240:241] op_sel:[0,1,0] op_sel_hi:[1,1,0]
v_pk_fma_f32 v[66:67], v[66:67], v[240:241], v[240:241] op_sel:[0,1,0] op_sel_hi:[1,1,0]
v_pk_fma_f32 v[68:69], v[68:69], v[240:241], v[240:241] op_sel:[0,1,0] op_sel_hi:[1,1,0]
v_pk_fma_f32 v[70:71], v[70:71], v[240:241], v[240:241] op_sel:[0,1,0] op_sel_hi:[1,1,0]
v_pk_fma_f32 v[72:73], v[72:73], v[240:241], v[240:241] op_sel:[0,1,0] op_sel_hi:[1,1,0]
v_pk_fma_f32 v[74:75], v[74:75], v[240:241], v[240:241] op_sel:[0,1,0] op_sel_hi:[1,1,0]
v_pk_fma_f32 v[76:77], v[76:77], v[240:241], v[240:241] op_sel:[0,1,0] op_sel_hi:[1,1,0]
v_pk_fma_f32 v[78:79], v[78:79], v[240:241], v[240:241] op_sel:[0,1,0] op_sel_hi:[1,1,0]
v_pk_fma_f32 v[80:81], v[80:81], v[240:241], v[240:241] op_sel:[0,1,0] op_sel_hi:[1,1,0]
v_pk_fma_f32 v[82:83], v[82:83], v[240:241], v[240:241] op_sel:[0,1,0] op_sel_hi:[1,1,0]
v_pk_fma_f32 v[84:85], v[84:85], v[240:241], v[240:241] op_sel:[0,1,0] op_sel_hi:[1,1,0]
v_pk_fma_f32 v[86:87], v[86:87], v[240:241], v[240:241] op_sel:[0,1,0] op_sel_hi:[1,1,0]
v_pk_fma_f32 v[88:89], v[88:89], v[240:241], v[240:241] op_sel:[0,1,0] op_sel_hi:[1,1,0]
v_pk_fma_f32 v[90:91], v[90:91], v[240:241], v[240:241] op_sel:[0,1,0] op_sel_hi:[1,1,0]
v_pk_fma_f32 v[92:93], v[92:93], v[240:241], v[240:241] op_sel:[0,1,0] op_sel_hi:[1,1,0]
v_pk_fma_f32 v[94:95], v[94:95], v[240:241], v[240:241] op_sel:[0,1,0] op_sel_hi:[1,1,0]
v_pk_fma_f32 v[96:97], v[96:97], v[240:241], v[240:241] op_sel:[0,1,0] op_sel_hi:[1,1,0]
v_pk_fma_f32 v[98:99], v[98:99], v[240:241], v[240:241] op_sel:[0,1,0] op_sel_hi:[1,1,0]
v_pk_fma_f32 v[100:101], v[100:101], v[240:241], v[240:241] op_sel:[0,1,0] op_sel_hi:[1,1,0]
v_pk_fma_f32 v[102:103], v[102:103], v[240:241], v[240:241] op_sel:[0,1,0] op_sel_hi:[1,1,0]
v_pk_fma_f32 v[104:105], v[104:105], v[240:241], v[240:241] op_sel:[0,1,0] op_sel_hi:[1,1,0]
v_pk_fma_f32 v[106:107], v[106:107], v[240:241], v[240:241] op_sel:[0,1,0] op_sel_hi:[1,1,0]
v_pk_fma_f32 v[108:109], v[108:109], v[240:241], v[240:241] op_sel:[0,1,0] op_sel_hi:[1,1,0]
v_pk_fma_f32 v[110:111], v[110:111], v[240:241], v[240:241] op_sel:[0,1,0] op_sel_hi:[1,1,0]
v_lshlrev_b32 v14, 5, v0
Lbw_621:
s_mov_b32 s42, 3178496
buffer_load_dwordx4 v[16:19], v14, s[4:7], s42 offen offset:0 sc1
buffer_load_dwordx4 v[20:23], v14, s[4:7], s42 offen offset:16 sc1
s_mov_b32 s42, 3186688
buffer_load_dwordx4 v[24:27], v14, s[4:7], s42 offen offset:0 sc1
buffer_load_dwordx4 v[28:31], v14, s[4:7], s42 offen offset:16 sc1
s_waitcnt vmcnt(0)
v_max3_u32 v15, v16, v17, v18
v_max3_u32 v15, v15, v19, v20
v_max3_u32 v15, v15, v21, v22
v_max3_u32 v15, v15, v23, v24
v_max3_u32 v15, v15, v25, v26
v_max3_u32 v15, v15, v27, v28
v_max3_u32 v15, v15, v29, v30
v_max_u32 v15, v15, v31
v_cmp_eq_u32 vcc, -1, v15
s_cbranch_vccz Lbo_622
s_sub_u32 s37, s37, 1
s_cbranch_scc1 Lend_7
s_sleep 4
s_branch Lbw_621
Lbo_622:
s_add_u32 s52, s26, 64
s_lshl_b32 s41, s52, 15
s_lshl_b32 s42, s32, 9
s_add_u32 s41, s41, s42
buffer_load_dwordx4 a[32:35], v6, s[88:91], s41 offen offset:0
buffer_load_dwordx4 a[36:39], v6, s[88:91], s41 offen offset:64
buffer_load_dwordx4 a[40:43], v6, s[88:91], s41 offen offset:128
buffer_load_dwordx4 a[44:47], v6, s[88:91], s41 offen offset:192
buffer_load_dwordx4 a[48:51], v6, s[88:91], s41 offen offset:256
buffer_load_dwordx4 a[52:55], v6, s[88:91], s41 offen offset:320
buffer_load_dwordx4 a[56:59], v6, s[88:91], s41 offen offset:384
buffer_load_dwordx4 a[60:63], v6, s[88:91], s41 offen offset:448
s_cmp_ge_u32 s32, 2
s_cselect_b32 s42, 1.0, 0
s_lshl_b32 s43, s32, 10
v_add_u32 v7, s43, v7
v_add_f32 v16, v16, v24
v_add_f32 v17, v17, v25
v_add_f32 v18, v18, v26
v_add_f32 v19, v19, v27
v_add_f32 v20, v20, v28
v_add_f32 v21, v21, v29
v_add_f32 v22, v22, v30
v_add_f32 v23, v23, v31
v_cvt_pk_bf16_f32 v16, 0, v16
v_cvt_pk_bf16_f32 v17, 0, v17
v_cvt_pk_bf16_f32 v18, 0, v18
v_cvt_pk_bf16_f32 v19, 0, v19
v_cvt_pk_bf16_f32 v20, 0, v20
v_cvt_pk_bf16_f32 v21, 0, v21
v_cvt_pk_bf16_f32 v22, 0, v22
v_cvt_pk_bf16_f32 v23, 0, v23
v_add_f32 v16, s42, v16
v_add_f32 v17, s42, v17
v_add_f32 v18, s42, v18
v_add_f32 v19, s42, v19
v_add_f32 v20, s42, v20
v_add_f32 v21, s42, v21
v_add_f32 v22, s42, v22
v_add_f32 v23, s42, v23
ds_write_b128 v14, v[16:19] offset:4096
ds_write_b128 v14, v[20:23] offset:4112
s_waitcnt lgkmcnt(0)
s_barrier
ds_read_b128 v[112:115], v7 offset:4096
ds_read_b128 v[176:179], v7 offset:8192
ds_read_b128 v[116:119], v7 offset:4112
ds_read_b128 v[180:183], v7 offset:8208
ds_read_b128 v[120:123], v7 offset:4224
ds_read_b128 v[184:187], v7 offset:8320
ds_read_b128 v[124:127], v7 offset:4240
ds_read_b128 v[188:191], v7 offset:8336
ds_read_b128 v[128:131], v7 offset:4352
ds_read_b128 v[192:195], v7 offset:8448
ds_read_b128 v[132:135], v7 offset:4368
ds_read_b128 v[196:199], v7 offset:8464
ds_read_b128 v[136:139], v7 offset:4480
ds_read_b128 v[200:203], v7 offset:8576
ds_read_b128 v[140:143], v7 offset:4496
ds_read_b128 v[204:207], v7 offset:8592
ds_read_b128 v[144:147], v7 offset:4608
ds_read_b128 v[208:211], v7 offset:8704
ds_read_b128 v[148:151], v7 offset:4624
ds_read_b128 v[212:215], v7 offset:8720
ds_read_b128 v[152:155], v7 offset:4736
ds_read_b128 v[216:219], v7 offset:8832
ds_read_b128 v[156:159], v7 offset:4752
ds_read_b128 v[220:223], v7 offset:8848
ds_read_b128 v[160:163], v7 offset:4864
ds_read_b128 v[224:227], v7 offset:8960
ds_read_b128 v[164:167], v7 offset:4880
ds_read_b128 v[228:231], v7 offset:8976
ds_read_b128 v[168:171], v7 offset:4992
ds_read_b128 v[232:235], v7 offset:9088
ds_read_b128 v[172:175], v7 offset:5008
ds_read_b128 v[236:239], v7 offset:9104
s_waitcnt lgkmcnt(0)
v_pk_fma_f32 v[48:49], v[48:49], v[176:177], v[112:113]
v_pk_fma_f32 v[50:51], v[50:51], v[178:179], v[114:115]
v_pk_fma_f32 v[52:53], v[52:53], v[180:181], v[116:117]
v_pk_fma_f32 v[54:55], v[54:55], v[182:183], v[118:119]
v_cvt_pk_bf16_f32 v16, v48, v49
v_cvt_pk_bf16_f32 v17, v50, v51
v_cvt_pk_bf16_f32 v18, v52, v53
v_cvt_pk_bf16_f32 v19, v54, v55
s_add_u32 s41, s40, 8388608
buffer_store_dwordx4 v[16:19], v13, s[4:7], s41 offen sc1
v_pk_fma_f32 v[56:57], v[56:57], v[184:185], v[120:121]
v_pk_fma_f32 v[58:59], v[58:59], v[186:187], v[122:123]
v_pk_fma_f32 v[60:61], v[60:61], v[188:189], v[124:125]
v_pk_fma_f32 v[62:63], v[62:63], v[190:191], v[126:127]
v_cvt_pk_bf16_f32 v20, v56, v57
v_cvt_pk_bf16_f32 v21, v58, v59
v_cvt_pk_bf16_f32 v22, v60, v61
v_cvt_pk_bf16_f32 v23, v62, v63
s_add_u32 s41, s40, 8390656
buffer_store_dwordx4 v[20:23], v13, s[4:7], s41 offen sc1
v_pk_fma_f32 v[64:65], v[64:65], v[192:193], v[128:129]
v_pk_fma_f32 v[66:67], v[66:67], v[194:195], v[130:131]
v_pk_fma_f32 v[68:69], v[68:69], v[196:197], v[132:133]
v_pk_fma_f32 v[70:71], v[70:71], v[198:199], v[134:135]
v_cvt_pk_bf16_f32 v24, v64, v65
v_cvt_pk_bf16_f32 v25, v66, v67
v_cvt_pk_bf16_f32 v26, v68, v69
v_cvt_pk_bf16_f32 v27, v70, v71
s_add_u32 s41, s40, 8392704
buffer_store_dwordx4 v[24:27], v13, s[4:7], s41 offen sc1
v_pk_fma_f32 v[72:73], v[72:73], v[200:201], v[136:137]
v_pk_fma_f32 v[74:75], v[74:75], v[202:203], v[138:139]
v_pk_fma_f32 v[76:77], v[76:77], v[204:205], v[140:141]
v_pk_fma_f32 v[78:79], v[78:79], v[206:207], v[142:143]
v_cvt_pk_bf16_f32 v28, v72, v73
v_cvt_pk_bf16_f32 v29, v74, v75
v_cvt_pk_bf16_f32 v30, v76, v77
v_cvt_pk_bf16_f32 v31, v78, v79
s_add_u32 s41, s40, 8394752
buffer_store_dwordx4 v[28:31], v13, s[4:7], s41 offen sc1
v_pk_fma_f32 v[80:81], v[80:81], v[208:209], v[144:145]
v_pk_fma_f32 v[82:83], v[82:83], v[210:211], v[146:147]
v_pk_fma_f32 v[84:85], v[84:85], v[212:213], v[148:149]
v_pk_fma_f32 v[86:87], v[86:87], v[214:215], v[150:151]
v_cvt_pk_bf16_f32 v32, v80, v81
v_cvt_pk_bf16_f32 v33, v82, v83
v_cvt_pk_bf16_f32 v34, v84, v85
v_cvt_pk_bf16_f32 v35, v86, v87
s_add_u32 s41, s40, 8396800
buffer_store_dwordx4 v[32:35], v13, s[4:7], s41 offen sc1
v_pk_fma_f32 v[88:89], v[88:89], v[216:217], v[152:153]
v_pk_fma_f32 v[90:91], v[90:91], v[218:219], v[154:155]
v_pk_fma_f32 v[92:93], v[92:93], v[220:221], v[156:157]
v_pk_fma_f32 v[94:95], v[94:95], v[222:223], v[158:159]
v_cvt_pk_bf16_f32 v36, v88, v89
v_cvt_pk_bf16_f32 v37, v90, v91
v_cvt_pk_bf16_f32 v38, v92, v93
v_cvt_pk_bf16_f32 v39, v94, v95
s_add_u32 s41, s40, 8398848
buffer_store_dwordx4 v[36:39], v13, s[4:7], s41 offen sc1
v_pk_fma_f32 v[96:97], v[96:97], v[224:225], v[160:161]
v_pk_fma_f32 v[98:99], v[98:99], v[226:227], v[162:163]
v_pk_fma_f32 v[100:101], v[100:101], v[228:229], v[164:165]
v_pk_fma_f32 v[102:103], v[102:103], v[230:231], v[166:167]
v_cvt_pk_bf16_f32 v40, v96, v97
v_cvt_pk_bf16_f32 v41, v98, v99
v_cvt_pk_bf16_f32 v42, v100, v101
v_cvt_pk_bf16_f32 v43, v102, v103
s_add_u32 s41, s40, 8400896
buffer_store_dwordx4 v[40:43], v13, s[4:7], s41 offen sc1
v_pk_fma_f32 v[104:105], v[104:105], v[232:233], v[168:169]
v_pk_fma_f32 v[106:107], v[106:107], v[234:235], v[170:171]
v_pk_fma_f32 v[108:109], v[108:109], v[236:237], v[172:173]
v_pk_fma_f32 v[110:111], v[110:111], v[238:239], v[174:175]
v_cvt_pk_bf16_f32 v44, v104, v105
v_cvt_pk_bf16_f32 v45, v106, v107
v_cvt_pk_bf16_f32 v46, v108, v109
v_cvt_pk_bf16_f32 v47, v110, v111
s_add_u32 s41, s40, 8402944
buffer_store_dwordx4 v[44:47], v13, s[4:7], s41 offen sc1
v_mov_b32 v14, 2
s_waitcnt vmcnt(0)
s_barrier
buffer_store_dword v14, v10, s[4:7], 0 offen sc1
s_add_u32 s52, s26, 64
v_accvgpr_read_b32 v16, a32
v_accvgpr_read_b32 v17, a33
v_accvgpr_read_b32 v18, a34
v_accvgpr_read_b32 v19, a35
v_accvgpr_read_b32 v20, a36
v_accvgpr_read_b32 v21, a37
v_accvgpr_read_b32 v22, a38
v_accvgpr_read_b32 v23, a39
v_accvgpr_read_b32 v24, a40
v_accvgpr_read_b32 v25, a41
v_accvgpr_read_b32 v26, a42
v_accvgpr_read_b32 v27, a43
v_accvgpr_read_b32 v28, a44
v_accvgpr_read_b32 v29, a45
v_accvgpr_read_b32 v30, a46
v_accvgpr_read_b32 v31, a47
v_accvgpr_read_b32 v32, a48
v_accvgpr_read_b32 v33, a49
v_accvgpr_read_b32 v34, a50
v_accvgpr_read_b32 v35, a51
v_accvgpr_read_b32 v36, a52
v_accvgpr_read_b32 v37, a53
v_accvgpr_read_b32 v38, a54
v_accvgpr_read_b32 v39, a55
v_accvgpr_read_b32 v40, a56
v_accvgpr_read_b32 v41, a57
v_accvgpr_read_b32 v42, a58
v_accvgpr_read_b32 v43, a59
v_accvgpr_read_b32 v44, a60
v_accvgpr_read_b32 v45, a61
v_accvgpr_read_b32 v46, a62
v_accvgpr_read_b32 v47, a63
s_lshr_b32 s40, s52, 1
s_lshl_b32 s40, s40, 2
s_add_u32 s40, s40, s32
s_lshl_b32 s40, s40, 14
s_and_b32 s41, s52, 1
s_lshl_b32 s41, s41, 10
s_add_u32 s40, s40, s41
v_lshlrev_b32 v48, 16, v16
v_and_b32 v49, 0xffff0000, v16
v_lshlrev_b32 v50, 16, v17
v_and_b32 v51, 0xffff0000, v17
v_lshlrev_b32 v52, 16, v18
v_and_b32 v53, 0xffff0000, v18
v_lshlrev_b32 v54, 16, v19
v_and_b32 v55, 0xffff0000, v19
v_lshlrev_b32 v56, 16, v20
v_and_b32 v57, 0xffff0000, v20
v_lshlrev_b32 v58, 16, v21
v_and_b32 v59, 0xffff0000, v21
v_lshlrev_b32 v60, 16, v22
v_and_b32 v61, 0xffff0000, v22
v_lshlrev_b32 v62, 16, v23
v_and_b32 v63, 0xffff0000, v23
v_lshlrev_b32 v64, 16, v24
v_and_b32 v65, 0xffff0000, v24
v_lshlrev_b32 v66, 16, v25
v_and_b32 v67, 0xffff0000, v25
v_lshlrev_b32 v68, 16, v26
v_and_b32 v69, 0xffff0000, v26
v_lshlrev_b32 v70, 16, v27
v_and_b32 v71, 0xffff0000, v27
v_lshlrev_b32 v72, 16, v28
v_and_b32 v73, 0xffff0000, v28
v_lshlrev_b32 v74, 16, v29
v_and_b32 v75, 0xffff0000, v29
v_lshlrev_b32 v76, 16, v30
v_and_b32 v77, 0xffff0000, v30
v_lshlrev_b32 v78, 16, v31
v_and_b32 v79, 0xffff0000, v31
v_lshlrev_b32 v80, 16, v32
v_and_b32 v81, 0xffff0000, v32
v_lshlrev_b32 v82, 16, v33
v_and_b32 v83, 0xffff0000, v33
v_lshlrev_b32 v84, 16, v34
v_and_b32 v85, 0xffff0000, v34
v_lshlrev_b32 v86, 16, v35
v_and_b32 v87, 0xffff0000, v35
v_lshlrev_b32 v88, 16, v36
v_and_b32 v89, 0xffff0000, v36
v_lshlrev_b32 v90, 16, v37
v_and_b32 v91, 0xffff0000, v37
v_lshlrev_b32 v92, 16, v38
v_and_b32 v93, 0xffff0000, v38
v_lshlrev_b32 v94, 16, v39
v_and_b32 v95, 0xffff0000, v39
v_lshlrev_b32 v96, 16, v40
v_and_b32 v97, 0xffff0000, v40
v_lshlrev_b32 v98, 16, v41
v_and_b32 v99, 0xffff0000, v41
v_lshlrev_b32 v100, 16, v42
v_and_b32 v101, 0xffff0000, v42
v_lshlrev_b32 v102, 16, v43
v_and_b32 v103, 0xffff0000, v43
v_lshlrev_b32 v104, 16, v44
v_and_b32 v105, 0xffff0000, v44
v_lshlrev_b32 v106, 16, v45
v_and_b32 v107, 0xffff0000, v45
v_lshlrev_b32 v108, 16, v46
v_and_b32 v109, 0xffff0000, v46
v_lshlrev_b32 v110, 16, v47
v_and_b32 v111, 0xffff0000, v47
v_pk_mul_f32 v[240:241], v[48:49], 1.0 op_sel_hi:[1,0]
v_pk_mul_f32 v[242:243], v[48:49], v[48:49]
v_pk_add_f32 v[240:241], v[240:241], v[50:51]
v_pk_fma_f32 v[242:243], v[50:51], v[50:51], v[242:243]
v_pk_add_f32 v[240:241], v[240:241], v[52:53]
v_pk_fma_f32 v[242:243], v[52:53], v[52:53], v[242:243]
v_pk_add_f32 v[240:241], v[240:241], v[54:55]
v_pk_fma_f32 v[242:243], v[54:55], v[54:55], v[242:243]
v_pk_add_f32 v[240:241], v[240:241], v[56:57]
v_pk_fma_f32 v[242:243], v[56:57], v[56:57], v[242:243]
v_pk_add_f32 v[240:241], v[240:241], v[58:59]
v_pk_fma_f32 v[242:243], v[58:59], v[58:59], v[242:243]
v_pk_add_f32 v[240:241], v[240:241], v[60:61]
v_pk_fma_f32 v[242:243], v[60:61], v[60:61], v[242:243]
v_pk_add_f32 v[240:241], v[240:241], v[62:63]
v_pk_fma_f32 v[242:243], v[62:63], v[62:63], v[242:243]
v_pk_add_f32 v[240:241], v[240:241], v[64:65]
v_pk_fma_f32 v[242:243], v[64:65], v[64:65], v[242:243]
v_pk_add_f32 v[240:241], v[240:241], v[66:67]
v_pk_fma_f32 v[242:243], v[66:67], v[66:67], v[242:243]
v_pk_add_f32 v[240:241], v[240:241], v[68:69]
v_pk_fma_f32 v[242:243], v[68:69], v[68:69], v[242:243]
v_pk_add_f32 v[240:241], v[240:241], v[70:71]
v_pk_fma_f32 v[242:243], v[70:71], v[70:71], v[242:243]
v_pk_add_f32 v[240:241], v[240:241], v[72:73]
v_pk_fma_f32 v[242:243], v[72:73], v[72:73], v[242:243]
v_pk_add_f32 v[240:241], v[240:241], v[74:75]
v_pk_fma_f32 v[242:243], v[74:75], v[74:75], v[242:243]
v_pk_add_f32 v[240:241], v[240:241], v[76:77]
v_pk_fma_f32 v[242:243], v[76:77], v[76:77], v[242:243]
v_pk_add_f32 v[240:241], v[240:241], v[78:79]
v_pk_fma_f32 v[242:243], v[78:79], v[78:79], v[242:243]
v_pk_add_f32 v[240:241], v[240:241], v[80:81]
v_pk_fma_f32 v[242:243], v[80:81], v[80:81], v[242:243]
v_pk_add_f32 v[240:241], v[240:241], v[82:83]
v_pk_fma_f32 v[242:243], v[82:83], v[82:83], v[242:243]
v_pk_add_f32 v[240:241], v[240:241], v[84:85]
v_pk_fma_f32 v[242:243], v[84:85], v[84:85], v[242:243]
v_pk_add_f32 v[240:241], v[240:241], v[86:87]
v_pk_fma_f32 v[242:243], v[86:87], v[86:87], v[242:243]
v_pk_add_f32 v[240:241], v[240:241], v[88:89]
v_pk_fma_f32 v[242:243], v[88:89], v[88:89], v[242:243]
v_pk_add_f32 v[240:241], v[240:241], v[90:91]
v_pk_fma_f32 v[242:243], v[90:91], v[90:91], v[242:243]
v_pk_add_f32 v[240:241], v[240:241], v[92:93]
v_pk_fma_f32 v[242:243], v[92:93], v[92:93], v[242:243]
v_pk_add_f32 v[240:241], v[240:241], v[94:95]
v_pk_fma_f32 v[242:243], v[94:95], v[94:95], v[242:243]
v_pk_add_f32 v[240:241], v[240:241], v[96:97]
v_pk_fma_f32 v[242:243], v[96:97], v[96:97], v[242:243]
v_pk_add_f32 v[240:241], v[240:241], v[98:99]
v_pk_fma_f32 v[242:243], v[98:99], v[98:99], v[242:243]
v_pk_add_f32 v[240:241], v[240:241], v[100:101]
v_pk_fma_f32 v[242:243], v[100:101], v[100:101], v[242:243]
v_pk_add_f32 v[240:241], v[240:241], v[102:103]
v_pk_fma_f32 v[242:243], v[102:103], v[102:103], v[242:243]
v_pk_add_f32 v[240:241], v[240:241], v[104:105]
v_pk_fma_f32 v[242:243], v[104:105], v[104:105], v[242:243]
v_pk_add_f32 v[240:241], v[240:241], v[106:107]
v_pk_fma_f32 v[242:243], v[106:107], v[106:107], v[242:243]
v_pk_add_f32 v[240:241], v[240:241], v[108:109]
v_pk_fma_f32 v[242:243], v[108:109], v[108:109], v[242:243]
v_pk_add_f32 v[240:241], v[240:241], v[110:111]
v_pk_fma_f32 v[242:243], v[110:111], v[110:111], v[242:243]
v_add_f32 v240, v240, v241
v_add_f32 v241, v242, v243
v_mov_b32 v242, v240
v_mov_b32 v243, v241
s_nop 1
v_permlane16_swap_b32 v240, v242
v_permlane16_swap_b32 v241, v243
v_add_f32 v240, v240, v242
v_add_f32 v241, v241, v243
v_mov_b32 v242, v240
v_mov_b32 v243, v241
s_nop 1
v_permlane32_swap_b32 v240, v242
v_permlane32_swap_b32 v241, v243
v_add_f32 v240, v240, v242
v_add_f32 v241, v241, v243
ds_write_b64 v11, v[240:241] offset:2048
s_waitcnt lgkmcnt(0)
s_barrier
ds_read_b128 v[240:243], v12 offset:2048
ds_read_b128 v[244:247], v12 offset:2064
v_xor_b32 v11, 512, v11
v_xor_b32 v12, 512, v12
s_mov_b32 s38, 0x3a800000
s_waitcnt lgkmcnt(0)
v_pk_add_f32 v[240:241], v[240:241], v[242:243]
v_pk_add_f32 v[244:245], v[244:245], v[246:247]
v_pk_add_f32 v[240:241], v[240:241], v[244:245]
v_pk_mul_f32 v[240:241], v[240:241], s[38:39] op_sel_hi:[1,0]
v_fma_f32 v241, -v240, v240, v241
v_max_f32 v241, 0, v241
v_add_f32 v241, 0x3727c5ac, v241
v_rsq_f32 v241, v241
s_nop 0
v_mul_f32 v240, -v240, v241
v_pk_fma_f32 v[48:49], v[48:49], v[240:241], v[240:241] op_sel:[0,1,0] op_sel_hi:[1,1,0]
v_pk_fma_f32 v[50:51], v[50:51], v[240:241], v[240:241] op_sel:[0,1,0] op_sel_hi:[1,1,0]
v_pk_fma_f32 v[52:53], v[52:53], v[240:241], v[240:241] op_sel:[0,1,0] op_sel_hi:[1,1,0]
v_pk_fma_f32 v[54:55], v[54:55], v[240:241], v[240:241] op_sel:[0,1,0] op_sel_hi:[1,1,0]
v_pk_fma_f32 v[56:57], v[56:57], v[240:241], v[240:241] op_sel:[0,1,0] op_sel_hi:[1,1,0]
v_pk_fma_f32 v[58:59], v[58:59], v[240:241], v[240:241] op_sel:[0,1,0] op_sel_hi:[1,1,0]
v_pk_fma_f32 v[60:61], v[60:61], v[240:241], v[240:241] op_sel:[0,1,0] op_sel_hi:[1,1,0]
v_pk_fma_f32 v[62:63], v[62:63], v[240:241], v[240:241] op_sel:[0,1,0] op_sel_hi:[1,1,0]
v_pk_fma_f32 v[64:65], v[64:65], v[240:241], v[240:241] op_sel:[0,1,0] op_sel_hi:[1,1,0]
v_pk_fma_f32 v[66:67], v[66:67], v[240:241], v[240:241] op_sel:[0,1,0] op_sel_hi:[1,1,0]
v_pk_fma_f32 v[68:69], v[68:69], v[240:241], v[240:241] op_sel:[0,1,0] op_sel_hi:[1,1,0]
v_pk_fma_f32 v[70:71], v[70:71], v[240:241], v[240:241] op_sel:[0,1,0] op_sel_hi:[1,1,0]
v_pk_fma_f32 v[72:73], v[72:73], v[240:241], v[240:241] op_sel:[0,1,0] op_sel_hi:[1,1,0]
v_pk_fma_f32 v[74:75], v[74:75], v[240:241], v[240:241] op_sel:[0,1,0] op_sel_hi:[1,1,0]
v_pk_fma_f32 v[76:77], v[76:77], v[240:241], v[240:241] op_sel:[0,1,0] op_sel_hi:[1,1,0]
v_pk_fma_f32 v[78:79], v[78:79], v[240:241], v[240:241] op_sel:[0,1,0] op_sel_hi:[1,1,0]
v_pk_fma_f32 v[80:81], v[80:81], v[240:241], v[240:241] op_sel:[0,1,0] op_sel_hi:[1,1,0]
v_pk_fma_f32 v[82:83], v[82:83], v[240:241], v[240:241] op_sel:[0,1,0] op_sel_hi:[1,1,0]
v_pk_fma_f32 v[84:85], v[84:85], v[240:241], v[240:241] op_sel:[0,1,0] op_sel_hi:[1,1,0]
v_pk_fma_f32 v[86:87], v[86:87], v[240:241], v[240:241] op_sel:[0,1,0] op_sel_hi:[1,1,0]
v_pk_fma_f32 v[88:89], v[88:89], v[240:241], v[240:241] op_sel:[0,1,0] op_sel_hi:[1,1,0]
v_pk_fma_f32 v[90:91], v[90:91], v[240:241], v[240:241] op_sel:[0,1,0] op_sel_hi:[1,1,0]
v_pk_fma_f32 v[92:93], v[92:93], v[240:241], v[240:241] op_sel:[0,1,0] op_sel_hi:[1,1,0]
v_pk_fma_f32 v[94:95], v[94:95], v[240:241], v[240:241] op_sel:[0,1,0] op_sel_hi:[1,1,0]
v_pk_fma_f32 v[96:97], v[96:97], v[240:241], v[240:241] op_sel:[0,1,0] op_sel_hi:[1,1,0]
v_pk_fma_f32 v[98:99], v[98:99], v[240:241], v[240:241] op_sel:[0,1,0] op_sel_hi:[1,1,0]
v_pk_fma_f32 v[100:101], v[100:101], v[240:241], v[240:241] op_sel:[0,1,0] op_sel_hi:[1,1,0]
v_pk_fma_f32 v[102:103], v[102:103], v[240:241], v[240:241] op_sel:[0,1,0] op_sel_hi:[1,1,0]
v_pk_fma_f32 v[104:105], v[104:105], v[240:241], v[240:241] op_sel:[0,1,0] op_sel_hi:[1,1,0]
v_pk_fma_f32 v[106:107], v[106:107], v[240:241], v[240:241] op_sel:[0,1,0] op_sel_hi:[1,1,0]
v_pk_fma_f32 v[108:109], v[108:109], v[240:241], v[240:241] op_sel:[0,1,0] op_sel_hi:[1,1,0]
v_pk_fma_f32 v[110:111], v[110:111], v[240:241], v[240:241] op_sel:[0,1,0] op_sel_hi:[1,1,0]
v_pk_fma_f32 v[48:49], v[48:49], v[176:177], v[112:113]
v_pk_fma_f32 v[50:51], v[50:51], v[178:179], v[114:115]
v_pk_fma_f32 v[52:53], v[52:53], v[180:181], v[116:117]
v_pk_fma_f32 v[54:55], v[54:55], v[182:183], v[118:119]
v_cvt_pk_bf16_f32 v16, v48, v49
v_cvt_pk_bf16_f32 v17, v50, v51
v_cvt_pk_bf16_f32 v18, v52, v53
v_cvt_pk_bf16_f32 v19, v54, v55
s_add_u32 s41, s40, 8388608
buffer_store_dwordx4 v[16:19], v13, s[4:7], s41 offen sc1
v_pk_fma_f32 v[56:57], v[56:57], v[184:185], v[120:121]
v_pk_fma_f32 v[58:59], v[58:59], v[186:187], v[122:123]
v_pk_fma_f32 v[60:61], v[60:61], v[188:189], v[124:125]
v_pk_fma_f32 v[62:63], v[62:63], v[190:191], v[126:127]
v_cvt_pk_bf16_f32 v20, v56, v57
v_cvt_pk_bf16_f32 v21, v58, v59
v_cvt_pk_bf16_f32 v22, v60, v61
v_cvt_pk_bf16_f32 v23, v62, v63
s_add_u32 s41, s40, 8390656
buffer_store_dwordx4 v[20:23], v13, s[4:7], s41 offen sc1
v_pk_fma_f32 v[64:65], v[64:65], v[192:193], v[128:129]
v_pk_fma_f32 v[66:67], v[66:67], v[194:195], v[130:131]
v_pk_fma_f32 v[68:69], v[68:69], v[196:197], v[132:133]
v_pk_fma_f32 v[70:71], v[70:71], v[198:199], v[134:135]
v_cvt_pk_bf16_f32 v24, v64, v65
v_cvt_pk_bf16_f32 v25, v66, v67
v_cvt_pk_bf16_f32 v26, v68, v69
v_cvt_pk_bf16_f32 v27, v70, v71
s_add_u32 s41, s40, 8392704
buffer_store_dwordx4 v[24:27], v13, s[4:7], s41 offen sc1
v_pk_fma_f32 v[72:73], v[72:73], v[200:201], v[136:137]
v_pk_fma_f32 v[74:75], v[74:75], v[202:203], v[138:139]
v_pk_fma_f32 v[76:77], v[76:77], v[204:205], v[140:141]
v_pk_fma_f32 v[78:79], v[78:79], v[206:207], v[142:143]
v_cvt_pk_bf16_f32 v28, v72, v73
v_cvt_pk_bf16_f32 v29, v74, v75
v_cvt_pk_bf16_f32 v30, v76, v77
v_cvt_pk_bf16_f32 v31, v78, v79
s_add_u32 s41, s40, 8394752
buffer_store_dwordx4 v[28:31], v13, s[4:7], s41 offen sc1
v_pk_fma_f32 v[80:81], v[80:81], v[208:209], v[144:145]
v_pk_fma_f32 v[82:83], v[82:83], v[210:211], v[146:147]
v_pk_fma_f32 v[84:85], v[84:85], v[212:213], v[148:149]
v_pk_fma_f32 v[86:87], v[86:87], v[214:215], v[150:151]
v_cvt_pk_bf16_f32 v32, v80, v81
v_cvt_pk_bf16_f32 v33, v82, v83
v_cvt_pk_bf16_f32 v34, v84, v85
v_cvt_pk_bf16_f32 v35, v86, v87
s_add_u32 s41, s40, 8396800
buffer_store_dwordx4 v[32:35], v13, s[4:7], s41 offen sc1
v_pk_fma_f32 v[88:89], v[88:89], v[216:217], v[152:153]
v_pk_fma_f32 v[90:91], v[90:91], v[218:219], v[154:155]
v_pk_fma_f32 v[92:93], v[92:93], v[220:221], v[156:157]
v_pk_fma_f32 v[94:95], v[94:95], v[222:223], v[158:159]
v_cvt_pk_bf16_f32 v36, v88, v89
v_cvt_pk_bf16_f32 v37, v90, v91
v_cvt_pk_bf16_f32 v38, v92, v93
v_cvt_pk_bf16_f32 v39, v94, v95
s_add_u32 s41, s40, 8398848
buffer_store_dwordx4 v[36:39], v13, s[4:7], s41 offen sc1
v_pk_fma_f32 v[96:97], v[96:97], v[224:225], v[160:161]
v_pk_fma_f32 v[98:99], v[98:99], v[226:227], v[162:163]
v_pk_fma_f32 v[100:101], v[100:101], v[228:229], v[164:165]
v_pk_fma_f32 v[102:103], v[102:103], v[230:231], v[166:167]
v_cvt_pk_bf16_f32 v40, v96, v97
v_cvt_pk_bf16_f32 v41, v98, v99
v_cvt_pk_bf16_f32 v42, v100, v101
v_cvt_pk_bf16_f32 v43, v102, v103
s_add_u32 s41, s40, 8400896
buffer_store_dwordx4 v[40:43], v13, s[4:7], s41 offen sc1
v_pk_fma_f32 v[104:105], v[104:105], v[232:233], v[168:169]
v_pk_fma_f32 v[106:107], v[106:107], v[234:235], v[170:171]
v_pk_fma_f32 v[108:109], v[108:109], v[236:237], v[172:173]
v_pk_fma_f32 v[110:111], v[110:111], v[238:239], v[174:175]
v_cvt_pk_bf16_f32 v44, v104, v105
v_cvt_pk_bf16_f32 v45, v106, v107
v_cvt_pk_bf16_f32 v46, v108, v109
v_cvt_pk_bf16_f32 v47, v110, v111
s_add_u32 s41, s40, 8402944
buffer_store_dwordx4 v[44:47], v13, s[4:7], s41 offen sc1
v_mov_b32 v14, 3
s_waitcnt vmcnt(0)
s_barrier
buffer_store_dword v14, v10, s[4:7], 0 offen sc1
v_mov_b32 v4, v8
v_mov_b32 v5, 0
s_cmp_ge_u32 s44, 56
s_cbranch_scc1 Lln_6
s_load_dwordx2 s[16:17], s[0:1], 64
s_load_dwordx2 s[18:19], s[0:1], 72
s_load_dwordx2 s[20:21], s[0:1], 80
s_waitcnt lgkmcnt(0)
s_mov_b32 s8, s16
s_and_b32 s9, s17, 0xffff
s_mov_b32 s10, 0x700000
s_mov_b32 s11, 0x20000
s_mov_b32 s84, s18
s_and_b32 s85, s19, 0xffff
s_mov_b32 s86, 0x700000
s_mov_b32 s87, 0x20000
s_mov_b32 s88, s20
s_and_b32 s89, s21, 0xffff
s_mov_b32 s90, 0x700000
s_mov_b32 s91, 0x20000
s_lshl_b32 s60, s44, 7
s_lshl_b32 s52, s32, 5
v_bfe_u32 v84, v9, 2, 2
v_lshrrev_b32 v85, 4, v9
v_lshl_add_u32 v84, v85, 3, v84
v_lshl_add_u32 v84, v84, 7, s52
v_and_b32 v85, 3, v9
v_lshl_add_u32 v84, v85, 3, v84
v_add_u32 v80, 0, v84
v_bfe_u32 v84, v9, 2, 2
v_lshrrev_b32 v85, 4, v9
v_lshl_add_u32 v84, v85, 3, v84
v_lshl_add_u32 v84, v84, 7, s52
v_and_b32 v85, 3, v9
v_lshl_add_u32 v84, v85, 3, v84
v_add_u32 v81, 16384, v84
v_lshrrev_b32 v84, 3, v9
s_mul_i32 s38, s32, 256
v_add_u32 v84, s38, v84
v_mul_u32_u24 v84, 7168, v84
v_and_b32 v85, 7, v9
v_lshl_add_u32 v84, v85, 4, v84
s_lshl_b32 s38, s32, 12
s_barrier
s_add_u32 m0, s38, 0
s_add_u32 s39, s60, 0
buffer_load_dwordx4 v84, s[8:11], s39 offen lds
s_add_u32 m0, s38, 1024
s_add_u32 s39, s60, 57344
buffer_load_dwordx4 v84, s[8:11], s39 offen lds
s_add_u32 m0, s38, 2048
s_add_u32 s39, s60, 114688
buffer_load_dwordx4 v84, s[8:11], s39 offen lds
s_add_u32 m0, s38, 3072
s_add_u32 s39, s60, 172032
buffer_load_dwordx4 v84, s[8:11], s39 offen lds
s_add_u32 m0, s38, 16384
s_add_u32 s39, s60, 0
buffer_load_dwordx4 v84, s[84:87], s39 offen lds
s_add_u32 m0, s38, 17408
s_add_u32 s39, s60, 57344
buffer_load_dwordx4 v84, s[84:87], s39 offen lds
s_add_u32 m0, s38, 18432
s_add_u32 s39, s60, 114688
buffer_load_dwordx4 v84, s[84:87], s39 offen lds
s_add_u32 m0, s38, 19456
s_add_u32 s39, s60, 172032
buffer_load_dwordx4 v84, s[84:87], s39 offen lds
s_add_u32 m0, s38, 32768
s_add_u32 s39, s60, 229376
buffer_load_dwordx4 v84, s[8:11], s39 offen lds
s_add_u32 m0, s38, 33792
s_add_u32 s39, s60, 286720
buffer_load_dwordx4 v84, s[8:11], s39 offen lds
s_add_u32 m0, s38, 34816
s_add_u32 s39, s60, 344064
buffer_load_dwordx4 v84, s[8:11], s39 offen lds
s_add_u32 m0, s38, 35840
s_add_u32 s39, s60, 401408
buffer_load_dwordx4 v84, s[8:11], s39 offen lds
s_add_u32 m0, s38, 49152
s_add_u32 s39, s60, 229376
buffer_load_dwordx4 v84, s[84:87], s39 offen lds
s_add_u32 m0, s38, 50176
s_add_u32 s39, s60, 286720
buffer_load_dwordx4 v84, s[84:87], s39 offen lds
s_add_u32 m0, s38, 51200
s_add_u32 s39, s60, 344064
buffer_load_dwordx4 v84, s[84:87], s39 offen lds
s_add_u32 m0, s38, 52224
s_add_u32 s39, s60, 401408
buffer_load_dwordx4 v84, s[84:87], s39 offen lds
s_add_u32 m0, s38, 65536
s_add_u32 s39, s60, 458752
buffer_load_dwordx4 v84, s[8:11], s39 offen lds
s_add_u32 m0, s38, 66560
s_add_u32 s39, s60, 516096
buffer_load_dwordx4 v84, s[8:11], s39 offen lds
s_add_u32 m0, s38, 67584
s_add_u32 s39, s60, 573440
buffer_load_dwordx4 v84, s[8:11], s39 offen lds
s_add_u32 m0, s38, 68608
s_add_u32 s39, s60, 630784
buffer_load_dwordx4 v84, s[8:11], s39 offen lds
s_add_u32 m0, s38, 81920
s_add_u32 s39, s60, 458752
buffer_load_dwordx4 v84, s[84:87], s39 offen lds
s_add_u32 m0, s38, 82944
s_add_u32 s39, s60, 516096
buffer_load_dwordx4 v84, s[84:87], s39 offen lds
s_add_u32 m0, s38, 83968
s_add_u32 s39, s60, 573440
buffer_load_dwordx4 v84, s[84:87], s39 offen lds
s_add_u32 m0, s38, 84992
s_add_u32 s39, s60, 630784
buffer_load_dwordx4 v84, s[84:87], s39 offen lds
s_add_u32 m0, s38, 98304
s_add_u32 s39, s60, 688128
buffer_load_dwordx4 v84, s[8:11], s39 offen lds
s_add_u32 m0, s38, 99328
s_add_u32 s39, s60, 745472
buffer_load_dwordx4 v84, s[8:11], s39 offen lds
s_add_u32 m0, s38, 100352
s_add_u32 s39, s60, 802816
buffer_load_dwordx4 v84, s[8:11], s39 offen lds
s_add_u32 m0, s38, 101376
s_add_u32 s39, s60, 860160
buffer_load_dwordx4 v84, s[8:11], s39 offen lds
s_add_u32 m0, s38, 114688
s_add_u32 s39, s60, 688128
buffer_load_dwordx4 v84, s[84:87], s39 offen lds
s_add_u32 m0, s38, 115712
s_add_u32 s39, s60, 745472
buffer_load_dwordx4 v84, s[84:87], s39 offen lds
s_add_u32 m0, s38, 116736
s_add_u32 s39, s60, 802816
buffer_load_dwordx4 v84, s[84:87], s39 offen lds
s_add_u32 m0, s38, 117760
s_add_u32 s39, s60, 860160
buffer_load_dwordx4 v84, s[84:87], s39 offen lds
s_add_u32 m0, s38, 131072
s_add_u32 s39, s60, 917504
buffer_load_dwordx4 v84, s[8:11], s39 offen lds
s_add_u32 m0, s38, 132096
s_add_u32 s39, s60, 974848
buffer_load_dwordx4 v84, s[8:11], s39 offen lds
s_add_u32 m0, s38, 133120
s_add_u32 s39, s60, 1032192
buffer_load_dwordx4 v84, s[8:11], s39 offen lds
s_add_u32 m0, s38, 134144
s_add_u32 s39, s60, 1089536
buffer_load_dwordx4 v84, s[8:11], s39 offen lds
s_add_u32 m0, s38, 147456
s_add_u32 s39, s60, 917504
buffer_load_dwordx4 v84, s[84:87], s39 offen lds
s_add_u32 m0, s38, 148480
s_add_u32 s39, s60, 974848
buffer_load_dwordx4 v84, s[84:87], s39 offen lds
s_add_u32 m0, s38, 149504
s_add_u32 s39, s60, 1032192
buffer_load_dwordx4 v84, s[84:87], s39 offen lds
s_add_u32 m0, s38, 150528
s_add_u32 s39, s60, 1089536
buffer_load_dwordx4 v84, s[84:87], s39 offen lds
s_waitcnt vmcnt(32)
s_barrier
ds_read_b64_tr_b16 a[0:1], v80 offset:0
ds_read_b64_tr_b16 a[2:3], v80 offset:512
ds_read_b64_tr_b16 a[32:33], v80 offset:4096
ds_read_b64_tr_b16 a[34:35], v80 offset:4608
ds_read_b64_tr_b16 a[64:65], v80 offset:8192
ds_read_b64_tr_b16 a[66:67], v80 offset:8704
ds_read_b64_tr_b16 a[96:97], v80 offset:12288
ds_read_b64_tr_b16 a[98:99], v80 offset:12800
ds_read_b64_tr_b16 a[128:129], v81 offset:0
ds_read_b64_tr_b16 a[130:131], v81 offset:512
ds_read_b64_tr_b16 a[160:161], v81 offset:4096
ds_read_b64_tr_b16 a[162:163], v81 offset:4608
ds_read_b64_tr_b16 a[192:193], v81 offset:8192
ds_read_b64_tr_b16 a[194:195], v81 offset:8704
ds_read_b64_tr_b16 a[224:225], v81 offset:12288
ds_read_b64_tr_b16 a[226:227], v81 offset:12800
v_add_u32 v80, 32768, v80
v_add_u32 v81, 32768, v81
s_waitcnt lgkmcnt(0)
s_barrier
s_add_u32 m0, s38, 0
s_add_u32 s39, s60, 1146880
buffer_load_dwordx4 v84, s[8:11], s39 offen lds
s_add_u32 m0, s38, 1024
s_add_u32 s39, s60, 1204224
buffer_load_dwordx4 v84, s[8:11], s39 offen lds
s_add_u32 m0, s38, 2048
s_add_u32 s39, s60, 1261568
buffer_load_dwordx4 v84, s[8:11], s39 offen lds
s_add_u32 m0, s38, 3072
s_add_u32 s39, s60, 1318912
buffer_load_dwordx4 v84, s[8:11], s39 offen lds
s_add_u32 m0, s38, 16384
s_add_u32 s39, s60, 1146880
buffer_load_dwordx4 v84, s[84:87], s39 offen lds
s_add_u32 m0, s38, 17408
s_add_u32 s39, s60, 1204224
buffer_load_dwordx4 v84, s[84:87], s39 offen lds
s_add_u32 m0, s38, 18432
s_add_u32 s39, s60, 1261568
buffer_load_dwordx4 v84, s[84:87], s39 offen lds
s_add_u32 m0, s38, 19456
s_add_u32 s39, s60, 1318912
buffer_load_dwordx4 v84, s[84:87], s39 offen lds
s_waitcnt vmcnt(32)
s_barrier
ds_read_b64_tr_b16 a[4:5], v80 offset:0
ds_read_b64_tr_b16 a[6:7], v80 offset:512
ds_read_b64_tr_b16 a[36:37], v80 offset:4096
ds_read_b64_tr_b16 a[38:39], v80 offset:4608
ds_read_b64_tr_b16 a[68:69], v80 offset:8192
ds_read_b64_tr_b16 a[70:71], v80 offset:8704
ds_read_b64_tr_b16 a[100:101], v80 offset:12288
ds_read_b64_tr_b16 a[102:103], v80 offset:12800
ds_read_b64_tr_b16 a[132:133], v81 offset:0
ds_read_b64_tr_b16 a[134:135], v81 offset:512
ds_read_b64_tr_b16 a[164:165], v81 offset:4096
ds_read_b64_tr_b16 a[166:167], v81 offset:4608
ds_read_b64_tr_b16 a[196:197], v81 offset:8192
ds_read_b64_tr_b16 a[198:199], v81 offset:8704
ds_read_b64_tr_b16 a[228:229], v81 offset:12288
ds_read_b64_tr_b16 a[230:231], v81 offset:12800
v_add_u32 v80, 32768, v80
v_add_u32 v81, 32768, v81
s_waitcnt lgkmcnt(0)
s_barrier
s_add_u32 m0, s38, 32768
s_add_u32 s39, s60, 1376256
buffer_load_dwordx4 v84, s[8:11], s39 offen lds
s_add_u32 m0, s38, 33792
s_add_u32 s39, s60, 1433600
buffer_load_dwordx4 v84, s[8:11], s39 offen lds
s_add_u32 m0, s38, 34816
s_add_u32 s39, s60, 1490944
buffer_load_dwordx4 v84, s[8:11], s39 offen lds
s_add_u32 m0, s38, 35840
s_add_u32 s39, s60, 1548288
buffer_load_dwordx4 v84, s[8:11], s39 offen lds
s_add_u32 m0, s38, 49152
s_add_u32 s39, s60, 1376256
buffer_load_dwordx4 v84, s[84:87], s39 offen lds
s_add_u32 m0, s38, 50176
s_add_u32 s39, s60, 1433600
buffer_load_dwordx4 v84, s[84:87], s39 offen lds
s_add_u32 m0, s38, 51200
s_add_u32 s39, s60, 1490944
buffer_load_dwordx4 v84, s[84:87], s39 offen lds
s_add_u32 m0, s38, 52224
s_add_u32 s39, s60, 1548288
buffer_load_dwordx4 v84, s[84:87], s39 offen lds
s_waitcnt vmcnt(32)
s_barrier
ds_read_b64_tr_b16 a[8:9], v80 offset:0
ds_read_b64_tr_b16 a[10:11], v80 offset:512
ds_read_b64_tr_b16 a[40:41], v80 offset:4096
ds_read_b64_tr_b16 a[42:43], v80 offset:4608
ds_read_b64_tr_b16 a[72:73], v80 offset:8192
ds_read_b64_tr_b16 a[74:75], v80 offset:8704
ds_read_b64_tr_b16 a[104:105], v80 offset:12288
ds_read_b64_tr_b16 a[106:107], v80 offset:12800
ds_read_b64_tr_b16 a[136:137], v81 offset:0
ds_read_b64_tr_b16 a[138:139], v81 offset:512
ds_read_b64_tr_b16 a[168:169], v81 offset:4096
ds_read_b64_tr_b16 a[170:171], v81 offset:4608
ds_read_b64_tr_b16 a[200:201], v81 offset:8192
ds_read_b64_tr_b16 a[202:203], v81 offset:8704
ds_read_b64_tr_b16 a[232:233], v81 offset:12288
ds_read_b64_tr_b16 a[234:235], v81 offset:12800
v_add_u32 v80, 32768, v80
v_add_u32 v81, 32768, v81
s_waitcnt lgkmcnt(0)
s_barrier
s_add_u32 m0, s38, 65536
s_add_u32 s39, s60, 1605632
buffer_load_dwordx4 v84, s[8:11], s39 offen lds
s_add_u32 m0, s38, 66560
s_add_u32 s39, s60, 1662976
buffer_load_dwordx4 v84, s[8:11], s39 offen lds
s_add_u32 m0, s38, 67584
s_add_u32 s39, s60, 1720320
buffer_load_dwordx4 v84, s[8:11], s39 offen lds
s_add_u32 m0, s38, 68608
s_add_u32 s39, s60, 1777664
buffer_load_dwordx4 v84, s[8:11], s39 offen lds
s_add_u32 m0, s38, 81920
s_add_u32 s39, s60, 1605632
buffer_load_dwordx4 v84, s[84:87], s39 offen lds
s_add_u32 m0, s38, 82944
s_add_u32 s39, s60, 1662976
buffer_load_dwordx4 v84, s[84:87], s39 offen lds
s_add_u32 m0, s38, 83968
s_add_u32 s39, s60, 1720320
buffer_load_dwordx4 v84, s[84:87], s39 offen lds
s_add_u32 m0, s38, 84992
s_add_u32 s39, s60, 1777664
buffer_load_dwordx4 v84, s[84:87], s39 offen lds
s_waitcnt vmcnt(32)
s_barrier
ds_read_b64_tr_b16 a[12:13], v80 offset:0
ds_read_b64_tr_b16 a[14:15], v80 offset:512
ds_read_b64_tr_b16 a[44:45], v80 offset:4096
ds_read_b64_tr_b16 a[46:47], v80 offset:4608
ds_read_b64_tr_b16 a[76:77], v80 offset:8192
ds_read_b64_tr_b16 a[78:79], v80 offset:8704
ds_read_b64_tr_b16 a[108:109], v80 offset:12288
ds_read_b64_tr_b16 a[110:111], v80 offset:12800
ds_read_b64_tr_b16 a[140:141], v81 offset:0
ds_read_b64_tr_b16 a[142:143], v81 offset:512
ds_read_b64_tr_b16 a[172:173], v81 offset:4096
ds_read_b64_tr_b16 a[174:175], v81 offset:4608
ds_read_b64_tr_b16 a[204:205], v81 offset:8192
ds_read_b64_tr_b16 a[206:207], v81 offset:8704
ds_read_b64_tr_b16 a[236:237], v81 offset:12288
ds_read_b64_tr_b16 a[238:239], v81 offset:12800
v_add_u32 v80, 32768, v80
v_add_u32 v81, 32768, v81
s_waitcnt lgkmcnt(0)
s_barrier
s_waitcnt vmcnt(24)
s_barrier
ds_read_b64_tr_b16 a[16:17], v80 offset:0
ds_read_b64_tr_b16 a[18:19], v80 offset:512
ds_read_b64_tr_b16 a[48:49], v80 offset:4096
ds_read_b64_tr_b16 a[50:51], v80 offset:4608
ds_read_b64_tr_b16 a[80:81], v80 offset:8192
ds_read_b64_tr_b16 a[82:83], v80 offset:8704
ds_read_b64_tr_b16 a[112:113], v80 offset:12288
ds_read_b64_tr_b16 a[114:115], v80 offset:12800
ds_read_b64_tr_b16 a[144:145], v81 offset:0
ds_read_b64_tr_b16 a[146:147], v81 offset:512
ds_read_b64_tr_b16 a[176:177], v81 offset:4096
ds_read_b64_tr_b16 a[178:179], v81 offset:4608
ds_read_b64_tr_b16 a[208:209], v81 offset:8192
ds_read_b64_tr_b16 a[210:211], v81 offset:8704
ds_read_b64_tr_b16 a[240:241], v81 offset:12288
ds_read_b64_tr_b16 a[242:243], v81 offset:12800
v_add_u32 v80, -131072, v80
v_add_u32 v81, -131072, v81
s_waitcnt lgkmcnt(0)
s_barrier
s_waitcnt vmcnt(16)
s_barrier
ds_read_b64_tr_b16 a[20:21], v80 offset:0
ds_read_b64_tr_b16 a[22:23], v80 offset:512
ds_read_b64_tr_b16 a[52:53], v80 offset:4096
ds_read_b64_tr_b16 a[54:55], v80 offset:4608
ds_read_b64_tr_b16 a[84:85], v80 offset:8192
ds_read_b64_tr_b16 a[86:87], v80 offset:8704
ds_read_b64_tr_b16 a[116:117], v80 offset:12288
ds_read_b64_tr_b16 a[118:119], v80 offset:12800
ds_read_b64_tr_b16 a[148:149], v81 offset:0
ds_read_b64_tr_b16 a[150:151], v81 offset:512
ds_read_b64_tr_b16 a[180:181], v81 offset:4096
ds_read_b64_tr_b16 a[182:183], v81 offset:4608
ds_read_b64_tr_b16 a[212:213], v81 offset:8192
ds_read_b64_tr_b16 a[214:215], v81 offset:8704
ds_read_b64_tr_b16 a[244:245], v81 offset:12288
ds_read_b64_tr_b16 a[246:247], v81 offset:12800
v_add_u32 v80, 32768, v80
v_add_u32 v81, 32768, v81
s_waitcnt lgkmcnt(0)
s_barrier
s_waitcnt vmcnt(8)
s_barrier
ds_read_b64_tr_b16 a[24:25], v80 offset:0
ds_read_b64_tr_b16 a[26:27], v80 offset:512
ds_read_b64_tr_b16 a[56:57], v80 offset:4096
ds_read_b64_tr_b16 a[58:59], v80 offset:4608
ds_read_b64_tr_b16 a[88:89], v80 offset:8192
ds_read_b64_tr_b16 a[90:91], v80 offset:8704
ds_read_b64_tr_b16 a[120:121], v80 offset:12288
ds_read_b64_tr_b16 a[122:123], v80 offset:12800
ds_read_b64_tr_b16 a[152:153], v81 offset:0
ds_read_b64_tr_b16 a[154:155], v81 offset:512
ds_read_b64_tr_b16 a[184:185], v81 offset:4096
ds_read_b64_tr_b16 a[186:187], v81 offset:4608
ds_read_b64_tr_b16 a[216:217], v81 offset:8192
ds_read_b64_tr_b16 a[218:219], v81 offset:8704
ds_read_b64_tr_b16 a[248:249], v81 offset:12288
ds_read_b64_tr_b16 a[250:251], v81 offset:12800
v_add_u32 v80, 32768, v80
v_add_u32 v81, 32768, v81
s_waitcnt lgkmcnt(0)
s_barrier
s_waitcnt vmcnt(0)
s_barrier
ds_read_b64_tr_b16 a[28:29], v80 offset:0
ds_read_b64_tr_b16 a[30:31], v80 offset:512
ds_read_b64_tr_b16 a[60:61], v80 offset:4096
ds_read_b64_tr_b16 a[62:63], v80 offset:4608
ds_read_b64_tr_b16 a[92:93], v80 offset:8192
ds_read_b64_tr_b16 a[94:95], v80 offset:8704
ds_read_b64_tr_b16 a[124:125], v80 offset:12288
ds_read_b64_tr_b16 a[126:127], v80 offset:12800
ds_read_b64_tr_b16 a[156:157], v81 offset:0
ds_read_b64_tr_b16 a[158:159], v81 offset:512
ds_read_b64_tr_b16 a[188:189], v81 offset:4096
ds_read_b64_tr_b16 a[190:191], v81 offset:4608
ds_read_b64_tr_b16 a[220:221], v81 offset:8192
ds_read_b64_tr_b16 a[222:223], v81 offset:8704
ds_read_b64_tr_b16 a[252:253], v81 offset:12288
ds_read_b64_tr_b16 a[254:255], v81 offset:12800
v_add_u32 v80, 32768, v80
v_add_u32 v81, 32768, v81
s_waitcnt lgkmcnt(0)
s_barrier
s_lshr_b32 s26, s44, 3
s_and_b32 s62, s44, 7
s_lshl_b32 s60, s26, 20
s_lshl_b32 s38, s62, 8
s_add_u32 s60, s60, s38
s_add_u32 s61, s60, 128
s_lshr_b32 s52, s32, 1
s_lshl_b32 s52, s52, 14
s_and_b32 s53, s32, 1
s_lshl_b32 s53, s53, 6
s_add_u32 s52, s52, s53
v_bfe_u32 v84, v9, 2, 2
v_lshrrev_b32 v85, 4, v9
v_lshl_add_u32 v84, v85, 3, v84
v_lshl_add_u32 v84, v84, 7, s52
v_and_b32 v85, 3, v9
v_lshl_add_u32 v84, v85, 4, v84
v_add_u32 v80, 0, v84
v_bfe_u32 v84, v9, 2, 2
v_lshrrev_b32 v85, 4, v9
v_lshl_add_u32 v84, v85, 3, v84
v_lshl_add_u32 v84, v84, 7, s52
v_and_b32 v85, 3, v9
v_lshl_add_u32 v84, v85, 4, v84
v_add_u32 v81, 8, v84
v_lshrrev_b32 v84, 3, v9
s_mul_i32 s38, s32, 128
v_add_u32 v84, s38, v84
v_mul_u32_u24 v84, 2048, v84
v_and_b32 v85, 7, v9
v_lshl_add_u32 v84, v85, 4, v84
s_lshl_b32 s38, s32, 12
s_barrier
s_add_u32 m0, s38, 0
s_add_u32 s39, s60, 0
buffer_load_dwordx4 v84, s[88:91], s39 offen lds
s_add_u32 m0, s38, 1024
s_add_u32 s39, s60, 16384
buffer_load_dwordx4 v84, s[88:91], s39 offen lds
s_add_u32 m0, s38, 2048
s_add_u32 s39, s60, 32768
buffer_load_dwordx4 v84, s[88:91], s39 offen lds
s_add_u32 m0, s38, 3072
s_add_u32 s39, s60, 49152
buffer_load_dwordx4 v84, s[88:91], s39 offen lds
s_add_u32 m0, s38, 16384
s_add_u32 s39, s61, 0
buffer_load_dwordx4 v84, s[88:91], s39 offen lds
s_add_u32 m0, s38, 17408
s_add_u32 s39, s61, 16384
buffer_load_dwordx4 v84, s[88:91], s39 offen lds
s_add_u32 m0, s38, 18432
s_add_u32 s39, s61, 32768
buffer_load_dwordx4 v84, s[88:91], s39 offen lds
s_add_u32 m0, s38, 19456
s_add_u32 s39, s61, 49152
buffer_load_dwordx4 v84, s[88:91], s39 offen lds
s_add_u32 m0, s38, 32768
s_add_u32 s39, s60, 65536
buffer_load_dwordx4 v84, s[88:91], s39 offen lds
s_add_u32 m0, s38, 33792
s_add_u32 s39, s60, 81920
buffer_load_dwordx4 v84, s[88:91], s39 offen lds
s_add_u32 m0, s38, 34816
s_add_u32 s39, s60, 98304
buffer_load_dwordx4 v84, s[88:91], s39 offen lds
s_add_u32 m0, s38, 35840
s_add_u32 s39, s60, 114688
buffer_load_dwordx4 v84, s[88:91], s39 offen lds
s_add_u32 m0, s38, 49152
s_add_u32 s39, s61, 65536
buffer_load_dwordx4 v84, s[88:91], s39 offen lds
s_add_u32 m0, s38, 50176
s_add_u32 s39, s61, 81920
buffer_load_dwordx4 v84, s[88:91], s39 offen lds
s_add_u32 m0, s38, 51200
s_add_u32 s39, s61, 98304
buffer_load_dwordx4 v84, s[88:91], s39 offen lds
s_add_u32 m0, s38, 52224
s_add_u32 s39, s61, 114688
buffer_load_dwordx4 v84, s[88:91], s39 offen lds
s_add_u32 m0, s38, 65536
s_add_u32 s39, s60, 131072
buffer_load_dwordx4 v84, s[88:91], s39 offen lds
s_add_u32 m0, s38, 66560
s_add_u32 s39, s60, 147456
buffer_load_dwordx4 v84, s[88:91], s39 offen lds
s_add_u32 m0, s38, 67584
s_add_u32 s39, s60, 163840
buffer_load_dwordx4 v84, s[88:91], s39 offen lds
s_add_u32 m0, s38, 68608
s_add_u32 s39, s60, 180224
buffer_load_dwordx4 v84, s[88:91], s39 offen lds
s_add_u32 m0, s38, 81920
s_add_u32 s39, s61, 131072
buffer_load_dwordx4 v84, s[88:91], s39 offen lds
s_add_u32 m0, s38, 82944
s_add_u32 s39, s61, 147456
buffer_load_dwordx4 v84, s[88:91], s39 offen lds
s_add_u32 m0, s38, 83968
s_add_u32 s39, s61, 163840
buffer_load_dwordx4 v84, s[88:91], s39 offen lds
s_add_u32 m0, s38, 84992
s_add_u32 s39, s61, 180224
buffer_load_dwordx4 v84, s[88:91], s39 offen lds
s_add_u32 m0, s38, 98304
s_add_u32 s39, s60, 196608
buffer_load_dwordx4 v84, s[88:91], s39 offen lds
s_add_u32 m0, s38, 99328
s_add_u32 s39, s60, 212992
buffer_load_dwordx4 v84, s[88:91], s39 offen lds
s_add_u32 m0, s38, 100352
s_add_u32 s39, s60, 229376
buffer_load_dwordx4 v84, s[88:91], s39 offen lds
s_add_u32 m0, s38, 101376
s_add_u32 s39, s60, 245760
buffer_load_dwordx4 v84, s[88:91], s39 offen lds
s_add_u32 m0, s38, 114688
s_add_u32 s39, s61, 196608
buffer_load_dwordx4 v84, s[88:91], s39 offen lds
s_add_u32 m0, s38, 115712
s_add_u32 s39, s61, 212992
buffer_load_dwordx4 v84, s[88:91], s39 offen lds
s_add_u32 m0, s38, 116736
s_add_u32 s39, s61, 229376
buffer_load_dwordx4 v84, s[88:91], s39 offen lds
s_add_u32 m0, s38, 117760
s_add_u32 s39, s61, 245760
buffer_load_dwordx4 v84, s[88:91], s39 offen lds
s_waitcnt vmcnt(24)
s_barrier
ds_read_b64_tr_b16 v[128:129], v80 offset:0
ds_read_b64_tr_b16 v[130:131], v80 offset:512
ds_read_b64_tr_b16 v[144:145], v80 offset:4096
ds_read_b64_tr_b16 v[146:147], v80 offset:4608
ds_read_b64_tr_b16 v[160:161], v80 offset:8192
ds_read_b64_tr_b16 v[162:163], v80 offset:8704
ds_read_b64_tr_b16 v[176:177], v80 offset:12288
ds_read_b64_tr_b16 v[178:179], v80 offset:12800
ds_read_b64_tr_b16 v[192:193], v81 offset:0
ds_read_b64_tr_b16 v[194:195], v81 offset:512
ds_read_b64_tr_b16 v[208:209], v81 offset:4096
ds_read_b64_tr_b16 v[210:211], v81 offset:4608
ds_read_b64_tr_b16 v[224:225], v81 offset:8192
ds_read_b64_tr_b16 v[226:227], v81 offset:8704
ds_read_b64_tr_b16 v[240:241], v81 offset:12288
ds_read_b64_tr_b16 v[242:243], v81 offset:12800
v_add_u32 v80, 32768, v80
v_add_u32 v81, 32768, v81
s_waitcnt lgkmcnt(0)
s_barrier
s_waitcnt vmcnt(16)
s_barrier
ds_read_b64_tr_b16 v[132:133], v80 offset:0
ds_read_b64_tr_b16 v[134:135], v80 offset:512
ds_read_b64_tr_b16 v[148:149], v80 offset:4096
ds_read_b64_tr_b16 v[150:151], v80 offset:4608
ds_read_b64_tr_b16 v[164:165], v80 offset:8192
ds_read_b64_tr_b16 v[166:167], v80 offset:8704
ds_read_b64_tr_b16 v[180:181], v80 offset:12288
ds_read_b64_tr_b16 v[182:183], v80 offset:12800
ds_read_b64_tr_b16 v[196:197], v81 offset:0
ds_read_b64_tr_b16 v[198:199], v81 offset:512
ds_read_b64_tr_b16 v[212:213], v81 offset:4096
ds_read_b64_tr_b16 v[214:215], v81 offset:4608
ds_read_b64_tr_b16 v[228:229], v81 offset:8192
ds_read_b64_tr_b16 v[230:231], v81 offset:8704
ds_read_b64_tr_b16 v[244:245], v81 offset:12288
ds_read_b64_tr_b16 v[246:247], v81 offset:12800
v_add_u32 v80, 32768, v80
v_add_u32 v81, 32768, v81
s_waitcnt lgkmcnt(0)
s_barrier
s_waitcnt vmcnt(8)
s_barrier
ds_read_b64_tr_b16 v[136:137], v80 offset:0
ds_read_b64_tr_b16 v[138:139], v80 offset:512
ds_read_b64_tr_b16 v[152:153], v80 offset:4096
ds_read_b64_tr_b16 v[154:155], v80 offset:4608
ds_read_b64_tr_b16 v[168:169], v80 offset:8192
ds_read_b64_tr_b16 v[170:171], v80 offset:8704
ds_read_b64_tr_b16 v[184:185], v80 offset:12288
ds_read_b64_tr_b16 v[186:187], v80 offset:12800
ds_read_b64_tr_b16 v[200:201], v81 offset:0
ds_read_b64_tr_b16 v[202:203], v81 offset:512
ds_read_b64_tr_b16 v[216:217], v81 offset:4096
ds_read_b64_tr_b16 v[218:219], v81 offset:4608
ds_read_b64_tr_b16 v[232:233], v81 offset:8192
ds_read_b64_tr_b16 v[234:235], v81 offset:8704
ds_read_b64_tr_b16 v[248:249], v81 offset:12288
ds_read_b64_tr_b16 v[250:251], v81 offset:12800
v_add_u32 v80, 32768, v80
v_add_u32 v81, 32768, v81
s_waitcnt lgkmcnt(0)
s_barrier
s_waitcnt vmcnt(0)
s_barrier
ds_read_b64_tr_b16 v[140:141], v80 offset:0
ds_read_b64_tr_b16 v[142:143], v80 offset:512
ds_read_b64_tr_b16 v[156:157], v80 offset:4096
ds_read_b64_tr_b16 v[158:159], v80 offset:4608
ds_read_b64_tr_b16 v[172:173], v80 offset:8192
ds_read_b64_tr_b16 v[174:175], v80 offset:8704
ds_read_b64_tr_b16 v[188:189], v80 offset:12288
ds_read_b64_tr_b16 v[190:191], v80 offset:12800
ds_read_b64_tr_b16 v[204:205], v81 offset:0
ds_read_b64_tr_b16 v[206:207], v81 offset:512
ds_read_b64_tr_b16 v[220:221], v81 offset:4096
ds_read_b64_tr_b16 v[222:223], v81 offset:4608
ds_read_b64_tr_b16 v[236:237], v81 offset:8192
ds_read_b64_tr_b16 v[238:239], v81 offset:8704
ds_read_b64_tr_b16 v[252:253], v81 offset:12288
ds_read_b64_tr_b16 v[254:255], v81 offset:12800
v_add_u32 v80, -98304, v80
v_add_u32 v81, -98304, v81
s_waitcnt lgkmcnt(0)
s_barrier
s_mul_i32 s50, s32, 4096
v_lshlrev_b32 v1, 4, v9
v_add_u32 v0, s50, v1
s_mov_b32 s60, s50
v_add_u32 v11, 0x20000, v1
v_mov_b32 v7, v1
v_min_u32 v2, 3, v9
v_lshlrev_b32 v2, 7, v2
v_min_u32 v12, 7, v9
v_lshlrev_b32 v12, 7, v12
s_lshl_b32 s61, s26, 10
s_add_u32 s61, s61, 3416064
s_lshl_b32 s38, s44, 1
s_lshr_b32 s39, s32, 1
s_add_u32 s38, s38, s39
s_lshl_b32 s38, s38, 11
s_and_b32 s39, s32, 1
s_lshl_b32 s39, s39, 9
s_add_u32 s38, s38, s39
v_and_b32 v80, 15, v9
v_lshl_add_u32 v6, v80, 4, s38
v_bfe_u32 v80, v9, 4, 1
v_lshl_add_u32 v6, v80, 10, v6
v_lshrrev_b32 v80, 5, v9
v_lshl_add_u32 v6, v80, 8, v6
s_mov_b32 s49, 100663296
s_mov_b32 s54, 16777216
s_lshl_b32 s59, s26, 15
s_add_u32 s59, s59, 99975168
s_lshl_b32 s38, s62, 2
s_add_u32 s38, s38, s32
s_lshl_b32 s38, s38, 11
s_lshl_b32 s62, s26, 22
s_add_u32 s62, s62, s38
s_add_u32 s62, s62, 134021120
s_mov_b32 s64, 0xbfb8aa3b
v_mov_b32 v100, 0
v_mov_b32 v101, 0
v_mov_b32 v80, -1
v_mov_b32 v81, -1
v_mov_b32 v82, -1
v_mov_b32 v83, -1
s_add_u32 s38, s62, 4128768
buffer_store_dwordx4 v[80:83], v7, s[4:7], s38 offen offset:0 sc1
buffer_store_dwordx4 v[80:83], v7, s[4:7], s38 offen offset:1024 sc1
s_add_u32 s38, s62, 4194304
buffer_store_dwordx4 v[80:83], v7, s[4:7], s38 offen offset:0 sc1
buffer_store_dwordx4 v[80:83], v7, s[4:7], s38 offen offset:1024 sc1
s_add_u32 s38, s62, 4259840
buffer_store_dwordx4 v[80:83], v7, s[4:7], s38 offen offset:0 sc1
buffer_store_dwordx4 v[80:83], v7, s[4:7], s38 offen offset:1024 sc1
s_add_u32 s38, s62, 4325376
buffer_store_dwordx4 v[80:83], v7, s[4:7], s38 offen offset:0 sc1
buffer_store_dwordx4 v[80:83], v7, s[4:7], s38 offen offset:1024 sc1
s_mov_b32 s36, 0
s_add_u32 s48, s36, 0
s_and_b32 s47, s48, 1
s_lshl_b32 s47, s47, 9
s_add_u32 s47, s47, 3423232
s_add_u32 s48, s48, 1
Lfw_624:
Lbw_631:
buffer_load_dword v13, v12, s[4:7], s61 offen sc1
buffer_load_dword v3, v2, s[4:7], s47 offen sc1
s_waitcnt vmcnt(0)
v_cmp_gt_u32 vcc, s48, v3
s_cbranch_vccz Lbo_632
s_sub_u32 s37, s37, 1
s_cbranch_scc1 Lend_7
s_sleep 4
s_branch Lbw_631
Lbo_632:
s_add_u32 m0, s50, 0
s_add_u32 s39, s54, 0
buffer_load_dwordx4 v0, s[4:7], s39 offen offset:0 sc1 lds
buffer_load_dwordx4 v0, s[4:7], s39 offen offset:2048 sc1 lds
s_add_u32 m0, s50, 16384
s_add_u32 s39, s54, 16384
buffer_load_dwordx4 v0, s[4:7], s39 offen offset:0 sc1 lds
buffer_load_dwordx4 v0, s[4:7], s39 offen offset:2048 sc1 lds
s_add_u32 m0, s50, 32768
s_add_u32 s39, s54, 32768
buffer_load_dwordx4 v0, s[4:7], s39 offen offset:0 sc1 lds
buffer_load_dwordx4 v0, s[4:7], s39 offen offset:2048 sc1 lds
s_add_u32 m0, s50, 49152
s_add_u32 s39, s54, 49152
buffer_load_dwordx4 v0, s[4:7], s39 offen offset:0 sc1 lds
buffer_load_dwordx4 v0, s[4:7], s39 offen offset:2048 sc1 lds
s_add_u32 m0, s50, 0
s_add_u32 s39, s54, 0
buffer_load_dwordx4 v0, s[4:7], s39 offen offset:1024 sc1 lds
buffer_load_dwordx4 v0, s[4:7], s39 offen offset:3072 sc1 lds
s_add_u32 m0, s50, 16384
s_add_u32 s39, s54, 16384
buffer_load_dwordx4 v0, s[4:7], s39 offen offset:1024 sc1 lds
buffer_load_dwordx4 v0, s[4:7], s39 offen offset:3072 sc1 lds
s_add_u32 m0, s50, 32768
s_add_u32 s39, s54, 32768
buffer_load_dwordx4 v0, s[4:7], s39 offen offset:1024 sc1 lds
buffer_load_dwordx4 v0, s[4:7], s39 offen offset:3072 sc1 lds
s_add_u32 m0, s50, 49152
s_add_u32 s39, s54, 49152
buffer_load_dwordx4 v0, s[4:7], s39 offen offset:1024 sc1 lds
buffer_load_dwordx4 v0, s[4:7], s39 offen offset:3072 sc1 lds
s_waitcnt vmcnt(8)
Lfe_629:
s_mov_b32 s58, 0x70000000
s_barrier
ds_read_b128 v[16:19], v1 offset:0
ds_read_b128 v[20:23], v1 offset:2048
ds_read_b128 v[24:27], v1 offset:4096
ds_read_b128 v[28:31], v1 offset:6144
ds_read_b128 v[32:35], v1 offset:8192
ds_read_b128 v[36:39], v1 offset:10240
ds_read_b128 v[40:43], v1 offset:12288
Lfb_623:
s_waitcnt lgkmcnt(5)
v_mfma_f32_16x16x32_bf16 v[48:51], a[0:3], v[16:19], 0
s_sub_u32 s57, s36, 2
ds_read_b128 v[44:47], v1 offset:14336
s_max_i32 s57, s57, 0
v_mfma_f32_16x16x32_bf16 v[56:59], a[128:131], v[16:19], 0
v_cmp_gt_u32 vcc, s57, v13
v_mfma_f32_16x16x32_bf16 v[48:51], a[4:7], v[20:23], v[48:51]
ds_read_b128 v[16:19], v1 offset:16384
v_mfma_f32_16x16x32_bf16 v[56:59], a[132:135], v[20:23], v[56:59]
s_waitcnt lgkmcnt(5)
s_cmp_eq_u64 vcc, 0
s_cselect_b32 s56, 1, 0
v_mfma_f32_16x16x32_bf16 v[48:51], a[8:11], v[24:27], v[48:51]
s_cselect_b32 s55, s59, 0x70000000
ds_read_b128 v[20:23], v1 offset:18432
s_add_u32 s48, s36, 1
v_mfma_f32_16x16x32_bf16 v[56:59], a[136:139], v[24:27], v[56:59]
s_and_b32 s47, s48, 1
s_lshl_b32 s47, s47, 9
s_add_u32 s47, s47, 3423232
v_mfma_f32_16x16x32_bf16 v[48:51], a[12:15], v[28:31], v[48:51]
s_add_u32 s48, s48, 1
ds_read_b128 v[24:27], v1 offset:20480
buffer_load_dword v3, v2, s[4:7], s47 offen sc1
v_mfma_f32_16x16x32_bf16 v[56:59], a[140:143], v[28:31], v[56:59]
s_waitcnt lgkmcnt(5)
s_add_u32 s54, s54, 65536
s_xor_b32 s50, s50, 0x10000
v_mfma_f32_16x16x32_bf16 v[48:51], a[16:19], v[32:35], v[48:51]
s_add_u32 m0, s60, 131072
ds_read_b128 v[28:31], v1 offset:22528
s_add_u32 s39, s55, 0
v_mfma_f32_16x16x32_bf16 v[56:59], a[144:147], v[32:35], v[56:59]
buffer_load_dwordx4 v0, s[4:7], s39 offen offset:0 sc1 lds
v_mfma_f32_16x16x32_bf16 v[48:51], a[20:23], v[36:39], v[48:51]
ds_read_b128 v[32:35], v1 offset:24576
v_cvt_pk_bf16_f32 v80, v64, v65
v_mfma_f32_16x16x32_bf16 v[56:59], a[148:151], v[36:39], v[56:59]
s_waitcnt lgkmcnt(5)
v_cvt_pk_bf16_f32 v81, v66, v67
v_cvt_pk_bf16_f32 v82, v68, v69
v_mfma_f32_16x16x32_bf16 v[48:51], a[24:27], v[40:43], v[48:51]
ds_read_b128 v[36:39], v1 offset:26624
v_cvt_pk_bf16_f32 v83, v70, v71
v_mfma_f32_16x16x32_bf16 v[56:59], a[152:155], v[40:43], v[56:59]
v_cvt_pk_bf16_f32 v84, v72, v73
v_cvt_pk_bf16_f32 v85, v74, v75
v_mfma_f32_16x16x32_bf16 v[48:51], a[28:31], v[44:47], v[48:51]
ds_read_b128 v[40:43], v1 offset:28672
v_cvt_pk_bf16_f32 v86, v76, v77
v_mfma_f32_16x16x32_bf16 v[56:59], a[156:159], v[44:47], v[56:59]
s_waitcnt lgkmcnt(5)
v_cvt_pk_bf16_f32 v87, v78, v79
v_mfma_f32_16x16x32_bf16 v[48:51], a[32:35], v[16:19], v[48:51]
ds_read_b128 v[44:47], v1 offset:30720
v_mfma_f32_16x16x32_bf16 v[56:59], a[160:163], v[16:19], v[56:59]
buffer_load_dwordx4 v0, s[4:7], s39 offen offset:1024 sc1 lds
v_mfma_f32_16x16x32_bf16 v[48:51], a[36:39], v[20:23], v[48:51]
ds_read_b128 v[16:19], v1 offset:32768
v_mfma_f32_16x16x32_bf16 v[56:59], a[164:167], v[20:23], v[56:59]
s_waitcnt lgkmcnt(5)
v_mfma_f32_16x16x32_bf16 v[48:51], a[40:43], v[24:27], v[48:51]
ds_read_b128 v[20:23], v1 offset:34816
v_mfma_f32_16x16x32_bf16 v[56:59], a[168:171], v[24:27], v[56:59]
v_mfma_f32_16x16x32_bf16 v[48:51], a[44:47], v[28:31], v[48:51]
ds_read_b128 v[24:27], v1 offset:36864
v_mfma_f32_16x16x32_bf16 v[56:59], a[172:175], v[28:31], v[56:59]
s_waitcnt lgkmcnt(5)
v_mfma_f32_16x16x32_bf16 v[48:51], a[48:51], v[32:35], v[48:51]
ds_read_b128 v[28:31], v1 offset:38912
v_mfma_f32_16x16x32_bf16 v[56:59], a[176:179], v[32:35], v[56:59]
buffer_load_dwordx4 v0, s[4:7], s39 offen offset:2048 sc1 lds
v_mfma_f32_16x16x32_bf16 v[48:51], a[52:55], v[36:39], v[48:51]
ds_read_b128 v[32:35], v1 offset:40960
v_mfma_f32_16x16x32_bf16 v[56:59], a[180:183], v[36:39], v[56:59]
s_waitcnt lgkmcnt(5)
v_mfma_f32_16x16x32_bf16 v[48:51], a[56:59], v[40:43], v[48:51]
ds_read_b128 v[36:39], v1 offset:43008
v_mfma_f32_16x16x32_bf16 v[56:59], a[184:187], v[40:43], v[56:59]
v_mfma_f32_16x16x32_bf16 v[48:51], a[60:63], v[44:47], v[48:51]
ds_read_b128 v[40:43], v1 offset:45056
v_mfma_f32_16x16x32_bf16 v[56:59], a[188:191], v[44:47], v[56:59]
s_waitcnt lgkmcnt(5)
v_mfma_f32_16x16x32_bf16 v[48:51], a[64:67], v[16:19], v[48:51]
ds_read_b128 v[44:47], v1 offset:47104
v_mfma_f32_16x16x32_bf16 v[56:59], a[192:195], v[16:19], v[56:59]
buffer_load_dwordx4 v0, s[4:7], s39 offen offset:3072 sc1 lds
s_add_u32 m0, s60, 147456
v_mfma_f32_16x16x32_bf16 v[48:51], a[68:71], v[20:23], v[48:51]
s_add_u32 s39, s55, 16384
ds_read_b128 v[16:19], v1 offset:49152
v_mfma_f32_16x16x32_bf16 v[56:59], a[196:199], v[20:23], v[56:59]
s_waitcnt lgkmcnt(5)
v_mfma_f32_16x16x32_bf16 v[48:51], a[72:75], v[24:27], v[48:51]
ds_read_b128 v[20:23], v1 offset:51200
v_mfma_f32_16x16x32_bf16 v[56:59], a[200:203], v[24:27], v[56:59]
v_mfma_f32_16x16x32_bf16 v[48:51], a[76:79], v[28:31], v[48:51]
ds_read_b128 v[24:27], v1 offset:53248
v_mfma_f32_16x16x32_bf16 v[56:59], a[204:207], v[28:31], v[56:59]
s_waitcnt lgkmcnt(5)
v_mfma_f32_16x16x32_bf16 v[48:51], a[80:83], v[32:35], v[48:51]
ds_read_b128 v[28:31], v1 offset:55296
v_mfma_f32_16x16x32_bf16 v[56:59], a[208:211], v[32:35], v[56:59]
buffer_load_dwordx4 v0, s[4:7], s39 offen offset:0 sc1 lds
v_mfma_f32_16x16x32_bf16 v[48:51], a[84:87], v[36:39], v[48:51]
ds_read_b128 v[32:35], v1 offset:57344
v_mfma_f32_16x16x32_bf16 v[56:59], a[212:215], v[36:39], v[56:59]
s_waitcnt lgkmcnt(5)
v_mfma_f32_16x16x32_bf16 v[48:51], a[88:91], v[40:43], v[48:51]
ds_read_b128 v[36:39], v1 offset:59392
v_mfma_f32_16x16x32_bf16 v[56:59], a[216:219], v[40:43], v[56:59]
v_mfma_f32_16x16x32_bf16 v[48:51], a[92:95], v[44:47], v[48:51]
ds_read_b128 v[40:43], v1 offset:61440
v_mfma_f32_16x16x32_bf16 v[56:59], a[220:223], v[44:47], v[56:59]
s_waitcnt lgkmcnt(5)
v_mfma_f32_16x16x32_bf16 v[48:51], a[96:99], v[16:19], v[48:51]
ds_read_b128 v[44:47], v1 offset:63488
v_mfma_f32_16x16x32_bf16 v[56:59], a[224:227], v[16:19], v[56:59]
v_mfma_f32_16x16x32_bf16 v[48:51], a[100:103], v[20:23], v[48:51]
s_waitcnt vmcnt(6)
s_barrier
ds_read_b128 v[16:19], v1 offset:1024
v_mfma_f32_16x16x32_bf16 v[56:59], a[228:231], v[20:23], v[56:59]
s_waitcnt lgkmcnt(5)
v_min_u32 v100, s36, 64
s_sub_u32 s38, s36, 4
v_mfma_f32_16x16x32_bf16 v[48:51], a[104:107], v[24:27], v[48:51]
ds_read_b128 v[20:23], v1 offset:3072
v_max_i32 v101, s38, 0
v_mfma_f32_16x16x32_bf16 v[56:59], a[232:235], v[24:27], v[56:59]
buffer_store_dwordx2 v[100:101], v4, s[4:7], 0 offen sc1
v_mfma_f32_16x16x32_bf16 v[48:51], a[108:111], v[28:31], v[48:51]
ds_read_b128 v[24:27], v1 offset:5120
v_mfma_f32_16x16x32_bf16 v[56:59], a[236:239], v[28:31], v[56:59]
s_waitcnt lgkmcnt(5)
v_mfma_f32_16x16x32_bf16 v[48:51], a[112:115], v[32:35], v[48:51]
ds_read_b128 v[28:31], v1 offset:7168
buffer_load_dwordx4 v0, s[4:7], s39 offen offset:1024 sc1 lds
v_mfma_f32_16x16x32_bf16 v[56:59], a[240:243], v[32:35], v[56:59]
v_mfma_f32_16x16x32_bf16 v[48:51], a[116:119], v[36:39], v[48:51]
ds_read_b128 v[32:35], v1 offset:9216
v_mfma_f32_16x16x32_bf16 v[56:59], a[244:247], v[36:39], v[56:59]
s_waitcnt lgkmcnt(5)
v_mfma_f32_16x16x32_bf16 v[48:51], a[120:123], v[40:43], v[48:51]
s_waitcnt vmcnt(7)
ds_read_b128 v[36:39], v1 offset:11264
v_cmp_gt_u32 vcc, s48, v3
v_mfma_f32_16x16x32_bf16 v[56:59], a[248:251], v[40:43], v[56:59]
v_mfma_f32_16x16x32_bf16 v[48:51], a[124:127], v[44:47], v[48:51]
ds_read_b128 v[40:43], v1 offset:13312
buffer_load_dwordx4 v0, s[4:7], s39 offen offset:2048 sc1 lds
v_mfma_f32_16x16x32_bf16 v[56:59], a[252:255], v[44:47], v[56:59]
s_waitcnt lgkmcnt(5)
s_cmp_eq_u64 vcc, 0
s_cselect_b32 s46, 1, 0
v_mfma_f32_16x16x32_bf16 v[52:55], a[0:3], v[16:19], 0
s_cselect_b32 s45, s54, 0x70000000
ds_read_b128 v[44:47], v1 offset:15360
v_cmp_gt_u32 vcc, 62, v13
v_mfma_f32_16x16x32_bf16 v[60:63], a[128:131], v[16:19], 0
s_add_u32 s52, s59, 229376
v_mfma_f32_16x16x32_bf16 v[52:55], a[4:7], v[20:23], v[52:55]
ds_read_b128 v[16:19], v1 offset:17408
v_mfma_f32_16x16x32_bf16 v[60:63], a[132:135], v[20:23], v[60:63]
s_waitcnt lgkmcnt(5)
s_cmp_eq_u64 vcc, 0
s_cselect_b32 s52, s52, 0x70000000
v_mfma_f32_16x16x32_bf16 v[52:55], a[8:11], v[24:27], v[52:55]
ds_read_b128 v[20:23], v1 offset:19456
buffer_load_dwordx4 v0, s[4:7], s39 offen offset:3072 sc1 lds
v_mfma_f32_16x16x32_bf16 v[60:63], a[136:139], v[24:27], v[60:63]
s_cmp_eq_u32 s36, 63
s_cselect_b32 s45, s52, s45
v_mfma_f32_16x16x32_bf16 v[52:55], a[12:15], v[28:31], v[52:55]
s_add_u32 m0, s50, 0
ds_read_b128 v[24:27], v1 offset:21504
s_add_u32 s39, s45, 0
v_mfma_f32_16x16x32_bf16 v[60:63], a[140:143], v[28:31], v[60:63]
s_waitcnt lgkmcnt(5)
buffer_load_dwordx4 v0, s[4:7], s39 offen offset:0 sc1 lds
v_mfma_f32_16x16x32_bf16 v[52:55], a[16:19], v[32:35], v[52:55]
ds_read_b128 v[28:31], v1 offset:23552
v_mul_f32 v88, s64, v48
v_mfma_f32_16x16x32_bf16 v[60:63], a[144:147], v[32:35], v[60:63]
v_mul_f32 v89, s64, v49
v_mul_f32 v90, s64, v50
v_mfma_f32_16x16x32_bf16 v[52:55], a[20:23], v[36:39], v[52:55]
ds_read_b128 v[32:35], v1 offset:25600
v_mul_f32 v91, s64, v51
v_mfma_f32_16x16x32_bf16 v[60:63], a[148:151], v[36:39], v[60:63]
s_waitcnt lgkmcnt(5)
v_exp_f32 v88, v88
v_mfma_f32_16x16x32_bf16 v[52:55], a[24:27], v[40:43], v[52:55]
ds_read_b128 v[36:39], v1 offset:27648
v_mfma_f32_16x16x32_bf16 v[60:63], a[152:155], v[40:43], v[60:63]
v_exp_f32 v89, v89
v_mfma_f32_16x16x32_bf16 v[52:55], a[28:31], v[44:47], v[52:55]
ds_read_b128 v[40:43], v1 offset:29696
v_mfma_f32_16x16x32_bf16 v[60:63], a[156:159], v[44:47], v[60:63]
s_waitcnt lgkmcnt(5)
buffer_load_dwordx4 v0, s[4:7], s39 offen offset:2048 sc1 lds
s_add_u32 m0, s50, 16384
v_mfma_f32_16x16x32_bf16 v[52:55], a[32:35], v[16:19], v[52:55]
s_add_u32 s39, s45, 16384
ds_read_b128 v[44:47], v1 offset:31744
v_mfma_f32_16x16x32_bf16 v[60:63], a[160:163], v[16:19], v[60:63]
v_exp_f32 v90, v90
v_mfma_f32_16x16x32_bf16 v[52:55], a[36:39], v[20:23], v[52:55]
ds_read_b128 v[16:19], v1 offset:33792
v_mfma_f32_16x16x32_bf16 v[60:63], a[164:167], v[20:23], v[60:63]
s_waitcnt lgkmcnt(5)
v_exp_f32 v91, v91
v_mfma_f32_16x16x32_bf16 v[52:55], a[40:43], v[24:27], v[52:55]
ds_read_b128 v[20:23], v1 offset:35840
v_mul_f32 v104, v48, v56
v_mfma_f32_16x16x32_bf16 v[60:63], a[168:171], v[24:27], v[60:63]
v_mul_f32 v105, v49, v57
v_mul_f32 v106, v50, v58
v_mfma_f32_16x16x32_bf16 v[52:55], a[44:47], v[28:31], v[52:55]
ds_read_b128 v[24:27], v1 offset:37888
v_mul_f32 v107, v51, v59
v_mfma_f32_16x16x32_bf16 v[60:63], a[172:175], v[28:31], v[60:63]
s_waitcnt lgkmcnt(5)
buffer_load_dwordx4 v0, s[4:7], s39 offen offset:0 sc1 lds
v_add_f32 v88, 1.0, v88
v_mfma_f32_16x16x32_bf16 v[52:55], a[48:51], v[32:35], v[52:55]
ds_read_b128 v[28:31], v1 offset:39936
v_add_f32 v89, 1.0, v89
v_mfma_f32_16x16x32_bf16 v[60:63], a[176:179], v[32:35], v[60:63]
v_add_f32 v90, 1.0, v90
v_add_f32 v91, 1.0, v91
v_mfma_f32_16x16x32_bf16 v[52:55], a[52:55], v[36:39], v[52:55]
ds_read_b128 v[32:35], v1 offset:41984
v_mfma_f32_16x16x32_bf16 v[60:63], a[180:183], v[36:39], v[60:63]
s_waitcnt lgkmcnt(5)
v_rcp_f32 v88, v88
v_mfma_f32_16x16x32_bf16 v[52:55], a[56:59], v[40:43], v[52:55]
ds_read_b128 v[36:39], v1 offset:44032
v_mfma_f32_16x16x32_bf16 v[60:63], a[184:187], v[40:43], v[60:63]
v_rcp_f32 v89, v89
v_mfma_f32_16x16x32_bf16 v[52:55], a[60:63], v[44:47], v[52:55]
ds_read_b128 v[40:43], v1 offset:46080
v_mfma_f32_16x16x32_bf16 v[60:63], a[188:191], v[44:47], v[60:63]
s_waitcnt lgkmcnt(5)
buffer_load_dwordx4 v0, s[4:7], s39 offen offset:2048 sc1 lds
s_add_u32 m0, s50, 32768
v_mfma_f32_16x16x32_bf16 v[52:55], a[64:67], v[16:19], v[52:55]
s_add_u32 s39, s45, 32768
ds_read_b128 v[44:47], v1 offset:48128
v_mfma_f32_16x16x32_bf16 v[60:63], a[192:195], v[16:19], v[60:63]
v_rcp_f32 v90, v90
v_mfma_f32_16x16x32_bf16 v[52:55], a[68:71], v[20:23], v[52:55]
ds_read_b128 v[16:19], v1 offset:50176
v_mfma_f32_16x16x32_bf16 v[60:63], a[196:199], v[20:23], v[60:63]
s_waitcnt lgkmcnt(5)
v_rcp_f32 v91, v91
v_mfma_f32_16x16x32_bf16 v[52:55], a[72:75], v[24:27], v[52:55]
ds_read_b128 v[20:23], v1 offset:52224
v_mul_f32 v104, v104, v88
v_mfma_f32_16x16x32_bf16 v[60:63], a[200:203], v[24:27], v[60:63]
v_mul_f32 v105, v105, v89
v_mul_f32 v106, v106, v90
v_mfma_f32_16x16x32_bf16 v[52:55], a[76:79], v[28:31], v[52:55]
ds_read_b128 v[24:27], v1 offset:54272
v_mul_f32 v107, v107, v91
v_mfma_f32_16x16x32_bf16 v[60:63], a[204:207], v[28:31], v[60:63]
s_waitcnt lgkmcnt(5)
buffer_load_dwordx4 v0, s[4:7], s39 offen offset:0 sc1 lds
v_mfma_f32_16x16x32_bf16 v[52:55], a[80:83], v[32:35], v[52:55]
ds_read_b128 v[28:31], v1 offset:56320
v_mfma_f32_16x16x32_bf16 v[60:63], a[208:211], v[32:35], v[60:63]
v_mfma_f32_16x16x32_bf16 v[52:55], a[84:87], v[36:39], v[52:55]
ds_read_b128 v[32:35], v1 offset:58368
v_mfma_f32_16x16x32_bf16 v[60:63], a[212:215], v[36:39], v[60:63]
s_waitcnt lgkmcnt(5)
v_mfma_f32_16x16x32_bf16 v[52:55], a[88:91], v[40:43], v[52:55]
ds_read_b128 v[36:39], v1 offset:60416
v_mfma_f32_16x16x32_bf16 v[60:63], a[216:219], v[40:43], v[60:63]
v_mfma_f32_16x16x32_bf16 v[52:55], a[92:95], v[44:47], v[52:55]
ds_read_b128 v[40:43], v1 offset:62464
v_mfma_f32_16x16x32_bf16 v[60:63], a[220:223], v[44:47], v[60:63]
s_waitcnt lgkmcnt(5)
buffer_load_dwordx4 v0, s[4:7], s39 offen offset:2048 sc1 lds
v_mfma_f32_16x16x32_bf16 v[52:55], a[96:99], v[16:19], v[52:55]
ds_read_b128 v[44:47], v1 offset:64512
v_mfma_f32_16x16x32_bf16 v[60:63], a[224:227], v[16:19], v[60:63]
v_mfma_f32_16x16x32_bf16 v[52:55], a[100:103], v[20:23], v[52:55]
v_mfma_f32_16x16x32_bf16 v[60:63], a[228:231], v[20:23], v[60:63]
s_waitcnt lgkmcnt(4)
v_mfma_f32_16x16x32_bf16 v[52:55], a[104:107], v[24:27], v[52:55]
v_mfma_f32_16x16x32_bf16 v[60:63], a[232:235], v[24:27], v[60:63]
s_cmp_eq_u32 s56, 0
s_cbranch_scc1 Lfl_625
s_waitcnt vmcnt(6) lgkmcnt(0)
Lfg_626:
s_barrier
v_mfma_f32_16x16x32_bf16 v[52:55], a[108:111], v[28:31], v[52:55]
ds_read_b128 v[16:19], v11 offset:0
ds_read_b128 v[20:23], v11 offset:1024
v_mfma_f32_16x16x32_bf16 v[60:63], a[236:239], v[28:31], v[60:63]
s_add_u32 m0, s50, 49152
ds_read_b128 v[24:27], v11 offset:2048
s_add_u32 s39, s45, 49152
v_mfma_f32_16x16x32_bf16 v[52:55], a[112:115], v[32:35], v[52:55]
ds_read_b128 v[28:31], v11 offset:3072
buffer_load_dwordx4 v0, s[4:7], s39 offen offset:0 sc1 lds
v_mfma_f32_16x16x32_bf16 v[60:63], a[240:243], v[32:35], v[60:63]
v_mfma_f32_16x16x32_bf16 v[52:55], a[116:119], v[36:39], v[52:55]
ds_read_b128 v[32:35], v11 offset:4096
buffer_load_dword v3, v2, s[4:7], s47 offen sc1
v_mfma_f32_16x16x32_bf16 v[60:63], a[244:247], v[36:39], v[60:63]
buffer_load_dword v13, v12, s[4:7], s61 offen sc1
v_mfma_f32_16x16x32_bf16 v[52:55], a[120:123], v[40:43], v[52:55]
ds_read_b128 v[36:39], v11 offset:5120
v_xor_b32 v1, 0x10000, v1
v_mfma_f32_16x16x32_bf16 v[60:63], a[248:251], v[40:43], v[60:63]
v_mfma_f32_16x16x32_bf16 v[52:55], a[124:127], v[44:47], v[52:55]
ds_read_b128 v[40:43], v11 offset:6144
buffer_load_dwordx4 v0, s[4:7], s39 offen offset:2048 sc1 lds
v_mfma_f32_16x16x32_bf16 v[60:63], a[252:255], v[44:47], v[60:63]
s_waitcnt lgkmcnt(5)
v_mfma_f32_16x16x32_bf16 v[64:67], v[128:131], v[16:19], 0
s_add_u32 m0, s50, 0
ds_read_b128 v[44:47], v11 offset:7168
s_add_u32 s39, s45, 0
v_mfma_f32_16x16x32_bf16 v[68:71], v[192:195], v[16:19], 0
buffer_load_dwordx4 v0, s[4:7], s39 offen offset:1024 sc1 lds
v_mfma_f32_16x16x32_bf16 v[72:75], v[128:131], v[20:23], 0
ds_read_b128 v[16:19], v11 offset:8192
v_mfma_f32_16x16x32_bf16 v[76:79], v[192:195], v[20:23], 0
s_waitcnt lgkmcnt(5)
buffer_store_dwordx4 v[80:83], v7, s[4:7], s58 offen offset:0 sc1
v_mfma_f32_16x16x32_bf16 v[64:67], v[132:135], v[24:27], v[64:67]
ds_read_b128 v[20:23], v11 offset:9216
v_mfma_f32_16x16x32_bf16 v[68:71], v[196:199], v[24:27], v[68:71]
v_mfma_f32_16x16x32_bf16 v[72:75], v[132:135], v[28:31], v[72:75]
ds_read_b128 v[24:27], v11 offset:10240
v_mfma_f32_16x16x32_bf16 v[76:79], v[196:199], v[28:31], v[76:79]
s_waitcnt lgkmcnt(5)
buffer_store_dwordx4 v[84:87], v7, s[4:7], s58 offen offset:1024 sc1
v_mfma_f32_16x16x32_bf16 v[64:67], v[136:139], v[32:35], v[64:67]
ds_read_b128 v[28:31], v11 offset:11264
v_mul_f32 v88, s64, v52
v_mfma_f32_16x16x32_bf16 v[68:71], v[200:203], v[32:35], v[68:71]
buffer_load_dwordx4 v0, s[4:7], s39 offen offset:3072 sc1 lds
s_add_u32 m0, s50, 16384
v_mfma_f32_16x16x32_bf16 v[72:75], v[136:139], v[36:39], v[72:75]
s_add_u32 s39, s45, 16384
ds_read_b128 v[32:35], v11 offset:12288
v_mul_f32 v89, s64, v53
v_mfma_f32_16x16x32_bf16 v[76:79], v[200:203], v[36:39], v[76:79]
s_waitcnt lgkmcnt(5)
v_mul_f32 v90, s64, v54
v_mul_f32 v91, s64, v55
v_mfma_f32_16x16x32_bf16 v[64:67], v[140:143], v[40:43], v[64:67]
ds_read_b128 v[36:39], v11 offset:13312
v_mfma_f32_16x16x32_bf16 v[68:71], v[204:207], v[40:43], v[68:71]
v_exp_f32 v88, v88
v_mfma_f32_16x16x32_bf16 v[72:75], v[140:143], v[44:47], v[72:75]
ds_read_b128 v[40:43], v11 offset:14336
v_mfma_f32_16x16x32_bf16 v[76:79], v[204:207], v[44:47], v[76:79]
s_waitcnt lgkmcnt(5)
v_exp_f32 v89, v89
v_mfma_f32_16x16x32_bf16 v[64:67], v[144:147], v[16:19], v[64:67]
ds_read_b128 v[44:47], v11 offset:15360
v_mfma_f32_16x16x32_bf16 v[68:71], v[208:211], v[16:19], v[68:71]
buffer_load_dwordx4 v0, s[4:7], s39 offen offset:1024 sc1 lds
v_mfma_f32_16x16x32_bf16 v[72:75], v[144:147], v[20:23], v[72:75]
ds_read_b128 v[16:19], v11 offset:16384
v_mfma_f32_16x16x32_bf16 v[76:79], v[208:211], v[20:23], v[76:79]
s_waitcnt lgkmcnt(5)
v_exp_f32 v90, v90
v_mfma_f32_16x16x32_bf16 v[64:67], v[148:151], v[24:27], v[64:67]
ds_read_b128 v[20:23], v11 offset:17408
v_mfma_f32_16x16x32_bf16 v[68:71], v[212:215], v[24:27], v[68:71]
v_exp_f32 v91, v91
v_mfma_f32_16x16x32_bf16 v[72:75], v[148:151], v[28:31], v[72:75]
ds_read_b128 v[24:27], v11 offset:18432
v_mul_f32 v108, v52, v60
v_mfma_f32_16x16x32_bf16 v[76:79], v[212:215], v[28:31], v[76:79]
s_waitcnt lgkmcnt(5)
v_mul_f32 v109, v53, v61
v_mul_f32 v110, v54, v62
v_mfma_f32_16x16x32_bf16 v[64:67], v[152:155], v[32:35], v[64:67]
ds_read_b128 v[28:31], v11 offset:19456
v_mul_f32 v111, v55, v63
v_mfma_f32_16x16x32_bf16 v[68:71], v[216:219], v[32:35], v[68:71]
buffer_load_dwordx4 v0, s[4:7], s39 offen offset:3072 sc1 lds
s_add_u32 m0, s50, 32768
v_mfma_f32_16x16x32_bf16 v[72:75], v[152:155], v[36:39], v[72:75]
s_add_u32 s39, s45, 32768
ds_read_b128 v[32:35], v11 offset:20480
v_add_f32 v88, 1.0, v88
v_mfma_f32_16x16x32_bf16 v[76:79], v[216:219], v[36:39], v[76:79]
s_waitcnt lgkmcnt(5)
v_add_f32 v89, 1.0, v89
v_add_f32 v90, 1.0, v90
v_mfma_f32_16x16x32_bf16 v[64:67], v[156:159], v[40:43], v[64:67]
ds_read_b128 v[36:39], v11 offset:21504
v_add_f32 v91, 1.0, v91
v_mfma_f32_16x16x32_bf16 v[68:71], v[220:223], v[40:43], v[68:71]
v_rcp_f32 v88, v88
v_mfma_f32_16x16x32_bf16 v[72:75], v[156:159], v[44:47], v[72:75]
ds_read_b128 v[40:43], v11 offset:22528
v_mfma_f32_16x16x32_bf16 v[76:79], v[220:223], v[44:47], v[76:79]
s_waitcnt lgkmcnt(5)
v_rcp_f32 v89, v89
v_mfma_f32_16x16x32_bf16 v[64:67], v[160:163], v[16:19], v[64:67]
ds_read_b128 v[44:47], v11 offset:23552
v_mfma_f32_16x16x32_bf16 v[68:71], v[224:227], v[16:19], v[68:71]
buffer_load_dwordx4 v0, s[4:7], s39 offen offset:1024 sc1 lds
v_mfma_f32_16x16x32_bf16 v[72:75], v[160:163], v[20:23], v[72:75]
ds_read_b128 v[16:19], v11 offset:24576
v_mfma_f32_16x16x32_bf16 v[76:79], v[224:227], v[20:23], v[76:79]
s_waitcnt lgkmcnt(5)
v_rcp_f32 v90, v90
v_mfma_f32_16x16x32_bf16 v[64:67], v[164:167], v[24:27], v[64:67]
ds_read_b128 v[20:23], v11 offset:25600
v_mfma_f32_16x16x32_bf16 v[68:71], v[228:231], v[24:27], v[68:71]
v_rcp_f32 v91, v91
v_mfma_f32_16x16x32_bf16 v[72:75], v[164:167], v[28:31], v[72:75]
ds_read_b128 v[24:27], v11 offset:26624
v_mul_f32 v108, v108, v88
v_mfma_f32_16x16x32_bf16 v[76:79], v[228:231], v[28:31], v[76:79]
s_waitcnt lgkmcnt(5)
v_mul_f32 v109, v109, v89
v_mul_f32 v110, v110, v90
v_mfma_f32_16x16x32_bf16 v[64:67], v[168:171], v[32:35], v[64:67]
ds_read_b128 v[28:31], v11 offset:27648
v_mul_f32 v111, v111, v91
v_mfma_f32_16x16x32_bf16 v[68:71], v[232:235], v[32:35], v[68:71]
buffer_load_dwordx4 v0, s[4:7], s39 offen offset:3072 sc1 lds
s_add_u32 m0, s50, 49152
v_mfma_f32_16x16x32_bf16 v[72:75], v[168:171], v[36:39], v[72:75]
s_add_u32 s39, s45, 49152
ds_read_b128 v[32:35], v11 offset:28672
v_cvt_pk_bf16_f32 v96, v104, v105
v_mfma_f32_16x16x32_bf16 v[76:79], v[232:235], v[36:39], v[76:79]
s_waitcnt lgkmcnt(5)
v_cvt_pk_bf16_f32 v97, v106, v107
v_cvt_pk_bf16_f32 v98, v108, v109
v_mfma_f32_16x16x32_bf16 v[64:67], v[172:175], v[40:43], v[64:67]
ds_read_b128 v[36:39], v11 offset:29696
v_cvt_pk_bf16_f32 v99, v110, v111
v_mfma_f32_16x16x32_bf16 v[68:71], v[236:239], v[40:43], v[68:71]
v_mfma_f32_16x16x32_bf16 v[72:75], v[172:175], v[44:47], v[72:75]
ds_read_b128 v[40:43], v11 offset:30720
v_permlane16_swap_b32 v96, v98
v_mfma_f32_16x16x32_bf16 v[76:79], v[236:239], v[44:47], v[76:79]
s_waitcnt lgkmcnt(5)
v_permlane16_swap_b32 v97, v99
v_mfma_f32_16x16x32_bf16 v[64:67], v[176:179], v[16:19], v[64:67]
ds_read_b128 v[44:47], v11 offset:31744
v_mfma_f32_16x16x32_bf16 v[68:71], v[240:243], v[16:19], v[68:71]
buffer_load_dwordx4 v0, s[4:7], s39 offen offset:1024 sc1 lds
v_mfma_f32_16x16x32_bf16 v[72:75], v[176:179], v[20:23], v[72:75]
buffer_store_dwordx4 v[96:99], v6, s[4:7], s49 offen sc1
v_mfma_f32_16x16x32_bf16 v[76:79], v[240:243], v[20:23], v[76:79]
s_waitcnt lgkmcnt(4)
s_cmp_ge_u32 s36, 3
s_cselect_b32 s58, s62, 0x70000000
v_mfma_f32_16x16x32_bf16 v[64:67], v[180:183], v[24:27], v[64:67]
s_add_u32 s49, s49, 229376
s_add_u32 s62, s62, 65536
s_add_u32 s59, s59, 229376
v_mfma_f32_16x16x32_bf16 v[68:71], v[244:247], v[24:27], v[68:71]
s_add_u32 s36, s36, 1
s_cmp_eq_u32 s46, 0
s_waitcnt vmcnt(10) lgkmcnt(0)
s_cbranch_scc1 Lfs_627
s_barrier
v_mfma_f32_16x16x32_bf16 v[72:75], v[180:183], v[28:31], v[72:75]
ds_read_b128 v[16:19], v1 offset:0
ds_read_b128 v[20:23], v1 offset:2048
v_mfma_f32_16x16x32_bf16 v[76:79], v[244:247], v[28:31], v[76:79]
ds_read_b128 v[24:27], v1 offset:4096
v_mfma_f32_16x16x32_bf16 v[64:67], v[184:187], v[32:35], v[64:67]
ds_read_b128 v[28:31], v1 offset:6144
v_mfma_f32_16x16x32_bf16 v[68:71], v[248:251], v[32:35], v[68:71]
v_mfma_f32_16x16x32_bf16 v[72:75], v[184:187], v[36:39], v[72:75]
ds_read_b128 v[32:35], v1 offset:8192
v_mfma_f32_16x16x32_bf16 v[76:79], v[248:251], v[36:39], v[76:79]
buffer_load_dwordx4 v0, s[4:7], s39 offen offset:3072 sc1 lds
v_mfma_f32_16x16x32_bf16 v[64:67], v[188:191], v[40:43], v[64:67]
ds_read_b128 v[36:39], v1 offset:10240
v_mfma_f32_16x16x32_bf16 v[68:71], v[252:255], v[40:43], v[68:71]
v_mfma_f32_16x16x32_bf16 v[72:75], v[188:191], v[44:47], v[72:75]
ds_read_b128 v[40:43], v1 offset:12288
v_mfma_f32_16x16x32_bf16 v[76:79], v[252:255], v[44:47], v[76:79]
s_branch Lfb_623
Lfs_627:
v_cmp_gt_u32 vcc, s48, v3
s_cbranch_vccnz Lfd_630
s_add_u32 m0, s50, 0
s_add_u32 s39, s54, 0
buffer_load_dwordx4 v0, s[4:7], s39 offen offset:0 sc1 lds
buffer_load_dwordx4 v0, s[4:7], s39 offen offset:2048 sc1 lds
s_add_u32 m0, s50, 16384
s_add_u32 s39, s54, 16384
buffer_load_dwordx4 v0, s[4:7], s39 offen offset:0 sc1 lds
buffer_load_dwordx4 v0, s[4:7], s39 offen offset:2048 sc1 lds
s_add_u32 m0, s50, 32768
s_add_u32 s39, s54, 32768
buffer_load_dwordx4 v0, s[4:7], s39 offen offset:0 sc1 lds
buffer_load_dwordx4 v0, s[4:7], s39 offen offset:2048 sc1 lds
s_add_u32 m0, s50, 49152
s_add_u32 s39, s54, 49152
buffer_load_dwordx4 v0, s[4:7], s39 offen offset:0 sc1 lds
buffer_load_dwordx4 v0, s[4:7], s39 offen offset:2048 sc1 lds
s_add_u32 m0, s50, 0
s_add_u32 s39, s54, 0
buffer_load_dwordx4 v0, s[4:7], s39 offen offset:1024 sc1 lds
buffer_load_dwordx4 v0, s[4:7], s39 offen offset:3072 sc1 lds
s_add_u32 m0, s50, 16384
s_add_u32 s39, s54, 16384
buffer_load_dwordx4 v0, s[4:7], s39 offen offset:1024 sc1 lds
buffer_load_dwordx4 v0, s[4:7], s39 offen offset:3072 sc1 lds
s_add_u32 m0, s50, 32768
s_add_u32 s39, s54, 32768
buffer_load_dwordx4 v0, s[4:7], s39 offen offset:1024 sc1 lds
buffer_load_dwordx4 v0, s[4:7], s39 offen offset:3072 sc1 lds
s_add_u32 m0, s50, 49152
s_add_u32 s39, s54, 49152
buffer_load_dwordx4 v0, s[4:7], s39 offen offset:1024 sc1 lds
buffer_load_dwordx4 v0, s[4:7], s39 offen offset:3072 sc1 lds
v_mfma_f32_16x16x32_bf16 v[72:75], v[180:183], v[28:31], v[72:75]
v_mfma_f32_16x16x32_bf16 v[76:79], v[244:247], v[28:31], v[76:79]
s_waitcnt lgkmcnt(2)
v_mfma_f32_16x16x32_bf16 v[64:67], v[184:187], v[32:35], v[64:67]
v_mfma_f32_16x16x32_bf16 v[68:71], v[248:251], v[32:35], v[68:71]
v_mfma_f32_16x16x32_bf16 v[72:75], v[184:187], v[36:39], v[72:75]
v_mfma_f32_16x16x32_bf16 v[76:79], v[248:251], v[36:39], v[76:79]
s_waitcnt lgkmcnt(0)
v_mfma_f32_16x16x32_bf16 v[64:67], v[188:191], v[40:43], v[64:67]
v_mfma_f32_16x16x32_bf16 v[68:71], v[252:255], v[40:43], v[68:71]
v_mfma_f32_16x16x32_bf16 v[72:75], v[188:191], v[44:47], v[72:75]
v_mfma_f32_16x16x32_bf16 v[76:79], v[252:255], v[44:47], v[76:79]
s_nop 7
v_cvt_pk_bf16_f32 v80, v64, v65
v_cvt_pk_bf16_f32 v81, v66, v67
v_cvt_pk_bf16_f32 v82, v68, v69
v_cvt_pk_bf16_f32 v83, v70, v71
v_cvt_pk_bf16_f32 v84, v72, v73
v_cvt_pk_bf16_f32 v85, v74, v75
v_cvt_pk_bf16_f32 v86, v76, v77
v_cvt_pk_bf16_f32 v87, v78, v79
buffer_store_dwordx4 v[80:83], v7, s[4:7], s58 offen offset:0 sc1
buffer_store_dwordx4 v[84:87], v7, s[4:7], s58 offen offset:1024 sc1
s_waitcnt vmcnt(10)
s_branch Lfe_629
Lfd_630:
v_mfma_f32_16x16x32_bf16 v[72:75], v[180:183], v[28:31], v[72:75]
v_mfma_f32_16x16x32_bf16 v[76:79], v[244:247], v[28:31], v[76:79]
s_waitcnt lgkmcnt(2)
v_mfma_f32_16x16x32_bf16 v[64:67], v[184:187], v[32:35], v[64:67]
v_mfma_f32_16x16x32_bf16 v[68:71], v[248:251], v[32:35], v[68:71]
v_mfma_f32_16x16x32_bf16 v[72:75], v[184:187], v[36:39], v[72:75]
v_mfma_f32_16x16x32_bf16 v[76:79], v[248:251], v[36:39], v[76:79]
s_waitcnt lgkmcnt(0)
v_mfma_f32_16x16x32_bf16 v[64:67], v[188:191], v[40:43], v[64:67]
v_mfma_f32_16x16x32_bf16 v[68:71], v[252:255], v[40:43], v[68:71]
v_mfma_f32_16x16x32_bf16 v[72:75], v[188:191], v[44:47], v[72:75]
v_mfma_f32_16x16x32_bf16 v[76:79], v[252:255], v[44:47], v[76:79]
s_nop 7
v_cvt_pk_bf16_f32 v80, v64, v65
v_cvt_pk_bf16_f32 v81, v66, v67
v_cvt_pk_bf16_f32 v82, v68, v69
v_cvt_pk_bf16_f32 v83, v70, v71
v_cvt_pk_bf16_f32 v84, v72, v73
v_cvt_pk_bf16_f32 v85, v74, v75
v_cvt_pk_bf16_f32 v86, v76, v77
v_cvt_pk_bf16_f32 v87, v78, v79
s_cmp_eq_u32 s36, 64
s_cbranch_scc1 Lfz_628
buffer_store_dwordx4 v[80:83], v7, s[4:7], s58 offen offset:0 sc1
buffer_store_dwordx4 v[84:87], v7, s[4:7], s58 offen offset:1024 sc1
s_branch Lfw_624
Lfl_625:
Lbw_633:
buffer_load_dword v13, v12, s[4:7], s61 offen sc1
s_waitcnt vmcnt(0)
v_cmp_gt_u32 vcc, s57, v13
s_cbranch_vccz Lbo_634
s_sub_u32 s37, s37, 1
s_cbranch_scc1 Lend_7
s_sleep 2
s_branch Lbw_633
Lbo_634:
s_add_u32 m0, s60, 131072
s_add_u32 s39, s59, 0
buffer_load_dwordx4 v0, s[4:7], s39 offen offset:0 sc1 lds
buffer_load_dwordx4 v0, s[4:7], s39 offen offset:1024 sc1 lds
buffer_load_dwordx4 v0, s[4:7], s39 offen offset:2048 sc1 lds
buffer_load_dwordx4 v0, s[4:7], s39 offen offset:3072 sc1 lds
s_add_u32 m0, s60, 147456
s_add_u32 s39, s59, 16384
buffer_load_dwordx4 v0, s[4:7], s39 offen offset:0 sc1 lds
buffer_load_dwordx4 v0, s[4:7], s39 offen offset:1024 sc1 lds
buffer_load_dwordx4 v0, s[4:7], s39 offen offset:2048 sc1 lds
buffer_load_dwordx4 v0, s[4:7], s39 offen offset:3072 sc1 lds
s_waitcnt vmcnt(0) lgkmcnt(0)
s_branch Lfg_626
Lfz_628:
s_waitcnt vmcnt(0)
s_barrier
v_min_u32 v100, s36, 64
s_sub_u32 s38, s36, 4
v_max_i32 v101, s38, 0
buffer_store_dwordx2 v[100:101], v4, s[4:7], 0 offen sc1
v_add_u32 v11, -0x20000, v11
s_mov_b32 s53, s59
s_cmp_lg_u32 s45, 0x70000000
s_cselect_b32 s56, 1, 0
s_mov_b32 s57, 62
s_cmp_lg_u32 s56, 0
s_cbranch_scc1 Lfq_635
Lbw_636:
buffer_load_dword v13, v12, s[4:7], s61 offen sc1
s_waitcnt vmcnt(0)
v_cmp_gt_u32 vcc, s57, v13
s_cbranch_vccz Lbo_637
s_sub_u32 s37, s37, 1
s_cbranch_scc1 Lend_7
s_sleep 1
s_branch Lbw_636
Lbo_637:
s_add_u32 s55, s53, 0
s_add_u32 m0, s60, 0
s_add_u32 s39, s55, 0
buffer_load_dwordx4 v0, s[4:7], s39 offen offset:0 sc1 lds
buffer_load_dwordx4 v0, s[4:7], s39 offen offset:1024 sc1 lds
buffer_load_dwordx4 v0, s[4:7], s39 offen offset:2048 sc1 lds
buffer_load_dwordx4 v0, s[4:7], s39 offen offset:3072 sc1 lds
s_add_u32 m0, s60, 16384
s_add_u32 s39, s55, 16384
buffer_load_dwordx4 v0, s[4:7], s39 offen offset:0 sc1 lds
buffer_load_dwordx4 v0, s[4:7], s39 offen offset:1024 sc1 lds
buffer_load_dwordx4 v0, s[4:7], s39 offen offset:2048 sc1 lds
buffer_load_dwordx4 v0, s[4:7], s39 offen offset:3072 sc1 lds
s_waitcnt vmcnt(0)
Lfq_635:
s_mov_b32 s57, 63
v_cmp_gt_u32 vcc, s57, v13
s_mov_b32 s56, 0
s_cbranch_vccnz Lfq_638
s_mov_b32 s56, 1
s_add_u32 s55, s53, 229376
s_add_u32 m0, s60, 65536
s_add_u32 s39, s55, 0
buffer_load_dwordx4 v0, s[4:7], s39 offen offset:0 sc1 lds
buffer_load_dwordx4 v0, s[4:7], s39 offen offset:1024 sc1 lds
buffer_load_dwordx4 v0, s[4:7], s39 offen offset:2048 sc1 lds
buffer_load_dwordx4 v0, s[4:7], s39 offen offset:3072 sc1 lds
s_add_u32 m0, s60, 81920
s_add_u32 s39, s55, 16384
buffer_load_dwordx4 v0, s[4:7], s39 offen offset:0 sc1 lds
buffer_load_dwordx4 v0, s[4:7], s39 offen offset:1024 sc1 lds
buffer_load_dwordx4 v0, s[4:7], s39 offen offset:2048 sc1 lds
buffer_load_dwordx4 v0, s[4:7], s39 offen offset:3072 sc1 lds
Lfq_638:
s_barrier
ds_read_b128 v[16:19], v11 offset:0
ds_read_b128 v[20:23], v11 offset:1024
ds_read_b128 v[24:27], v11 offset:2048
ds_read_b128 v[28:31], v11 offset:3072
ds_read_b128 v[32:35], v11 offset:4096
ds_read_b128 v[36:39], v11 offset:5120
ds_read_b128 v[40:43], v11 offset:6144
s_waitcnt lgkmcnt(5)
v_mfma_f32_16x16x32_bf16 v[64:67], v[128:131], v[16:19], 0
ds_read_b128 v[44:47], v11 offset:7168
v_mfma_f32_16x16x32_bf16 v[68:71], v[192:195], v[16:19], 0
v_mfma_f32_16x16x32_bf16 v[72:75], v[128:131], v[20:23], 0
ds_read_b128 v[16:19], v11 offset:8192
v_mfma_f32_16x16x32_bf16 v[76:79], v[192:195], v[20:23], 0
s_waitcnt lgkmcnt(5)
buffer_store_dwordx4 v[80:83], v7, s[4:7], s58 offen offset:0 sc1
v_mfma_f32_16x16x32_bf16 v[64:67], v[132:135], v[24:27], v[64:67]
ds_read_b128 v[20:23], v11 offset:9216
v_mfma_f32_16x16x32_bf16 v[68:71], v[196:199], v[24:27], v[68:71]
v_mfma_f32_16x16x32_bf16 v[72:75], v[132:135], v[28:31], v[72:75]
ds_read_b128 v[24:27], v11 offset:10240
v_mfma_f32_16x16x32_bf16 v[76:79], v[196:199], v[28:31], v[76:79]
s_waitcnt lgkmcnt(5)
v_mfma_f32_16x16x32_bf16 v[64:67], v[136:139], v[32:35], v[64:67]
ds_read_b128 v[28:31], v11 offset:11264
v_mfma_f32_16x16x32_bf16 v[68:71], v[200:203], v[32:35], v[68:71]
buffer_store_dwordx4 v[84:87], v7, s[4:7], s58 offen offset:1024 sc1
v_mfma_f32_16x16x32_bf16 v[72:75], v[136:139], v[36:39], v[72:75]
ds_read_b128 v[32:35], v11 offset:12288
v_mfma_f32_16x16x32_bf16 v[76:79], v[200:203], v[36:39], v[76:79]
s_waitcnt lgkmcnt(5)
v_mfma_f32_16x16x32_bf16 v[64:67], v[140:143], v[40:43], v[64:67]
ds_read_b128 v[36:39], v11 offset:13312
v_mfma_f32_16x16x32_bf16 v[68:71], v[204:207], v[40:43], v[68:71]
v_mfma_f32_16x16x32_bf16 v[72:75], v[140:143], v[44:47], v[72:75]
ds_read_b128 v[40:43], v11 offset:14336
v_mfma_f32_16x16x32_bf16 v[76:79], v[204:207], v[44:47], v[76:79]
s_waitcnt lgkmcnt(5)
v_mfma_f32_16x16x32_bf16 v[64:67], v[144:147], v[16:19], v[64:67]
ds_read_b128 v[44:47], v11 offset:15360
v_mfma_f32_16x16x32_bf16 v[68:71], v[208:211], v[16:19], v[68:71]
v_mfma_f32_16x16x32_bf16 v[72:75], v[144:147], v[20:23], v[72:75]
ds_read_b128 v[16:19], v11 offset:16384
v_mfma_f32_16x16x32_bf16 v[76:79], v[208:211], v[20:23], v[76:79]
s_waitcnt lgkmcnt(5)
v_mfma_f32_16x16x32_bf16 v[64:67], v[148:151], v[24:27], v[64:67]
ds_read_b128 v[20:23], v11 offset:17408
v_mfma_f32_16x16x32_bf16 v[68:71], v[212:215], v[24:27], v[68:71]
v_mfma_f32_16x16x32_bf16 v[72:75], v[148:151], v[28:31], v[72:75]
ds_read_b128 v[24:27], v11 offset:18432
v_mfma_f32_16x16x32_bf16 v[76:79], v[212:215], v[28:31], v[76:79]
s_waitcnt lgkmcnt(5)
v_mfma_f32_16x16x32_bf16 v[64:67], v[152:155], v[32:35], v[64:67]
ds_read_b128 v[28:31], v11 offset:19456
v_mfma_f32_16x16x32_bf16 v[68:71], v[216:219], v[32:35], v[68:71]
v_mfma_f32_16x16x32_bf16 v[72:75], v[152:155], v[36:39], v[72:75]
ds_read_b128 v[32:35], v11 offset:20480
v_mfma_f32_16x16x32_bf16 v[76:79], v[216:219], v[36:39], v[76:79]
s_waitcnt lgkmcnt(5)
v_mfma_f32_16x16x32_bf16 v[64:67], v[156:159], v[40:43], v[64:67]
ds_read_b128 v[36:39], v11 offset:21504
v_mfma_f32_16x16x32_bf16 v[68:71], v[220:223], v[40:43], v[68:71]
v_mfma_f32_16x16x32_bf16 v[72:75], v[156:159], v[44:47], v[72:75]
ds_read_b128 v[40:43], v11 offset:22528
v_mfma_f32_16x16x32_bf16 v[76:79], v[220:223], v[44:47], v[76:79]
s_waitcnt lgkmcnt(5)
v_mfma_f32_16x16x32_bf16 v[64:67], v[160:163], v[16:19], v[64:67]
ds_read_b128 v[44:47], v11 offset:23552
v_mfma_f32_16x16x32_bf16 v[68:71], v[224:227], v[16:19], v[68:71]
v_mfma_f32_16x16x32_bf16 v[72:75], v[160:163], v[20:23], v[72:75]
ds_read_b128 v[16:19], v11 offset:24576
v_mfma_f32_16x16x32_bf16 v[76:79], v[224:227], v[20:23], v[76:79]
s_waitcnt lgkmcnt(5)
v_mfma_f32_16x16x32_bf16 v[64:67], v[164:167], v[24:27], v[64:67]
ds_read_b128 v[20:23], v11 offset:25600
v_mfma_f32_16x16x32_bf16 v[68:71], v[228:231], v[24:27], v[68:71]
v_mfma_f32_16x16x32_bf16 v[72:75], v[164:167], v[28:31], v[72:75]
ds_read_b128 v[24:27], v11 offset:26624
v_mfma_f32_16x16x32_bf16 v[76:79], v[228:231], v[28:31], v[76:79]
s_waitcnt lgkmcnt(5)
v_mfma_f32_16x16x32_bf16 v[64:67], v[168:171], v[32:35], v[64:67]
ds_read_b128 v[28:31], v11 offset:27648
v_mfma_f32_16x16x32_bf16 v[68:71], v[232:235], v[32:35], v[68:71]
v_mfma_f32_16x16x32_bf16 v[72:75], v[168:171], v[36:39], v[72:75]
ds_read_b128 v[32:35], v11 offset:28672
v_mfma_f32_16x16x32_bf16 v[76:79], v[232:235], v[36:39], v[76:79]
s_waitcnt lgkmcnt(5)
v_mfma_f32_16x16x32_bf16 v[64:67], v[172:175], v[40:43], v[64:67]
ds_read_b128 v[36:39], v11 offset:29696
v_mfma_f32_16x16x32_bf16 v[68:71], v[236:239], v[40:43], v[68:71]
buffer_load_dword v13, v12, s[4:7], s61 offen sc1
v_mfma_f32_16x16x32_bf16 v[72:75], v[172:175], v[44:47], v[72:75]
ds_read_b128 v[40:43], v11 offset:30720
v_mfma_f32_16x16x32_bf16 v[76:79], v[236:239], v[44:47], v[76:79]
s_waitcnt lgkmcnt(5)
v_mfma_f32_16x16x32_bf16 v[64:67], v[176:179], v[16:19], v[64:67]
ds_read_b128 v[44:47], v11 offset:31744
v_mfma_f32_16x16x32_bf16 v[68:71], v[240:243], v[16:19], v[68:71]
v_mfma_f32_16x16x32_bf16 v[72:75], v[176:179], v[20:23], v[72:75]
v_mfma_f32_16x16x32_bf16 v[76:79], v[240:243], v[20:23], v[76:79]
s_waitcnt lgkmcnt(4)
v_mfma_f32_16x16x32_bf16 v[64:67], v[180:183], v[24:27], v[64:67]
v_mfma_f32_16x16x32_bf16 v[68:71], v[244:247], v[24:27], v[68:71]
v_mfma_f32_16x16x32_bf16 v[72:75], v[180:183], v[28:31], v[72:75]
v_mfma_f32_16x16x32_bf16 v[76:79], v[244:247], v[28:31], v[76:79]
s_waitcnt lgkmcnt(2)
v_mfma_f32_16x16x32_bf16 v[64:67], v[184:187], v[32:35], v[64:67]
v_mfma_f32_16x16x32_bf16 v[68:71], v[248:251], v[32:35], v[68:71]
v_mfma_f32_16x16x32_bf16 v[72:75], v[184:187], v[36:39], v[72:75]
v_mfma_f32_16x16x32_bf16 v[76:79], v[248:251], v[36:39], v[76:79]
s_waitcnt lgkmcnt(0)
v_mfma_f32_16x16x32_bf16 v[64:67], v[188:191], v[40:43], v[64:67]
v_mfma_f32_16x16x32_bf16 v[68:71], v[252:255], v[40:43], v[68:71]
v_mfma_f32_16x16x32_bf16 v[72:75], v[188:191], v[44:47], v[72:75]
v_mfma_f32_16x16x32_bf16 v[76:79], v[252:255], v[44:47], v[76:79]
s_cmp_ge_u32 s36, 3
s_cselect_b32 s58, s62, 0x70000000
s_add_u32 s49, s49, 229376
s_add_u32 s62, s62, 65536
s_add_u32 s59, s59, 229376
s_add_u32 s36, s36, 1
v_add_u32 v11, 0x10000, v11
s_nop 0
v_cvt_pk_bf16_f32 v80, v64, v65
v_cvt_pk_bf16_f32 v81, v66, v67
v_cvt_pk_bf16_f32 v82, v68, v69
v_cvt_pk_bf16_f32 v83, v70, v71
v_cvt_pk_bf16_f32 v84, v72, v73
v_cvt_pk_bf16_f32 v85, v74, v75
v_cvt_pk_bf16_f32 v86, v76, v77
v_cvt_pk_bf16_f32 v87, v78, v79
s_waitcnt vmcnt(0)
s_mov_b32 s57, 63
s_cmp_lg_u32 s56, 0
s_cbranch_scc1 Lfq_639
Lbw_640:
buffer_load_dword v13, v12, s[4:7], s61 offen sc1
s_waitcnt vmcnt(0)
v_cmp_gt_u32 vcc, s57, v13
s_cbranch_vccz Lbo_641
s_sub_u32 s37, s37, 1
s_cbranch_scc1 Lend_7
s_sleep 1
s_branch Lbw_640
Lbo_641:
s_add_u32 s55, s53, 229376
s_add_u32 m0, s60, 65536
s_add_u32 s39, s55, 0
buffer_load_dwordx4 v0, s[4:7], s39 offen offset:0 sc1 lds
buffer_load_dwordx4 v0, s[4:7], s39 offen offset:1024 sc1 lds
buffer_load_dwordx4 v0, s[4:7], s39 offen offset:2048 sc1 lds
buffer_load_dwordx4 v0, s[4:7], s39 offen offset:3072 sc1 lds
s_add_u32 m0, s60, 81920
s_add_u32 s39, s55, 16384
buffer_load_dwordx4 v0, s[4:7], s39 offen offset:0 sc1 lds
buffer_load_dwordx4 v0, s[4:7], s39 offen offset:1024 sc1 lds
buffer_load_dwordx4 v0, s[4:7], s39 offen offset:2048 sc1 lds
buffer_load_dwordx4 v0, s[4:7], s39 offen offset:3072 sc1 lds
s_waitcnt vmcnt(0)
Lfq_639:
s_mov_b32 s57, 64
v_cmp_gt_u32 vcc, s57, v13
s_mov_b32 s56, 0
s_cbranch_vccnz Lfq_642
s_mov_b32 s56, 1
s_add_u32 s55, s53, 458752
s_add_u32 m0, s60, 131072
s_add_u32 s39, s55, 0
buffer_load_dwordx4 v0, s[4:7], s39 offen offset:0 sc1 lds
buffer_load_dwordx4 v0, s[4:7], s39 offen offset:1024 sc1 lds
buffer_load_dwordx4 v0, s[4:7], s39 offen offset:2048 sc1 lds
buffer_load_dwordx4 v0, s[4:7], s39 offen offset:3072 sc1 lds
s_add_u32 m0, s60, 147456
s_add_u32 s39, s55, 16384
buffer_load_dwordx4 v0, s[4:7], s39 offen offset:0 sc1 lds
buffer_load_dwordx4 v0, s[4:7], s39 offen offset:1024 sc1 lds
buffer_load_dwordx4 v0, s[4:7], s39 offen offset:2048 sc1 lds
buffer_load_dwordx4 v0, s[4:7], s39 offen offset:3072 sc1 lds
Lfq_642:
s_barrier
ds_read_b128 v[16:19], v11 offset:0
ds_read_b128 v[20:23], v11 offset:1024
ds_read_b128 v[24:27], v11 offset:2048
ds_read_b128 v[28:31], v11 offset:3072
ds_read_b128 v[32:35], v11 offset:4096
ds_read_b128 v[36:39], v11 offset:5120
ds_read_b128 v[40:43], v11 offset:6144
s_waitcnt lgkmcnt(5)
v_mfma_f32_16x16x32_bf16 v[64:67], v[128:131], v[16:19], 0
ds_read_b128 v[44:47], v11 offset:7168
v_mfma_f32_16x16x32_bf16 v[68:71], v[192:195], v[16:19], 0
v_mfma_f32_16x16x32_bf16 v[72:75], v[128:131], v[20:23], 0
ds_read_b128 v[16:19], v11 offset:8192
v_mfma_f32_16x16x32_bf16 v[76:79], v[192:195], v[20:23], 0
s_waitcnt lgkmcnt(5)
buffer_store_dwordx4 v[80:83], v7, s[4:7], s58 offen offset:0 sc1
v_mfma_f32_16x16x32_bf16 v[64:67], v[132:135], v[24:27], v[64:67]
ds_read_b128 v[20:23], v11 offset:9216
v_mfma_f32_16x16x32_bf16 v[68:71], v[196:199], v[24:27], v[68:71]
v_mfma_f32_16x16x32_bf16 v[72:75], v[132:135], v[28:31], v[72:75]
ds_read_b128 v[24:27], v11 offset:10240
v_mfma_f32_16x16x32_bf16 v[76:79], v[196:199], v[28:31], v[76:79]
s_waitcnt lgkmcnt(5)
v_mfma_f32_16x16x32_bf16 v[64:67], v[136:139], v[32:35], v[64:67]
ds_read_b128 v[28:31], v11 offset:11264
v_mfma_f32_16x16x32_bf16 v[68:71], v[200:203], v[32:35], v[68:71]
buffer_store_dwordx4 v[84:87], v7, s[4:7], s58 offen offset:1024 sc1
v_mfma_f32_16x16x32_bf16 v[72:75], v[136:139], v[36:39], v[72:75]
ds_read_b128 v[32:35], v11 offset:12288
v_mfma_f32_16x16x32_bf16 v[76:79], v[200:203], v[36:39], v[76:79]
s_waitcnt lgkmcnt(5)
v_mfma_f32_16x16x32_bf16 v[64:67], v[140:143], v[40:43], v[64:67]
ds_read_b128 v[36:39], v11 offset:13312
v_mfma_f32_16x16x32_bf16 v[68:71], v[204:207], v[40:43], v[68:71]
v_mfma_f32_16x16x32_bf16 v[72:75], v[140:143], v[44:47], v[72:75]
ds_read_b128 v[40:43], v11 offset:14336
v_mfma_f32_16x16x32_bf16 v[76:79], v[204:207], v[44:47], v[76:79]
s_waitcnt lgkmcnt(5)
v_mfma_f32_16x16x32_bf16 v[64:67], v[144:147], v[16:19], v[64:67]
ds_read_b128 v[44:47], v11 offset:15360
v_mfma_f32_16x16x32_bf16 v[68:71], v[208:211], v[16:19], v[68:71]
v_mfma_f32_16x16x32_bf16 v[72:75], v[144:147], v[20:23], v[72:75]
ds_read_b128 v[16:19], v11 offset:16384
v_mfma_f32_16x16x32_bf16 v[76:79], v[208:211], v[20:23], v[76:79]
s_waitcnt lgkmcnt(5)
v_mfma_f32_16x16x32_bf16 v[64:67], v[148:151], v[24:27], v[64:67]
ds_read_b128 v[20:23], v11 offset:17408
v_mfma_f32_16x16x32_bf16 v[68:71], v[212:215], v[24:27], v[68:71]
v_mfma_f32_16x16x32_bf16 v[72:75], v[148:151], v[28:31], v[72:75]
ds_read_b128 v[24:27], v11 offset:18432
v_mfma_f32_16x16x32_bf16 v[76:79], v[212:215], v[28:31], v[76:79]
s_waitcnt lgkmcnt(5)
v_mfma_f32_16x16x32_bf16 v[64:67], v[152:155], v[32:35], v[64:67]
ds_read_b128 v[28:31], v11 offset:19456
v_mfma_f32_16x16x32_bf16 v[68:71], v[216:219], v[32:35], v[68:71]
v_mfma_f32_16x16x32_bf16 v[72:75], v[152:155], v[36:39], v[72:75]
ds_read_b128 v[32:35], v11 offset:20480
v_mfma_f32_16x16x32_bf16 v[76:79], v[216:219], v[36:39], v[76:79]
s_waitcnt lgkmcnt(5)
v_mfma_f32_16x16x32_bf16 v[64:67], v[156:159], v[40:43], v[64:67]
ds_read_b128 v[36:39], v11 offset:21504
v_mfma_f32_16x16x32_bf16 v[68:71], v[220:223], v[40:43], v[68:71]
v_mfma_f32_16x16x32_bf16 v[72:75], v[156:159], v[44:47], v[72:75]
ds_read_b128 v[40:43], v11 offset:22528
v_mfma_f32_16x16x32_bf16 v[76:79], v[220:223], v[44:47], v[76:79]
s_waitcnt lgkmcnt(5)
v_mfma_f32_16x16x32_bf16 v[64:67], v[160:163], v[16:19], v[64:67]
ds_read_b128 v[44:47], v11 offset:23552
v_mfma_f32_16x16x32_bf16 v[68:71], v[224:227], v[16:19], v[68:71]
v_mfma_f32_16x16x32_bf16 v[72:75], v[160:163], v[20:23], v[72:75]
ds_read_b128 v[16:19], v11 offset:24576
v_mfma_f32_16x16x32_bf16 v[76:79], v[224:227], v[20:23], v[76:79]
s_waitcnt lgkmcnt(5)
v_mfma_f32_16x16x32_bf16 v[64:67], v[164:167], v[24:27], v[64:67]
ds_read_b128 v[20:23], v11 offset:25600
v_mfma_f32_16x16x32_bf16 v[68:71], v[228:231], v[24:27], v[68:71]
v_mfma_f32_16x16x32_bf16 v[72:75], v[164:167], v[28:31], v[72:75]
ds_read_b128 v[24:27], v11 offset:26624
v_mfma_f32_16x16x32_bf16 v[76:79], v[228:231], v[28:31], v[76:79]
s_waitcnt lgkmcnt(5)
v_mfma_f32_16x16x32_bf16 v[64:67], v[168:171], v[32:35], v[64:67]
ds_read_b128 v[28:31], v11 offset:27648
v_mfma_f32_16x16x32_bf16 v[68:71], v[232:235], v[32:35], v[68:71]
v_mfma_f32_16x16x32_bf16 v[72:75], v[168:171], v[36:39], v[72:75]
ds_read_b128 v[32:35], v11 offset:28672
v_mfma_f32_16x16x32_bf16 v[76:79], v[232:235], v[36:39], v[76:79]
s_waitcnt lgkmcnt(5)
v_mfma_f32_16x16x32_bf16 v[64:67], v[172:175], v[40:43], v[64:67]
ds_read_b128 v[36:39], v11 offset:29696
v_mfma_f32_16x16x32_bf16 v[68:71], v[236:239], v[40:43], v[68:71]
v_mfma_f32_16x16x32_bf16 v[72:75], v[172:175], v[44:47], v[72:75]
ds_read_b128 v[40:43], v11 offset:30720
v_mfma_f32_16x16x32_bf16 v[76:79], v[236:239], v[44:47], v[76:79]
s_waitcnt lgkmcnt(5)
v_mfma_f32_16x16x32_bf16 v[64:67], v[176:179], v[16:19], v[64:67]
ds_read_b128 v[44:47], v11 offset:31744
v_mfma_f32_16x16x32_bf16 v[68:71], v[240:243], v[16:19], v[68:71]
v_mfma_f32_16x16x32_bf16 v[72:75], v[176:179], v[20:23], v[72:75]
v_mfma_f32_16x16x32_bf16 v[76:79], v[240:243], v[20:23], v[76:79]
s_waitcnt lgkmcnt(4)
v_mfma_f32_16x16x32_bf16 v[64:67], v[180:183], v[24:27], v[64:67]
v_mfma_f32_16x16x32_bf16 v[68:71], v[244:247], v[24:27], v[68:71]
v_mfma_f32_16x16x32_bf16 v[72:75], v[180:183], v[28:31], v[72:75]
v_mfma_f32_16x16x32_bf16 v[76:79], v[244:247], v[28:31], v[76:79]
s_waitcnt lgkmcnt(2)
v_mfma_f32_16x16x32_bf16 v[64:67], v[184:187], v[32:35], v[64:67]
v_mfma_f32_16x16x32_bf16 v[68:71], v[248:251], v[32:35], v[68:71]
v_mfma_f32_16x16x32_bf16 v[72:75], v[184:187], v[36:39], v[72:75]
v_mfma_f32_16x16x32_bf16 v[76:79], v[248:251], v[36:39], v[76:79]
s_waitcnt lgkmcnt(0)
v_mfma_f32_16x16x32_bf16 v[64:67], v[188:191], v[40:43], v[64:67]
v_mfma_f32_16x16x32_bf16 v[68:71], v[252:255], v[40:43], v[68:71]
v_mfma_f32_16x16x32_bf16 v[72:75], v[188:191], v[44:47], v[72:75]
v_mfma_f32_16x16x32_bf16 v[76:79], v[252:255], v[44:47], v[76:79]
s_cmp_ge_u32 s36, 3
s_cselect_b32 s58, s62, 0x70000000
s_add_u32 s49, s49, 229376
s_add_u32 s62, s62, 65536
s_add_u32 s59, s59, 229376
s_add_u32 s36, s36, 1
v_add_u32 v11, 0x10000, v11
s_nop 0
v_cvt_pk_bf16_f32 v80, v64, v65
v_cvt_pk_bf16_f32 v81, v66, v67
v_cvt_pk_bf16_f32 v82, v68, v69
v_cvt_pk_bf16_f32 v83, v70, v71
v_cvt_pk_bf16_f32 v84, v72, v73
v_cvt_pk_bf16_f32 v85, v74, v75
v_cvt_pk_bf16_f32 v86, v76, v77
v_cvt_pk_bf16_f32 v87, v78, v79
s_waitcnt vmcnt(2)
s_mov_b32 s57, 64
s_cmp_lg_u32 s56, 0
s_cbranch_scc1 Lfq_643
Lbw_644:
buffer_load_dword v13, v12, s[4:7], s61 offen sc1
s_waitcnt vmcnt(0)
v_cmp_gt_u32 vcc, s57, v13
s_cbranch_vccz Lbo_645
s_sub_u32 s37, s37, 1
s_cbranch_scc1 Lend_7
s_sleep 1
s_branch Lbw_644
Lbo_645:
s_add_u32 s55, s53, 458752
s_add_u32 m0, s60, 131072
s_add_u32 s39, s55, 0
buffer_load_dwordx4 v0, s[4:7], s39 offen offset:0 sc1 lds
buffer_load_dwordx4 v0, s[4:7], s39 offen offset:1024 sc1 lds
buffer_load_dwordx4 v0, s[4:7], s39 offen offset:2048 sc1 lds
buffer_load_dwordx4 v0, s[4:7], s39 offen offset:3072 sc1 lds
s_add_u32 m0, s60, 147456
s_add_u32 s39, s55, 16384
buffer_load_dwordx4 v0, s[4:7], s39 offen offset:0 sc1 lds
buffer_load_dwordx4 v0, s[4:7], s39 offen offset:1024 sc1 lds
buffer_load_dwordx4 v0, s[4:7], s39 offen offset:2048 sc1 lds
buffer_load_dwordx4 v0, s[4:7], s39 offen offset:3072 sc1 lds
s_waitcnt vmcnt(0)
Lfq_643:
s_barrier
ds_read_b128 v[16:19], v11 offset:0
ds_read_b128 v[20:23], v11 offset:1024
ds_read_b128 v[24:27], v11 offset:2048
ds_read_b128 v[28:31], v11 offset:3072
ds_read_b128 v[32:35], v11 offset:4096
ds_read_b128 v[36:39], v11 offset:5120
ds_read_b128 v[40:43], v11 offset:6144
s_waitcnt lgkmcnt(5)
v_mfma_f32_16x16x32_bf16 v[64:67], v[128:131], v[16:19], 0
ds_read_b128 v[44:47], v11 offset:7168
v_mfma_f32_16x16x32_bf16 v[68:71], v[192:195], v[16:19], 0
v_mfma_f32_16x16x32_bf16 v[72:75], v[128:131], v[20:23], 0
ds_read_b128 v[16:19], v11 offset:8192
v_mfma_f32_16x16x32_bf16 v[76:79], v[192:195], v[20:23], 0
s_waitcnt lgkmcnt(5)
buffer_store_dwordx4 v[80:83], v7, s[4:7], s58 offen offset:0 sc1
v_mfma_f32_16x16x32_bf16 v[64:67], v[132:135], v[24:27], v[64:67]
ds_read_b128 v[20:23], v11 offset:9216
v_mfma_f32_16x16x32_bf16 v[68:71], v[196:199], v[24:27], v[68:71]
v_mfma_f32_16x16x32_bf16 v[72:75], v[132:135], v[28:31], v[72:75]
ds_read_b128 v[24:27], v11 offset:10240
v_mfma_f32_16x16x32_bf16 v[76:79], v[196:199], v[28:31], v[76:79]
s_waitcnt lgkmcnt(5)
buffer_store_dwordx4 v[84:87], v7, s[4:7], s58 offen offset:1024 sc1
v_mfma_f32_16x16x32_bf16 v[64:67], v[136:139], v[32:35], v[64:67]
ds_read_b128 v[28:31], v11 offset:11264
v_mfma_f32_16x16x32_bf16 v[68:71], v[200:203], v[32:35], v[68:71]
v_mfma_f32_16x16x32_bf16 v[72:75], v[136:139], v[36:39], v[72:75]
ds_read_b128 v[32:35], v11 offset:12288
v_mfma_f32_16x16x32_bf16 v[76:79], v[200:203], v[36:39], v[76:79]
s_waitcnt lgkmcnt(5)
v_mfma_f32_16x16x32_bf16 v[64:67], v[140:143], v[40:43], v[64:67]
ds_read_b128 v[36:39], v11 offset:13312
v_mfma_f32_16x16x32_bf16 v[68:71], v[204:207], v[40:43], v[68:71]
v_mfma_f32_16x16x32_bf16 v[72:75], v[140:143], v[44:47], v[72:75]
ds_read_b128 v[40:43], v11 offset:14336
v_mfma_f32_16x16x32_bf16 v[76:79], v[204:207], v[44:47], v[76:79]
s_waitcnt lgkmcnt(5)
v_mfma_f32_16x16x32_bf16 v[64:67], v[144:147], v[16:19], v[64:67]
ds_read_b128 v[44:47], v11 offset:15360
v_mfma_f32_16x16x32_bf16 v[68:71], v[208:211], v[16:19], v[68:71]
v_mfma_f32_16x16x32_bf16 v[72:75], v[144:147], v[20:23], v[72:75]
ds_read_b128 v[16:19], v11 offset:16384
v_mfma_f32_16x16x32_bf16 v[76:79], v[208:211], v[20:23], v[76:79]
s_waitcnt lgkmcnt(5)
v_mfma_f32_16x16x32_bf16 v[64:67], v[148:151], v[24:27], v[64:67]
ds_read_b128 v[20:23], v11 offset:17408
v_mfma_f32_16x16x32_bf16 v[68:71], v[212:215], v[24:27], v[68:71]
v_mfma_f32_16x16x32_bf16 v[72:75], v[148:151], v[28:31], v[72:75]
ds_read_b128 v[24:27], v11 offset:18432
v_mfma_f32_16x16x32_bf16 v[76:79], v[212:215], v[28:31], v[76:79]
s_waitcnt lgkmcnt(5)
v_mfma_f32_16x16x32_bf16 v[64:67], v[152:155], v[32:35], v[64:67]
ds_read_b128 v[28:31], v11 offset:19456
v_mfma_f32_16x16x32_bf16 v[68:71], v[216:219], v[32:35], v[68:71]
v_mfma_f32_16x16x32_bf16 v[72:75], v[152:155], v[36:39], v[72:75]
ds_read_b128 v[32:35], v11 offset:20480
v_mfma_f32_16x16x32_bf16 v[76:79], v[216:219], v[36:39], v[76:79]
s_waitcnt lgkmcnt(5)
v_mfma_f32_16x16x32_bf16 v[64:67], v[156:159], v[40:43], v[64:67]
ds_read_b128 v[36:39], v11 offset:21504
v_mfma_f32_16x16x32_bf16 v[68:71], v[220:223], v[40:43], v[68:71]
v_mfma_f32_16x16x32_bf16 v[72:75], v[156:159], v[44:47], v[72:75]
ds_read_b128 v[40:43], v11 offset:22528
v_min_u32 v100, s36, 64
v_mfma_f32_16x16x32_bf16 v[76:79], v[220:223], v[44:47], v[76:79]
s_waitcnt lgkmcnt(5)
s_sub_u32 s38, s36, 2
v_max_i32 v101, s38, 0
v_mfma_f32_16x16x32_bf16 v[64:67], v[160:163], v[16:19], v[64:67]
ds_read_b128 v[44:47], v11 offset:23552
buffer_store_dwordx2 v[100:101], v4, s[4:7], 0 offen sc1
v_mfma_f32_16x16x32_bf16 v[68:71], v[224:227], v[16:19], v[68:71]
v_mfma_f32_16x16x32_bf16 v[72:75], v[160:163], v[20:23], v[72:75]
ds_read_b128 v[16:19], v11 offset:24576
v_mfma_f32_16x16x32_bf16 v[76:79], v[224:227], v[20:23], v[76:79]
s_waitcnt lgkmcnt(5)
v_mfma_f32_16x16x32_bf16 v[64:67], v[164:167], v[24:27], v[64:67]
ds_read_b128 v[20:23], v11 offset:25600
v_mfma_f32_16x16x32_bf16 v[68:71], v[228:231], v[24:27], v[68:71]
v_mfma_f32_16x16x32_bf16 v[72:75], v[164:167], v[28:31], v[72:75]
ds_read_b128 v[24:27], v11 offset:26624
v_mfma_f32_16x16x32_bf16 v[76:79], v[228:231], v[28:31], v[76:79]
s_waitcnt lgkmcnt(5)
v_mfma_f32_16x16x32_bf16 v[64:67], v[168:171], v[32:35], v[64:67]
ds_read_b128 v[28:31], v11 offset:27648
v_mfma_f32_16x16x32_bf16 v[68:71], v[232:235], v[32:35], v[68:71]
v_mfma_f32_16x16x32_bf16 v[72:75], v[168:171], v[36:39], v[72:75]
ds_read_b128 v[32:35], v11 offset:28672
v_mfma_f32_16x16x32_bf16 v[76:79], v[232:235], v[36:39], v[76:79]
s_waitcnt lgkmcnt(5)
v_mfma_f32_16x16x32_bf16 v[64:67], v[172:175], v[40:43], v[64:67]
ds_read_b128 v[36:39], v11 offset:29696
v_mfma_f32_16x16x32_bf16 v[68:71], v[236:239], v[40:43], v[68:71]
v_mfma_f32_16x16x32_bf16 v[72:75], v[172:175], v[44:47], v[72:75]
ds_read_b128 v[40:43], v11 offset:30720
v_mfma_f32_16x16x32_bf16 v[76:79], v[236:239], v[44:47], v[76:79]
s_waitcnt lgkmcnt(5)
v_mfma_f32_16x16x32_bf16 v[64:67], v[176:179], v[16:19], v[64:67]
ds_read_b128 v[44:47], v11 offset:31744
v_mfma_f32_16x16x32_bf16 v[68:71], v[240:243], v[16:19], v[68:71]
v_mfma_f32_16x16x32_bf16 v[72:75], v[176:179], v[20:23], v[72:75]
v_mfma_f32_16x16x32_bf16 v[76:79], v[240:243], v[20:23], v[76:79]
s_waitcnt lgkmcnt(4)
v_mfma_f32_16x16x32_bf16 v[64:67], v[180:183], v[24:27], v[64:67]
v_mfma_f32_16x16x32_bf16 v[68:71], v[244:247], v[24:27], v[68:71]
v_mfma_f32_16x16x32_bf16 v[72:75], v[180:183], v[28:31], v[72:75]
v_mfma_f32_16x16x32_bf16 v[76:79], v[244:247], v[28:31], v[76:79]
s_waitcnt lgkmcnt(2)
v_mfma_f32_16x16x32_bf16 v[64:67], v[184:187], v[32:35], v[64:67]
v_mfma_f32_16x16x32_bf16 v[68:71], v[248:251], v[32:35], v[68:71]
v_mfma_f32_16x16x32_bf16 v[72:75], v[184:187], v[36:39], v[72:75]
v_mfma_f32_16x16x32_bf16 v[76:79], v[248:251], v[36:39], v[76:79]
s_waitcnt lgkmcnt(0)
v_mfma_f32_16x16x32_bf16 v[64:67], v[188:191], v[40:43], v[64:67]
v_mfma_f32_16x16x32_bf16 v[68:71], v[252:255], v[40:43], v[68:71]
v_mfma_f32_16x16x32_bf16 v[72:75], v[188:191], v[44:47], v[72:75]
v_mfma_f32_16x16x32_bf16 v[76:79], v[252:255], v[44:47], v[76:79]
s_cmp_ge_u32 s36, 3
s_cselect_b32 s58, s62, 0x70000000
s_add_u32 s49, s49, 229376
s_add_u32 s62, s62, 65536
s_add_u32 s59, s59, 229376
s_add_u32 s36, s36, 1
v_add_u32 v11, 0x10000, v11
s_nop 0
v_cvt_pk_bf16_f32 v80, v64, v65
v_cvt_pk_bf16_f32 v81, v66, v67
v_cvt_pk_bf16_f32 v82, v68, v69
v_cvt_pk_bf16_f32 v83, v70, v71
v_cvt_pk_bf16_f32 v84, v72, v73
v_cvt_pk_bf16_f32 v85, v74, v75
v_cvt_pk_bf16_f32 v86, v76, v77
v_cvt_pk_bf16_f32 v87, v78, v79
buffer_store_dwordx4 v[80:83], v7, s[4:7], s58 offen offset:0 sc1
buffer_store_dwordx4 v[84:87], v7, s[4:7], s58 offen offset:1024 sc1
s_endpgm
Lln_6:
s_sub_u32 s26, s44, 56
s_and_b32 s52, s26, 3
s_lshl_b32 s53, s32, 2
v_lshrrev_b32 v80, 3, v9
v_and_b32 v81, 7, v9
s_lshr_b32 s38, s52, 1
s_lshl_b32 s38, s38, 10
s_and_b32 s39, s52, 1
s_lshl_b32 s39, s39, 7
s_add_u32 s38, s38, s39
s_lshl_b32 s39, s53, 12
s_add_u32 s38, s38, s39
v_lshl_add_u32 v6, v81, 4, s38
v_and_b32 v82, 3, v80
v_lshl_add_u32 v6, v82, 8, v6
v_lshrrev_b32 v82, 2, v80
v_lshl_add_u32 v6, v82, 11, v6
s_lshl_b32 s38, s52, 14
s_lshl_b32 s39, s53, 7
s_add_u32 s38, s38, s39
v_lshl_add_u32 v7, v81, 11, s38
v_lshl_add_u32 v7, v80, 4, v7
s_lshl_b32 s38, s53, 8
v_lshl_add_u32 v8, v80, 5, s38
v_and_b32 v12, 7, v9
v_lshlrev_b32 v12, 5, v12
s_lshl_b32 s38, s32, 3
v_add_u32 v11, s38, v12
s_mov_b32 s60, 0x00003f80
s_mov_b32 s61, 0x3f800000
v_min_u32 v2, 31, v9
v_lshlrev_b32 v2, 7, v2
s_lshr_b32 s47, s26, 2
s_xor_b32 s47, s47, 1
s_lshl_b32 s47, s47, 12
s_add_u32 s47, s47, 3440640
Lst_646:
buffer_load_dword v48, off, s[12:15], 0 offset:16 sc1
buffer_load_dword v49, off, s[12:15], 0 offset:144 sc1
s_waitcnt vmcnt(0)
v_add_u32 v48, v48, v49
s_nop 0
v_readfirstlane_b32 s38, v48
s_nop 3
s_and_b32 s39, s38, 0xffff
s_cmp_eq_u32 s39, 0x100
s_cbranch_scc1 Lso_647
s_sub_u32 s37, s37, 1
s_cbranch_scc1 Lend_7
s_sleep 8
s_branch Lst_646
Lso_647:
s_bfe_u32 s35, s38, 0x80010
s_bfe_u32 s46, s38, 0x10018
s_lshl_b32 s46, s46, 13
s_barrier
v_min_u32 v80, 31, v9
v_lshlrev_b32 v80, 7, v80
s_mov_b32 s38, 3448832
Lbw_648:
buffer_load_dword v81, v80, s[4:7], s38 offen sc1
s_waitcnt vmcnt(0)
v_cmp_gt_u32 vcc, 1, v81
s_cbranch_vccz Lbo_649
s_sub_u32 s37, s37, 1
s_cbranch_scc1 Lend_7
s_sleep 8
s_branch Lbw_648
Lbo_649:
s_mov_b32 s38, 3153920
buffer_load_dwordx4 v[128:131], v8, s[4:7], s38 offen offset:0 sc1
buffer_load_dwordx4 v[132:135], v8, s[4:7], s38 offen offset:16 sc1
buffer_load_dwordx4 v[136:139], v8, s[4:7], s38 offen offset:256 sc1
buffer_load_dwordx4 v[140:143], v8, s[4:7], s38 offen offset:272 sc1
buffer_load_dwordx4 v[144:147], v8, s[4:7], s38 offen offset:512 sc1
buffer_load_dwordx4 v[148:151], v8, s[4:7], s38 offen offset:528 sc1
buffer_load_dwordx4 v[152:155], v8, s[4:7], s38 offen offset:768 sc1
buffer_load_dwordx4 v[156:159], v8, s[4:7], s38 offen offset:784 sc1
s_mov_b32 s38, 3158016
buffer_load_dwordx4 v[192:195], v8, s[4:7], s38 offen offset:0 sc1
buffer_load_dwordx4 v[196:199], v8, s[4:7], s38 offen offset:16 sc1
buffer_load_dwordx4 v[200:203], v8, s[4:7], s38 offen offset:256 sc1
buffer_load_dwordx4 v[204:207], v8, s[4:7], s38 offen offset:272 sc1
buffer_load_dwordx4 v[208:211], v8, s[4:7], s38 offen offset:512 sc1
buffer_load_dwordx4 v[212:215], v8, s[4:7], s38 offen offset:528 sc1
buffer_load_dwordx4 v[216:219], v8, s[4:7], s38 offen offset:768 sc1
buffer_load_dwordx4 v[220:223], v8, s[4:7], s38 offen offset:784 sc1
s_mov_b32 s38, 3162112
buffer_load_dwordx4 v[160:163], v8, s[4:7], s38 offen offset:0 sc1
buffer_load_dwordx4 v[164:167], v8, s[4:7], s38 offen offset:16 sc1
buffer_load_dwordx4 v[168:171], v8, s[4:7], s38 offen offset:256 sc1
buffer_load_dwordx4 v[172:175], v8, s[4:7], s38 offen offset:272 sc1
buffer_load_dwordx4 v[176:179], v8, s[4:7], s38 offen offset:512 sc1
buffer_load_dwordx4 v[180:183], v8, s[4:7], s38 offen offset:528 sc1
buffer_load_dwordx4 v[184:187], v8, s[4:7], s38 offen offset:768 sc1
buffer_load_dwordx4 v[188:191], v8, s[4:7], s38 offen offset:784 sc1
s_waitcnt vmcnt(0)
v_pk_add_f32 v[160:161], v[160:161], 1.0 op_sel_hi:[1,0]
v_pk_add_f32 v[162:163], v[162:163], 1.0 op_sel_hi:[1,0]
v_pk_add_f32 v[164:165], v[164:165], 1.0 op_sel_hi:[1,0]
v_pk_add_f32 v[166:167], v[166:167], 1.0 op_sel_hi:[1,0]
v_pk_add_f32 v[168:169], v[168:169], 1.0 op_sel_hi:[1,0]
v_pk_add_f32 v[170:171], v[170:171], 1.0 op_sel_hi:[1,0]
v_pk_add_f32 v[172:173], v[172:173], 1.0 op_sel_hi:[1,0]
v_pk_add_f32 v[174:175], v[174:175], 1.0 op_sel_hi:[1,0]
v_pk_add_f32 v[176:177], v[176:177], 1.0 op_sel_hi:[1,0]
v_pk_add_f32 v[178:179], v[178:179], 1.0 op_sel_hi:[1,0]
v_pk_add_f32 v[180:181], v[180:181], 1.0 op_sel_hi:[1,0]
v_pk_add_f32 v[182:183], v[182:183], 1.0 op_sel_hi:[1,0]
v_pk_add_f32 v[184:185], v[184:185], 1.0 op_sel_hi:[1,0]
v_pk_add_f32 v[186:187], v[186:187], 1.0 op_sel_hi:[1,0]
v_pk_add_f32 v[188:189], v[188:189], 1.0 op_sel_hi:[1,0]
v_pk_add_f32 v[190:191], v[190:191], 1.0 op_sel_hi:[1,0]
s_lshr_b32 s36, s26, 2
Lln_650:
s_lshl_b32 s49, s36, 16
buffer_load_dwordx4 v[80:83], v7, s[88:91], s49 offen offset:0
buffer_load_dwordx4 v[84:87], v7, s[88:91], s49 offen offset:128
buffer_load_dwordx4 v[88:91], v7, s[88:91], s49 offen offset:256
buffer_load_dwordx4 v[92:95], v7, s[88:91], s49 offen offset:384
s_add_u32 s48, s36, 1
s_cmp_lg_u32 s32, 0
s_cbranch_scc1 Llo_651
Lbw_652:
buffer_load_dword v3, v2, s[4:7], s47 offen sc1
s_waitcnt vmcnt(0)
v_cmp_gt_u32 vcc, s48, v3
s_cbranch_vccz Lbo_653
s_sub_u32 s37, s37, 1
s_cbranch_scc1 Lend_7
s_sleep 2
s_branch Lbw_652
Lbo_653:
Llo_651:
s_waitcnt vmcnt(0)
s_barrier
Lla_654:
s_add_u32 s39, s49, 117440512
buffer_load_dwordx4 v[16:19], v6, s[4:7], s39 offen sc1
s_add_u32 s39, s49, 121634816
buffer_load_dwordx4 v[20:23], v6, s[4:7], s39 offen sc1
s_add_u32 s39, s49, 125829120
buffer_load_dwordx4 v[24:27], v6, s[4:7], s39 offen sc1
s_add_u32 s39, s49, 130023424
buffer_load_dwordx4 v[28:31], v6, s[4:7], s39 offen sc1
s_add_u32 s39, s49, 117444608
buffer_load_dwordx4 v[32:35], v6, s[4:7], s39 offen sc1
s_add_u32 s39, s49, 121638912
buffer_load_dwordx4 v[36:39], v6, s[4:7], s39 offen sc1
s_add_u32 s39, s49, 125833216
buffer_load_dwordx4 v[40:43], v6, s[4:7], s39 offen sc1
s_add_u32 s39, s49, 130027520
buffer_load_dwordx4 v[44:47], v6, s[4:7], s39 offen sc1
s_add_u32 s39, s49, 117448704
buffer_load_dwordx4 v[48:51], v6, s[4:7], s39 offen sc1
s_add_u32 s39, s49, 121643008
buffer_load_dwordx4 v[52:55], v6, s[4:7], s39 offen sc1
s_add_u32 s39, s49, 125837312
buffer_load_dwordx4 v[56:59], v6, s[4:7], s39 offen sc1
s_add_u32 s39, s49, 130031616
buffer_load_dwordx4 v[60:63], v6, s[4:7], s39 offen sc1
s_add_u32 s39, s49, 117452800
buffer_load_dwordx4 v[64:67], v6, s[4:7], s39 offen sc1
s_add_u32 s39, s49, 121647104
buffer_load_dwordx4 v[68:71], v6, s[4:7], s39 offen sc1
s_add_u32 s39, s49, 125841408
buffer_load_dwordx4 v[72:75], v6, s[4:7], s39 offen sc1
s_add_u32 s39, s49, 130035712
buffer_load_dwordx4 v[76:79], v6, s[4:7], s39 offen sc1
s_cmp_lt_u32 s36, 60
s_cbranch_scc1 Lls_655
s_sub_u32 s37, s37, 1
s_cbranch_scc1 Lend_7
v_mov_b32 v224, 0
s_waitcnt vmcnt(12)
v_max3_u32 v224, v224, v16, v17
v_max3_u32 v224, v224, v18, v19
v_max3_u32 v224, v224, v20, v21
v_max3_u32 v224, v224, v22, v23
v_max3_u32 v224, v224, v24, v25
v_max3_u32 v224, v224, v26, v27
v_max3_u32 v224, v224, v28, v29
v_max3_u32 v224, v224, v30, v31
s_waitcnt vmcnt(8)
v_max3_u32 v224, v224, v32, v33
v_max3_u32 v224, v224, v34, v35
v_max3_u32 v224, v224, v36, v37
v_max3_u32 v224, v224, v38, v39
v_max3_u32 v224, v224, v40, v41
v_max3_u32 v224, v224, v42, v43
v_max3_u32 v224, v224, v44, v45
v_max3_u32 v224, v224, v46, v47
s_waitcnt vmcnt(4)
v_max3_u32 v224, v224, v48, v49
v_max3_u32 v224, v224, v50, v51
v_max3_u32 v224, v224, v52, v53
v_max3_u32 v224, v224, v54, v55
v_max3_u32 v224, v224, v56, v57
v_max3_u32 v224, v224, v58, v59
v_max3_u32 v224, v224, v60, v61
v_max3_u32 v224, v224, v62, v63
s_waitcnt vmcnt(0)
v_max3_u32 v224, v224, v64, v65
v_max3_u32 v224, v224, v66, v67
v_max3_u32 v224, v224, v68, v69
v_max3_u32 v224, v224, v70, v71
v_max3_u32 v224, v224, v72, v73
v_max3_u32 v224, v224, v74, v75
v_max3_u32 v224, v224, v76, v77
v_max3_u32 v224, v224, v78, v79
v_cmp_eq_u32 vcc, -1, v224
s_cbranch_vccnz Lla_654
Lls_655:
v_lshlrev_b32 v96, 16, v80
v_and_b32 v97, 0xffff0000, v80
v_lshlrev_b32 v98, 16, v81
v_and_b32 v99, 0xffff0000, v81
v_lshlrev_b32 v100, 16, v82
v_and_b32 v101, 0xffff0000, v82
v_lshlrev_b32 v102, 16, v83
v_and_b32 v103, 0xffff0000, v83
v_lshlrev_b32 v104, 16, v84
v_and_b32 v105, 0xffff0000, v84
v_lshlrev_b32 v106, 16, v85
v_and_b32 v107, 0xffff0000, v85
v_lshlrev_b32 v108, 16, v86
v_and_b32 v109, 0xffff0000, v86
v_lshlrev_b32 v110, 16, v87
v_and_b32 v111, 0xffff0000, v87
v_lshlrev_b32 v112, 16, v88
v_and_b32 v113, 0xffff0000, v88
v_lshlrev_b32 v114, 16, v89
v_and_b32 v115, 0xffff0000, v89
v_lshlrev_b32 v116, 16, v90
v_and_b32 v117, 0xffff0000, v90
v_lshlrev_b32 v118, 16, v91
v_and_b32 v119, 0xffff0000, v91
v_lshlrev_b32 v120, 16, v92
v_and_b32 v121, 0xffff0000, v92
v_lshlrev_b32 v122, 16, v93
v_and_b32 v123, 0xffff0000, v93
v_lshlrev_b32 v124, 16, v94
v_and_b32 v125, 0xffff0000, v94
v_lshlrev_b32 v126, 16, v95
v_and_b32 v127, 0xffff0000, v95
s_waitcnt vmcnt(12)
v_dot2_f32_bf16 v224, v16, s60, 0
v_dot2_f32_bf16 v225, v16, s61, 0
v_dot2_f32_bf16 v226, v17, s60, 0
v_dot2_f32_bf16 v227, v17, s61, 0
v_dot2_f32_bf16 v228, v18, s60, 0
v_dot2_f32_bf16 v229, v18, s61, 0
v_dot2_f32_bf16 v230, v19, s60, 0
v_dot2_f32_bf16 v231, v19, s61, 0
v_dot2_f32_bf16 v224, v20, s60, v224
v_dot2_f32_bf16 v225, v20, s61, v225
v_dot2_f32_bf16 v226, v21, s60, v226
v_dot2_f32_bf16 v227, v21, s61, v227
v_dot2_f32_bf16 v228, v22, s60, v228
v_dot2_f32_bf16 v229, v22, s61, v229
v_dot2_f32_bf16 v230, v23, s60, v230
v_dot2_f32_bf16 v231, v23, s61, v231
v_dot2_f32_bf16 v224, v24, s60, v224
v_dot2_f32_bf16 v225, v24, s61, v225
v_dot2_f32_bf16 v226, v25, s60, v226
v_dot2_f32_bf16 v227, v25, s61, v227
v_dot2_f32_bf16 v228, v26, s60, v228
v_dot2_f32_bf16 v229, v26, s61, v229
v_dot2_f32_bf16 v230, v27, s60, v230
v_dot2_f32_bf16 v231, v27, s61, v231
v_dot2_f32_bf16 v224, v28, s60, v224
v_dot2_f32_bf16 v225, v28, s61, v225
v_dot2_f32_bf16 v226, v29, s60, v226
v_dot2_f32_bf16 v227, v29, s61, v227
v_dot2_f32_bf16 v228, v30, s60, v228
v_dot2_f32_bf16 v229, v30, s61, v229
v_dot2_f32_bf16 v230, v31, s60, v230
v_dot2_f32_bf16 v231, v31, s61, v231
s_nop 1
v_pk_fma_f32 v[96:97], v[224:225], v[128:129], v[96:97]
v_pk_fma_f32 v[98:99], v[226:227], v[130:131], v[98:99]
v_pk_fma_f32 v[100:101], v[228:229], v[132:133], v[100:101]
v_pk_fma_f32 v[102:103], v[230:231], v[134:135], v[102:103]
v_cvt_pk_bf16_f32 v80, v96, v97
v_cvt_pk_bf16_f32 v81, v98, v99
v_cvt_pk_bf16_f32 v82, v100, v101
v_cvt_pk_bf16_f32 v83, v102, v103
s_add_u32 s39, s49, 12582912
buffer_store_dwordx4 v[80:83], v6, s[4:7], s39 offen sc1
v_lshlrev_b32 v96, 16, v80
v_and_b32 v97, 0xffff0000, v80
v_lshlrev_b32 v98, 16, v81
v_and_b32 v99, 0xffff0000, v81
v_lshlrev_b32 v100, 16, v82
v_and_b32 v101, 0xffff0000, v82
v_lshlrev_b32 v102, 16, v83
v_and_b32 v103, 0xffff0000, v83
v_pk_mul_f32 v[232:233], v[96:97], 1.0 op_sel_hi:[1,0]
v_pk_mul_f32 v[234:235], v[96:97], v[96:97]
v_pk_add_f32 v[232:233], v[232:233], v[98:99]
v_pk_fma_f32 v[234:235], v[98:99], v[98:99], v[234:235]
v_pk_add_f32 v[232:233], v[232:233], v[100:101]
v_pk_fma_f32 v[234:235], v[100:101], v[100:101], v[234:235]
v_pk_add_f32 v[232:233], v[232:233], v[102:103]
v_pk_fma_f32 v[234:235], v[102:103], v[102:103], v[234:235]
s_waitcnt vmcnt(9)
v_dot2_f32_bf16 v224, v32, s60, 0
v_dot2_f32_bf16 v225, v32, s61, 0
v_dot2_f32_bf16 v226, v33, s60, 0
v_dot2_f32_bf16 v227, v33, s61, 0
v_dot2_f32_bf16 v228, v34, s60, 0
v_dot2_f32_bf16 v229, v34, s61, 0
v_dot2_f32_bf16 v230, v35, s60, 0
v_dot2_f32_bf16 v231, v35, s61, 0
v_dot2_f32_bf16 v224, v36, s60, v224
v_dot2_f32_bf16 v225, v36, s61, v225
v_dot2_f32_bf16 v226, v37, s60, v226
v_dot2_f32_bf16 v227, v37, s61, v227
v_dot2_f32_bf16 v228, v38, s60, v228
v_dot2_f32_bf16 v229, v38, s61, v229
v_dot2_f32_bf16 v230, v39, s60, v230
v_dot2_f32_bf16 v231, v39, s61, v231
v_dot2_f32_bf16 v224, v40, s60, v224
v_dot2_f32_bf16 v225, v40, s61, v225
v_dot2_f32_bf16 v226, v41, s60, v226
v_dot2_f32_bf16 v227, v41, s61, v227
v_dot2_f32_bf16 v228, v42, s60, v228
v_dot2_f32_bf16 v229, v42, s61, v229
v_dot2_f32_bf16 v230, v43, s60, v230
v_dot2_f32_bf16 v231, v43, s61, v231
v_dot2_f32_bf16 v224, v44, s60, v224
v_dot2_f32_bf16 v225, v44, s61, v225
v_dot2_f32_bf16 v226, v45, s60, v226
v_dot2_f32_bf16 v227, v45, s61, v227
v_dot2_f32_bf16 v228, v46, s60, v228
v_dot2_f32_bf16 v229, v46, s61, v229
v_dot2_f32_bf16 v230, v47, s60, v230
v_dot2_f32_bf16 v231, v47, s61, v231
s_nop 1
v_pk_fma_f32 v[104:105], v[224:225], v[136:137], v[104:105]
v_pk_fma_f32 v[106:107], v[226:227], v[138:139], v[106:107]
v_pk_fma_f32 v[108:109], v[228:229], v[140:141], v[108:109]
v_pk_fma_f32 v[110:111], v[230:231], v[142:143], v[110:111]
v_cvt_pk_bf16_f32 v84, v104, v105
v_cvt_pk_bf16_f32 v85, v106, v107
v_cvt_pk_bf16_f32 v86, v108, v109
v_cvt_pk_bf16_f32 v87, v110, v111
s_add_u32 s39, s49, 12587008
buffer_store_dwordx4 v[84:87], v6, s[4:7], s39 offen sc1
v_lshlrev_b32 v104, 16, v84
v_and_b32 v105, 0xffff0000, v84
v_lshlrev_b32 v106, 16, v85
v_and_b32 v107, 0xffff0000, v85
v_lshlrev_b32 v108, 16, v86
v_and_b32 v109, 0xffff0000, v86
v_lshlrev_b32 v110, 16, v87
v_and_b32 v111, 0xffff0000, v87
v_pk_add_f32 v[232:233], v[232:233], v[104:105]
v_pk_fma_f32 v[234:235], v[104:105], v[104:105], v[234:235]
v_pk_add_f32 v[232:233], v[232:233], v[106:107]
v_pk_fma_f32 v[234:235], v[106:107], v[106:107], v[234:235]
v_pk_add_f32 v[232:233], v[232:233], v[108:109]
v_pk_fma_f32 v[234:235], v[108:109], v[108:109], v[234:235]
v_pk_add_f32 v[232:233], v[232:233], v[110:111]
v_pk_fma_f32 v[234:235], v[110:111], v[110:111], v[234:235]
s_waitcnt vmcnt(6)
v_dot2_f32_bf16 v224, v48, s60, 0
v_dot2_f32_bf16 v225, v48, s61, 0
v_dot2_f32_bf16 v226, v49, s60, 0
v_dot2_f32_bf16 v227, v49, s61, 0
v_dot2_f32_bf16 v228, v50, s60, 0
v_dot2_f32_bf16 v229, v50, s61, 0
v_dot2_f32_bf16 v230, v51, s60, 0
v_dot2_f32_bf16 v231, v51, s61, 0
v_dot2_f32_bf16 v224, v52, s60, v224
v_dot2_f32_bf16 v225, v52, s61, v225
v_dot2_f32_bf16 v226, v53, s60, v226
v_dot2_f32_bf16 v227, v53, s61, v227
v_dot2_f32_bf16 v228, v54, s60, v228
v_dot2_f32_bf16 v229, v54, s61, v229
v_dot2_f32_bf16 v230, v55, s60, v230
v_dot2_f32_bf16 v231, v55, s61, v231
v_dot2_f32_bf16 v224, v56, s60, v224
v_dot2_f32_bf16 v225, v56, s61, v225
v_dot2_f32_bf16 v226, v57, s60, v226
v_dot2_f32_bf16 v227, v57, s61, v227
v_dot2_f32_bf16 v228, v58, s60, v228
v_dot2_f32_bf16 v229, v58, s61, v229
v_dot2_f32_bf16 v230, v59, s60, v230
v_dot2_f32_bf16 v231, v59, s61, v231
v_dot2_f32_bf16 v224, v60, s60, v224
v_dot2_f32_bf16 v225, v60, s61, v225
v_dot2_f32_bf16 v226, v61, s60, v226
v_dot2_f32_bf16 v227, v61, s61, v227
v_dot2_f32_bf16 v228, v62, s60, v228
v_dot2_f32_bf16 v229, v62, s61, v229
v_dot2_f32_bf16 v230, v63, s60, v230
v_dot2_f32_bf16 v231, v63, s61, v231
s_nop 1
v_pk_fma_f32 v[112:113], v[224:225], v[144:145], v[112:113]
v_pk_fma_f32 v[114:115], v[226:227], v[146:147], v[114:115]
v_pk_fma_f32 v[116:117], v[228:229], v[148:149], v[116:117]
v_pk_fma_f32 v[118:119], v[230:231], v[150:151], v[118:119]
v_cvt_pk_bf16_f32 v88, v112, v113
v_cvt_pk_bf16_f32 v89, v114, v115
v_cvt_pk_bf16_f32 v90, v116, v117
v_cvt_pk_bf16_f32 v91, v118, v119
s_add_u32 s39, s49, 12591104
buffer_store_dwordx4 v[88:91], v6, s[4:7], s39 offen sc1
v_lshlrev_b32 v112, 16, v88
v_and_b32 v113, 0xffff0000, v88
v_lshlrev_b32 v114, 16, v89
v_and_b32 v115, 0xffff0000, v89
v_lshlrev_b32 v116, 16, v90
v_and_b32 v117, 0xffff0000, v90
v_lshlrev_b32 v118, 16, v91
v_and_b32 v119, 0xffff0000, v91
v_pk_add_f32 v[232:233], v[232:233], v[112:113]
v_pk_fma_f32 v[234:235], v[112:113], v[112:113], v[234:235]
v_pk_add_f32 v[232:233], v[232:233], v[114:115]
v_pk_fma_f32 v[234:235], v[114:115], v[114:115], v[234:235]
v_pk_add_f32 v[232:233], v[232:233], v[116:117]
v_pk_fma_f32 v[234:235], v[116:117], v[116:117], v[234:235]
v_pk_add_f32 v[232:233], v[232:233], v[118:119]
v_pk_fma_f32 v[234:235], v[118:119], v[118:119], v[234:235]
s_waitcnt vmcnt(3)
v_dot2_f32_bf16 v224, v64, s60, 0
v_dot2_f32_bf16 v225, v64, s61, 0
v_dot2_f32_bf16 v226, v65, s60, 0
v_dot2_f32_bf16 v227, v65, s61, 0
v_dot2_f32_bf16 v228, v66, s60, 0
v_dot2_f32_bf16 v229, v66, s61, 0
v_dot2_f32_bf16 v230, v67, s60, 0
v_dot2_f32_bf16 v231, v67, s61, 0
v_dot2_f32_bf16 v224, v68, s60, v224
v_dot2_f32_bf16 v225, v68, s61, v225
v_dot2_f32_bf16 v226, v69, s60, v226
v_dot2_f32_bf16 v227, v69, s61, v227
v_dot2_f32_bf16 v228, v70, s60, v228
v_dot2_f32_bf16 v229, v70, s61, v229
v_dot2_f32_bf16 v230, v71, s60, v230
v_dot2_f32_bf16 v231, v71, s61, v231
v_dot2_f32_bf16 v224, v72, s60, v224
v_dot2_f32_bf16 v225, v72, s61, v225
v_dot2_f32_bf16 v226, v73, s60, v226
v_dot2_f32_bf16 v227, v73, s61, v227
v_dot2_f32_bf16 v228, v74, s60, v228
v_dot2_f32_bf16 v229, v74, s61, v229
v_dot2_f32_bf16 v230, v75, s60, v230
v_dot2_f32_bf16 v231, v75, s61, v231
v_dot2_f32_bf16 v224, v76, s60, v224
v_dot2_f32_bf16 v225, v76, s61, v225
v_dot2_f32_bf16 v226, v77, s60, v226
v_dot2_f32_bf16 v227, v77, s61, v227
v_dot2_f32_bf16 v228, v78, s60, v228
v_dot2_f32_bf16 v229, v78, s61, v229
v_dot2_f32_bf16 v230, v79, s60, v230
v_dot2_f32_bf16 v231, v79, s61, v231
s_nop 1
v_pk_fma_f32 v[120:121], v[224:225], v[152:153], v[120:121]
v_pk_fma_f32 v[122:123], v[226:227], v[154:155], v[122:123]
v_pk_fma_f32 v[124:125], v[228:229], v[156:157], v[124:125]
v_pk_fma_f32 v[126:127], v[230:231], v[158:159], v[126:127]
v_cvt_pk_bf16_f32 v92, v120, v121
v_cvt_pk_bf16_f32 v93, v122, v123
v_cvt_pk_bf16_f32 v94, v124, v125
v_cvt_pk_bf16_f32 v95, v126, v127
s_add_u32 s39, s49, 12595200
buffer_store_dwordx4 v[92:95], v6, s[4:7], s39 offen sc1
v_lshlrev_b32 v120, 16, v92
v_and_b32 v121, 0xffff0000, v92
v_lshlrev_b32 v122, 16, v93
v_and_b32 v123, 0xffff0000, v93
v_lshlrev_b32 v124, 16, v94
v_and_b32 v125, 0xffff0000, v94
v_lshlrev_b32 v126, 16, v95
v_and_b32 v127, 0xffff0000, v95
v_pk_add_f32 v[232:233], v[232:233], v[120:121]
v_pk_fma_f32 v[234:235], v[120:121], v[120:121], v[234:235]
v_pk_add_f32 v[232:233], v[232:233], v[122:123]
v_pk_fma_f32 v[234:235], v[122:123], v[122:123], v[234:235]
v_pk_add_f32 v[232:233], v[232:233], v[124:125]
v_pk_fma_f32 v[234:235], v[124:125], v[124:125], v[234:235]
v_pk_add_f32 v[232:233], v[232:233], v[126:127]
v_pk_fma_f32 v[234:235], v[126:127], v[126:127], v[234:235]
v_add_f32 v232, v232, v233
v_add_f32 v233, v234, v235
s_nop 1
v_add_f32_dpp v232, v232, v232 row_ror:8 row_mask:0xf bank_mask:0xf
v_add_f32_dpp v233, v233, v233 row_ror:8 row_mask:0xf bank_mask:0xf
v_mov_b32 v234, v232
v_mov_b32 v235, v233
s_nop 1
v_permlane16_swap_b32 v232, v234
v_permlane16_swap_b32 v233, v235
v_add_f32 v232, v232, v234
v_add_f32 v233, v233, v235
v_mov_b32 v234, v232
v_mov_b32 v235, v233
s_nop 1
v_permlane32_swap_b32 v232, v234
v_permlane32_swap_b32 v233, v235
v_add_f32 v232, v232, v234
v_add_f32 v233, v233, v235
ds_write_b64 v11, v[232:233] offset:2048
s_waitcnt lgkmcnt(0)
s_barrier
ds_read_b128 v[232:235], v12 offset:2048
ds_read_b128 v[236:239], v12 offset:2064
v_xor_b32 v11, 512, v11
v_xor_b32 v12, 512, v12
s_mov_b32 s38, 0x3a800000
s_waitcnt lgkmcnt(0)
v_pk_add_f32 v[232:233], v[232:233], v[234:235]
v_pk_add_f32 v[236:237], v[236:237], v[238:239]
v_pk_add_f32 v[232:233], v[232:233], v[236:237]
v_pk_mul_f32 v[232:233], v[232:233], s[38:39] op_sel_hi:[1,0]
v_fma_f32 v233, -v232, v232, v233
v_max_f32 v233, 0, v233
v_add_f32 v233, 0x3727c5ac, v233
v_rsq_f32 v233, v233
s_nop 0
v_mul_f32 v232, -v232, v233
v_pk_fma_f32 v[96:97], v[96:97], v[232:233], v[232:233] op_sel:[0,1,0] op_sel_hi:[1,1,0]
v_pk_fma_f32 v[98:99], v[98:99], v[232:233], v[232:233] op_sel:[0,1,0] op_sel_hi:[1,1,0]
v_pk_fma_f32 v[100:101], v[100:101], v[232:233], v[232:233] op_sel:[0,1,0] op_sel_hi:[1,1,0]
v_pk_fma_f32 v[102:103], v[102:103], v[232:233], v[232:233] op_sel:[0,1,0] op_sel_hi:[1,1,0]
v_pk_fma_f32 v[104:105], v[104:105], v[232:233], v[232:233] op_sel:[0,1,0] op_sel_hi:[1,1,0]
v_pk_fma_f32 v[106:107], v[106:107], v[232:233], v[232:233] op_sel:[0,1,0] op_sel_hi:[1,1,0]
v_pk_fma_f32 v[108:109], v[108:109], v[232:233], v[232:233] op_sel:[0,1,0] op_sel_hi:[1,1,0]
v_pk_fma_f32 v[110:111], v[110:111], v[232:233], v[232:233] op_sel:[0,1,0] op_sel_hi:[1,1,0]
v_pk_fma_f32 v[112:113], v[112:113], v[232:233], v[232:233] op_sel:[0,1,0] op_sel_hi:[1,1,0]
v_pk_fma_f32 v[114:115], v[114:115], v[232:233], v[232:233] op_sel:[0,1,0] op_sel_hi:[1,1,0]
v_pk_fma_f32 v[116:117], v[116:117], v[232:233], v[232:233] op_sel:[0,1,0] op_sel_hi:[1,1,0]
v_pk_fma_f32 v[118:119], v[118:119], v[232:233], v[232:233] op_sel:[0,1,0] op_sel_hi:[1,1,0]
v_pk_fma_f32 v[120:121], v[120:121], v[232:233], v[232:233] op_sel:[0,1,0] op_sel_hi:[1,1,0]
v_pk_fma_f32 v[122:123], v[122:123], v[232:233], v[232:233] op_sel:[0,1,0] op_sel_hi:[1,1,0]
v_pk_fma_f32 v[124:125], v[124:125], v[232:233], v[232:233] op_sel:[0,1,0] op_sel_hi:[1,1,0]
v_pk_fma_f32 v[126:127], v[126:127], v[232:233], v[232:233] op_sel:[0,1,0] op_sel_hi:[1,1,0]
v_pk_fma_f32 v[96:97], v[96:97], v[160:161], v[192:193]
v_pk_fma_f32 v[98:99], v[98:99], v[162:163], v[194:195]
v_pk_fma_f32 v[100:101], v[100:101], v[164:165], v[196:197]
v_pk_fma_f32 v[102:103], v[102:103], v[166:167], v[198:199]
v_cvt_pk_bf16_f32 v16, v96, v97
v_cvt_pk_bf16_f32 v17, v98, v99
v_cvt_pk_bf16_f32 v18, v100, v101
v_cvt_pk_bf16_f32 v19, v102, v103
s_add_u32 s39, s49, 16777216
buffer_store_dwordx4 v[16:19], v6, s[4:7], s39 offen sc1
v_pk_fma_f32 v[104:105], v[104:105], v[168:169], v[200:201]
v_pk_fma_f32 v[106:107], v[106:107], v[170:171], v[202:203]
v_pk_fma_f32 v[108:109], v[108:109], v[172:173], v[204:205]
v_pk_fma_f32 v[110:111], v[110:111], v[174:175], v[206:207]
v_cvt_pk_bf16_f32 v20, v104, v105
v_cvt_pk_bf16_f32 v21, v106, v107
v_cvt_pk_bf16_f32 v22, v108, v109
v_cvt_pk_bf16_f32 v23, v110, v111
s_add_u32 s39, s49, 16781312
buffer_store_dwordx4 v[20:23], v6, s[4:7], s39 offen sc1
v_pk_fma_f32 v[112:113], v[112:113], v[176:177], v[208:209]
v_pk_fma_f32 v[114:115], v[114:115], v[178:179], v[210:211]
v_pk_fma_f32 v[116:117], v[116:117], v[180:181], v[212:213]
v_pk_fma_f32 v[118:119], v[118:119], v[182:183], v[214:215]
v_cvt_pk_bf16_f32 v24, v112, v113
v_cvt_pk_bf16_f32 v25, v114, v115
v_cvt_pk_bf16_f32 v26, v116, v117
v_cvt_pk_bf16_f32 v27, v118, v119
s_add_u32 s39, s49, 16785408
buffer_store_dwordx4 v[24:27], v6, s[4:7], s39 offen sc1
v_pk_fma_f32 v[120:121], v[120:121], v[184:185], v[216:217]
v_pk_fma_f32 v[122:123], v[122:123], v[186:187], v[218:219]
v_pk_fma_f32 v[124:125], v[124:125], v[188:189], v[220:221]
v_pk_fma_f32 v[126:127], v[126:127], v[190:191], v[222:223]
v_cvt_pk_bf16_f32 v28, v120, v121
v_cvt_pk_bf16_f32 v29, v122, v123
v_cvt_pk_bf16_f32 v30, v124, v125
v_cvt_pk_bf16_f32 v31, v126, v127
s_add_u32 s39, s49, 16789504
buffer_store_dwordx4 v[28:31], v6, s[4:7], s39 offen sc1
v_mov_b32 v5, s48
s_waitcnt vmcnt(0)
s_barrier
buffer_store_dword v5, v4, s[4:7], 0 offen sc1
s_add_u32 s36, s36, 2
s_cmp_lt_u32 s36, 64
s_cbranch_scc1 Lln_650
s_endpgm
Lcode_end:

.section .rodata,"a"
.p2align 6
.amdhsa_kernel adaLN_cond__memory_aug_recurrent_mem_tr__glu_gated_swiglu__prompt_kernel
  .amdhsa_next_free_vgpr 512
  .amdhsa_next_free_sgpr 102
  .amdhsa_accum_offset 256
  .amdhsa_group_segment_fixed_size 0
  .amdhsa_kernarg_size 128
  .amdhsa_user_sgpr_count 2
  .amdhsa_user_sgpr_kernarg_segment_ptr 1
  .amdhsa_system_sgpr_workgroup_id_x 1
  .amdhsa_float_denorm_mode_32 3
.end_amdhsa_kernel
```

```asm
; @launch grid=(256,1,1) block=(256,1,1) lds=163840
.amdgcn_target "amdgcn-amd-amdhsa--gfx950"
.text
.globl adaLN_cond__memory_aug_recurrent_mem_tr__glu_gated_swiglu__prompt_kernel
.p2align 8
.type adaLN_cond__memory_aug_recurrent_mem_tr__glu_gated_swiglu__prompt_kernel,@function
adaLN_cond__memory_aug_recurrent_mem_tr__glu_gated_swiglu__prompt_kernel:
s_cmp_ge_u32 s2, 256
s_cbranch_scc1 Lend_1
s_load_dwordx8 s[16:23], s[0:1], 8
s_load_dwordx2 s[24:25], s[0:1], 40
s_load_dwordx4 s[28:31], s[0:1], 112
s_getreg_b32 s51, hwreg(HW_REG_XCC_ID, 0, 4)
s_and_b32 s51, s51, 7
v_lshrrev_b32 v1, 6, v0
s_nop 0
v_readfirstlane_b32 s32, v1
v_and_b32 v1, 63, v0
s_waitcnt lgkmcnt(0)
s_mov_b32 s4, s30
s_and_b32 s5, s31, 0xffff
s_mov_b32 s6, 0x10000000
s_mov_b32 s7, 0x20000
s_mov_b32 s12, s28
s_and_b32 s13, s29, 0xffff
s_mov_b32 s14, 0x100
s_mov_b32 s15, 0x20000
s_mov_b32 s37, 200000
s_mov_b32 s80, 0
s_mov_b32 s81, 0
s_mov_b32 s82, 0
s_mov_b32 s83, 0
s_cmp_lg_u32 s32, 0
s_cbranch_scc1 Lrs_10
s_mov_b32 s33, s51
s_mov_b32 s35, 0
s_mov_b64 exec, 1
Lrl_9:
v_lshlrev_b32 v2, 5, s33
v_mov_b32 v3, 1
buffer_atomic_add v3, v2, s[12:15], 0 offen sc0 sc1
s_waitcnt vmcnt(0)
v_readfirstlane_b32 s34, v3
s_nop 3
s_cmp_lt_u32 s34, 32
s_cbranch_scc1 Lrg_8
s_add_u32 s33, s33, 1
s_and_b32 s33, s33, 7
s_add_u32 s35, s35, 1
s_cmp_lt_u32 s35, 8
s_cbranch_scc1 Lrl_9
Lrg_8:
s_lshl_b32 s38, s33, 8
s_min_u32 s34, s34, 255
s_or_b32 s38, s38, s34
s_lshl_b32 s39, s35, 16
s_or_b32 s38, s38, s39
v_mov_b32 v3, s38
v_mov_b32 v2, 0
ds_write_b32 v2, v3
s_mov_b64 exec, -1
Lrs_10:
s_waitcnt lgkmcnt(0)
s_barrier
v_mov_b32 v2, 0
ds_read_b32 v3, v2
s_waitcnt lgkmcnt(0)
v_readfirstlane_b32 s38, v3
s_barrier
s_and_b32 s34, s38, 255
s_bfe_u32 s33, s38, 0x80008
s_lshr_b32 s35, s38, 16
s_min_u32 s35, s35, 1
s_cmp_ge_u32 s34, 32
s_cbranch_scc1 Lend_1
s_cmp_ge_u32 s33, 4
s_cselect_b32 s38, 0, 8
s_add_u32 s34, s34, s38
s_and_b32 s34, s34, 31
s_getpc_b64 s[40:41]
Lcode_here:
s_lshl_b32 s42, s34, 12
v_lshl_add_u32 v2, v0, 4, s42
v_min_u32 v2, Lcode_end-Lcode_here-16, v2
v_mov_b32 v3, s41
v_add_co_u32 v2, vcc, s40, v2
s_nop 1
v_addc_co_u32 v3, vcc, 0, v3, vcc
global_load_dword v255, v[2:3], off
s_cmp_ge_u32 s33, 4
s_cbranch_scc1 Lhi_4
s_cmp_ge_u32 s34, 24
s_cbranch_scc1 Lg3_3
s_cmp_ge_u32 s34, 8
s_cbranch_scc1 Lkvo_2
v_mov_b32 v48, v0
v_mov_b32 v50, v1
s_lshl_b32 s54, s33, 3
s_add_u32 s54, s54, s34
s_and_b32 s55, s32, 1
s_lshr_b32 s56, s32, 1
s_lshl_b32 s45, s33, 18
s_add_u32 s45, s45, 2097152
s_lshl_b32 s38, s32, 12
v_lshl_add_u32 v10, v50, 4, s38
s_lshl_b32 s38, s34, 11
s_add_u32 s39, s38, 16384
v_lshl_add_u32 v11, v50, 4, s39
s_lshl_b32 s39, s56, 10
s_add_u32 s38, s38, s39
s_lshl_b32 s39, s55, 9
s_add_u32 s39, s39, s38
s_add_u32 s39, s39, 32768
v_lshl_add_u32 v12, v50, 3, s39
v_xor_b32 v13, 512, v12
s_add_u32 s39, s39, 16384
v_mov_b32 v14, s39
v_bfe_u32 v51, v50, 5, 1
v_lshl_add_u32 v14, v51, 8, v14
v_bfe_u32 v51, v50, 1, 2
v_lshl_add_u32 v14, v51, 6, v14
v_bfe_u32 v51, v50, 4, 1
v_lshl_add_u32 v14, v51, 5, v14
v_bfe_u32 v51, v50, 0, 1
v_lshl_add_u32 v14, v51, 4, v14
v_bfe_u32 v51, v50, 3, 1
v_lshl_add_u32 v14, v51, 30, v14
v_bfe_u32 v15, v50, 1, 1
v_mul_u32_u24 v15, 0xaaaa, v15
v_add_u32 v15, 0x4444, v15
v_mov_b32 v200, 0
v_mov_b32 v201, 0
v_mov_b32 v202, 0
v_mov_b32 v203, 0
v_mov_b32 v204, 0
v_mov_b32 v205, 0
v_mov_b32 v206, 0
v_mov_b32 v207, 0
s_xor_b32 s38, s32, 3
s_mul_i32 s38, s38, 3072
s_add_u32 s38, s38, 0
v_lshl_add_u32 v211, v50, 4, s38
s_xor_b32 s38, s32, 2
s_mul_i32 s38, s38, 3072
s_add_u32 s38, s38, 1024
v_lshl_add_u32 v212, v50, 4, s38
s_xor_b32 s38, s32, 1
s_mul_i32 s38, s38, 3072
s_add_u32 s38, s38, 2048
v_lshl_add_u32 v213, v50, 4, s38
s_mul_i32 s38, s32, 3072
v_lshl_add_u32 v18, v50, 4, s38
s_lshl_b32 s38, s32, 9
v_and_b32 v51, 15, v50
v_lshl_add_u32 v19, v51, 4, s38
v_lshrrev_b32 v51, 4, v50
v_lshl_add_u32 v19, v51, 2, v19
v_lshrrev_b32 v51, 2, v50
v_and_b32 v52, 1, v50
v_lshlrev_b32 v52, 3, v52
v_lshl_add_u32 v20, v51, 4, v52
v_lshlrev_b32 v51, 4, v50
s_mul_i32 s38, s32, 6144
v_add_u32 v21, s38, v51
s_add_u32 s57, s38, 32768
v_add_u32 v22, 40960, v51
s_lshl_b32 s38, s55, 12
s_add_u32 s38, s38, 32768
v_add_u32 v23, s38, v51
s_lshl_b32 s38, s32, 11
s_add_u32 s38, s38, 49152
v_add_u32 v24, s38, v51
v_xor_b32 v25, 2048, v24
s_lshl_b32 s59, s33, 12
s_add_u32 s59, s59, 3276800
s_lshl_b32 s38, s32, 8
v_lshl_add_u32 v192, v50, 2, s38
s_lshr_b32 s38, s34, 1
s_lshl_b32 s38, s38, 8
s_and_b32 s39, s34, 1
s_lshl_b32 s39, s39, 2
s_add_u32 s38, s38, s39
s_add_u32 s38, s38, 2048
v_min_u32 v52, 1, v48
v_lshl_add_u32 v193, v52, 30, s38
v_mov_b32 v197, 0
buffer_store_dword v197, v193, s[4:7], s59 offen sc1
s_lshr_b32 s38, s34, 2
s_lshl_b32 s38, s38, 14
s_and_b32 s39, s34, 3
s_lshl_b32 s39, s39, 11
s_add_u32 s38, s38, s39
s_lshl_b32 s39, s33, 16
s_add_u32 s38, s38, s39
v_lshl_add_u32 v198, v48, 3, s38
s_lshl_b32 s38, s54, 2
s_add_u32 s38, s38, s32
s_lshl_b32 s38, s38, 11
s_lshl_b32 s39, s55, 10
s_add_u32 s38, s38, s39
v_add_u32 v26, s38, v51
v_xor_b32 v27, 2048, v26
s_lshl_b32 s38, s54, 5
s_add_u32 s38, s38, s32
s_lshl_b32 s38, s38, 2
s_add_u32 s38, s38, 3432448
v_min_u32 v52, 1, v50
v_lshl_add_u32 v199, v52, 30, s38
buffer_store_dword v197, v199, s[4:7], 0 offen sc1
v_min_u32 v53, 15, v50
v_lshlrev_b32 v53, 7, v53
s_lshr_b32 s38, s54, 2
s_lshl_b32 s38, s38, 10
s_add_u32 s38, s38, 3407872
v_add_u32 v208, s38, v53
s_lshl_b32 s38, s33, 10
s_add_u32 s38, s38, 3435520
v_add_u32 v53, s38, v53
v_cmp_lt_u32 vcc, 7, v50
s_nop 1
v_cndmask_b32 v208, v208, v53, vcc
v_cndmask_b32 v210, 0, 8, vcc
v_mov_b32 v28, -1
v_mov_b32 v32, 0x3f803f80
v_mov_b32 v29, -1
v_mov_b32 v33, 0x3f803f80
v_mov_b32 v30, -1
v_mov_b32 v34, 0x3f803f80
v_mov_b32 v31, -1
v_mov_b32 v35, 0x3f803f80
v_and_b32 v51, 15, v50
s_lshl_b32 s38, s55, 4
v_add_u32 v51, s38, v51
v_lshrrev_b32 v52, 4, v50
v_lshlrev_b32 v52, 2, v52
v_mov_b32 v54, 0xf149f2ca
v_add_u32 v53, 0, v52
v_cmp_gt_u32 vcc, v53, v51
s_nop 1
v_cndmask_b32 v36, 0, v54, vcc
v_add_u32 v53, 1, v52
v_cmp_gt_u32 vcc, v53, v51
s_nop 1
v_cndmask_b32 v37, 0, v54, vcc
v_add_u32 v53, 2, v52
v_cmp_gt_u32 vcc, v53, v51
s_nop 1
v_cndmask_b32 v38, 0, v54, vcc
v_add_u32 v53, 3, v52
v_cmp_gt_u32 vcc, v53, v51
s_nop 1
v_cndmask_b32 v39, 0, v54, vcc
v_add_u32 v53, 16, v52
v_cmp_gt_u32 vcc, v53, v51
s_nop 1
v_cndmask_b32 v40, 0, v54, vcc
v_add_u32 v53, 17, v52
v_cmp_gt_u32 vcc, v53, v51
s_nop 1
v_cndmask_b32 v41, 0, v54, vcc
v_add_u32 v53, 18, v52
v_cmp_gt_u32 vcc, v53, v51
s_nop 1
v_cndmask_b32 v42, 0, v54, vcc
v_add_u32 v53, 19, v52
v_cmp_gt_u32 vcc, v53, v51
s_nop 1
v_cndmask_b32 v43, 0, v54, vcc
v_mov_b32 v0, 0
v_mov_b32 v1, 0
v_mov_b32 v2, 0
v_mov_b32 v3, 0
v_mov_b32 v4, 0
v_mov_b32 v5, 0
v_mov_b32 v6, 0
v_mov_b32 v7, 0
v_mov_b32 v8, 0
v_mov_b32 v9, 0
s_mov_b32 s48, 0x3e0293ee
s_mov_b32 s49, 0xbe0293ee
s_add_u32 s38, s45, 0
buffer_store_dwordx4 v[28:31], v14, s[4:7], s38 offen sc1
s_add_u32 s38, s45, 65536
buffer_store_dwordx4 v[28:31], v14, s[4:7], s38 offen sc1
s_add_u32 s38, s45, 131072
buffer_store_dwordx4 v[28:31], v14, s[4:7], s38 offen sc1
s_add_u32 s38, s45, 196608
buffer_store_dwordx4 v[28:31], v14, s[4:7], s38 offen sc1
s_lshl_b32 s52, s35, 16
s_or_b32 s52, s52, 1
s_waitcnt vmcnt(0)
s_barrier
s_cmp_lg_u32 s32, 0
s_cbranch_scc1 Lar_11
s_mov_b64 exec, 1
v_mov_b32 v48, 16
v_mov_b32 v49, s52
buffer_atomic_add v49, v48, s[12:15], 0 offen sc1
s_mov_b64 exec, -1
Lar_11:
s_xor_b32 s52, s32, 3
s_lshl_b32 s52, s52, 6
v_and_b32 v54, 7, v50
v_lshlrev_b32 v54, 4, v54
v_xor_b32 v54, s52, v54
v_lshrrev_b32 v51, 3, v50
v_lshl_add_u32 v51, v51, 13, v54
s_xor_b32 s52, s32, 1
s_lshl_b32 s52, s52, 6
v_and_b32 v54, 7, v50
v_lshlrev_b32 v54, 4, v54
v_xor_b32 v54, s52, v54
v_lshrrev_b32 v52, 3, v50
v_lshl_add_u32 v52, v52, 13, v54
v_bfe_u32 v53, v50, 2, 1
v_bfe_u32 v54, v50, 5, 1
v_lshl_add_u32 v53, v54, 4, v53
v_bfe_u32 v54, v50, 4, 1
v_lshl_add_u32 v53, v54, 2, v53
v_bfe_u32 v54, v50, 3, 1
v_lshl_add_u32 v53, v54, 3, v53
s_mul_i32 s38, s32, 40960
v_lshl_add_u32 v53, v53, 7, s38
v_bfe_u32 v54, v50, 0, 1
v_lshl_add_u32 v53, v54, 3, v53
v_bfe_u32 v54, v50, 1, 1
v_lshl_add_u32 v53, v54, 4, v53
s_mov_b32 s8, s18
s_and_b32 s9, s19, 0xffff
s_mov_b32 s10, 0x800000
s_mov_b32 s11, 0x20000
s_lshl_b32 s39, s32, 21
s_lshl_b32 s38, s54, 8
s_add_u32 s39, s39, s38
s_add_u32 s39, s39, 1572864
s_mul_i32 s38, s32, 40960
s_add_u32 m0, s38, 0
s_nop 0
buffer_load_dwordx4 v52, s[8:11], s39 offen lds
s_add_u32 m0, m0, 1024
s_add_u32 s39, s39, 65536
buffer_load_dwordx4 v52, s[8:11], s39 offen lds
s_add_u32 m0, m0, 1024
s_add_u32 s39, s39, 65536
buffer_load_dwordx4 v52, s[8:11], s39 offen lds
s_add_u32 m0, m0, 1024
s_add_u32 s39, s39, 65536
buffer_load_dwordx4 v52, s[8:11], s39 offen lds
s_add_u32 m0, m0, 1024
s_add_u32 s39, s39, 65536
buffer_load_dwordx4 v52, s[8:11], s39 offen lds
s_add_u32 m0, m0, 1024
s_add_u32 s39, s39, 65536
buffer_load_dwordx4 v52, s[8:11], s39 offen lds
s_add_u32 m0, m0, 1024
s_add_u32 s39, s39, 65536
buffer_load_dwordx4 v52, s[8:11], s39 offen lds
s_add_u32 m0, m0, 1024
s_add_u32 s39, s39, 65536
buffer_load_dwordx4 v52, s[8:11], s39 offen lds
s_lshl_b32 s39, s32, 21
s_lshl_b32 s38, s54, 8
s_add_u32 s39, s39, s38
s_add_u32 s39, s39, 1572864
s_mul_i32 s38, s32, 40960
s_add_u32 m0, s38, 8192
s_nop 0
buffer_load_dwordx4 v51, s[8:11], s39 offen lds
s_add_u32 m0, m0, 1024
s_add_u32 s39, s39, 65536
buffer_load_dwordx4 v51, s[8:11], s39 offen lds
s_add_u32 m0, m0, 1024
s_add_u32 s39, s39, 65536
buffer_load_dwordx4 v51, s[8:11], s39 offen lds
s_add_u32 m0, m0, 1024
s_add_u32 s39, s39, 65536
buffer_load_dwordx4 v51, s[8:11], s39 offen lds
s_add_u32 m0, m0, 1024
s_add_u32 s39, s39, 65536
buffer_load_dwordx4 v51, s[8:11], s39 offen lds
s_add_u32 m0, m0, 1024
s_add_u32 s39, s39, 65536
buffer_load_dwordx4 v51, s[8:11], s39 offen lds
s_add_u32 m0, m0, 1024
s_add_u32 s39, s39, 65536
buffer_load_dwordx4 v51, s[8:11], s39 offen lds
s_add_u32 m0, m0, 1024
s_add_u32 s39, s39, 65536
buffer_load_dwordx4 v51, s[8:11], s39 offen lds
s_waitcnt vmcnt(8)
ds_read_b64_tr_b16 a[224:225], v53 offset:0
ds_read_b64_tr_b16 a[226:227], v53 offset:256
ds_read_b64_tr_b16 a[228:229], v53 offset:4096
ds_read_b64_tr_b16 a[230:231], v53 offset:4352
ds_read_b64_tr_b16 a[232:233], v53 offset:32
ds_read_b64_tr_b16 a[234:235], v53 offset:288
ds_read_b64_tr_b16 a[236:237], v53 offset:4128
ds_read_b64_tr_b16 a[238:239], v53 offset:4384
ds_read_b64_tr_b16 a[240:241], v53 offset:64
ds_read_b64_tr_b16 a[242:243], v53 offset:320
ds_read_b64_tr_b16 a[244:245], v53 offset:4160
ds_read_b64_tr_b16 a[246:247], v53 offset:4416
ds_read_b64_tr_b16 a[248:249], v53 offset:96
ds_read_b64_tr_b16 a[250:251], v53 offset:352
ds_read_b64_tr_b16 a[252:253], v53 offset:4192
ds_read_b64_tr_b16 a[254:255], v53 offset:4448
s_lshl_b32 s39, s32, 21
s_lshl_b32 s38, s54, 8
s_add_u32 s39, s39, s38
s_add_u32 s39, s39, 1048576
s_mul_i32 s38, s32, 40960
s_add_u32 m0, s38, 16384
s_nop 0
buffer_load_dwordx4 v52, s[8:11], s39 offen lds
s_add_u32 m0, m0, 1024
s_add_u32 s39, s39, 65536
buffer_load_dwordx4 v52, s[8:11], s39 offen lds
s_add_u32 m0, m0, 1024
s_add_u32 s39, s39, 65536
buffer_load_dwordx4 v52, s[8:11], s39 offen lds
s_add_u32 m0, m0, 1024
s_add_u32 s39, s39, 65536
buffer_load_dwordx4 v52, s[8:11], s39 offen lds
s_add_u32 m0, m0, 1024
s_add_u32 s39, s39, 65536
buffer_load_dwordx4 v52, s[8:11], s39 offen lds
s_add_u32 m0, m0, 1024
s_add_u32 s39, s39, 65536
buffer_load_dwordx4 v52, s[8:11], s39 offen lds
s_add_u32 m0, m0, 1024
s_add_u32 s39, s39, 65536
buffer_load_dwordx4 v52, s[8:11], s39 offen lds
s_add_u32 m0, m0, 1024
s_add_u32 s39, s39, 65536
buffer_load_dwordx4 v52, s[8:11], s39 offen lds
s_waitcnt lgkmcnt(0)
s_waitcnt vmcnt(8)
ds_read_b64_tr_b16 a[192:193], v53 offset:8192
ds_read_b64_tr_b16 a[194:195], v53 offset:8448
ds_read_b64_tr_b16 a[196:197], v53 offset:12288
ds_read_b64_tr_b16 a[198:199], v53 offset:12544
ds_read_b64_tr_b16 a[200:201], v53 offset:8224
ds_read_b64_tr_b16 a[202:203], v53 offset:8480
ds_read_b64_tr_b16 a[204:205], v53 offset:12320
ds_read_b64_tr_b16 a[206:207], v53 offset:12576
ds_read_b64_tr_b16 a[208:209], v53 offset:8256
ds_read_b64_tr_b16 a[210:211], v53 offset:8512
ds_read_b64_tr_b16 a[212:213], v53 offset:12352
ds_read_b64_tr_b16 a[214:215], v53 offset:12608
ds_read_b64_tr_b16 a[216:217], v53 offset:8288
ds_read_b64_tr_b16 a[218:219], v53 offset:8544
ds_read_b64_tr_b16 a[220:221], v53 offset:12384
ds_read_b64_tr_b16 a[222:223], v53 offset:12640
s_lshl_b32 s39, s32, 21
s_lshl_b32 s38, s54, 8
s_add_u32 s39, s39, s38
s_add_u32 s39, s39, 1048576
s_mul_i32 s38, s32, 40960
s_add_u32 m0, s38, 24576
s_nop 0
buffer_load_dwordx4 v51, s[8:11], s39 offen lds
s_add_u32 m0, m0, 1024
s_add_u32 s39, s39, 65536
buffer_load_dwordx4 v51, s[8:11], s39 offen lds
s_add_u32 m0, m0, 1024
s_add_u32 s39, s39, 65536
buffer_load_dwordx4 v51, s[8:11], s39 offen lds
s_add_u32 m0, m0, 1024
s_add_u32 s39, s39, 65536
buffer_load_dwordx4 v51, s[8:11], s39 offen lds
s_add_u32 m0, m0, 1024
s_add_u32 s39, s39, 65536
buffer_load_dwordx4 v51, s[8:11], s39 offen lds
s_add_u32 m0, m0, 1024
s_add_u32 s39, s39, 65536
buffer_load_dwordx4 v51, s[8:11], s39 offen lds
s_add_u32 m0, m0, 1024
s_add_u32 s39, s39, 65536
buffer_load_dwordx4 v51, s[8:11], s39 offen lds
s_add_u32 m0, m0, 1024
s_add_u32 s39, s39, 65536
buffer_load_dwordx4 v51, s[8:11], s39 offen lds
s_waitcnt lgkmcnt(0)
s_waitcnt vmcnt(8)
ds_read_b64_tr_b16 a[160:161], v53 offset:16384
ds_read_b64_tr_b16 a[162:163], v53 offset:16640
ds_read_b64_tr_b16 a[164:165], v53 offset:20480
ds_read_b64_tr_b16 a[166:167], v53 offset:20736
ds_read_b64_tr_b16 a[168:169], v53 offset:16416
ds_read_b64_tr_b16 a[170:171], v53 offset:16672
ds_read_b64_tr_b16 a[172:173], v53 offset:20512
ds_read_b64_tr_b16 a[174:175], v53 offset:20768
ds_read_b64_tr_b16 a[176:177], v53 offset:16448
ds_read_b64_tr_b16 a[178:179], v53 offset:16704
ds_read_b64_tr_b16 a[180:181], v53 offset:20544
ds_read_b64_tr_b16 a[182:183], v53 offset:20800
ds_read_b64_tr_b16 a[184:185], v53 offset:16480
ds_read_b64_tr_b16 a[186:187], v53 offset:16736
ds_read_b64_tr_b16 a[188:189], v53 offset:20576
ds_read_b64_tr_b16 a[190:191], v53 offset:20832
s_lshl_b32 s39, s32, 21
s_lshl_b32 s38, s54, 8
s_add_u32 s39, s39, s38
s_add_u32 s39, s39, 524288
s_mul_i32 s38, s32, 40960
s_add_u32 m0, s38, 32768
s_nop 0
buffer_load_dwordx4 v52, s[8:11], s39 offen lds
s_add_u32 m0, m0, 1024
s_add_u32 s39, s39, 65536
buffer_load_dwordx4 v52, s[8:11], s39 offen lds
s_add_u32 m0, m0, 1024
s_add_u32 s39, s39, 65536
buffer_load_dwordx4 v52, s[8:11], s39 offen lds
s_add_u32 m0, m0, 1024
s_add_u32 s39, s39, 65536
buffer_load_dwordx4 v52, s[8:11], s39 offen lds
s_add_u32 m0, m0, 1024
s_add_u32 s39, s39, 65536
buffer_load_dwordx4 v52, s[8:11], s39 offen lds
s_add_u32 m0, m0, 1024
s_add_u32 s39, s39, 65536
buffer_load_dwordx4 v52, s[8:11], s39 offen lds
s_add_u32 m0, m0, 1024
s_add_u32 s39, s39, 65536
buffer_load_dwordx4 v52, s[8:11], s39 offen lds
s_add_u32 m0, m0, 1024
s_add_u32 s39, s39, 65536
buffer_load_dwordx4 v52, s[8:11], s39 offen lds
s_waitcnt lgkmcnt(0)
s_waitcnt vmcnt(8)
ds_read_b64_tr_b16 a[128:129], v53 offset:24576
ds_read_b64_tr_b16 a[130:131], v53 offset:24832
ds_read_b64_tr_b16 a[132:133], v53 offset:28672
ds_read_b64_tr_b16 a[134:135], v53 offset:28928
ds_read_b64_tr_b16 a[136:137], v53 offset:24608
ds_read_b64_tr_b16 a[138:139], v53 offset:24864
ds_read_b64_tr_b16 a[140:141], v53 offset:28704
ds_read_b64_tr_b16 a[142:143], v53 offset:28960
ds_read_b64_tr_b16 a[144:145], v53 offset:24640
ds_read_b64_tr_b16 a[146:147], v53 offset:24896
ds_read_b64_tr_b16 a[148:149], v53 offset:28736
ds_read_b64_tr_b16 a[150:151], v53 offset:28992
ds_read_b64_tr_b16 a[152:153], v53 offset:24672
ds_read_b64_tr_b16 a[154:155], v53 offset:24928
ds_read_b64_tr_b16 a[156:157], v53 offset:28768
ds_read_b64_tr_b16 a[158:159], v53 offset:29024
s_lshl_b32 s39, s32, 21
s_lshl_b32 s38, s54, 8
s_add_u32 s39, s39, s38
s_add_u32 s39, s39, 524288
s_mul_i32 s38, s32, 40960
s_add_u32 m0, s38, 0
s_nop 0
buffer_load_dwordx4 v51, s[8:11], s39 offen lds
s_add_u32 m0, m0, 1024
s_add_u32 s39, s39, 65536
buffer_load_dwordx4 v51, s[8:11], s39 offen lds
s_add_u32 m0, m0, 1024
s_add_u32 s39, s39, 65536
buffer_load_dwordx4 v51, s[8:11], s39 offen lds
s_add_u32 m0, m0, 1024
s_add_u32 s39, s39, 65536
buffer_load_dwordx4 v51, s[8:11], s39 offen lds
s_add_u32 m0, m0, 1024
s_add_u32 s39, s39, 65536
buffer_load_dwordx4 v51, s[8:11], s39 offen lds
s_add_u32 m0, m0, 1024
s_add_u32 s39, s39, 65536
buffer_load_dwordx4 v51, s[8:11], s39 offen lds
s_add_u32 m0, m0, 1024
s_add_u32 s39, s39, 65536
buffer_load_dwordx4 v51, s[8:11], s39 offen lds
s_add_u32 m0, m0, 1024
s_add_u32 s39, s39, 65536
buffer_load_dwordx4 v51, s[8:11], s39 offen lds
s_waitcnt lgkmcnt(0)
s_waitcnt vmcnt(8)
ds_read_b64_tr_b16 a[96:97], v53 offset:32768
ds_read_b64_tr_b16 a[98:99], v53 offset:33024
ds_read_b64_tr_b16 a[100:101], v53 offset:36864
ds_read_b64_tr_b16 a[102:103], v53 offset:37120
ds_read_b64_tr_b16 a[104:105], v53 offset:32800
ds_read_b64_tr_b16 a[106:107], v53 offset:33056
ds_read_b64_tr_b16 a[108:109], v53 offset:36896
ds_read_b64_tr_b16 a[110:111], v53 offset:37152
ds_read_b64_tr_b16 a[112:113], v53 offset:32832
ds_read_b64_tr_b16 a[114:115], v53 offset:33088
ds_read_b64_tr_b16 a[116:117], v53 offset:36928
ds_read_b64_tr_b16 a[118:119], v53 offset:37184
ds_read_b64_tr_b16 a[120:121], v53 offset:32864
ds_read_b64_tr_b16 a[122:123], v53 offset:33120
ds_read_b64_tr_b16 a[124:125], v53 offset:36960
ds_read_b64_tr_b16 a[126:127], v53 offset:37216
s_lshl_b32 s39, s32, 21
s_lshl_b32 s38, s54, 8
s_add_u32 s39, s39, s38
s_add_u32 s39, s39, 0
s_mul_i32 s38, s32, 40960
s_add_u32 m0, s38, 8192
s_nop 0
buffer_load_dwordx4 v52, s[8:11], s39 offen lds
s_add_u32 m0, m0, 1024
s_add_u32 s39, s39, 65536
buffer_load_dwordx4 v52, s[8:11], s39 offen lds
s_add_u32 m0, m0, 1024
s_add_u32 s39, s39, 65536
buffer_load_dwordx4 v52, s[8:11], s39 offen lds
s_add_u32 m0, m0, 1024
s_add_u32 s39, s39, 65536
buffer_load_dwordx4 v52, s[8:11], s39 offen lds
s_add_u32 m0, m0, 1024
s_add_u32 s39, s39, 65536
buffer_load_dwordx4 v52, s[8:11], s39 offen lds
s_add_u32 m0, m0, 1024
s_add_u32 s39, s39, 65536
buffer_load_dwordx4 v52, s[8:11], s39 offen lds
s_add_u32 m0, m0, 1024
s_add_u32 s39, s39, 65536
buffer_load_dwordx4 v52, s[8:11], s39 offen lds
s_add_u32 m0, m0, 1024
s_add_u32 s39, s39, 65536
buffer_load_dwordx4 v52, s[8:11], s39 offen lds
s_waitcnt lgkmcnt(0)
s_waitcnt vmcnt(8)
ds_read_b64_tr_b16 a[64:65], v53 offset:0
ds_read_b64_tr_b16 a[66:67], v53 offset:256
ds_read_b64_tr_b16 a[68:69], v53 offset:4096
ds_read_b64_tr_b16 a[70:71], v53 offset:4352
ds_read_b64_tr_b16 a[72:73], v53 offset:32
ds_read_b64_tr_b16 a[74:75], v53 offset:288
ds_read_b64_tr_b16 a[76:77], v53 offset:4128
ds_read_b64_tr_b16 a[78:79], v53 offset:4384
ds_read_b64_tr_b16 a[80:81], v53 offset:64
ds_read_b64_tr_b16 a[82:83], v53 offset:320
ds_read_b64_tr_b16 a[84:85], v53 offset:4160
ds_read_b64_tr_b16 a[86:87], v53 offset:4416
ds_read_b64_tr_b16 a[88:89], v53 offset:96
ds_read_b64_tr_b16 a[90:91], v53 offset:352
ds_read_b64_tr_b16 a[92:93], v53 offset:4192
ds_read_b64_tr_b16 a[94:95], v53 offset:4448
s_lshl_b32 s39, s32, 21
s_lshl_b32 s38, s54, 8
s_add_u32 s39, s39, s38
s_add_u32 s39, s39, 0
s_mul_i32 s38, s32, 40960
s_add_u32 m0, s38, 16384
s_nop 0
buffer_load_dwordx4 v51, s[8:11], s39 offen lds
s_add_u32 m0, m0, 1024
s_add_u32 s39, s39, 65536
buffer_load_dwordx4 v51, s[8:11], s39 offen lds
s_add_u32 m0, m0, 1024
s_add_u32 s39, s39, 65536
buffer_load_dwordx4 v51, s[8:11], s39 offen lds
s_add_u32 m0, m0, 1024
s_add_u32 s39, s39, 65536
buffer_load_dwordx4 v51, s[8:11], s39 offen lds
s_add_u32 m0, m0, 1024
s_add_u32 s39, s39, 65536
buffer_load_dwordx4 v51, s[8:11], s39 offen lds
s_add_u32 m0, m0, 1024
s_add_u32 s39, s39, 65536
buffer_load_dwordx4 v51, s[8:11], s39 offen lds
s_add_u32 m0, m0, 1024
s_add_u32 s39, s39, 65536
buffer_load_dwordx4 v51, s[8:11], s39 offen lds
s_add_u32 m0, m0, 1024
s_add_u32 s39, s39, 65536
buffer_load_dwordx4 v51, s[8:11], s39 offen lds
s_waitcnt lgkmcnt(0)
s_waitcnt vmcnt(8)
ds_read_b64_tr_b16 a[32:33], v53 offset:8192
ds_read_b64_tr_b16 a[34:35], v53 offset:8448
ds_read_b64_tr_b16 a[36:37], v53 offset:12288
ds_read_b64_tr_b16 a[38:39], v53 offset:12544
ds_read_b64_tr_b16 a[40:41], v53 offset:8224
ds_read_b64_tr_b16 a[42:43], v53 offset:8480
ds_read_b64_tr_b16 a[44:45], v53 offset:12320
ds_read_b64_tr_b16 a[46:47], v53 offset:12576
ds_read_b64_tr_b16 a[48:49], v53 offset:8256
ds_read_b64_tr_b16 a[50:51], v53 offset:8512
ds_read_b64_tr_b16 a[52:53], v53 offset:12352
ds_read_b64_tr_b16 a[54:55], v53 offset:12608
ds_read_b64_tr_b16 a[56:57], v53 offset:8288
ds_read_b64_tr_b16 a[58:59], v53 offset:8544
ds_read_b64_tr_b16 a[60:61], v53 offset:12384
ds_read_b64_tr_b16 a[62:63], v53 offset:12640
s_waitcnt lgkmcnt(0)
s_waitcnt vmcnt(0)
ds_read_b64_tr_b16 a[0:1], v53 offset:16384
ds_read_b64_tr_b16 a[2:3], v53 offset:16640
ds_read_b64_tr_b16 a[4:5], v53 offset:20480
ds_read_b64_tr_b16 a[6:7], v53 offset:20736
ds_read_b64_tr_b16 a[8:9], v53 offset:16416
ds_read_b64_tr_b16 a[10:11], v53 offset:16672
ds_read_b64_tr_b16 a[12:13], v53 offset:20512
ds_read_b64_tr_b16 a[14:15], v53 offset:20768
ds_read_b64_tr_b16 a[16:17], v53 offset:16448
ds_read_b64_tr_b16 a[18:19], v53 offset:16704
ds_read_b64_tr_b16 a[20:21], v53 offset:20544
ds_read_b64_tr_b16 a[22:23], v53 offset:20800
ds_read_b64_tr_b16 a[24:25], v53 offset:16480
ds_read_b64_tr_b16 a[26:27], v53 offset:16736
ds_read_b64_tr_b16 a[28:29], v53 offset:20576
ds_read_b64_tr_b16 a[30:31], v53 offset:20832
s_waitcnt lgkmcnt(0)
s_cmp_lg_u32 s54, 0
s_cbranch_scc1 Lnp_12
s_barrier
s_mov_b32 s52, 0x2000000
s_cmp_lg_u32 s32, 0
s_cbranch_scc1 Lpb_13
v_lshlrev_b32 v52, 8, v50
v_mov_b32 v53, -1
s_mov_b32 s53, 32768
buffer_store_dword v53, v52, s[4:7], s53 offen sc1
s_waitcnt vmcnt(0)
s_mov_b64 exec, 1
s_mov_b32 s60, -1
s_mov_b32 s61, -1
v_mov_b32 v52, 0
s_mov_b32 s66, 5
Lpl_14:
s_memtime s[62:63]
s_waitcnt lgkmcnt(0)
buffer_load_dword v53, v52, s[4:7], s53 offen sc1
s_waitcnt vmcnt(0)
s_memtime s[64:65]
s_waitcnt lgkmcnt(0)
s_sub_u32 s62, s64, s62
s_min_u32 s60, s60, s62
v_add_u32 v52, 8192, v52
s_memtime s[62:63]
s_waitcnt lgkmcnt(0)
buffer_load_dword v53, v52, s[4:7], s53 offen sc1
s_waitcnt vmcnt(0)
s_memtime s[64:65]
s_waitcnt lgkmcnt(0)
s_sub_u32 s62, s64, s62
s_min_u32 s61, s61, s62
v_add_u32 v52, -6912, v52
s_sub_u32 s66, s66, 1
s_cmp_lg_u32 s66, 0
s_cbranch_scc1 Lpl_14
s_mov_b64 exec, -1
s_cmp_lt_u32 s61, s60
s_cselect_b32 s62, 1, 0
s_lshr_b32 s63, s51, 2
s_xor_b32 s62, s62, s63
s_lshl_b32 s62, s62, 24
s_or_b32 s52, s52, s62
Lpb_13:
s_waitcnt vmcnt(0)
s_barrier
s_cmp_lg_u32 s32, 0
s_cbranch_scc1 Lar_15
s_mov_b64 exec, 1
v_mov_b32 v48, 16
v_mov_b32 v49, s52
buffer_atomic_add v49, v48, s[12:15], 0 offen sc1
s_mov_b64 exec, -1
Lar_15:
Lnp_12:
Lst_16:
buffer_load_dword v48, off, s[12:15], 0 offset:16 sc1
buffer_load_dword v49, off, s[12:15], 0 offset:144 sc1
s_waitcnt vmcnt(0)
v_add_u32 v48, v48, v49
s_nop 0
v_readfirstlane_b32 s38, v48
s_nop 3
s_and_b32 s39, s38, 0x200ffff
s_cmp_eq_u32 s39, 0x2000100
s_cbranch_scc1 Lso_17
s_sub_u32 s37, s37, 1
s_cbranch_scc1 Lend_1
s_sleep 8
s_branch Lst_16
Lso_17:
s_bfe_u32 s35, s38, 0x80010
s_bfe_u32 s46, s38, 0x10018
s_lshl_b32 s46, s46, 13
s_barrier
s_mul_i32 s47, s54, 24576
s_add_u32 s47, s47, 33554432
s_mov_b32 s36, 0
s_mov_b32 s27, 1
s_cmp_lg_u32 s35, 0
s_cbranch_scc1 Lq_sc1_18
Lq_19:
s_cmp_gt_u32 s36, 3
s_cbranch_scc1 Lqf_20
s_waitcnt vmcnt(0)
s_barrier
s_cmp_eq_u32 s36, 0
s_cbranch_scc1 Lqn_21
Lqf_20:
ds_read_b128 v[128:131], v22 offset:0
ds_read_b128 v[132:135], v22 offset:1024
ds_read_b128 v[136:139], v22 offset:2048
ds_read_b128 v[140:143], v22 offset:3072
ds_read_b128 v[144:147], v22 offset:4096
ds_read_b128 v[148:151], v22 offset:5120
ds_read_b128 v[152:155], v22 offset:6144
ds_read_b128 v[156:159], v22 offset:7168
ds_read_b128 v[160:163], v24 offset:0
ds_read_b128 v[164:167], v24 offset:1024
ds_read_b128 v[168:171], v25 offset:0
ds_read_b128 v[172:175], v25 offset:1024
ds_read_b128 v[176:179], v23 offset:0
ds_read_b128 v[180:183], v23 offset:1024
ds_read_b128 v[184:187], v23 offset:2048
ds_read_b128 v[188:191], v23 offset:3072
v_xor_b32 v22, 98304, v22
v_xor_b32 v24, 98304, v24
v_xor_b32 v25, 98304, v25
v_xor_b32 v23, 98304, v23
Lqn_21:
s_and_b32 s38, s36, 3
s_lshl_b32 s39, s38, 16
s_add_u32 s40, s39, s45
s_xor_b32 s42, s40, 0x20000
s_add_u32 s26, s36, 1
v_pk_mul_f32 v[64:65], 0, 0
v_pk_mul_f32 v[66:67], 0, 0
v_pk_mul_f32 v[68:69], 0, 0
v_pk_mul_f32 v[70:71], 0, 0
v_pk_mul_f32 v[72:73], 0, 0
v_pk_mul_f32 v[74:75], 0, 0
v_pk_mul_f32 v[76:77], 0, 0
v_pk_mul_f32 v[78:79], 0, 0
v_pk_mul_f32 v[80:81], 0, 0
v_pk_mul_f32 v[82:83], 0, 0
v_pk_mul_f32 v[84:85], 0, 0
v_pk_mul_f32 v[86:87], 0, 0
v_pk_mul_f32 v[88:89], 0, 0
v_pk_mul_f32 v[90:91], 0, 0
v_pk_mul_f32 v[92:93], 0, 0
v_pk_mul_f32 v[94:95], 0, 0
v_mov_b32 v214, v197
s_waitcnt vmcnt(0)
buffer_store_dword v214, v199, s[4:7], 0 offen
v_add_u32 v197, 1, v197
s_cmp_eq_u32 s36, 63
s_cbranch_scc1 Lqz_22
s_mov_b64 exec, 15
buffer_load_dword v216, v192, s[4:7], s59 offen sc1
s_nop 5
buffer_load_dword v217, v192, s[4:7], s59 offen sc1
s_nop 5
buffer_load_dword v218, v192, s[4:7], s59 offen sc1
Lft_24:
s_waitcnt vmcnt(2)
v_cmp_gt_u32 vcc, s26, v216
buffer_load_dword v216, v192, s[4:7], s59 offen sc1
s_cbranch_vccz Lfg_23
s_waitcnt vmcnt(2)
v_cmp_gt_u32 vcc, s26, v217
buffer_load_dword v217, v192, s[4:7], s59 offen sc1
s_cbranch_vccz Lfg_23
s_waitcnt vmcnt(2)
v_cmp_gt_u32 vcc, s26, v218
buffer_load_dword v218, v192, s[4:7], s59 offen sc1
s_cbranch_vccz Lfg_23
s_sub_u32 s37, s37, 1
s_cbranch_scc1 Lend_1
s_branch Lft_24
Lfg_23:
s_mov_b64 exec, -1
buffer_load_dwordx4 v[48:51], v10, s[4:7], s40 offen offset:0 sc1
s_nop 11
buffer_load_dwordx4 v[52:55], v10, s[4:7], s40 offen offset:1024 sc1
s_nop 11
buffer_load_dwordx4 v[56:59], v10, s[4:7], s40 offen offset:2048 sc1
s_nop 11
buffer_load_dwordx4 v[60:63], v10, s[4:7], s40 offen offset:3072 sc1
s_nop 11
s_waitcnt vmcnt(3)
v_max3_u32 v44, v48, v49, v50
v_max_u32 v44, v44, v51
v_cmp_eq_u32 vcc, -1, v44
s_cbranch_vccnz Lpf_26
v_smfmac_f32_16x16x64_bf16 v[64:67], v[48:51], a[0:7], v15
v_smfmac_f32_16x16x64_bf16 v[68:71], v[48:51], a[8:15], v15
v_smfmac_f32_16x16x64_bf16 v[72:75], v[48:51], a[16:23], v15
s_waitcnt vmcnt(2)
v_max3_u32 v44, v52, v53, v54
v_max_u32 v44, v44, v55
v_cmp_eq_u32 vcc, -1, v44
v_smfmac_f32_16x16x64_bf16 v[76:79], v[48:51], a[24:31], v15
v_smfmac_f32_16x16x64_bf16 v[80:83], v[48:51], a[32:39], v15
v_smfmac_f32_16x16x64_bf16 v[84:87], v[48:51], a[40:47], v15
s_cbranch_vccnz Lpf_27
v_smfmac_f32_16x16x64_bf16 v[64:67], v[52:55], a[64:71], v15
v_smfmac_f32_16x16x64_bf16 v[68:71], v[52:55], a[72:79], v15
v_smfmac_f32_16x16x64_bf16 v[72:75], v[52:55], a[80:87], v15
s_waitcnt vmcnt(0)
v_max3_u32 v44, v56, v57, v58
v_max3_u32 v44, v44, v59, v60
v_max3_u32 v44, v44, v61, v62
v_max_u32 v44, v44, v63
v_cmp_eq_u32 vcc, -1, v44
v_smfmac_f32_16x16x64_bf16 v[76:79], v[52:55], a[88:95], v15
v_smfmac_f32_16x16x64_bf16 v[80:83], v[52:55], a[96:103], v15
v_smfmac_f32_16x16x64_bf16 v[84:87], v[52:55], a[104:111], v15
s_cbranch_vccnz Lpj_28
v_smfmac_f32_16x16x64_bf16 v[64:67], v[56:59], a[128:135], v15
s_nop 1
v_smfmac_f32_16x16x64_bf16 v[64:67], v[60:63], a[192:199], v15
s_nop 1
v_smfmac_f32_16x16x64_bf16 v[68:71], v[56:59], a[136:143], v15
s_nop 1
v_smfmac_f32_16x16x64_bf16 v[68:71], v[60:63], a[200:207], v15
s_nop 1
v_smfmac_f32_16x16x64_bf16 v[72:75], v[56:59], a[144:151], v15
v_add_f32 v96, v64, v66
v_add_f32 v97, v65, v67
v_smfmac_f32_16x16x64_bf16 v[72:75], v[60:63], a[208:215], v15
s_nop 1
v_smfmac_f32_16x16x64_bf16 v[76:79], v[56:59], a[152:159], v15
v_add_f32 v98, v68, v70
v_add_f32 v99, v69, v71
v_smfmac_f32_16x16x64_bf16 v[76:79], v[60:63], a[216:223], v15
ds_write_b128 v211, v[96:99] offset:0
s_nop 0
v_smfmac_f32_16x16x64_bf16 v[80:83], v[56:59], a[160:167], v15
v_add_f32 v100, v72, v74
v_add_f32 v101, v73, v75
v_smfmac_f32_16x16x64_bf16 v[80:83], v[60:63], a[224:231], v15
s_nop 1
v_smfmac_f32_16x16x64_bf16 v[84:87], v[56:59], a[168:175], v15
v_add_f32 v102, v76, v78
v_add_f32 v103, v77, v79
v_smfmac_f32_16x16x64_bf16 v[84:87], v[60:63], a[232:239], v15
ds_write_b128 v212, v[100:103] offset:0
s_nop 0
v_smfmac_f32_16x16x64_bf16 v[88:91], v[48:51], a[48:55], v15
v_add_f32 v104, v80, v82
v_add_f32 v105, v81, v83
v_smfmac_f32_16x16x64_bf16 v[88:91], v[52:55], a[112:119], v15
s_nop 1
v_add_f32 v106, v84, v86
v_add_f32 v107, v85, v87
ds_write_b128 v213, v[104:107] offset:0
Lpd_25:
v_smfmac_f32_16x16x64_bf16 v[88:91], v[56:59], a[176:183], v15
v_smfmac_f32_16x16x64_bf16 v[88:91], v[60:63], a[240:247], v15
v_smfmac_f32_16x16x64_bf16 v[92:95], v[48:51], a[56:63], v15
v_smfmac_f32_16x16x64_bf16 v[92:95], v[52:55], a[120:127], v15
s_waitcnt lgkmcnt(0)
s_barrier
ds_read_b128 v[76:79], v18 offset:0
ds_read_b128 v[80:83], v18 offset:1024
ds_read_b128 v[84:87], v18 offset:2048
v_smfmac_f32_16x16x64_bf16 v[92:95], v[56:59], a[184:191], v15
v_smfmac_f32_16x16x64_bf16 v[92:95], v[60:63], a[248:255], v15
v_mov_b32 v72, 0
v_mov_b32 v73, 0
v_mov_b32 v74, 0
v_mov_b32 v75, 0
v_add_f32 v108, v88, v90
v_add_f32 v109, v89, v91
s_nop 1
v_add_f32 v110, v92, v94
v_add_f32 v111, v93, v95
s_waitcnt lgkmcnt(0)
v_pk_add_f32 v[76:77], v[76:77], v[108:109]
v_pk_add_f32 v[80:81], v[80:81], v[84:85]
v_pk_add_f32 v[78:79], v[78:79], v[110:111]
v_pk_add_f32 v[82:83], v[82:83], v[86:87]
v_pk_add_f32 v[76:77], v[76:77], v[80:81]
v_pk_add_f32 v[78:79], v[78:79], v[82:83]
v_cvt_pk_bf16_f32 v76, v76, v77
v_cvt_pk_bf16_f32 v77, v78, v79
ds_write2st64_b32 v19, v76, v77 offset0:48 offset1:49
s_cmp_eq_u32 s36, 0
s_cbranch_scc1 Lq0_29
Lq1_30:
buffer_load_dwordx4 v[112:115], v11, s[4:7], s40 offen offset:0 sc1
buffer_load_dwordx4 v[116:119], v11, s[4:7], s40 offen offset:1024 sc1
s_waitcnt lgkmcnt(0)
s_barrier
ds_read_b64_tr_b16 v[96:97], v20 offset:12288
ds_read_b64_tr_b16 v[98:99], v20 offset:12544
ds_read_b64_tr_b16 v[100:101], v20 offset:12800
ds_read_b64_tr_b16 v[102:103], v20 offset:13056
ds_read_b64_tr_b16 v[104:105], v20 offset:13312
ds_read_b64_tr_b16 v[106:107], v20 offset:13568
ds_read_b64_tr_b16 v[108:109], v20 offset:13824
ds_read_b64_tr_b16 v[110:111], v20 offset:14080
s_waitcnt lgkmcnt(6)
v_mfma_f32_16x16x32_bf16 v[64:67], v[128:131], v[96:99], 0
v_mfma_f32_16x16x32_bf16 v[68:71], v[144:147], v[96:99], 0
s_waitcnt lgkmcnt(4)
buffer_load_dwordx4 v[48:51], v11, s[4:7], s40 offen offset:0 sc1
v_mfma_f32_16x16x32_bf16 v[64:67], v[132:135], v[100:103], v[64:67]
v_mfma_f32_16x16x32_bf16 v[68:71], v[148:151], v[100:103], v[68:71]
s_waitcnt lgkmcnt(2)
buffer_load_dwordx4 v[52:55], v11, s[4:7], s40 offen offset:1024 sc1
v_mfma_f32_16x16x32_bf16 v[64:67], v[136:139], v[104:107], v[64:67]
v_mfma_f32_16x16x32_bf16 v[68:71], v[152:155], v[104:107], v[68:71]
s_waitcnt lgkmcnt(0)
s_waitcnt vmcnt(2)
v_max3_u32 v44, v112, v113, v114
v_max3_u32 v44, v44, v115, v116
v_max3_u32 v44, v44, v117, v118
v_max_u32 v44, v44, v119
v_cmp_eq_u32 vcc, -1, v44
v_mfma_f32_16x16x32_bf16 v[64:67], v[140:143], v[108:111], v[64:67]
v_mfma_f32_16x16x32_bf16 v[68:71], v[156:159], v[108:111], v[68:71]
s_cbranch_vccnz Lkr_31
v_smfmac_f32_16x16x64_bf16 v[72:75], v[112:115], v[96:103], v15
v_smfmac_f32_16x16x64_bf16 v[72:75], v[116:119], v[104:111], v15
Lko_32:
s_nop 3
v_max3_f32 v45, v64, v65, v66
v_max3_f32 v45, v45, v67, v68
v_max3_f32 v45, v45, v69, v70
v_max_f32 v45, v45, v71
v_pk_add_f32 v[72:73], v[72:73], v[74:75]
v_max3_f32 v46, v45, v72, v73
v_max3_f32 v47, v45, v72, v73
buffer_load_dwordx2 v[120:121], v12, s[4:7], s40 offen sc1
buffer_load_dwordx2 v[122:123], v13, s[4:7], s40 offen sc1
v_permlane32_swap_b32 v46, v47
v_max_f32 v45, v46, v47
v_max_f32 v46, v46, v47
s_nop 1
v_permlane16_swap_b32 v45, v46
v_max_f32 v45, v45, v46
v_mul_f32 v46, s49, v45
v_pk_fma_f32 v[64:65], v[64:65], s[48:49], v[46:47] op_sel_hi:[1,0,0]
v_pk_fma_f32 v[66:67], v[66:67], s[48:49], v[46:47] op_sel_hi:[1,0,0]
v_pk_fma_f32 v[68:69], v[68:69], s[48:49], v[46:47] op_sel_hi:[1,0,0]
v_pk_fma_f32 v[70:71], v[70:71], s[48:49], v[46:47] op_sel_hi:[1,0,0]
v_pk_fma_f32 v[72:73], v[72:73], s[48:49], v[46:47] op_sel_hi:[1,0,0]
v_exp_f32 v64, v64
v_exp_f32 v65, v65
v_exp_f32 v66, v66
v_exp_f32 v67, v67
v_exp_f32 v68, v68
v_exp_f32 v69, v69
v_exp_f32 v70, v70
v_exp_f32 v71, v71
v_exp_f32 v72, v72
v_exp_f32 v73, v73
buffer_store_dword v197, v193, s[4:7], s59 offen
v_cvt_pk_bf16_f32 v76, v64, v65
v_cvt_pk_bf16_f32 v77, v66, v67
v_cvt_pk_bf16_f32 v78, v68, v69
v_cvt_pk_bf16_f32 v79, v70, v71
v_cvt_pk_bf16_f32 v2, v72, v73
v_cvt_pk_bf16_f32 v7, v72, v73
v_mfma_f32_16x16x32_bf16 v[84:87], v[32:35], v[76:79], 0
v_mfma_f32_16x16x32_bf16 v[84:87], v[32:35], v[2:5], v[84:87]
v_mfma_f32_16x16x32_bf16 v[96:99], v[160:163], v[76:79], 0
s_waitcnt vmcnt(1)
v_max3_u32 v44, v120, v121, v122
v_max_u32 v44, v44, v123
v_cmp_eq_u32 vcc, -1, v44
v_mfma_f32_16x16x32_bf16 v[100:103], v[164:167], v[76:79], 0
s_cbranch_vccnz Lvr_33
Lvo_34:
v_mfma_f32_16x16x32_bf16 v[96:99], v[120:123], v[2:5], v[96:99]
v_mfma_f32_16x16x32_bf16 v[100:103], v[120:123], v[6:9], v[100:103]
v_rcp_f32 v46, v84
s_nop 5
v_pk_mul_f32 v[96:97], v[96:97], v[46:47] op_sel_hi:[1,0]
v_pk_mul_f32 v[98:99], v[98:99], v[46:47] op_sel_hi:[1,0]
v_pk_mul_f32 v[100:101], v[100:101], v[46:47] op_sel_hi:[1,0]
v_pk_mul_f32 v[102:103], v[102:103], v[46:47] op_sel_hi:[1,0]
v_cvt_pk_bf16_f32 v124, v96, v97
v_cvt_pk_bf16_f32 v125, v98, v99
v_cvt_pk_bf16_f32 v126, v100, v101
v_cvt_pk_bf16_f32 v127, v102, v103
buffer_store_dwordx4 v[124:127], v14, s[4:7], s40 offen
s_barrier
buffer_store_dwordx4 v[28:31], v14, s[4:7], s42 offen
s_cmp_eq_u32 s36, 2
s_cbranch_scc1 Lp2_37
Lp1_38:
s_add_u32 s27, s27, 1
s_min_u32 s27, s27, 64
v_add_u32 v44, v209, v210
v_cmp_gt_u32 vcc, s27, v44
v_mov_b32 v72, 0
v_mov_b32 v73, 0
v_mov_b32 v74, 0
v_mov_b32 v75, 0
s_add_u32 s38, s36, 2
s_and_b32 s38, s38, 3
s_lshl_b32 s88, s38, 18
s_add_u32 s88, s88, s46
s_add_u32 s89, s88, 0x100000
s_cmp_lt_u32 s36, 62
s_cselect_b32 s53, s47, 0x70000000
s_cbranch_vccnz Lpw_35
Lpk_36:
buffer_store_dwordx2 v[28:29], v198, s[4:7], s88 offen sc1
buffer_store_dwordx2 v[28:29], v198, s[4:7], s89 offen sc1
v_mfma_f32_16x16x32_bf16 v[64:67], v[128:131], v[176:179], v[36:39]
v_mfma_f32_16x16x32_bf16 v[68:71], v[144:147], v[176:179], v[40:43]
s_mov_b32 m0, s57
s_add_u32 s52, s53, 3072
buffer_load_dwordx4 v21, s[4:7], s53 offen offset:0 sc1 lds
v_mfma_f32_16x16x32_bf16 v[64:67], v[132:135], v[180:183], v[64:67]
v_mfma_f32_16x16x32_bf16 v[68:71], v[148:151], v[180:183], v[68:71]
v_mfma_f32_16x16x32_bf16 v[64:67], v[136:139], v[184:187], v[64:67]
v_mfma_f32_16x16x32_bf16 v[68:71], v[152:155], v[184:187], v[68:71]
buffer_load_dwordx4 v21, s[4:7], s53 offen offset:1024 sc1 lds
v_mfma_f32_16x16x32_bf16 v[64:67], v[140:143], v[188:191], v[64:67]
v_mfma_f32_16x16x32_bf16 v[68:71], v[156:159], v[188:191], v[68:71]
v_smfmac_f32_16x16x64_bf16 v[72:75], v[112:115], v[176:183], v15
v_smfmac_f32_16x16x64_bf16 v[72:75], v[116:119], v[184:191], v15
s_and_b32 s38, s36, 7
s_lshl_b32 s38, s38, 18
s_add_u32 s50, s38, 83886080
buffer_load_dwordx4 v21, s[4:7], s53 offen offset:2048 sc1 lds
s_nop 1
v_max3_f32 v45, v64, v65, v66
v_max3_f32 v45, v45, v67, v68
v_max3_f32 v45, v45, v69, v70
v_max_f32 v45, v45, v71
v_pk_add_f32 v[72:73], v[72:73], v[74:75]
v_max3_f32 v46, v45, v72, v73
v_max3_f32 v47, v45, v72, v73
s_nop 1
v_permlane32_swap_b32 v46, v47
v_max_f32 v45, v46, v47
v_max_f32 v46, v46, v47
s_nop 1
v_permlane16_swap_b32 v45, v46
v_max_f32 v45, v45, v46
v_mul_f32 v46, s49, v45
s_add_u32 m0, s57, 3072
s_xor_b32 s57, s57, 98304
buffer_load_dwordx4 v21, s[4:7], s52 offen offset:0 sc1 lds
v_pk_fma_f32 v[64:65], v[64:65], s[48:49], v[46:47] op_sel_hi:[1,0,0]
v_pk_fma_f32 v[66:67], v[66:67], s[48:49], v[46:47] op_sel_hi:[1,0,0]
v_pk_fma_f32 v[68:69], v[68:69], s[48:49], v[46:47] op_sel_hi:[1,0,0]
v_pk_fma_f32 v[70:71], v[70:71], s[48:49], v[46:47] op_sel_hi:[1,0,0]
v_pk_fma_f32 v[72:73], v[72:73], s[48:49], v[46:47] op_sel_hi:[1,0,0]
v_exp_f32 v64, v64
v_exp_f32 v65, v65
v_exp_f32 v66, v66
v_exp_f32 v67, v67
v_exp_f32 v68, v68
buffer_load_dwordx4 v21, s[4:7], s52 offen offset:1024 sc1 lds
v_exp_f32 v69, v69
v_exp_f32 v70, v70
v_exp_f32 v71, v71
v_exp_f32 v72, v72
v_exp_f32 v73, v73
buffer_load_dwordx4 v21, s[4:7], s52 offen offset:2048 sc1 lds
s_add_u32 s47, s47, 786432
buffer_load_dword v209, v208, s[4:7], 0 offen sc1
v_cvt_pk_bf16_f32 v76, v64, v65
v_cvt_pk_bf16_f32 v77, v66, v67
v_cvt_pk_bf16_f32 v78, v68, v69
v_cvt_pk_bf16_f32 v79, v70, v71
v_cvt_pk_bf16_f32 v2, v72, v73
v_cvt_pk_bf16_f32 v7, v72, v73
v_mfma_f32_16x16x32_bf16 v[84:87], v[32:35], v[76:79], 0
v_mfma_f32_16x16x32_bf16 v[84:87], v[32:35], v[2:5], v[84:87]
v_mfma_f32_16x16x32_bf16 v[96:99], v[160:163], v[76:79], 0
v_mfma_f32_16x16x32_bf16 v[100:103], v[164:167], v[76:79], 0
v_mfma_f32_16x16x32_bf16 v[104:107], v[168:171], v[76:79], 0
v_mfma_f32_16x16x32_bf16 v[108:111], v[172:175], v[76:79], 0
v_mfma_f32_16x16x32_bf16 v[96:99], v[120:123], v[2:5], v[96:99]
v_mfma_f32_16x16x32_bf16 v[100:103], v[120:123], v[6:9], v[100:103]
v_mfma_f32_16x16x32_bf16 v[104:107], v[120:123], v[0:3], v[104:107]
v_mfma_f32_16x16x32_bf16 v[108:111], v[120:123], v[4:7], v[108:111]
v_rcp_f32 v46, v84
s_nop 3
v_pk_mul_f32 v[96:97], v[96:97], v[46:47] op_sel_hi:[1,0]
v_pk_mul_f32 v[98:99], v[98:99], v[46:47] op_sel_hi:[1,0]
v_pk_mul_f32 v[100:101], v[100:101], v[46:47] op_sel_hi:[1,0]
v_pk_mul_f32 v[102:103], v[102:103], v[46:47] op_sel_hi:[1,0]
v_pk_mul_f32 v[104:105], v[104:105], v[46:47] op_sel_hi:[1,0]
v_pk_mul_f32 v[106:107], v[106:107], v[46:47] op_sel_hi:[1,0]
v_pk_mul_f32 v[108:109], v[108:109], v[46:47] op_sel_hi:[1,0]
v_pk_mul_f32 v[110:111], v[110:111], v[46:47] op_sel_hi:[1,0]
v_cvt_pk_bf16_f32 v96, v96, v97
v_cvt_pk_bf16_f32 v97, v98, v99
v_cvt_pk_bf16_f32 v98, v100, v101
v_cvt_pk_bf16_f32 v99, v102, v103
v_cvt_pk_bf16_f32 v100, v104, v105
v_cvt_pk_bf16_f32 v101, v106, v107
v_cvt_pk_bf16_f32 v102, v108, v109
v_cvt_pk_bf16_f32 v103, v110, v111
buffer_store_dwordx4 v[96:99], v26, s[4:7], s50 offen
buffer_store_dwordx4 v[100:103], v27, s[4:7], s50 offen
s_add_u32 s36, s36, 1
s_cmp_lt_u32 s36, 64
s_cbranch_scc1 Lq_19
s_waitcnt vmcnt(0)
buffer_store_dword v197, v199, s[4:7], 0 offen
s_branch Lend_1
Lqz_22:
Lbw_39:
buffer_load_dwordx4 v[112:115], v11, s[4:7], s40 offen offset:0 sc1
buffer_load_dwordx4 v[116:119], v11, s[4:7], s40 offen offset:1024 sc1
buffer_load_dwordx2 v[120:121], v12, s[4:7], s40 offen sc1
buffer_load_dwordx2 v[122:123], v13, s[4:7], s40 offen sc1
s_waitcnt vmcnt(0)
v_max3_u32 v44, v112, v113, v114
v_max3_u32 v44, v44, v115, v116
v_max3_u32 v44, v44, v117, v118
v_max3_u32 v44, v44, v119, v120
v_max3_u32 v44, v44, v121, v122
v_max_u32 v44, v44, v123
v_cmp_eq_u32 vcc, -1, v44
s_cbranch_vccz Lbo_40
s_sub_u32 s37, s37, 1
s_cbranch_scc1 Lend_1
s_branch Lbw_39
Lbo_40:
s_waitcnt lgkmcnt(0)
s_barrier
s_branch Lp1_38
Lq0_29:
Lbw_41:
buffer_load_dword v209, v208, s[4:7], 0 offen sc1
s_waitcnt vmcnt(0)
v_add_u32 v44, v209, v210
v_cmp_gt_u32 vcc, s27, v44
s_cbranch_vccz Lbo_42
s_sub_u32 s37, s37, 1
s_cbranch_scc1 Lend_1
s_sleep 2
s_branch Lbw_41
Lbo_42:
s_mov_b32 m0, s57
s_add_u32 s52, s47, 3072
buffer_load_dwordx4 v21, s[4:7], s47 offen offset:0 sc1 lds
buffer_load_dwordx4 v21, s[4:7], s47 offen offset:1024 sc1 lds
buffer_load_dwordx4 v21, s[4:7], s47 offen offset:2048 sc1 lds
s_add_u32 m0, s57, 3072
s_xor_b32 s57, s57, 98304
buffer_load_dwordx4 v21, s[4:7], s52 offen offset:0 sc1 lds
buffer_load_dwordx4 v21, s[4:7], s52 offen offset:1024 sc1 lds
buffer_load_dwordx4 v21, s[4:7], s52 offen offset:2048 sc1 lds
s_add_u32 s47, s47, 786432
s_waitcnt vmcnt(0)
s_barrier
ds_read_b128 v[128:131], v22 offset:0
ds_read_b128 v[132:135], v22 offset:1024
ds_read_b128 v[136:139], v22 offset:2048
ds_read_b128 v[140:143], v22 offset:3072
ds_read_b128 v[144:147], v22 offset:4096
ds_read_b128 v[148:151], v22 offset:5120
ds_read_b128 v[152:155], v22 offset:6144
ds_read_b128 v[156:159], v22 offset:7168
ds_read_b128 v[160:163], v24 offset:0
ds_read_b128 v[164:167], v24 offset:1024
ds_read_b128 v[168:171], v25 offset:0
ds_read_b128 v[172:175], v25 offset:1024
ds_read_b128 v[176:179], v23 offset:0
ds_read_b128 v[180:183], v23 offset:1024
ds_read_b128 v[184:187], v23 offset:2048
ds_read_b128 v[188:191], v23 offset:3072
v_xor_b32 v22, 98304, v22
v_xor_b32 v24, 98304, v24
v_xor_b32 v25, 98304, v25
v_xor_b32 v23, 98304, v23
s_branch Lq1_30
Lp2_37:
s_add_u32 s27, s27, 1
Lbw_43:
buffer_load_dword v209, v208, s[4:7], 0 offen sc1
s_waitcnt vmcnt(0)
v_add_u32 v44, v209, v210
v_cmp_gt_u32 vcc, s27, v44
s_cbranch_vccz Lbo_44
s_sub_u32 s37, s37, 1
s_cbranch_scc1 Lend_1
s_sleep 2
s_branch Lbw_43
Lbo_44:
s_mov_b32 m0, s57
s_add_u32 s52, s47, 3072
buffer_load_dwordx4 v21, s[4:7], s47 offen offset:0 sc1 lds
buffer_load_dwordx4 v21, s[4:7], s47 offen offset:1024 sc1 lds
buffer_load_dwordx4 v21, s[4:7], s47 offen offset:2048 sc1 lds
s_add_u32 m0, s57, 3072
s_xor_b32 s57, s57, 98304
buffer_load_dwordx4 v21, s[4:7], s52 offen offset:0 sc1 lds
buffer_load_dwordx4 v21, s[4:7], s52 offen offset:1024 sc1 lds
buffer_load_dwordx4 v21, s[4:7], s52 offen offset:2048 sc1 lds
s_add_u32 s47, s47, 786432
s_branch Lp1_38
Lpw_35:
Lbw_45:
buffer_load_dword v209, v208, s[4:7], 0 offen sc1
s_waitcnt vmcnt(0)
v_add_u32 v44, v209, v210
v_cmp_gt_u32 vcc, s27, v44
s_cbranch_vccz Lbo_46
s_sub_u32 s37, s37, 1
s_cbranch_scc1 Lend_1
s_sleep 2
s_branch Lbw_45
Lbo_46:
s_branch Lpk_36
Lpj_28:
buffer_load_dwordx4 v[56:59], v10, s[4:7], s40 offen offset:2048 sc1
buffer_load_dwordx4 v[60:63], v10, s[4:7], s40 offen offset:3072 sc1
s_sub_u32 s37, s37, 1
s_cbranch_scc1 Lend_1
s_branch Lps_47
Lpf_26:
buffer_load_dwordx4 v[48:51], v10, s[4:7], s40 offen offset:0 sc1
s_sub_u32 s37, s37, 1
s_cbranch_scc1 Lend_1
Lps_48:
s_waitcnt vmcnt(3)
v_max3_u32 v44, v52, v53, v54
v_max_u32 v44, v44, v55
v_cmp_eq_u32 vcc, -1, v44
s_cbranch_vccnz Lpf_49
v_smfmac_f32_16x16x64_bf16 v[64:67], v[52:55], a[64:71], v15
v_smfmac_f32_16x16x64_bf16 v[68:71], v[52:55], a[72:79], v15
v_smfmac_f32_16x16x64_bf16 v[72:75], v[52:55], a[80:87], v15
v_smfmac_f32_16x16x64_bf16 v[76:79], v[52:55], a[88:95], v15
v_smfmac_f32_16x16x64_bf16 v[80:83], v[52:55], a[96:103], v15
v_smfmac_f32_16x16x64_bf16 v[84:87], v[52:55], a[104:111], v15
Lps_50:
s_waitcnt vmcnt(2)
v_max3_u32 v44, v56, v57, v58
v_max_u32 v44, v44, v59
v_cmp_eq_u32 vcc, -1, v44
s_cbranch_vccnz Lpf_51
v_smfmac_f32_16x16x64_bf16 v[64:67], v[56:59], a[128:135], v15
v_smfmac_f32_16x16x64_bf16 v[68:71], v[56:59], a[136:143], v15
v_smfmac_f32_16x16x64_bf16 v[72:75], v[56:59], a[144:151], v15
v_smfmac_f32_16x16x64_bf16 v[76:79], v[56:59], a[152:159], v15
v_smfmac_f32_16x16x64_bf16 v[80:83], v[56:59], a[160:167], v15
v_smfmac_f32_16x16x64_bf16 v[84:87], v[56:59], a[168:175], v15
Lps_52:
s_waitcnt vmcnt(1)
v_max3_u32 v44, v60, v61, v62
v_max_u32 v44, v44, v63
v_cmp_eq_u32 vcc, -1, v44
s_cbranch_vccnz Lpf_53
v_smfmac_f32_16x16x64_bf16 v[64:67], v[60:63], a[192:199], v15
v_smfmac_f32_16x16x64_bf16 v[68:71], v[60:63], a[200:207], v15
v_smfmac_f32_16x16x64_bf16 v[72:75], v[60:63], a[208:215], v15
v_smfmac_f32_16x16x64_bf16 v[76:79], v[60:63], a[216:223], v15
v_smfmac_f32_16x16x64_bf16 v[80:83], v[60:63], a[224:231], v15
v_smfmac_f32_16x16x64_bf16 v[84:87], v[60:63], a[232:239], v15
Lps_54:
s_waitcnt vmcnt(0)
v_max3_u32 v44, v48, v49, v50
v_max_u32 v44, v44, v51
v_cmp_eq_u32 vcc, -1, v44
s_cbranch_vccnz Lpf_55
v_smfmac_f32_16x16x64_bf16 v[64:67], v[48:51], a[0:7], v15
s_nop 1
v_smfmac_f32_16x16x64_bf16 v[68:71], v[48:51], a[8:15], v15
s_nop 1
v_smfmac_f32_16x16x64_bf16 v[72:75], v[48:51], a[16:23], v15
s_nop 1
v_smfmac_f32_16x16x64_bf16 v[76:79], v[48:51], a[24:31], v15
v_add_f32 v96, v64, v66
v_add_f32 v97, v65, v67
v_smfmac_f32_16x16x64_bf16 v[80:83], v[48:51], a[32:39], v15
v_add_f32 v98, v68, v70
v_add_f32 v99, v69, v71
v_smfmac_f32_16x16x64_bf16 v[84:87], v[48:51], a[40:47], v15
v_add_f32 v100, v72, v74
v_add_f32 v101, v73, v75
ds_write_b128 v211, v[96:99] offset:0
v_smfmac_f32_16x16x64_bf16 v[88:91], v[48:51], a[48:55], v15
v_add_f32 v102, v76, v78
v_add_f32 v103, v77, v79
v_add_f32 v104, v80, v82
v_add_f32 v105, v81, v83
ds_write_b128 v212, v[100:103] offset:0
v_smfmac_f32_16x16x64_bf16 v[88:91], v[52:55], a[112:119], v15
v_add_f32 v106, v84, v86
v_add_f32 v107, v85, v87
ds_write_b128 v213, v[104:107] offset:0
s_branch Lpd_25
Lpf_27:
buffer_load_dwordx4 v[52:55], v10, s[4:7], s40 offen offset:1024 sc1
s_sub_u32 s37, s37, 1
s_cbranch_scc1 Lend_1
Lps_56:
s_waitcnt vmcnt(2)
v_max3_u32 v44, v56, v57, v58
v_max_u32 v44, v44, v59
v_cmp_eq_u32 vcc, -1, v44
s_cbranch_vccnz Lpf_57
v_smfmac_f32_16x16x64_bf16 v[64:67], v[56:59], a[128:135], v15
v_smfmac_f32_16x16x64_bf16 v[68:71], v[56:59], a[136:143], v15
v_smfmac_f32_16x16x64_bf16 v[72:75], v[56:59], a[144:151], v15
v_smfmac_f32_16x16x64_bf16 v[76:79], v[56:59], a[152:159], v15
v_smfmac_f32_16x16x64_bf16 v[80:83], v[56:59], a[160:167], v15
v_smfmac_f32_16x16x64_bf16 v[84:87], v[56:59], a[168:175], v15
Lps_58:
s_waitcnt vmcnt(1)
v_max3_u32 v44, v60, v61, v62
v_max_u32 v44, v44, v63
v_cmp_eq_u32 vcc, -1, v44
s_cbranch_vccnz Lpf_59
v_smfmac_f32_16x16x64_bf16 v[64:67], v[60:63], a[192:199], v15
v_smfmac_f32_16x16x64_bf16 v[68:71], v[60:63], a[200:207], v15
v_smfmac_f32_16x16x64_bf16 v[72:75], v[60:63], a[208:215], v15
v_smfmac_f32_16x16x64_bf16 v[76:79], v[60:63], a[216:223], v15
v_smfmac_f32_16x16x64_bf16 v[80:83], v[60:63], a[224:231], v15
v_smfmac_f32_16x16x64_bf16 v[84:87], v[60:63], a[232:239], v15
Lps_60:
s_waitcnt vmcnt(0)
v_max3_u32 v44, v52, v53, v54
v_max_u32 v44, v44, v55
v_cmp_eq_u32 vcc, -1, v44
s_cbranch_vccnz Lpf_61
v_smfmac_f32_16x16x64_bf16 v[64:67], v[52:55], a[64:71], v15
s_nop 1
v_smfmac_f32_16x16x64_bf16 v[68:71], v[52:55], a[72:79], v15
s_nop 1
v_smfmac_f32_16x16x64_bf16 v[72:75], v[52:55], a[80:87], v15
s_nop 1
v_smfmac_f32_16x16x64_bf16 v[76:79], v[52:55], a[88:95], v15
v_add_f32 v96, v64, v66
v_add_f32 v97, v65, v67
v_smfmac_f32_16x16x64_bf16 v[80:83], v[52:55], a[96:103], v15
v_add_f32 v98, v68, v70
v_add_f32 v99, v69, v71
v_smfmac_f32_16x16x64_bf16 v[84:87], v[52:55], a[104:111], v15
v_add_f32 v100, v72, v74
v_add_f32 v101, v73, v75
ds_write_b128 v211, v[96:99] offset:0
v_smfmac_f32_16x16x64_bf16 v[88:91], v[48:51], a[48:55], v15
v_add_f32 v102, v76, v78
v_add_f32 v103, v77, v79
v_add_f32 v104, v80, v82
v_add_f32 v105, v81, v83
ds_write_b128 v212, v[100:103] offset:0
v_smfmac_f32_16x16x64_bf16 v[88:91], v[52:55], a[112:119], v15
v_add_f32 v106, v84, v86
v_add_f32 v107, v85, v87
ds_write_b128 v213, v[104:107] offset:0
s_branch Lpd_25
Lpf_49:
buffer_load_dwordx4 v[52:55], v10, s[4:7], s40 offen offset:1024 sc1
Lps_62:
s_waitcnt vmcnt(3)
v_max3_u32 v44, v56, v57, v58
v_max_u32 v44, v44, v59
v_cmp_eq_u32 vcc, -1, v44
s_cbranch_vccnz Lpf_63
v_smfmac_f32_16x16x64_bf16 v[64:67], v[56:59], a[128:135], v15
v_smfmac_f32_16x16x64_bf16 v[68:71], v[56:59], a[136:143], v15
v_smfmac_f32_16x16x64_bf16 v[72:75], v[56:59], a[144:151], v15
v_smfmac_f32_16x16x64_bf16 v[76:79], v[56:59], a[152:159], v15
v_smfmac_f32_16x16x64_bf16 v[80:83], v[56:59], a[160:167], v15
v_smfmac_f32_16x16x64_bf16 v[84:87], v[56:59], a[168:175], v15
Lps_64:
s_waitcnt vmcnt(2)
v_max3_u32 v44, v60, v61, v62
v_max_u32 v44, v44, v63
v_cmp_eq_u32 vcc, -1, v44
s_cbranch_vccnz Lpf_65
v_smfmac_f32_16x16x64_bf16 v[64:67], v[60:63], a[192:199], v15
v_smfmac_f32_16x16x64_bf16 v[68:71], v[60:63], a[200:207], v15
v_smfmac_f32_16x16x64_bf16 v[72:75], v[60:63], a[208:215], v15
v_smfmac_f32_16x16x64_bf16 v[76:79], v[60:63], a[216:223], v15
v_smfmac_f32_16x16x64_bf16 v[80:83], v[60:63], a[224:231], v15
v_smfmac_f32_16x16x64_bf16 v[84:87], v[60:63], a[232:239], v15
Lps_66:
s_waitcnt vmcnt(1)
v_max3_u32 v44, v48, v49, v50
v_max_u32 v44, v44, v51
v_cmp_eq_u32 vcc, -1, v44
s_cbranch_vccnz Lpf_67
v_smfmac_f32_16x16x64_bf16 v[64:67], v[48:51], a[0:7], v15
v_smfmac_f32_16x16x64_bf16 v[68:71], v[48:51], a[8:15], v15
v_smfmac_f32_16x16x64_bf16 v[72:75], v[48:51], a[16:23], v15
v_smfmac_f32_16x16x64_bf16 v[76:79], v[48:51], a[24:31], v15
v_smfmac_f32_16x16x64_bf16 v[80:83], v[48:51], a[32:39], v15
v_smfmac_f32_16x16x64_bf16 v[84:87], v[48:51], a[40:47], v15
s_branch Lps_60
Lpf_51:
buffer_load_dwordx4 v[56:59], v10, s[4:7], s40 offen offset:2048 sc1
Lps_68:
s_waitcnt vmcnt(2)
v_max3_u32 v44, v60, v61, v62
v_max_u32 v44, v44, v63
v_cmp_eq_u32 vcc, -1, v44
s_cbranch_vccnz Lpf_69
v_smfmac_f32_16x16x64_bf16 v[64:67], v[60:63], a[192:199], v15
v_smfmac_f32_16x16x64_bf16 v[68:71], v[60:63], a[200:207], v15
v_smfmac_f32_16x16x64_bf16 v[72:75], v[60:63], a[208:215], v15
v_smfmac_f32_16x16x64_bf16 v[76:79], v[60:63], a[216:223], v15
v_smfmac_f32_16x16x64_bf16 v[80:83], v[60:63], a[224:231], v15
v_smfmac_f32_16x16x64_bf16 v[84:87], v[60:63], a[232:239], v15
Lps_70:
s_waitcnt vmcnt(1)
v_max3_u32 v44, v48, v49, v50
v_max_u32 v44, v44, v51
v_cmp_eq_u32 vcc, -1, v44
s_cbranch_vccnz Lpf_71
v_smfmac_f32_16x16x64_bf16 v[64:67], v[48:51], a[0:7], v15
v_smfmac_f32_16x16x64_bf16 v[68:71], v[48:51], a[8:15], v15
v_smfmac_f32_16x16x64_bf16 v[72:75], v[48:51], a[16:23], v15
v_smfmac_f32_16x16x64_bf16 v[76:79], v[48:51], a[24:31], v15
v_smfmac_f32_16x16x64_bf16 v[80:83], v[48:51], a[32:39], v15
v_smfmac_f32_16x16x64_bf16 v[84:87], v[48:51], a[40:47], v15
Lps_72:
s_waitcnt vmcnt(0)
v_max3_u32 v44, v56, v57, v58
v_max_u32 v44, v44, v59
v_cmp_eq_u32 vcc, -1, v44
s_cbranch_vccnz Lpf_73
v_smfmac_f32_16x16x64_bf16 v[64:67], v[56:59], a[128:135], v15
s_nop 1
v_smfmac_f32_16x16x64_bf16 v[68:71], v[56:59], a[136:143], v15
s_nop 1
v_smfmac_f32_16x16x64_bf16 v[72:75], v[56:59], a[144:151], v15
s_nop 1
v_smfmac_f32_16x16x64_bf16 v[76:79], v[56:59], a[152:159], v15
v_add_f32 v96, v64, v66
v_add_f32 v97, v65, v67
v_smfmac_f32_16x16x64_bf16 v[80:83], v[56:59], a[160:167], v15
v_add_f32 v98, v68, v70
v_add_f32 v99, v69, v71
v_smfmac_f32_16x16x64_bf16 v[84:87], v[56:59], a[168:175], v15
v_add_f32 v100, v72, v74
v_add_f32 v101, v73, v75
ds_write_b128 v211, v[96:99] offset:0
v_smfmac_f32_16x16x64_bf16 v[88:91], v[48:51], a[48:55], v15
v_add_f32 v102, v76, v78
v_add_f32 v103, v77, v79
v_add_f32 v104, v80, v82
v_add_f32 v105, v81, v83
ds_write_b128 v212, v[100:103] offset:0
v_smfmac_f32_16x16x64_bf16 v[88:91], v[52:55], a[112:119], v15
v_add_f32 v106, v84, v86
v_add_f32 v107, v85, v87
ds_write_b128 v213, v[104:107] offset:0
s_branch Lpd_25
Lpf_53:
buffer_load_dwordx4 v[60:63], v10, s[4:7], s40 offen offset:3072 sc1
Lps_74:
s_waitcnt vmcnt(1)
v_max3_u32 v44, v48, v49, v50
v_max_u32 v44, v44, v51
v_cmp_eq_u32 vcc, -1, v44
s_cbranch_vccnz Lpf_75
v_smfmac_f32_16x16x64_bf16 v[64:67], v[48:51], a[0:7], v15
v_smfmac_f32_16x16x64_bf16 v[68:71], v[48:51], a[8:15], v15
v_smfmac_f32_16x16x64_bf16 v[72:75], v[48:51], a[16:23], v15
v_smfmac_f32_16x16x64_bf16 v[76:79], v[48:51], a[24:31], v15
v_smfmac_f32_16x16x64_bf16 v[80:83], v[48:51], a[32:39], v15
v_smfmac_f32_16x16x64_bf16 v[84:87], v[48:51], a[40:47], v15
Lps_76:
s_waitcnt vmcnt(0)
v_max3_u32 v44, v60, v61, v62
v_max_u32 v44, v44, v63
v_cmp_eq_u32 vcc, -1, v44
s_cbranch_vccnz Lpf_77
v_smfmac_f32_16x16x64_bf16 v[64:67], v[60:63], a[192:199], v15
s_nop 1
v_smfmac_f32_16x16x64_bf16 v[68:71], v[60:63], a[200:207], v15
s_nop 1
v_smfmac_f32_16x16x64_bf16 v[72:75], v[60:63], a[208:215], v15
s_nop 1
v_smfmac_f32_16x16x64_bf16 v[76:79], v[60:63], a[216:223], v15
v_add_f32 v96, v64, v66
v_add_f32 v97, v65, v67
v_smfmac_f32_16x16x64_bf16 v[80:83], v[60:63], a[224:231], v15
v_add_f32 v98, v68, v70
v_add_f32 v99, v69, v71
v_smfmac_f32_16x16x64_bf16 v[84:87], v[60:63], a[232:239], v15
v_add_f32 v100, v72, v74
v_add_f32 v101, v73, v75
ds_write_b128 v211, v[96:99] offset:0
v_smfmac_f32_16x16x64_bf16 v[88:91], v[48:51], a[48:55], v15
v_add_f32 v102, v76, v78
v_add_f32 v103, v77, v79
v_add_f32 v104, v80, v82
v_add_f32 v105, v81, v83
ds_write_b128 v212, v[100:103] offset:0
v_smfmac_f32_16x16x64_bf16 v[88:91], v[52:55], a[112:119], v15
v_add_f32 v106, v84, v86
v_add_f32 v107, v85, v87
ds_write_b128 v213, v[104:107] offset:0
s_branch Lpd_25
Lpf_55:
buffer_load_dwordx4 v[48:51], v10, s[4:7], s40 offen offset:0 sc1
s_sub_u32 s37, s37, 1
s_cbranch_scc1 Lend_1
s_branch Lps_54
Lpf_57:
buffer_load_dwordx4 v[56:59], v10, s[4:7], s40 offen offset:2048 sc1
Lps_78:
s_waitcnt vmcnt(2)
v_max3_u32 v44, v60, v61, v62
v_max_u32 v44, v44, v63
v_cmp_eq_u32 vcc, -1, v44
s_cbranch_vccnz Lpf_79
v_smfmac_f32_16x16x64_bf16 v[64:67], v[60:63], a[192:199], v15
v_smfmac_f32_16x16x64_bf16 v[68:71], v[60:63], a[200:207], v15
v_smfmac_f32_16x16x64_bf16 v[72:75], v[60:63], a[208:215], v15
v_smfmac_f32_16x16x64_bf16 v[76:79], v[60:63], a[216:223], v15
v_smfmac_f32_16x16x64_bf16 v[80:83], v[60:63], a[224:231], v15
v_smfmac_f32_16x16x64_bf16 v[84:87], v[60:63], a[232:239], v15
Lps_80:
s_waitcnt vmcnt(1)
v_max3_u32 v44, v52, v53, v54
v_max_u32 v44, v44, v55
v_cmp_eq_u32 vcc, -1, v44
s_cbranch_vccnz Lpf_81
v_smfmac_f32_16x16x64_bf16 v[64:67], v[52:55], a[64:71], v15
v_smfmac_f32_16x16x64_bf16 v[68:71], v[52:55], a[72:79], v15
v_smfmac_f32_16x16x64_bf16 v[72:75], v[52:55], a[80:87], v15
v_smfmac_f32_16x16x64_bf16 v[76:79], v[52:55], a[88:95], v15
v_smfmac_f32_16x16x64_bf16 v[80:83], v[52:55], a[96:103], v15
v_smfmac_f32_16x16x64_bf16 v[84:87], v[52:55], a[104:111], v15
s_branch Lps_72
Lpf_59:
buffer_load_dwordx4 v[60:63], v10, s[4:7], s40 offen offset:3072 sc1
Lps_82:
s_waitcnt vmcnt(1)
v_max3_u32 v44, v52, v53, v54
v_max_u32 v44, v44, v55
v_cmp_eq_u32 vcc, -1, v44
s_cbranch_vccnz Lpf_83
v_smfmac_f32_16x16x64_bf16 v[64:67], v[52:55], a[64:71], v15
v_smfmac_f32_16x16x64_bf16 v[68:71], v[52:55], a[72:79], v15
v_smfmac_f32_16x16x64_bf16 v[72:75], v[52:55], a[80:87], v15
v_smfmac_f32_16x16x64_bf16 v[76:79], v[52:55], a[88:95], v15
v_smfmac_f32_16x16x64_bf16 v[80:83], v[52:55], a[96:103], v15
v_smfmac_f32_16x16x64_bf16 v[84:87], v[52:55], a[104:111], v15
s_branch Lps_76
Lpf_61:
buffer_load_dwordx4 v[52:55], v10, s[4:7], s40 offen offset:1024 sc1
s_sub_u32 s37, s37, 1
s_cbranch_scc1 Lend_1
s_branch Lps_60
Lpf_63:
buffer_load_dwordx4 v[56:59], v10, s[4:7], s40 offen offset:2048 sc1
Lps_84:
s_waitcnt vmcnt(3)
v_max3_u32 v44, v60, v61, v62
v_max_u32 v44, v44, v63
v_cmp_eq_u32 vcc, -1, v44
s_cbranch_vccnz Lpf_85
v_smfmac_f32_16x16x64_bf16 v[64:67], v[60:63], a[192:199], v15
v_smfmac_f32_16x16x64_bf16 v[68:71], v[60:63], a[200:207], v15
v_smfmac_f32_16x16x64_bf16 v[72:75], v[60:63], a[208:215], v15
v_smfmac_f32_16x16x64_bf16 v[76:79], v[60:63], a[216:223], v15
v_smfmac_f32_16x16x64_bf16 v[80:83], v[60:63], a[224:231], v15
v_smfmac_f32_16x16x64_bf16 v[84:87], v[60:63], a[232:239], v15
Lps_86:
s_waitcnt vmcnt(2)
v_max3_u32 v44, v48, v49, v50
v_max_u32 v44, v44, v51
v_cmp_eq_u32 vcc, -1, v44
s_cbranch_vccnz Lpf_87
v_smfmac_f32_16x16x64_bf16 v[64:67], v[48:51], a[0:7], v15
v_smfmac_f32_16x16x64_bf16 v[68:71], v[48:51], a[8:15], v15
v_smfmac_f32_16x16x64_bf16 v[72:75], v[48:51], a[16:23], v15
v_smfmac_f32_16x16x64_bf16 v[76:79], v[48:51], a[24:31], v15
v_smfmac_f32_16x16x64_bf16 v[80:83], v[48:51], a[32:39], v15
v_smfmac_f32_16x16x64_bf16 v[84:87], v[48:51], a[40:47], v15
s_branch Lps_80
Lpf_65:
buffer_load_dwordx4 v[60:63], v10, s[4:7], s40 offen offset:3072 sc1
Lps_88:
s_waitcnt vmcnt(2)
v_max3_u32 v44, v48, v49, v50
v_max_u32 v44, v44, v51
v_cmp_eq_u32 vcc, -1, v44
s_cbranch_vccnz Lpf_89
v_smfmac_f32_16x16x64_bf16 v[64:67], v[48:51], a[0:7], v15
v_smfmac_f32_16x16x64_bf16 v[68:71], v[48:51], a[8:15], v15
v_smfmac_f32_16x16x64_bf16 v[72:75], v[48:51], a[16:23], v15
v_smfmac_f32_16x16x64_bf16 v[76:79], v[48:51], a[24:31], v15
v_smfmac_f32_16x16x64_bf16 v[80:83], v[48:51], a[32:39], v15
v_smfmac_f32_16x16x64_bf16 v[84:87], v[48:51], a[40:47], v15
s_branch Lps_82
Lpf_67:
buffer_load_dwordx4 v[48:51], v10, s[4:7], s40 offen offset:0 sc1
s_sub_u32 s37, s37, 1
s_cbranch_scc1 Lend_1
Lps_90:
s_waitcnt vmcnt(1)
v_max3_u32 v44, v52, v53, v54
v_max_u32 v44, v44, v55
v_cmp_eq_u32 vcc, -1, v44
s_cbranch_vccnz Lpf_91
v_smfmac_f32_16x16x64_bf16 v[64:67], v[52:55], a[64:71], v15
v_smfmac_f32_16x16x64_bf16 v[68:71], v[52:55], a[72:79], v15
v_smfmac_f32_16x16x64_bf16 v[72:75], v[52:55], a[80:87], v15
v_smfmac_f32_16x16x64_bf16 v[76:79], v[52:55], a[88:95], v15
v_smfmac_f32_16x16x64_bf16 v[80:83], v[52:55], a[96:103], v15
v_smfmac_f32_16x16x64_bf16 v[84:87], v[52:55], a[104:111], v15
s_branch Lps_54
Lpf_69:
buffer_load_dwordx4 v[60:63], v10, s[4:7], s40 offen offset:3072 sc1
Lps_92:
s_waitcnt vmcnt(2)
v_max3_u32 v44, v48, v49, v50
v_max_u32 v44, v44, v51
v_cmp_eq_u32 vcc, -1, v44
s_cbranch_vccnz Lpf_93
v_smfmac_f32_16x16x64_bf16 v[64:67], v[48:51], a[0:7], v15
v_smfmac_f32_16x16x64_bf16 v[68:71], v[48:51], a[8:15], v15
v_smfmac_f32_16x16x64_bf16 v[72:75], v[48:51], a[16:23], v15
v_smfmac_f32_16x16x64_bf16 v[76:79], v[48:51], a[24:31], v15
v_smfmac_f32_16x16x64_bf16 v[80:83], v[48:51], a[32:39], v15
v_smfmac_f32_16x16x64_bf16 v[84:87], v[48:51], a[40:47], v15
Lps_47:
s_waitcnt vmcnt(1)
v_max3_u32 v44, v56, v57, v58
v_max_u32 v44, v44, v59
v_cmp_eq_u32 vcc, -1, v44
s_cbranch_vccnz Lpf_94
v_smfmac_f32_16x16x64_bf16 v[64:67], v[56:59], a[128:135], v15
v_smfmac_f32_16x16x64_bf16 v[68:71], v[56:59], a[136:143], v15
v_smfmac_f32_16x16x64_bf16 v[72:75], v[56:59], a[144:151], v15
v_smfmac_f32_16x16x64_bf16 v[76:79], v[56:59], a[152:159], v15
v_smfmac_f32_16x16x64_bf16 v[80:83], v[56:59], a[160:167], v15
v_smfmac_f32_16x16x64_bf16 v[84:87], v[56:59], a[168:175], v15
s_branch Lps_76
Lpf_71:
buffer_load_dwordx4 v[48:51], v10, s[4:7], s40 offen offset:0 sc1
s_sub_u32 s37, s37, 1
s_cbranch_scc1 Lend_1
Lps_95:
s_waitcnt vmcnt(1)
v_max3_u32 v44, v56, v57, v58
v_max_u32 v44, v44, v59
v_cmp_eq_u32 vcc, -1, v44
s_cbranch_vccnz Lpf_96
v_smfmac_f32_16x16x64_bf16 v[64:67], v[56:59], a[128:135], v15
v_smfmac_f32_16x16x64_bf16 v[68:71], v[56:59], a[136:143], v15
v_smfmac_f32_16x16x64_bf16 v[72:75], v[56:59], a[144:151], v15
v_smfmac_f32_16x16x64_bf16 v[76:79], v[56:59], a[152:159], v15
v_smfmac_f32_16x16x64_bf16 v[80:83], v[56:59], a[160:167], v15
v_smfmac_f32_16x16x64_bf16 v[84:87], v[56:59], a[168:175], v15
s_branch Lps_54
Lpf_73:
buffer_load_dwordx4 v[56:59], v10, s[4:7], s40 offen offset:2048 sc1
s_sub_u32 s37, s37, 1
s_cbranch_scc1 Lend_1
s_branch Lps_72
Lpf_75:
buffer_load_dwordx4 v[48:51], v10, s[4:7], s40 offen offset:0 sc1
s_sub_u32 s37, s37, 1
s_cbranch_scc1 Lend_1
s_branch Lps_52
Lpf_77:
buffer_load_dwordx4 v[60:63], v10, s[4:7], s40 offen offset:3072 sc1
s_sub_u32 s37, s37, 1
s_cbranch_scc1 Lend_1
s_branch Lps_76
Lpf_79:
buffer_load_dwordx4 v[60:63], v10, s[4:7], s40 offen offset:3072 sc1
Lps_97:
s_waitcnt vmcnt(2)
v_max3_u32 v44, v52, v53, v54
v_max_u32 v44, v44, v55
v_cmp_eq_u32 vcc, -1, v44
s_cbranch_vccnz Lpf_98
v_smfmac_f32_16x16x64_bf16 v[64:67], v[52:55], a[64:71], v15
v_smfmac_f32_16x16x64_bf16 v[68:71], v[52:55], a[72:79], v15
v_smfmac_f32_16x16x64_bf16 v[72:75], v[52:55], a[80:87], v15
v_smfmac_f32_16x16x64_bf16 v[76:79], v[52:55], a[88:95], v15
v_smfmac_f32_16x16x64_bf16 v[80:83], v[52:55], a[96:103], v15
v_smfmac_f32_16x16x64_bf16 v[84:87], v[52:55], a[104:111], v15
s_branch Lps_47
Lpf_81:
buffer_load_dwordx4 v[52:55], v10, s[4:7], s40 offen offset:1024 sc1
s_sub_u32 s37, s37, 1
s_cbranch_scc1 Lend_1
Lps_99:
s_waitcnt vmcnt(1)
v_max3_u32 v44, v56, v57, v58
v_max_u32 v44, v44, v59
v_cmp_eq_u32 vcc, -1, v44
s_cbranch_vccnz Lpf_100
v_smfmac_f32_16x16x64_bf16 v[64:67], v[56:59], a[128:135], v15
v_smfmac_f32_16x16x64_bf16 v[68:71], v[56:59], a[136:143], v15
v_smfmac_f32_16x16x64_bf16 v[72:75], v[56:59], a[144:151], v15
v_smfmac_f32_16x16x64_bf16 v[76:79], v[56:59], a[152:159], v15
v_smfmac_f32_16x16x64_bf16 v[80:83], v[56:59], a[160:167], v15
v_smfmac_f32_16x16x64_bf16 v[84:87], v[56:59], a[168:175], v15
s_branch Lps_60
Lpf_83:
buffer_load_dwordx4 v[52:55], v10, s[4:7], s40 offen offset:1024 sc1
s_sub_u32 s37, s37, 1
s_cbranch_scc1 Lend_1
s_branch Lps_58
Lpf_85:
buffer_load_dwordx4 v[60:63], v10, s[4:7], s40 offen offset:3072 sc1
Lps_101:
s_waitcnt vmcnt(3)
v_max3_u32 v44, v48, v49, v50
v_max_u32 v44, v44, v51
v_cmp_eq_u32 vcc, -1, v44
s_cbranch_vccnz Lpf_102
v_smfmac_f32_16x16x64_bf16 v[64:67], v[48:51], a[0:7], v15
v_smfmac_f32_16x16x64_bf16 v[68:71], v[48:51], a[8:15], v15
v_smfmac_f32_16x16x64_bf16 v[72:75], v[48:51], a[16:23], v15
v_smfmac_f32_16x16x64_bf16 v[76:79], v[48:51], a[24:31], v15
v_smfmac_f32_16x16x64_bf16 v[80:83], v[48:51], a[32:39], v15
v_smfmac_f32_16x16x64_bf16 v[84:87], v[48:51], a[40:47], v15
s_branch Lps_97
Lpf_87:
buffer_load_dwordx4 v[48:51], v10, s[4:7], s40 offen offset:0 sc1
s_sub_u32 s37, s37, 1
s_cbranch_scc1 Lend_1
Lps_103:
s_waitcnt vmcnt(2)
v_max3_u32 v44, v52, v53, v54
v_max_u32 v44, v44, v55
v_cmp_eq_u32 vcc, -1, v44
s_cbranch_vccnz Lpf_104
v_smfmac_f32_16x16x64_bf16 v[64:67], v[52:55], a[64:71], v15
v_smfmac_f32_16x16x64_bf16 v[68:71], v[52:55], a[72:79], v15
v_smfmac_f32_16x16x64_bf16 v[72:75], v[52:55], a[80:87], v15
v_smfmac_f32_16x16x64_bf16 v[76:79], v[52:55], a[88:95], v15
v_smfmac_f32_16x16x64_bf16 v[80:83], v[52:55], a[96:103], v15
v_smfmac_f32_16x16x64_bf16 v[84:87], v[52:55], a[104:111], v15
s_branch Lps_95
Lpf_89:
buffer_load_dwordx4 v[48:51], v10, s[4:7], s40 offen offset:0 sc1
s_sub_u32 s37, s37, 1
s_cbranch_scc1 Lend_1
Lps_105:
s_waitcnt vmcnt(2)
v_max3_u32 v44, v52, v53, v54
v_max_u32 v44, v44, v55
v_cmp_eq_u32 vcc, -1, v44
s_cbranch_vccnz Lpf_106
v_smfmac_f32_16x16x64_bf16 v[64:67], v[52:55], a[64:71], v15
v_smfmac_f32_16x16x64_bf16 v[68:71], v[52:55], a[72:79], v15
v_smfmac_f32_16x16x64_bf16 v[72:75], v[52:55], a[80:87], v15
v_smfmac_f32_16x16x64_bf16 v[76:79], v[52:55], a[88:95], v15
v_smfmac_f32_16x16x64_bf16 v[80:83], v[52:55], a[96:103], v15
v_smfmac_f32_16x16x64_bf16 v[84:87], v[52:55], a[104:111], v15
s_branch Lps_52
Lpf_91:
buffer_load_dwordx4 v[52:55], v10, s[4:7], s40 offen offset:1024 sc1
s_branch Lps_66
Lpf_93:
buffer_load_dwordx4 v[48:51], v10, s[4:7], s40 offen offset:0 sc1
s_sub_u32 s37, s37, 1
s_cbranch_scc1 Lend_1
s_branch Lps_50
Lpf_94:
buffer_load_dwordx4 v[56:59], v10, s[4:7], s40 offen offset:2048 sc1
s_sub_u32 s37, s37, 1
s_cbranch_scc1 Lend_1
Lps_107:
s_waitcnt vmcnt(1)
v_max3_u32 v44, v60, v61, v62
v_max_u32 v44, v44, v63
v_cmp_eq_u32 vcc, -1, v44
s_cbranch_vccnz Lpf_108
v_smfmac_f32_16x16x64_bf16 v[64:67], v[60:63], a[192:199], v15
v_smfmac_f32_16x16x64_bf16 v[68:71], v[60:63], a[200:207], v15
v_smfmac_f32_16x16x64_bf16 v[72:75], v[60:63], a[208:215], v15
v_smfmac_f32_16x16x64_bf16 v[76:79], v[60:63], a[216:223], v15
v_smfmac_f32_16x16x64_bf16 v[80:83], v[60:63], a[224:231], v15
v_smfmac_f32_16x16x64_bf16 v[84:87], v[60:63], a[232:239], v15
s_branch Lps_72
Lpf_96:
buffer_load_dwordx4 v[56:59], v10, s[4:7], s40 offen offset:2048 sc1
s_branch Lps_70
Lpf_98:
buffer_load_dwordx4 v[52:55], v10, s[4:7], s40 offen offset:1024 sc1
s_sub_u32 s37, s37, 1
s_cbranch_scc1 Lend_1
s_branch Lps_56
Lpf_100:
buffer_load_dwordx4 v[56:59], v10, s[4:7], s40 offen offset:2048 sc1
s_branch Lps_80
Lpf_102:
buffer_load_dwordx4 v[48:51], v10, s[4:7], s40 offen offset:0 sc1
s_sub_u32 s37, s37, 1
s_cbranch_scc1 Lend_1
s_branch Lps_48
Lpf_104:
buffer_load_dwordx4 v[52:55], v10, s[4:7], s40 offen offset:1024 sc1
Lps_109:
s_waitcnt vmcnt(2)
v_max3_u32 v44, v56, v57, v58
v_max_u32 v44, v44, v59
v_cmp_eq_u32 vcc, -1, v44
s_cbranch_vccnz Lpf_110
v_smfmac_f32_16x16x64_bf16 v[64:67], v[56:59], a[128:135], v15
v_smfmac_f32_16x16x64_bf16 v[68:71], v[56:59], a[136:143], v15
v_smfmac_f32_16x16x64_bf16 v[72:75], v[56:59], a[144:151], v15
v_smfmac_f32_16x16x64_bf16 v[76:79], v[56:59], a[152:159], v15
v_smfmac_f32_16x16x64_bf16 v[80:83], v[56:59], a[160:167], v15
v_smfmac_f32_16x16x64_bf16 v[84:87], v[56:59], a[168:175], v15
s_branch Lps_66
Lpf_106:
buffer_load_dwordx4 v[52:55], v10, s[4:7], s40 offen offset:1024 sc1
s_branch Lps_64
Lpf_108:
buffer_load_dwordx4 v[60:63], v10, s[4:7], s40 offen offset:3072 sc1
s_branch Lps_47
Lpf_110:
buffer_load_dwordx4 v[56:59], v10, s[4:7], s40 offen offset:2048 sc1
s_branch Lps_86
Lkr_31:
buffer_load_dwordx4 v[56:59], v11, s[4:7], s40 offen offset:0 sc1
buffer_load_dwordx4 v[60:63], v11, s[4:7], s40 offen offset:1024 sc1
Lps_112:
s_waitcnt vmcnt(3)
v_max3_u32 v44, v48, v49, v50
v_max_u32 v44, v44, v51
v_cmp_eq_u32 vcc, -1, v44
s_cbranch_vccnz Lpf_113
v_smfmac_f32_16x16x64_bf16 v[72:75], v[48:51], v[96:103], v15
v_mov_b32 v112, v48
v_mov_b32 v113, v49
v_mov_b32 v114, v50
v_mov_b32 v115, v51
Lps_114:
s_waitcnt vmcnt(2)
v_max3_u32 v44, v52, v53, v54
v_max_u32 v44, v44, v55
v_cmp_eq_u32 vcc, -1, v44
s_cbranch_vccnz Lpf_115
v_smfmac_f32_16x16x64_bf16 v[72:75], v[52:55], v[104:111], v15
v_mov_b32 v116, v52
v_mov_b32 v117, v53
v_mov_b32 v118, v54
v_mov_b32 v119, v55
Lpd_111:
s_branch Lko_32
Lpf_113:
buffer_load_dwordx4 v[48:51], v11, s[4:7], s40 offen offset:0 sc1
s_sub_u32 s37, s37, 1
s_cbranch_scc1 Lend_1
Lps_116:
s_waitcnt vmcnt(3)
v_max3_u32 v44, v52, v53, v54
v_max_u32 v44, v44, v55
v_cmp_eq_u32 vcc, -1, v44
s_cbranch_vccnz Lpf_117
v_smfmac_f32_16x16x64_bf16 v[72:75], v[52:55], v[104:111], v15
v_mov_b32 v116, v52
v_mov_b32 v117, v53
v_mov_b32 v118, v54
v_mov_b32 v119, v55
Lps_118:
s_waitcnt vmcnt(2)
v_max3_u32 v44, v56, v57, v58
v_max_u32 v44, v44, v59
v_cmp_eq_u32 vcc, -1, v44
s_cbranch_vccnz Lpf_119
v_smfmac_f32_16x16x64_bf16 v[72:75], v[56:59], v[96:103], v15
v_mov_b32 v112, v56
v_mov_b32 v113, v57
v_mov_b32 v114, v58
v_mov_b32 v115, v59
s_branch Lpd_111
Lpf_115:
buffer_load_dwordx4 v[52:55], v11, s[4:7], s40 offen offset:1024 sc1
s_sub_u32 s37, s37, 1
s_cbranch_scc1 Lend_1
Lps_120:
s_waitcnt vmcnt(2)
v_max3_u32 v44, v56, v57, v58
v_max_u32 v44, v44, v59
v_cmp_eq_u32 vcc, -1, v44
s_cbranch_vccnz Lpf_121
Lps_122:
s_waitcnt vmcnt(1)
v_max3_u32 v44, v60, v61, v62
v_max_u32 v44, v44, v63
v_cmp_eq_u32 vcc, -1, v44
s_cbranch_vccnz Lpf_123
v_smfmac_f32_16x16x64_bf16 v[72:75], v[60:63], v[104:111], v15
v_mov_b32 v116, v60
v_mov_b32 v117, v61
v_mov_b32 v118, v62
v_mov_b32 v119, v63
s_branch Lpd_111
Lpf_117:
buffer_load_dwordx4 v[52:55], v11, s[4:7], s40 offen offset:1024 sc1
Lps_124:
s_waitcnt vmcnt(3)
v_max3_u32 v44, v56, v57, v58
v_max_u32 v44, v44, v59
v_cmp_eq_u32 vcc, -1, v44
s_cbranch_vccnz Lpf_125
v_smfmac_f32_16x16x64_bf16 v[72:75], v[56:59], v[96:103], v15
v_mov_b32 v112, v56
v_mov_b32 v113, v57
v_mov_b32 v114, v58
v_mov_b32 v115, v59
Lps_126:
s_waitcnt vmcnt(2)
v_max3_u32 v44, v60, v61, v62
v_max_u32 v44, v44, v63
v_cmp_eq_u32 vcc, -1, v44
s_cbranch_vccnz Lpf_127
v_smfmac_f32_16x16x64_bf16 v[72:75], v[60:63], v[104:111], v15
v_mov_b32 v116, v60
v_mov_b32 v117, v61
v_mov_b32 v118, v62
v_mov_b32 v119, v63
s_branch Lpd_111
Lpf_119:
buffer_load_dwordx4 v[56:59], v11, s[4:7], s40 offen offset:0 sc1
Lps_128:
s_waitcnt vmcnt(2)
v_max3_u32 v44, v60, v61, v62
v_max_u32 v44, v44, v63
v_cmp_eq_u32 vcc, -1, v44
s_cbranch_vccnz Lpf_129
Lps_130:
s_waitcnt vmcnt(1)
v_max3_u32 v44, v48, v49, v50
v_max_u32 v44, v44, v51
v_cmp_eq_u32 vcc, -1, v44
s_cbranch_vccnz Lpf_131
v_smfmac_f32_16x16x64_bf16 v[72:75], v[48:51], v[96:103], v15
v_mov_b32 v112, v48
v_mov_b32 v113, v49
v_mov_b32 v114, v50
v_mov_b32 v115, v51
s_branch Lpd_111
Lpf_121:
buffer_load_dwordx4 v[56:59], v11, s[4:7], s40 offen offset:0 sc1
Lps_132:
s_waitcnt vmcnt(2)
v_max3_u32 v44, v60, v61, v62
v_max_u32 v44, v44, v63
v_cmp_eq_u32 vcc, -1, v44
s_cbranch_vccnz Lpf_133
v_smfmac_f32_16x16x64_bf16 v[72:75], v[60:63], v[104:111], v15
v_mov_b32 v116, v60
v_mov_b32 v117, v61
v_mov_b32 v118, v62
v_mov_b32 v119, v63
s_branch Lpd_111
Lpf_123:
buffer_load_dwordx4 v[60:63], v11, s[4:7], s40 offen offset:1024 sc1
Lps_134:
s_waitcnt vmcnt(1)
v_max3_u32 v44, v52, v53, v54
v_max_u32 v44, v44, v55
v_cmp_eq_u32 vcc, -1, v44
s_cbranch_vccnz Lpf_135
v_smfmac_f32_16x16x64_bf16 v[72:75], v[52:55], v[104:111], v15
v_mov_b32 v116, v52
v_mov_b32 v117, v53
v_mov_b32 v118, v54
v_mov_b32 v119, v55
s_branch Lpd_111
Lpf_125:
buffer_load_dwordx4 v[56:59], v11, s[4:7], s40 offen offset:0 sc1
Lps_136:
s_waitcnt vmcnt(3)
v_max3_u32 v44, v60, v61, v62
v_max_u32 v44, v44, v63
v_cmp_eq_u32 vcc, -1, v44
s_cbranch_vccnz Lpf_137
v_smfmac_f32_16x16x64_bf16 v[72:75], v[60:63], v[104:111], v15
v_mov_b32 v116, v60
v_mov_b32 v117, v61
v_mov_b32 v118, v62
v_mov_b32 v119, v63
Lps_138:
s_waitcnt vmcnt(2)
v_max3_u32 v44, v48, v49, v50
v_max_u32 v44, v44, v51
v_cmp_eq_u32 vcc, -1, v44
s_cbranch_vccnz Lpf_139
v_smfmac_f32_16x16x64_bf16 v[72:75], v[48:51], v[96:103], v15
v_mov_b32 v112, v48
v_mov_b32 v113, v49
v_mov_b32 v114, v50
v_mov_b32 v115, v51
s_branch Lpd_111
Lpf_127:
buffer_load_dwordx4 v[60:63], v11, s[4:7], s40 offen offset:1024 sc1
Lps_140:
s_waitcnt vmcnt(2)
v_max3_u32 v44, v48, v49, v50
v_max_u32 v44, v44, v51
v_cmp_eq_u32 vcc, -1, v44
s_cbranch_vccnz Lpf_141
s_branch Lps_134
Lpf_129:
buffer_load_dwordx4 v[60:63], v11, s[4:7], s40 offen offset:1024 sc1
Lps_142:
s_waitcnt vmcnt(2)
v_max3_u32 v44, v48, v49, v50
v_max_u32 v44, v44, v51
v_cmp_eq_u32 vcc, -1, v44
s_cbranch_vccnz Lpf_143
v_smfmac_f32_16x16x64_bf16 v[72:75], v[48:51], v[96:103], v15
v_mov_b32 v112, v48
v_mov_b32 v113, v49
v_mov_b32 v114, v50
v_mov_b32 v115, v51
s_branch Lpd_111
Lpf_131:
buffer_load_dwordx4 v[48:51], v11, s[4:7], s40 offen offset:0 sc1
s_sub_u32 s37, s37, 1
s_cbranch_scc1 Lend_1
Lps_144:
s_waitcnt vmcnt(1)
v_max3_u32 v44, v56, v57, v58
v_max_u32 v44, v44, v59
v_cmp_eq_u32 vcc, -1, v44
s_cbranch_vccnz Lpf_145
v_smfmac_f32_16x16x64_bf16 v[72:75], v[56:59], v[96:103], v15
v_mov_b32 v112, v56
v_mov_b32 v113, v57
v_mov_b32 v114, v58
v_mov_b32 v115, v59
s_branch Lpd_111
Lpf_133:
buffer_load_dwordx4 v[60:63], v11, s[4:7], s40 offen offset:1024 sc1
s_branch Lps_114
Lpf_135:
buffer_load_dwordx4 v[52:55], v11, s[4:7], s40 offen offset:1024 sc1
s_sub_u32 s37, s37, 1
s_cbranch_scc1 Lend_1
s_branch Lps_122
Lpf_137:
buffer_load_dwordx4 v[60:63], v11, s[4:7], s40 offen offset:1024 sc1
s_branch Lps_112
Lpf_139:
buffer_load_dwordx4 v[48:51], v11, s[4:7], s40 offen offset:0 sc1
s_sub_u32 s37, s37, 1
s_cbranch_scc1 Lend_1
Lps_146:
s_waitcnt vmcnt(2)
v_max3_u32 v44, v52, v53, v54
v_max_u32 v44, v44, v55
v_cmp_eq_u32 vcc, -1, v44
s_cbranch_vccnz Lpf_147
s_branch Lps_144
Lpf_141:
buffer_load_dwordx4 v[48:51], v11, s[4:7], s40 offen offset:0 sc1
s_sub_u32 s37, s37, 1
s_cbranch_scc1 Lend_1
Lps_148:
s_waitcnt vmcnt(2)
v_max3_u32 v44, v52, v53, v54
v_max_u32 v44, v44, v55
v_cmp_eq_u32 vcc, -1, v44
s_cbranch_vccnz Lpf_149
v_smfmac_f32_16x16x64_bf16 v[72:75], v[52:55], v[104:111], v15
v_mov_b32 v116, v52
v_mov_b32 v117, v53
v_mov_b32 v118, v54
v_mov_b32 v119, v55
s_branch Lpd_111
Lpf_143:
buffer_load_dwordx4 v[48:51], v11, s[4:7], s40 offen offset:0 sc1
s_sub_u32 s37, s37, 1
s_cbranch_scc1 Lend_1
s_branch Lps_118
Lpf_145:
buffer_load_dwordx4 v[56:59], v11, s[4:7], s40 offen offset:0 sc1
s_branch Lps_130
Lpf_147:
buffer_load_dwordx4 v[52:55], v11, s[4:7], s40 offen offset:1024 sc1
Lps_150:
s_waitcnt vmcnt(2)
v_max3_u32 v44, v56, v57, v58
v_max_u32 v44, v44, v59
v_cmp_eq_u32 vcc, -1, v44
s_cbranch_vccnz Lpf_151
v_smfmac_f32_16x16x64_bf16 v[72:75], v[56:59], v[96:103], v15
v_mov_b32 v112, v56
v_mov_b32 v113, v57
v_mov_b32 v114, v58
v_mov_b32 v115, v59
s_branch Lpd_111
Lpf_149:
buffer_load_dwordx4 v[52:55], v11, s[4:7], s40 offen offset:1024 sc1
s_branch Lps_126
Lpf_151:
buffer_load_dwordx4 v[56:59], v11, s[4:7], s40 offen offset:0 sc1
s_branch Lps_138
Lvr_33:
buffer_load_dwordx2 v[120:121], v12, s[4:7], s40 offen sc1
buffer_load_dwordx2 v[122:123], v13, s[4:7], s40 offen sc1
s_sub_u32 s37, s37, 1
s_cbranch_scc1 Lend_1
s_waitcnt vmcnt(0)
v_max3_u32 v44, v120, v121, v122
v_max_u32 v44, v44, v123
v_cmp_eq_u32 vcc, -1, v44
s_cbranch_vccnz Lvr_33
s_branch Lvo_34
Lq_sc1_18:
Lq_152:
s_cmp_gt_u32 s36, 3
s_cbranch_scc1 Lqf_153
s_waitcnt vmcnt(0)
s_barrier
s_cmp_eq_u32 s36, 0
s_cbranch_scc1 Lqn_154
Lqf_153:
ds_read_b128 v[128:131], v22 offset:0
ds_read_b128 v[132:135], v22 offset:1024
ds_read_b128 v[136:139], v22 offset:2048
ds_read_b128 v[140:143], v22 offset:3072
ds_read_b128 v[144:147], v22 offset:4096
ds_read_b128 v[148:151], v22 offset:5120
ds_read_b128 v[152:155], v22 offset:6144
ds_read_b128 v[156:159], v22 offset:7168
ds_read_b128 v[160:163], v24 offset:0
ds_read_b128 v[164:167], v24 offset:1024
ds_read_b128 v[168:171], v25 offset:0
ds_read_b128 v[172:175], v25 offset:1024
ds_read_b128 v[176:179], v23 offset:0
ds_read_b128 v[180:183], v23 offset:1024
ds_read_b128 v[184:187], v23 offset:2048
ds_read_b128 v[188:191], v23 offset:3072
v_xor_b32 v22, 98304, v22
v_xor_b32 v24, 98304, v24
v_xor_b32 v25, 98304, v25
v_xor_b32 v23, 98304, v23
Lqn_154:
s_and_b32 s38, s36, 3
s_lshl_b32 s39, s38, 16
s_add_u32 s40, s39, s45
s_xor_b32 s42, s40, 0x20000
s_add_u32 s26, s36, 1
v_pk_mul_f32 v[64:65], 0, 0
v_pk_mul_f32 v[66:67], 0, 0
v_pk_mul_f32 v[68:69], 0, 0
v_pk_mul_f32 v[70:71], 0, 0
v_pk_mul_f32 v[72:73], 0, 0
v_pk_mul_f32 v[74:75], 0, 0
v_pk_mul_f32 v[76:77], 0, 0
v_pk_mul_f32 v[78:79], 0, 0
v_pk_mul_f32 v[80:81], 0, 0
v_pk_mul_f32 v[82:83], 0, 0
v_pk_mul_f32 v[84:85], 0, 0
v_pk_mul_f32 v[86:87], 0, 0
v_pk_mul_f32 v[88:89], 0, 0
v_pk_mul_f32 v[90:91], 0, 0
v_pk_mul_f32 v[92:93], 0, 0
v_pk_mul_f32 v[94:95], 0, 0
v_mov_b32 v214, v197
s_waitcnt vmcnt(0)
buffer_store_dword v214, v199, s[4:7], 0 offen sc1
v_add_u32 v197, 1, v197
s_cmp_eq_u32 s36, 63
s_cbranch_scc1 Lqz_155
s_mov_b64 exec, 15
buffer_load_dword v216, v192, s[4:7], s59 offen sc1
s_nop 5
buffer_load_dword v217, v192, s[4:7], s59 offen sc1
s_nop 5
buffer_load_dword v218, v192, s[4:7], s59 offen sc1
Lft_157:
s_waitcnt vmcnt(2)
v_cmp_gt_u32 vcc, s26, v216
buffer_load_dword v216, v192, s[4:7], s59 offen sc1
s_cbranch_vccz Lfg_156
s_waitcnt vmcnt(2)
v_cmp_gt_u32 vcc, s26, v217
buffer_load_dword v217, v192, s[4:7], s59 offen sc1
s_cbranch_vccz Lfg_156
s_waitcnt vmcnt(2)
v_cmp_gt_u32 vcc, s26, v218
buffer_load_dword v218, v192, s[4:7], s59 offen sc1
s_cbranch_vccz Lfg_156
s_sub_u32 s37, s37, 1
s_cbranch_scc1 Lend_1
s_branch Lft_157
Lfg_156:
s_mov_b64 exec, -1
buffer_load_dwordx4 v[48:51], v10, s[4:7], s40 offen offset:0 sc1
s_nop 11
buffer_load_dwordx4 v[52:55], v10, s[4:7], s40 offen offset:1024 sc1
s_nop 11
buffer_load_dwordx4 v[56:59], v10, s[4:7], s40 offen offset:2048 sc1
s_nop 11
buffer_load_dwordx4 v[60:63], v10, s[4:7], s40 offen offset:3072 sc1
s_nop 11
s_waitcnt vmcnt(3)
v_max3_u32 v44, v48, v49, v50
v_max_u32 v44, v44, v51
v_cmp_eq_u32 vcc, -1, v44
s_cbranch_vccnz Lpf_159
v_smfmac_f32_16x16x64_bf16 v[64:67], v[48:51], a[0:7], v15
v_smfmac_f32_16x16x64_bf16 v[68:71], v[48:51], a[8:15], v15
v_smfmac_f32_16x16x64_bf16 v[72:75], v[48:51], a[16:23], v15
s_waitcnt vmcnt(2)
v_max3_u32 v44, v52, v53, v54
v_max_u32 v44, v44, v55
v_cmp_eq_u32 vcc, -1, v44
v_smfmac_f32_16x16x64_bf16 v[76:79], v[48:51], a[24:31], v15
v_smfmac_f32_16x16x64_bf16 v[80:83], v[48:51], a[32:39], v15
v_smfmac_f32_16x16x64_bf16 v[84:87], v[48:51], a[40:47], v15
s_cbranch_vccnz Lpf_160
v_smfmac_f32_16x16x64_bf16 v[64:67], v[52:55], a[64:71], v15
v_smfmac_f32_16x16x64_bf16 v[68:71], v[52:55], a[72:79], v15
v_smfmac_f32_16x16x64_bf16 v[72:75], v[52:55], a[80:87], v15
s_waitcnt vmcnt(0)
v_max3_u32 v44, v56, v57, v58
v_max3_u32 v44, v44, v59, v60
v_max3_u32 v44, v44, v61, v62
v_max_u32 v44, v44, v63
v_cmp_eq_u32 vcc, -1, v44
v_smfmac_f32_16x16x64_bf16 v[76:79], v[52:55], a[88:95], v15
v_smfmac_f32_16x16x64_bf16 v[80:83], v[52:55], a[96:103], v15
v_smfmac_f32_16x16x64_bf16 v[84:87], v[52:55], a[104:111], v15
s_cbranch_vccnz Lpj_161
v_smfmac_f32_16x16x64_bf16 v[64:67], v[56:59], a[128:135], v15
s_nop 1
v_smfmac_f32_16x16x64_bf16 v[64:67], v[60:63], a[192:199], v15
s_nop 1
v_smfmac_f32_16x16x64_bf16 v[68:71], v[56:59], a[136:143], v15
s_nop 1
v_smfmac_f32_16x16x64_bf16 v[68:71], v[60:63], a[200:207], v15
s_nop 1
v_smfmac_f32_16x16x64_bf16 v[72:75], v[56:59], a[144:151], v15
v_add_f32 v96, v64, v66
v_add_f32 v97, v65, v67
v_smfmac_f32_16x16x64_bf16 v[72:75], v[60:63], a[208:215], v15
s_nop 1
v_smfmac_f32_16x16x64_bf16 v[76:79], v[56:59], a[152:159], v15
v_add_f32 v98, v68, v70
v_add_f32 v99, v69, v71
v_smfmac_f32_16x16x64_bf16 v[76:79], v[60:63], a[216:223], v15
ds_write_b128 v211, v[96:99] offset:0
s_nop 0
v_smfmac_f32_16x16x64_bf16 v[80:83], v[56:59], a[160:167], v15
v_add_f32 v100, v72, v74
v_add_f32 v101, v73, v75
v_smfmac_f32_16x16x64_bf16 v[80:83], v[60:63], a[224:231], v15
s_nop 1
v_smfmac_f32_16x16x64_bf16 v[84:87], v[56:59], a[168:175], v15
v_add_f32 v102, v76, v78
v_add_f32 v103, v77, v79
v_smfmac_f32_16x16x64_bf16 v[84:87], v[60:63], a[232:239], v15
ds_write_b128 v212, v[100:103] offset:0
s_nop 0
v_smfmac_f32_16x16x64_bf16 v[88:91], v[48:51], a[48:55], v15
v_add_f32 v104, v80, v82
v_add_f32 v105, v81, v83
v_smfmac_f32_16x16x64_bf16 v[88:91], v[52:55], a[112:119], v15
s_nop 1
v_add_f32 v106, v84, v86
v_add_f32 v107, v85, v87
ds_write_b128 v213, v[104:107] offset:0
Lpd_158:
v_smfmac_f32_16x16x64_bf16 v[88:91], v[56:59], a[176:183], v15
v_smfmac_f32_16x16x64_bf16 v[88:91], v[60:63], a[240:247], v15
v_smfmac_f32_16x16x64_bf16 v[92:95], v[48:51], a[56:63], v15
v_smfmac_f32_16x16x64_bf16 v[92:95], v[52:55], a[120:127], v15
s_waitcnt lgkmcnt(0)
s_barrier
ds_read_b128 v[76:79], v18 offset:0
ds_read_b128 v[80:83], v18 offset:1024
ds_read_b128 v[84:87], v18 offset:2048
v_smfmac_f32_16x16x64_bf16 v[92:95], v[56:59], a[184:191], v15
v_smfmac_f32_16x16x64_bf16 v[92:95], v[60:63], a[248:255], v15
v_mov_b32 v72, 0
v_mov_b32 v73, 0
v_mov_b32 v74, 0
v_mov_b32 v75, 0
v_add_f32 v108, v88, v90
v_add_f32 v109, v89, v91
s_nop 1
v_add_f32 v110, v92, v94
v_add_f32 v111, v93, v95
s_waitcnt lgkmcnt(0)
v_pk_add_f32 v[76:77], v[76:77], v[108:109]
v_pk_add_f32 v[80:81], v[80:81], v[84:85]
v_pk_add_f32 v[78:79], v[78:79], v[110:111]
v_pk_add_f32 v[82:83], v[82:83], v[86:87]
v_pk_add_f32 v[76:77], v[76:77], v[80:81]
v_pk_add_f32 v[78:79], v[78:79], v[82:83]
v_cvt_pk_bf16_f32 v76, v76, v77
v_cvt_pk_bf16_f32 v77, v78, v79
ds_write2st64_b32 v19, v76, v77 offset0:48 offset1:49
s_cmp_eq_u32 s36, 0
s_cbranch_scc1 Lq0_162
Lq1_163:
buffer_load_dwordx4 v[112:115], v11, s[4:7], s40 offen offset:0 sc1
buffer_load_dwordx4 v[116:119], v11, s[4:7], s40 offen offset:1024 sc1
s_waitcnt lgkmcnt(0)
s_barrier
ds_read_b64_tr_b16 v[96:97], v20 offset:12288
ds_read_b64_tr_b16 v[98:99], v20 offset:12544
ds_read_b64_tr_b16 v[100:101], v20 offset:12800
ds_read_b64_tr_b16 v[102:103], v20 offset:13056
ds_read_b64_tr_b16 v[104:105], v20 offset:13312
ds_read_b64_tr_b16 v[106:107], v20 offset:13568
ds_read_b64_tr_b16 v[108:109], v20 offset:13824
ds_read_b64_tr_b16 v[110:111], v20 offset:14080
s_waitcnt lgkmcnt(6)
v_mfma_f32_16x16x32_bf16 v[64:67], v[128:131], v[96:99], 0
v_mfma_f32_16x16x32_bf16 v[68:71], v[144:147], v[96:99], 0
s_waitcnt lgkmcnt(4)
buffer_load_dwordx4 v[48:51], v11, s[4:7], s40 offen offset:0 sc1
v_mfma_f32_16x16x32_bf16 v[64:67], v[132:135], v[100:103], v[64:67]
v_mfma_f32_16x16x32_bf16 v[68:71], v[148:151], v[100:103], v[68:71]
s_waitcnt lgkmcnt(2)
buffer_load_dwordx4 v[52:55], v11, s[4:7], s40 offen offset:1024 sc1
v_mfma_f32_16x16x32_bf16 v[64:67], v[136:139], v[104:107], v[64:67]
v_mfma_f32_16x16x32_bf16 v[68:71], v[152:155], v[104:107], v[68:71]
s_waitcnt lgkmcnt(0)
s_waitcnt vmcnt(2)
v_max3_u32 v44, v112, v113, v114
v_max3_u32 v44, v44, v115, v116
v_max3_u32 v44, v44, v117, v118
v_max_u32 v44, v44, v119
v_cmp_eq_u32 vcc, -1, v44
v_mfma_f32_16x16x32_bf16 v[64:67], v[140:143], v[108:111], v[64:67]
v_mfma_f32_16x16x32_bf16 v[68:71], v[156:159], v[108:111], v[68:71]
s_cbranch_vccnz Lkr_164
v_smfmac_f32_16x16x64_bf16 v[72:75], v[112:115], v[96:103], v15
v_smfmac_f32_16x16x64_bf16 v[72:75], v[116:119], v[104:111], v15
Lko_165:
s_nop 3
v_max3_f32 v45, v64, v65, v66
v_max3_f32 v45, v45, v67, v68
v_max3_f32 v45, v45, v69, v70
v_max_f32 v45, v45, v71
v_pk_add_f32 v[72:73], v[72:73], v[74:75]
v_max3_f32 v46, v45, v72, v73
v_max3_f32 v47, v45, v72, v73
buffer_load_dwordx2 v[120:121], v12, s[4:7], s40 offen sc1
buffer_load_dwordx2 v[122:123], v13, s[4:7], s40 offen sc1
v_permlane32_swap_b32 v46, v47
v_max_f32 v45, v46, v47
v_max_f32 v46, v46, v47
s_nop 1
v_permlane16_swap_b32 v45, v46
v_max_f32 v45, v45, v46
v_mul_f32 v46, s49, v45
v_pk_fma_f32 v[64:65], v[64:65], s[48:49], v[46:47] op_sel_hi:[1,0,0]
v_pk_fma_f32 v[66:67], v[66:67], s[48:49], v[46:47] op_sel_hi:[1,0,0]
v_pk_fma_f32 v[68:69], v[68:69], s[48:49], v[46:47] op_sel_hi:[1,0,0]
v_pk_fma_f32 v[70:71], v[70:71], s[48:49], v[46:47] op_sel_hi:[1,0,0]
v_pk_fma_f32 v[72:73], v[72:73], s[48:49], v[46:47] op_sel_hi:[1,0,0]
v_exp_f32 v64, v64
v_exp_f32 v65, v65
v_exp_f32 v66, v66
v_exp_f32 v67, v67
v_exp_f32 v68, v68
v_exp_f32 v69, v69
v_exp_f32 v70, v70
v_exp_f32 v71, v71
v_exp_f32 v72, v72
v_exp_f32 v73, v73
buffer_store_dword v197, v193, s[4:7], s59 offen sc1
v_cvt_pk_bf16_f32 v76, v64, v65
v_cvt_pk_bf16_f32 v77, v66, v67
v_cvt_pk_bf16_f32 v78, v68, v69
v_cvt_pk_bf16_f32 v79, v70, v71
v_cvt_pk_bf16_f32 v2, v72, v73
v_cvt_pk_bf16_f32 v7, v72, v73
v_mfma_f32_16x16x32_bf16 v[84:87], v[32:35], v[76:79], 0
v_mfma_f32_16x16x32_bf16 v[84:87], v[32:35], v[2:5], v[84:87]
v_mfma_f32_16x16x32_bf16 v[96:99], v[160:163], v[76:79], 0
s_waitcnt vmcnt(1)
v_max3_u32 v44, v120, v121, v122
v_max_u32 v44, v44, v123
v_cmp_eq_u32 vcc, -1, v44
v_mfma_f32_16x16x32_bf16 v[100:103], v[164:167], v[76:79], 0
s_cbranch_vccnz Lvr_166
Lvo_167:
v_mfma_f32_16x16x32_bf16 v[96:99], v[120:123], v[2:5], v[96:99]
v_mfma_f32_16x16x32_bf16 v[100:103], v[120:123], v[6:9], v[100:103]
v_rcp_f32 v46, v84
s_nop 5
v_pk_mul_f32 v[96:97], v[96:97], v[46:47] op_sel_hi:[1,0]
v_pk_mul_f32 v[98:99], v[98:99], v[46:47] op_sel_hi:[1,0]
v_pk_mul_f32 v[100:101], v[100:101], v[46:47] op_sel_hi:[1,0]
v_pk_mul_f32 v[102:103], v[102:103], v[46:47] op_sel_hi:[1,0]
v_cvt_pk_bf16_f32 v124, v96, v97
v_cvt_pk_bf16_f32 v125, v98, v99
v_cvt_pk_bf16_f32 v126, v100, v101
v_cvt_pk_bf16_f32 v127, v102, v103
buffer_store_dwordx4 v[124:127], v14, s[4:7], s40 offen sc1
s_barrier
buffer_store_dwordx4 v[28:31], v14, s[4:7], s42 offen sc1
s_cmp_eq_u32 s36, 2
s_cbranch_scc1 Lp2_170
Lp1_171:
s_add_u32 s27, s27, 1
s_min_u32 s27, s27, 64
v_add_u32 v44, v209, v210
v_cmp_gt_u32 vcc, s27, v44
v_mov_b32 v72, 0
v_mov_b32 v73, 0
v_mov_b32 v74, 0
v_mov_b32 v75, 0
s_add_u32 s38, s36, 2
s_and_b32 s38, s38, 3
s_lshl_b32 s88, s38, 18
s_add_u32 s88, s88, s46
s_add_u32 s89, s88, 0x100000
s_cmp_lt_u32 s36, 62
s_cselect_b32 s53, s47, 0x70000000
s_cbranch_vccnz Lpw_168
Lpk_169:
buffer_store_dwordx2 v[28:29], v198, s[4:7], s88 offen sc1
buffer_store_dwordx2 v[28:29], v198, s[4:7], s89 offen sc1
v_mfma_f32_16x16x32_bf16 v[64:67], v[128:131], v[176:179], v[36:39]
v_mfma_f32_16x16x32_bf16 v[68:71], v[144:147], v[176:179], v[40:43]
s_mov_b32 m0, s57
s_add_u32 s52, s53, 3072
buffer_load_dwordx4 v21, s[4:7], s53 offen offset:0 sc1 lds
v_mfma_f32_16x16x32_bf16 v[64:67], v[132:135], v[180:183], v[64:67]
v_mfma_f32_16x16x32_bf16 v[68:71], v[148:151], v[180:183], v[68:71]
v_mfma_f32_16x16x32_bf16 v[64:67], v[136:139], v[184:187], v[64:67]
v_mfma_f32_16x16x32_bf16 v[68:71], v[152:155], v[184:187], v[68:71]
buffer_load_dwordx4 v21, s[4:7], s53 offen offset:1024 sc1 lds
v_mfma_f32_16x16x32_bf16 v[64:67], v[140:143], v[188:191], v[64:67]
v_mfma_f32_16x16x32_bf16 v[68:71], v[156:159], v[188:191], v[68:71]
v_smfmac_f32_16x16x64_bf16 v[72:75], v[112:115], v[176:183], v15
v_smfmac_f32_16x16x64_bf16 v[72:75], v[116:119], v[184:191], v15
s_and_b32 s38, s36, 7
s_lshl_b32 s38, s38, 18
s_add_u32 s50, s38, 83886080
buffer_load_dwordx4 v21, s[4:7], s53 offen offset:2048 sc1 lds
s_nop 1
v_max3_f32 v45, v64, v65, v66
v_max3_f32 v45, v45, v67, v68
v_max3_f32 v45, v45, v69, v70
v_max_f32 v45, v45, v71
v_pk_add_f32 v[72:73], v[72:73], v[74:75]
v_max3_f32 v46, v45, v72, v73
v_max3_f32 v47, v45, v72, v73
s_nop 1
v_permlane32_swap_b32 v46, v47
v_max_f32 v45, v46, v47
v_max_f32 v46, v46, v47
s_nop 1
v_permlane16_swap_b32 v45, v46
v_max_f32 v45, v45, v46
v_mul_f32 v46, s49, v45
s_add_u32 m0, s57, 3072
s_xor_b32 s57, s57, 98304
buffer_load_dwordx4 v21, s[4:7], s52 offen offset:0 sc1 lds
v_pk_fma_f32 v[64:65], v[64:65], s[48:49], v[46:47] op_sel_hi:[1,0,0]
v_pk_fma_f32 v[66:67], v[66:67], s[48:49], v[46:47] op_sel_hi:[1,0,0]
v_pk_fma_f32 v[68:69], v[68:69], s[48:49], v[46:47] op_sel_hi:[1,0,0]
v_pk_fma_f32 v[70:71], v[70:71], s[48:49], v[46:47] op_sel_hi:[1,0,0]
v_pk_fma_f32 v[72:73], v[72:73], s[48:49], v[46:47] op_sel_hi:[1,0,0]
v_exp_f32 v64, v64
v_exp_f32 v65, v65
v_exp_f32 v66, v66
v_exp_f32 v67, v67
v_exp_f32 v68, v68
buffer_load_dwordx4 v21, s[4:7], s52 offen offset:1024 sc1 lds
v_exp_f32 v69, v69
v_exp_f32 v70, v70
v_exp_f32 v71, v71
v_exp_f32 v72, v72
v_exp_f32 v73, v73
buffer_load_dwordx4 v21, s[4:7], s52 offen offset:2048 sc1 lds
s_add_u32 s47, s47, 786432
buffer_load_dword v209, v208, s[4:7], 0 offen sc1
v_cvt_pk_bf16_f32 v76, v64, v65
v_cvt_pk_bf16_f32 v77, v66, v67
v_cvt_pk_bf16_f32 v78, v68, v69
v_cvt_pk_bf16_f32 v79, v70, v71
v_cvt_pk_bf16_f32 v2, v72, v73
v_cvt_pk_bf16_f32 v7, v72, v73
v_mfma_f32_16x16x32_bf16 v[84:87], v[32:35], v[76:79], 0
v_mfma_f32_16x16x32_bf16 v[84:87], v[32:35], v[2:5], v[84:87]
v_mfma_f32_16x16x32_bf16 v[96:99], v[160:163], v[76:79], 0
v_mfma_f32_16x16x32_bf16 v[100:103], v[164:167], v[76:79], 0
v_mfma_f32_16x16x32_bf16 v[104:107], v[168:171], v[76:79], 0
v_mfma_f32_16x16x32_bf16 v[108:111], v[172:175], v[76:79], 0
v_mfma_f32_16x16x32_bf16 v[96:99], v[120:123], v[2:5], v[96:99]
v_mfma_f32_16x16x32_bf16 v[100:103], v[120:123], v[6:9], v[100:103]
v_mfma_f32_16x16x32_bf16 v[104:107], v[120:123], v[0:3], v[104:107]
v_mfma_f32_16x16x32_bf16 v[108:111], v[120:123], v[4:7], v[108:111]
v_rcp_f32 v46, v84
s_nop 3
v_pk_mul_f32 v[96:97], v[96:97], v[46:47] op_sel_hi:[1,0]
v_pk_mul_f32 v[98:99], v[98:99], v[46:47] op_sel_hi:[1,0]
v_pk_mul_f32 v[100:101], v[100:101], v[46:47] op_sel_hi:[1,0]
v_pk_mul_f32 v[102:103], v[102:103], v[46:47] op_sel_hi:[1,0]
v_pk_mul_f32 v[104:105], v[104:105], v[46:47] op_sel_hi:[1,0]
v_pk_mul_f32 v[106:107], v[106:107], v[46:47] op_sel_hi:[1,0]
v_pk_mul_f32 v[108:109], v[108:109], v[46:47] op_sel_hi:[1,0]
v_pk_mul_f32 v[110:111], v[110:111], v[46:47] op_sel_hi:[1,0]
v_cvt_pk_bf16_f32 v96, v96, v97
v_cvt_pk_bf16_f32 v97, v98, v99
v_cvt_pk_bf16_f32 v98, v100, v101
v_cvt_pk_bf16_f32 v99, v102, v103
v_cvt_pk_bf16_f32 v100, v104, v105
v_cvt_pk_bf16_f32 v101, v106, v107
v_cvt_pk_bf16_f32 v102, v108, v109
v_cvt_pk_bf16_f32 v103, v110, v111
buffer_store_dwordx4 v[96:99], v26, s[4:7], s50 offen sc1
buffer_store_dwordx4 v[100:103], v27, s[4:7], s50 offen sc1
s_add_u32 s36, s36, 1
s_cmp_lt_u32 s36, 64
s_cbranch_scc1 Lq_152
s_waitcnt vmcnt(0)
buffer_store_dword v197, v199, s[4:7], 0 offen sc1
s_branch Lend_1
Lqz_155:
Lbw_172:
buffer_load_dwordx4 v[112:115], v11, s[4:7], s40 offen offset:0 sc1
buffer_load_dwordx4 v[116:119], v11, s[4:7], s40 offen offset:1024 sc1
buffer_load_dwordx2 v[120:121], v12, s[4:7], s40 offen sc1
buffer_load_dwordx2 v[122:123], v13, s[4:7], s40 offen sc1
s_waitcnt vmcnt(0)
v_max3_u32 v44, v112, v113, v114
v_max3_u32 v44, v44, v115, v116
v_max3_u32 v44, v44, v117, v118
v_max3_u32 v44, v44, v119, v120
v_max3_u32 v44, v44, v121, v122
v_max_u32 v44, v44, v123
v_cmp_eq_u32 vcc, -1, v44
s_cbranch_vccz Lbo_173
s_sub_u32 s37, s37, 1
s_cbranch_scc1 Lend_1
s_branch Lbw_172
Lbo_173:
s_waitcnt lgkmcnt(0)
s_barrier
s_branch Lp1_171
Lq0_162:
Lbw_174:
buffer_load_dword v209, v208, s[4:7], 0 offen sc1
s_waitcnt vmcnt(0)
v_add_u32 v44, v209, v210
v_cmp_gt_u32 vcc, s27, v44
s_cbranch_vccz Lbo_175
s_sub_u32 s37, s37, 1
s_cbranch_scc1 Lend_1
s_sleep 2
s_branch Lbw_174
Lbo_175:
s_mov_b32 m0, s57
s_add_u32 s52, s47, 3072
buffer_load_dwordx4 v21, s[4:7], s47 offen offset:0 sc1 lds
buffer_load_dwordx4 v21, s[4:7], s47 offen offset:1024 sc1 lds
buffer_load_dwordx4 v21, s[4:7], s47 offen offset:2048 sc1 lds
s_add_u32 m0, s57, 3072
s_xor_b32 s57, s57, 98304
buffer_load_dwordx4 v21, s[4:7], s52 offen offset:0 sc1 lds
buffer_load_dwordx4 v21, s[4:7], s52 offen offset:1024 sc1 lds
buffer_load_dwordx4 v21, s[4:7], s52 offen offset:2048 sc1 lds
s_add_u32 s47, s47, 786432
s_waitcnt vmcnt(0)
s_barrier
ds_read_b128 v[128:131], v22 offset:0
ds_read_b128 v[132:135], v22 offset:1024
ds_read_b128 v[136:139], v22 offset:2048
ds_read_b128 v[140:143], v22 offset:3072
ds_read_b128 v[144:147], v22 offset:4096
ds_read_b128 v[148:151], v22 offset:5120
ds_read_b128 v[152:155], v22 offset:6144
ds_read_b128 v[156:159], v22 offset:7168
ds_read_b128 v[160:163], v24 offset:0
ds_read_b128 v[164:167], v24 offset:1024
ds_read_b128 v[168:171], v25 offset:0
ds_read_b128 v[172:175], v25 offset:1024
ds_read_b128 v[176:179], v23 offset:0
ds_read_b128 v[180:183], v23 offset:1024
ds_read_b128 v[184:187], v23 offset:2048
ds_read_b128 v[188:191], v23 offset:3072
v_xor_b32 v22, 98304, v22
v_xor_b32 v24, 98304, v24
v_xor_b32 v25, 98304, v25
v_xor_b32 v23, 98304, v23
s_branch Lq1_163
Lp2_170:
s_add_u32 s27, s27, 1
Lbw_176:
buffer_load_dword v209, v208, s[4:7], 0 offen sc1
s_waitcnt vmcnt(0)
v_add_u32 v44, v209, v210
v_cmp_gt_u32 vcc, s27, v44
s_cbranch_vccz Lbo_177
s_sub_u32 s37, s37, 1
s_cbranch_scc1 Lend_1
s_sleep 2
s_branch Lbw_176
Lbo_177:
s_mov_b32 m0, s57
s_add_u32 s52, s47, 3072
buffer_load_dwordx4 v21, s[4:7], s47 offen offset:0 sc1 lds
buffer_load_dwordx4 v21, s[4:7], s47 offen offset:1024 sc1 lds
buffer_load_dwordx4 v21, s[4:7], s47 offen offset:2048 sc1 lds
s_add_u32 m0, s57, 3072
s_xor_b32 s57, s57, 98304
buffer_load_dwordx4 v21, s[4:7], s52 offen offset:0 sc1 lds
buffer_load_dwordx4 v21, s[4:7], s52 offen offset:1024 sc1 lds
buffer_load_dwordx4 v21, s[4:7], s52 offen offset:2048 sc1 lds
s_add_u32 s47, s47, 786432
s_branch Lp1_171
Lpw_168:
Lbw_178:
buffer_load_dword v209, v208, s[4:7], 0 offen sc1
s_waitcnt vmcnt(0)
v_add_u32 v44, v209, v210
v_cmp_gt_u32 vcc, s27, v44
s_cbranch_vccz Lbo_179
s_sub_u32 s37, s37, 1
s_cbranch_scc1 Lend_1
s_sleep 2
s_branch Lbw_178
Lbo_179:
s_branch Lpk_169
Lpj_161:
buffer_load_dwordx4 v[56:59], v10, s[4:7], s40 offen offset:2048 sc1
buffer_load_dwordx4 v[60:63], v10, s[4:7], s40 offen offset:3072 sc1
s_sub_u32 s37, s37, 1
s_cbranch_scc1 Lend_1
s_branch Lps_180
Lpf_159:
buffer_load_dwordx4 v[48:51], v10, s[4:7], s40 offen offset:0 sc1
s_sub_u32 s37, s37, 1
s_cbranch_scc1 Lend_1
Lps_181:
s_waitcnt vmcnt(3)
v_max3_u32 v44, v52, v53, v54
v_max_u32 v44, v44, v55
v_cmp_eq_u32 vcc, -1, v44
s_cbranch_vccnz Lpf_182
v_smfmac_f32_16x16x64_bf16 v[64:67], v[52:55], a[64:71], v15
v_smfmac_f32_16x16x64_bf16 v[68:71], v[52:55], a[72:79], v15
v_smfmac_f32_16x16x64_bf16 v[72:75], v[52:55], a[80:87], v15
v_smfmac_f32_16x16x64_bf16 v[76:79], v[52:55], a[88:95], v15
v_smfmac_f32_16x16x64_bf16 v[80:83], v[52:55], a[96:103], v15
v_smfmac_f32_16x16x64_bf16 v[84:87], v[52:55], a[104:111], v15
Lps_183:
s_waitcnt vmcnt(2)
v_max3_u32 v44, v56, v57, v58
v_max_u32 v44, v44, v59
v_cmp_eq_u32 vcc, -1, v44
s_cbranch_vccnz Lpf_184
v_smfmac_f32_16x16x64_bf16 v[64:67], v[56:59], a[128:135], v15
v_smfmac_f32_16x16x64_bf16 v[68:71], v[56:59], a[136:143], v15
v_smfmac_f32_16x16x64_bf16 v[72:75], v[56:59], a[144:151], v15
v_smfmac_f32_16x16x64_bf16 v[76:79], v[56:59], a[152:159], v15
v_smfmac_f32_16x16x64_bf16 v[80:83], v[56:59], a[160:167], v15
v_smfmac_f32_16x16x64_bf16 v[84:87], v[56:59], a[168:175], v15
Lps_185:
s_waitcnt vmcnt(1)
v_max3_u32 v44, v60, v61, v62
v_max_u32 v44, v44, v63
v_cmp_eq_u32 vcc, -1, v44
s_cbranch_vccnz Lpf_186
v_smfmac_f32_16x16x64_bf16 v[64:67], v[60:63], a[192:199], v15
v_smfmac_f32_16x16x64_bf16 v[68:71], v[60:63], a[200:207], v15
v_smfmac_f32_16x16x64_bf16 v[72:75], v[60:63], a[208:215], v15
v_smfmac_f32_16x16x64_bf16 v[76:79], v[60:63], a[216:223], v15
v_smfmac_f32_16x16x64_bf16 v[80:83], v[60:63], a[224:231], v15
v_smfmac_f32_16x16x64_bf16 v[84:87], v[60:63], a[232:239], v15
Lps_187:
s_waitcnt vmcnt(0)
v_max3_u32 v44, v48, v49, v50
v_max_u32 v44, v44, v51
v_cmp_eq_u32 vcc, -1, v44
s_cbranch_vccnz Lpf_188
v_smfmac_f32_16x16x64_bf16 v[64:67], v[48:51], a[0:7], v15
s_nop 1
v_smfmac_f32_16x16x64_bf16 v[68:71], v[48:51], a[8:15], v15
s_nop 1
v_smfmac_f32_16x16x64_bf16 v[72:75], v[48:51], a[16:23], v15
s_nop 1
v_smfmac_f32_16x16x64_bf16 v[76:79], v[48:51], a[24:31], v15
v_add_f32 v96, v64, v66
v_add_f32 v97, v65, v67
v_smfmac_f32_16x16x64_bf16 v[80:83], v[48:51], a[32:39], v15
v_add_f32 v98, v68, v70
v_add_f32 v99, v69, v71
v_smfmac_f32_16x16x64_bf16 v[84:87], v[48:51], a[40:47], v15
v_add_f32 v100, v72, v74
v_add_f32 v101, v73, v75
ds_write_b128 v211, v[96:99] offset:0
v_smfmac_f32_16x16x64_bf16 v[88:91], v[48:51], a[48:55], v15
v_add_f32 v102, v76, v78
v_add_f32 v103, v77, v79
v_add_f32 v104, v80, v82
v_add_f32 v105, v81, v83
ds_write_b128 v212, v[100:103] offset:0
v_smfmac_f32_16x16x64_bf16 v[88:91], v[52:55], a[112:119], v15
v_add_f32 v106, v84, v86
v_add_f32 v107, v85, v87
ds_write_b128 v213, v[104:107] offset:0
s_branch Lpd_158
Lpf_160:
buffer_load_dwordx4 v[52:55], v10, s[4:7], s40 offen offset:1024 sc1
s_sub_u32 s37, s37, 1
s_cbranch_scc1 Lend_1
Lps_189:
s_waitcnt vmcnt(2)
v_max3_u32 v44, v56, v57, v58
v_max_u32 v44, v44, v59
v_cmp_eq_u32 vcc, -1, v44
s_cbranch_vccnz Lpf_190
v_smfmac_f32_16x16x64_bf16 v[64:67], v[56:59], a[128:135], v15
v_smfmac_f32_16x16x64_bf16 v[68:71], v[56:59], a[136:143], v15
v_smfmac_f32_16x16x64_bf16 v[72:75], v[56:59], a[144:151], v15
v_smfmac_f32_16x16x64_bf16 v[76:79], v[56:59], a[152:159], v15
v_smfmac_f32_16x16x64_bf16 v[80:83], v[56:59], a[160:167], v15
v_smfmac_f32_16x16x64_bf16 v[84:87], v[56:59], a[168:175], v15
Lps_191:
s_waitcnt vmcnt(1)
v_max3_u32 v44, v60, v61, v62
v_max_u32 v44, v44, v63
v_cmp_eq_u32 vcc, -1, v44
s_cbranch_vccnz Lpf_192
v_smfmac_f32_16x16x64_bf16 v[64:67], v[60:63], a[192:199], v15
v_smfmac_f32_16x16x64_bf16 v[68:71], v[60:63], a[200:207], v15
v_smfmac_f32_16x16x64_bf16 v[72:75], v[60:63], a[208:215], v15
v_smfmac_f32_16x16x64_bf16 v[76:79], v[60:63], a[216:223], v15
v_smfmac_f32_16x16x64_bf16 v[80:83], v[60:63], a[224:231], v15
v_smfmac_f32_16x16x64_bf16 v[84:87], v[60:63], a[232:239], v15
Lps_193:
s_waitcnt vmcnt(0)
v_max3_u32 v44, v52, v53, v54
v_max_u32 v44, v44, v55
v_cmp_eq_u32 vcc, -1, v44
s_cbranch_vccnz Lpf_194
v_smfmac_f32_16x16x64_bf16 v[64:67], v[52:55], a[64:71], v15
s_nop 1
v_smfmac_f32_16x16x64_bf16 v[68:71], v[52:55], a[72:79], v15
s_nop 1
v_smfmac_f32_16x16x64_bf16 v[72:75], v[52:55], a[80:87], v15
s_nop 1
v_smfmac_f32_16x16x64_bf16 v[76:79], v[52:55], a[88:95], v15
v_add_f32 v96, v64, v66
v_add_f32 v97, v65, v67
v_smfmac_f32_16x16x64_bf16 v[80:83], v[52:55], a[96:103], v15
v_add_f32 v98, v68, v70
v_add_f32 v99, v69, v71
v_smfmac_f32_16x16x64_bf16 v[84:87], v[52:55], a[104:111], v15
v_add_f32 v100, v72, v74
v_add_f32 v101, v73, v75
ds_write_b128 v211, v[96:99] offset:0
v_smfmac_f32_16x16x64_bf16 v[88:91], v[48:51], a[48:55], v15
v_add_f32 v102, v76, v78
v_add_f32 v103, v77, v79
v_add_f32 v104, v80, v82
v_add_f32 v105, v81, v83
ds_write_b128 v212, v[100:103] offset:0
v_smfmac_f32_16x16x64_bf16 v[88:91], v[52:55], a[112:119], v15
v_add_f32 v106, v84, v86
v_add_f32 v107, v85, v87
ds_write_b128 v213, v[104:107] offset:0
s_branch Lpd_158
Lpf_182:
buffer_load_dwordx4 v[52:55], v10, s[4:7], s40 offen offset:1024 sc1
Lps_195:
s_waitcnt vmcnt(3)
v_max3_u32 v44, v56, v57, v58
v_max_u32 v44, v44, v59
v_cmp_eq_u32 vcc, -1, v44
s_cbranch_vccnz Lpf_196
v_smfmac_f32_16x16x64_bf16 v[64:67], v[56:59], a[128:135], v15
v_smfmac_f32_16x16x64_bf16 v[68:71], v[56:59], a[136:143], v15
v_smfmac_f32_16x16x64_bf16 v[72:75], v[56:59], a[144:151], v15
v_smfmac_f32_16x16x64_bf16 v[76:79], v[56:59], a[152:159], v15
v_smfmac_f32_16x16x64_bf16 v[80:83], v[56:59], a[160:167], v15
v_smfmac_f32_16x16x64_bf16 v[84:87], v[56:59], a[168:175], v15
Lps_197:
s_waitcnt vmcnt(2)
v_max3_u32 v44, v60, v61, v62
v_max_u32 v44, v44, v63
v_cmp_eq_u32 vcc, -1, v44
s_cbranch_vccnz Lpf_198
v_smfmac_f32_16x16x64_bf16 v[64:67], v[60:63], a[192:199], v15
v_smfmac_f32_16x16x64_bf16 v[68:71], v[60:63], a[200:207], v15
v_smfmac_f32_16x16x64_bf16 v[72:75], v[60:63], a[208:215], v15
v_smfmac_f32_16x16x64_bf16 v[76:79], v[60:63], a[216:223], v15
v_smfmac_f32_16x16x64_bf16 v[80:83], v[60:63], a[224:231], v15
v_smfmac_f32_16x16x64_bf16 v[84:87], v[60:63], a[232:239], v15
Lps_199:
s_waitcnt vmcnt(1)
v_max3_u32 v44, v48, v49, v50
v_max_u32 v44, v44, v51
v_cmp_eq_u32 vcc, -1, v44
s_cbranch_vccnz Lpf_200
v_smfmac_f32_16x16x64_bf16 v[64:67], v[48:51], a[0:7], v15
v_smfmac_f32_16x16x64_bf16 v[68:71], v[48:51], a[8:15], v15
v_smfmac_f32_16x16x64_bf16 v[72:75], v[48:51], a[16:23], v15
v_smfmac_f32_16x16x64_bf16 v[76:79], v[48:51], a[24:31], v15
v_smfmac_f32_16x16x64_bf16 v[80:83], v[48:51], a[32:39], v15
v_smfmac_f32_16x16x64_bf16 v[84:87], v[48:51], a[40:47], v15
s_branch Lps_193
Lpf_184:
buffer_load_dwordx4 v[56:59], v10, s[4:7], s40 offen offset:2048 sc1
Lps_201:
s_waitcnt vmcnt(2)
v_max3_u32 v44, v60, v61, v62
v_max_u32 v44, v44, v63
v_cmp_eq_u32 vcc, -1, v44
s_cbranch_vccnz Lpf_202
v_smfmac_f32_16x16x64_bf16 v[64:67], v[60:63], a[192:199], v15
v_smfmac_f32_16x16x64_bf16 v[68:71], v[60:63], a[200:207], v15
v_smfmac_f32_16x16x64_bf16 v[72:75], v[60:63], a[208:215], v15
v_smfmac_f32_16x16x64_bf16 v[76:79], v[60:63], a[216:223], v15
v_smfmac_f32_16x16x64_bf16 v[80:83], v[60:63], a[224:231], v15
v_smfmac_f32_16x16x64_bf16 v[84:87], v[60:63], a[232:239], v15
Lps_203:
s_waitcnt vmcnt(1)
v_max3_u32 v44, v48, v49, v50
v_max_u32 v44, v44, v51
v_cmp_eq_u32 vcc, -1, v44
s_cbranch_vccnz Lpf_204
v_smfmac_f32_16x16x64_bf16 v[64:67], v[48:51], a[0:7], v15
v_smfmac_f32_16x16x64_bf16 v[68:71], v[48:51], a[8:15], v15
v_smfmac_f32_16x16x64_bf16 v[72:75], v[48:51], a[16:23], v15
v_smfmac_f32_16x16x64_bf16 v[76:79], v[48:51], a[24:31], v15
v_smfmac_f32_16x16x64_bf16 v[80:83], v[48:51], a[32:39], v15
v_smfmac_f32_16x16x64_bf16 v[84:87], v[48:51], a[40:47], v15
Lps_205:
s_waitcnt vmcnt(0)
v_max3_u32 v44, v56, v57, v58
v_max_u32 v44, v44, v59
v_cmp_eq_u32 vcc, -1, v44
s_cbranch_vccnz Lpf_206
v_smfmac_f32_16x16x64_bf16 v[64:67], v[56:59], a[128:135], v15
s_nop 1
v_smfmac_f32_16x16x64_bf16 v[68:71], v[56:59], a[136:143], v15
s_nop 1
v_smfmac_f32_16x16x64_bf16 v[72:75], v[56:59], a[144:151], v15
s_nop 1
v_smfmac_f32_16x16x64_bf16 v[76:79], v[56:59], a[152:159], v15
v_add_f32 v96, v64, v66
v_add_f32 v97, v65, v67
v_smfmac_f32_16x16x64_bf16 v[80:83], v[56:59], a[160:167], v15
v_add_f32 v98, v68, v70
v_add_f32 v99, v69, v71
v_smfmac_f32_16x16x64_bf16 v[84:87], v[56:59], a[168:175], v15
v_add_f32 v100, v72, v74
v_add_f32 v101, v73, v75
ds_write_b128 v211, v[96:99] offset:0
v_smfmac_f32_16x16x64_bf16 v[88:91], v[48:51], a[48:55], v15
v_add_f32 v102, v76, v78
v_add_f32 v103, v77, v79
v_add_f32 v104, v80, v82
v_add_f32 v105, v81, v83
ds_write_b128 v212, v[100:103] offset:0
v_smfmac_f32_16x16x64_bf16 v[88:91], v[52:55], a[112:119], v15
v_add_f32 v106, v84, v86
v_add_f32 v107, v85, v87
ds_write_b128 v213, v[104:107] offset:0
s_branch Lpd_158
Lpf_186:
buffer_load_dwordx4 v[60:63], v10, s[4:7], s40 offen offset:3072 sc1
Lps_207:
s_waitcnt vmcnt(1)
v_max3_u32 v44, v48, v49, v50
v_max_u32 v44, v44, v51
v_cmp_eq_u32 vcc, -1, v44
s_cbranch_vccnz Lpf_208
v_smfmac_f32_16x16x64_bf16 v[64:67], v[48:51], a[0:7], v15
v_smfmac_f32_16x16x64_bf16 v[68:71], v[48:51], a[8:15], v15
v_smfmac_f32_16x16x64_bf16 v[72:75], v[48:51], a[16:23], v15
v_smfmac_f32_16x16x64_bf16 v[76:79], v[48:51], a[24:31], v15
v_smfmac_f32_16x16x64_bf16 v[80:83], v[48:51], a[32:39], v15
v_smfmac_f32_16x16x64_bf16 v[84:87], v[48:51], a[40:47], v15
Lps_209:
s_waitcnt vmcnt(0)
v_max3_u32 v44, v60, v61, v62
v_max_u32 v44, v44, v63
v_cmp_eq_u32 vcc, -1, v44
s_cbranch_vccnz Lpf_210
v_smfmac_f32_16x16x64_bf16 v[64:67], v[60:63], a[192:199], v15
s_nop 1
v_smfmac_f32_16x16x64_bf16 v[68:71], v[60:63], a[200:207], v15
s_nop 1
v_smfmac_f32_16x16x64_bf16 v[72:75], v[60:63], a[208:215], v15
s_nop 1
v_smfmac_f32_16x16x64_bf16 v[76:79], v[60:63], a[216:223], v15
v_add_f32 v96, v64, v66
v_add_f32 v97, v65, v67
v_smfmac_f32_16x16x64_bf16 v[80:83], v[60:63], a[224:231], v15
v_add_f32 v98, v68, v70
v_add_f32 v99, v69, v71
v_smfmac_f32_16x16x64_bf16 v[84:87], v[60:63], a[232:239], v15
v_add_f32 v100, v72, v74
v_add_f32 v101, v73, v75
ds_write_b128 v211, v[96:99] offset:0
v_smfmac_f32_16x16x64_bf16 v[88:91], v[48:51], a[48:55], v15
v_add_f32 v102, v76, v78
v_add_f32 v103, v77, v79
v_add_f32 v104, v80, v82
v_add_f32 v105, v81, v83
ds_write_b128 v212, v[100:103] offset:0
v_smfmac_f32_16x16x64_bf16 v[88:91], v[52:55], a[112:119], v15
v_add_f32 v106, v84, v86
v_add_f32 v107, v85, v87
ds_write_b128 v213, v[104:107] offset:0
s_branch Lpd_158
Lpf_188:
buffer_load_dwordx4 v[48:51], v10, s[4:7], s40 offen offset:0 sc1
s_sub_u32 s37, s37, 1
s_cbranch_scc1 Lend_1
s_branch Lps_187
Lpf_190:
buffer_load_dwordx4 v[56:59], v10, s[4:7], s40 offen offset:2048 sc1
Lps_211:
s_waitcnt vmcnt(2)
v_max3_u32 v44, v60, v61, v62
v_max_u32 v44, v44, v63
v_cmp_eq_u32 vcc, -1, v44
s_cbranch_vccnz Lpf_212
v_smfmac_f32_16x16x64_bf16 v[64:67], v[60:63], a[192:199], v15
v_smfmac_f32_16x16x64_bf16 v[68:71], v[60:63], a[200:207], v15
v_smfmac_f32_16x16x64_bf16 v[72:75], v[60:63], a[208:215], v15
v_smfmac_f32_16x16x64_bf16 v[76:79], v[60:63], a[216:223], v15
v_smfmac_f32_16x16x64_bf16 v[80:83], v[60:63], a[224:231], v15
v_smfmac_f32_16x16x64_bf16 v[84:87], v[60:63], a[232:239], v15
Lps_213:
s_waitcnt vmcnt(1)
v_max3_u32 v44, v52, v53, v54
v_max_u32 v44, v44, v55
v_cmp_eq_u32 vcc, -1, v44
s_cbranch_vccnz Lpf_214
v_smfmac_f32_16x16x64_bf16 v[64:67], v[52:55], a[64:71], v15
v_smfmac_f32_16x16x64_bf16 v[68:71], v[52:55], a[72:79], v15
v_smfmac_f32_16x16x64_bf16 v[72:75], v[52:55], a[80:87], v15
v_smfmac_f32_16x16x64_bf16 v[76:79], v[52:55], a[88:95], v15
v_smfmac_f32_16x16x64_bf16 v[80:83], v[52:55], a[96:103], v15
v_smfmac_f32_16x16x64_bf16 v[84:87], v[52:55], a[104:111], v15
s_branch Lps_205
Lpf_192:
buffer_load_dwordx4 v[60:63], v10, s[4:7], s40 offen offset:3072 sc1
Lps_215:
s_waitcnt vmcnt(1)
v_max3_u32 v44, v52, v53, v54
v_max_u32 v44, v44, v55
v_cmp_eq_u32 vcc, -1, v44
s_cbranch_vccnz Lpf_216
v_smfmac_f32_16x16x64_bf16 v[64:67], v[52:55], a[64:71], v15
v_smfmac_f32_16x16x64_bf16 v[68:71], v[52:55], a[72:79], v15
v_smfmac_f32_16x16x64_bf16 v[72:75], v[52:55], a[80:87], v15
v_smfmac_f32_16x16x64_bf16 v[76:79], v[52:55], a[88:95], v15
v_smfmac_f32_16x16x64_bf16 v[80:83], v[52:55], a[96:103], v15
v_smfmac_f32_16x16x64_bf16 v[84:87], v[52:55], a[104:111], v15
s_branch Lps_209
Lpf_194:
buffer_load_dwordx4 v[52:55], v10, s[4:7], s40 offen offset:1024 sc1
s_sub_u32 s37, s37, 1
s_cbranch_scc1 Lend_1
s_branch Lps_193
Lpf_196:
buffer_load_dwordx4 v[56:59], v10, s[4:7], s40 offen offset:2048 sc1
Lps_217:
s_waitcnt vmcnt(3)
v_max3_u32 v44, v60, v61, v62
v_max_u32 v44, v44, v63
v_cmp_eq_u32 vcc, -1, v44
s_cbranch_vccnz Lpf_218
v_smfmac_f32_16x16x64_bf16 v[64:67], v[60:63], a[192:199], v15
v_smfmac_f32_16x16x64_bf16 v[68:71], v[60:63], a[200:207], v15
v_smfmac_f32_16x16x64_bf16 v[72:75], v[60:63], a[208:215], v15
v_smfmac_f32_16x16x64_bf16 v[76:79], v[60:63], a[216:223], v15
v_smfmac_f32_16x16x64_bf16 v[80:83], v[60:63], a[224:231], v15
v_smfmac_f32_16x16x64_bf16 v[84:87], v[60:63], a[232:239], v15
Lps_219:
s_waitcnt vmcnt(2)
v_max3_u32 v44, v48, v49, v50
v_max_u32 v44, v44, v51
v_cmp_eq_u32 vcc, -1, v44
s_cbranch_vccnz Lpf_220
v_smfmac_f32_16x16x64_bf16 v[64:67], v[48:51], a[0:7], v15
v_smfmac_f32_16x16x64_bf16 v[68:71], v[48:51], a[8:15], v15
v_smfmac_f32_16x16x64_bf16 v[72:75], v[48:51], a[16:23], v15
v_smfmac_f32_16x16x64_bf16 v[76:79], v[48:51], a[24:31], v15
v_smfmac_f32_16x16x64_bf16 v[80:83], v[48:51], a[32:39], v15
v_smfmac_f32_16x16x64_bf16 v[84:87], v[48:51], a[40:47], v15
s_branch Lps_213
Lpf_198:
buffer_load_dwordx4 v[60:63], v10, s[4:7], s40 offen offset:3072 sc1
Lps_221:
s_waitcnt vmcnt(2)
v_max3_u32 v44, v48, v49, v50
v_max_u32 v44, v44, v51
v_cmp_eq_u32 vcc, -1, v44
s_cbranch_vccnz Lpf_222
v_smfmac_f32_16x16x64_bf16 v[64:67], v[48:51], a[0:7], v15
v_smfmac_f32_16x16x64_bf16 v[68:71], v[48:51], a[8:15], v15
v_smfmac_f32_16x16x64_bf16 v[72:75], v[48:51], a[16:23], v15
v_smfmac_f32_16x16x64_bf16 v[76:79], v[48:51], a[24:31], v15
v_smfmac_f32_16x16x64_bf16 v[80:83], v[48:51], a[32:39], v15
v_smfmac_f32_16x16x64_bf16 v[84:87], v[48:51], a[40:47], v15
s_branch Lps_215
Lpf_200:
buffer_load_dwordx4 v[48:51], v10, s[4:7], s40 offen offset:0 sc1
s_sub_u32 s37, s37, 1
s_cbranch_scc1 Lend_1
Lps_223:
s_waitcnt vmcnt(1)
v_max3_u32 v44, v52, v53, v54
v_max_u32 v44, v44, v55
v_cmp_eq_u32 vcc, -1, v44
s_cbranch_vccnz Lpf_224
v_smfmac_f32_16x16x64_bf16 v[64:67], v[52:55], a[64:71], v15
v_smfmac_f32_16x16x64_bf16 v[68:71], v[52:55], a[72:79], v15
v_smfmac_f32_16x16x64_bf16 v[72:75], v[52:55], a[80:87], v15
v_smfmac_f32_16x16x64_bf16 v[76:79], v[52:55], a[88:95], v15
v_smfmac_f32_16x16x64_bf16 v[80:83], v[52:55], a[96:103], v15
v_smfmac_f32_16x16x64_bf16 v[84:87], v[52:55], a[104:111], v15
s_branch Lps_187
Lpf_202:
buffer_load_dwordx4 v[60:63], v10, s[4:7], s40 offen offset:3072 sc1
Lps_225:
s_waitcnt vmcnt(2)
v_max3_u32 v44, v48, v49, v50
v_max_u32 v44, v44, v51
v_cmp_eq_u32 vcc, -1, v44
s_cbranch_vccnz Lpf_226
v_smfmac_f32_16x16x64_bf16 v[64:67], v[48:51], a[0:7], v15
v_smfmac_f32_16x16x64_bf16 v[68:71], v[48:51], a[8:15], v15
v_smfmac_f32_16x16x64_bf16 v[72:75], v[48:51], a[16:23], v15
v_smfmac_f32_16x16x64_bf16 v[76:79], v[48:51], a[24:31], v15
v_smfmac_f32_16x16x64_bf16 v[80:83], v[48:51], a[32:39], v15
v_smfmac_f32_16x16x64_bf16 v[84:87], v[48:51], a[40:47], v15
Lps_180:
s_waitcnt vmcnt(1)
v_max3_u32 v44, v56, v57, v58
v_max_u32 v44, v44, v59
v_cmp_eq_u32 vcc, -1, v44
s_cbranch_vccnz Lpf_227
v_smfmac_f32_16x16x64_bf16 v[64:67], v[56:59], a[128:135], v15
v_smfmac_f32_16x16x64_bf16 v[68:71], v[56:59], a[136:143], v15
v_smfmac_f32_16x16x64_bf16 v[72:75], v[56:59], a[144:151], v15
v_smfmac_f32_16x16x64_bf16 v[76:79], v[56:59], a[152:159], v15
v_smfmac_f32_16x16x64_bf16 v[80:83], v[56:59], a[160:167], v15
v_smfmac_f32_16x16x64_bf16 v[84:87], v[56:59], a[168:175], v15
s_branch Lps_209
Lpf_204:
buffer_load_dwordx4 v[48:51], v10, s[4:7], s40 offen offset:0 sc1
s_sub_u32 s37, s37, 1
s_cbranch_scc1 Lend_1
Lps_228:
s_waitcnt vmcnt(1)
v_max3_u32 v44, v56, v57, v58
v_max_u32 v44, v44, v59
v_cmp_eq_u32 vcc, -1, v44
s_cbranch_vccnz Lpf_229
v_smfmac_f32_16x16x64_bf16 v[64:67], v[56:59], a[128:135], v15
v_smfmac_f32_16x16x64_bf16 v[68:71], v[56:59], a[136:143], v15
v_smfmac_f32_16x16x64_bf16 v[72:75], v[56:59], a[144:151], v15
v_smfmac_f32_16x16x64_bf16 v[76:79], v[56:59], a[152:159], v15
v_smfmac_f32_16x16x64_bf16 v[80:83], v[56:59], a[160:167], v15
v_smfmac_f32_16x16x64_bf16 v[84:87], v[56:59], a[168:175], v15
s_branch Lps_187
Lpf_206:
buffer_load_dwordx4 v[56:59], v10, s[4:7], s40 offen offset:2048 sc1
s_sub_u32 s37, s37, 1
s_cbranch_scc1 Lend_1
s_branch Lps_205
Lpf_208:
buffer_load_dwordx4 v[48:51], v10, s[4:7], s40 offen offset:0 sc1
s_sub_u32 s37, s37, 1
s_cbranch_scc1 Lend_1
s_branch Lps_185
Lpf_210:
buffer_load_dwordx4 v[60:63], v10, s[4:7], s40 offen offset:3072 sc1
s_sub_u32 s37, s37, 1
s_cbranch_scc1 Lend_1
s_branch Lps_209
Lpf_212:
buffer_load_dwordx4 v[60:63], v10, s[4:7], s40 offen offset:3072 sc1
Lps_230:
s_waitcnt vmcnt(2)
v_max3_u32 v44, v52, v53, v54
v_max_u32 v44, v44, v55
v_cmp_eq_u32 vcc, -1, v44
s_cbranch_vccnz Lpf_231
v_smfmac_f32_16x16x64_bf16 v[64:67], v[52:55], a[64:71], v15
v_smfmac_f32_16x16x64_bf16 v[68:71], v[52:55], a[72:79], v15
v_smfmac_f32_16x16x64_bf16 v[72:75], v[52:55], a[80:87], v15
v_smfmac_f32_16x16x64_bf16 v[76:79], v[52:55], a[88:95], v15
v_smfmac_f32_16x16x64_bf16 v[80:83], v[52:55], a[96:103], v15
v_smfmac_f32_16x16x64_bf16 v[84:87], v[52:55], a[104:111], v15
s_branch Lps_180
Lpf_214:
buffer_load_dwordx4 v[52:55], v10, s[4:7], s40 offen offset:1024 sc1
s_sub_u32 s37, s37, 1
s_cbranch_scc1 Lend_1
Lps_232:
s_waitcnt vmcnt(1)
v_max3_u32 v44, v56, v57, v58
v_max_u32 v44, v44, v59
v_cmp_eq_u32 vcc, -1, v44
s_cbranch_vccnz Lpf_233
v_smfmac_f32_16x16x64_bf16 v[64:67], v[56:59], a[128:135], v15
v_smfmac_f32_16x16x64_bf16 v[68:71], v[56:59], a[136:143], v15
v_smfmac_f32_16x16x64_bf16 v[72:75], v[56:59], a[144:151], v15
v_smfmac_f32_16x16x64_bf16 v[76:79], v[56:59], a[152:159], v15
v_smfmac_f32_16x16x64_bf16 v[80:83], v[56:59], a[160:167], v15
v_smfmac_f32_16x16x64_bf16 v[84:87], v[56:59], a[168:175], v15
s_branch Lps_193
Lpf_216:
buffer_load_dwordx4 v[52:55], v10, s[4:7], s40 offen offset:1024 sc1
s_sub_u32 s37, s37, 1
s_cbranch_scc1 Lend_1
s_branch Lps_191
Lpf_218:
buffer_load_dwordx4 v[60:63], v10, s[4:7], s40 offen offset:3072 sc1
Lps_234:
s_waitcnt vmcnt(3)
v_max3_u32 v44, v48, v49, v50
v_max_u32 v44, v44, v51
v_cmp_eq_u32 vcc, -1, v44
s_cbranch_vccnz Lpf_235
v_smfmac_f32_16x16x64_bf16 v[64:67], v[48:51], a[0:7], v15
v_smfmac_f32_16x16x64_bf16 v[68:71], v[48:51], a[8:15], v15
v_smfmac_f32_16x16x64_bf16 v[72:75], v[48:51], a[16:23], v15
v_smfmac_f32_16x16x64_bf16 v[76:79], v[48:51], a[24:31], v15
v_smfmac_f32_16x16x64_bf16 v[80:83], v[48:51], a[32:39], v15
v_smfmac_f32_16x16x64_bf16 v[84:87], v[48:51], a[40:47], v15
s_branch Lps_230
Lpf_220:
buffer_load_dwordx4 v[48:51], v10, s[4:7], s40 offen offset:0 sc1
s_sub_u32 s37, s37, 1
s_cbranch_scc1 Lend_1
Lps_236:
s_waitcnt vmcnt(2)
v_max3_u32 v44, v52, v53, v54
v_max_u32 v44, v44, v55
v_cmp_eq_u32 vcc, -1, v44
s_cbranch_vccnz Lpf_237
v_smfmac_f32_16x16x64_bf16 v[64:67], v[52:55], a[64:71], v15
v_smfmac_f32_16x16x64_bf16 v[68:71], v[52:55], a[72:79], v15
v_smfmac_f32_16x16x64_bf16 v[72:75], v[52:55], a[80:87], v15
v_smfmac_f32_16x16x64_bf16 v[76:79], v[52:55], a[88:95], v15
v_smfmac_f32_16x16x64_bf16 v[80:83], v[52:55], a[96:103], v15
v_smfmac_f32_16x16x64_bf16 v[84:87], v[52:55], a[104:111], v15
s_branch Lps_228
Lpf_222:
buffer_load_dwordx4 v[48:51], v10, s[4:7], s40 offen offset:0 sc1
s_sub_u32 s37, s37, 1
s_cbranch_scc1 Lend_1
Lps_238:
s_waitcnt vmcnt(2)
v_max3_u32 v44, v52, v53, v54
v_max_u32 v44, v44, v55
v_cmp_eq_u32 vcc, -1, v44
s_cbranch_vccnz Lpf_239
v_smfmac_f32_16x16x64_bf16 v[64:67], v[52:55], a[64:71], v15
v_smfmac_f32_16x16x64_bf16 v[68:71], v[52:55], a[72:79], v15
v_smfmac_f32_16x16x64_bf16 v[72:75], v[52:55], a[80:87], v15
v_smfmac_f32_16x16x64_bf16 v[76:79], v[52:55], a[88:95], v15
v_smfmac_f32_16x16x64_bf16 v[80:83], v[52:55], a[96:103], v15
v_smfmac_f32_16x16x64_bf16 v[84:87], v[52:55], a[104:111], v15
s_branch Lps_185
Lpf_224:
buffer_load_dwordx4 v[52:55], v10, s[4:7], s40 offen offset:1024 sc1
s_branch Lps_199
Lpf_226:
buffer_load_dwordx4 v[48:51], v10, s[4:7], s40 offen offset:0 sc1
s_sub_u32 s37, s37, 1
s_cbranch_scc1 Lend_1
s_branch Lps_183
Lpf_227:
buffer_load_dwordx4 v[56:59], v10, s[4:7], s40 offen offset:2048 sc1
s_sub_u32 s37, s37, 1
s_cbranch_scc1 Lend_1
Lps_240:
s_waitcnt vmcnt(1)
v_max3_u32 v44, v60, v61, v62
v_max_u32 v44, v44, v63
v_cmp_eq_u32 vcc, -1, v44
s_cbranch_vccnz Lpf_241
v_smfmac_f32_16x16x64_bf16 v[64:67], v[60:63], a[192:199], v15
v_smfmac_f32_16x16x64_bf16 v[68:71], v[60:63], a[200:207], v15
v_smfmac_f32_16x16x64_bf16 v[72:75], v[60:63], a[208:215], v15
v_smfmac_f32_16x16x64_bf16 v[76:79], v[60:63], a[216:223], v15
v_smfmac_f32_16x16x64_bf16 v[80:83], v[60:63], a[224:231], v15
v_smfmac_f32_16x16x64_bf16 v[84:87], v[60:63], a[232:239], v15
s_branch Lps_205
Lpf_229:
buffer_load_dwordx4 v[56:59], v10, s[4:7], s40 offen offset:2048 sc1
s_branch Lps_203
Lpf_231:
buffer_load_dwordx4 v[52:55], v10, s[4:7], s40 offen offset:1024 sc1
s_sub_u32 s37, s37, 1
s_cbranch_scc1 Lend_1
s_branch Lps_189
Lpf_233:
buffer_load_dwordx4 v[56:59], v10, s[4:7], s40 offen offset:2048 sc1
s_branch Lps_213
Lpf_235:
buffer_load_dwordx4 v[48:51], v10, s[4:7], s40 offen offset:0 sc1
s_sub_u32 s37, s37, 1
s_cbranch_scc1 Lend_1
s_branch Lps_181
Lpf_237:
buffer_load_dwordx4 v[52:55], v10, s[4:7], s40 offen offset:1024 sc1
Lps_242:
s_waitcnt vmcnt(2)
v_max3_u32 v44, v56, v57, v58
v_max_u32 v44, v44, v59
v_cmp_eq_u32 vcc, -1, v44
s_cbranch_vccnz Lpf_243
v_smfmac_f32_16x16x64_bf16 v[64:67], v[56:59], a[128:135], v15
v_smfmac_f32_16x16x64_bf16 v[68:71], v[56:59], a[136:143], v15
v_smfmac_f32_16x16x64_bf16 v[72:75], v[56:59], a[144:151], v15
v_smfmac_f32_16x16x64_bf16 v[76:79], v[56:59], a[152:159], v15
v_smfmac_f32_16x16x64_bf16 v[80:83], v[56:59], a[160:167], v15
v_smfmac_f32_16x16x64_bf16 v[84:87], v[56:59], a[168:175], v15
s_branch Lps_199
Lpf_239:
buffer_load_dwordx4 v[52:55], v10, s[4:7], s40 offen offset:1024 sc1
s_branch Lps_197
Lpf_241:
buffer_load_dwordx4 v[60:63], v10, s[4:7], s40 offen offset:3072 sc1
s_branch Lps_180
Lpf_243:
buffer_load_dwordx4 v[56:59], v10, s[4:7], s40 offen offset:2048 sc1
s_branch Lps_219
Lkr_164:
buffer_load_dwordx4 v[56:59], v11, s[4:7], s40 offen offset:0 sc1
buffer_load_dwordx4 v[60:63], v11, s[4:7], s40 offen offset:1024 sc1
Lps_245:
s_waitcnt vmcnt(3)
v_max3_u32 v44, v48, v49, v50
v_max_u32 v44, v44, v51
v_cmp_eq_u32 vcc, -1, v44
s_cbranch_vccnz Lpf_246
v_smfmac_f32_16x16x64_bf16 v[72:75], v[48:51], v[96:103], v15
v_mov_b32 v112, v48
v_mov_b32 v113, v49
v_mov_b32 v114, v50
v_mov_b32 v115, v51
Lps_247:
s_waitcnt vmcnt(2)
v_max3_u32 v44, v52, v53, v54
v_max_u32 v44, v44, v55
v_cmp_eq_u32 vcc, -1, v44
s_cbranch_vccnz Lpf_248
v_smfmac_f32_16x16x64_bf16 v[72:75], v[52:55], v[104:111], v15
v_mov_b32 v116, v52
v_mov_b32 v117, v53
v_mov_b32 v118, v54
v_mov_b32 v119, v55
Lpd_244:
s_branch Lko_165
Lpf_246:
buffer_load_dwordx4 v[48:51], v11, s[4:7], s40 offen offset:0 sc1
s_sub_u32 s37, s37, 1
s_cbranch_scc1 Lend_1
Lps_249:
s_waitcnt vmcnt(3)
v_max3_u32 v44, v52, v53, v54
v_max_u32 v44, v44, v55
v_cmp_eq_u32 vcc, -1, v44
s_cbranch_vccnz Lpf_250
v_smfmac_f32_16x16x64_bf16 v[72:75], v[52:55], v[104:111], v15
v_mov_b32 v116, v52
v_mov_b32 v117, v53
v_mov_b32 v118, v54
v_mov_b32 v119, v55
Lps_251:
s_waitcnt vmcnt(2)
v_max3_u32 v44, v56, v57, v58
v_max_u32 v44, v44, v59
v_cmp_eq_u32 vcc, -1, v44
s_cbranch_vccnz Lpf_252
v_smfmac_f32_16x16x64_bf16 v[72:75], v[56:59], v[96:103], v15
v_mov_b32 v112, v56
v_mov_b32 v113, v57
v_mov_b32 v114, v58
v_mov_b32 v115, v59
s_branch Lpd_244
Lpf_248:
buffer_load_dwordx4 v[52:55], v11, s[4:7], s40 offen offset:1024 sc1
s_sub_u32 s37, s37, 1
s_cbranch_scc1 Lend_1
Lps_253:
s_waitcnt vmcnt(2)
v_max3_u32 v44, v56, v57, v58
v_max_u32 v44, v44, v59
v_cmp_eq_u32 vcc, -1, v44
s_cbranch_vccnz Lpf_254
Lps_255:
s_waitcnt vmcnt(1)
v_max3_u32 v44, v60, v61, v62
v_max_u32 v44, v44, v63
v_cmp_eq_u32 vcc, -1, v44
s_cbranch_vccnz Lpf_256
v_smfmac_f32_16x16x64_bf16 v[72:75], v[60:63], v[104:111], v15
v_mov_b32 v116, v60
v_mov_b32 v117, v61
v_mov_b32 v118, v62
v_mov_b32 v119, v63
s_branch Lpd_244
Lpf_250:
buffer_load_dwordx4 v[52:55], v11, s[4:7], s40 offen offset:1024 sc1
Lps_257:
s_waitcnt vmcnt(3)
v_max3_u32 v44, v56, v57, v58
v_max_u32 v44, v44, v59
v_cmp_eq_u32 vcc, -1, v44
s_cbranch_vccnz Lpf_258
v_smfmac_f32_16x16x64_bf16 v[72:75], v[56:59], v[96:103], v15
v_mov_b32 v112, v56
v_mov_b32 v113, v57
v_mov_b32 v114, v58
v_mov_b32 v115, v59
Lps_259:
s_waitcnt vmcnt(2)
v_max3_u32 v44, v60, v61, v62
v_max_u32 v44, v44, v63
v_cmp_eq_u32 vcc, -1, v44
s_cbranch_vccnz Lpf_260
v_smfmac_f32_16x16x64_bf16 v[72:75], v[60:63], v[104:111], v15
v_mov_b32 v116, v60
v_mov_b32 v117, v61
v_mov_b32 v118, v62
v_mov_b32 v119, v63
s_branch Lpd_244
Lpf_252:
buffer_load_dwordx4 v[56:59], v11, s[4:7], s40 offen offset:0 sc1
Lps_261:
s_waitcnt vmcnt(2)
v_max3_u32 v44, v60, v61, v62
v_max_u32 v44, v44, v63
v_cmp_eq_u32 vcc, -1, v44
s_cbranch_vccnz Lpf_262
Lps_263:
s_waitcnt vmcnt(1)
v_max3_u32 v44, v48, v49, v50
v_max_u32 v44, v44, v51
v_cmp_eq_u32 vcc, -1, v44
s_cbranch_vccnz Lpf_264
v_smfmac_f32_16x16x64_bf16 v[72:75], v[48:51], v[96:103], v15
v_mov_b32 v112, v48
v_mov_b32 v113, v49
v_mov_b32 v114, v50
v_mov_b32 v115, v51
s_branch Lpd_244
Lpf_254:
buffer_load_dwordx4 v[56:59], v11, s[4:7], s40 offen offset:0 sc1
Lps_265:
s_waitcnt vmcnt(2)
v_max3_u32 v44, v60, v61, v62
v_max_u32 v44, v44, v63
v_cmp_eq_u32 vcc, -1, v44
s_cbranch_vccnz Lpf_266
v_smfmac_f32_16x16x64_bf16 v[72:75], v[60:63], v[104:111], v15
v_mov_b32 v116, v60
v_mov_b32 v117, v61
v_mov_b32 v118, v62
v_mov_b32 v119, v63
s_branch Lpd_244
Lpf_256:
buffer_load_dwordx4 v[60:63], v11, s[4:7], s40 offen offset:1024 sc1
Lps_267:
s_waitcnt vmcnt(1)
v_max3_u32 v44, v52, v53, v54
v_max_u32 v44, v44, v55
v_cmp_eq_u32 vcc, -1, v44
s_cbranch_vccnz Lpf_268
v_smfmac_f32_16x16x64_bf16 v[72:75], v[52:55], v[104:111], v15
v_mov_b32 v116, v52
v_mov_b32 v117, v53
v_mov_b32 v118, v54
v_mov_b32 v119, v55
s_branch Lpd_244
Lpf_258:
buffer_load_dwordx4 v[56:59], v11, s[4:7], s40 offen offset:0 sc1
Lps_269:
s_waitcnt vmcnt(3)
v_max3_u32 v44, v60, v61, v62
v_max_u32 v44, v44, v63
v_cmp_eq_u32 vcc, -1, v44
s_cbranch_vccnz Lpf_270
v_smfmac_f32_16x16x64_bf16 v[72:75], v[60:63], v[104:111], v15
v_mov_b32 v116, v60
v_mov_b32 v117, v61
v_mov_b32 v118, v62
v_mov_b32 v119, v63
Lps_271:
s_waitcnt vmcnt(2)
v_max3_u32 v44, v48, v49, v50
v_max_u32 v44, v44, v51
v_cmp_eq_u32 vcc, -1, v44
s_cbranch_vccnz Lpf_272
v_smfmac_f32_16x16x64_bf16 v[72:75], v[48:51], v[96:103], v15
v_mov_b32 v112, v48
v_mov_b32 v113, v49
v_mov_b32 v114, v50
v_mov_b32 v115, v51
s_branch Lpd_244
Lpf_260:
buffer_load_dwordx4 v[60:63], v11, s[4:7], s40 offen offset:1024 sc1
Lps_273:
s_waitcnt vmcnt(2)
v_max3_u32 v44, v48, v49, v50
v_max_u32 v44, v44, v51
v_cmp_eq_u32 vcc, -1, v44
s_cbranch_vccnz Lpf_274
s_branch Lps_267
Lpf_262:
buffer_load_dwordx4 v[60:63], v11, s[4:7], s40 offen offset:1024 sc1
Lps_275:
s_waitcnt vmcnt(2)
v_max3_u32 v44, v48, v49, v50
v_max_u32 v44, v44, v51
v_cmp_eq_u32 vcc, -1, v44
s_cbranch_vccnz Lpf_276
v_smfmac_f32_16x16x64_bf16 v[72:75], v[48:51], v[96:103], v15
v_mov_b32 v112, v48
v_mov_b32 v113, v49
v_mov_b32 v114, v50
v_mov_b32 v115, v51
s_branch Lpd_244
Lpf_264:
buffer_load_dwordx4 v[48:51], v11, s[4:7], s40 offen offset:0 sc1
s_sub_u32 s37, s37, 1
s_cbranch_scc1 Lend_1
Lps_277:
s_waitcnt vmcnt(1)
v_max3_u32 v44, v56, v57, v58
v_max_u32 v44, v44, v59
v_cmp_eq_u32 vcc, -1, v44
s_cbranch_vccnz Lpf_278
v_smfmac_f32_16x16x64_bf16 v[72:75], v[56:59], v[96:103], v15
v_mov_b32 v112, v56
v_mov_b32 v113, v57
v_mov_b32 v114, v58
v_mov_b32 v115, v59
s_branch Lpd_244
Lpf_266:
buffer_load_dwordx4 v[60:63], v11, s[4:7], s40 offen offset:1024 sc1
s_branch Lps_247
Lpf_268:
buffer_load_dwordx4 v[52:55], v11, s[4:7], s40 offen offset:1024 sc1
s_sub_u32 s37, s37, 1
s_cbranch_scc1 Lend_1
s_branch Lps_255
Lpf_270:
buffer_load_dwordx4 v[60:63], v11, s[4:7], s40 offen offset:1024 sc1
s_branch Lps_245
Lpf_272:
buffer_load_dwordx4 v[48:51], v11, s[4:7], s40 offen offset:0 sc1
s_sub_u32 s37, s37, 1
s_cbranch_scc1 Lend_1
Lps_279:
s_waitcnt vmcnt(2)
v_max3_u32 v44, v52, v53, v54
v_max_u32 v44, v44, v55
v_cmp_eq_u32 vcc, -1, v44
s_cbranch_vccnz Lpf_280
s_branch Lps_277
Lpf_274:
buffer_load_dwordx4 v[48:51], v11, s[4:7], s40 offen offset:0 sc1
s_sub_u32 s37, s37, 1
s_cbranch_scc1 Lend_1
Lps_281:
s_waitcnt vmcnt(2)
v_max3_u32 v44, v52, v53, v54
v_max_u32 v44, v44, v55
v_cmp_eq_u32 vcc, -1, v44
s_cbranch_vccnz Lpf_282
v_smfmac_f32_16x16x64_bf16 v[72:75], v[52:55], v[104:111], v15
v_mov_b32 v116, v52
v_mov_b32 v117, v53
v_mov_b32 v118, v54
v_mov_b32 v119, v55
s_branch Lpd_244
Lpf_276:
buffer_load_dwordx4 v[48:51], v11, s[4:7], s40 offen offset:0 sc1
s_sub_u32 s37, s37, 1
s_cbranch_scc1 Lend_1
s_branch Lps_251
Lpf_278:
buffer_load_dwordx4 v[56:59], v11, s[4:7], s40 offen offset:0 sc1
s_branch Lps_263
Lpf_280:
buffer_load_dwordx4 v[52:55], v11, s[4:7], s40 offen offset:1024 sc1
Lps_283:
s_waitcnt vmcnt(2)
v_max3_u32 v44, v56, v57, v58
v_max_u32 v44, v44, v59
v_cmp_eq_u32 vcc, -1, v44
s_cbranch_vccnz Lpf_284
v_smfmac_f32_16x16x64_bf16 v[72:75], v[56:59], v[96:103], v15
v_mov_b32 v112, v56
v_mov_b32 v113, v57
v_mov_b32 v114, v58
v_mov_b32 v115, v59
s_branch Lpd_244
Lpf_282:
buffer_load_dwordx4 v[52:55], v11, s[4:7], s40 offen offset:1024 sc1
s_branch Lps_259
Lpf_284:
buffer_load_dwordx4 v[56:59], v11, s[4:7], s40 offen offset:0 sc1
s_branch Lps_271
Lvr_166:
buffer_load_dwordx2 v[120:121], v12, s[4:7], s40 offen sc1
buffer_load_dwordx2 v[122:123], v13, s[4:7], s40 offen sc1
s_sub_u32 s37, s37, 1
s_cbranch_scc1 Lend_1
s_waitcnt vmcnt(0)
v_max3_u32 v44, v120, v121, v122
v_max_u32 v44, v44, v123
v_cmp_eq_u32 vcc, -1, v44
s_cbranch_vccnz Lvr_166
s_branch Lvo_167
Lend_1:
s_endpgm
Lkvo_2:
v_mov_b32 v44, v0
v_mov_b32 v45, v1
s_sub_u32 s54, s34, 8
s_xor_b32 s57, s32, 3
s_lshl_b32 s45, s33, 18
s_add_u32 s45, s45, 2097152
s_lshl_b32 s59, s33, 12
s_add_u32 s59, s59, 3276800
s_lshl_b32 s38, s32, 12
v_lshl_add_u32 v8, v45, 4, s38
v_add_u32 v9, 49152, v8
s_lshl_b32 s38, s54, 10
s_lshl_b32 s39, s32, 8
s_add_u32 s39, s39, s38
v_mov_b32 v10, s39
v_bfe_u32 v46, v45, 1, 2
v_lshl_add_u32 v10, v46, 6, v10
v_bfe_u32 v46, v45, 5, 1
v_lshl_add_u32 v10, v46, 5, v10
v_bfe_u32 v46, v45, 0, 1
v_lshl_add_u32 v10, v46, 4, v10
v_bfe_u32 v46, v45, 4, 1
v_lshl_add_u32 v10, v46, 3, v10
v_bfe_u32 v46, v45, 3, 1
v_lshl_add_u32 v10, v46, 30, v10
v_and_b32 v46, 0xf0, v44
v_lshl_add_u32 v11, v46, 2, s38
v_and_b32 v46, 3, v45
v_lshl_add_u32 v11, v46, 4, v11
v_and_b32 v46, 12, v45
v_add_u32 v11, v11, v46
v_xor_b32 v11, 20480, v11
s_lshr_b32 s39, s32, 1
s_lshl_b32 s39, s39, 9
s_add_u32 s38, s38, s39
s_and_b32 s39, s32, 1
s_lshl_b32 s39, s39, 2
s_add_u32 s38, s38, s39
s_xor_b32 s38, s38, 34816
v_lshl_add_u32 v27, v45, 3, s38
s_lshl_b32 s38, s32, 8
s_add_u32 s38, s38, 2048
v_lshl_add_u32 v1, v45, 2, s38
s_lshr_b32 s38, s54, 2
s_lshl_b32 s38, s38, 8
s_and_b32 s39, s54, 3
s_lshl_b32 s39, s39, 2
s_add_u32 s38, s38, s39
v_min_u32 v46, 1, v44
v_lshl_add_u32 v2, v46, 30, s38
s_lshr_b32 s38, s54, 3
s_lshl_b32 s38, s38, 14
s_and_b32 s39, s54, 7
s_lshl_b32 s39, s39, 10
s_add_u32 s38, s38, s39
s_lshl_b32 s39, s33, 16
s_add_u32 s38, s38, s39
v_lshl_add_u32 v12, v44, 2, s38
v_xor_b32 v13, 0x10000, v12
v_xor_b32 v14, 0x20000, v12
v_xor_b32 v15, 0x30000, v12
v_bfe_u32 v126, v45, 1, 1
v_mul_u32_u24 v126, 0xaaaa, v126
v_add_u32 v126, 0x4444, v126
s_xor_b32 s38, s57, 0
s_mul_i32 s38, s38, 1536
s_add_u32 s38, s38, 0
v_lshl_add_u32 v24, v45, 3, s38
s_xor_b32 s38, s57, 1
s_mul_i32 s38, s38, 1536
s_add_u32 s38, s38, 512
v_lshl_add_u32 v25, v45, 3, s38
s_xor_b32 s38, s57, 2
s_mul_i32 s38, s38, 1536
s_add_u32 s38, s38, 1024
v_lshl_add_u32 v26, v45, 3, s38
s_mul_i32 s38, s32, 1536
v_lshl_add_u32 v0, v45, 3, s38
v_and_b32 v46, 1, v45
v_mov_b32 v3, 0x05040100
v_mov_b32 v47, 0x03020706
v_cmp_eq_u32 vcc, 1, v46
s_nop 1
v_cndmask_b32 v3, v3, v47, vcc
v_and_b32 v46, 7, v45
v_lshrrev_b32 v47, 4, v45
v_lshlrev_b32 v50, 3, v47
v_lshl_add_u32 v57, v46, 11, v50
s_mov_b32 s8, s16
s_and_b32 s9, s17, 0xffff
s_mov_b32 s10, 0x4000
s_mov_b32 s11, 0x20000
v_bfe_u32 v46, v45, 1, 3
v_cmp_eq_u32 vcc, v46, v47
v_and_b32 v46, 1, v45
v_lshlrev_b32 v46, 4, v46
v_mov_b32 v47, 0x3f80
v_lshlrev_b32 v46, v46, v47
v_cndmask_b32 v20, 0, v46, vcc
v_cndmask_b32 v21, 0, v46, vcc
v_cndmask_b32 v22, 0, v46, vcc
v_cndmask_b32 v23, 0, v46, vcc
v_mov_b32 v4, -1
v_mov_b32 v5, -1
s_add_u32 s38, s45, 0
buffer_store_dwordx2 v[4:5], v10, s[4:7], s38 offen sc1
buffer_store_dword v4, v11, s[4:7], s38 offen sc1
buffer_store_dword v4, v27, s[4:7], s38 offen sc1
s_mov_b32 s39, 0
buffer_store_dword v4, v12, s[4:7], s39 offen sc1
s_mov_b32 s39, 8192
buffer_store_dword v4, v12, s[4:7], s39 offen sc1
s_mov_b32 s39, 1048576
buffer_store_dword v4, v12, s[4:7], s39 offen sc1
s_mov_b32 s39, 1056768
buffer_store_dword v4, v12, s[4:7], s39 offen sc1
s_add_u32 s38, s45, 65536
buffer_store_dwordx2 v[4:5], v10, s[4:7], s38 offen sc1
buffer_store_dword v4, v11, s[4:7], s38 offen sc1
buffer_store_dword v4, v27, s[4:7], s38 offen sc1
s_mov_b32 s39, 262144
buffer_store_dword v4, v12, s[4:7], s39 offen sc1
s_mov_b32 s39, 270336
buffer_store_dword v4, v12, s[4:7], s39 offen sc1
s_mov_b32 s39, 1310720
buffer_store_dword v4, v12, s[4:7], s39 offen sc1
s_mov_b32 s39, 1318912
buffer_store_dword v4, v12, s[4:7], s39 offen sc1
s_add_u32 s38, s45, 131072
buffer_store_dwordx2 v[4:5], v10, s[4:7], s38 offen sc1
buffer_store_dword v4, v11, s[4:7], s38 offen sc1
buffer_store_dword v4, v27, s[4:7], s38 offen sc1
s_mov_b32 s39, 524288
buffer_store_dword v4, v12, s[4:7], s39 offen sc1
s_mov_b32 s39, 532480
buffer_store_dword v4, v12, s[4:7], s39 offen sc1
s_mov_b32 s39, 1572864
buffer_store_dword v4, v12, s[4:7], s39 offen sc1
s_mov_b32 s39, 1581056
buffer_store_dword v4, v12, s[4:7], s39 offen sc1
s_add_u32 s38, s45, 196608
buffer_store_dwordx2 v[4:5], v10, s[4:7], s38 offen sc1
buffer_store_dword v4, v11, s[4:7], s38 offen sc1
buffer_store_dword v4, v27, s[4:7], s38 offen sc1
s_mov_b32 s39, 786432
buffer_store_dword v4, v12, s[4:7], s39 offen sc1
s_mov_b32 s39, 794624
buffer_store_dword v4, v12, s[4:7], s39 offen sc1
s_mov_b32 s39, 1835008
buffer_store_dword v4, v12, s[4:7], s39 offen sc1
s_mov_b32 s39, 1843200
buffer_store_dword v4, v12, s[4:7], s39 offen sc1
v_mov_b32 v7, 1
buffer_store_dword v7, v2, s[4:7], s59 offen sc1
s_lshl_b32 s52, s35, 16
s_or_b32 s52, s52, 1
s_waitcnt vmcnt(0)
s_barrier
s_cmp_lg_u32 s32, 0
s_cbranch_scc1 Lar_285
s_mov_b64 exec, 1
v_mov_b32 v48, 16
v_mov_b32 v49, s52
buffer_atomic_add v49, v48, s[12:15], 0 offen sc1
s_mov_b64 exec, -1
Lar_285:
s_lshl_b32 s38, s54, 2
s_add_u32 s38, s38, s32
s_lshl_b32 s38, s38, 5
buffer_load_dwordx2 v[58:59], v57, s[8:11], s38 offen
s_lshl_b32 s52, s57, 5
v_and_b32 v46, 7, v45
v_lshlrev_b32 v46, 4, v46
v_xor_b32 v46, s52, v46
v_lshrrev_b32 v52, 3, v45
v_lshl_add_u32 v52, v52, 13, v46
v_and_b32 v46, 7, v45
v_lshlrev_b32 v46, 4, v46
v_xor_b32 v46, s52, v46
v_lshrrev_b32 v53, 3, v45
v_lshl_add_u32 v53, v53, 11, v46
s_and_b32 s53, s52, 32
s_lshr_b32 s53, s53, 1
s_and_b32 s52, s52, 64
s_or_b32 s52, s52, s53
v_and_b32 v46, 7, v45
v_lshlrev_b32 v46, 4, v46
v_xor_b32 v46, s52, v46
v_lshrrev_b32 v51, 3, v45
v_lshl_add_u32 v51, v51, 13, v46
v_bfe_u32 v54, v45, 2, 1
v_bfe_u32 v46, v45, 5, 1
v_lshl_add_u32 v54, v46, 4, v54
v_bfe_u32 v46, v45, 4, 1
v_lshl_add_u32 v54, v46, 2, v54
v_bfe_u32 v46, v45, 3, 1
v_lshl_add_u32 v54, v46, 3, v54
s_mul_i32 s38, s32, 40960
v_lshl_add_u32 v54, v54, 7, s38
v_bfe_u32 v46, v45, 0, 1
v_lshl_add_u32 v54, v46, 5, v54
v_bfe_u32 v46, v45, 1, 1
v_lshl_add_u32 v54, v46, 3, v54
v_bfe_u32 v55, v45, 2, 1
v_bfe_u32 v46, v45, 5, 1
v_lshl_add_u32 v55, v46, 4, v55
v_bfe_u32 v46, v45, 4, 1
v_lshl_add_u32 v55, v46, 2, v55
v_bfe_u32 v46, v45, 3, 1
v_lshl_add_u32 v55, v46, 3, v55
s_mul_i32 s38, s32, 40960
v_lshl_add_u32 v55, v55, 7, s38
v_bfe_u32 v46, v45, 0, 1
v_lshl_add_u32 v55, v46, 3, v55
v_bfe_u32 v46, v45, 1, 1
v_lshl_add_u32 v55, v46, 4, v55
v_bfe_u32 v56, v45, 2, 1
v_bfe_u32 v46, v45, 4, 1
v_lshl_add_u32 v56, v46, 4, v56
v_bfe_u32 v46, v45, 5, 1
v_lshl_add_u32 v56, v46, 3, v56
v_bfe_u32 v46, v45, 3, 1
v_lshl_add_u32 v56, v46, 2, v56
s_mul_i32 s38, s32, 40960
v_lshl_add_u32 v56, v56, 7, s38
v_bfe_u32 v46, v45, 0, 1
v_lshl_add_u32 v56, v46, 3, v56
v_bfe_u32 v46, v45, 1, 1
v_lshl_add_u32 v56, v46, 4, v56
s_mov_b32 s8, s20
s_and_b32 s9, s21, 0xffff
s_mov_b32 s10, 0x800000
s_mov_b32 s11, 0x20000
s_lshl_b32 s39, s32, 21
s_lshl_b32 s38, s33, 4
s_add_u32 s38, s38, s54
s_xor_b32 s38, s38, 4
s_lshl_b32 s38, s38, 7
s_add_u32 s39, s39, s38
s_add_u32 s39, s39, 1572864
s_mul_i32 s38, s32, 40960
s_add_u32 m0, s38, 0
s_nop 0
buffer_load_dwordx4 v51, s[8:11], s39 offen lds
s_add_u32 m0, m0, 1024
s_add_u32 s39, s39, 65536
buffer_load_dwordx4 v51, s[8:11], s39 offen lds
s_add_u32 m0, m0, 1024
s_add_u32 s39, s39, 65536
buffer_load_dwordx4 v51, s[8:11], s39 offen lds
s_add_u32 m0, m0, 1024
s_add_u32 s39, s39, 65536
buffer_load_dwordx4 v51, s[8:11], s39 offen lds
s_add_u32 m0, m0, 1024
s_add_u32 s39, s39, 65536
buffer_load_dwordx4 v51, s[8:11], s39 offen lds
s_add_u32 m0, m0, 1024
s_add_u32 s39, s39, 65536
buffer_load_dwordx4 v51, s[8:11], s39 offen lds
s_add_u32 m0, m0, 1024
s_add_u32 s39, s39, 65536
buffer_load_dwordx4 v51, s[8:11], s39 offen lds
s_add_u32 m0, m0, 1024
s_add_u32 s39, s39, 65536
buffer_load_dwordx4 v51, s[8:11], s39 offen lds
s_mov_b32 s8, s22
s_and_b32 s9, s23, 0xffff
s_mov_b32 s10, 0x800000
s_mov_b32 s11, 0x20000
s_lshl_b32 s39, s32, 21
s_lshl_b32 s38, s33, 4
s_add_u32 s38, s38, s54
s_xor_b32 s38, s38, 2
s_lshl_b32 s38, s38, 7
s_add_u32 s39, s39, s38
s_add_u32 s39, s39, 1572864
s_mul_i32 s38, s32, 40960
s_add_u32 m0, s38, 8192
s_nop 0
buffer_load_dwordx4 v52, s[8:11], s39 offen lds
s_add_u32 m0, m0, 1024
s_add_u32 s39, s39, 65536
buffer_load_dwordx4 v52, s[8:11], s39 offen lds
s_add_u32 m0, m0, 1024
s_add_u32 s39, s39, 65536
buffer_load_dwordx4 v52, s[8:11], s39 offen lds
s_add_u32 m0, m0, 1024
s_add_u32 s39, s39, 65536
buffer_load_dwordx4 v52, s[8:11], s39 offen lds
s_add_u32 m0, m0, 1024
s_add_u32 s39, s39, 65536
buffer_load_dwordx4 v52, s[8:11], s39 offen lds
s_add_u32 m0, m0, 1024
s_add_u32 s39, s39, 65536
buffer_load_dwordx4 v52, s[8:11], s39 offen lds
s_add_u32 m0, m0, 1024
s_add_u32 s39, s39, 65536
buffer_load_dwordx4 v52, s[8:11], s39 offen lds
s_add_u32 m0, m0, 1024
s_add_u32 s39, s39, 65536
buffer_load_dwordx4 v52, s[8:11], s39 offen lds
s_waitcnt vmcnt(8)
v_min_u32 v58, -2, v58
v_min_u32 v59, -2, v59
buffer_store_dwordx2 v[58:59], v10, s[4:7], s45 offen sc1
ds_read_b64_tr_b16 a[96:97], v54 offset:0
ds_read_b64_tr_b16 a[98:99], v54 offset:256
ds_read_b64_tr_b16 a[100:101], v54 offset:4096
ds_read_b64_tr_b16 a[102:103], v54 offset:4352
ds_read_b64_tr_b16 a[104:105], v54 offset:16
ds_read_b64_tr_b16 a[106:107], v54 offset:272
ds_read_b64_tr_b16 a[108:109], v54 offset:4112
ds_read_b64_tr_b16 a[110:111], v54 offset:4368
ds_read_b64_tr_b16 a[112:113], v54 offset:64
ds_read_b64_tr_b16 a[114:115], v54 offset:320
ds_read_b64_tr_b16 a[116:117], v54 offset:4160
ds_read_b64_tr_b16 a[118:119], v54 offset:4416
ds_read_b64_tr_b16 a[120:121], v54 offset:80
ds_read_b64_tr_b16 a[122:123], v54 offset:336
ds_read_b64_tr_b16 a[124:125], v54 offset:4176
ds_read_b64_tr_b16 a[126:127], v54 offset:4432
s_mov_b32 s8, s20
s_and_b32 s9, s21, 0xffff
s_mov_b32 s10, 0x800000
s_mov_b32 s11, 0x20000
s_lshl_b32 s39, s32, 21
s_lshl_b32 s38, s33, 4
s_add_u32 s38, s38, s54
s_xor_b32 s38, s38, 4
s_lshl_b32 s38, s38, 7
s_add_u32 s39, s39, s38
s_add_u32 s39, s39, 1048576
s_mul_i32 s38, s32, 40960
s_add_u32 m0, s38, 16384
s_nop 0
buffer_load_dwordx4 v51, s[8:11], s39 offen lds
s_add_u32 m0, m0, 1024
s_add_u32 s39, s39, 65536
buffer_load_dwordx4 v51, s[8:11], s39 offen lds
s_add_u32 m0, m0, 1024
s_add_u32 s39, s39, 65536
buffer_load_dwordx4 v51, s[8:11], s39 offen lds
s_add_u32 m0, m0, 1024
s_add_u32 s39, s39, 65536
buffer_load_dwordx4 v51, s[8:11], s39 offen lds
s_add_u32 m0, m0, 1024
s_add_u32 s39, s39, 65536
buffer_load_dwordx4 v51, s[8:11], s39 offen lds
s_add_u32 m0, m0, 1024
s_add_u32 s39, s39, 65536
buffer_load_dwordx4 v51, s[8:11], s39 offen lds
s_add_u32 m0, m0, 1024
s_add_u32 s39, s39, 65536
buffer_load_dwordx4 v51, s[8:11], s39 offen lds
s_add_u32 m0, m0, 1024
s_add_u32 s39, s39, 65536
buffer_load_dwordx4 v51, s[8:11], s39 offen lds
s_waitcnt lgkmcnt(0)
s_waitcnt vmcnt(8)
ds_read_b64_tr_b16 v[224:225], v55 offset:8192
ds_read_b64_tr_b16 v[226:227], v55 offset:8448
ds_read_b64_tr_b16 v[228:229], v55 offset:12288
ds_read_b64_tr_b16 v[230:231], v55 offset:12544
ds_read_b64_tr_b16 v[232:233], v55 offset:8224
ds_read_b64_tr_b16 v[234:235], v55 offset:8480
ds_read_b64_tr_b16 v[236:237], v55 offset:12320
ds_read_b64_tr_b16 v[238:239], v55 offset:12576
ds_read_b64_tr_b16 v[240:241], v55 offset:8256
ds_read_b64_tr_b16 v[242:243], v55 offset:8512
ds_read_b64_tr_b16 v[244:245], v55 offset:12352
ds_read_b64_tr_b16 v[246:247], v55 offset:12608
ds_read_b64_tr_b16 v[248:249], v55 offset:8288
ds_read_b64_tr_b16 v[250:251], v55 offset:8544
ds_read_b64_tr_b16 v[252:253], v55 offset:12384
ds_read_b64_tr_b16 v[254:255], v55 offset:12640
s_mov_b32 s8, s22
s_and_b32 s9, s23, 0xffff
s_mov_b32 s10, 0x800000
s_mov_b32 s11, 0x20000
s_lshl_b32 s39, s32, 21
s_lshl_b32 s38, s33, 4
s_add_u32 s38, s38, s54
s_xor_b32 s38, s38, 2
s_lshl_b32 s38, s38, 7
s_add_u32 s39, s39, s38
s_add_u32 s39, s39, 1048576
s_mul_i32 s38, s32, 40960
s_add_u32 m0, s38, 24576
s_nop 0
buffer_load_dwordx4 v52, s[8:11], s39 offen lds
s_add_u32 m0, m0, 1024
s_add_u32 s39, s39, 65536
buffer_load_dwordx4 v52, s[8:11], s39 offen lds
s_add_u32 m0, m0, 1024
s_add_u32 s39, s39, 65536
buffer_load_dwordx4 v52, s[8:11], s39 offen lds
s_add_u32 m0, m0, 1024
s_add_u32 s39, s39, 65536
buffer_load_dwordx4 v52, s[8:11], s39 offen lds
s_add_u32 m0, m0, 1024
s_add_u32 s39, s39, 65536
buffer_load_dwordx4 v52, s[8:11], s39 offen lds
s_add_u32 m0, m0, 1024
s_add_u32 s39, s39, 65536
buffer_load_dwordx4 v52, s[8:11], s39 offen lds
s_add_u32 m0, m0, 1024
s_add_u32 s39, s39, 65536
buffer_load_dwordx4 v52, s[8:11], s39 offen lds
s_add_u32 m0, m0, 1024
s_add_u32 s39, s39, 65536
buffer_load_dwordx4 v52, s[8:11], s39 offen lds
s_waitcnt lgkmcnt(0)
s_waitcnt vmcnt(8)
ds_read_b64_tr_b16 a[64:65], v54 offset:16384
ds_read_b64_tr_b16 a[66:67], v54 offset:16640
ds_read_b64_tr_b16 a[68:69], v54 offset:20480
ds_read_b64_tr_b16 a[70:71], v54 offset:20736
ds_read_b64_tr_b16 a[72:73], v54 offset:16400
ds_read_b64_tr_b16 a[74:75], v54 offset:16656
ds_read_b64_tr_b16 a[76:77], v54 offset:20496
ds_read_b64_tr_b16 a[78:79], v54 offset:20752
ds_read_b64_tr_b16 a[80:81], v54 offset:16448
ds_read_b64_tr_b16 a[82:83], v54 offset:16704
ds_read_b64_tr_b16 a[84:85], v54 offset:20544
ds_read_b64_tr_b16 a[86:87], v54 offset:20800
ds_read_b64_tr_b16 a[88:89], v54 offset:16464
ds_read_b64_tr_b16 a[90:91], v54 offset:16720
ds_read_b64_tr_b16 a[92:93], v54 offset:20560
ds_read_b64_tr_b16 a[94:95], v54 offset:20816
s_mov_b32 s8, s20
s_and_b32 s9, s21, 0xffff
s_mov_b32 s10, 0x800000
s_mov_b32 s11, 0x20000
s_lshl_b32 s39, s32, 21
s_lshl_b32 s38, s33, 4
s_add_u32 s38, s38, s54
s_xor_b32 s38, s38, 4
s_lshl_b32 s38, s38, 7
s_add_u32 s39, s39, s38
s_add_u32 s39, s39, 524288
s_mul_i32 s38, s32, 40960
s_add_u32 m0, s38, 32768
s_nop 0
buffer_load_dwordx4 v51, s[8:11], s39 offen lds
s_add_u32 m0, m0, 1024
s_add_u32 s39, s39, 65536
buffer_load_dwordx4 v51, s[8:11], s39 offen lds
s_add_u32 m0, m0, 1024
s_add_u32 s39, s39, 65536
buffer_load_dwordx4 v51, s[8:11], s39 offen lds
s_add_u32 m0, m0, 1024
s_add_u32 s39, s39, 65536
buffer_load_dwordx4 v51, s[8:11], s39 offen lds
s_add_u32 m0, m0, 1024
s_add_u32 s39, s39, 65536
buffer_load_dwordx4 v51, s[8:11], s39 offen lds
s_add_u32 m0, m0, 1024
s_add_u32 s39, s39, 65536
buffer_load_dwordx4 v51, s[8:11], s39 offen lds
s_add_u32 m0, m0, 1024
s_add_u32 s39, s39, 65536
buffer_load_dwordx4 v51, s[8:11], s39 offen lds
s_add_u32 m0, m0, 1024
s_add_u32 s39, s39, 65536
buffer_load_dwordx4 v51, s[8:11], s39 offen lds
s_waitcnt lgkmcnt(0)
s_waitcnt vmcnt(8)
ds_read_b64_tr_b16 v[192:193], v55 offset:24576
ds_read_b64_tr_b16 v[194:195], v55 offset:24832
ds_read_b64_tr_b16 v[196:197], v55 offset:28672
ds_read_b64_tr_b16 v[198:199], v55 offset:28928
ds_read_b64_tr_b16 v[200:201], v55 offset:24608
ds_read_b64_tr_b16 v[202:203], v55 offset:24864
ds_read_b64_tr_b16 v[204:205], v55 offset:28704
ds_read_b64_tr_b16 v[206:207], v55 offset:28960
ds_read_b64_tr_b16 v[208:209], v55 offset:24640
ds_read_b64_tr_b16 v[210:211], v55 offset:24896
ds_read_b64_tr_b16 v[212:213], v55 offset:28736
ds_read_b64_tr_b16 v[214:215], v55 offset:28992
ds_read_b64_tr_b16 v[216:217], v55 offset:24672
ds_read_b64_tr_b16 v[218:219], v55 offset:24928
ds_read_b64_tr_b16 v[220:221], v55 offset:28768
ds_read_b64_tr_b16 v[222:223], v55 offset:29024
s_mov_b32 s8, s22
s_and_b32 s9, s23, 0xffff
s_mov_b32 s10, 0x800000
s_mov_b32 s11, 0x20000
s_lshl_b32 s39, s32, 21
s_lshl_b32 s38, s33, 4
s_add_u32 s38, s38, s54
s_xor_b32 s38, s38, 2
s_lshl_b32 s38, s38, 7
s_add_u32 s39, s39, s38
s_add_u32 s39, s39, 524288
s_mul_i32 s38, s32, 40960
s_add_u32 m0, s38, 0
s_nop 0
buffer_load_dwordx4 v52, s[8:11], s39 offen lds
s_add_u32 m0, m0, 1024
s_add_u32 s39, s39, 65536
buffer_load_dwordx4 v52, s[8:11], s39 offen lds
s_add_u32 m0, m0, 1024
s_add_u32 s39, s39, 65536
buffer_load_dwordx4 v52, s[8:11], s39 offen lds
s_add_u32 m0, m0, 1024
s_add_u32 s39, s39, 65536
buffer_load_dwordx4 v52, s[8:11], s39 offen lds
s_add_u32 m0, m0, 1024
s_add_u32 s39, s39, 65536
buffer_load_dwordx4 v52, s[8:11], s39 offen lds
s_add_u32 m0, m0, 1024
s_add_u32 s39, s39, 65536
buffer_load_dwordx4 v52, s[8:11], s39 offen lds
s_add_u32 m0, m0, 1024
s_add_u32 s39, s39, 65536
buffer_load_dwordx4 v52, s[8:11], s39 offen lds
s_add_u32 m0, m0, 1024
s_add_u32 s39, s39, 65536
buffer_load_dwordx4 v52, s[8:11], s39 offen lds
s_waitcnt lgkmcnt(0)
s_waitcnt vmcnt(8)
ds_read_b64_tr_b16 a[32:33], v54 offset:32768
ds_read_b64_tr_b16 a[34:35], v54 offset:33024
ds_read_b64_tr_b16 a[36:37], v54 offset:36864
ds_read_b64_tr_b16 a[38:39], v54 offset:37120
ds_read_b64_tr_b16 a[40:41], v54 offset:32784
ds_read_b64_tr_b16 a[42:43], v54 offset:33040
ds_read_b64_tr_b16 a[44:45], v54 offset:36880
ds_read_b64_tr_b16 a[46:47], v54 offset:37136
ds_read_b64_tr_b16 a[48:49], v54 offset:32832
ds_read_b64_tr_b16 a[50:51], v54 offset:33088
ds_read_b64_tr_b16 a[52:53], v54 offset:36928
ds_read_b64_tr_b16 a[54:55], v54 offset:37184
ds_read_b64_tr_b16 a[56:57], v54 offset:32848
ds_read_b64_tr_b16 a[58:59], v54 offset:33104
ds_read_b64_tr_b16 a[60:61], v54 offset:36944
ds_read_b64_tr_b16 a[62:63], v54 offset:37200
s_mov_b32 s8, s20
s_and_b32 s9, s21, 0xffff
s_mov_b32 s10, 0x800000
s_mov_b32 s11, 0x20000
s_lshl_b32 s39, s32, 21
s_lshl_b32 s38, s33, 4
s_add_u32 s38, s38, s54
s_xor_b32 s38, s38, 4
s_lshl_b32 s38, s38, 7
s_add_u32 s39, s39, s38
s_add_u32 s39, s39, 0
s_mul_i32 s38, s32, 40960
s_add_u32 m0, s38, 8192
s_nop 0
buffer_load_dwordx4 v51, s[8:11], s39 offen lds
s_add_u32 m0, m0, 1024
s_add_u32 s39, s39, 65536
buffer_load_dwordx4 v51, s[8:11], s39 offen lds
s_add_u32 m0, m0, 1024
s_add_u32 s39, s39, 65536
buffer_load_dwordx4 v51, s[8:11], s39 offen lds
s_add_u32 m0, m0, 1024
s_add_u32 s39, s39, 65536
buffer_load_dwordx4 v51, s[8:11], s39 offen lds
s_add_u32 m0, m0, 1024
s_add_u32 s39, s39, 65536
buffer_load_dwordx4 v51, s[8:11], s39 offen lds
s_add_u32 m0, m0, 1024
s_add_u32 s39, s39, 65536
buffer_load_dwordx4 v51, s[8:11], s39 offen lds
s_add_u32 m0, m0, 1024
s_add_u32 s39, s39, 65536
buffer_load_dwordx4 v51, s[8:11], s39 offen lds
s_add_u32 m0, m0, 1024
s_add_u32 s39, s39, 65536
buffer_load_dwordx4 v51, s[8:11], s39 offen lds
s_waitcnt lgkmcnt(0)
s_waitcnt vmcnt(8)
ds_read_b64_tr_b16 v[160:161], v55 offset:0
ds_read_b64_tr_b16 v[162:163], v55 offset:256
ds_read_b64_tr_b16 v[164:165], v55 offset:4096
ds_read_b64_tr_b16 v[166:167], v55 offset:4352
ds_read_b64_tr_b16 v[168:169], v55 offset:32
ds_read_b64_tr_b16 v[170:171], v55 offset:288
ds_read_b64_tr_b16 v[172:173], v55 offset:4128
ds_read_b64_tr_b16 v[174:175], v55 offset:4384
ds_read_b64_tr_b16 v[176:177], v55 offset:64
ds_read_b64_tr_b16 v[178:179], v55 offset:320
ds_read_b64_tr_b16 v[180:181], v55 offset:4160
ds_read_b64_tr_b16 v[182:183], v55 offset:4416
ds_read_b64_tr_b16 v[184:185], v55 offset:96
ds_read_b64_tr_b16 v[186:187], v55 offset:352
ds_read_b64_tr_b16 v[188:189], v55 offset:4192
ds_read_b64_tr_b16 v[190:191], v55 offset:4448
s_mov_b32 s8, s22
s_and_b32 s9, s23, 0xffff
s_mov_b32 s10, 0x800000
s_mov_b32 s11, 0x20000
s_lshl_b32 s39, s32, 21
s_lshl_b32 s38, s33, 4
s_add_u32 s38, s38, s54
s_xor_b32 s38, s38, 2
s_lshl_b32 s38, s38, 7
s_add_u32 s39, s39, s38
s_add_u32 s39, s39, 0
s_mul_i32 s38, s32, 40960
s_add_u32 m0, s38, 16384
s_nop 0
buffer_load_dwordx4 v52, s[8:11], s39 offen lds
s_add_u32 m0, m0, 1024
s_add_u32 s39, s39, 65536
buffer_load_dwordx4 v52, s[8:11], s39 offen lds
s_add_u32 m0, m0, 1024
s_add_u32 s39, s39, 65536
buffer_load_dwordx4 v52, s[8:11], s39 offen lds
s_add_u32 m0, m0, 1024
s_add_u32 s39, s39, 65536
buffer_load_dwordx4 v52, s[8:11], s39 offen lds
s_add_u32 m0, m0, 1024
s_add_u32 s39, s39, 65536
buffer_load_dwordx4 v52, s[8:11], s39 offen lds
s_add_u32 m0, m0, 1024
s_add_u32 s39, s39, 65536
buffer_load_dwordx4 v52, s[8:11], s39 offen lds
s_add_u32 m0, m0, 1024
s_add_u32 s39, s39, 65536
buffer_load_dwordx4 v52, s[8:11], s39 offen lds
s_add_u32 m0, m0, 1024
s_add_u32 s39, s39, 65536
buffer_load_dwordx4 v52, s[8:11], s39 offen lds
s_waitcnt lgkmcnt(0)
s_waitcnt vmcnt(8)
ds_read_b64_tr_b16 a[0:1], v54 offset:8192
ds_read_b64_tr_b16 a[2:3], v54 offset:8448
ds_read_b64_tr_b16 a[4:5], v54 offset:12288
ds_read_b64_tr_b16 a[6:7], v54 offset:12544
ds_read_b64_tr_b16 a[8:9], v54 offset:8208
ds_read_b64_tr_b16 a[10:11], v54 offset:8464
ds_read_b64_tr_b16 a[12:13], v54 offset:12304
ds_read_b64_tr_b16 a[14:15], v54 offset:12560
ds_read_b64_tr_b16 a[16:17], v54 offset:8256
ds_read_b64_tr_b16 a[18:19], v54 offset:8512
ds_read_b64_tr_b16 a[20:21], v54 offset:12352
ds_read_b64_tr_b16 a[22:23], v54 offset:12608
ds_read_b64_tr_b16 a[24:25], v54 offset:8272
ds_read_b64_tr_b16 a[26:27], v54 offset:8528
ds_read_b64_tr_b16 a[28:29], v54 offset:12368
ds_read_b64_tr_b16 a[30:31], v54 offset:12624
s_mov_b32 s8, s24
s_and_b32 s9, s25, 0xffff
s_mov_b32 s10, 0x800000
s_mov_b32 s11, 0x20000
s_lshl_b32 s39, s33, 2
s_add_u32 s39, s39, s32
s_lshl_b32 s39, s39, 19
s_lshl_b32 s38, s54, 7
s_add_u32 s39, s39, s38
s_add_u32 s39, s39, 0
s_mul_i32 s38, s32, 40960
s_add_u32 m0, s38, 24576
s_nop 0
buffer_load_dwordx4 v53, s[8:11], s39 offen lds
s_add_u32 m0, m0, 1024
s_add_u32 s39, s39, 16384
buffer_load_dwordx4 v53, s[8:11], s39 offen lds
s_add_u32 m0, m0, 1024
s_add_u32 s39, s39, 16384
buffer_load_dwordx4 v53, s[8:11], s39 offen lds
s_add_u32 m0, m0, 1024
s_add_u32 s39, s39, 16384
buffer_load_dwordx4 v53, s[8:11], s39 offen lds
s_add_u32 m0, m0, 1024
s_add_u32 s39, s39, 16384
buffer_load_dwordx4 v53, s[8:11], s39 offen lds
s_add_u32 m0, m0, 1024
s_add_u32 s39, s39, 16384
buffer_load_dwordx4 v53, s[8:11], s39 offen lds
s_add_u32 m0, m0, 1024
s_add_u32 s39, s39, 16384
buffer_load_dwordx4 v53, s[8:11], s39 offen lds
s_add_u32 m0, m0, 1024
s_add_u32 s39, s39, 16384
buffer_load_dwordx4 v53, s[8:11], s39 offen lds
s_waitcnt lgkmcnt(0)
s_waitcnt vmcnt(8)
ds_read_b64_tr_b16 v[128:129], v55 offset:16384
ds_read_b64_tr_b16 v[130:131], v55 offset:16640
ds_read_b64_tr_b16 v[132:133], v55 offset:20480
ds_read_b64_tr_b16 v[134:135], v55 offset:20736
ds_read_b64_tr_b16 v[136:137], v55 offset:16416
ds_read_b64_tr_b16 v[138:139], v55 offset:16672
ds_read_b64_tr_b16 v[140:141], v55 offset:20512
ds_read_b64_tr_b16 v[142:143], v55 offset:20768
ds_read_b64_tr_b16 v[144:145], v55 offset:16448
ds_read_b64_tr_b16 v[146:147], v55 offset:16704
ds_read_b64_tr_b16 v[148:149], v55 offset:20544
ds_read_b64_tr_b16 v[150:151], v55 offset:20800
ds_read_b64_tr_b16 v[152:153], v55 offset:16480
ds_read_b64_tr_b16 v[154:155], v55 offset:16736
ds_read_b64_tr_b16 v[156:157], v55 offset:20576
ds_read_b64_tr_b16 v[158:159], v55 offset:20832
s_mov_b32 s8, s24
s_and_b32 s9, s25, 0xffff
s_mov_b32 s10, 0x800000
s_mov_b32 s11, 0x20000
s_lshl_b32 s39, s33, 2
s_add_u32 s39, s39, s32
s_lshl_b32 s39, s39, 19
s_lshl_b32 s38, s54, 7
s_add_u32 s39, s39, s38
s_add_u32 s39, s39, 131072
s_mul_i32 s38, s32, 40960
s_add_u32 m0, s38, 32768
s_nop 0
buffer_load_dwordx4 v53, s[8:11], s39 offen lds
s_add_u32 m0, m0, 1024
s_add_u32 s39, s39, 16384
buffer_load_dwordx4 v53, s[8:11], s39 offen lds
s_add_u32 m0, m0, 1024
s_add_u32 s39, s39, 16384
buffer_load_dwordx4 v53, s[8:11], s39 offen lds
s_add_u32 m0, m0, 1024
s_add_u32 s39, s39, 16384
buffer_load_dwordx4 v53, s[8:11], s39 offen lds
s_add_u32 m0, m0, 1024
s_add_u32 s39, s39, 16384
buffer_load_dwordx4 v53, s[8:11], s39 offen lds
s_add_u32 m0, m0, 1024
s_add_u32 s39, s39, 16384
buffer_load_dwordx4 v53, s[8:11], s39 offen lds
s_add_u32 m0, m0, 1024
s_add_u32 s39, s39, 16384
buffer_load_dwordx4 v53, s[8:11], s39 offen lds
s_add_u32 m0, m0, 1024
s_add_u32 s39, s39, 16384
buffer_load_dwordx4 v53, s[8:11], s39 offen lds
s_waitcnt lgkmcnt(0)
s_waitcnt vmcnt(8)
ds_read_b64_tr_b16 a[128:129], v56 offset:24576
ds_read_b64_tr_b16 a[130:131], v56 offset:24832
ds_read_b64_tr_b16 a[132:133], v56 offset:28672
ds_read_b64_tr_b16 a[134:135], v56 offset:28928
ds_read_b64_tr_b16 a[136:137], v56 offset:24608
ds_read_b64_tr_b16 a[138:139], v56 offset:24864
ds_read_b64_tr_b16 a[140:141], v56 offset:28704
ds_read_b64_tr_b16 a[142:143], v56 offset:28960
ds_read_b64_tr_b16 a[144:145], v56 offset:24640
ds_read_b64_tr_b16 a[146:147], v56 offset:24896
ds_read_b64_tr_b16 a[148:149], v56 offset:28736
ds_read_b64_tr_b16 a[150:151], v56 offset:28992
ds_read_b64_tr_b16 a[152:153], v56 offset:24672
ds_read_b64_tr_b16 a[154:155], v56 offset:24928
ds_read_b64_tr_b16 a[156:157], v56 offset:28768
ds_read_b64_tr_b16 a[158:159], v56 offset:29024
s_mov_b32 s8, s24
s_and_b32 s9, s25, 0xffff
s_mov_b32 s10, 0x800000
s_mov_b32 s11, 0x20000
s_lshl_b32 s39, s33, 2
s_add_u32 s39, s39, s32
s_lshl_b32 s39, s39, 19
s_lshl_b32 s38, s54, 7
s_add_u32 s39, s39, s38
s_add_u32 s39, s39, 262144
s_mul_i32 s38, s32, 40960
s_add_u32 m0, s38, 0
s_nop 0
buffer_load_dwordx4 v53, s[8:11], s39 offen lds
s_add_u32 m0, m0, 1024
s_add_u32 s39, s39, 16384
buffer_load_dwordx4 v53, s[8:11], s39 offen lds
s_add_u32 m0, m0, 1024
s_add_u32 s39, s39, 16384
buffer_load_dwordx4 v53, s[8:11], s39 offen lds
s_add_u32 m0, m0, 1024
s_add_u32 s39, s39, 16384
buffer_load_dwordx4 v53, s[8:11], s39 offen lds
s_add_u32 m0, m0, 1024
s_add_u32 s39, s39, 16384
buffer_load_dwordx4 v53, s[8:11], s39 offen lds
s_add_u32 m0, m0, 1024
s_add_u32 s39, s39, 16384
buffer_load_dwordx4 v53, s[8:11], s39 offen lds
s_add_u32 m0, m0, 1024
s_add_u32 s39, s39, 16384
buffer_load_dwordx4 v53, s[8:11], s39 offen lds
s_add_u32 m0, m0, 1024
s_add_u32 s39, s39, 16384
buffer_load_dwordx4 v53, s[8:11], s39 offen lds
s_waitcnt lgkmcnt(0)
s_waitcnt vmcnt(8)
ds_read_b64_tr_b16 a[160:161], v56 offset:32768
ds_read_b64_tr_b16 a[162:163], v56 offset:33024
ds_read_b64_tr_b16 a[164:165], v56 offset:36864
ds_read_b64_tr_b16 a[166:167], v56 offset:37120
ds_read_b64_tr_b16 a[168:169], v56 offset:32800
ds_read_b64_tr_b16 a[170:171], v56 offset:33056
ds_read_b64_tr_b16 a[172:173], v56 offset:36896
ds_read_b64_tr_b16 a[174:175], v56 offset:37152
ds_read_b64_tr_b16 a[176:177], v56 offset:32832
ds_read_b64_tr_b16 a[178:179], v56 offset:33088
ds_read_b64_tr_b16 a[180:181], v56 offset:36928
ds_read_b64_tr_b16 a[182:183], v56 offset:37184
ds_read_b64_tr_b16 a[184:185], v56 offset:32864
ds_read_b64_tr_b16 a[186:187], v56 offset:33120
ds_read_b64_tr_b16 a[188:189], v56 offset:36960
ds_read_b64_tr_b16 a[190:191], v56 offset:37216
s_mov_b32 s8, s24
s_and_b32 s9, s25, 0xffff
s_mov_b32 s10, 0x800000
s_mov_b32 s11, 0x20000
s_lshl_b32 s39, s33, 2
s_add_u32 s39, s39, s32
s_lshl_b32 s39, s39, 19
s_lshl_b32 s38, s54, 7
s_add_u32 s39, s39, s38
s_add_u32 s39, s39, 393216
s_mul_i32 s38, s32, 40960
s_add_u32 m0, s38, 8192
s_nop 0
buffer_load_dwordx4 v53, s[8:11], s39 offen lds
s_add_u32 m0, m0, 1024
s_add_u32 s39, s39, 16384
buffer_load_dwordx4 v53, s[8:11], s39 offen lds
s_add_u32 m0, m0, 1024
s_add_u32 s39, s39, 16384
buffer_load_dwordx4 v53, s[8:11], s39 offen lds
s_add_u32 m0, m0, 1024
s_add_u32 s39, s39, 16384
buffer_load_dwordx4 v53, s[8:11], s39 offen lds
s_add_u32 m0, m0, 1024
s_add_u32 s39, s39, 16384
buffer_load_dwordx4 v53, s[8:11], s39 offen lds
s_add_u32 m0, m0, 1024
s_add_u32 s39, s39, 16384
buffer_load_dwordx4 v53, s[8:11], s39 offen lds
s_add_u32 m0, m0, 1024
s_add_u32 s39, s39, 16384
buffer_load_dwordx4 v53, s[8:11], s39 offen lds
s_add_u32 m0, m0, 1024
s_add_u32 s39, s39, 16384
buffer_load_dwordx4 v53, s[8:11], s39 offen lds
s_waitcnt lgkmcnt(0)
s_waitcnt vmcnt(8)
ds_read_b64_tr_b16 a[192:193], v56 offset:0
ds_read_b64_tr_b16 a[194:195], v56 offset:256
ds_read_b64_tr_b16 a[196:197], v56 offset:4096
ds_read_b64_tr_b16 a[198:199], v56 offset:4352
ds_read_b64_tr_b16 a[200:201], v56 offset:32
ds_read_b64_tr_b16 a[202:203], v56 offset:288
ds_read_b64_tr_b16 a[204:205], v56 offset:4128
ds_read_b64_tr_b16 a[206:207], v56 offset:4384
ds_read_b64_tr_b16 a[208:209], v56 offset:64
ds_read_b64_tr_b16 a[210:211], v56 offset:320
ds_read_b64_tr_b16 a[212:213], v56 offset:4160
ds_read_b64_tr_b16 a[214:215], v56 offset:4416
ds_read_b64_tr_b16 a[216:217], v56 offset:96
ds_read_b64_tr_b16 a[218:219], v56 offset:352
ds_read_b64_tr_b16 a[220:221], v56 offset:4192
ds_read_b64_tr_b16 a[222:223], v56 offset:4448
s_waitcnt lgkmcnt(0)
s_waitcnt vmcnt(0)
ds_read_b64_tr_b16 a[224:225], v56 offset:8192
ds_read_b64_tr_b16 a[226:227], v56 offset:8448
ds_read_b64_tr_b16 a[228:229], v56 offset:12288
ds_read_b64_tr_b16 a[230:231], v56 offset:12544
ds_read_b64_tr_b16 a[232:233], v56 offset:8224
ds_read_b64_tr_b16 a[234:235], v56 offset:8480
ds_read_b64_tr_b16 a[236:237], v56 offset:12320
ds_read_b64_tr_b16 a[238:239], v56 offset:12576
ds_read_b64_tr_b16 a[240:241], v56 offset:8256
ds_read_b64_tr_b16 a[242:243], v56 offset:8512
ds_read_b64_tr_b16 a[244:245], v56 offset:12352
ds_read_b64_tr_b16 a[246:247], v56 offset:12608
ds_read_b64_tr_b16 a[248:249], v56 offset:8288
ds_read_b64_tr_b16 a[250:251], v56 offset:8544
ds_read_b64_tr_b16 a[252:253], v56 offset:12384
ds_read_b64_tr_b16 a[254:255], v56 offset:12640
s_waitcnt lgkmcnt(0)
Lst_286:
buffer_load_dword v48, off, s[12:15], 0 offset:16 sc1
buffer_load_dword v49, off, s[12:15], 0 offset:144 sc1
s_waitcnt vmcnt(0)
v_add_u32 v48, v48, v49
s_nop 0
v_readfirstlane_b32 s38, v48
s_nop 3
s_and_b32 s39, s38, 0x200ffff
s_cmp_eq_u32 s39, 0x2000100
s_cbranch_scc1 Lso_287
s_sub_u32 s37, s37, 1
s_cbranch_scc1 Lend_1
s_sleep 8
s_branch Lst_286
Lso_287:
s_bfe_u32 s35, s38, 0x80010
s_bfe_u32 s46, s38, 0x10018
s_lshl_b32 s46, s46, 13
s_barrier
s_lshl_b32 s38, s54, 14
s_add_u32 s38, s38, s45
buffer_load_dwordx4 v[28:31], v8, s[4:7], s38 offen offset:0 sc1
buffer_load_dwordx4 v[32:35], v8, s[4:7], s38 offen offset:1024 sc1
buffer_load_dwordx4 v[36:39], v8, s[4:7], s38 offen offset:2048 sc1
buffer_load_dwordx4 v[40:43], v8, s[4:7], s38 offen offset:3072 sc1
v_mov_b32 v44, 0
v_mov_b32 v45, 0
v_mov_b32 v46, 0
v_mov_b32 v47, 0
v_mov_b32 v48, 0
v_mov_b32 v49, 0
v_mov_b32 v50, 0
v_mov_b32 v51, 0
v_mov_b32 v52, 0
v_mov_b32 v53, 0
v_mov_b32 v54, 0
v_mov_b32 v55, 0
v_mov_b32 v56, 0
v_mov_b32 v57, 0
v_mov_b32 v58, 0
v_mov_b32 v59, 0
v_mov_b32 v60, 0
v_mov_b32 v61, 0
v_mov_b32 v62, 0
v_mov_b32 v63, 0
v_mov_b32 v64, 0
v_mov_b32 v65, 0
v_mov_b32 v66, 0
v_mov_b32 v67, 0
v_mov_b32 v68, 0
v_mov_b32 v69, 0
v_mov_b32 v70, 0
v_mov_b32 v71, 0
v_mov_b32 v72, 0
v_mov_b32 v73, 0
v_mov_b32 v74, 0
v_mov_b32 v75, 0
v_mov_b32 v76, 0
v_mov_b32 v77, 0
v_mov_b32 v78, 0
v_mov_b32 v79, 0
v_mov_b32 v80, 0
v_mov_b32 v81, 0
v_mov_b32 v82, 0
v_mov_b32 v83, 0
v_mov_b32 v84, 0
v_mov_b32 v85, 0
v_mov_b32 v86, 0
v_mov_b32 v87, 0
v_mov_b32 v88, 0
v_mov_b32 v89, 0
v_mov_b32 v90, 0
v_mov_b32 v91, 0
s_mov_b32 s36, 0
s_and_b32 s38, s36, 3
s_lshl_b32 s39, s38, 16
s_add_u32 s40, s39, s45
s_xor_b32 s42, s40, 0x20000
s_add_u32 s26, s36, 1
s_cmp_lg_u32 s35, 0
s_cbranch_scc1 Lkvo_sc1_288
Lkvo_289:
buffer_load_dwordx4 v[28:31], v8, s[4:7], s40 offen offset:0 sc1
s_nop 11
buffer_load_dwordx4 v[32:35], v8, s[4:7], s40 offen offset:1024 sc1
s_nop 11
buffer_load_dwordx4 v[36:39], v8, s[4:7], s40 offen offset:2048 sc1
s_nop 11
buffer_load_dwordx4 v[40:43], v8, s[4:7], s40 offen offset:3072 sc1
s_nop 11
s_waitcnt vmcnt(3)
v_max3_u32 v110, v28, v29, v30
v_max_u32 v110, v110, v31
v_cmp_eq_u32 vcc, -1, v110
s_cbranch_vccnz Lpf_291
v_smfmac_f32_16x16x64_bf16 v[44:47], v[28:31], a[0:7], v126
v_smfmac_f32_16x16x64_bf16 v[48:51], v[28:31], a[8:15], v126
s_waitcnt vmcnt(2)
v_max3_u32 v110, v32, v33, v34
v_max_u32 v110, v110, v35
v_cmp_eq_u32 vcc, -1, v110
v_smfmac_f32_16x16x64_bf16 v[52:55], v[28:31], a[16:23], v126
v_smfmac_f32_16x16x64_bf16 v[60:63], v[28:31], v[128:135], v126
s_cbranch_vccnz Lpf_292
v_smfmac_f32_16x16x64_bf16 v[44:47], v[32:35], a[32:39], v126
v_smfmac_f32_16x16x64_bf16 v[48:51], v[32:35], a[40:47], v126
s_waitcnt vmcnt(1)
v_max3_u32 v110, v36, v37, v38
v_max_u32 v110, v110, v39
v_cmp_eq_u32 vcc, -1, v110
v_smfmac_f32_16x16x64_bf16 v[52:55], v[32:35], a[48:55], v126
v_smfmac_f32_16x16x64_bf16 v[60:63], v[32:35], v[160:167], v126
s_cbranch_vccnz Lpf_293
v_smfmac_f32_16x16x64_bf16 v[44:47], v[36:39], a[64:71], v126
v_smfmac_f32_16x16x64_bf16 v[48:51], v[36:39], a[72:79], v126
s_waitcnt vmcnt(0)
v_max3_u32 v110, v40, v41, v42
v_max_u32 v110, v110, v43
v_cmp_eq_u32 vcc, -1, v110
v_smfmac_f32_16x16x64_bf16 v[52:55], v[36:39], a[80:87], v126
v_smfmac_f32_16x16x64_bf16 v[60:63], v[36:39], v[192:199], v126
s_cbranch_vccnz Lpf_294
v_smfmac_f32_16x16x64_bf16 v[44:47], v[40:43], a[96:103], v126
s_nop 1
v_smfmac_f32_16x16x64_bf16 v[48:51], v[40:43], a[104:111], v126
s_nop 1
v_smfmac_f32_16x16x64_bf16 v[52:55], v[40:43], a[112:119], v126
s_nop 1
v_add_f32 v92, v44, v46
v_add_f32 v93, v45, v47
v_smfmac_f32_16x16x64_bf16 v[56:59], v[28:31], a[24:31], v126
v_add_f32 v94, v48, v50
v_add_f32 v95, v49, v51
ds_write_b64 v24, v[92:93] offset:0
v_add_f32 v96, v52, v54
v_add_f32 v97, v53, v55
ds_write_b64 v25, v[94:95] offset:0
v_smfmac_f32_16x16x64_bf16 v[56:59], v[32:35], a[56:63], v126
ds_write_b64 v26, v[96:97] offset:0
v_smfmac_f32_16x16x64_bf16 v[56:59], v[36:39], a[88:95], v126
v_smfmac_f32_16x16x64_bf16 v[56:59], v[40:43], a[120:127], v126
v_smfmac_f32_16x16x64_bf16 v[60:63], v[40:43], v[224:231], v126
Lpd_290:
v_smfmac_f32_16x16x64_bf16 v[64:67], v[28:31], v[136:143], v126
v_smfmac_f32_16x16x64_bf16 v[64:67], v[32:35], v[168:175], v126
s_waitcnt lgkmcnt(0)
s_barrier
ds_read_b64 v[100:101], v0 offset:0
ds_read_b64 v[102:103], v0 offset:512
ds_read_b64 v[104:105], v0 offset:1024
s_nop 2
v_add_f32 v98, v56, v58
v_add_f32 v99, v57, v59
v_smfmac_f32_16x16x64_bf16 v[64:67], v[36:39], v[200:207], v126
v_smfmac_f32_16x16x64_bf16 v[64:67], v[40:43], v[232:239], v126
v_smfmac_f32_16x16x64_bf16 v[68:71], v[28:31], v[144:151], v126
v_smfmac_f32_16x16x64_bf16 v[68:71], v[32:35], v[176:183], v126
s_waitcnt lgkmcnt(0)
v_add_f32 v100, v100, v98
v_add_f32 v102, v102, v104
v_add_f32 v101, v101, v99
v_add_f32 v103, v103, v105
v_add_f32 v100, v100, v102
v_add_f32 v101, v101, v103
v_cvt_pk_bf16_f32 v108, v100, v101
s_nop 1
v_mov_b32_dpp v109, v108 quad_perm:[1,0,3,2] row_mask:0xf bank_mask:0xf
v_perm_b32 v109, v109, v108, v3
buffer_store_dword v109, v11, s[4:7], s40 offen
v_smfmac_f32_16x16x64_bf16 v[68:71], v[36:39], v[208:215], v126
v_smfmac_f32_16x16x64_bf16 v[68:71], v[40:43], v[240:247], v126
s_nop 3
v_smfmac_f32_16x16x64_bf16 v[72:75], v[28:31], v[152:159], v126
v_add_f32 v92, v60, v62
v_add_f32 v93, v61, v63
v_smfmac_f32_16x16x64_bf16 v[72:75], v[32:35], v[184:191], v126
v_add_f32 v94, v64, v66
v_add_f32 v95, v65, v67
ds_write_b64 v24, v[92:93] offset:6144
v_smfmac_f32_16x16x64_bf16 v[72:75], v[36:39], v[216:223], v126
v_add_f32 v96, v68, v70
v_add_f32 v97, v69, v71
ds_write_b64 v25, v[94:95] offset:6144
ds_write_b64 v26, v[96:97] offset:6144
v_smfmac_f32_16x16x64_bf16 v[72:75], v[40:43], v[248:255], v126
s_waitcnt lgkmcnt(0)
s_barrier
ds_read_b64 v[100:101], v0 offset:6144
ds_read_b64 v[102:103], v0 offset:6656
ds_read_b64 v[104:105], v0 offset:7168
s_nop 2
v_add_f32 v98, v72, v74
v_add_f32 v99, v73, v75
s_waitcnt lgkmcnt(0)
v_pk_add_f32 v[100:101], v[100:101], v[98:99]
v_pk_add_f32 v[102:103], v[102:103], v[104:105]
v_pk_add_f32 v[100:101], v[100:101], v[102:103]
v_cvt_pk_bf16_f32 v108, v100, v101
buffer_store_dword v108, v27, s[4:7], s40 offen
s_cmp_eq_u32 s36, 63
s_cbranch_scc1 Lend_1
v_add_u32 v7, 1, v7
s_and_b32 s38, s36, 3
s_lshl_b32 s84, s38, 18
s_add_u32 s84, s84, s46
s_add_u32 s85, s84, 0x100000
s_mov_b64 exec, 3
buffer_load_dword v112, v1, s[4:7], s59 offen sc1
s_nop 5
buffer_load_dword v113, v1, s[4:7], s59 offen sc1
s_nop 5
buffer_load_dword v114, v1, s[4:7], s59 offen sc1
Lft_296:
s_waitcnt vmcnt(2)
v_cmp_gt_u32 vcc, s26, v112
buffer_load_dword v112, v1, s[4:7], s59 offen sc1
s_cbranch_vccz Lfg_295
s_waitcnt vmcnt(2)
v_cmp_gt_u32 vcc, s26, v113
buffer_load_dword v113, v1, s[4:7], s59 offen sc1
s_cbranch_vccz Lfg_295
s_waitcnt vmcnt(2)
v_cmp_gt_u32 vcc, s26, v114
buffer_load_dword v114, v1, s[4:7], s59 offen sc1
s_cbranch_vccz Lfg_295
s_sub_u32 s37, s37, 1
s_cbranch_scc1 Lend_1
s_branch Lft_296
Lfg_295:
s_mov_b64 exec, -1
buffer_load_dwordx4 v[28:31], v9, s[4:7], s40 offen offset:0 sc1
s_nop 11
buffer_load_dwordx4 v[32:35], v9, s[4:7], s40 offen offset:1024 sc1
s_nop 11
buffer_load_dwordx4 v[36:39], v9, s[4:7], s40 offen offset:2048 sc1
s_nop 11
buffer_load_dwordx4 v[40:43], v9, s[4:7], s40 offen offset:3072 sc1
s_nop 11
s_waitcnt vmcnt(3)
v_max3_u32 v110, v28, v29, v30
v_max_u32 v110, v110, v31
v_cmp_eq_u32 vcc, -1, v110
s_cbranch_vccnz Lpf_298
v_smfmac_f32_16x16x64_bf16 v[76:79], v[28:31], a[128:135], v126
s_waitcnt vmcnt(2)
v_max3_u32 v110, v32, v33, v34
v_max_u32 v110, v110, v35
v_cmp_eq_u32 vcc, -1, v110
v_smfmac_f32_16x16x64_bf16 v[80:83], v[28:31], a[136:143], v126
v_smfmac_f32_16x16x64_bf16 v[84:87], v[28:31], a[144:151], v126
s_cbranch_vccnz Lpf_299
v_smfmac_f32_16x16x64_bf16 v[76:79], v[32:35], a[160:167], v126
s_waitcnt vmcnt(1)
v_max3_u32 v110, v36, v37, v38
v_max_u32 v110, v110, v39
v_cmp_eq_u32 vcc, -1, v110
v_smfmac_f32_16x16x64_bf16 v[80:83], v[32:35], a[168:175], v126
v_smfmac_f32_16x16x64_bf16 v[84:87], v[32:35], a[176:183], v126
s_cbranch_vccnz Lpf_300
v_smfmac_f32_16x16x64_bf16 v[76:79], v[36:39], a[192:199], v126
s_waitcnt vmcnt(0)
v_max3_u32 v110, v40, v41, v42
v_max_u32 v110, v110, v43
v_cmp_eq_u32 vcc, -1, v110
v_smfmac_f32_16x16x64_bf16 v[80:83], v[36:39], a[200:207], v126
v_smfmac_f32_16x16x64_bf16 v[84:87], v[36:39], a[208:215], v126
s_cbranch_vccnz Lpf_301
v_smfmac_f32_16x16x64_bf16 v[76:79], v[40:43], a[224:231], v126
s_nop 1
v_smfmac_f32_16x16x64_bf16 v[80:83], v[40:43], a[232:239], v126
s_nop 1
v_smfmac_f32_16x16x64_bf16 v[84:87], v[40:43], a[240:247], v126
s_nop 1
v_add_f32 v92, v76, v78
v_add_f32 v93, v77, v79
v_smfmac_f32_16x16x64_bf16 v[88:91], v[28:31], a[152:159], v126
v_add_f32 v94, v80, v82
v_add_f32 v95, v81, v83
ds_write_b64 v24, v[92:93] offset:12288
v_add_f32 v96, v84, v86
v_add_f32 v97, v85, v87
ds_write_b64 v25, v[94:95] offset:12288
v_smfmac_f32_16x16x64_bf16 v[88:91], v[32:35], a[184:191], v126
ds_write_b64 v26, v[96:97] offset:12288
v_smfmac_f32_16x16x64_bf16 v[88:91], v[36:39], a[216:223], v126
v_smfmac_f32_16x16x64_bf16 v[88:91], v[40:43], a[248:255], v126
Lpd_297:
s_waitcnt lgkmcnt(0)
s_barrier
ds_read_b64 v[100:101], v0 offset:12288
ds_read_b64 v[102:103], v0 offset:12800
ds_read_b64 v[104:105], v0 offset:13312
s_nop 2
v_add_f32 v98, v88, v90
v_add_f32 v99, v89, v91
s_waitcnt lgkmcnt(0)
v_pk_add_f32 v[100:101], v[100:101], v[98:99]
v_pk_add_f32 v[102:103], v[102:103], v[104:105]
v_pk_add_f32 v[100:101], v[100:101], v[102:103]
v_cvt_pk_bf16_f32 v108, v100, v101
buffer_store_dword v108, v12, s[4:7], s84 offen sc1
buffer_store_dword v108, v12, s[4:7], s85 offen sc1
s_waitcnt vmcnt(2)
buffer_store_dwordx2 v[4:5], v10, s[4:7], s42 offen
buffer_store_dword v4, v11, s[4:7], s42 offen
buffer_store_dword v4, v27, s[4:7], s42 offen
v_mov_b32 v112, v108
v_mov_b32 v116, v108
v_mov_b32 v120, v108
s_add_u32 s36, s36, 1
s_and_b32 s38, s36, 3
s_lshl_b32 s39, s38, 16
s_add_u32 s40, s39, s45
s_xor_b32 s42, s40, 0x20000
s_add_u32 s26, s36, 1
s_nop 15
s_nop 15
s_nop 15
s_nop 15
s_nop 15
buffer_load_dword v113, v13, s[4:7], s84 offen sc1
buffer_load_dword v114, v14, s[4:7], s84 offen sc1
buffer_load_dword v115, v15, s[4:7], s84 offen sc1
v_pk_mul_f32 v[44:45], 0, 0
v_pk_mul_f32 v[46:47], 0, 0
v_pk_mul_f32 v[48:49], 0, 0
v_pk_mul_f32 v[50:51], 0, 0
v_pk_mul_f32 v[52:53], 0, 0
v_pk_mul_f32 v[54:55], 0, 0
v_pk_mul_f32 v[56:57], 0, 0
v_pk_mul_f32 v[58:59], 0, 0
v_pk_mul_f32 v[60:61], 0, 0
v_pk_mul_f32 v[62:63], 0, 0
v_pk_mul_f32 v[64:65], 0, 0
v_pk_mul_f32 v[66:67], 0, 0
v_pk_mul_f32 v[68:69], 0, 0
v_pk_mul_f32 v[70:71], 0, 0
v_pk_mul_f32 v[72:73], 0, 0
v_pk_mul_f32 v[74:75], 0, 0
v_pk_mul_f32 v[76:77], 0, 0
v_pk_mul_f32 v[78:79], 0, 0
v_pk_mul_f32 v[80:81], 0, 0
v_pk_mul_f32 v[82:83], 0, 0
v_pk_mul_f32 v[84:85], 0, 0
v_pk_mul_f32 v[86:87], 0, 0
v_pk_mul_f32 v[88:89], 0, 0
v_pk_mul_f32 v[90:91], 0, 0
buffer_load_dword v117, v13, s[4:7], s85 offen sc1
buffer_load_dword v118, v14, s[4:7], s85 offen sc1
buffer_load_dword v119, v15, s[4:7], s85 offen sc1
buffer_store_dword v7, v2, s[4:7], s59 offen
s_nop 15
s_nop 15
s_nop 15
buffer_load_dword v121, v13, s[4:7], s84 offen sc1
buffer_load_dword v122, v14, s[4:7], s84 offen sc1
buffer_load_dword v123, v15, s[4:7], s84 offen sc1
s_waitcnt vmcnt(7)
v_mfma_f32_16x16x32_bf16 v[100:103], v[112:115], v[20:23], 0
v_max3_u32 v110, v113, v114, v115
v_cmp_eq_u32 vcc, -1, v110
s_nop 5
v_cvt_pk_bf16_f32 v106, v100, v101
v_cvt_pk_bf16_f32 v107, v102, v103
s_cbranch_vccnz Lx2_302
Lxs_303:
buffer_store_dwordx2 v[106:107], v10, s[4:7], s40 offen
s_nop 15
s_nop 15
s_nop 11
s_branch Lkvo_289
Lx2_302:
buffer_load_dword v113, v13, s[4:7], s85 offen sc1
buffer_load_dword v114, v14, s[4:7], s85 offen sc1
buffer_load_dword v115, v15, s[4:7], s85 offen sc1
s_waitcnt vmcnt(6)
v_mfma_f32_16x16x32_bf16 v[100:103], v[116:119], v[20:23], 0
v_max3_u32 v110, v117, v118, v119
v_cmp_eq_u32 vcc, -1, v110
s_nop 5
v_cvt_pk_bf16_f32 v106, v100, v101
v_cvt_pk_bf16_f32 v107, v102, v103
s_cbranch_vccz Lxs_303
buffer_load_dword v117, v13, s[4:7], s84 offen sc1
buffer_load_dword v118, v14, s[4:7], s84 offen sc1
buffer_load_dword v119, v15, s[4:7], s84 offen sc1
s_waitcnt vmcnt(6)
v_mfma_f32_16x16x32_bf16 v[100:103], v[120:123], v[20:23], 0
v_max3_u32 v110, v121, v122, v123
v_cmp_eq_u32 vcc, -1, v110
s_nop 5
v_cvt_pk_bf16_f32 v106, v100, v101
v_cvt_pk_bf16_f32 v107, v102, v103
s_cbranch_vccz Lxs_303
buffer_load_dword v121, v13, s[4:7], s85 offen sc1
buffer_load_dword v122, v14, s[4:7], s85 offen sc1
buffer_load_dword v123, v15, s[4:7], s85 offen sc1
s_waitcnt vmcnt(6)
v_mfma_f32_16x16x32_bf16 v[100:103], v[112:115], v[20:23], 0
v_max3_u32 v110, v113, v114, v115
v_cmp_eq_u32 vcc, -1, v110
s_nop 5
v_cvt_pk_bf16_f32 v106, v100, v101
v_cvt_pk_bf16_f32 v107, v102, v103
s_cbranch_vccz Lxs_303
buffer_load_dword v113, v13, s[4:7], s84 offen sc1
buffer_load_dword v114, v14, s[4:7], s84 offen sc1
buffer_load_dword v115, v15, s[4:7], s84 offen sc1
s_waitcnt vmcnt(6)
v_mfma_f32_16x16x32_bf16 v[100:103], v[116:119], v[20:23], 0
v_max3_u32 v110, v117, v118, v119
v_cmp_eq_u32 vcc, -1, v110
s_nop 5
v_cvt_pk_bf16_f32 v106, v100, v101
v_cvt_pk_bf16_f32 v107, v102, v103
s_cbranch_vccz Lxs_303
buffer_load_dword v117, v13, s[4:7], s85 offen sc1
buffer_load_dword v118, v14, s[4:7], s85 offen sc1
buffer_load_dword v119, v15, s[4:7], s85 offen sc1
s_waitcnt vmcnt(6)
v_mfma_f32_16x16x32_bf16 v[100:103], v[120:123], v[20:23], 0
v_max3_u32 v110, v121, v122, v123
v_cmp_eq_u32 vcc, -1, v110
s_nop 5
v_cvt_pk_bf16_f32 v106, v100, v101
v_cvt_pk_bf16_f32 v107, v102, v103
s_cbranch_vccz Lxs_303
buffer_load_dword v121, v13, s[4:7], s84 offen sc1
buffer_load_dword v122, v14, s[4:7], s84 offen sc1
buffer_load_dword v123, v15, s[4:7], s84 offen sc1
s_waitcnt vmcnt(6)
v_mfma_f32_16x16x32_bf16 v[100:103], v[112:115], v[20:23], 0
v_max3_u32 v110, v113, v114, v115
v_cmp_eq_u32 vcc, -1, v110
s_nop 5
v_cvt_pk_bf16_f32 v106, v100, v101
v_cvt_pk_bf16_f32 v107, v102, v103
s_cbranch_vccz Lxs_303
s_sub_u32 s37, s37, 1
s_cbranch_scc1 Lend_1
s_branch Lx2_302
Lpf_291:
buffer_load_dwordx4 v[28:31], v8, s[4:7], s40 offen offset:0 sc1
s_sub_u32 s37, s37, 1
s_cbranch_scc1 Lend_1
Lps_304:
s_waitcnt vmcnt(3)
v_max3_u32 v110, v32, v33, v34
v_max_u32 v110, v110, v35
v_cmp_eq_u32 vcc, -1, v110
s_cbranch_vccnz Lpf_305
v_smfmac_f32_16x16x64_bf16 v[44:47], v[32:35], a[32:39], v126
v_smfmac_f32_16x16x64_bf16 v[48:51], v[32:35], a[40:47], v126
v_smfmac_f32_16x16x64_bf16 v[52:55], v[32:35], a[48:55], v126
v_smfmac_f32_16x16x64_bf16 v[60:63], v[32:35], v[160:167], v126
Lps_306:
s_waitcnt vmcnt(2)
v_max3_u32 v110, v36, v37, v38
v_max_u32 v110, v110, v39
v_cmp_eq_u32 vcc, -1, v110
s_cbranch_vccnz Lpf_307
v_smfmac_f32_16x16x64_bf16 v[44:47], v[36:39], a[64:71], v126
v_smfmac_f32_16x16x64_bf16 v[48:51], v[36:39], a[72:79], v126
v_smfmac_f32_16x16x64_bf16 v[52:55], v[36:39], a[80:87], v126
v_smfmac_f32_16x16x64_bf16 v[60:63], v[36:39], v[192:199], v126
Lps_308:
s_waitcnt vmcnt(1)
v_max3_u32 v110, v40, v41, v42
v_max_u32 v110, v110, v43
v_cmp_eq_u32 vcc, -1, v110
s_cbranch_vccnz Lpf_309
v_smfmac_f32_16x16x64_bf16 v[44:47], v[40:43], a[96:103], v126
v_smfmac_f32_16x16x64_bf16 v[48:51], v[40:43], a[104:111], v126
v_smfmac_f32_16x16x64_bf16 v[52:55], v[40:43], a[112:119], v126
v_smfmac_f32_16x16x64_bf16 v[60:63], v[40:43], v[224:231], v126
Lps_310:
s_waitcnt vmcnt(0)
v_max3_u32 v110, v28, v29, v30
v_max_u32 v110, v110, v31
v_cmp_eq_u32 vcc, -1, v110
s_cbranch_vccnz Lpf_311
v_smfmac_f32_16x16x64_bf16 v[44:47], v[28:31], a[0:7], v126
s_nop 1
v_smfmac_f32_16x16x64_bf16 v[48:51], v[28:31], a[8:15], v126
s_nop 1
v_smfmac_f32_16x16x64_bf16 v[52:55], v[28:31], a[16:23], v126
s_nop 1
v_add_f32 v92, v44, v46
v_add_f32 v93, v45, v47
v_smfmac_f32_16x16x64_bf16 v[56:59], v[28:31], a[24:31], v126
v_add_f32 v94, v48, v50
v_add_f32 v95, v49, v51
ds_write_b64 v24, v[92:93] offset:0
v_add_f32 v96, v52, v54
v_add_f32 v97, v53, v55
ds_write_b64 v25, v[94:95] offset:0
v_smfmac_f32_16x16x64_bf16 v[56:59], v[32:35], a[56:63], v126
ds_write_b64 v26, v[96:97] offset:0
v_smfmac_f32_16x16x64_bf16 v[56:59], v[36:39], a[88:95], v126
v_smfmac_f32_16x16x64_bf16 v[56:59], v[40:43], a[120:127], v126
v_smfmac_f32_16x16x64_bf16 v[60:63], v[28:31], v[128:135], v126
s_branch Lpd_290
Lpf_292:
buffer_load_dwordx4 v[32:35], v8, s[4:7], s40 offen offset:1024 sc1
s_sub_u32 s37, s37, 1
s_cbranch_scc1 Lend_1
Lps_312:
s_waitcnt vmcnt(2)
v_max3_u32 v110, v36, v37, v38
v_max_u32 v110, v110, v39
v_cmp_eq_u32 vcc, -1, v110
s_cbranch_vccnz Lpf_313
v_smfmac_f32_16x16x64_bf16 v[44:47], v[36:39], a[64:71], v126
v_smfmac_f32_16x16x64_bf16 v[48:51], v[36:39], a[72:79], v126
v_smfmac_f32_16x16x64_bf16 v[52:55], v[36:39], a[80:87], v126
v_smfmac_f32_16x16x64_bf16 v[60:63], v[36:39], v[192:199], v126
Lps_314:
s_waitcnt vmcnt(1)
v_max3_u32 v110, v40, v41, v42
v_max_u32 v110, v110, v43
v_cmp_eq_u32 vcc, -1, v110
s_cbranch_vccnz Lpf_315
v_smfmac_f32_16x16x64_bf16 v[44:47], v[40:43], a[96:103], v126
v_smfmac_f32_16x16x64_bf16 v[48:51], v[40:43], a[104:111], v126
v_smfmac_f32_16x16x64_bf16 v[52:55], v[40:43], a[112:119], v126
v_smfmac_f32_16x16x64_bf16 v[60:63], v[40:43], v[224:231], v126
Lps_316:
s_waitcnt vmcnt(0)
v_max3_u32 v110, v32, v33, v34
v_max_u32 v110, v110, v35
v_cmp_eq_u32 vcc, -1, v110
s_cbranch_vccnz Lpf_317
v_smfmac_f32_16x16x64_bf16 v[44:47], v[32:35], a[32:39], v126
s_nop 1
v_smfmac_f32_16x16x64_bf16 v[48:51], v[32:35], a[40:47], v126
s_nop 1
v_smfmac_f32_16x16x64_bf16 v[52:55], v[32:35], a[48:55], v126
s_nop 1
v_add_f32 v92, v44, v46
v_add_f32 v93, v45, v47
v_smfmac_f32_16x16x64_bf16 v[56:59], v[28:31], a[24:31], v126
v_add_f32 v94, v48, v50
v_add_f32 v95, v49, v51
ds_write_b64 v24, v[92:93] offset:0
v_add_f32 v96, v52, v54
v_add_f32 v97, v53, v55
ds_write_b64 v25, v[94:95] offset:0
v_smfmac_f32_16x16x64_bf16 v[56:59], v[32:35], a[56:63], v126
ds_write_b64 v26, v[96:97] offset:0
v_smfmac_f32_16x16x64_bf16 v[56:59], v[36:39], a[88:95], v126
v_smfmac_f32_16x16x64_bf16 v[56:59], v[40:43], a[120:127], v126
v_smfmac_f32_16x16x64_bf16 v[60:63], v[32:35], v[160:167], v126
s_branch Lpd_290
Lpf_293:
buffer_load_dwordx4 v[36:39], v8, s[4:7], s40 offen offset:2048 sc1
s_sub_u32 s37, s37, 1
s_cbranch_scc1 Lend_1
Lps_318:
s_waitcnt vmcnt(1)
v_max3_u32 v110, v40, v41, v42
v_max_u32 v110, v110, v43
v_cmp_eq_u32 vcc, -1, v110
s_cbranch_vccnz Lpf_319
v_smfmac_f32_16x16x64_bf16 v[44:47], v[40:43], a[96:103], v126
v_smfmac_f32_16x16x64_bf16 v[48:51], v[40:43], a[104:111], v126
v_smfmac_f32_16x16x64_bf16 v[52:55], v[40:43], a[112:119], v126
v_smfmac_f32_16x16x64_bf16 v[60:63], v[40:43], v[224:231], v126
Lps_320:
s_waitcnt vmcnt(0)
v_max3_u32 v110, v36, v37, v38
v_max_u32 v110, v110, v39
v_cmp_eq_u32 vcc, -1, v110
s_cbranch_vccnz Lpf_321
v_smfmac_f32_16x16x64_bf16 v[44:47], v[36:39], a[64:71], v126
s_nop 1
v_smfmac_f32_16x16x64_bf16 v[48:51], v[36:39], a[72:79], v126
s_nop 1
v_smfmac_f32_16x16x64_bf16 v[52:55], v[36:39], a[80:87], v126
s_nop 1
v_add_f32 v92, v44, v46
v_add_f32 v93, v45, v47
v_smfmac_f32_16x16x64_bf16 v[56:59], v[28:31], a[24:31], v126
v_add_f32 v94, v48, v50
v_add_f32 v95, v49, v51
ds_write_b64 v24, v[92:93] offset:0
v_add_f32 v96, v52, v54
v_add_f32 v97, v53, v55
ds_write_b64 v25, v[94:95] offset:0
v_smfmac_f32_16x16x64_bf16 v[56:59], v[32:35], a[56:63], v126
ds_write_b64 v26, v[96:97] offset:0
v_smfmac_f32_16x16x64_bf16 v[56:59], v[36:39], a[88:95], v126
v_smfmac_f32_16x16x64_bf16 v[56:59], v[40:43], a[120:127], v126
v_smfmac_f32_16x16x64_bf16 v[60:63], v[36:39], v[192:199], v126
s_branch Lpd_290
Lpf_294:
buffer_load_dwordx4 v[40:43], v8, s[4:7], s40 offen offset:3072 sc1
s_sub_u32 s37, s37, 1
s_cbranch_scc1 Lend_1
Lps_322:
s_waitcnt vmcnt(0)
v_max3_u32 v110, v40, v41, v42
v_max_u32 v110, v110, v43
v_cmp_eq_u32 vcc, -1, v110
s_cbranch_vccnz Lpf_323
v_smfmac_f32_16x16x64_bf16 v[44:47], v[40:43], a[96:103], v126
s_nop 1
v_smfmac_f32_16x16x64_bf16 v[48:51], v[40:43], a[104:111], v126
s_nop 1
v_smfmac_f32_16x16x64_bf16 v[52:55], v[40:43], a[112:119], v126
s_nop 1
v_add_f32 v92, v44, v46
v_add_f32 v93, v45, v47
v_smfmac_f32_16x16x64_bf16 v[56:59], v[28:31], a[24:31], v126
v_add_f32 v94, v48, v50
v_add_f32 v95, v49, v51
ds_write_b64 v24, v[92:93] offset:0
v_add_f32 v96, v52, v54
v_add_f32 v97, v53, v55
ds_write_b64 v25, v[94:95] offset:0
v_smfmac_f32_16x16x64_bf16 v[56:59], v[32:35], a[56:63], v126
ds_write_b64 v26, v[96:97] offset:0
v_smfmac_f32_16x16x64_bf16 v[56:59], v[36:39], a[88:95], v126
v_smfmac_f32_16x16x64_bf16 v[56:59], v[40:43], a[120:127], v126
v_smfmac_f32_16x16x64_bf16 v[60:63], v[40:43], v[224:231], v126
s_branch Lpd_290
Lpf_305:
buffer_load_dwordx4 v[32:35], v8, s[4:7], s40 offen offset:1024 sc1
Lps_324:
s_waitcnt vmcnt(3)
v_max3_u32 v110, v36, v37, v38
v_max_u32 v110, v110, v39
v_cmp_eq_u32 vcc, -1, v110
s_cbranch_vccnz Lpf_325
v_smfmac_f32_16x16x64_bf16 v[44:47], v[36:39], a[64:71], v126
v_smfmac_f32_16x16x64_bf16 v[48:51], v[36:39], a[72:79], v126
v_smfmac_f32_16x16x64_bf16 v[52:55], v[36:39], a[80:87], v126
v_smfmac_f32_16x16x64_bf16 v[60:63], v[36:39], v[192:199], v126
Lps_326:
s_waitcnt vmcnt(2)
v_max3_u32 v110, v40, v41, v42
v_max_u32 v110, v110, v43
v_cmp_eq_u32 vcc, -1, v110
s_cbranch_vccnz Lpf_327
v_smfmac_f32_16x16x64_bf16 v[44:47], v[40:43], a[96:103], v126
v_smfmac_f32_16x16x64_bf16 v[48:51], v[40:43], a[104:111], v126
v_smfmac_f32_16x16x64_bf16 v[52:55], v[40:43], a[112:119], v126
v_smfmac_f32_16x16x64_bf16 v[60:63], v[40:43], v[224:231], v126
Lps_328:
s_waitcnt vmcnt(1)
v_max3_u32 v110, v28, v29, v30
v_max_u32 v110, v110, v31
v_cmp_eq_u32 vcc, -1, v110
s_cbranch_vccnz Lpf_329
v_smfmac_f32_16x16x64_bf16 v[44:47], v[28:31], a[0:7], v126
v_smfmac_f32_16x16x64_bf16 v[48:51], v[28:31], a[8:15], v126
v_smfmac_f32_16x16x64_bf16 v[52:55], v[28:31], a[16:23], v126
v_smfmac_f32_16x16x64_bf16 v[60:63], v[28:31], v[128:135], v126
s_branch Lps_316
Lpf_307:
buffer_load_dwordx4 v[36:39], v8, s[4:7], s40 offen offset:2048 sc1
Lps_330:
s_waitcnt vmcnt(2)
v_max3_u32 v110, v40, v41, v42
v_max_u32 v110, v110, v43
v_cmp_eq_u32 vcc, -1, v110
s_cbranch_vccnz Lpf_331
v_smfmac_f32_16x16x64_bf16 v[44:47], v[40:43], a[96:103], v126
v_smfmac_f32_16x16x64_bf16 v[48:51], v[40:43], a[104:111], v126
v_smfmac_f32_16x16x64_bf16 v[52:55], v[40:43], a[112:119], v126
v_smfmac_f32_16x16x64_bf16 v[60:63], v[40:43], v[224:231], v126
Lps_332:
s_waitcnt vmcnt(1)
v_max3_u32 v110, v28, v29, v30
v_max_u32 v110, v110, v31
v_cmp_eq_u32 vcc, -1, v110
s_cbranch_vccnz Lpf_333
v_smfmac_f32_16x16x64_bf16 v[44:47], v[28:31], a[0:7], v126
v_smfmac_f32_16x16x64_bf16 v[48:51], v[28:31], a[8:15], v126
v_smfmac_f32_16x16x64_bf16 v[52:55], v[28:31], a[16:23], v126
v_smfmac_f32_16x16x64_bf16 v[60:63], v[28:31], v[128:135], v126
s_branch Lps_320
Lpf_309:
buffer_load_dwordx4 v[40:43], v8, s[4:7], s40 offen offset:3072 sc1
Lps_334:
s_waitcnt vmcnt(1)
v_max3_u32 v110, v28, v29, v30
v_max_u32 v110, v110, v31
v_cmp_eq_u32 vcc, -1, v110
s_cbranch_vccnz Lpf_335
v_smfmac_f32_16x16x64_bf16 v[44:47], v[28:31], a[0:7], v126
v_smfmac_f32_16x16x64_bf16 v[48:51], v[28:31], a[8:15], v126
v_smfmac_f32_16x16x64_bf16 v[52:55], v[28:31], a[16:23], v126
v_smfmac_f32_16x16x64_bf16 v[60:63], v[28:31], v[128:135], v126
s_branch Lps_322
Lpf_311:
buffer_load_dwordx4 v[28:31], v8, s[4:7], s40 offen offset:0 sc1
s_sub_u32 s37, s37, 1
s_cbranch_scc1 Lend_1
s_branch Lps_310
Lpf_313:
buffer_load_dwordx4 v[36:39], v8, s[4:7], s40 offen offset:2048 sc1
Lps_336:
s_waitcnt vmcnt(2)
v_max3_u32 v110, v40, v41, v42
v_max_u32 v110, v110, v43
v_cmp_eq_u32 vcc, -1, v110
s_cbranch_vccnz Lpf_337
v_smfmac_f32_16x16x64_bf16 v[44:47], v[40:43], a[96:103], v126
v_smfmac_f32_16x16x64_bf16 v[48:51], v[40:43], a[104:111], v126
v_smfmac_f32_16x16x64_bf16 v[52:55], v[40:43], a[112:119], v126
v_smfmac_f32_16x16x64_bf16 v[60:63], v[40:43], v[224:231], v126
Lps_338:
s_waitcnt vmcnt(1)
v_max3_u32 v110, v32, v33, v34
v_max_u32 v110, v110, v35
v_cmp_eq_u32 vcc, -1, v110
s_cbranch_vccnz Lpf_339
v_smfmac_f32_16x16x64_bf16 v[44:47], v[32:35], a[32:39], v126
v_smfmac_f32_16x16x64_bf16 v[48:51], v[32:35], a[40:47], v126
v_smfmac_f32_16x16x64_bf16 v[52:55], v[32:35], a[48:55], v126
v_smfmac_f32_16x16x64_bf16 v[60:63], v[32:35], v[160:167], v126
s_branch Lps_320
Lpf_315:
buffer_load_dwordx4 v[40:43], v8, s[4:7], s40 offen offset:3072 sc1
Lps_340:
s_waitcnt vmcnt(1)
v_max3_u32 v110, v32, v33, v34
v_max_u32 v110, v110, v35
v_cmp_eq_u32 vcc, -1, v110
s_cbranch_vccnz Lpf_341
v_smfmac_f32_16x16x64_bf16 v[44:47], v[32:35], a[32:39], v126
v_smfmac_f32_16x16x64_bf16 v[48:51], v[32:35], a[40:47], v126
v_smfmac_f32_16x16x64_bf16 v[52:55], v[32:35], a[48:55], v126
v_smfmac_f32_16x16x64_bf16 v[60:63], v[32:35], v[160:167], v126
s_branch Lps_322
Lpf_317:
buffer_load_dwordx4 v[32:35], v8, s[4:7], s40 offen offset:1024 sc1
s_sub_u32 s37, s37, 1
s_cbranch_scc1 Lend_1
s_branch Lps_316
Lpf_319:
buffer_load_dwordx4 v[40:43], v8, s[4:7], s40 offen offset:3072 sc1
Lps_342:
s_waitcnt vmcnt(1)
v_max3_u32 v110, v36, v37, v38
v_max_u32 v110, v110, v39
v_cmp_eq_u32 vcc, -1, v110
s_cbranch_vccnz Lpf_343
v_smfmac_f32_16x16x64_bf16 v[44:47], v[36:39], a[64:71], v126
v_smfmac_f32_16x16x64_bf16 v[48:51], v[36:39], a[72:79], v126
v_smfmac_f32_16x16x64_bf16 v[52:55], v[36:39], a[80:87], v126
v_smfmac_f32_16x16x64_bf16 v[60:63], v[36:39], v[192:199], v126
s_branch Lps_322
Lpf_321:
buffer_load_dwordx4 v[36:39], v8, s[4:7], s40 offen offset:2048 sc1
s_sub_u32 s37, s37, 1
s_cbranch_scc1 Lend_1
s_branch Lps_320
Lpf_323:
buffer_load_dwordx4 v[40:43], v8, s[4:7], s40 offen offset:3072 sc1
s_sub_u32 s37, s37, 1
s_cbranch_scc1 Lend_1
s_branch Lps_322
Lpf_325:
buffer_load_dwordx4 v[36:39], v8, s[4:7], s40 offen offset:2048 sc1
Lps_344:
s_waitcnt vmcnt(3)
v_max3_u32 v110, v40, v41, v42
v_max_u32 v110, v110, v43
v_cmp_eq_u32 vcc, -1, v110
s_cbranch_vccnz Lpf_345
v_smfmac_f32_16x16x64_bf16 v[44:47], v[40:43], a[96:103], v126
v_smfmac_f32_16x16x64_bf16 v[48:51], v[40:43], a[104:111], v126
v_smfmac_f32_16x16x64_bf16 v[52:55], v[40:43], a[112:119], v126
v_smfmac_f32_16x16x64_bf16 v[60:63], v[40:43], v[224:231], v126
Lps_346:
s_waitcnt vmcnt(2)
v_max3_u32 v110, v28, v29, v30
v_max_u32 v110, v110, v31
v_cmp_eq_u32 vcc, -1, v110
s_cbranch_vccnz Lpf_347
v_smfmac_f32_16x16x64_bf16 v[44:47], v[28:31], a[0:7], v126
v_smfmac_f32_16x16x64_bf16 v[48:51], v[28:31], a[8:15], v126
v_smfmac_f32_16x16x64_bf16 v[52:55], v[28:31], a[16:23], v126
v_smfmac_f32_16x16x64_bf16 v[60:63], v[28:31], v[128:135], v126
s_branch Lps_338
Lpf_327:
buffer_load_dwordx4 v[40:43], v8, s[4:7], s40 offen offset:3072 sc1
Lps_348:
s_waitcnt vmcnt(2)
v_max3_u32 v110, v28, v29, v30
v_max_u32 v110, v110, v31
v_cmp_eq_u32 vcc, -1, v110
s_cbranch_vccnz Lpf_349
v_smfmac_f32_16x16x64_bf16 v[44:47], v[28:31], a[0:7], v126
v_smfmac_f32_16x16x64_bf16 v[48:51], v[28:31], a[8:15], v126
v_smfmac_f32_16x16x64_bf16 v[52:55], v[28:31], a[16:23], v126
v_smfmac_f32_16x16x64_bf16 v[60:63], v[28:31], v[128:135], v126
s_branch Lps_340
Lpf_329:
buffer_load_dwordx4 v[28:31], v8, s[4:7], s40 offen offset:0 sc1
s_sub_u32 s37, s37, 1
s_cbranch_scc1 Lend_1
Lps_350:
s_waitcnt vmcnt(1)
v_max3_u32 v110, v32, v33, v34
v_max_u32 v110, v110, v35
v_cmp_eq_u32 vcc, -1, v110
s_cbranch_vccnz Lpf_351
v_smfmac_f32_16x16x64_bf16 v[44:47], v[32:35], a[32:39], v126
v_smfmac_f32_16x16x64_bf16 v[48:51], v[32:35], a[40:47], v126
v_smfmac_f32_16x16x64_bf16 v[52:55], v[32:35], a[48:55], v126
v_smfmac_f32_16x16x64_bf16 v[60:63], v[32:35], v[160:167], v126
s_branch Lps_310
Lpf_331:
buffer_load_dwordx4 v[40:43], v8, s[4:7], s40 offen offset:3072 sc1
Lps_352:
s_waitcnt vmcnt(2)
v_max3_u32 v110, v28, v29, v30
v_max_u32 v110, v110, v31
v_cmp_eq_u32 vcc, -1, v110
s_cbranch_vccnz Lpf_353
v_smfmac_f32_16x16x64_bf16 v[44:47], v[28:31], a[0:7], v126
v_smfmac_f32_16x16x64_bf16 v[48:51], v[28:31], a[8:15], v126
v_smfmac_f32_16x16x64_bf16 v[52:55], v[28:31], a[16:23], v126
v_smfmac_f32_16x16x64_bf16 v[60:63], v[28:31], v[128:135], v126
s_branch Lps_342
Lpf_333:
buffer_load_dwordx4 v[28:31], v8, s[4:7], s40 offen offset:0 sc1
s_sub_u32 s37, s37, 1
s_cbranch_scc1 Lend_1
Lps_354:
s_waitcnt vmcnt(1)
v_max3_u32 v110, v36, v37, v38
v_max_u32 v110, v110, v39
v_cmp_eq_u32 vcc, -1, v110
s_cbranch_vccnz Lpf_355
v_smfmac_f32_16x16x64_bf16 v[44:47], v[36:39], a[64:71], v126
v_smfmac_f32_16x16x64_bf16 v[48:51], v[36:39], a[72:79], v126
v_smfmac_f32_16x16x64_bf16 v[52:55], v[36:39], a[80:87], v126
v_smfmac_f32_16x16x64_bf16 v[60:63], v[36:39], v[192:199], v126
s_branch Lps_310
Lpf_335:
buffer_load_dwordx4 v[28:31], v8, s[4:7], s40 offen offset:0 sc1
s_sub_u32 s37, s37, 1
s_cbranch_scc1 Lend_1
s_branch Lps_308
Lpf_337:
buffer_load_dwordx4 v[40:43], v8, s[4:7], s40 offen offset:3072 sc1
Lps_356:
s_waitcnt vmcnt(2)
v_max3_u32 v110, v32, v33, v34
v_max_u32 v110, v110, v35
v_cmp_eq_u32 vcc, -1, v110
s_cbranch_vccnz Lpf_357
v_smfmac_f32_16x16x64_bf16 v[44:47], v[32:35], a[32:39], v126
v_smfmac_f32_16x16x64_bf16 v[48:51], v[32:35], a[40:47], v126
v_smfmac_f32_16x16x64_bf16 v[52:55], v[32:35], a[48:55], v126
v_smfmac_f32_16x16x64_bf16 v[60:63], v[32:35], v[160:167], v126
s_branch Lps_342
Lpf_339:
buffer_load_dwordx4 v[32:35], v8, s[4:7], s40 offen offset:1024 sc1
s_sub_u32 s37, s37, 1
s_cbranch_scc1 Lend_1
Lps_358:
s_waitcnt vmcnt(1)
v_max3_u32 v110, v36, v37, v38
v_max_u32 v110, v110, v39
v_cmp_eq_u32 vcc, -1, v110
s_cbranch_vccnz Lpf_359
v_smfmac_f32_16x16x64_bf16 v[44:47], v[36:39], a[64:71], v126
v_smfmac_f32_16x16x64_bf16 v[48:51], v[36:39], a[72:79], v126
v_smfmac_f32_16x16x64_bf16 v[52:55], v[36:39], a[80:87], v126
v_smfmac_f32_16x16x64_bf16 v[60:63], v[36:39], v[192:199], v126
s_branch Lps_316
Lpf_341:
buffer_load_dwordx4 v[32:35], v8, s[4:7], s40 offen offset:1024 sc1
s_sub_u32 s37, s37, 1
s_cbranch_scc1 Lend_1
s_branch Lps_314
Lpf_343:
buffer_load_dwordx4 v[36:39], v8, s[4:7], s40 offen offset:2048 sc1
s_sub_u32 s37, s37, 1
s_cbranch_scc1 Lend_1
s_branch Lps_318
Lpf_345:
buffer_load_dwordx4 v[40:43], v8, s[4:7], s40 offen offset:3072 sc1
Lps_360:
s_waitcnt vmcnt(3)
v_max3_u32 v110, v28, v29, v30
v_max_u32 v110, v110, v31
v_cmp_eq_u32 vcc, -1, v110
s_cbranch_vccnz Lpf_361
v_smfmac_f32_16x16x64_bf16 v[44:47], v[28:31], a[0:7], v126
v_smfmac_f32_16x16x64_bf16 v[48:51], v[28:31], a[8:15], v126
v_smfmac_f32_16x16x64_bf16 v[52:55], v[28:31], a[16:23], v126
v_smfmac_f32_16x16x64_bf16 v[60:63], v[28:31], v[128:135], v126
s_branch Lps_356
Lpf_347:
buffer_load_dwordx4 v[28:31], v8, s[4:7], s40 offen offset:0 sc1
s_sub_u32 s37, s37, 1
s_cbranch_scc1 Lend_1
Lps_362:
s_waitcnt vmcnt(2)
v_max3_u32 v110, v32, v33, v34
v_max_u32 v110, v110, v35
v_cmp_eq_u32 vcc, -1, v110
s_cbranch_vccnz Lpf_363
v_smfmac_f32_16x16x64_bf16 v[44:47], v[32:35], a[32:39], v126
v_smfmac_f32_16x16x64_bf16 v[48:51], v[32:35], a[40:47], v126
v_smfmac_f32_16x16x64_bf16 v[52:55], v[32:35], a[48:55], v126
v_smfmac_f32_16x16x64_bf16 v[60:63], v[32:35], v[160:167], v126
s_branch Lps_354
Lpf_349:
buffer_load_dwordx4 v[28:31], v8, s[4:7], s40 offen offset:0 sc1
s_sub_u32 s37, s37, 1
s_cbranch_scc1 Lend_1
Lps_364:
s_waitcnt vmcnt(2)
v_max3_u32 v110, v32, v33, v34
v_max_u32 v110, v110, v35
v_cmp_eq_u32 vcc, -1, v110
s_cbranch_vccnz Lpf_365
v_smfmac_f32_16x16x64_bf16 v[44:47], v[32:35], a[32:39], v126
v_smfmac_f32_16x16x64_bf16 v[48:51], v[32:35], a[40:47], v126
v_smfmac_f32_16x16x64_bf16 v[52:55], v[32:35], a[48:55], v126
v_smfmac_f32_16x16x64_bf16 v[60:63], v[32:35], v[160:167], v126
s_branch Lps_308
Lpf_351:
buffer_load_dwordx4 v[32:35], v8, s[4:7], s40 offen offset:1024 sc1
s_branch Lps_328
Lpf_353:
buffer_load_dwordx4 v[28:31], v8, s[4:7], s40 offen offset:0 sc1
s_sub_u32 s37, s37, 1
s_cbranch_scc1 Lend_1
s_branch Lps_306
Lpf_355:
buffer_load_dwordx4 v[36:39], v8, s[4:7], s40 offen offset:2048 sc1
s_branch Lps_332
Lpf_357:
buffer_load_dwordx4 v[32:35], v8, s[4:7], s40 offen offset:1024 sc1
s_sub_u32 s37, s37, 1
s_cbranch_scc1 Lend_1
s_branch Lps_312
Lpf_359:
buffer_load_dwordx4 v[36:39], v8, s[4:7], s40 offen offset:2048 sc1
s_branch Lps_338
Lpf_361:
buffer_load_dwordx4 v[28:31], v8, s[4:7], s40 offen offset:0 sc1
s_sub_u32 s37, s37, 1
s_cbranch_scc1 Lend_1
s_branch Lps_304
Lpf_363:
buffer_load_dwordx4 v[32:35], v8, s[4:7], s40 offen offset:1024 sc1
Lps_366:
s_waitcnt vmcnt(2)
v_max3_u32 v110, v36, v37, v38
v_max_u32 v110, v110, v39
v_cmp_eq_u32 vcc, -1, v110
s_cbranch_vccnz Lpf_367
v_smfmac_f32_16x16x64_bf16 v[44:47], v[36:39], a[64:71], v126
v_smfmac_f32_16x16x64_bf16 v[48:51], v[36:39], a[72:79], v126
v_smfmac_f32_16x16x64_bf16 v[52:55], v[36:39], a[80:87], v126
v_smfmac_f32_16x16x64_bf16 v[60:63], v[36:39], v[192:199], v126
s_branch Lps_328
Lpf_365:
buffer_load_dwordx4 v[32:35], v8, s[4:7], s40 offen offset:1024 sc1
s_branch Lps_326
Lpf_367:
buffer_load_dwordx4 v[36:39], v8, s[4:7], s40 offen offset:2048 sc1
s_branch Lps_346
Lpf_298:
buffer_load_dwordx4 v[28:31], v9, s[4:7], s40 offen offset:0 sc1
s_sub_u32 s37, s37, 1
s_cbranch_scc1 Lend_1
Lps_368:
s_waitcnt vmcnt(3)
v_max3_u32 v110, v32, v33, v34
v_max_u32 v110, v110, v35
v_cmp_eq_u32 vcc, -1, v110
s_cbranch_vccnz Lpf_369
v_smfmac_f32_16x16x64_bf16 v[76:79], v[32:35], a[160:167], v126
v_smfmac_f32_16x16x64_bf16 v[80:83], v[32:35], a[168:175], v126
v_smfmac_f32_16x16x64_bf16 v[84:87], v[32:35], a[176:183], v126
Lps_370:
s_waitcnt vmcnt(2)
v_max3_u32 v110, v36, v37, v38
v_max_u32 v110, v110, v39
v_cmp_eq_u32 vcc, -1, v110
s_cbranch_vccnz Lpf_371
v_smfmac_f32_16x16x64_bf16 v[76:79], v[36:39], a[192:199], v126
v_smfmac_f32_16x16x64_bf16 v[80:83], v[36:39], a[200:207], v126
v_smfmac_f32_16x16x64_bf16 v[84:87], v[36:39], a[208:215], v126
Lps_372:
s_waitcnt vmcnt(1)
v_max3_u32 v110, v40, v41, v42
v_max_u32 v110, v110, v43
v_cmp_eq_u32 vcc, -1, v110
s_cbranch_vccnz Lpf_373
v_smfmac_f32_16x16x64_bf16 v[76:79], v[40:43], a[224:231], v126
v_smfmac_f32_16x16x64_bf16 v[80:83], v[40:43], a[232:239], v126
v_smfmac_f32_16x16x64_bf16 v[84:87], v[40:43], a[240:247], v126
Lps_374:
s_waitcnt vmcnt(0)
v_max3_u32 v110, v28, v29, v30
v_max_u32 v110, v110, v31
v_cmp_eq_u32 vcc, -1, v110
s_cbranch_vccnz Lpf_375
v_smfmac_f32_16x16x64_bf16 v[76:79], v[28:31], a[128:135], v126
s_nop 1
v_smfmac_f32_16x16x64_bf16 v[80:83], v[28:31], a[136:143], v126
s_nop 1
v_smfmac_f32_16x16x64_bf16 v[84:87], v[28:31], a[144:151], v126
s_nop 1
v_add_f32 v92, v76, v78
v_add_f32 v93, v77, v79
v_smfmac_f32_16x16x64_bf16 v[88:91], v[28:31], a[152:159], v126
v_add_f32 v94, v80, v82
v_add_f32 v95, v81, v83
ds_write_b64 v24, v[92:93] offset:12288
v_add_f32 v96, v84, v86
v_add_f32 v97, v85, v87
ds_write_b64 v25, v[94:95] offset:12288
v_smfmac_f32_16x16x64_bf16 v[88:91], v[32:35], a[184:191], v126
ds_write_b64 v26, v[96:97] offset:12288
v_smfmac_f32_16x16x64_bf16 v[88:91], v[36:39], a[216:223], v126
v_smfmac_f32_16x16x64_bf16 v[88:91], v[40:43], a[248:255], v126
s_branch Lpd_297
Lpf_299:
buffer_load_dwordx4 v[32:35], v9, s[4:7], s40 offen offset:1024 sc1
s_sub_u32 s37, s37, 1
s_cbranch_scc1 Lend_1
Lps_376:
s_waitcnt vmcnt(2)
v_max3_u32 v110, v36, v37, v38
v_max_u32 v110, v110, v39
v_cmp_eq_u32 vcc, -1, v110
s_cbranch_vccnz Lpf_377
v_smfmac_f32_16x16x64_bf16 v[76:79], v[36:39], a[192:199], v126
v_smfmac_f32_16x16x64_bf16 v[80:83], v[36:39], a[200:207], v126
v_smfmac_f32_16x16x64_bf16 v[84:87], v[36:39], a[208:215], v126
Lps_378:
s_waitcnt vmcnt(1)
v_max3_u32 v110, v40, v41, v42
v_max_u32 v110, v110, v43
v_cmp_eq_u32 vcc, -1, v110
s_cbranch_vccnz Lpf_379
v_smfmac_f32_16x16x64_bf16 v[76:79], v[40:43], a[224:231], v126
v_smfmac_f32_16x16x64_bf16 v[80:83], v[40:43], a[232:239], v126
v_smfmac_f32_16x16x64_bf16 v[84:87], v[40:43], a[240:247], v126
Lps_380:
s_waitcnt vmcnt(0)
v_max3_u32 v110, v32, v33, v34
v_max_u32 v110, v110, v35
v_cmp_eq_u32 vcc, -1, v110
s_cbranch_vccnz Lpf_381
v_smfmac_f32_16x16x64_bf16 v[76:79], v[32:35], a[160:167], v126
s_nop 1
v_smfmac_f32_16x16x64_bf16 v[80:83], v[32:35], a[168:175], v126
s_nop 1
v_smfmac_f32_16x16x64_bf16 v[84:87], v[32:35], a[176:183], v126
s_nop 1
v_add_f32 v92, v76, v78
v_add_f32 v93, v77, v79
v_smfmac_f32_16x16x64_bf16 v[88:91], v[28:31], a[152:159], v126
v_add_f32 v94, v80, v82
v_add_f32 v95, v81, v83
ds_write_b64 v24, v[92:93] offset:12288
v_add_f32 v96, v84, v86
v_add_f32 v97, v85, v87
ds_write_b64 v25, v[94:95] offset:12288
v_smfmac_f32_16x16x64_bf16 v[88:91], v[32:35], a[184:191], v126
ds_write_b64 v26, v[96:97] offset:12288
v_smfmac_f32_16x16x64_bf16 v[88:91], v[36:39], a[216:223], v126
v_smfmac_f32_16x16x64_bf16 v[88:91], v[40:43], a[248:255], v126
s_branch Lpd_297
Lpf_300:
buffer_load_dwordx4 v[36:39], v9, s[4:7], s40 offen offset:2048 sc1
s_sub_u32 s37, s37, 1
s_cbranch_scc1 Lend_1
Lps_382:
s_waitcnt vmcnt(1)
v_max3_u32 v110, v40, v41, v42
v_max_u32 v110, v110, v43
v_cmp_eq_u32 vcc, -1, v110
s_cbranch_vccnz Lpf_383
v_smfmac_f32_16x16x64_bf16 v[76:79], v[40:43], a[224:231], v126
v_smfmac_f32_16x16x64_bf16 v[80:83], v[40:43], a[232:239], v126
v_smfmac_f32_16x16x64_bf16 v[84:87], v[40:43], a[240:247], v126
Lps_384:
s_waitcnt vmcnt(0)
v_max3_u32 v110, v36, v37, v38
v_max_u32 v110, v110, v39
v_cmp_eq_u32 vcc, -1, v110
s_cbranch_vccnz Lpf_385
v_smfmac_f32_16x16x64_bf16 v[76:79], v[36:39], a[192:199], v126
s_nop 1
v_smfmac_f32_16x16x64_bf16 v[80:83], v[36:39], a[200:207], v126
s_nop 1
v_smfmac_f32_16x16x64_bf16 v[84:87], v[36:39], a[208:215], v126
s_nop 1
v_add_f32 v92, v76, v78
v_add_f32 v93, v77, v79
v_smfmac_f32_16x16x64_bf16 v[88:91], v[28:31], a[152:159], v126
v_add_f32 v94, v80, v82
v_add_f32 v95, v81, v83
ds_write_b64 v24, v[92:93] offset:12288
v_add_f32 v96, v84, v86
v_add_f32 v97, v85, v87
ds_write_b64 v25, v[94:95] offset:12288
v_smfmac_f32_16x16x64_bf16 v[88:91], v[32:35], a[184:191], v126
ds_write_b64 v26, v[96:97] offset:12288
v_smfmac_f32_16x16x64_bf16 v[88:91], v[36:39], a[216:223], v126
v_smfmac_f32_16x16x64_bf16 v[88:91], v[40:43], a[248:255], v126
s_branch Lpd_297
Lpf_301:
buffer_load_dwordx4 v[40:43], v9, s[4:7], s40 offen offset:3072 sc1
s_sub_u32 s37, s37, 1
s_cbranch_scc1 Lend_1
Lps_386:
s_waitcnt vmcnt(0)
v_max3_u32 v110, v40, v41, v42
v_max_u32 v110, v110, v43
v_cmp_eq_u32 vcc, -1, v110
s_cbranch_vccnz Lpf_387
v_smfmac_f32_16x16x64_bf16 v[76:79], v[40:43], a[224:231], v126
s_nop 1
v_smfmac_f32_16x16x64_bf16 v[80:83], v[40:43], a[232:239], v126
s_nop 1
v_smfmac_f32_16x16x64_bf16 v[84:87], v[40:43], a[240:247], v126
s_nop 1
v_add_f32 v92, v76, v78
v_add_f32 v93, v77, v79
v_smfmac_f32_16x16x64_bf16 v[88:91], v[28:31], a[152:159], v126
v_add_f32 v94, v80, v82
v_add_f32 v95, v81, v83
ds_write_b64 v24, v[92:93] offset:12288
v_add_f32 v96, v84, v86
v_add_f32 v97, v85, v87
ds_write_b64 v25, v[94:95] offset:12288
v_smfmac_f32_16x16x64_bf16 v[88:91], v[32:35], a[184:191], v126
ds_write_b64 v26, v[96:97] offset:12288
v_smfmac_f32_16x16x64_bf16 v[88:91], v[36:39], a[216:223], v126
v_smfmac_f32_16x16x64_bf16 v[88:91], v[40:43], a[248:255], v126
s_branch Lpd_297
Lpf_369:
buffer_load_dwordx4 v[32:35], v9, s[4:7], s40 offen offset:1024 sc1
Lps_388:
s_waitcnt vmcnt(3)
v_max3_u32 v110, v36, v37, v38
v_max_u32 v110, v110, v39
v_cmp_eq_u32 vcc, -1, v110
s_cbranch_vccnz Lpf_389
v_smfmac_f32_16x16x64_bf16 v[76:79], v[36:39], a[192:199], v126
v_smfmac_f32_16x16x64_bf16 v[80:83], v[36:39], a[200:207], v126
v_smfmac_f32_16x16x64_bf16 v[84:87], v[36:39], a[208:215], v126
Lps_390:
s_waitcnt vmcnt(2)
v_max3_u32 v110, v40, v41, v42
v_max_u32 v110, v110, v43
v_cmp_eq_u32 vcc, -1, v110
s_cbranch_vccnz Lpf_391
v_smfmac_f32_16x16x64_bf16 v[76:79], v[40:43], a[224:231], v126
v_smfmac_f32_16x16x64_bf16 v[80:83], v[40:43], a[232:239], v126
v_smfmac_f32_16x16x64_bf16 v[84:87], v[40:43], a[240:247], v126
Lps_392:
s_waitcnt vmcnt(1)
v_max3_u32 v110, v28, v29, v30
v_max_u32 v110, v110, v31
v_cmp_eq_u32 vcc, -1, v110
s_cbranch_vccnz Lpf_393
v_smfmac_f32_16x16x64_bf16 v[76:79], v[28:31], a[128:135], v126
v_smfmac_f32_16x16x64_bf16 v[80:83], v[28:31], a[136:143], v126
v_smfmac_f32_16x16x64_bf16 v[84:87], v[28:31], a[144:151], v126
s_branch Lps_380
Lpf_371:
buffer_load_dwordx4 v[36:39], v9, s[4:7], s40 offen offset:2048 sc1
Lps_394:
s_waitcnt vmcnt(2)
v_max3_u32 v110, v40, v41, v42
v_max_u32 v110, v110, v43
v_cmp_eq_u32 vcc, -1, v110
s_cbranch_vccnz Lpf_395
v_smfmac_f32_16x16x64_bf16 v[76:79], v[40:43], a[224:231], v126
v_smfmac_f32_16x16x64_bf16 v[80:83], v[40:43], a[232:239], v126
v_smfmac_f32_16x16x64_bf16 v[84:87], v[40:43], a[240:247], v126
Lps_396:
s_waitcnt vmcnt(1)
v_max3_u32 v110, v28, v29, v30
v_max_u32 v110, v110, v31
v_cmp_eq_u32 vcc, -1, v110
s_cbranch_vccnz Lpf_397
v_smfmac_f32_16x16x64_bf16 v[76:79], v[28:31], a[128:135], v126
v_smfmac_f32_16x16x64_bf16 v[80:83], v[28:31], a[136:143], v126
v_smfmac_f32_16x16x64_bf16 v[84:87], v[28:31], a[144:151], v126
s_branch Lps_384
Lpf_373:
buffer_load_dwordx4 v[40:43], v9, s[4:7], s40 offen offset:3072 sc1
Lps_398:
s_waitcnt vmcnt(1)
v_max3_u32 v110, v28, v29, v30
v_max_u32 v110, v110, v31
v_cmp_eq_u32 vcc, -1, v110
s_cbranch_vccnz Lpf_399
v_smfmac_f32_16x16x64_bf16 v[76:79], v[28:31], a[128:135], v126
v_smfmac_f32_16x16x64_bf16 v[80:83], v[28:31], a[136:143], v126
v_smfmac_f32_16x16x64_bf16 v[84:87], v[28:31], a[144:151], v126
s_branch Lps_386
Lpf_375:
buffer_load_dwordx4 v[28:31], v9, s[4:7], s40 offen offset:0 sc1
s_sub_u32 s37, s37, 1
s_cbranch_scc1 Lend_1
s_branch Lps_374
Lpf_377:
buffer_load_dwordx4 v[36:39], v9, s[4:7], s40 offen offset:2048 sc1
Lps_400:
s_waitcnt vmcnt(2)
v_max3_u32 v110, v40, v41, v42
v_max_u32 v110, v110, v43
v_cmp_eq_u32 vcc, -1, v110
s_cbranch_vccnz Lpf_401
v_smfmac_f32_16x16x64_bf16 v[76:79], v[40:43], a[224:231], v126
v_smfmac_f32_16x16x64_bf16 v[80:83], v[40:43], a[232:239], v126
v_smfmac_f32_16x16x64_bf16 v[84:87], v[40:43], a[240:247], v126
Lps_402:
s_waitcnt vmcnt(1)
v_max3_u32 v110, v32, v33, v34
v_max_u32 v110, v110, v35
v_cmp_eq_u32 vcc, -1, v110
s_cbranch_vccnz Lpf_403
v_smfmac_f32_16x16x64_bf16 v[76:79], v[32:35], a[160:167], v126
v_smfmac_f32_16x16x64_bf16 v[80:83], v[32:35], a[168:175], v126
v_smfmac_f32_16x16x64_bf16 v[84:87], v[32:35], a[176:183], v126
s_branch Lps_384
Lpf_379:
buffer_load_dwordx4 v[40:43], v9, s[4:7], s40 offen offset:3072 sc1
Lps_404:
s_waitcnt vmcnt(1)
v_max3_u32 v110, v32, v33, v34
v_max_u32 v110, v110, v35
v_cmp_eq_u32 vcc, -1, v110
s_cbranch_vccnz Lpf_405
v_smfmac_f32_16x16x64_bf16 v[76:79], v[32:35], a[160:167], v126
v_smfmac_f32_16x16x64_bf16 v[80:83], v[32:35], a[168:175], v126
v_smfmac_f32_16x16x64_bf16 v[84:87], v[32:35], a[176:183], v126
s_branch Lps_386
Lpf_381:
buffer_load_dwordx4 v[32:35], v9, s[4:7], s40 offen offset:1024 sc1
s_sub_u32 s37, s37, 1
s_cbranch_scc1 Lend_1
s_branch Lps_380
Lpf_383:
buffer_load_dwordx4 v[40:43], v9, s[4:7], s40 offen offset:3072 sc1
Lps_406:
s_waitcnt vmcnt(1)
v_max3_u32 v110, v36, v37, v38
v_max_u32 v110, v110, v39
v_cmp_eq_u32 vcc, -1, v110
s_cbranch_vccnz Lpf_407
v_smfmac_f32_16x16x64_bf16 v[76:79], v[36:39], a[192:199], v126
v_smfmac_f32_16x16x64_bf16 v[80:83], v[36:39], a[200:207], v126
v_smfmac_f32_16x16x64_bf16 v[84:87], v[36:39], a[208:215], v126
s_branch Lps_386
Lpf_385:
buffer_load_dwordx4 v[36:39], v9, s[4:7], s40 offen offset:2048 sc1
s_sub_u32 s37, s37, 1
s_cbranch_scc1 Lend_1
s_branch Lps_384
Lpf_387:
buffer_load_dwordx4 v[40:43], v9, s[4:7], s40 offen offset:3072 sc1
s_sub_u32 s37, s37, 1
s_cbranch_scc1 Lend_1
s_branch Lps_386
Lpf_389:
buffer_load_dwordx4 v[36:39], v9, s[4:7], s40 offen offset:2048 sc1
Lps_408:
s_waitcnt vmcnt(3)
v_max3_u32 v110, v40, v41, v42
v_max_u32 v110, v110, v43
v_cmp_eq_u32 vcc, -1, v110
s_cbranch_vccnz Lpf_409
v_smfmac_f32_16x16x64_bf16 v[76:79], v[40:43], a[224:231], v126
v_smfmac_f32_16x16x64_bf16 v[80:83], v[40:43], a[232:239], v126
v_smfmac_f32_16x16x64_bf16 v[84:87], v[40:43], a[240:247], v126
Lps_410:
s_waitcnt vmcnt(2)
v_max3_u32 v110, v28, v29, v30
v_max_u32 v110, v110, v31
v_cmp_eq_u32 vcc, -1, v110
s_cbranch_vccnz Lpf_411
v_smfmac_f32_16x16x64_bf16 v[76:79], v[28:31], a[128:135], v126
v_smfmac_f32_16x16x64_bf16 v[80:83], v[28:31], a[136:143], v126
v_smfmac_f32_16x16x64_bf16 v[84:87], v[28:31], a[144:151], v126
s_branch Lps_402
Lpf_391:
buffer_load_dwordx4 v[40:43], v9, s[4:7], s40 offen offset:3072 sc1
Lps_412:
s_waitcnt vmcnt(2)
v_max3_u32 v110, v28, v29, v30
v_max_u32 v110, v110, v31
v_cmp_eq_u32 vcc, -1, v110
s_cbranch_vccnz Lpf_413
v_smfmac_f32_16x16x64_bf16 v[76:79], v[28:31], a[128:135], v126
v_smfmac_f32_16x16x64_bf16 v[80:83], v[28:31], a[136:143], v126
v_smfmac_f32_16x16x64_bf16 v[84:87], v[28:31], a[144:151], v126
s_branch Lps_404
Lpf_393:
buffer_load_dwordx4 v[28:31], v9, s[4:7], s40 offen offset:0 sc1
s_sub_u32 s37, s37, 1
s_cbranch_scc1 Lend_1
Lps_414:
s_waitcnt vmcnt(1)
v_max3_u32 v110, v32, v33, v34
v_max_u32 v110, v110, v35
v_cmp_eq_u32 vcc, -1, v110
s_cbranch_vccnz Lpf_415
v_smfmac_f32_16x16x64_bf16 v[76:79], v[32:35], a[160:167], v126
v_smfmac_f32_16x16x64_bf16 v[80:83], v[32:35], a[168:175], v126
v_smfmac_f32_16x16x64_bf16 v[84:87], v[32:35], a[176:183], v126
s_branch Lps_374
Lpf_395:
buffer_load_dwordx4 v[40:43], v9, s[4:7], s40 offen offset:3072 sc1
Lps_416:
s_waitcnt vmcnt(2)
v_max3_u32 v110, v28, v29, v30
v_max_u32 v110, v110, v31
v_cmp_eq_u32 vcc, -1, v110
s_cbranch_vccnz Lpf_417
v_smfmac_f32_16x16x64_bf16 v[76:79], v[28:31], a[128:135], v126
v_smfmac_f32_16x16x64_bf16 v[80:83], v[28:31], a[136:143], v126
v_smfmac_f32_16x16x64_bf16 v[84:87], v[28:31], a[144:151], v126
s_branch Lps_406
Lpf_397:
buffer_load_dwordx4 v[28:31], v9, s[4:7], s40 offen offset:0 sc1
s_sub_u32 s37, s37, 1
s_cbranch_scc1 Lend_1
Lps_418:
s_waitcnt vmcnt(1)
v_max3_u32 v110, v36, v37, v38
v_max_u32 v110, v110, v39
v_cmp_eq_u32 vcc, -1, v110
s_cbranch_vccnz Lpf_419
v_smfmac_f32_16x16x64_bf16 v[76:79], v[36:39], a[192:199], v126
v_smfmac_f32_16x16x64_bf16 v[80:83], v[36:39], a[200:207], v126
v_smfmac_f32_16x16x64_bf16 v[84:87], v[36:39], a[208:215], v126
s_branch Lps_374
Lpf_399:
buffer_load_dwordx4 v[28:31], v9, s[4:7], s40 offen offset:0 sc1
s_sub_u32 s37, s37, 1
s_cbranch_scc1 Lend_1
s_branch Lps_372
Lpf_401:
buffer_load_dwordx4 v[40:43], v9, s[4:7], s40 offen offset:3072 sc1
Lps_420:
s_waitcnt vmcnt(2)
v_max3_u32 v110, v32, v33, v34
v_max_u32 v110, v110, v35
v_cmp_eq_u32 vcc, -1, v110
s_cbranch_vccnz Lpf_421
v_smfmac_f32_16x16x64_bf16 v[76:79], v[32:35], a[160:167], v126
v_smfmac_f32_16x16x64_bf16 v[80:83], v[32:35], a[168:175], v126
v_smfmac_f32_16x16x64_bf16 v[84:87], v[32:35], a[176:183], v126
s_branch Lps_406
Lpf_403:
buffer_load_dwordx4 v[32:35], v9, s[4:7], s40 offen offset:1024 sc1
s_sub_u32 s37, s37, 1
s_cbranch_scc1 Lend_1
Lps_422:
s_waitcnt vmcnt(1)
v_max3_u32 v110, v36, v37, v38
v_max_u32 v110, v110, v39
v_cmp_eq_u32 vcc, -1, v110
s_cbranch_vccnz Lpf_423
v_smfmac_f32_16x16x64_bf16 v[76:79], v[36:39], a[192:199], v126
v_smfmac_f32_16x16x64_bf16 v[80:83], v[36:39], a[200:207], v126
v_smfmac_f32_16x16x64_bf16 v[84:87], v[36:39], a[208:215], v126
s_branch Lps_380
Lpf_405:
buffer_load_dwordx4 v[32:35], v9, s[4:7], s40 offen offset:1024 sc1
s_sub_u32 s37, s37, 1
s_cbranch_scc1 Lend_1
s_branch Lps_378
Lpf_407:
buffer_load_dwordx4 v[36:39], v9, s[4:7], s40 offen offset:2048 sc1
s_sub_u32 s37, s37, 1
s_cbranch_scc1 Lend_1
s_branch Lps_382
Lpf_409:
buffer_load_dwordx4 v[40:43], v9, s[4:7], s40 offen offset:3072 sc1
Lps_424:
s_waitcnt vmcnt(3)
v_max3_u32 v110, v28, v29, v30
v_max_u32 v110, v110, v31
v_cmp_eq_u32 vcc, -1, v110
s_cbranch_vccnz Lpf_425
v_smfmac_f32_16x16x64_bf16 v[76:79], v[28:31], a[128:135], v126
v_smfmac_f32_16x16x64_bf16 v[80:83], v[28:31], a[136:143], v126
v_smfmac_f32_16x16x64_bf16 v[84:87], v[28:31], a[144:151], v126
s_branch Lps_420
Lpf_411:
buffer_load_dwordx4 v[28:31], v9, s[4:7], s40 offen offset:0 sc1
s_sub_u32 s37, s37, 1
s_cbranch_scc1 Lend_1
Lps_426:
s_waitcnt vmcnt(2)
v_max3_u32 v110, v32, v33, v34
v_max_u32 v110, v110, v35
v_cmp_eq_u32 vcc, -1, v110
s_cbranch_vccnz Lpf_427
v_smfmac_f32_16x16x64_bf16 v[76:79], v[32:35], a[160:167], v126
v_smfmac_f32_16x16x64_bf16 v[80:83], v[32:35], a[168:175], v126
v_smfmac_f32_16x16x64_bf16 v[84:87], v[32:35], a[176:183], v126
s_branch Lps_418
Lpf_413:
buffer_load_dwordx4 v[28:31], v9, s[4:7], s40 offen offset:0 sc1
s_sub_u32 s37, s37, 1
s_cbranch_scc1 Lend_1
Lps_428:
s_waitcnt vmcnt(2)
v_max3_u32 v110, v32, v33, v34
v_max_u32 v110, v110, v35
v_cmp_eq_u32 vcc, -1, v110
s_cbranch_vccnz Lpf_429
v_smfmac_f32_16x16x64_bf16 v[76:79], v[32:35], a[160:167], v126
v_smfmac_f32_16x16x64_bf16 v[80:83], v[32:35], a[168:175], v126
v_smfmac_f32_16x16x64_bf16 v[84:87], v[32:35], a[176:183], v126
s_branch Lps_372
Lpf_415:
buffer_load_dwordx4 v[32:35], v9, s[4:7], s40 offen offset:1024 sc1
s_branch Lps_392
Lpf_417:
buffer_load_dwordx4 v[28:31], v9, s[4:7], s40 offen offset:0 sc1
s_sub_u32 s37, s37, 1
s_cbranch_scc1 Lend_1
s_branch Lps_370
Lpf_419:
buffer_load_dwordx4 v[36:39], v9, s[4:7], s40 offen offset:2048 sc1
s_branch Lps_396
Lpf_421:
buffer_load_dwordx4 v[32:35], v9, s[4:7], s40 offen offset:1024 sc1
s_sub_u32 s37, s37, 1
s_cbranch_scc1 Lend_1
s_branch Lps_376
Lpf_423:
buffer_load_dwordx4 v[36:39], v9, s[4:7], s40 offen offset:2048 sc1
s_branch Lps_402
Lpf_425:
buffer_load_dwordx4 v[28:31], v9, s[4:7], s40 offen offset:0 sc1
s_sub_u32 s37, s37, 1
s_cbranch_scc1 Lend_1
s_branch Lps_368
Lpf_427:
buffer_load_dwordx4 v[32:35], v9, s[4:7], s40 offen offset:1024 sc1
Lps_430:
s_waitcnt vmcnt(2)
v_max3_u32 v110, v36, v37, v38
v_max_u32 v110, v110, v39
v_cmp_eq_u32 vcc, -1, v110
s_cbranch_vccnz Lpf_431
v_smfmac_f32_16x16x64_bf16 v[76:79], v[36:39], a[192:199], v126
v_smfmac_f32_16x16x64_bf16 v[80:83], v[36:39], a[200:207], v126
v_smfmac_f32_16x16x64_bf16 v[84:87], v[36:39], a[208:215], v126
s_branch Lps_392
Lpf_429:
buffer_load_dwordx4 v[32:35], v9, s[4:7], s40 offen offset:1024 sc1
s_branch Lps_390
Lpf_431:
buffer_load_dwordx4 v[36:39], v9, s[4:7], s40 offen offset:2048 sc1
s_branch Lps_410
Lkvo_sc1_288:
Lkvo_432:
buffer_load_dwordx4 v[28:31], v8, s[4:7], s40 offen offset:0 sc1
s_nop 11
buffer_load_dwordx4 v[32:35], v8, s[4:7], s40 offen offset:1024 sc1
s_nop 11
buffer_load_dwordx4 v[36:39], v8, s[4:7], s40 offen offset:2048 sc1
s_nop 11
buffer_load_dwordx4 v[40:43], v8, s[4:7], s40 offen offset:3072 sc1
s_nop 11
s_waitcnt vmcnt(3)
v_max3_u32 v110, v28, v29, v30
v_max_u32 v110, v110, v31
v_cmp_eq_u32 vcc, -1, v110
s_cbranch_vccnz Lpf_434
v_smfmac_f32_16x16x64_bf16 v[44:47], v[28:31], a[0:7], v126
v_smfmac_f32_16x16x64_bf16 v[48:51], v[28:31], a[8:15], v126
s_waitcnt vmcnt(2)
v_max3_u32 v110, v32, v33, v34
v_max_u32 v110, v110, v35
v_cmp_eq_u32 vcc, -1, v110
v_smfmac_f32_16x16x64_bf16 v[52:55], v[28:31], a[16:23], v126
v_smfmac_f32_16x16x64_bf16 v[60:63], v[28:31], v[128:135], v126
s_cbranch_vccnz Lpf_435
v_smfmac_f32_16x16x64_bf16 v[44:47], v[32:35], a[32:39], v126
v_smfmac_f32_16x16x64_bf16 v[48:51], v[32:35], a[40:47], v126
s_waitcnt vmcnt(1)
v_max3_u32 v110, v36, v37, v38
v_max_u32 v110, v110, v39
v_cmp_eq_u32 vcc, -1, v110
v_smfmac_f32_16x16x64_bf16 v[52:55], v[32:35], a[48:55], v126
v_smfmac_f32_16x16x64_bf16 v[60:63], v[32:35], v[160:167], v126
s_cbranch_vccnz Lpf_436
v_smfmac_f32_16x16x64_bf16 v[44:47], v[36:39], a[64:71], v126
v_smfmac_f32_16x16x64_bf16 v[48:51], v[36:39], a[72:79], v126
s_waitcnt vmcnt(0)
v_max3_u32 v110, v40, v41, v42
v_max_u32 v110, v110, v43
v_cmp_eq_u32 vcc, -1, v110
v_smfmac_f32_16x16x64_bf16 v[52:55], v[36:39], a[80:87], v126
v_smfmac_f32_16x16x64_bf16 v[60:63], v[36:39], v[192:199], v126
s_cbranch_vccnz Lpf_437
v_smfmac_f32_16x16x64_bf16 v[44:47], v[40:43], a[96:103], v126
s_nop 1
v_smfmac_f32_16x16x64_bf16 v[48:51], v[40:43], a[104:111], v126
s_nop 1
v_smfmac_f32_16x16x64_bf16 v[52:55], v[40:43], a[112:119], v126
s_nop 1
v_add_f32 v92, v44, v46
v_add_f32 v93, v45, v47
v_smfmac_f32_16x16x64_bf16 v[56:59], v[28:31], a[24:31], v126
v_add_f32 v94, v48, v50
v_add_f32 v95, v49, v51
ds_write_b64 v24, v[92:93] offset:0
v_add_f32 v96, v52, v54
v_add_f32 v97, v53, v55
ds_write_b64 v25, v[94:95] offset:0
v_smfmac_f32_16x16x64_bf16 v[56:59], v[32:35], a[56:63], v126
ds_write_b64 v26, v[96:97] offset:0
v_smfmac_f32_16x16x64_bf16 v[56:59], v[36:39], a[88:95], v126
v_smfmac_f32_16x16x64_bf16 v[56:59], v[40:43], a[120:127], v126
v_smfmac_f32_16x16x64_bf16 v[60:63], v[40:43], v[224:231], v126
Lpd_433:
v_smfmac_f32_16x16x64_bf16 v[64:67], v[28:31], v[136:143], v126
v_smfmac_f32_16x16x64_bf16 v[64:67], v[32:35], v[168:175], v126
s_waitcnt lgkmcnt(0)
s_barrier
ds_read_b64 v[100:101], v0 offset:0
ds_read_b64 v[102:103], v0 offset:512
ds_read_b64 v[104:105], v0 offset:1024
s_nop 2
v_add_f32 v98, v56, v58
v_add_f32 v99, v57, v59
v_smfmac_f32_16x16x64_bf16 v[64:67], v[36:39], v[200:207], v126
v_smfmac_f32_16x16x64_bf16 v[64:67], v[40:43], v[232:239], v126
v_smfmac_f32_16x16x64_bf16 v[68:71], v[28:31], v[144:151], v126
v_smfmac_f32_16x16x64_bf16 v[68:71], v[32:35], v[176:183], v126
s_waitcnt lgkmcnt(0)
v_add_f32 v100, v100, v98
v_add_f32 v102, v102, v104
v_add_f32 v101, v101, v99
v_add_f32 v103, v103, v105
v_add_f32 v100, v100, v102
v_add_f32 v101, v101, v103
v_cvt_pk_bf16_f32 v108, v100, v101
s_nop 1
v_mov_b32_dpp v109, v108 quad_perm:[1,0,3,2] row_mask:0xf bank_mask:0xf
v_perm_b32 v109, v109, v108, v3
buffer_store_dword v109, v11, s[4:7], s40 offen sc1
v_smfmac_f32_16x16x64_bf16 v[68:71], v[36:39], v[208:215], v126
v_smfmac_f32_16x16x64_bf16 v[68:71], v[40:43], v[240:247], v126
s_nop 3
v_smfmac_f32_16x16x64_bf16 v[72:75], v[28:31], v[152:159], v126
v_add_f32 v92, v60, v62
v_add_f32 v93, v61, v63
v_smfmac_f32_16x16x64_bf16 v[72:75], v[32:35], v[184:191], v126
v_add_f32 v94, v64, v66
v_add_f32 v95, v65, v67
ds_write_b64 v24, v[92:93] offset:6144
v_smfmac_f32_16x16x64_bf16 v[72:75], v[36:39], v[216:223], v126
v_add_f32 v96, v68, v70
v_add_f32 v97, v69, v71
ds_write_b64 v25, v[94:95] offset:6144
ds_write_b64 v26, v[96:97] offset:6144
v_smfmac_f32_16x16x64_bf16 v[72:75], v[40:43], v[248:255], v126
s_waitcnt lgkmcnt(0)
s_barrier
ds_read_b64 v[100:101], v0 offset:6144
ds_read_b64 v[102:103], v0 offset:6656
ds_read_b64 v[104:105], v0 offset:7168
s_nop 2
v_add_f32 v98, v72, v74
v_add_f32 v99, v73, v75
s_waitcnt lgkmcnt(0)
v_pk_add_f32 v[100:101], v[100:101], v[98:99]
v_pk_add_f32 v[102:103], v[102:103], v[104:105]
v_pk_add_f32 v[100:101], v[100:101], v[102:103]
v_cvt_pk_bf16_f32 v108, v100, v101
buffer_store_dword v108, v27, s[4:7], s40 offen sc1
s_cmp_eq_u32 s36, 63
s_cbranch_scc1 Lend_1
v_add_u32 v7, 1, v7
s_and_b32 s38, s36, 3
s_lshl_b32 s84, s38, 18
s_add_u32 s84, s84, s46
s_add_u32 s85, s84, 0x100000
s_mov_b64 exec, 3
buffer_load_dword v112, v1, s[4:7], s59 offen sc1
s_nop 5
buffer_load_dword v113, v1, s[4:7], s59 offen sc1
s_nop 5
buffer_load_dword v114, v1, s[4:7], s59 offen sc1
Lft_439:
s_waitcnt vmcnt(2)
v_cmp_gt_u32 vcc, s26, v112
buffer_load_dword v112, v1, s[4:7], s59 offen sc1
s_cbranch_vccz Lfg_438
s_waitcnt vmcnt(2)
v_cmp_gt_u32 vcc, s26, v113
buffer_load_dword v113, v1, s[4:7], s59 offen sc1
s_cbranch_vccz Lfg_438
s_waitcnt vmcnt(2)
v_cmp_gt_u32 vcc, s26, v114
buffer_load_dword v114, v1, s[4:7], s59 offen sc1
s_cbranch_vccz Lfg_438
s_sub_u32 s37, s37, 1
s_cbranch_scc1 Lend_1
s_branch Lft_439
Lfg_438:
s_mov_b64 exec, -1
buffer_load_dwordx4 v[28:31], v9, s[4:7], s40 offen offset:0 sc1
s_nop 11
buffer_load_dwordx4 v[32:35], v9, s[4:7], s40 offen offset:1024 sc1
s_nop 11
buffer_load_dwordx4 v[36:39], v9, s[4:7], s40 offen offset:2048 sc1
s_nop 11
buffer_load_dwordx4 v[40:43], v9, s[4:7], s40 offen offset:3072 sc1
s_nop 11
s_waitcnt vmcnt(3)
v_max3_u32 v110, v28, v29, v30
v_max_u32 v110, v110, v31
v_cmp_eq_u32 vcc, -1, v110
s_cbranch_vccnz Lpf_441
v_smfmac_f32_16x16x64_bf16 v[76:79], v[28:31], a[128:135], v126
s_waitcnt vmcnt(2)
v_max3_u32 v110, v32, v33, v34
v_max_u32 v110, v110, v35
v_cmp_eq_u32 vcc, -1, v110
v_smfmac_f32_16x16x64_bf16 v[80:83], v[28:31], a[136:143], v126
v_smfmac_f32_16x16x64_bf16 v[84:87], v[28:31], a[144:151], v126
s_cbranch_vccnz Lpf_442
v_smfmac_f32_16x16x64_bf16 v[76:79], v[32:35], a[160:167], v126
s_waitcnt vmcnt(1)
v_max3_u32 v110, v36, v37, v38
v_max_u32 v110, v110, v39
v_cmp_eq_u32 vcc, -1, v110
v_smfmac_f32_16x16x64_bf16 v[80:83], v[32:35], a[168:175], v126
v_smfmac_f32_16x16x64_bf16 v[84:87], v[32:35], a[176:183], v126
s_cbranch_vccnz Lpf_443
v_smfmac_f32_16x16x64_bf16 v[76:79], v[36:39], a[192:199], v126
s_waitcnt vmcnt(0)
v_max3_u32 v110, v40, v41, v42
v_max_u32 v110, v110, v43
v_cmp_eq_u32 vcc, -1, v110
v_smfmac_f32_16x16x64_bf16 v[80:83], v[36:39], a[200:207], v126
v_smfmac_f32_16x16x64_bf16 v[84:87], v[36:39], a[208:215], v126
s_cbranch_vccnz Lpf_444
v_smfmac_f32_16x16x64_bf16 v[76:79], v[40:43], a[224:231], v126
s_nop 1
v_smfmac_f32_16x16x64_bf16 v[80:83], v[40:43], a[232:239], v126
s_nop 1
v_smfmac_f32_16x16x64_bf16 v[84:87], v[40:43], a[240:247], v126
s_nop 1
v_add_f32 v92, v76, v78
v_add_f32 v93, v77, v79
v_smfmac_f32_16x16x64_bf16 v[88:91], v[28:31], a[152:159], v126
v_add_f32 v94, v80, v82
v_add_f32 v95, v81, v83
ds_write_b64 v24, v[92:93] offset:12288
v_add_f32 v96, v84, v86
v_add_f32 v97, v85, v87
ds_write_b64 v25, v[94:95] offset:12288
v_smfmac_f32_16x16x64_bf16 v[88:91], v[32:35], a[184:191], v126
ds_write_b64 v26, v[96:97] offset:12288
v_smfmac_f32_16x16x64_bf16 v[88:91], v[36:39], a[216:223], v126
v_smfmac_f32_16x16x64_bf16 v[88:91], v[40:43], a[248:255], v126
Lpd_440:
s_waitcnt lgkmcnt(0)
s_barrier
ds_read_b64 v[100:101], v0 offset:12288
ds_read_b64 v[102:103], v0 offset:12800
ds_read_b64 v[104:105], v0 offset:13312
s_nop 2
v_add_f32 v98, v88, v90
v_add_f32 v99, v89, v91
s_waitcnt lgkmcnt(0)
v_pk_add_f32 v[100:101], v[100:101], v[98:99]
v_pk_add_f32 v[102:103], v[102:103], v[104:105]
v_pk_add_f32 v[100:101], v[100:101], v[102:103]
v_cvt_pk_bf16_f32 v108, v100, v101
buffer_store_dword v108, v12, s[4:7], s84 offen sc1
buffer_store_dword v108, v12, s[4:7], s85 offen sc1
s_waitcnt vmcnt(2)
buffer_store_dwordx2 v[4:5], v10, s[4:7], s42 offen sc1
buffer_store_dword v4, v11, s[4:7], s42 offen sc1
buffer_store_dword v4, v27, s[4:7], s42 offen sc1
v_mov_b32 v112, v108
v_mov_b32 v116, v108
v_mov_b32 v120, v108
s_add_u32 s36, s36, 1
s_and_b32 s38, s36, 3
s_lshl_b32 s39, s38, 16
s_add_u32 s40, s39, s45
s_xor_b32 s42, s40, 0x20000
s_add_u32 s26, s36, 1
s_nop 15
s_nop 15
s_nop 15
s_nop 15
s_nop 15
buffer_load_dword v113, v13, s[4:7], s84 offen sc1
buffer_load_dword v114, v14, s[4:7], s84 offen sc1
buffer_load_dword v115, v15, s[4:7], s84 offen sc1
v_pk_mul_f32 v[44:45], 0, 0
v_pk_mul_f32 v[46:47], 0, 0
v_pk_mul_f32 v[48:49], 0, 0
v_pk_mul_f32 v[50:51], 0, 0
v_pk_mul_f32 v[52:53], 0, 0
v_pk_mul_f32 v[54:55], 0, 0
v_pk_mul_f32 v[56:57], 0, 0
v_pk_mul_f32 v[58:59], 0, 0
v_pk_mul_f32 v[60:61], 0, 0
v_pk_mul_f32 v[62:63], 0, 0
v_pk_mul_f32 v[64:65], 0, 0
v_pk_mul_f32 v[66:67], 0, 0
v_pk_mul_f32 v[68:69], 0, 0
v_pk_mul_f32 v[70:71], 0, 0
v_pk_mul_f32 v[72:73], 0, 0
v_pk_mul_f32 v[74:75], 0, 0
v_pk_mul_f32 v[76:77], 0, 0
v_pk_mul_f32 v[78:79], 0, 0
v_pk_mul_f32 v[80:81], 0, 0
v_pk_mul_f32 v[82:83], 0, 0
v_pk_mul_f32 v[84:85], 0, 0
v_pk_mul_f32 v[86:87], 0, 0
v_pk_mul_f32 v[88:89], 0, 0
v_pk_mul_f32 v[90:91], 0, 0
buffer_load_dword v117, v13, s[4:7], s85 offen sc1
buffer_load_dword v118, v14, s[4:7], s85 offen sc1
buffer_load_dword v119, v15, s[4:7], s85 offen sc1
buffer_store_dword v7, v2, s[4:7], s59 offen sc1
s_nop 15
s_nop 15
s_nop 15
buffer_load_dword v121, v13, s[4:7], s84 offen sc1
buffer_load_dword v122, v14, s[4:7], s84 offen sc1
buffer_load_dword v123, v15, s[4:7], s84 offen sc1
s_waitcnt vmcnt(7)
v_mfma_f32_16x16x32_bf16 v[100:103], v[112:115], v[20:23], 0
v_max3_u32 v110, v113, v114, v115
v_cmp_eq_u32 vcc, -1, v110
s_nop 5
v_cvt_pk_bf16_f32 v106, v100, v101
v_cvt_pk_bf16_f32 v107, v102, v103
s_cbranch_vccnz Lx2_445
Lxs_446:
buffer_store_dwordx2 v[106:107], v10, s[4:7], s40 offen sc1
s_nop 15
s_nop 15
s_nop 11
s_branch Lkvo_432
Lx2_445:
buffer_load_dword v113, v13, s[4:7], s85 offen sc1
buffer_load_dword v114, v14, s[4:7], s85 offen sc1
buffer_load_dword v115, v15, s[4:7], s85 offen sc1
s_waitcnt vmcnt(6)
v_mfma_f32_16x16x32_bf16 v[100:103], v[116:119], v[20:23], 0
v_max3_u32 v110, v117, v118, v119
v_cmp_eq_u32 vcc, -1, v110
s_nop 5
v_cvt_pk_bf16_f32 v106, v100, v101
v_cvt_pk_bf16_f32 v107, v102, v103
s_cbranch_vccz Lxs_446
buffer_load_dword v117, v13, s[4:7], s84 offen sc1
buffer_load_dword v118, v14, s[4:7], s84 offen sc1
buffer_load_dword v119, v15, s[4:7], s84 offen sc1
s_waitcnt vmcnt(6)
v_mfma_f32_16x16x32_bf16 v[100:103], v[120:123], v[20:23], 0
v_max3_u32 v110, v121, v122, v123
v_cmp_eq_u32 vcc, -1, v110
s_nop 5
v_cvt_pk_bf16_f32 v106, v100, v101
v_cvt_pk_bf16_f32 v107, v102, v103
s_cbranch_vccz Lxs_446
buffer_load_dword v121, v13, s[4:7], s85 offen sc1
buffer_load_dword v122, v14, s[4:7], s85 offen sc1
buffer_load_dword v123, v15, s[4:7], s85 offen sc1
s_waitcnt vmcnt(6)
v_mfma_f32_16x16x32_bf16 v[100:103], v[112:115], v[20:23], 0
v_max3_u32 v110, v113, v114, v115
v_cmp_eq_u32 vcc, -1, v110
s_nop 5
v_cvt_pk_bf16_f32 v106, v100, v101
v_cvt_pk_bf16_f32 v107, v102, v103
s_cbranch_vccz Lxs_446
buffer_load_dword v113, v13, s[4:7], s84 offen sc1
buffer_load_dword v114, v14, s[4:7], s84 offen sc1
buffer_load_dword v115, v15, s[4:7], s84 offen sc1
s_waitcnt vmcnt(6)
v_mfma_f32_16x16x32_bf16 v[100:103], v[116:119], v[20:23], 0
v_max3_u32 v110, v117, v118, v119
v_cmp_eq_u32 vcc, -1, v110
s_nop 5
v_cvt_pk_bf16_f32 v106, v100, v101
v_cvt_pk_bf16_f32 v107, v102, v103
s_cbranch_vccz Lxs_446
buffer_load_dword v117, v13, s[4:7], s85 offen sc1
buffer_load_dword v118, v14, s[4:7], s85 offen sc1
buffer_load_dword v119, v15, s[4:7], s85 offen sc1
s_waitcnt vmcnt(6)
v_mfma_f32_16x16x32_bf16 v[100:103], v[120:123], v[20:23], 0
v_max3_u32 v110, v121, v122, v123
v_cmp_eq_u32 vcc, -1, v110
s_nop 5
v_cvt_pk_bf16_f32 v106, v100, v101
v_cvt_pk_bf16_f32 v107, v102, v103
s_cbranch_vccz Lxs_446
buffer_load_dword v121, v13, s[4:7], s84 offen sc1
buffer_load_dword v122, v14, s[4:7], s84 offen sc1
buffer_load_dword v123, v15, s[4:7], s84 offen sc1
s_waitcnt vmcnt(6)
v_mfma_f32_16x16x32_bf16 v[100:103], v[112:115], v[20:23], 0
v_max3_u32 v110, v113, v114, v115
v_cmp_eq_u32 vcc, -1, v110
s_nop 5
v_cvt_pk_bf16_f32 v106, v100, v101
v_cvt_pk_bf16_f32 v107, v102, v103
s_cbranch_vccz Lxs_446
s_sub_u32 s37, s37, 1
s_cbranch_scc1 Lend_1
s_branch Lx2_445
Lpf_434:
buffer_load_dwordx4 v[28:31], v8, s[4:7], s40 offen offset:0 sc1
s_sub_u32 s37, s37, 1
s_cbranch_scc1 Lend_1
Lps_447:
s_waitcnt vmcnt(3)
v_max3_u32 v110, v32, v33, v34
v_max_u32 v110, v110, v35
v_cmp_eq_u32 vcc, -1, v110
s_cbranch_vccnz Lpf_448
v_smfmac_f32_16x16x64_bf16 v[44:47], v[32:35], a[32:39], v126
v_smfmac_f32_16x16x64_bf16 v[48:51], v[32:35], a[40:47], v126
v_smfmac_f32_16x16x64_bf16 v[52:55], v[32:35], a[48:55], v126
v_smfmac_f32_16x16x64_bf16 v[60:63], v[32:35], v[160:167], v126
Lps_449:
s_waitcnt vmcnt(2)
v_max3_u32 v110, v36, v37, v38
v_max_u32 v110, v110, v39
v_cmp_eq_u32 vcc, -1, v110
s_cbranch_vccnz Lpf_450
v_smfmac_f32_16x16x64_bf16 v[44:47], v[36:39], a[64:71], v126
v_smfmac_f32_16x16x64_bf16 v[48:51], v[36:39], a[72:79], v126
v_smfmac_f32_16x16x64_bf16 v[52:55], v[36:39], a[80:87], v126
v_smfmac_f32_16x16x64_bf16 v[60:63], v[36:39], v[192:199], v126
Lps_451:
s_waitcnt vmcnt(1)
v_max3_u32 v110, v40, v41, v42
v_max_u32 v110, v110, v43
v_cmp_eq_u32 vcc, -1, v110
s_cbranch_vccnz Lpf_452
v_smfmac_f32_16x16x64_bf16 v[44:47], v[40:43], a[96:103], v126
v_smfmac_f32_16x16x64_bf16 v[48:51], v[40:43], a[104:111], v126
v_smfmac_f32_16x16x64_bf16 v[52:55], v[40:43], a[112:119], v126
v_smfmac_f32_16x16x64_bf16 v[60:63], v[40:43], v[224:231], v126
Lps_453:
s_waitcnt vmcnt(0)
v_max3_u32 v110, v28, v29, v30
v_max_u32 v110, v110, v31
v_cmp_eq_u32 vcc, -1, v110
s_cbranch_vccnz Lpf_454
v_smfmac_f32_16x16x64_bf16 v[44:47], v[28:31], a[0:7], v126
s_nop 1
v_smfmac_f32_16x16x64_bf16 v[48:51], v[28:31], a[8:15], v126
s_nop 1
v_smfmac_f32_16x16x64_bf16 v[52:55], v[28:31], a[16:23], v126
s_nop 1
v_add_f32 v92, v44, v46
v_add_f32 v93, v45, v47
v_smfmac_f32_16x16x64_bf16 v[56:59], v[28:31], a[24:31], v126
v_add_f32 v94, v48, v50
v_add_f32 v95, v49, v51
ds_write_b64 v24, v[92:93] offset:0
v_add_f32 v96, v52, v54
v_add_f32 v97, v53, v55
ds_write_b64 v25, v[94:95] offset:0
v_smfmac_f32_16x16x64_bf16 v[56:59], v[32:35], a[56:63], v126
ds_write_b64 v26, v[96:97] offset:0
v_smfmac_f32_16x16x64_bf16 v[56:59], v[36:39], a[88:95], v126
v_smfmac_f32_16x16x64_bf16 v[56:59], v[40:43], a[120:127], v126
v_smfmac_f32_16x16x64_bf16 v[60:63], v[28:31], v[128:135], v126
s_branch Lpd_433
Lpf_435:
buffer_load_dwordx4 v[32:35], v8, s[4:7], s40 offen offset:1024 sc1
s_sub_u32 s37, s37, 1
s_cbranch_scc1 Lend_1
Lps_455:
s_waitcnt vmcnt(2)
v_max3_u32 v110, v36, v37, v38
v_max_u32 v110, v110, v39
v_cmp_eq_u32 vcc, -1, v110
s_cbranch_vccnz Lpf_456
v_smfmac_f32_16x16x64_bf16 v[44:47], v[36:39], a[64:71], v126
v_smfmac_f32_16x16x64_bf16 v[48:51], v[36:39], a[72:79], v126
v_smfmac_f32_16x16x64_bf16 v[52:55], v[36:39], a[80:87], v126
v_smfmac_f32_16x16x64_bf16 v[60:63], v[36:39], v[192:199], v126
Lps_457:
s_waitcnt vmcnt(1)
v_max3_u32 v110, v40, v41, v42
v_max_u32 v110, v110, v43
v_cmp_eq_u32 vcc, -1, v110
s_cbranch_vccnz Lpf_458
v_smfmac_f32_16x16x64_bf16 v[44:47], v[40:43], a[96:103], v126
v_smfmac_f32_16x16x64_bf16 v[48:51], v[40:43], a[104:111], v126
v_smfmac_f32_16x16x64_bf16 v[52:55], v[40:43], a[112:119], v126
v_smfmac_f32_16x16x64_bf16 v[60:63], v[40:43], v[224:231], v126
Lps_459:
s_waitcnt vmcnt(0)
v_max3_u32 v110, v32, v33, v34
v_max_u32 v110, v110, v35
v_cmp_eq_u32 vcc, -1, v110
s_cbranch_vccnz Lpf_460
v_smfmac_f32_16x16x64_bf16 v[44:47], v[32:35], a[32:39], v126
s_nop 1
v_smfmac_f32_16x16x64_bf16 v[48:51], v[32:35], a[40:47], v126
s_nop 1
v_smfmac_f32_16x16x64_bf16 v[52:55], v[32:35], a[48:55], v126
s_nop 1
v_add_f32 v92, v44, v46
v_add_f32 v93, v45, v47
v_smfmac_f32_16x16x64_bf16 v[56:59], v[28:31], a[24:31], v126
v_add_f32 v94, v48, v50
v_add_f32 v95, v49, v51
ds_write_b64 v24, v[92:93] offset:0
v_add_f32 v96, v52, v54
v_add_f32 v97, v53, v55
ds_write_b64 v25, v[94:95] offset:0
v_smfmac_f32_16x16x64_bf16 v[56:59], v[32:35], a[56:63], v126
ds_write_b64 v26, v[96:97] offset:0
v_smfmac_f32_16x16x64_bf16 v[56:59], v[36:39], a[88:95], v126
v_smfmac_f32_16x16x64_bf16 v[56:59], v[40:43], a[120:127], v126
v_smfmac_f32_16x16x64_bf16 v[60:63], v[32:35], v[160:167], v126
s_branch Lpd_433
Lpf_436:
buffer_load_dwordx4 v[36:39], v8, s[4:7], s40 offen offset:2048 sc1
s_sub_u32 s37, s37, 1
s_cbranch_scc1 Lend_1
Lps_461:
s_waitcnt vmcnt(1)
v_max3_u32 v110, v40, v41, v42
v_max_u32 v110, v110, v43
v_cmp_eq_u32 vcc, -1, v110
s_cbranch_vccnz Lpf_462
v_smfmac_f32_16x16x64_bf16 v[44:47], v[40:43], a[96:103], v126
v_smfmac_f32_16x16x64_bf16 v[48:51], v[40:43], a[104:111], v126
v_smfmac_f32_16x16x64_bf16 v[52:55], v[40:43], a[112:119], v126
v_smfmac_f32_16x16x64_bf16 v[60:63], v[40:43], v[224:231], v126
Lps_463:
s_waitcnt vmcnt(0)
v_max3_u32 v110, v36, v37, v38
v_max_u32 v110, v110, v39
v_cmp_eq_u32 vcc, -1, v110
s_cbranch_vccnz Lpf_464
v_smfmac_f32_16x16x64_bf16 v[44:47], v[36:39], a[64:71], v126
s_nop 1
v_smfmac_f32_16x16x64_bf16 v[48:51], v[36:39], a[72:79], v126
s_nop 1
v_smfmac_f32_16x16x64_bf16 v[52:55], v[36:39], a[80:87], v126
s_nop 1
v_add_f32 v92, v44, v46
v_add_f32 v93, v45, v47
v_smfmac_f32_16x16x64_bf16 v[56:59], v[28:31], a[24:31], v126
v_add_f32 v94, v48, v50
v_add_f32 v95, v49, v51
ds_write_b64 v24, v[92:93] offset:0
v_add_f32 v96, v52, v54
v_add_f32 v97, v53, v55
ds_write_b64 v25, v[94:95] offset:0
v_smfmac_f32_16x16x64_bf16 v[56:59], v[32:35], a[56:63], v126
ds_write_b64 v26, v[96:97] offset:0
v_smfmac_f32_16x16x64_bf16 v[56:59], v[36:39], a[88:95], v126
v_smfmac_f32_16x16x64_bf16 v[56:59], v[40:43], a[120:127], v126
v_smfmac_f32_16x16x64_bf16 v[60:63], v[36:39], v[192:199], v126
s_branch Lpd_433
Lpf_437:
buffer_load_dwordx4 v[40:43], v8, s[4:7], s40 offen offset:3072 sc1
s_sub_u32 s37, s37, 1
s_cbranch_scc1 Lend_1
Lps_465:
s_waitcnt vmcnt(0)
v_max3_u32 v110, v40, v41, v42
v_max_u32 v110, v110, v43
v_cmp_eq_u32 vcc, -1, v110
s_cbranch_vccnz Lpf_466
v_smfmac_f32_16x16x64_bf16 v[44:47], v[40:43], a[96:103], v126
s_nop 1
v_smfmac_f32_16x16x64_bf16 v[48:51], v[40:43], a[104:111], v126
s_nop 1
v_smfmac_f32_16x16x64_bf16 v[52:55], v[40:43], a[112:119], v126
s_nop 1
v_add_f32 v92, v44, v46
v_add_f32 v93, v45, v47
v_smfmac_f32_16x16x64_bf16 v[56:59], v[28:31], a[24:31], v126
v_add_f32 v94, v48, v50
v_add_f32 v95, v49, v51
ds_write_b64 v24, v[92:93] offset:0
v_add_f32 v96, v52, v54
v_add_f32 v97, v53, v55
ds_write_b64 v25, v[94:95] offset:0
v_smfmac_f32_16x16x64_bf16 v[56:59], v[32:35], a[56:63], v126
ds_write_b64 v26, v[96:97] offset:0
v_smfmac_f32_16x16x64_bf16 v[56:59], v[36:39], a[88:95], v126
v_smfmac_f32_16x16x64_bf16 v[56:59], v[40:43], a[120:127], v126
v_smfmac_f32_16x16x64_bf16 v[60:63], v[40:43], v[224:231], v126
s_branch Lpd_433
Lpf_448:
buffer_load_dwordx4 v[32:35], v8, s[4:7], s40 offen offset:1024 sc1
Lps_467:
s_waitcnt vmcnt(3)
v_max3_u32 v110, v36, v37, v38
v_max_u32 v110, v110, v39
v_cmp_eq_u32 vcc, -1, v110
s_cbranch_vccnz Lpf_468
v_smfmac_f32_16x16x64_bf16 v[44:47], v[36:39], a[64:71], v126
v_smfmac_f32_16x16x64_bf16 v[48:51], v[36:39], a[72:79], v126
v_smfmac_f32_16x16x64_bf16 v[52:55], v[36:39], a[80:87], v126
v_smfmac_f32_16x16x64_bf16 v[60:63], v[36:39], v[192:199], v126
Lps_469:
s_waitcnt vmcnt(2)
v_max3_u32 v110, v40, v41, v42
v_max_u32 v110, v110, v43
v_cmp_eq_u32 vcc, -1, v110
s_cbranch_vccnz Lpf_470
v_smfmac_f32_16x16x64_bf16 v[44:47], v[40:43], a[96:103], v126
v_smfmac_f32_16x16x64_bf16 v[48:51], v[40:43], a[104:111], v126
v_smfmac_f32_16x16x64_bf16 v[52:55], v[40:43], a[112:119], v126
v_smfmac_f32_16x16x64_bf16 v[60:63], v[40:43], v[224:231], v126
Lps_471:
s_waitcnt vmcnt(1)
v_max3_u32 v110, v28, v29, v30
v_max_u32 v110, v110, v31
v_cmp_eq_u32 vcc, -1, v110
s_cbranch_vccnz Lpf_472
v_smfmac_f32_16x16x64_bf16 v[44:47], v[28:31], a[0:7], v126
v_smfmac_f32_16x16x64_bf16 v[48:51], v[28:31], a[8:15], v126
v_smfmac_f32_16x16x64_bf16 v[52:55], v[28:31], a[16:23], v126
v_smfmac_f32_16x16x64_bf16 v[60:63], v[28:31], v[128:135], v126
s_branch Lps_459
Lpf_450:
buffer_load_dwordx4 v[36:39], v8, s[4:7], s40 offen offset:2048 sc1
Lps_473:
s_waitcnt vmcnt(2)
v_max3_u32 v110, v40, v41, v42
v_max_u32 v110, v110, v43
v_cmp_eq_u32 vcc, -1, v110
s_cbranch_vccnz Lpf_474
v_smfmac_f32_16x16x64_bf16 v[44:47], v[40:43], a[96:103], v126
v_smfmac_f32_16x16x64_bf16 v[48:51], v[40:43], a[104:111], v126
v_smfmac_f32_16x16x64_bf16 v[52:55], v[40:43], a[112:119], v126
v_smfmac_f32_16x16x64_bf16 v[60:63], v[40:43], v[224:231], v126
Lps_475:
s_waitcnt vmcnt(1)
v_max3_u32 v110, v28, v29, v30
v_max_u32 v110, v110, v31
v_cmp_eq_u32 vcc, -1, v110
s_cbranch_vccnz Lpf_476
v_smfmac_f32_16x16x64_bf16 v[44:47], v[28:31], a[0:7], v126
v_smfmac_f32_16x16x64_bf16 v[48:51], v[28:31], a[8:15], v126
v_smfmac_f32_16x16x64_bf16 v[52:55], v[28:31], a[16:23], v126
v_smfmac_f32_16x16x64_bf16 v[60:63], v[28:31], v[128:135], v126
s_branch Lps_463
Lpf_452:
buffer_load_dwordx4 v[40:43], v8, s[4:7], s40 offen offset:3072 sc1
Lps_477:
s_waitcnt vmcnt(1)
v_max3_u32 v110, v28, v29, v30
v_max_u32 v110, v110, v31
v_cmp_eq_u32 vcc, -1, v110
s_cbranch_vccnz Lpf_478
v_smfmac_f32_16x16x64_bf16 v[44:47], v[28:31], a[0:7], v126
v_smfmac_f32_16x16x64_bf16 v[48:51], v[28:31], a[8:15], v126
v_smfmac_f32_16x16x64_bf16 v[52:55], v[28:31], a[16:23], v126
v_smfmac_f32_16x16x64_bf16 v[60:63], v[28:31], v[128:135], v126
s_branch Lps_465
Lpf_454:
buffer_load_dwordx4 v[28:31], v8, s[4:7], s40 offen offset:0 sc1
s_sub_u32 s37, s37, 1
s_cbranch_scc1 Lend_1
s_branch Lps_453
Lpf_456:
buffer_load_dwordx4 v[36:39], v8, s[4:7], s40 offen offset:2048 sc1
Lps_479:
s_waitcnt vmcnt(2)
v_max3_u32 v110, v40, v41, v42
v_max_u32 v110, v110, v43
v_cmp_eq_u32 vcc, -1, v110
s_cbranch_vccnz Lpf_480
v_smfmac_f32_16x16x64_bf16 v[44:47], v[40:43], a[96:103], v126
v_smfmac_f32_16x16x64_bf16 v[48:51], v[40:43], a[104:111], v126
v_smfmac_f32_16x16x64_bf16 v[52:55], v[40:43], a[112:119], v126
v_smfmac_f32_16x16x64_bf16 v[60:63], v[40:43], v[224:231], v126
Lps_481:
s_waitcnt vmcnt(1)
v_max3_u32 v110, v32, v33, v34
v_max_u32 v110, v110, v35
v_cmp_eq_u32 vcc, -1, v110
s_cbranch_vccnz Lpf_482
v_smfmac_f32_16x16x64_bf16 v[44:47], v[32:35], a[32:39], v126
v_smfmac_f32_16x16x64_bf16 v[48:51], v[32:35], a[40:47], v126
v_smfmac_f32_16x16x64_bf16 v[52:55], v[32:35], a[48:55], v126
v_smfmac_f32_16x16x64_bf16 v[60:63], v[32:35], v[160:167], v126
s_branch Lps_463
Lpf_458:
buffer_load_dwordx4 v[40:43], v8, s[4:7], s40 offen offset:3072 sc1
Lps_483:
s_waitcnt vmcnt(1)
v_max3_u32 v110, v32, v33, v34
v_max_u32 v110, v110, v35
v_cmp_eq_u32 vcc, -1, v110
s_cbranch_vccnz Lpf_484
v_smfmac_f32_16x16x64_bf16 v[44:47], v[32:35], a[32:39], v126
v_smfmac_f32_16x16x64_bf16 v[48:51], v[32:35], a[40:47], v126
v_smfmac_f32_16x16x64_bf16 v[52:55], v[32:35], a[48:55], v126
v_smfmac_f32_16x16x64_bf16 v[60:63], v[32:35], v[160:167], v126
s_branch Lps_465
Lpf_460:
buffer_load_dwordx4 v[32:35], v8, s[4:7], s40 offen offset:1024 sc1
s_sub_u32 s37, s37, 1
s_cbranch_scc1 Lend_1
s_branch Lps_459
Lpf_462:
buffer_load_dwordx4 v[40:43], v8, s[4:7], s40 offen offset:3072 sc1
Lps_485:
s_waitcnt vmcnt(1)
v_max3_u32 v110, v36, v37, v38
v_max_u32 v110, v110, v39
v_cmp_eq_u32 vcc, -1, v110
s_cbranch_vccnz Lpf_486
v_smfmac_f32_16x16x64_bf16 v[44:47], v[36:39], a[64:71], v126
v_smfmac_f32_16x16x64_bf16 v[48:51], v[36:39], a[72:79], v126
v_smfmac_f32_16x16x64_bf16 v[52:55], v[36:39], a[80:87], v126
v_smfmac_f32_16x16x64_bf16 v[60:63], v[36:39], v[192:199], v126
s_branch Lps_465
Lpf_464:
buffer_load_dwordx4 v[36:39], v8, s[4:7], s40 offen offset:2048 sc1
s_sub_u32 s37, s37, 1
s_cbranch_scc1 Lend_1
s_branch Lps_463
Lpf_466:
buffer_load_dwordx4 v[40:43], v8, s[4:7], s40 offen offset:3072 sc1
s_sub_u32 s37, s37, 1
s_cbranch_scc1 Lend_1
s_branch Lps_465
Lpf_468:
buffer_load_dwordx4 v[36:39], v8, s[4:7], s40 offen offset:2048 sc1
Lps_487:
s_waitcnt vmcnt(3)
v_max3_u32 v110, v40, v41, v42
v_max_u32 v110, v110, v43
v_cmp_eq_u32 vcc, -1, v110
s_cbranch_vccnz Lpf_488
v_smfmac_f32_16x16x64_bf16 v[44:47], v[40:43], a[96:103], v126
v_smfmac_f32_16x16x64_bf16 v[48:51], v[40:43], a[104:111], v126
v_smfmac_f32_16x16x64_bf16 v[52:55], v[40:43], a[112:119], v126
v_smfmac_f32_16x16x64_bf16 v[60:63], v[40:43], v[224:231], v126
Lps_489:
s_waitcnt vmcnt(2)
v_max3_u32 v110, v28, v29, v30
v_max_u32 v110, v110, v31
v_cmp_eq_u32 vcc, -1, v110
s_cbranch_vccnz Lpf_490
v_smfmac_f32_16x16x64_bf16 v[44:47], v[28:31], a[0:7], v126
v_smfmac_f32_16x16x64_bf16 v[48:51], v[28:31], a[8:15], v126
v_smfmac_f32_16x16x64_bf16 v[52:55], v[28:31], a[16:23], v126
v_smfmac_f32_16x16x64_bf16 v[60:63], v[28:31], v[128:135], v126
s_branch Lps_481
Lpf_470:
buffer_load_dwordx4 v[40:43], v8, s[4:7], s40 offen offset:3072 sc1
Lps_491:
s_waitcnt vmcnt(2)
v_max3_u32 v110, v28, v29, v30
v_max_u32 v110, v110, v31
v_cmp_eq_u32 vcc, -1, v110
s_cbranch_vccnz Lpf_492
v_smfmac_f32_16x16x64_bf16 v[44:47], v[28:31], a[0:7], v126
v_smfmac_f32_16x16x64_bf16 v[48:51], v[28:31], a[8:15], v126
v_smfmac_f32_16x16x64_bf16 v[52:55], v[28:31], a[16:23], v126
v_smfmac_f32_16x16x64_bf16 v[60:63], v[28:31], v[128:135], v126
s_branch Lps_483
Lpf_472:
buffer_load_dwordx4 v[28:31], v8, s[4:7], s40 offen offset:0 sc1
s_sub_u32 s37, s37, 1
s_cbranch_scc1 Lend_1
Lps_493:
s_waitcnt vmcnt(1)
v_max3_u32 v110, v32, v33, v34
v_max_u32 v110, v110, v35
v_cmp_eq_u32 vcc, -1, v110
s_cbranch_vccnz Lpf_494
v_smfmac_f32_16x16x64_bf16 v[44:47], v[32:35], a[32:39], v126
v_smfmac_f32_16x16x64_bf16 v[48:51], v[32:35], a[40:47], v126
v_smfmac_f32_16x16x64_bf16 v[52:55], v[32:35], a[48:55], v126
v_smfmac_f32_16x16x64_bf16 v[60:63], v[32:35], v[160:167], v126
s_branch Lps_453
Lpf_474:
buffer_load_dwordx4 v[40:43], v8, s[4:7], s40 offen offset:3072 sc1
Lps_495:
s_waitcnt vmcnt(2)
v_max3_u32 v110, v28, v29, v30
v_max_u32 v110, v110, v31
v_cmp_eq_u32 vcc, -1, v110
s_cbranch_vccnz Lpf_496
v_smfmac_f32_16x16x64_bf16 v[44:47], v[28:31], a[0:7], v126
v_smfmac_f32_16x16x64_bf16 v[48:51], v[28:31], a[8:15], v126
v_smfmac_f32_16x16x64_bf16 v[52:55], v[28:31], a[16:23], v126
v_smfmac_f32_16x16x64_bf16 v[60:63], v[28:31], v[128:135], v126
s_branch Lps_485
Lpf_476:
buffer_load_dwordx4 v[28:31], v8, s[4:7], s40 offen offset:0 sc1
s_sub_u32 s37, s37, 1
s_cbranch_scc1 Lend_1
Lps_497:
s_waitcnt vmcnt(1)
v_max3_u32 v110, v36, v37, v38
v_max_u32 v110, v110, v39
v_cmp_eq_u32 vcc, -1, v110
s_cbranch_vccnz Lpf_498
v_smfmac_f32_16x16x64_bf16 v[44:47], v[36:39], a[64:71], v126
v_smfmac_f32_16x16x64_bf16 v[48:51], v[36:39], a[72:79], v126
v_smfmac_f32_16x16x64_bf16 v[52:55], v[36:39], a[80:87], v126
v_smfmac_f32_16x16x64_bf16 v[60:63], v[36:39], v[192:199], v126
s_branch Lps_453
Lpf_478:
buffer_load_dwordx4 v[28:31], v8, s[4:7], s40 offen offset:0 sc1
s_sub_u32 s37, s37, 1
s_cbranch_scc1 Lend_1
s_branch Lps_451
Lpf_480:
buffer_load_dwordx4 v[40:43], v8, s[4:7], s40 offen offset:3072 sc1
Lps_499:
s_waitcnt vmcnt(2)
v_max3_u32 v110, v32, v33, v34
v_max_u32 v110, v110, v35
v_cmp_eq_u32 vcc, -1, v110
s_cbranch_vccnz Lpf_500
v_smfmac_f32_16x16x64_bf16 v[44:47], v[32:35], a[32:39], v126
v_smfmac_f32_16x16x64_bf16 v[48:51], v[32:35], a[40:47], v126
v_smfmac_f32_16x16x64_bf16 v[52:55], v[32:35], a[48:55], v126
v_smfmac_f32_16x16x64_bf16 v[60:63], v[32:35], v[160:167], v126
s_branch Lps_485
Lpf_482:
buffer_load_dwordx4 v[32:35], v8, s[4:7], s40 offen offset:1024 sc1
s_sub_u32 s37, s37, 1
s_cbranch_scc1 Lend_1
Lps_501:
s_waitcnt vmcnt(1)
v_max3_u32 v110, v36, v37, v38
v_max_u32 v110, v110, v39
v_cmp_eq_u32 vcc, -1, v110
s_cbranch_vccnz Lpf_502
v_smfmac_f32_16x16x64_bf16 v[44:47], v[36:39], a[64:71], v126
v_smfmac_f32_16x16x64_bf16 v[48:51], v[36:39], a[72:79], v126
v_smfmac_f32_16x16x64_bf16 v[52:55], v[36:39], a[80:87], v126
v_smfmac_f32_16x16x64_bf16 v[60:63], v[36:39], v[192:199], v126
s_branch Lps_459
Lpf_484:
buffer_load_dwordx4 v[32:35], v8, s[4:7], s40 offen offset:1024 sc1
s_sub_u32 s37, s37, 1
s_cbranch_scc1 Lend_1
s_branch Lps_457
Lpf_486:
buffer_load_dwordx4 v[36:39], v8, s[4:7], s40 offen offset:2048 sc1
s_sub_u32 s37, s37, 1
s_cbranch_scc1 Lend_1
s_branch Lps_461
Lpf_488:
buffer_load_dwordx4 v[40:43], v8, s[4:7], s40 offen offset:3072 sc1
Lps_503:
s_waitcnt vmcnt(3)
v_max3_u32 v110, v28, v29, v30
v_max_u32 v110, v110, v31
v_cmp_eq_u32 vcc, -1, v110
s_cbranch_vccnz Lpf_504
v_smfmac_f32_16x16x64_bf16 v[44:47], v[28:31], a[0:7], v126
v_smfmac_f32_16x16x64_bf16 v[48:51], v[28:31], a[8:15], v126
v_smfmac_f32_16x16x64_bf16 v[52:55], v[28:31], a[16:23], v126
v_smfmac_f32_16x16x64_bf16 v[60:63], v[28:31], v[128:135], v126
s_branch Lps_499
Lpf_490:
buffer_load_dwordx4 v[28:31], v8, s[4:7], s40 offen offset:0 sc1
s_sub_u32 s37, s37, 1
s_cbranch_scc1 Lend_1
Lps_505:
s_waitcnt vmcnt(2)
v_max3_u32 v110, v32, v33, v34
v_max_u32 v110, v110, v35
v_cmp_eq_u32 vcc, -1, v110
s_cbranch_vccnz Lpf_506
v_smfmac_f32_16x16x64_bf16 v[44:47], v[32:35], a[32:39], v126
v_smfmac_f32_16x16x64_bf16 v[48:51], v[32:35], a[40:47], v126
v_smfmac_f32_16x16x64_bf16 v[52:55], v[32:35], a[48:55], v126
v_smfmac_f32_16x16x64_bf16 v[60:63], v[32:35], v[160:167], v126
s_branch Lps_497
Lpf_492:
buffer_load_dwordx4 v[28:31], v8, s[4:7], s40 offen offset:0 sc1
s_sub_u32 s37, s37, 1
s_cbranch_scc1 Lend_1
Lps_507:
s_waitcnt vmcnt(2)
v_max3_u32 v110, v32, v33, v34
v_max_u32 v110, v110, v35
v_cmp_eq_u32 vcc, -1, v110
s_cbranch_vccnz Lpf_508
v_smfmac_f32_16x16x64_bf16 v[44:47], v[32:35], a[32:39], v126
v_smfmac_f32_16x16x64_bf16 v[48:51], v[32:35], a[40:47], v126
v_smfmac_f32_16x16x64_bf16 v[52:55], v[32:35], a[48:55], v126
v_smfmac_f32_16x16x64_bf16 v[60:63], v[32:35], v[160:167], v126
s_branch Lps_451
Lpf_494:
buffer_load_dwordx4 v[32:35], v8, s[4:7], s40 offen offset:1024 sc1
s_branch Lps_471
Lpf_496:
buffer_load_dwordx4 v[28:31], v8, s[4:7], s40 offen offset:0 sc1
s_sub_u32 s37, s37, 1
s_cbranch_scc1 Lend_1
s_branch Lps_449
Lpf_498:
buffer_load_dwordx4 v[36:39], v8, s[4:7], s40 offen offset:2048 sc1
s_branch Lps_475
Lpf_500:
buffer_load_dwordx4 v[32:35], v8, s[4:7], s40 offen offset:1024 sc1
s_sub_u32 s37, s37, 1
s_cbranch_scc1 Lend_1
s_branch Lps_455
Lpf_502:
buffer_load_dwordx4 v[36:39], v8, s[4:7], s40 offen offset:2048 sc1
s_branch Lps_481
Lpf_504:
buffer_load_dwordx4 v[28:31], v8, s[4:7], s40 offen offset:0 sc1
s_sub_u32 s37, s37, 1
s_cbranch_scc1 Lend_1
s_branch Lps_447
Lpf_506:
buffer_load_dwordx4 v[32:35], v8, s[4:7], s40 offen offset:1024 sc1
Lps_509:
s_waitcnt vmcnt(2)
v_max3_u32 v110, v36, v37, v38
v_max_u32 v110, v110, v39
v_cmp_eq_u32 vcc, -1, v110
s_cbranch_vccnz Lpf_510
v_smfmac_f32_16x16x64_bf16 v[44:47], v[36:39], a[64:71], v126
v_smfmac_f32_16x16x64_bf16 v[48:51], v[36:39], a[72:79], v126
v_smfmac_f32_16x16x64_bf16 v[52:55], v[36:39], a[80:87], v126
v_smfmac_f32_16x16x64_bf16 v[60:63], v[36:39], v[192:199], v126
s_branch Lps_471
Lpf_508:
buffer_load_dwordx4 v[32:35], v8, s[4:7], s40 offen offset:1024 sc1
s_branch Lps_469
Lpf_510:
buffer_load_dwordx4 v[36:39], v8, s[4:7], s40 offen offset:2048 sc1
s_branch Lps_489
Lpf_441:
buffer_load_dwordx4 v[28:31], v9, s[4:7], s40 offen offset:0 sc1
s_sub_u32 s37, s37, 1
s_cbranch_scc1 Lend_1
Lps_511:
s_waitcnt vmcnt(3)
v_max3_u32 v110, v32, v33, v34
v_max_u32 v110, v110, v35
v_cmp_eq_u32 vcc, -1, v110
s_cbranch_vccnz Lpf_512
v_smfmac_f32_16x16x64_bf16 v[76:79], v[32:35], a[160:167], v126
v_smfmac_f32_16x16x64_bf16 v[80:83], v[32:35], a[168:175], v126
v_smfmac_f32_16x16x64_bf16 v[84:87], v[32:35], a[176:183], v126
Lps_513:
s_waitcnt vmcnt(2)
v_max3_u32 v110, v36, v37, v38
v_max_u32 v110, v110, v39
v_cmp_eq_u32 vcc, -1, v110
s_cbranch_vccnz Lpf_514
v_smfmac_f32_16x16x64_bf16 v[76:79], v[36:39], a[192:199], v126
v_smfmac_f32_16x16x64_bf16 v[80:83], v[36:39], a[200:207], v126
v_smfmac_f32_16x16x64_bf16 v[84:87], v[36:39], a[208:215], v126
Lps_515:
s_waitcnt vmcnt(1)
v_max3_u32 v110, v40, v41, v42
v_max_u32 v110, v110, v43
v_cmp_eq_u32 vcc, -1, v110
s_cbranch_vccnz Lpf_516
v_smfmac_f32_16x16x64_bf16 v[76:79], v[40:43], a[224:231], v126
v_smfmac_f32_16x16x64_bf16 v[80:83], v[40:43], a[232:239], v126
v_smfmac_f32_16x16x64_bf16 v[84:87], v[40:43], a[240:247], v126
Lps_517:
s_waitcnt vmcnt(0)
v_max3_u32 v110, v28, v29, v30
v_max_u32 v110, v110, v31
v_cmp_eq_u32 vcc, -1, v110
s_cbranch_vccnz Lpf_518
v_smfmac_f32_16x16x64_bf16 v[76:79], v[28:31], a[128:135], v126
s_nop 1
v_smfmac_f32_16x16x64_bf16 v[80:83], v[28:31], a[136:143], v126
s_nop 1
v_smfmac_f32_16x16x64_bf16 v[84:87], v[28:31], a[144:151], v126
s_nop 1
v_add_f32 v92, v76, v78
v_add_f32 v93, v77, v79
v_smfmac_f32_16x16x64_bf16 v[88:91], v[28:31], a[152:159], v126
v_add_f32 v94, v80, v82
v_add_f32 v95, v81, v83
ds_write_b64 v24, v[92:93] offset:12288
v_add_f32 v96, v84, v86
v_add_f32 v97, v85, v87
ds_write_b64 v25, v[94:95] offset:12288
v_smfmac_f32_16x16x64_bf16 v[88:91], v[32:35], a[184:191], v126
ds_write_b64 v26, v[96:97] offset:12288
v_smfmac_f32_16x16x64_bf16 v[88:91], v[36:39], a[216:223], v126
v_smfmac_f32_16x16x64_bf16 v[88:91], v[40:43], a[248:255], v126
s_branch Lpd_440
Lpf_442:
buffer_load_dwordx4 v[32:35], v9, s[4:7], s40 offen offset:1024 sc1
s_sub_u32 s37, s37, 1
s_cbranch_scc1 Lend_1
Lps_519:
s_waitcnt vmcnt(2)
v_max3_u32 v110, v36, v37, v38
v_max_u32 v110, v110, v39
v_cmp_eq_u32 vcc, -1, v110
s_cbranch_vccnz Lpf_520
v_smfmac_f32_16x16x64_bf16 v[76:79], v[36:39], a[192:199], v126
v_smfmac_f32_16x16x64_bf16 v[80:83], v[36:39], a[200:207], v126
v_smfmac_f32_16x16x64_bf16 v[84:87], v[36:39], a[208:215], v126
Lps_521:
s_waitcnt vmcnt(1)
v_max3_u32 v110, v40, v41, v42
v_max_u32 v110, v110, v43
v_cmp_eq_u32 vcc, -1, v110
s_cbranch_vccnz Lpf_522
v_smfmac_f32_16x16x64_bf16 v[76:79], v[40:43], a[224:231], v126
v_smfmac_f32_16x16x64_bf16 v[80:83], v[40:43], a[232:239], v126
v_smfmac_f32_16x16x64_bf16 v[84:87], v[40:43], a[240:247], v126
Lps_523:
s_waitcnt vmcnt(0)
v_max3_u32 v110, v32, v33, v34
v_max_u32 v110, v110, v35
v_cmp_eq_u32 vcc, -1, v110
s_cbranch_vccnz Lpf_524
v_smfmac_f32_16x16x64_bf16 v[76:79], v[32:35], a[160:167], v126
s_nop 1
v_smfmac_f32_16x16x64_bf16 v[80:83], v[32:35], a[168:175], v126
s_nop 1
v_smfmac_f32_16x16x64_bf16 v[84:87], v[32:35], a[176:183], v126
s_nop 1
v_add_f32 v92, v76, v78
v_add_f32 v93, v77, v79
v_smfmac_f32_16x16x64_bf16 v[88:91], v[28:31], a[152:159], v126
v_add_f32 v94, v80, v82
v_add_f32 v95, v81, v83
ds_write_b64 v24, v[92:93] offset:12288
v_add_f32 v96, v84, v86
v_add_f32 v97, v85, v87
ds_write_b64 v25, v[94:95] offset:12288
v_smfmac_f32_16x16x64_bf16 v[88:91], v[32:35], a[184:191], v126
ds_write_b64 v26, v[96:97] offset:12288
v_smfmac_f32_16x16x64_bf16 v[88:91], v[36:39], a[216:223], v126
v_smfmac_f32_16x16x64_bf16 v[88:91], v[40:43], a[248:255], v126
s_branch Lpd_440
Lpf_443:
buffer_load_dwordx4 v[36:39], v9, s[4:7], s40 offen offset:2048 sc1
s_sub_u32 s37, s37, 1
s_cbranch_scc1 Lend_1
Lps_525:
s_waitcnt vmcnt(1)
v_max3_u32 v110, v40, v41, v42
v_max_u32 v110, v110, v43
v_cmp_eq_u32 vcc, -1, v110
s_cbranch_vccnz Lpf_526
v_smfmac_f32_16x16x64_bf16 v[76:79], v[40:43], a[224:231], v126
v_smfmac_f32_16x16x64_bf16 v[80:83], v[40:43], a[232:239], v126
v_smfmac_f32_16x16x64_bf16 v[84:87], v[40:43], a[240:247], v126
Lps_527:
s_waitcnt vmcnt(0)
v_max3_u32 v110, v36, v37, v38
v_max_u32 v110, v110, v39
v_cmp_eq_u32 vcc, -1, v110
s_cbranch_vccnz Lpf_528
v_smfmac_f32_16x16x64_bf16 v[76:79], v[36:39], a[192:199], v126
s_nop 1
v_smfmac_f32_16x16x64_bf16 v[80:83], v[36:39], a[200:207], v126
s_nop 1
v_smfmac_f32_16x16x64_bf16 v[84:87], v[36:39], a[208:215], v126
s_nop 1
v_add_f32 v92, v76, v78
v_add_f32 v93, v77, v79
v_smfmac_f32_16x16x64_bf16 v[88:91], v[28:31], a[152:159], v126
v_add_f32 v94, v80, v82
v_add_f32 v95, v81, v83
ds_write_b64 v24, v[92:93] offset:12288
v_add_f32 v96, v84, v86
v_add_f32 v97, v85, v87
ds_write_b64 v25, v[94:95] offset:12288
v_smfmac_f32_16x16x64_bf16 v[88:91], v[32:35], a[184:191], v126
ds_write_b64 v26, v[96:97] offset:12288
v_smfmac_f32_16x16x64_bf16 v[88:91], v[36:39], a[216:223], v126
v_smfmac_f32_16x16x64_bf16 v[88:91], v[40:43], a[248:255], v126
s_branch Lpd_440
Lpf_444:
buffer_load_dwordx4 v[40:43], v9, s[4:7], s40 offen offset:3072 sc1
s_sub_u32 s37, s37, 1
s_cbranch_scc1 Lend_1
Lps_529:
s_waitcnt vmcnt(0)
v_max3_u32 v110, v40, v41, v42
v_max_u32 v110, v110, v43
v_cmp_eq_u32 vcc, -1, v110
s_cbranch_vccnz Lpf_530
v_smfmac_f32_16x16x64_bf16 v[76:79], v[40:43], a[224:231], v126
s_nop 1
v_smfmac_f32_16x16x64_bf16 v[80:83], v[40:43], a[232:239], v126
s_nop 1
v_smfmac_f32_16x16x64_bf16 v[84:87], v[40:43], a[240:247], v126
s_nop 1
v_add_f32 v92, v76, v78
v_add_f32 v93, v77, v79
v_smfmac_f32_16x16x64_bf16 v[88:91], v[28:31], a[152:159], v126
v_add_f32 v94, v80, v82
v_add_f32 v95, v81, v83
ds_write_b64 v24, v[92:93] offset:12288
v_add_f32 v96, v84, v86
v_add_f32 v97, v85, v87
ds_write_b64 v25, v[94:95] offset:12288
v_smfmac_f32_16x16x64_bf16 v[88:91], v[32:35], a[184:191], v126
ds_write_b64 v26, v[96:97] offset:12288
v_smfmac_f32_16x16x64_bf16 v[88:91], v[36:39], a[216:223], v126
v_smfmac_f32_16x16x64_bf16 v[88:91], v[40:43], a[248:255], v126
s_branch Lpd_440
Lpf_512:
buffer_load_dwordx4 v[32:35], v9, s[4:7], s40 offen offset:1024 sc1
Lps_531:
s_waitcnt vmcnt(3)
v_max3_u32 v110, v36, v37, v38
v_max_u32 v110, v110, v39
v_cmp_eq_u32 vcc, -1, v110
s_cbranch_vccnz Lpf_532
v_smfmac_f32_16x16x64_bf16 v[76:79], v[36:39], a[192:199], v126
v_smfmac_f32_16x16x64_bf16 v[80:83], v[36:39], a[200:207], v126
v_smfmac_f32_16x16x64_bf16 v[84:87], v[36:39], a[208:215], v126
Lps_533:
s_waitcnt vmcnt(2)
v_max3_u32 v110, v40, v41, v42
v_max_u32 v110, v110, v43
v_cmp_eq_u32 vcc, -1, v110
s_cbranch_vccnz Lpf_534
v_smfmac_f32_16x16x64_bf16 v[76:79], v[40:43], a[224:231], v126
v_smfmac_f32_16x16x64_bf16 v[80:83], v[40:43], a[232:239], v126
v_smfmac_f32_16x16x64_bf16 v[84:87], v[40:43], a[240:247], v126
Lps_535:
s_waitcnt vmcnt(1)
v_max3_u32 v110, v28, v29, v30
v_max_u32 v110, v110, v31
v_cmp_eq_u32 vcc, -1, v110
s_cbranch_vccnz Lpf_536
v_smfmac_f32_16x16x64_bf16 v[76:79], v[28:31], a[128:135], v126
v_smfmac_f32_16x16x64_bf16 v[80:83], v[28:31], a[136:143], v126
v_smfmac_f32_16x16x64_bf16 v[84:87], v[28:31], a[144:151], v126
s_branch Lps_523
Lpf_514:
buffer_load_dwordx4 v[36:39], v9, s[4:7], s40 offen offset:2048 sc1
Lps_537:
s_waitcnt vmcnt(2)
v_max3_u32 v110, v40, v41, v42
v_max_u32 v110, v110, v43
v_cmp_eq_u32 vcc, -1, v110
s_cbranch_vccnz Lpf_538
v_smfmac_f32_16x16x64_bf16 v[76:79], v[40:43], a[224:231], v126
v_smfmac_f32_16x16x64_bf16 v[80:83], v[40:43], a[232:239], v126
v_smfmac_f32_16x16x64_bf16 v[84:87], v[40:43], a[240:247], v126
Lps_539:
s_waitcnt vmcnt(1)
v_max3_u32 v110, v28, v29, v30
v_max_u32 v110, v110, v31
v_cmp_eq_u32 vcc, -1, v110
s_cbranch_vccnz Lpf_540
v_smfmac_f32_16x16x64_bf16 v[76:79], v[28:31], a[128:135], v126
v_smfmac_f32_16x16x64_bf16 v[80:83], v[28:31], a[136:143], v126
v_smfmac_f32_16x16x64_bf16 v[84:87], v[28:31], a[144:151], v126
s_branch Lps_527
Lpf_516:
buffer_load_dwordx4 v[40:43], v9, s[4:7], s40 offen offset:3072 sc1
Lps_541:
s_waitcnt vmcnt(1)
v_max3_u32 v110, v28, v29, v30
v_max_u32 v110, v110, v31
v_cmp_eq_u32 vcc, -1, v110
s_cbranch_vccnz Lpf_542
v_smfmac_f32_16x16x64_bf16 v[76:79], v[28:31], a[128:135], v126
v_smfmac_f32_16x16x64_bf16 v[80:83], v[28:31], a[136:143], v126
v_smfmac_f32_16x16x64_bf16 v[84:87], v[28:31], a[144:151], v126
s_branch Lps_529
Lpf_518:
buffer_load_dwordx4 v[28:31], v9, s[4:7], s40 offen offset:0 sc1
s_sub_u32 s37, s37, 1
s_cbranch_scc1 Lend_1
s_branch Lps_517
Lpf_520:
buffer_load_dwordx4 v[36:39], v9, s[4:7], s40 offen offset:2048 sc1
Lps_543:
s_waitcnt vmcnt(2)
v_max3_u32 v110, v40, v41, v42
v_max_u32 v110, v110, v43
v_cmp_eq_u32 vcc, -1, v110
s_cbranch_vccnz Lpf_544
v_smfmac_f32_16x16x64_bf16 v[76:79], v[40:43], a[224:231], v126
v_smfmac_f32_16x16x64_bf16 v[80:83], v[40:43], a[232:239], v126
v_smfmac_f32_16x16x64_bf16 v[84:87], v[40:43], a[240:247], v126
Lps_545:
s_waitcnt vmcnt(1)
v_max3_u32 v110, v32, v33, v34
v_max_u32 v110, v110, v35
v_cmp_eq_u32 vcc, -1, v110
s_cbranch_vccnz Lpf_546
v_smfmac_f32_16x16x64_bf16 v[76:79], v[32:35], a[160:167], v126
v_smfmac_f32_16x16x64_bf16 v[80:83], v[32:35], a[168:175], v126
v_smfmac_f32_16x16x64_bf16 v[84:87], v[32:35], a[176:183], v126
s_branch Lps_527
Lpf_522:
buffer_load_dwordx4 v[40:43], v9, s[4:7], s40 offen offset:3072 sc1
Lps_547:
s_waitcnt vmcnt(1)
v_max3_u32 v110, v32, v33, v34
v_max_u32 v110, v110, v35
v_cmp_eq_u32 vcc, -1, v110
s_cbranch_vccnz Lpf_548
v_smfmac_f32_16x16x64_bf16 v[76:79], v[32:35], a[160:167], v126
v_smfmac_f32_16x16x64_bf16 v[80:83], v[32:35], a[168:175], v126
v_smfmac_f32_16x16x64_bf16 v[84:87], v[32:35], a[176:183], v126
s_branch Lps_529
Lpf_524:
buffer_load_dwordx4 v[32:35], v9, s[4:7], s40 offen offset:1024 sc1
s_sub_u32 s37, s37, 1
s_cbranch_scc1 Lend_1
s_branch Lps_523
Lpf_526:
buffer_load_dwordx4 v[40:43], v9, s[4:7], s40 offen offset:3072 sc1
Lps_549:
s_waitcnt vmcnt(1)
v_max3_u32 v110, v36, v37, v38
v_max_u32 v110, v110, v39
v_cmp_eq_u32 vcc, -1, v110
s_cbranch_vccnz Lpf_550
v_smfmac_f32_16x16x64_bf16 v[76:79], v[36:39], a[192:199], v126
v_smfmac_f32_16x16x64_bf16 v[80:83], v[36:39], a[200:207], v126
v_smfmac_f32_16x16x64_bf16 v[84:87], v[36:39], a[208:215], v126
s_branch Lps_529
Lpf_528:
buffer_load_dwordx4 v[36:39], v9, s[4:7], s40 offen offset:2048 sc1
s_sub_u32 s37, s37, 1
s_cbranch_scc1 Lend_1
s_branch Lps_527
Lpf_530:
buffer_load_dwordx4 v[40:43], v9, s[4:7], s40 offen offset:3072 sc1
s_sub_u32 s37, s37, 1
s_cbranch_scc1 Lend_1
s_branch Lps_529
Lpf_532:
buffer_load_dwordx4 v[36:39], v9, s[4:7], s40 offen offset:2048 sc1
Lps_551:
s_waitcnt vmcnt(3)
v_max3_u32 v110, v40, v41, v42
v_max_u32 v110, v110, v43
v_cmp_eq_u32 vcc, -1, v110
s_cbranch_vccnz Lpf_552
v_smfmac_f32_16x16x64_bf16 v[76:79], v[40:43], a[224:231], v126
v_smfmac_f32_16x16x64_bf16 v[80:83], v[40:43], a[232:239], v126
v_smfmac_f32_16x16x64_bf16 v[84:87], v[40:43], a[240:247], v126
Lps_553:
s_waitcnt vmcnt(2)
v_max3_u32 v110, v28, v29, v30
v_max_u32 v110, v110, v31
v_cmp_eq_u32 vcc, -1, v110
s_cbranch_vccnz Lpf_554
v_smfmac_f32_16x16x64_bf16 v[76:79], v[28:31], a[128:135], v126
v_smfmac_f32_16x16x64_bf16 v[80:83], v[28:31], a[136:143], v126
v_smfmac_f32_16x16x64_bf16 v[84:87], v[28:31], a[144:151], v126
s_branch Lps_545
Lpf_534:
buffer_load_dwordx4 v[40:43], v9, s[4:7], s40 offen offset:3072 sc1
Lps_555:
s_waitcnt vmcnt(2)
v_max3_u32 v110, v28, v29, v30
v_max_u32 v110, v110, v31
v_cmp_eq_u32 vcc, -1, v110
s_cbranch_vccnz Lpf_556
v_smfmac_f32_16x16x64_bf16 v[76:79], v[28:31], a[128:135], v126
v_smfmac_f32_16x16x64_bf16 v[80:83], v[28:31], a[136:143], v126
v_smfmac_f32_16x16x64_bf16 v[84:87], v[28:31], a[144:151], v126
s_branch Lps_547
Lpf_536:
buffer_load_dwordx4 v[28:31], v9, s[4:7], s40 offen offset:0 sc1
s_sub_u32 s37, s37, 1
s_cbranch_scc1 Lend_1
Lps_557:
s_waitcnt vmcnt(1)
v_max3_u32 v110, v32, v33, v34
v_max_u32 v110, v110, v35
v_cmp_eq_u32 vcc, -1, v110
s_cbranch_vccnz Lpf_558
v_smfmac_f32_16x16x64_bf16 v[76:79], v[32:35], a[160:167], v126
v_smfmac_f32_16x16x64_bf16 v[80:83], v[32:35], a[168:175], v126
v_smfmac_f32_16x16x64_bf16 v[84:87], v[32:35], a[176:183], v126
s_branch Lps_517
Lpf_538:
buffer_load_dwordx4 v[40:43], v9, s[4:7], s40 offen offset:3072 sc1
Lps_559:
s_waitcnt vmcnt(2)
v_max3_u32 v110, v28, v29, v30
v_max_u32 v110, v110, v31
v_cmp_eq_u32 vcc, -1, v110
s_cbranch_vccnz Lpf_560
v_smfmac_f32_16x16x64_bf16 v[76:79], v[28:31], a[128:135], v126
v_smfmac_f32_16x16x64_bf16 v[80:83], v[28:31], a[136:143], v126
v_smfmac_f32_16x16x64_bf16 v[84:87], v[28:31], a[144:151], v126
s_branch Lps_549
Lpf_540:
buffer_load_dwordx4 v[28:31], v9, s[4:7], s40 offen offset:0 sc1
s_sub_u32 s37, s37, 1
s_cbranch_scc1 Lend_1
Lps_561:
s_waitcnt vmcnt(1)
v_max3_u32 v110, v36, v37, v38
v_max_u32 v110, v110, v39
v_cmp_eq_u32 vcc, -1, v110
s_cbranch_vccnz Lpf_562
v_smfmac_f32_16x16x64_bf16 v[76:79], v[36:39], a[192:199], v126
v_smfmac_f32_16x16x64_bf16 v[80:83], v[36:39], a[200:207], v126
v_smfmac_f32_16x16x64_bf16 v[84:87], v[36:39], a[208:215], v126
s_branch Lps_517
Lpf_542:
buffer_load_dwordx4 v[28:31], v9, s[4:7], s40 offen offset:0 sc1
s_sub_u32 s37, s37, 1
s_cbranch_scc1 Lend_1
s_branch Lps_515
Lpf_544:
buffer_load_dwordx4 v[40:43], v9, s[4:7], s40 offen offset:3072 sc1
Lps_563:
s_waitcnt vmcnt(2)
v_max3_u32 v110, v32, v33, v34
v_max_u32 v110, v110, v35
v_cmp_eq_u32 vcc, -1, v110
s_cbranch_vccnz Lpf_564
v_smfmac_f32_16x16x64_bf16 v[76:79], v[32:35], a[160:167], v126
v_smfmac_f32_16x16x64_bf16 v[80:83], v[32:35], a[168:175], v126
v_smfmac_f32_16x16x64_bf16 v[84:87], v[32:35], a[176:183], v126
s_branch Lps_549
Lpf_546:
buffer_load_dwordx4 v[32:35], v9, s[4:7], s40 offen offset:1024 sc1
s_sub_u32 s37, s37, 1
s_cbranch_scc1 Lend_1
Lps_565:
s_waitcnt vmcnt(1)
v_max3_u32 v110, v36, v37, v38
v_max_u32 v110, v110, v39
v_cmp_eq_u32 vcc, -1, v110
s_cbranch_vccnz Lpf_566
v_smfmac_f32_16x16x64_bf16 v[76:79], v[36:39], a[192:199], v126
v_smfmac_f32_16x16x64_bf16 v[80:83], v[36:39], a[200:207], v126
v_smfmac_f32_16x16x64_bf16 v[84:87], v[36:39], a[208:215], v126
s_branch Lps_523
Lpf_548:
buffer_load_dwordx4 v[32:35], v9, s[4:7], s40 offen offset:1024 sc1
s_sub_u32 s37, s37, 1
s_cbranch_scc1 Lend_1
s_branch Lps_521
Lpf_550:
buffer_load_dwordx4 v[36:39], v9, s[4:7], s40 offen offset:2048 sc1
s_sub_u32 s37, s37, 1
s_cbranch_scc1 Lend_1
s_branch Lps_525
Lpf_552:
buffer_load_dwordx4 v[40:43], v9, s[4:7], s40 offen offset:3072 sc1
Lps_567:
s_waitcnt vmcnt(3)
v_max3_u32 v110, v28, v29, v30
v_max_u32 v110, v110, v31
v_cmp_eq_u32 vcc, -1, v110
s_cbranch_vccnz Lpf_568
v_smfmac_f32_16x16x64_bf16 v[76:79], v[28:31], a[128:135], v126
v_smfmac_f32_16x16x64_bf16 v[80:83], v[28:31], a[136:143], v126
v_smfmac_f32_16x16x64_bf16 v[84:87], v[28:31], a[144:151], v126
s_branch Lps_563
Lpf_554:
buffer_load_dwordx4 v[28:31], v9, s[4:7], s40 offen offset:0 sc1
s_sub_u32 s37, s37, 1
s_cbranch_scc1 Lend_1
Lps_569:
s_waitcnt vmcnt(2)
v_max3_u32 v110, v32, v33, v34
v_max_u32 v110, v110, v35
v_cmp_eq_u32 vcc, -1, v110
s_cbranch_vccnz Lpf_570
v_smfmac_f32_16x16x64_bf16 v[76:79], v[32:35], a[160:167], v126
v_smfmac_f32_16x16x64_bf16 v[80:83], v[32:35], a[168:175], v126
v_smfmac_f32_16x16x64_bf16 v[84:87], v[32:35], a[176:183], v126
s_branch Lps_561
Lpf_556:
buffer_load_dwordx4 v[28:31], v9, s[4:7], s40 offen offset:0 sc1
s_sub_u32 s37, s37, 1
s_cbranch_scc1 Lend_1
Lps_571:
s_waitcnt vmcnt(2)
v_max3_u32 v110, v32, v33, v34
v_max_u32 v110, v110, v35
v_cmp_eq_u32 vcc, -1, v110
s_cbranch_vccnz Lpf_572
v_smfmac_f32_16x16x64_bf16 v[76:79], v[32:35], a[160:167], v126
v_smfmac_f32_16x16x64_bf16 v[80:83], v[32:35], a[168:175], v126
v_smfmac_f32_16x16x64_bf16 v[84:87], v[32:35], a[176:183], v126
s_branch Lps_515
Lpf_558:
buffer_load_dwordx4 v[32:35], v9, s[4:7], s40 offen offset:1024 sc1
s_branch Lps_535
Lpf_560:
buffer_load_dwordx4 v[28:31], v9, s[4:7], s40 offen offset:0 sc1
s_sub_u32 s37, s37, 1
s_cbranch_scc1 Lend_1
s_branch Lps_513
Lpf_562:
buffer_load_dwordx4 v[36:39], v9, s[4:7], s40 offen offset:2048 sc1
s_branch Lps_539
Lpf_564:
buffer_load_dwordx4 v[32:35], v9, s[4:7], s40 offen offset:1024 sc1
s_sub_u32 s37, s37, 1
s_cbranch_scc1 Lend_1
s_branch Lps_519
Lpf_566:
buffer_load_dwordx4 v[36:39], v9, s[4:7], s40 offen offset:2048 sc1
s_branch Lps_545
Lpf_568:
buffer_load_dwordx4 v[28:31], v9, s[4:7], s40 offen offset:0 sc1
s_sub_u32 s37, s37, 1
s_cbranch_scc1 Lend_1
s_branch Lps_511
Lpf_570:
buffer_load_dwordx4 v[32:35], v9, s[4:7], s40 offen offset:1024 sc1
Lps_573:
s_waitcnt vmcnt(2)
v_max3_u32 v110, v36, v37, v38
v_max_u32 v110, v110, v39
v_cmp_eq_u32 vcc, -1, v110
s_cbranch_vccnz Lpf_574
v_smfmac_f32_16x16x64_bf16 v[76:79], v[36:39], a[192:199], v126
v_smfmac_f32_16x16x64_bf16 v[80:83], v[36:39], a[200:207], v126
v_smfmac_f32_16x16x64_bf16 v[84:87], v[36:39], a[208:215], v126
s_branch Lps_535
Lpf_572:
buffer_load_dwordx4 v[32:35], v9, s[4:7], s40 offen offset:1024 sc1
s_branch Lps_533
Lpf_574:
buffer_load_dwordx4 v[36:39], v9, s[4:7], s40 offen offset:2048 sc1
s_branch Lps_553
Lg3_3:
v_mov_b32 v9, v1
s_sub_u32 s26, s34, 24
s_lshl_b32 s44, s33, 3
s_add_u32 s44, s44, s26
s_lshl_b32 s38, s44, 7
s_add_u32 s38, s38, 3440640
v_min_u32 v80, 1, v0
v_lshl_add_u32 v4, v80, 30, s38
v_mov_b32 v5, 0
buffer_store_dword v5, v4, s[4:7], 0 offen sc1
s_mov_b32 s52, 1
s_mov_b32 s38, 4096
buffer_store_dword v5, v4, s[4:7], s38 offen sc1
s_mov_b32 s38, 8192
buffer_store_dword v5, v4, s[4:7], s38 offen sc1
s_lshl_b32 s38, s44, 7
s_add_u32 s38, s38, 3436544
v_min_u32 v80, 1, v0
v_lshl_add_u32 v7, v80, 30, s38
buffer_store_dword v5, v7, s[4:7], 0 offen sc1
s_lshl_b32 s38, s35, 16
s_or_b32 s52, s52, s38
s_waitcnt vmcnt(0)
s_cmp_lg_u32 s32, 0
s_cbranch_scc1 Lar_576
s_mov_b64 exec, 1
v_mov_b32 v48, 16
v_mov_b32 v49, s52
buffer_atomic_add v49, v48, s[12:15], 0 offen sc1
s_mov_b64 exec, -1
Lar_576:
s_mov_b32 s8, s24
s_and_b32 s9, s25, 0xffff
s_mov_b32 s10, 0x800000
s_mov_b32 s11, 0x20000
s_lshl_b32 s60, s33, 21
s_lshl_b32 s38, s26, 8
s_add_u32 s60, s60, s38
s_add_u32 s61, s60, 128
s_lshr_b32 s52, s32, 1
s_lshl_b32 s52, s52, 14
s_and_b32 s53, s32, 1
s_lshl_b32 s53, s53, 6
s_add_u32 s52, s52, s53
v_bfe_u32 v84, v9, 2, 2
v_lshrrev_b32 v85, 4, v9
v_lshl_add_u32 v84, v85, 2, v84
v_lshl_add_u32 v84, v84, 7, s52
v_and_b32 v85, 3, v9
v_lshl_add_u32 v84, v85, 4, v84
v_add_u32 v84, 0, v84
v_bfe_u32 v85, v9, 3, 2
v_lshlrev_b32 v85, 5, v85
v_xor_b32 v80, v84, v85
v_bfe_u32 v84, v9, 2, 2
v_lshrrev_b32 v85, 4, v9
v_lshl_add_u32 v84, v85, 2, v84
v_lshl_add_u32 v84, v84, 7, s52
v_and_b32 v85, 3, v9
v_lshl_add_u32 v84, v85, 4, v84
v_add_u32 v84, 8, v84
v_bfe_u32 v85, v9, 3, 2
v_lshlrev_b32 v85, 5, v85
v_xor_b32 v81, v84, v85
v_lshrrev_b32 v84, 3, v9
s_mul_i32 s38, s32, 256
v_add_u32 v84, s38, v84
v_mul_u32_u24 v84, 2048, v84
v_and_b32 v85, 7, v9
v_lshl_add_u32 v84, v85, 4, v84
v_bfe_u32 v85, v9, 4, 2
v_lshlrev_b32 v85, 5, v85
v_xor_b32 v84, v84, v85
v_xor_b32 v85, 0, v84
s_lshl_b32 s38, s32, 12
s_barrier
s_add_u32 m0, s38, 0
s_add_u32 s39, s60, 0
buffer_load_dwordx4 v84, s[8:11], s39 offen lds
s_add_u32 m0, s38, 1024
s_add_u32 s39, s60, 16384
buffer_load_dwordx4 v85, s[8:11], s39 offen lds
s_add_u32 m0, s38, 2048
s_add_u32 s39, s60, 32768
buffer_load_dwordx4 v84, s[8:11], s39 offen lds
s_add_u32 m0, s38, 3072
s_add_u32 s39, s60, 49152
buffer_load_dwordx4 v85, s[8:11], s39 offen lds
s_add_u32 m0, s38, 16384
s_add_u32 s39, s61, 0
buffer_load_dwordx4 v84, s[8:11], s39 offen lds
s_add_u32 m0, s38, 17408
s_add_u32 s39, s61, 16384
buffer_load_dwordx4 v85, s[8:11], s39 offen lds
s_add_u32 m0, s38, 18432
s_add_u32 s39, s61, 32768
buffer_load_dwordx4 v84, s[8:11], s39 offen lds
s_add_u32 m0, s38, 19456
s_add_u32 s39, s61, 49152
buffer_load_dwordx4 v85, s[8:11], s39 offen lds
s_add_u32 m0, s38, 32768
s_add_u32 s39, s60, 65536
buffer_load_dwordx4 v84, s[8:11], s39 offen lds
s_add_u32 m0, s38, 33792
s_add_u32 s39, s60, 81920
buffer_load_dwordx4 v85, s[8:11], s39 offen lds
s_add_u32 m0, s38, 34816
s_add_u32 s39, s60, 98304
buffer_load_dwordx4 v84, s[8:11], s39 offen lds
s_add_u32 m0, s38, 35840
s_add_u32 s39, s60, 114688
buffer_load_dwordx4 v85, s[8:11], s39 offen lds
s_add_u32 m0, s38, 49152
s_add_u32 s39, s61, 65536
buffer_load_dwordx4 v84, s[8:11], s39 offen lds
s_add_u32 m0, s38, 50176
s_add_u32 s39, s61, 81920
buffer_load_dwordx4 v85, s[8:11], s39 offen lds
s_add_u32 m0, s38, 51200
s_add_u32 s39, s61, 98304
buffer_load_dwordx4 v84, s[8:11], s39 offen lds
s_add_u32 m0, s38, 52224
s_add_u32 s39, s61, 114688
buffer_load_dwordx4 v85, s[8:11], s39 offen lds
s_waitcnt vmcnt(8)
s_barrier
ds_read_b64_tr_b16 a[0:1], v80 offset:0
ds_read_b64_tr_b16 a[2:3], v80 offset:2048
ds_read_b64_tr_b16 a[32:33], v80 offset:4096
ds_read_b64_tr_b16 a[34:35], v80 offset:6144
ds_read_b64_tr_b16 a[64:65], v80 offset:8192
ds_read_b64_tr_b16 a[66:67], v80 offset:10240
ds_read_b64_tr_b16 a[96:97], v80 offset:12288
ds_read_b64_tr_b16 a[98:99], v80 offset:14336
ds_read_b64_tr_b16 a[128:129], v81 offset:0
ds_read_b64_tr_b16 a[130:131], v81 offset:2048
ds_read_b64_tr_b16 a[160:161], v81 offset:4096
ds_read_b64_tr_b16 a[162:163], v81 offset:6144
ds_read_b64_tr_b16 a[192:193], v81 offset:8192
ds_read_b64_tr_b16 a[194:195], v81 offset:10240
ds_read_b64_tr_b16 a[224:225], v81 offset:12288
ds_read_b64_tr_b16 a[226:227], v81 offset:14336
v_add_u32 v80, 32768, v80
v_add_u32 v81, 32768, v81
s_add_u32 m0, s38, 65536
s_add_u32 s39, s60, 131072
buffer_load_dwordx4 v84, s[8:11], s39 offen lds
s_add_u32 m0, s38, 66560
s_add_u32 s39, s60, 147456
buffer_load_dwordx4 v85, s[8:11], s39 offen lds
s_add_u32 m0, s38, 67584
s_add_u32 s39, s60, 163840
buffer_load_dwordx4 v84, s[8:11], s39 offen lds
s_add_u32 m0, s38, 68608
s_add_u32 s39, s60, 180224
buffer_load_dwordx4 v85, s[8:11], s39 offen lds
s_add_u32 m0, s38, 81920
s_add_u32 s39, s61, 131072
buffer_load_dwordx4 v84, s[8:11], s39 offen lds
s_add_u32 m0, s38, 82944
s_add_u32 s39, s61, 147456
buffer_load_dwordx4 v85, s[8:11], s39 offen lds
s_add_u32 m0, s38, 83968
s_add_u32 s39, s61, 163840
buffer_load_dwordx4 v84, s[8:11], s39 offen lds
s_add_u32 m0, s38, 84992
s_add_u32 s39, s61, 180224
buffer_load_dwordx4 v85, s[8:11], s39 offen lds
s_waitcnt lgkmcnt(0)
s_waitcnt vmcnt(8)
s_barrier
ds_read_b64_tr_b16 a[4:5], v80 offset:0
ds_read_b64_tr_b16 a[6:7], v80 offset:2048
ds_read_b64_tr_b16 a[36:37], v80 offset:4096
ds_read_b64_tr_b16 a[38:39], v80 offset:6144
ds_read_b64_tr_b16 a[68:69], v80 offset:8192
ds_read_b64_tr_b16 a[70:71], v80 offset:10240
ds_read_b64_tr_b16 a[100:101], v80 offset:12288
ds_read_b64_tr_b16 a[102:103], v80 offset:14336
ds_read_b64_tr_b16 a[132:133], v81 offset:0
ds_read_b64_tr_b16 a[134:135], v81 offset:2048
ds_read_b64_tr_b16 a[164:165], v81 offset:4096
ds_read_b64_tr_b16 a[166:167], v81 offset:6144
ds_read_b64_tr_b16 a[196:197], v81 offset:8192
ds_read_b64_tr_b16 a[198:199], v81 offset:10240
ds_read_b64_tr_b16 a[228:229], v81 offset:12288
ds_read_b64_tr_b16 a[230:231], v81 offset:14336
v_add_u32 v80, 32768, v80
v_add_u32 v81, 32768, v81
s_add_u32 m0, s38, 98304
s_add_u32 s39, s60, 196608
buffer_load_dwordx4 v84, s[8:11], s39 offen lds
s_add_u32 m0, s38, 99328
s_add_u32 s39, s60, 212992
buffer_load_dwordx4 v85, s[8:11], s39 offen lds
s_add_u32 m0, s38, 100352
s_add_u32 s39, s60, 229376
buffer_load_dwordx4 v84, s[8:11], s39 offen lds
s_add_u32 m0, s38, 101376
s_add_u32 s39, s60, 245760
buffer_load_dwordx4 v85, s[8:11], s39 offen lds
s_add_u32 m0, s38, 114688
s_add_u32 s39, s61, 196608
buffer_load_dwordx4 v84, s[8:11], s39 offen lds
s_add_u32 m0, s38, 115712
s_add_u32 s39, s61, 212992
buffer_load_dwordx4 v85, s[8:11], s39 offen lds
s_add_u32 m0, s38, 116736
s_add_u32 s39, s61, 229376
buffer_load_dwordx4 v84, s[8:11], s39 offen lds
s_add_u32 m0, s38, 117760
s_add_u32 s39, s61, 245760
buffer_load_dwordx4 v85, s[8:11], s39 offen lds
s_waitcnt lgkmcnt(0)
s_waitcnt vmcnt(8)
s_barrier
ds_read_b64_tr_b16 a[8:9], v80 offset:0
ds_read_b64_tr_b16 a[10:11], v80 offset:2048
ds_read_b64_tr_b16 a[40:41], v80 offset:4096
ds_read_b64_tr_b16 a[42:43], v80 offset:6144
ds_read_b64_tr_b16 a[72:73], v80 offset:8192
ds_read_b64_tr_b16 a[74:75], v80 offset:10240
ds_read_b64_tr_b16 a[104:105], v80 offset:12288
ds_read_b64_tr_b16 a[106:107], v80 offset:14336
ds_read_b64_tr_b16 a[136:137], v81 offset:0
ds_read_b64_tr_b16 a[138:139], v81 offset:2048
ds_read_b64_tr_b16 a[168:169], v81 offset:4096
ds_read_b64_tr_b16 a[170:171], v81 offset:6144
ds_read_b64_tr_b16 a[200:201], v81 offset:8192
ds_read_b64_tr_b16 a[202:203], v81 offset:10240
ds_read_b64_tr_b16 a[232:233], v81 offset:12288
ds_read_b64_tr_b16 a[234:235], v81 offset:14336
v_add_u32 v80, 32768, v80
v_add_u32 v81, 32768, v81
s_add_u32 m0, s38, 131072
s_add_u32 s39, s60, 262144
buffer_load_dwordx4 v84, s[8:11], s39 offen lds
s_add_u32 m0, s38, 132096
s_add_u32 s39, s60, 278528
buffer_load_dwordx4 v85, s[8:11], s39 offen lds
s_add_u32 m0, s38, 133120
s_add_u32 s39, s60, 294912
buffer_load_dwordx4 v84, s[8:11], s39 offen lds
s_add_u32 m0, s38, 134144
s_add_u32 s39, s60, 311296
buffer_load_dwordx4 v85, s[8:11], s39 offen lds
s_add_u32 m0, s38, 147456
s_add_u32 s39, s61, 262144
buffer_load_dwordx4 v84, s[8:11], s39 offen lds
s_add_u32 m0, s38, 148480
s_add_u32 s39, s61, 278528
buffer_load_dwordx4 v85, s[8:11], s39 offen lds
s_add_u32 m0, s38, 149504
s_add_u32 s39, s61, 294912
buffer_load_dwordx4 v84, s[8:11], s39 offen lds
s_add_u32 m0, s38, 150528
s_add_u32 s39, s61, 311296
buffer_load_dwordx4 v85, s[8:11], s39 offen lds
s_waitcnt lgkmcnt(0)
s_waitcnt vmcnt(8)
s_barrier
ds_read_b64_tr_b16 a[12:13], v80 offset:0
ds_read_b64_tr_b16 a[14:15], v80 offset:2048
ds_read_b64_tr_b16 a[44:45], v80 offset:4096
ds_read_b64_tr_b16 a[46:47], v80 offset:6144
ds_read_b64_tr_b16 a[76:77], v80 offset:8192
ds_read_b64_tr_b16 a[78:79], v80 offset:10240
ds_read_b64_tr_b16 a[108:109], v80 offset:12288
ds_read_b64_tr_b16 a[110:111], v80 offset:14336
ds_read_b64_tr_b16 a[140:141], v81 offset:0
ds_read_b64_tr_b16 a[142:143], v81 offset:2048
ds_read_b64_tr_b16 a[172:173], v81 offset:4096
ds_read_b64_tr_b16 a[174:175], v81 offset:6144
ds_read_b64_tr_b16 a[204:205], v81 offset:8192
ds_read_b64_tr_b16 a[206:207], v81 offset:10240
ds_read_b64_tr_b16 a[236:237], v81 offset:12288
ds_read_b64_tr_b16 a[238:239], v81 offset:14336
v_add_u32 v80, 32768, v80
v_add_u32 v81, 32768, v81
s_add_u32 m0, s38, 0
s_add_u32 s39, s60, 327680
buffer_load_dwordx4 v84, s[8:11], s39 offen lds
s_add_u32 m0, s38, 1024
s_add_u32 s39, s60, 344064
buffer_load_dwordx4 v85, s[8:11], s39 offen lds
s_add_u32 m0, s38, 2048
s_add_u32 s39, s60, 360448
buffer_load_dwordx4 v84, s[8:11], s39 offen lds
s_add_u32 m0, s38, 3072
s_add_u32 s39, s60, 376832
buffer_load_dwordx4 v85, s[8:11], s39 offen lds
s_add_u32 m0, s38, 16384
s_add_u32 s39, s61, 327680
buffer_load_dwordx4 v84, s[8:11], s39 offen lds
s_add_u32 m0, s38, 17408
s_add_u32 s39, s61, 344064
buffer_load_dwordx4 v85, s[8:11], s39 offen lds
s_add_u32 m0, s38, 18432
s_add_u32 s39, s61, 360448
buffer_load_dwordx4 v84, s[8:11], s39 offen lds
s_add_u32 m0, s38, 19456
s_add_u32 s39, s61, 376832
buffer_load_dwordx4 v85, s[8:11], s39 offen lds
s_waitcnt lgkmcnt(0)
s_waitcnt vmcnt(8)
s_barrier
ds_read_b64_tr_b16 a[16:17], v80 offset:0
ds_read_b64_tr_b16 a[18:19], v80 offset:2048
ds_read_b64_tr_b16 a[48:49], v80 offset:4096
ds_read_b64_tr_b16 a[50:51], v80 offset:6144
ds_read_b64_tr_b16 a[80:81], v80 offset:8192
ds_read_b64_tr_b16 a[82:83], v80 offset:10240
ds_read_b64_tr_b16 a[112:113], v80 offset:12288
ds_read_b64_tr_b16 a[114:115], v80 offset:14336
ds_read_b64_tr_b16 a[144:145], v81 offset:0
ds_read_b64_tr_b16 a[146:147], v81 offset:2048
ds_read_b64_tr_b16 a[176:177], v81 offset:4096
ds_read_b64_tr_b16 a[178:179], v81 offset:6144
ds_read_b64_tr_b16 a[208:209], v81 offset:8192
ds_read_b64_tr_b16 a[210:211], v81 offset:10240
ds_read_b64_tr_b16 a[240:241], v81 offset:12288
ds_read_b64_tr_b16 a[242:243], v81 offset:14336
v_add_u32 v80, -131072, v80
v_add_u32 v81, -131072, v81
s_add_u32 m0, s38, 32768
s_add_u32 s39, s60, 393216
buffer_load_dwordx4 v84, s[8:11], s39 offen lds
s_add_u32 m0, s38, 33792
s_add_u32 s39, s60, 409600
buffer_load_dwordx4 v85, s[8:11], s39 offen lds
s_add_u32 m0, s38, 34816
s_add_u32 s39, s60, 425984
buffer_load_dwordx4 v84, s[8:11], s39 offen lds
s_add_u32 m0, s38, 35840
s_add_u32 s39, s60, 442368
buffer_load_dwordx4 v85, s[8:11], s39 offen lds
s_add_u32 m0, s38, 49152
s_add_u32 s39, s61, 393216
buffer_load_dwordx4 v84, s[8:11], s39 offen lds
s_add_u32 m0, s38, 50176
s_add_u32 s39, s61, 409600
buffer_load_dwordx4 v85, s[8:11], s39 offen lds
s_add_u32 m0, s38, 51200
s_add_u32 s39, s61, 425984
buffer_load_dwordx4 v84, s[8:11], s39 offen lds
s_add_u32 m0, s38, 52224
s_add_u32 s39, s61, 442368
buffer_load_dwordx4 v85, s[8:11], s39 offen lds
s_waitcnt lgkmcnt(0)
s_waitcnt vmcnt(8)
s_barrier
ds_read_b64_tr_b16 a[20:21], v80 offset:0
ds_read_b64_tr_b16 a[22:23], v80 offset:2048
ds_read_b64_tr_b16 a[52:53], v80 offset:4096
ds_read_b64_tr_b16 a[54:55], v80 offset:6144
ds_read_b64_tr_b16 a[84:85], v80 offset:8192
ds_read_b64_tr_b16 a[86:87], v80 offset:10240
ds_read_b64_tr_b16 a[116:117], v80 offset:12288
ds_read_b64_tr_b16 a[118:119], v80 offset:14336
ds_read_b64_tr_b16 a[148:149], v81 offset:0
ds_read_b64_tr_b16 a[150:151], v81 offset:2048
ds_read_b64_tr_b16 a[180:181], v81 offset:4096
ds_read_b64_tr_b16 a[182:183], v81 offset:6144
ds_read_b64_tr_b16 a[212:213], v81 offset:8192
ds_read_b64_tr_b16 a[214:215], v81 offset:10240
ds_read_b64_tr_b16 a[244:245], v81 offset:12288
ds_read_b64_tr_b16 a[246:247], v81 offset:14336
v_add_u32 v80, 32768, v80
v_add_u32 v81, 32768, v81
s_add_u32 m0, s38, 65536
s_add_u32 s39, s60, 458752
buffer_load_dwordx4 v84, s[8:11], s39 offen lds
s_add_u32 m0, s38, 66560
s_add_u32 s39, s60, 475136
buffer_load_dwordx4 v85, s[8:11], s39 offen lds
s_add_u32 m0, s38, 67584
s_add_u32 s39, s60, 491520
buffer_load_dwordx4 v84, s[8:11], s39 offen lds
s_add_u32 m0, s38, 68608
s_add_u32 s39, s60, 507904
buffer_load_dwordx4 v85, s[8:11], s39 offen lds
s_add_u32 m0, s38, 81920
s_add_u32 s39, s61, 458752
buffer_load_dwordx4 v84, s[8:11], s39 offen lds
s_add_u32 m0, s38, 82944
s_add_u32 s39, s61, 475136
buffer_load_dwordx4 v85, s[8:11], s39 offen lds
s_add_u32 m0, s38, 83968
s_add_u32 s39, s61, 491520
buffer_load_dwordx4 v84, s[8:11], s39 offen lds
s_add_u32 m0, s38, 84992
s_add_u32 s39, s61, 507904
buffer_load_dwordx4 v85, s[8:11], s39 offen lds
s_waitcnt lgkmcnt(0)
s_waitcnt vmcnt(8)
s_barrier
ds_read_b64_tr_b16 a[24:25], v80 offset:0
ds_read_b64_tr_b16 a[26:27], v80 offset:2048
ds_read_b64_tr_b16 a[56:57], v80 offset:4096
ds_read_b64_tr_b16 a[58:59], v80 offset:6144
ds_read_b64_tr_b16 a[88:89], v80 offset:8192
ds_read_b64_tr_b16 a[90:91], v80 offset:10240
ds_read_b64_tr_b16 a[120:121], v80 offset:12288
ds_read_b64_tr_b16 a[122:123], v80 offset:14336
ds_read_b64_tr_b16 a[152:153], v81 offset:0
ds_read_b64_tr_b16 a[154:155], v81 offset:2048
ds_read_b64_tr_b16 a[184:185], v81 offset:4096
ds_read_b64_tr_b16 a[186:187], v81 offset:6144
ds_read_b64_tr_b16 a[216:217], v81 offset:8192
ds_read_b64_tr_b16 a[218:219], v81 offset:10240
ds_read_b64_tr_b16 a[248:249], v81 offset:12288
ds_read_b64_tr_b16 a[250:251], v81 offset:14336
v_add_u32 v80, 32768, v80
v_add_u32 v81, 32768, v81
s_waitcnt lgkmcnt(0)
s_waitcnt vmcnt(0)
s_barrier
ds_read_b64_tr_b16 a[28:29], v80 offset:0
ds_read_b64_tr_b16 a[30:31], v80 offset:2048
ds_read_b64_tr_b16 a[60:61], v80 offset:4096
ds_read_b64_tr_b16 a[62:63], v80 offset:6144
ds_read_b64_tr_b16 a[92:93], v80 offset:8192
ds_read_b64_tr_b16 a[94:95], v80 offset:10240
ds_read_b64_tr_b16 a[124:125], v80 offset:12288
ds_read_b64_tr_b16 a[126:127], v80 offset:14336
ds_read_b64_tr_b16 a[156:157], v81 offset:0
ds_read_b64_tr_b16 a[158:159], v81 offset:2048
ds_read_b64_tr_b16 a[188:189], v81 offset:4096
ds_read_b64_tr_b16 a[190:191], v81 offset:6144
ds_read_b64_tr_b16 a[220:221], v81 offset:8192
ds_read_b64_tr_b16 a[222:223], v81 offset:10240
ds_read_b64_tr_b16 a[252:253], v81 offset:12288
ds_read_b64_tr_b16 a[254:255], v81 offset:14336
v_add_u32 v80, 32768, v80
v_add_u32 v81, 32768, v81
s_waitcnt lgkmcnt(0)
s_barrier
s_load_dwordx2 s[16:17], s[0:1], 96
s_load_dwordx2 s[18:19], s[0:1], 88
v_mov_b32 v10, v4
s_add_u32 s60, s44, 32
s_waitcnt lgkmcnt(0)
s_mov_b32 s8, s16
s_and_b32 s9, s17, 0xffff
s_mov_b32 s10, 0xc00000
s_mov_b32 s11, 0x20000
s_mov_b32 s84, s18
s_and_b32 s85, s19, 0xffff
s_mov_b32 s86, 0x800
s_mov_b32 s87, 0x20000
v_lshrrev_b32 v2, 3, v0
v_and_b32 v3, 7, v0
v_mul_u32_u24 v4, 12288, v2
v_lshl_add_u32 v4, v3, 4, v4
v_lshlrev_b32 v5, 1, v2
v_mov_b32 v96, 0
v_mov_b32 v97, 0
v_mov_b32 v98, 0
v_mov_b32 v99, 0
v_mov_b32 v100, 0
v_mov_b32 v101, 0
v_mov_b32 v102, 0
v_mov_b32 v103, 0
buffer_load_ushort v32, v5, s[84:87], 0 offen offset:0
buffer_load_ushort v33, v5, s[84:87], 0 offen offset:64
buffer_load_ushort v34, v5, s[84:87], 0 offen offset:128
buffer_load_ushort v35, v5, s[84:87], 0 offen offset:192
buffer_load_ushort v36, v5, s[84:87], 0 offen offset:256
buffer_load_ushort v37, v5, s[84:87], 0 offen offset:320
buffer_load_ushort v38, v5, s[84:87], 0 offen offset:384
buffer_load_ushort v39, v5, s[84:87], 0 offen offset:448
buffer_load_ushort v40, v5, s[84:87], 0 offen offset:512
buffer_load_ushort v41, v5, s[84:87], 0 offen offset:576
buffer_load_ushort v42, v5, s[84:87], 0 offen offset:640
buffer_load_ushort v43, v5, s[84:87], 0 offen offset:704
buffer_load_ushort v44, v5, s[84:87], 0 offen offset:768
buffer_load_ushort v45, v5, s[84:87], 0 offen offset:832
buffer_load_ushort v46, v5, s[84:87], 0 offen offset:896
buffer_load_ushort v47, v5, s[84:87], 0 offen offset:960
buffer_load_ushort v48, v5, s[84:87], 0 offen offset:1024
buffer_load_ushort v49, v5, s[84:87], 0 offen offset:1088
buffer_load_ushort v50, v5, s[84:87], 0 offen offset:1152
buffer_load_ushort v51, v5, s[84:87], 0 offen offset:1216
buffer_load_ushort v52, v5, s[84:87], 0 offen offset:1280
buffer_load_ushort v53, v5, s[84:87], 0 offen offset:1344
buffer_load_ushort v54, v5, s[84:87], 0 offen offset:1408
buffer_load_ushort v55, v5, s[84:87], 0 offen offset:1472
buffer_load_ushort v56, v5, s[84:87], 0 offen offset:1536
buffer_load_ushort v57, v5, s[84:87], 0 offen offset:1600
buffer_load_ushort v58, v5, s[84:87], 0 offen offset:1664
buffer_load_ushort v59, v5, s[84:87], 0 offen offset:1728
buffer_load_ushort v60, v5, s[84:87], 0 offen offset:1792
buffer_load_ushort v61, v5, s[84:87], 0 offen offset:1856
buffer_load_ushort v62, v5, s[84:87], 0 offen offset:1920
buffer_load_ushort v63, v5, s[84:87], 0 offen offset:1984
s_lshl_b32 s43, s60, 7
s_waitcnt vmcnt(1)
buffer_load_dwordx4 v[128:131], v4, s[8:11], s43 offen
s_add_u32 s43, s43, 393216
buffer_load_dwordx4 v[132:135], v4, s[8:11], s43 offen
s_add_u32 s43, s43, 393216
buffer_load_dwordx4 v[136:139], v4, s[8:11], s43 offen
s_add_u32 s43, s43, 393216
buffer_load_dwordx4 v[140:143], v4, s[8:11], s43 offen
s_add_u32 s43, s43, 393216
buffer_load_dwordx4 v[144:147], v4, s[8:11], s43 offen
s_add_u32 s43, s43, 393216
buffer_load_dwordx4 v[148:151], v4, s[8:11], s43 offen
s_add_u32 s43, s43, 393216
buffer_load_dwordx4 v[152:155], v4, s[8:11], s43 offen
s_add_u32 s43, s43, 393216
buffer_load_dwordx4 v[156:159], v4, s[8:11], s43 offen
s_add_u32 s43, s43, 393216
buffer_load_dwordx4 v[160:163], v4, s[8:11], s43 offen
s_add_u32 s43, s43, 393216
buffer_load_dwordx4 v[164:167], v4, s[8:11], s43 offen
s_add_u32 s43, s43, 393216
buffer_load_dwordx4 v[168:171], v4, s[8:11], s43 offen
s_add_u32 s43, s43, 393216
buffer_load_dwordx4 v[172:175], v4, s[8:11], s43 offen
s_add_u32 s43, s43, 393216
buffer_load_dwordx4 v[176:179], v4, s[8:11], s43 offen
s_add_u32 s43, s43, 393216
buffer_load_dwordx4 v[180:183], v4, s[8:11], s43 offen
s_add_u32 s43, s43, 393216
buffer_load_dwordx4 v[184:187], v4, s[8:11], s43 offen
s_add_u32 s43, s43, 393216
buffer_load_dwordx4 v[188:191], v4, s[8:11], s43 offen
s_add_u32 s43, s43, 393216
buffer_load_dwordx4 v[192:195], v4, s[8:11], s43 offen
s_add_u32 s43, s43, 393216
buffer_load_dwordx4 v[196:199], v4, s[8:11], s43 offen
s_add_u32 s43, s43, 393216
buffer_load_dwordx4 v[200:203], v4, s[8:11], s43 offen
s_add_u32 s43, s43, 393216
buffer_load_dwordx4 v[204:207], v4, s[8:11], s43 offen
s_add_u32 s43, s43, 393216
buffer_load_dwordx4 v[208:211], v4, s[8:11], s43 offen
s_add_u32 s43, s43, 393216
buffer_load_dwordx4 v[212:215], v4, s[8:11], s43 offen
s_add_u32 s43, s43, 393216
buffer_load_dwordx4 v[216:219], v4, s[8:11], s43 offen
s_add_u32 s43, s43, 393216
buffer_load_dwordx4 v[220:223], v4, s[8:11], s43 offen
s_add_u32 s43, s43, 393216
buffer_load_dwordx4 v[224:227], v4, s[8:11], s43 offen
s_add_u32 s43, s43, 393216
buffer_load_dwordx4 v[228:231], v4, s[8:11], s43 offen
s_add_u32 s43, s43, 393216
buffer_load_dwordx4 v[232:235], v4, s[8:11], s43 offen
s_add_u32 s43, s43, 393216
buffer_load_dwordx4 v[236:239], v4, s[8:11], s43 offen
s_add_u32 s43, s43, 393216
buffer_load_dwordx4 v[240:243], v4, s[8:11], s43 offen
s_add_u32 s43, s43, 393216
buffer_load_dwordx4 v[244:247], v4, s[8:11], s43 offen
s_add_u32 s43, s43, 393216
buffer_load_dwordx4 v[248:251], v4, s[8:11], s43 offen
s_add_u32 s43, s43, 393216
buffer_load_dwordx4 v[252:255], v4, s[8:11], s43 offen
s_add_u32 s43, s43, 393216
s_waitcnt vmcnt(32)
v_lshlrev_b32 v32, 16, v32
v_mul_f32 v104, 0xbfb8aa3b, v32
v_exp_f32 v104, v104
s_nop 0
v_add_f32 v104, 1.0, v104
v_rcp_f32 v104, v104
s_nop 0
v_mul_f32 v104, v104, v32
v_cvt_pk_bf16_f32 v32, 0, v104
v_lshlrev_b32 v33, 16, v33
v_mul_f32 v104, 0xbfb8aa3b, v33
v_exp_f32 v104, v104
s_nop 0
v_add_f32 v104, 1.0, v104
v_rcp_f32 v104, v104
s_nop 0
v_mul_f32 v104, v104, v33
v_cvt_pk_bf16_f32 v33, 0, v104
v_lshlrev_b32 v34, 16, v34
v_mul_f32 v104, 0xbfb8aa3b, v34
v_exp_f32 v104, v104
s_nop 0
v_add_f32 v104, 1.0, v104
v_rcp_f32 v104, v104
s_nop 0
v_mul_f32 v104, v104, v34
v_cvt_pk_bf16_f32 v34, 0, v104
v_lshlrev_b32 v35, 16, v35
v_mul_f32 v104, 0xbfb8aa3b, v35
v_exp_f32 v104, v104
s_nop 0
v_add_f32 v104, 1.0, v104
v_rcp_f32 v104, v104
s_nop 0
v_mul_f32 v104, v104, v35
v_cvt_pk_bf16_f32 v35, 0, v104
v_lshlrev_b32 v36, 16, v36
v_mul_f32 v104, 0xbfb8aa3b, v36
v_exp_f32 v104, v104
s_nop 0
v_add_f32 v104, 1.0, v104
v_rcp_f32 v104, v104
s_nop 0
v_mul_f32 v104, v104, v36
v_cvt_pk_bf16_f32 v36, 0, v104
v_lshlrev_b32 v37, 16, v37
v_mul_f32 v104, 0xbfb8aa3b, v37
v_exp_f32 v104, v104
s_nop 0
v_add_f32 v104, 1.0, v104
v_rcp_f32 v104, v104
s_nop 0
v_mul_f32 v104, v104, v37
v_cvt_pk_bf16_f32 v37, 0, v104
v_lshlrev_b32 v38, 16, v38
v_mul_f32 v104, 0xbfb8aa3b, v38
v_exp_f32 v104, v104
s_nop 0
v_add_f32 v104, 1.0, v104
v_rcp_f32 v104, v104
s_nop 0
v_mul_f32 v104, v104, v38
v_cvt_pk_bf16_f32 v38, 0, v104
v_lshlrev_b32 v39, 16, v39
v_mul_f32 v104, 0xbfb8aa3b, v39
v_exp_f32 v104, v104
s_nop 0
v_add_f32 v104, 1.0, v104
v_rcp_f32 v104, v104
s_nop 0
v_mul_f32 v104, v104, v39
v_cvt_pk_bf16_f32 v39, 0, v104
v_lshlrev_b32 v40, 16, v40
v_mul_f32 v104, 0xbfb8aa3b, v40
v_exp_f32 v104, v104
s_nop 0
v_add_f32 v104, 1.0, v104
v_rcp_f32 v104, v104
s_nop 0
v_mul_f32 v104, v104, v40
v_cvt_pk_bf16_f32 v40, 0, v104
v_lshlrev_b32 v41, 16, v41
v_mul_f32 v104, 0xbfb8aa3b, v41
v_exp_f32 v104, v104
s_nop 0
v_add_f32 v104, 1.0, v104
v_rcp_f32 v104, v104
s_nop 0
v_mul_f32 v104, v104, v41
v_cvt_pk_bf16_f32 v41, 0, v104
v_lshlrev_b32 v42, 16, v42
v_mul_f32 v104, 0xbfb8aa3b, v42
v_exp_f32 v104, v104
s_nop 0
v_add_f32 v104, 1.0, v104
v_rcp_f32 v104, v104
s_nop 0
v_mul_f32 v104, v104, v42
v_cvt_pk_bf16_f32 v42, 0, v104
v_lshlrev_b32 v43, 16, v43
v_mul_f32 v104, 0xbfb8aa3b, v43
v_exp_f32 v104, v104
s_nop 0
v_add_f32 v104, 1.0, v104
v_rcp_f32 v104, v104
s_nop 0
v_mul_f32 v104, v104, v43
v_cvt_pk_bf16_f32 v43, 0, v104
v_lshlrev_b32 v44, 16, v44
v_mul_f32 v104, 0xbfb8aa3b, v44
v_exp_f32 v104, v104
s_nop 0
v_add_f32 v104, 1.0, v104
v_rcp_f32 v104, v104
s_nop 0
v_mul_f32 v104, v104, v44
v_cvt_pk_bf16_f32 v44, 0, v104
v_lshlrev_b32 v45, 16, v45
v_mul_f32 v104, 0xbfb8aa3b, v45
v_exp_f32 v104, v104
s_nop 0
v_add_f32 v104, 1.0, v104
v_rcp_f32 v104, v104
s_nop 0
v_mul_f32 v104, v104, v45
v_cvt_pk_bf16_f32 v45, 0, v104
v_lshlrev_b32 v46, 16, v46
v_mul_f32 v104, 0xbfb8aa3b, v46
v_exp_f32 v104, v104
s_nop 0
v_add_f32 v104, 1.0, v104
v_rcp_f32 v104, v104
s_nop 0
v_mul_f32 v104, v104, v46
v_cvt_pk_bf16_f32 v46, 0, v104
v_lshlrev_b32 v47, 16, v47
v_mul_f32 v104, 0xbfb8aa3b, v47
v_exp_f32 v104, v104
s_nop 0
v_add_f32 v104, 1.0, v104
v_rcp_f32 v104, v104
s_nop 0
v_mul_f32 v104, v104, v47
v_cvt_pk_bf16_f32 v47, 0, v104
v_lshlrev_b32 v48, 16, v48
v_mul_f32 v104, 0xbfb8aa3b, v48
v_exp_f32 v104, v104
s_nop 0
v_add_f32 v104, 1.0, v104
v_rcp_f32 v104, v104
s_nop 0
v_mul_f32 v104, v104, v48
v_cvt_pk_bf16_f32 v48, 0, v104
v_lshlrev_b32 v49, 16, v49
v_mul_f32 v104, 0xbfb8aa3b, v49
v_exp_f32 v104, v104
s_nop 0
v_add_f32 v104, 1.0, v104
v_rcp_f32 v104, v104
s_nop 0
v_mul_f32 v104, v104, v49
v_cvt_pk_bf16_f32 v49, 0, v104
v_lshlrev_b32 v50, 16, v50
v_mul_f32 v104, 0xbfb8aa3b, v50
v_exp_f32 v104, v104
s_nop 0
v_add_f32 v104, 1.0, v104
v_rcp_f32 v104, v104
s_nop 0
v_mul_f32 v104, v104, v50
v_cvt_pk_bf16_f32 v50, 0, v104
v_lshlrev_b32 v51, 16, v51
v_mul_f32 v104, 0xbfb8aa3b, v51
v_exp_f32 v104, v104
s_nop 0
v_add_f32 v104, 1.0, v104
v_rcp_f32 v104, v104
s_nop 0
v_mul_f32 v104, v104, v51
v_cvt_pk_bf16_f32 v51, 0, v104
v_lshlrev_b32 v52, 16, v52
v_mul_f32 v104, 0xbfb8aa3b, v52
v_exp_f32 v104, v104
s_nop 0
v_add_f32 v104, 1.0, v104
v_rcp_f32 v104, v104
s_nop 0
v_mul_f32 v104, v104, v52
v_cvt_pk_bf16_f32 v52, 0, v104
v_lshlrev_b32 v53, 16, v53
v_mul_f32 v104, 0xbfb8aa3b, v53
v_exp_f32 v104, v104
s_nop 0
v_add_f32 v104, 1.0, v104
v_rcp_f32 v104, v104
s_nop 0
v_mul_f32 v104, v104, v53
v_cvt_pk_bf16_f32 v53, 0, v104
v_lshlrev_b32 v54, 16, v54
v_mul_f32 v104, 0xbfb8aa3b, v54
v_exp_f32 v104, v104
s_nop 0
v_add_f32 v104, 1.0, v104
v_rcp_f32 v104, v104
s_nop 0
v_mul_f32 v104, v104, v54
v_cvt_pk_bf16_f32 v54, 0, v104
v_lshlrev_b32 v55, 16, v55
v_mul_f32 v104, 0xbfb8aa3b, v55
v_exp_f32 v104, v104
s_nop 0
v_add_f32 v104, 1.0, v104
v_rcp_f32 v104, v104
s_nop 0
v_mul_f32 v104, v104, v55
v_cvt_pk_bf16_f32 v55, 0, v104
v_lshlrev_b32 v56, 16, v56
v_mul_f32 v104, 0xbfb8aa3b, v56
v_exp_f32 v104, v104
s_nop 0
v_add_f32 v104, 1.0, v104
v_rcp_f32 v104, v104
s_nop 0
v_mul_f32 v104, v104, v56
v_cvt_pk_bf16_f32 v56, 0, v104
v_lshlrev_b32 v57, 16, v57
v_mul_f32 v104, 0xbfb8aa3b, v57
v_exp_f32 v104, v104
s_nop 0
v_add_f32 v104, 1.0, v104
v_rcp_f32 v104, v104
s_nop 0
v_mul_f32 v104, v104, v57
v_cvt_pk_bf16_f32 v57, 0, v104
v_lshlrev_b32 v58, 16, v58
v_mul_f32 v104, 0xbfb8aa3b, v58
v_exp_f32 v104, v104
s_nop 0
v_add_f32 v104, 1.0, v104
v_rcp_f32 v104, v104
s_nop 0
v_mul_f32 v104, v104, v58
v_cvt_pk_bf16_f32 v58, 0, v104
v_lshlrev_b32 v59, 16, v59
v_mul_f32 v104, 0xbfb8aa3b, v59
v_exp_f32 v104, v104
s_nop 0
v_add_f32 v104, 1.0, v104
v_rcp_f32 v104, v104
s_nop 0
v_mul_f32 v104, v104, v59
v_cvt_pk_bf16_f32 v59, 0, v104
v_lshlrev_b32 v60, 16, v60
v_mul_f32 v104, 0xbfb8aa3b, v60
v_exp_f32 v104, v104
s_nop 0
v_add_f32 v104, 1.0, v104
v_rcp_f32 v104, v104
s_nop 0
v_mul_f32 v104, v104, v60
v_cvt_pk_bf16_f32 v60, 0, v104
v_lshlrev_b32 v61, 16, v61
v_mul_f32 v104, 0xbfb8aa3b, v61
v_exp_f32 v104, v104
s_nop 0
v_add_f32 v104, 1.0, v104
v_rcp_f32 v104, v104
s_nop 0
v_mul_f32 v104, v104, v61
v_cvt_pk_bf16_f32 v61, 0, v104
v_lshlrev_b32 v62, 16, v62
v_mul_f32 v104, 0xbfb8aa3b, v62
v_exp_f32 v104, v104
s_nop 0
v_add_f32 v104, 1.0, v104
v_rcp_f32 v104, v104
s_nop 0
v_mul_f32 v104, v104, v62
v_cvt_pk_bf16_f32 v62, 0, v104
v_lshlrev_b32 v63, 16, v63
v_mul_f32 v104, 0xbfb8aa3b, v63
v_exp_f32 v104, v104
s_nop 0
v_add_f32 v104, 1.0, v104
v_rcp_f32 v104, v104
s_nop 0
v_mul_f32 v104, v104, v63
v_cvt_pk_bf16_f32 v63, 0, v104
s_xor_b32 s43, s60, 0x62
s_lshl_b32 s43, s43, 7
s_waitcnt vmcnt(31)
v_lshlrev_b32 v104, 16, v128
v_and_b32 v105, 0xffff0000, v128
v_fmac_f32 v96, v104, v32
v_fmac_f32 v97, v105, v32
v_lshlrev_b32 v104, 16, v129
v_and_b32 v105, 0xffff0000, v129
v_fmac_f32 v98, v104, v32
v_fmac_f32 v99, v105, v32
v_lshlrev_b32 v104, 16, v130
v_and_b32 v105, 0xffff0000, v130
v_fmac_f32 v100, v104, v32
v_fmac_f32 v101, v105, v32
v_lshlrev_b32 v104, 16, v131
v_and_b32 v105, 0xffff0000, v131
v_fmac_f32 v102, v104, v32
v_fmac_f32 v103, v105, v32
buffer_load_dwordx4 v[128:131], v4, s[8:11], s43 offen
s_add_u32 s43, s43, 393216
s_waitcnt vmcnt(31)
v_lshlrev_b32 v104, 16, v132
v_and_b32 v105, 0xffff0000, v132
v_fmac_f32 v96, v104, v33
v_fmac_f32 v97, v105, v33
v_lshlrev_b32 v104, 16, v133
v_and_b32 v105, 0xffff0000, v133
v_fmac_f32 v98, v104, v33
v_fmac_f32 v99, v105, v33
v_lshlrev_b32 v104, 16, v134
v_and_b32 v105, 0xffff0000, v134
v_fmac_f32 v100, v104, v33
v_fmac_f32 v101, v105, v33
v_lshlrev_b32 v104, 16, v135
v_and_b32 v105, 0xffff0000, v135
v_fmac_f32 v102, v104, v33
v_fmac_f32 v103, v105, v33
buffer_load_dwordx4 v[132:135], v4, s[8:11], s43 offen
s_add_u32 s43, s43, 393216
s_waitcnt vmcnt(31)
v_lshlrev_b32 v104, 16, v136
v_and_b32 v105, 0xffff0000, v136
v_fmac_f32 v96, v104, v34
v_fmac_f32 v97, v105, v34
v_lshlrev_b32 v104, 16, v137
v_and_b32 v105, 0xffff0000, v137
v_fmac_f32 v98, v104, v34
v_fmac_f32 v99, v105, v34
v_lshlrev_b32 v104, 16, v138
v_and_b32 v105, 0xffff0000, v138
v_fmac_f32 v100, v104, v34
v_fmac_f32 v101, v105, v34
v_lshlrev_b32 v104, 16, v139
v_and_b32 v105, 0xffff0000, v139
v_fmac_f32 v102, v104, v34
v_fmac_f32 v103, v105, v34
buffer_load_dwordx4 v[136:139], v4, s[8:11], s43 offen
s_add_u32 s43, s43, 393216
s_waitcnt vmcnt(31)
v_lshlrev_b32 v104, 16, v140
v_and_b32 v105, 0xffff0000, v140
v_fmac_f32 v96, v104, v35
v_fmac_f32 v97, v105, v35
v_lshlrev_b32 v104, 16, v141
v_and_b32 v105, 0xffff0000, v141
v_fmac_f32 v98, v104, v35
v_fmac_f32 v99, v105, v35
v_lshlrev_b32 v104, 16, v142
v_and_b32 v105, 0xffff0000, v142
v_fmac_f32 v100, v104, v35
v_fmac_f32 v101, v105, v35
v_lshlrev_b32 v104, 16, v143
v_and_b32 v105, 0xffff0000, v143
v_fmac_f32 v102, v104, v35
v_fmac_f32 v103, v105, v35
buffer_load_dwordx4 v[140:143], v4, s[8:11], s43 offen
s_add_u32 s43, s43, 393216
s_waitcnt vmcnt(31)
v_lshlrev_b32 v104, 16, v144
v_and_b32 v105, 0xffff0000, v144
v_fmac_f32 v96, v104, v36
v_fmac_f32 v97, v105, v36
v_lshlrev_b32 v104, 16, v145
v_and_b32 v105, 0xffff0000, v145
v_fmac_f32 v98, v104, v36
v_fmac_f32 v99, v105, v36
v_lshlrev_b32 v104, 16, v146
v_and_b32 v105, 0xffff0000, v146
v_fmac_f32 v100, v104, v36
v_fmac_f32 v101, v105, v36
v_lshlrev_b32 v104, 16, v147
v_and_b32 v105, 0xffff0000, v147
v_fmac_f32 v102, v104, v36
v_fmac_f32 v103, v105, v36
buffer_load_dwordx4 v[144:147], v4, s[8:11], s43 offen
s_add_u32 s43, s43, 393216
s_waitcnt vmcnt(31)
v_lshlrev_b32 v104, 16, v148
v_and_b32 v105, 0xffff0000, v148
v_fmac_f32 v96, v104, v37
v_fmac_f32 v97, v105, v37
v_lshlrev_b32 v104, 16, v149
v_and_b32 v105, 0xffff0000, v149
v_fmac_f32 v98, v104, v37
v_fmac_f32 v99, v105, v37
v_lshlrev_b32 v104, 16, v150
v_and_b32 v105, 0xffff0000, v150
v_fmac_f32 v100, v104, v37
v_fmac_f32 v101, v105, v37
v_lshlrev_b32 v104, 16, v151
v_and_b32 v105, 0xffff0000, v151
v_fmac_f32 v102, v104, v37
v_fmac_f32 v103, v105, v37
buffer_load_dwordx4 v[148:151], v4, s[8:11], s43 offen
s_add_u32 s43, s43, 393216
s_waitcnt vmcnt(31)
v_lshlrev_b32 v104, 16, v152
v_and_b32 v105, 0xffff0000, v152
v_fmac_f32 v96, v104, v38
v_fmac_f32 v97, v105, v38
v_lshlrev_b32 v104, 16, v153
v_and_b32 v105, 0xffff0000, v153
v_fmac_f32 v98, v104, v38
v_fmac_f32 v99, v105, v38
v_lshlrev_b32 v104, 16, v154
v_and_b32 v105, 0xffff0000, v154
v_fmac_f32 v100, v104, v38
v_fmac_f32 v101, v105, v38
v_lshlrev_b32 v104, 16, v155
v_and_b32 v105, 0xffff0000, v155
v_fmac_f32 v102, v104, v38
v_fmac_f32 v103, v105, v38
buffer_load_dwordx4 v[152:155], v4, s[8:11], s43 offen
s_add_u32 s43, s43, 393216
s_waitcnt vmcnt(31)
v_lshlrev_b32 v104, 16, v156
v_and_b32 v105, 0xffff0000, v156
v_fmac_f32 v96, v104, v39
v_fmac_f32 v97, v105, v39
v_lshlrev_b32 v104, 16, v157
v_and_b32 v105, 0xffff0000, v157
v_fmac_f32 v98, v104, v39
v_fmac_f32 v99, v105, v39
v_lshlrev_b32 v104, 16, v158
v_and_b32 v105, 0xffff0000, v158
v_fmac_f32 v100, v104, v39
v_fmac_f32 v101, v105, v39
v_lshlrev_b32 v104, 16, v159
v_and_b32 v105, 0xffff0000, v159
v_fmac_f32 v102, v104, v39
v_fmac_f32 v103, v105, v39
buffer_load_dwordx4 v[156:159], v4, s[8:11], s43 offen
s_add_u32 s43, s43, 393216
s_waitcnt vmcnt(31)
v_lshlrev_b32 v104, 16, v160
v_and_b32 v105, 0xffff0000, v160
v_fmac_f32 v96, v104, v40
v_fmac_f32 v97, v105, v40
v_lshlrev_b32 v104, 16, v161
v_and_b32 v105, 0xffff0000, v161
v_fmac_f32 v98, v104, v40
v_fmac_f32 v99, v105, v40
v_lshlrev_b32 v104, 16, v162
v_and_b32 v105, 0xffff0000, v162
v_fmac_f32 v100, v104, v40
v_fmac_f32 v101, v105, v40
v_lshlrev_b32 v104, 16, v163
v_and_b32 v105, 0xffff0000, v163
v_fmac_f32 v102, v104, v40
v_fmac_f32 v103, v105, v40
buffer_load_dwordx4 v[160:163], v4, s[8:11], s43 offen
s_add_u32 s43, s43, 393216
s_waitcnt vmcnt(31)
v_lshlrev_b32 v104, 16, v164
v_and_b32 v105, 0xffff0000, v164
v_fmac_f32 v96, v104, v41
v_fmac_f32 v97, v105, v41
v_lshlrev_b32 v104, 16, v165
v_and_b32 v105, 0xffff0000, v165
v_fmac_f32 v98, v104, v41
v_fmac_f32 v99, v105, v41
v_lshlrev_b32 v104, 16, v166
v_and_b32 v105, 0xffff0000, v166
v_fmac_f32 v100, v104, v41
v_fmac_f32 v101, v105, v41
v_lshlrev_b32 v104, 16, v167
v_and_b32 v105, 0xffff0000, v167
v_fmac_f32 v102, v104, v41
v_fmac_f32 v103, v105, v41
buffer_load_dwordx4 v[164:167], v4, s[8:11], s43 offen
s_add_u32 s43, s43, 393216
s_waitcnt vmcnt(31)
v_lshlrev_b32 v104, 16, v168
v_and_b32 v105, 0xffff0000, v168
v_fmac_f32 v96, v104, v42
v_fmac_f32 v97, v105, v42
v_lshlrev_b32 v104, 16, v169
v_and_b32 v105, 0xffff0000, v169
v_fmac_f32 v98, v104, v42
v_fmac_f32 v99, v105, v42
v_lshlrev_b32 v104, 16, v170
v_and_b32 v105, 0xffff0000, v170
v_fmac_f32 v100, v104, v42
v_fmac_f32 v101, v105, v42
v_lshlrev_b32 v104, 16, v171
v_and_b32 v105, 0xffff0000, v171
v_fmac_f32 v102, v104, v42
v_fmac_f32 v103, v105, v42
buffer_load_dwordx4 v[168:171], v4, s[8:11], s43 offen
s_add_u32 s43, s43, 393216
s_waitcnt vmcnt(31)
v_lshlrev_b32 v104, 16, v172
v_and_b32 v105, 0xffff0000, v172
v_fmac_f32 v96, v104, v43
v_fmac_f32 v97, v105, v43
v_lshlrev_b32 v104, 16, v173
v_and_b32 v105, 0xffff0000, v173
v_fmac_f32 v98, v104, v43
v_fmac_f32 v99, v105, v43
v_lshlrev_b32 v104, 16, v174
v_and_b32 v105, 0xffff0000, v174
v_fmac_f32 v100, v104, v43
v_fmac_f32 v101, v105, v43
v_lshlrev_b32 v104, 16, v175
v_and_b32 v105, 0xffff0000, v175
v_fmac_f32 v102, v104, v43
v_fmac_f32 v103, v105, v43
buffer_load_dwordx4 v[172:175], v4, s[8:11], s43 offen
s_add_u32 s43, s43, 393216
s_waitcnt vmcnt(31)
v_lshlrev_b32 v104, 16, v176
v_and_b32 v105, 0xffff0000, v176
v_fmac_f32 v96, v104, v44
v_fmac_f32 v97, v105, v44
v_lshlrev_b32 v104, 16, v177
v_and_b32 v105, 0xffff0000, v177
v_fmac_f32 v98, v104, v44
v_fmac_f32 v99, v105, v44
v_lshlrev_b32 v104, 16, v178
v_and_b32 v105, 0xffff0000, v178
v_fmac_f32 v100, v104, v44
v_fmac_f32 v101, v105, v44
v_lshlrev_b32 v104, 16, v179
v_and_b32 v105, 0xffff0000, v179
v_fmac_f32 v102, v104, v44
v_fmac_f32 v103, v105, v44
buffer_load_dwordx4 v[176:179], v4, s[8:11], s43 offen
s_add_u32 s43, s43, 393216
s_waitcnt vmcnt(31)
v_lshlrev_b32 v104, 16, v180
v_and_b32 v105, 0xffff0000, v180
v_fmac_f32 v96, v104, v45
v_fmac_f32 v97, v105, v45
v_lshlrev_b32 v104, 16, v181
v_and_b32 v105, 0xffff0000, v181
v_fmac_f32 v98, v104, v45
v_fmac_f32 v99, v105, v45
v_lshlrev_b32 v104, 16, v182
v_and_b32 v105, 0xffff0000, v182
v_fmac_f32 v100, v104, v45
v_fmac_f32 v101, v105, v45
v_lshlrev_b32 v104, 16, v183
v_and_b32 v105, 0xffff0000, v183
v_fmac_f32 v102, v104, v45
v_fmac_f32 v103, v105, v45
buffer_load_dwordx4 v[180:183], v4, s[8:11], s43 offen
s_add_u32 s43, s43, 393216
s_waitcnt vmcnt(31)
v_lshlrev_b32 v104, 16, v184
v_and_b32 v105, 0xffff0000, v184
v_fmac_f32 v96, v104, v46
v_fmac_f32 v97, v105, v46
v_lshlrev_b32 v104, 16, v185
v_and_b32 v105, 0xffff0000, v185
v_fmac_f32 v98, v104, v46
v_fmac_f32 v99, v105, v46
v_lshlrev_b32 v104, 16, v186
v_and_b32 v105, 0xffff0000, v186
v_fmac_f32 v100, v104, v46
v_fmac_f32 v101, v105, v46
v_lshlrev_b32 v104, 16, v187
v_and_b32 v105, 0xffff0000, v187
v_fmac_f32 v102, v104, v46
v_fmac_f32 v103, v105, v46
buffer_load_dwordx4 v[184:187], v4, s[8:11], s43 offen
s_add_u32 s43, s43, 393216
s_waitcnt vmcnt(31)
v_lshlrev_b32 v104, 16, v188
v_and_b32 v105, 0xffff0000, v188
v_fmac_f32 v96, v104, v47
v_fmac_f32 v97, v105, v47
v_lshlrev_b32 v104, 16, v189
v_and_b32 v105, 0xffff0000, v189
v_fmac_f32 v98, v104, v47
v_fmac_f32 v99, v105, v47
v_lshlrev_b32 v104, 16, v190
v_and_b32 v105, 0xffff0000, v190
v_fmac_f32 v100, v104, v47
v_fmac_f32 v101, v105, v47
v_lshlrev_b32 v104, 16, v191
v_and_b32 v105, 0xffff0000, v191
v_fmac_f32 v102, v104, v47
v_fmac_f32 v103, v105, v47
buffer_load_dwordx4 v[188:191], v4, s[8:11], s43 offen
s_add_u32 s43, s43, 393216
s_waitcnt vmcnt(31)
v_lshlrev_b32 v104, 16, v192
v_and_b32 v105, 0xffff0000, v192
v_fmac_f32 v96, v104, v48
v_fmac_f32 v97, v105, v48
v_lshlrev_b32 v104, 16, v193
v_and_b32 v105, 0xffff0000, v193
v_fmac_f32 v98, v104, v48
v_fmac_f32 v99, v105, v48
v_lshlrev_b32 v104, 16, v194
v_and_b32 v105, 0xffff0000, v194
v_fmac_f32 v100, v104, v48
v_fmac_f32 v101, v105, v48
v_lshlrev_b32 v104, 16, v195
v_and_b32 v105, 0xffff0000, v195
v_fmac_f32 v102, v104, v48
v_fmac_f32 v103, v105, v48
buffer_load_dwordx4 v[192:195], v4, s[8:11], s43 offen
s_add_u32 s43, s43, 393216
s_waitcnt vmcnt(31)
v_lshlrev_b32 v104, 16, v196
v_and_b32 v105, 0xffff0000, v196
v_fmac_f32 v96, v104, v49
v_fmac_f32 v97, v105, v49
v_lshlrev_b32 v104, 16, v197
v_and_b32 v105, 0xffff0000, v197
v_fmac_f32 v98, v104, v49
v_fmac_f32 v99, v105, v49
v_lshlrev_b32 v104, 16, v198
v_and_b32 v105, 0xffff0000, v198
v_fmac_f32 v100, v104, v49
v_fmac_f32 v101, v105, v49
v_lshlrev_b32 v104, 16, v199
v_and_b32 v105, 0xffff0000, v199
v_fmac_f32 v102, v104, v49
v_fmac_f32 v103, v105, v49
buffer_load_dwordx4 v[196:199], v4, s[8:11], s43 offen
s_add_u32 s43, s43, 393216
s_waitcnt vmcnt(31)
v_lshlrev_b32 v104, 16, v200
v_and_b32 v105, 0xffff0000, v200
v_fmac_f32 v96, v104, v50
v_fmac_f32 v97, v105, v50
v_lshlrev_b32 v104, 16, v201
v_and_b32 v105, 0xffff0000, v201
v_fmac_f32 v98, v104, v50
v_fmac_f32 v99, v105, v50
v_lshlrev_b32 v104, 16, v202
v_and_b32 v105, 0xffff0000, v202
v_fmac_f32 v100, v104, v50
v_fmac_f32 v101, v105, v50
v_lshlrev_b32 v104, 16, v203
v_and_b32 v105, 0xffff0000, v203
v_fmac_f32 v102, v104, v50
v_fmac_f32 v103, v105, v50
buffer_load_dwordx4 v[200:203], v4, s[8:11], s43 offen
s_add_u32 s43, s43, 393216
s_waitcnt vmcnt(31)
v_lshlrev_b32 v104, 16, v204
v_and_b32 v105, 0xffff0000, v204
v_fmac_f32 v96, v104, v51
v_fmac_f32 v97, v105, v51
v_lshlrev_b32 v104, 16, v205
v_and_b32 v105, 0xffff0000, v205
v_fmac_f32 v98, v104, v51
v_fmac_f32 v99, v105, v51
v_lshlrev_b32 v104, 16, v206
v_and_b32 v105, 0xffff0000, v206
v_fmac_f32 v100, v104, v51
v_fmac_f32 v101, v105, v51
v_lshlrev_b32 v104, 16, v207
v_and_b32 v105, 0xffff0000, v207
v_fmac_f32 v102, v104, v51
v_fmac_f32 v103, v105, v51
buffer_load_dwordx4 v[204:207], v4, s[8:11], s43 offen
s_add_u32 s43, s43, 393216
s_waitcnt vmcnt(31)
v_lshlrev_b32 v104, 16, v208
v_and_b32 v105, 0xffff0000, v208
v_fmac_f32 v96, v104, v52
v_fmac_f32 v97, v105, v52
v_lshlrev_b32 v104, 16, v209
v_and_b32 v105, 0xffff0000, v209
v_fmac_f32 v98, v104, v52
v_fmac_f32 v99, v105, v52
v_lshlrev_b32 v104, 16, v210
v_and_b32 v105, 0xffff0000, v210
v_fmac_f32 v100, v104, v52
v_fmac_f32 v101, v105, v52
v_lshlrev_b32 v104, 16, v211
v_and_b32 v105, 0xffff0000, v211
v_fmac_f32 v102, v104, v52
v_fmac_f32 v103, v105, v52
buffer_load_dwordx4 v[208:211], v4, s[8:11], s43 offen
s_add_u32 s43, s43, 393216
s_waitcnt vmcnt(31)
v_lshlrev_b32 v104, 16, v212
v_and_b32 v105, 0xffff0000, v212
v_fmac_f32 v96, v104, v53
v_fmac_f32 v97, v105, v53
v_lshlrev_b32 v104, 16, v213
v_and_b32 v105, 0xffff0000, v213
v_fmac_f32 v98, v104, v53
v_fmac_f32 v99, v105, v53
v_lshlrev_b32 v104, 16, v214
v_and_b32 v105, 0xffff0000, v214
v_fmac_f32 v100, v104, v53
v_fmac_f32 v101, v105, v53
v_lshlrev_b32 v104, 16, v215
v_and_b32 v105, 0xffff0000, v215
v_fmac_f32 v102, v104, v53
v_fmac_f32 v103, v105, v53
buffer_load_dwordx4 v[212:215], v4, s[8:11], s43 offen
s_add_u32 s43, s43, 393216
s_waitcnt vmcnt(31)
v_lshlrev_b32 v104, 16, v216
v_and_b32 v105, 0xffff0000, v216
v_fmac_f32 v96, v104, v54
v_fmac_f32 v97, v105, v54
v_lshlrev_b32 v104, 16, v217
v_and_b32 v105, 0xffff0000, v217
v_fmac_f32 v98, v104, v54
v_fmac_f32 v99, v105, v54
v_lshlrev_b32 v104, 16, v218
v_and_b32 v105, 0xffff0000, v218
v_fmac_f32 v100, v104, v54
v_fmac_f32 v101, v105, v54
v_lshlrev_b32 v104, 16, v219
v_and_b32 v105, 0xffff0000, v219
v_fmac_f32 v102, v104, v54
v_fmac_f32 v103, v105, v54
buffer_load_dwordx4 v[216:219], v4, s[8:11], s43 offen
s_add_u32 s43, s43, 393216
s_waitcnt vmcnt(31)
v_lshlrev_b32 v104, 16, v220
v_and_b32 v105, 0xffff0000, v220
v_fmac_f32 v96, v104, v55
v_fmac_f32 v97, v105, v55
v_lshlrev_b32 v104, 16, v221
v_and_b32 v105, 0xffff0000, v221
v_fmac_f32 v98, v104, v55
v_fmac_f32 v99, v105, v55
v_lshlrev_b32 v104, 16, v222
v_and_b32 v105, 0xffff0000, v222
v_fmac_f32 v100, v104, v55
v_fmac_f32 v101, v105, v55
v_lshlrev_b32 v104, 16, v223
v_and_b32 v105, 0xffff0000, v223
v_fmac_f32 v102, v104, v55
v_fmac_f32 v103, v105, v55
buffer_load_dwordx4 v[220:223], v4, s[8:11], s43 offen
s_add_u32 s43, s43, 393216
s_waitcnt vmcnt(31)
v_lshlrev_b32 v104, 16, v224
v_and_b32 v105, 0xffff0000, v224
v_fmac_f32 v96, v104, v56
v_fmac_f32 v97, v105, v56
v_lshlrev_b32 v104, 16, v225
v_and_b32 v105, 0xffff0000, v225
v_fmac_f32 v98, v104, v56
v_fmac_f32 v99, v105, v56
v_lshlrev_b32 v104, 16, v226
v_and_b32 v105, 0xffff0000, v226
v_fmac_f32 v100, v104, v56
v_fmac_f32 v101, v105, v56
v_lshlrev_b32 v104, 16, v227
v_and_b32 v105, 0xffff0000, v227
v_fmac_f32 v102, v104, v56
v_fmac_f32 v103, v105, v56
buffer_load_dwordx4 v[224:227], v4, s[8:11], s43 offen
s_add_u32 s43, s43, 393216
s_waitcnt vmcnt(31)
v_lshlrev_b32 v104, 16, v228
v_and_b32 v105, 0xffff0000, v228
v_fmac_f32 v96, v104, v57
v_fmac_f32 v97, v105, v57
v_lshlrev_b32 v104, 16, v229
v_and_b32 v105, 0xffff0000, v229
v_fmac_f32 v98, v104, v57
v_fmac_f32 v99, v105, v57
v_lshlrev_b32 v104, 16, v230
v_and_b32 v105, 0xffff0000, v230
v_fmac_f32 v100, v104, v57
v_fmac_f32 v101, v105, v57
v_lshlrev_b32 v104, 16, v231
v_and_b32 v105, 0xffff0000, v231
v_fmac_f32 v102, v104, v57
v_fmac_f32 v103, v105, v57
buffer_load_dwordx4 v[228:231], v4, s[8:11], s43 offen
s_add_u32 s43, s43, 393216
s_waitcnt vmcnt(31)
v_lshlrev_b32 v104, 16, v232
v_and_b32 v105, 0xffff0000, v232
v_fmac_f32 v96, v104, v58
v_fmac_f32 v97, v105, v58
v_lshlrev_b32 v104, 16, v233
v_and_b32 v105, 0xffff0000, v233
v_fmac_f32 v98, v104, v58
v_fmac_f32 v99, v105, v58
v_lshlrev_b32 v104, 16, v234
v_and_b32 v105, 0xffff0000, v234
v_fmac_f32 v100, v104, v58
v_fmac_f32 v101, v105, v58
v_lshlrev_b32 v104, 16, v235
v_and_b32 v105, 0xffff0000, v235
v_fmac_f32 v102, v104, v58
v_fmac_f32 v103, v105, v58
buffer_load_dwordx4 v[232:235], v4, s[8:11], s43 offen
s_add_u32 s43, s43, 393216
s_waitcnt vmcnt(31)
v_lshlrev_b32 v104, 16, v236
v_and_b32 v105, 0xffff0000, v236
v_fmac_f32 v96, v104, v59
v_fmac_f32 v97, v105, v59
v_lshlrev_b32 v104, 16, v237
v_and_b32 v105, 0xffff0000, v237
v_fmac_f32 v98, v104, v59
v_fmac_f32 v99, v105, v59
v_lshlrev_b32 v104, 16, v238
v_and_b32 v105, 0xffff0000, v238
v_fmac_f32 v100, v104, v59
v_fmac_f32 v101, v105, v59
v_lshlrev_b32 v104, 16, v239
v_and_b32 v105, 0xffff0000, v239
v_fmac_f32 v102, v104, v59
v_fmac_f32 v103, v105, v59
buffer_load_dwordx4 v[236:239], v4, s[8:11], s43 offen
s_add_u32 s43, s43, 393216
s_waitcnt vmcnt(31)
v_lshlrev_b32 v104, 16, v240
v_and_b32 v105, 0xffff0000, v240
v_fmac_f32 v96, v104, v60
v_fmac_f32 v97, v105, v60
v_lshlrev_b32 v104, 16, v241
v_and_b32 v105, 0xffff0000, v241
v_fmac_f32 v98, v104, v60
v_fmac_f32 v99, v105, v60
v_lshlrev_b32 v104, 16, v242
v_and_b32 v105, 0xffff0000, v242
v_fmac_f32 v100, v104, v60
v_fmac_f32 v101, v105, v60
v_lshlrev_b32 v104, 16, v243
v_and_b32 v105, 0xffff0000, v243
v_fmac_f32 v102, v104, v60
v_fmac_f32 v103, v105, v60
buffer_load_dwordx4 v[240:243], v4, s[8:11], s43 offen
s_add_u32 s43, s43, 393216
s_waitcnt vmcnt(31)
v_lshlrev_b32 v104, 16, v244
v_and_b32 v105, 0xffff0000, v244
v_fmac_f32 v96, v104, v61
v_fmac_f32 v97, v105, v61
v_lshlrev_b32 v104, 16, v245
v_and_b32 v105, 0xffff0000, v245
v_fmac_f32 v98, v104, v61
v_fmac_f32 v99, v105, v61
v_lshlrev_b32 v104, 16, v246
v_and_b32 v105, 0xffff0000, v246
v_fmac_f32 v100, v104, v61
v_fmac_f32 v101, v105, v61
v_lshlrev_b32 v104, 16, v247
v_and_b32 v105, 0xffff0000, v247
v_fmac_f32 v102, v104, v61
v_fmac_f32 v103, v105, v61
buffer_load_dwordx4 v[244:247], v4, s[8:11], s43 offen
s_add_u32 s43, s43, 393216
s_waitcnt vmcnt(31)
v_lshlrev_b32 v104, 16, v248
v_and_b32 v105, 0xffff0000, v248
v_fmac_f32 v96, v104, v62
v_fmac_f32 v97, v105, v62
v_lshlrev_b32 v104, 16, v249
v_and_b32 v105, 0xffff0000, v249
v_fmac_f32 v98, v104, v62
v_fmac_f32 v99, v105, v62
v_lshlrev_b32 v104, 16, v250
v_and_b32 v105, 0xffff0000, v250
v_fmac_f32 v100, v104, v62
v_fmac_f32 v101, v105, v62
v_lshlrev_b32 v104, 16, v251
v_and_b32 v105, 0xffff0000, v251
v_fmac_f32 v102, v104, v62
v_fmac_f32 v103, v105, v62
buffer_load_dwordx4 v[248:251], v4, s[8:11], s43 offen
s_add_u32 s43, s43, 393216
s_waitcnt vmcnt(31)
v_lshlrev_b32 v104, 16, v252
v_and_b32 v105, 0xffff0000, v252
v_fmac_f32 v96, v104, v63
v_fmac_f32 v97, v105, v63
v_lshlrev_b32 v104, 16, v253
v_and_b32 v105, 0xffff0000, v253
v_fmac_f32 v98, v104, v63
v_fmac_f32 v99, v105, v63
v_lshlrev_b32 v104, 16, v254
v_and_b32 v105, 0xffff0000, v254
v_fmac_f32 v100, v104, v63
v_fmac_f32 v101, v105, v63
v_lshlrev_b32 v104, 16, v255
v_and_b32 v105, 0xffff0000, v255
v_fmac_f32 v102, v104, v63
v_fmac_f32 v103, v105, v63
buffer_load_dwordx4 v[252:255], v4, s[8:11], s43 offen
s_add_u32 s43, s43, 393216
s_lshl_b32 s62, s60, 8
s_add_u32 s62, s62, 3145728
s_nop 1
v_add_f32_dpp v96, v96, v96 row_ror:8 row_mask:0xf bank_mask:0xf
v_add_f32_dpp v97, v97, v97 row_ror:8 row_mask:0xf bank_mask:0xf
v_add_f32_dpp v98, v98, v98 row_ror:8 row_mask:0xf bank_mask:0xf
v_add_f32_dpp v99, v99, v99 row_ror:8 row_mask:0xf bank_mask:0xf
v_add_f32_dpp v100, v100, v100 row_ror:8 row_mask:0xf bank_mask:0xf
v_add_f32_dpp v101, v101, v101 row_ror:8 row_mask:0xf bank_mask:0xf
v_add_f32_dpp v102, v102, v102 row_ror:8 row_mask:0xf bank_mask:0xf
v_add_f32_dpp v103, v103, v103 row_ror:8 row_mask:0xf bank_mask:0xf
v_mov_b32 v16, v96
v_mov_b32 v17, v97
v_mov_b32 v18, v98
v_mov_b32 v19, v99
v_mov_b32 v20, v100
v_mov_b32 v21, v101
v_mov_b32 v22, v102
v_mov_b32 v23, v103
v_permlane16_swap_b32 v96, v16
v_permlane16_swap_b32 v97, v17
v_permlane16_swap_b32 v98, v18
v_permlane16_swap_b32 v99, v19
v_permlane16_swap_b32 v100, v20
v_permlane16_swap_b32 v101, v21
v_permlane16_swap_b32 v102, v22
v_permlane16_swap_b32 v103, v23
v_add_f32 v96, v96, v16
v_add_f32 v97, v97, v17
v_add_f32 v98, v98, v18
v_add_f32 v99, v99, v19
v_add_f32 v100, v100, v20
v_add_f32 v101, v101, v21
v_add_f32 v102, v102, v22
v_add_f32 v103, v103, v23
v_mov_b32 v16, v96
v_mov_b32 v17, v97
v_mov_b32 v18, v98
v_mov_b32 v19, v99
v_mov_b32 v20, v100
v_mov_b32 v21, v101
v_mov_b32 v22, v102
v_mov_b32 v23, v103
v_permlane32_swap_b32 v96, v16
v_permlane32_swap_b32 v97, v17
v_permlane32_swap_b32 v98, v18
v_permlane32_swap_b32 v99, v19
v_permlane32_swap_b32 v100, v20
v_permlane32_swap_b32 v101, v21
v_permlane32_swap_b32 v102, v22
v_permlane32_swap_b32 v103, v23
v_add_f32 v96, v96, v16
v_add_f32 v97, v97, v17
v_add_f32 v98, v98, v18
v_add_f32 v99, v99, v19
v_add_f32 v100, v100, v20
v_add_f32 v101, v101, v21
v_add_f32 v102, v102, v22
v_add_f32 v103, v103, v23
s_lshl_b32 s40, s32, 8
v_lshl_add_u32 v2, v3, 5, s40
ds_write_b128 v2, v[96:99] offset:1024
ds_write_b128 v2, v[100:103] offset:1040
s_waitcnt lgkmcnt(0)
s_barrier
v_and_b32 v2, 63, v0
v_lshlrev_b32 v2, 2, v2
ds_read_b32 v96, v2 offset:1024
ds_read_b32 v97, v2 offset:1280
ds_read_b32 v98, v2 offset:1536
ds_read_b32 v99, v2 offset:1792
s_min_u32 s40, s32, 1
s_lshl_b32 s40, s40, 30
s_add_u32 s40, s40, s62
s_waitcnt lgkmcnt(0)
v_add_f32 v96, v96, v97
v_add_f32 v98, v98, v99
v_add_f32 v96, v96, v98
v_cvt_pk_bf16_f32 v96, 0, v96
buffer_store_dword v96, v2, s[4:7], s40 offen sc1
s_xor_b32 s60, s60, 0x62
s_nop 0
v_mov_b32 v96, 0
v_mov_b32 v97, 0
v_mov_b32 v98, 0
v_mov_b32 v99, 0
v_mov_b32 v100, 0
v_mov_b32 v101, 0
v_mov_b32 v102, 0
v_mov_b32 v103, 0
s_waitcnt vmcnt(32)
v_lshlrev_b32 v104, 16, v128
v_and_b32 v105, 0xffff0000, v128
v_fmac_f32 v96, v104, v32
v_fmac_f32 v97, v105, v32
v_lshlrev_b32 v104, 16, v129
v_and_b32 v105, 0xffff0000, v129
v_fmac_f32 v98, v104, v32
v_fmac_f32 v99, v105, v32
v_lshlrev_b32 v104, 16, v130
v_and_b32 v105, 0xffff0000, v130
v_fmac_f32 v100, v104, v32
v_fmac_f32 v101, v105, v32
v_lshlrev_b32 v104, 16, v131
v_and_b32 v105, 0xffff0000, v131
v_fmac_f32 v102, v104, v32
v_fmac_f32 v103, v105, v32
s_waitcnt vmcnt(31)
v_lshlrev_b32 v104, 16, v132
v_and_b32 v105, 0xffff0000, v132
v_fmac_f32 v96, v104, v33
v_fmac_f32 v97, v105, v33
v_lshlrev_b32 v104, 16, v133
v_and_b32 v105, 0xffff0000, v133
v_fmac_f32 v98, v104, v33
v_fmac_f32 v99, v105, v33
v_lshlrev_b32 v104, 16, v134
v_and_b32 v105, 0xffff0000, v134
v_fmac_f32 v100, v104, v33
v_fmac_f32 v101, v105, v33
v_lshlrev_b32 v104, 16, v135
v_and_b32 v105, 0xffff0000, v135
v_fmac_f32 v102, v104, v33
v_fmac_f32 v103, v105, v33
s_waitcnt vmcnt(30)
v_lshlrev_b32 v104, 16, v136
v_and_b32 v105, 0xffff0000, v136
v_fmac_f32 v96, v104, v34
v_fmac_f32 v97, v105, v34
v_lshlrev_b32 v104, 16, v137
v_and_b32 v105, 0xffff0000, v137
v_fmac_f32 v98, v104, v34
v_fmac_f32 v99, v105, v34
v_lshlrev_b32 v104, 16, v138
v_and_b32 v105, 0xffff0000, v138
v_fmac_f32 v100, v104, v34
v_fmac_f32 v101, v105, v34
v_lshlrev_b32 v104, 16, v139
v_and_b32 v105, 0xffff0000, v139
v_fmac_f32 v102, v104, v34
v_fmac_f32 v103, v105, v34
s_waitcnt vmcnt(29)
v_lshlrev_b32 v104, 16, v140
v_and_b32 v105, 0xffff0000, v140
v_fmac_f32 v96, v104, v35
v_fmac_f32 v97, v105, v35
v_lshlrev_b32 v104, 16, v141
v_and_b32 v105, 0xffff0000, v141
v_fmac_f32 v98, v104, v35
v_fmac_f32 v99, v105, v35
v_lshlrev_b32 v104, 16, v142
v_and_b32 v105, 0xffff0000, v142
v_fmac_f32 v100, v104, v35
v_fmac_f32 v101, v105, v35
v_lshlrev_b32 v104, 16, v143
v_and_b32 v105, 0xffff0000, v143
v_fmac_f32 v102, v104, v35
v_fmac_f32 v103, v105, v35
s_waitcnt vmcnt(28)
v_lshlrev_b32 v104, 16, v144
v_and_b32 v105, 0xffff0000, v144
v_fmac_f32 v96, v104, v36
v_fmac_f32 v97, v105, v36
v_lshlrev_b32 v104, 16, v145
v_and_b32 v105, 0xffff0000, v145
v_fmac_f32 v98, v104, v36
v_fmac_f32 v99, v105, v36
v_lshlrev_b32 v104, 16, v146
v_and_b32 v105, 0xffff0000, v146
v_fmac_f32 v100, v104, v36
v_fmac_f32 v101, v105, v36
v_lshlrev_b32 v104, 16, v147
v_and_b32 v105, 0xffff0000, v147
v_fmac_f32 v102, v104, v36
v_fmac_f32 v103, v105, v36
s_waitcnt vmcnt(27)
v_lshlrev_b32 v104, 16, v148
v_and_b32 v105, 0xffff0000, v148
v_fmac_f32 v96, v104, v37
v_fmac_f32 v97, v105, v37
v_lshlrev_b32 v104, 16, v149
v_and_b32 v105, 0xffff0000, v149
v_fmac_f32 v98, v104, v37
v_fmac_f32 v99, v105, v37
v_lshlrev_b32 v104, 16, v150
v_and_b32 v105, 0xffff0000, v150
v_fmac_f32 v100, v104, v37
v_fmac_f32 v101, v105, v37
v_lshlrev_b32 v104, 16, v151
v_and_b32 v105, 0xffff0000, v151
v_fmac_f32 v102, v104, v37
v_fmac_f32 v103, v105, v37
s_waitcnt vmcnt(26)
v_lshlrev_b32 v104, 16, v152
v_and_b32 v105, 0xffff0000, v152
v_fmac_f32 v96, v104, v38
v_fmac_f32 v97, v105, v38
v_lshlrev_b32 v104, 16, v153
v_and_b32 v105, 0xffff0000, v153
v_fmac_f32 v98, v104, v38
v_fmac_f32 v99, v105, v38
v_lshlrev_b32 v104, 16, v154
v_and_b32 v105, 0xffff0000, v154
v_fmac_f32 v100, v104, v38
v_fmac_f32 v101, v105, v38
v_lshlrev_b32 v104, 16, v155
v_and_b32 v105, 0xffff0000, v155
v_fmac_f32 v102, v104, v38
v_fmac_f32 v103, v105, v38
s_waitcnt vmcnt(25)
v_lshlrev_b32 v104, 16, v156
v_and_b32 v105, 0xffff0000, v156
v_fmac_f32 v96, v104, v39
v_fmac_f32 v97, v105, v39
v_lshlrev_b32 v104, 16, v157
v_and_b32 v105, 0xffff0000, v157
v_fmac_f32 v98, v104, v39
v_fmac_f32 v99, v105, v39
v_lshlrev_b32 v104, 16, v158
v_and_b32 v105, 0xffff0000, v158
v_fmac_f32 v100, v104, v39
v_fmac_f32 v101, v105, v39
v_lshlrev_b32 v104, 16, v159
v_and_b32 v105, 0xffff0000, v159
v_fmac_f32 v102, v104, v39
v_fmac_f32 v103, v105, v39
s_waitcnt vmcnt(24)
v_lshlrev_b32 v104, 16, v160
v_and_b32 v105, 0xffff0000, v160
v_fmac_f32 v96, v104, v40
v_fmac_f32 v97, v105, v40
v_lshlrev_b32 v104, 16, v161
v_and_b32 v105, 0xffff0000, v161
v_fmac_f32 v98, v104, v40
v_fmac_f32 v99, v105, v40
v_lshlrev_b32 v104, 16, v162
v_and_b32 v105, 0xffff0000, v162
v_fmac_f32 v100, v104, v40
v_fmac_f32 v101, v105, v40
v_lshlrev_b32 v104, 16, v163
v_and_b32 v105, 0xffff0000, v163
v_fmac_f32 v102, v104, v40
v_fmac_f32 v103, v105, v40
s_waitcnt vmcnt(23)
v_lshlrev_b32 v104, 16, v164
v_and_b32 v105, 0xffff0000, v164
v_fmac_f32 v96, v104, v41
v_fmac_f32 v97, v105, v41
v_lshlrev_b32 v104, 16, v165
v_and_b32 v105, 0xffff0000, v165
v_fmac_f32 v98, v104, v41
v_fmac_f32 v99, v105, v41
v_lshlrev_b32 v104, 16, v166
v_and_b32 v105, 0xffff0000, v166
v_fmac_f32 v100, v104, v41
v_fmac_f32 v101, v105, v41
v_lshlrev_b32 v104, 16, v167
v_and_b32 v105, 0xffff0000, v167
v_fmac_f32 v102, v104, v41
v_fmac_f32 v103, v105, v41
s_waitcnt vmcnt(22)
v_lshlrev_b32 v104, 16, v168
v_and_b32 v105, 0xffff0000, v168
v_fmac_f32 v96, v104, v42
v_fmac_f32 v97, v105, v42
v_lshlrev_b32 v104, 16, v169
v_and_b32 v105, 0xffff0000, v169
v_fmac_f32 v98, v104, v42
v_fmac_f32 v99, v105, v42
v_lshlrev_b32 v104, 16, v170
v_and_b32 v105, 0xffff0000, v170
v_fmac_f32 v100, v104, v42
v_fmac_f32 v101, v105, v42
v_lshlrev_b32 v104, 16, v171
v_and_b32 v105, 0xffff0000, v171
v_fmac_f32 v102, v104, v42
v_fmac_f32 v103, v105, v42
s_waitcnt vmcnt(21)
v_lshlrev_b32 v104, 16, v172
v_and_b32 v105, 0xffff0000, v172
v_fmac_f32 v96, v104, v43
v_fmac_f32 v97, v105, v43
v_lshlrev_b32 v104, 16, v173
v_and_b32 v105, 0xffff0000, v173
v_fmac_f32 v98, v104, v43
v_fmac_f32 v99, v105, v43
v_lshlrev_b32 v104, 16, v174
v_and_b32 v105, 0xffff0000, v174
v_fmac_f32 v100, v104, v43
v_fmac_f32 v101, v105, v43
v_lshlrev_b32 v104, 16, v175
v_and_b32 v105, 0xffff0000, v175
v_fmac_f32 v102, v104, v43
v_fmac_f32 v103, v105, v43
s_waitcnt vmcnt(20)
v_lshlrev_b32 v104, 16, v176
v_and_b32 v105, 0xffff0000, v176
v_fmac_f32 v96, v104, v44
v_fmac_f32 v97, v105, v44
v_lshlrev_b32 v104, 16, v177
v_and_b32 v105, 0xffff0000, v177
v_fmac_f32 v98, v104, v44
v_fmac_f32 v99, v105, v44
v_lshlrev_b32 v104, 16, v178
v_and_b32 v105, 0xffff0000, v178
v_fmac_f32 v100, v104, v44
v_fmac_f32 v101, v105, v44
v_lshlrev_b32 v104, 16, v179
v_and_b32 v105, 0xffff0000, v179
v_fmac_f32 v102, v104, v44
v_fmac_f32 v103, v105, v44
s_waitcnt vmcnt(19)
v_lshlrev_b32 v104, 16, v180
v_and_b32 v105, 0xffff0000, v180
v_fmac_f32 v96, v104, v45
v_fmac_f32 v97, v105, v45
v_lshlrev_b32 v104, 16, v181
v_and_b32 v105, 0xffff0000, v181
v_fmac_f32 v98, v104, v45
v_fmac_f32 v99, v105, v45
v_lshlrev_b32 v104, 16, v182
v_and_b32 v105, 0xffff0000, v182
v_fmac_f32 v100, v104, v45
v_fmac_f32 v101, v105, v45
v_lshlrev_b32 v104, 16, v183
v_and_b32 v105, 0xffff0000, v183
v_fmac_f32 v102, v104, v45
v_fmac_f32 v103, v105, v45
s_waitcnt vmcnt(18)
v_lshlrev_b32 v104, 16, v184
v_and_b32 v105, 0xffff0000, v184
v_fmac_f32 v96, v104, v46
v_fmac_f32 v97, v105, v46
v_lshlrev_b32 v104, 16, v185
v_and_b32 v105, 0xffff0000, v185
v_fmac_f32 v98, v104, v46
v_fmac_f32 v99, v105, v46
v_lshlrev_b32 v104, 16, v186
v_and_b32 v105, 0xffff0000, v186
v_fmac_f32 v100, v104, v46
v_fmac_f32 v101, v105, v46
v_lshlrev_b32 v104, 16, v187
v_and_b32 v105, 0xffff0000, v187
v_fmac_f32 v102, v104, v46
v_fmac_f32 v103, v105, v46
s_waitcnt vmcnt(17)
v_lshlrev_b32 v104, 16, v188
v_and_b32 v105, 0xffff0000, v188
v_fmac_f32 v96, v104, v47
v_fmac_f32 v97, v105, v47
v_lshlrev_b32 v104, 16, v189
v_and_b32 v105, 0xffff0000, v189
v_fmac_f32 v98, v104, v47
v_fmac_f32 v99, v105, v47
v_lshlrev_b32 v104, 16, v190
v_and_b32 v105, 0xffff0000, v190
v_fmac_f32 v100, v104, v47
v_fmac_f32 v101, v105, v47
v_lshlrev_b32 v104, 16, v191
v_and_b32 v105, 0xffff0000, v191
v_fmac_f32 v102, v104, v47
v_fmac_f32 v103, v105, v47
s_waitcnt vmcnt(16)
v_lshlrev_b32 v104, 16, v192
v_and_b32 v105, 0xffff0000, v192
v_fmac_f32 v96, v104, v48
v_fmac_f32 v97, v105, v48
v_lshlrev_b32 v104, 16, v193
v_and_b32 v105, 0xffff0000, v193
v_fmac_f32 v98, v104, v48
v_fmac_f32 v99, v105, v48
v_lshlrev_b32 v104, 16, v194
v_and_b32 v105, 0xffff0000, v194
v_fmac_f32 v100, v104, v48
v_fmac_f32 v101, v105, v48
v_lshlrev_b32 v104, 16, v195
v_and_b32 v105, 0xffff0000, v195
v_fmac_f32 v102, v104, v48
v_fmac_f32 v103, v105, v48
s_waitcnt vmcnt(15)
v_lshlrev_b32 v104, 16, v196
v_and_b32 v105, 0xffff0000, v196
v_fmac_f32 v96, v104, v49
v_fmac_f32 v97, v105, v49
v_lshlrev_b32 v104, 16, v197
v_and_b32 v105, 0xffff0000, v197
v_fmac_f32 v98, v104, v49
v_fmac_f32 v99, v105, v49
v_lshlrev_b32 v104, 16, v198
v_and_b32 v105, 0xffff0000, v198
v_fmac_f32 v100, v104, v49
v_fmac_f32 v101, v105, v49
v_lshlrev_b32 v104, 16, v199
v_and_b32 v105, 0xffff0000, v199
v_fmac_f32 v102, v104, v49
v_fmac_f32 v103, v105, v49
s_waitcnt vmcnt(14)
v_lshlrev_b32 v104, 16, v200
v_and_b32 v105, 0xffff0000, v200
v_fmac_f32 v96, v104, v50
v_fmac_f32 v97, v105, v50
v_lshlrev_b32 v104, 16, v201
v_and_b32 v105, 0xffff0000, v201
v_fmac_f32 v98, v104, v50
v_fmac_f32 v99, v105, v50
v_lshlrev_b32 v104, 16, v202
v_and_b32 v105, 0xffff0000, v202
v_fmac_f32 v100, v104, v50
v_fmac_f32 v101, v105, v50
v_lshlrev_b32 v104, 16, v203
v_and_b32 v105, 0xffff0000, v203
v_fmac_f32 v102, v104, v50
v_fmac_f32 v103, v105, v50
s_waitcnt vmcnt(13)
v_lshlrev_b32 v104, 16, v204
v_and_b32 v105, 0xffff0000, v204
v_fmac_f32 v96, v104, v51
v_fmac_f32 v97, v105, v51
v_lshlrev_b32 v104, 16, v205
v_and_b32 v105, 0xffff0000, v205
v_fmac_f32 v98, v104, v51
v_fmac_f32 v99, v105, v51
v_lshlrev_b32 v104, 16, v206
v_and_b32 v105, 0xffff0000, v206
v_fmac_f32 v100, v104, v51
v_fmac_f32 v101, v105, v51
v_lshlrev_b32 v104, 16, v207
v_and_b32 v105, 0xffff0000, v207
v_fmac_f32 v102, v104, v51
v_fmac_f32 v103, v105, v51
s_waitcnt vmcnt(12)
v_lshlrev_b32 v104, 16, v208
v_and_b32 v105, 0xffff0000, v208
v_fmac_f32 v96, v104, v52
v_fmac_f32 v97, v105, v52
v_lshlrev_b32 v104, 16, v209
v_and_b32 v105, 0xffff0000, v209
v_fmac_f32 v98, v104, v52
v_fmac_f32 v99, v105, v52
v_lshlrev_b32 v104, 16, v210
v_and_b32 v105, 0xffff0000, v210
v_fmac_f32 v100, v104, v52
v_fmac_f32 v101, v105, v52
v_lshlrev_b32 v104, 16, v211
v_and_b32 v105, 0xffff0000, v211
v_fmac_f32 v102, v104, v52
v_fmac_f32 v103, v105, v52
s_waitcnt vmcnt(11)
v_lshlrev_b32 v104, 16, v212
v_and_b32 v105, 0xffff0000, v212
v_fmac_f32 v96, v104, v53
v_fmac_f32 v97, v105, v53
v_lshlrev_b32 v104, 16, v213
v_and_b32 v105, 0xffff0000, v213
v_fmac_f32 v98, v104, v53
v_fmac_f32 v99, v105, v53
v_lshlrev_b32 v104, 16, v214
v_and_b32 v105, 0xffff0000, v214
v_fmac_f32 v100, v104, v53
v_fmac_f32 v101, v105, v53
v_lshlrev_b32 v104, 16, v215
v_and_b32 v105, 0xffff0000, v215
v_fmac_f32 v102, v104, v53
v_fmac_f32 v103, v105, v53
s_waitcnt vmcnt(10)
v_lshlrev_b32 v104, 16, v216
v_and_b32 v105, 0xffff0000, v216
v_fmac_f32 v96, v104, v54
v_fmac_f32 v97, v105, v54
v_lshlrev_b32 v104, 16, v217
v_and_b32 v105, 0xffff0000, v217
v_fmac_f32 v98, v104, v54
v_fmac_f32 v99, v105, v54
v_lshlrev_b32 v104, 16, v218
v_and_b32 v105, 0xffff0000, v218
v_fmac_f32 v100, v104, v54
v_fmac_f32 v101, v105, v54
v_lshlrev_b32 v104, 16, v219
v_and_b32 v105, 0xffff0000, v219
v_fmac_f32 v102, v104, v54
v_fmac_f32 v103, v105, v54
s_waitcnt vmcnt(9)
v_lshlrev_b32 v104, 16, v220
v_and_b32 v105, 0xffff0000, v220
v_fmac_f32 v96, v104, v55
v_fmac_f32 v97, v105, v55
v_lshlrev_b32 v104, 16, v221
v_and_b32 v105, 0xffff0000, v221
v_fmac_f32 v98, v104, v55
v_fmac_f32 v99, v105, v55
v_lshlrev_b32 v104, 16, v222
v_and_b32 v105, 0xffff0000, v222
v_fmac_f32 v100, v104, v55
v_fmac_f32 v101, v105, v55
v_lshlrev_b32 v104, 16, v223
v_and_b32 v105, 0xffff0000, v223
v_fmac_f32 v102, v104, v55
v_fmac_f32 v103, v105, v55
s_waitcnt vmcnt(8)
v_lshlrev_b32 v104, 16, v224
v_and_b32 v105, 0xffff0000, v224
v_fmac_f32 v96, v104, v56
v_fmac_f32 v97, v105, v56
v_lshlrev_b32 v104, 16, v225
v_and_b32 v105, 0xffff0000, v225
v_fmac_f32 v98, v104, v56
v_fmac_f32 v99, v105, v56
v_lshlrev_b32 v104, 16, v226
v_and_b32 v105, 0xffff0000, v226
v_fmac_f32 v100, v104, v56
v_fmac_f32 v101, v105, v56
v_lshlrev_b32 v104, 16, v227
v_and_b32 v105, 0xffff0000, v227
v_fmac_f32 v102, v104, v56
v_fmac_f32 v103, v105, v56
s_waitcnt vmcnt(7)
v_lshlrev_b32 v104, 16, v228
v_and_b32 v105, 0xffff0000, v228
v_fmac_f32 v96, v104, v57
v_fmac_f32 v97, v105, v57
v_lshlrev_b32 v104, 16, v229
v_and_b32 v105, 0xffff0000, v229
v_fmac_f32 v98, v104, v57
v_fmac_f32 v99, v105, v57
v_lshlrev_b32 v104, 16, v230
v_and_b32 v105, 0xffff0000, v230
v_fmac_f32 v100, v104, v57
v_fmac_f32 v101, v105, v57
v_lshlrev_b32 v104, 16, v231
v_and_b32 v105, 0xffff0000, v231
v_fmac_f32 v102, v104, v57
v_fmac_f32 v103, v105, v57
s_waitcnt vmcnt(6)
v_lshlrev_b32 v104, 16, v232
v_and_b32 v105, 0xffff0000, v232
v_fmac_f32 v96, v104, v58
v_fmac_f32 v97, v105, v58
v_lshlrev_b32 v104, 16, v233
v_and_b32 v105, 0xffff0000, v233
v_fmac_f32 v98, v104, v58
v_fmac_f32 v99, v105, v58
v_lshlrev_b32 v104, 16, v234
v_and_b32 v105, 0xffff0000, v234
v_fmac_f32 v100, v104, v58
v_fmac_f32 v101, v105, v58
v_lshlrev_b32 v104, 16, v235
v_and_b32 v105, 0xffff0000, v235
v_fmac_f32 v102, v104, v58
v_fmac_f32 v103, v105, v58
s_waitcnt vmcnt(5)
v_lshlrev_b32 v104, 16, v236
v_and_b32 v105, 0xffff0000, v236
v_fmac_f32 v96, v104, v59
v_fmac_f32 v97, v105, v59
v_lshlrev_b32 v104, 16, v237
v_and_b32 v105, 0xffff0000, v237
v_fmac_f32 v98, v104, v59
v_fmac_f32 v99, v105, v59
v_lshlrev_b32 v104, 16, v238
v_and_b32 v105, 0xffff0000, v238
v_fmac_f32 v100, v104, v59
v_fmac_f32 v101, v105, v59
v_lshlrev_b32 v104, 16, v239
v_and_b32 v105, 0xffff0000, v239
v_fmac_f32 v102, v104, v59
v_fmac_f32 v103, v105, v59
s_waitcnt vmcnt(4)
v_lshlrev_b32 v104, 16, v240
v_and_b32 v105, 0xffff0000, v240
v_fmac_f32 v96, v104, v60
v_fmac_f32 v97, v105, v60
v_lshlrev_b32 v104, 16, v241
v_and_b32 v105, 0xffff0000, v241
v_fmac_f32 v98, v104, v60
v_fmac_f32 v99, v105, v60
v_lshlrev_b32 v104, 16, v242
v_and_b32 v105, 0xffff0000, v242
v_fmac_f32 v100, v104, v60
v_fmac_f32 v101, v105, v60
v_lshlrev_b32 v104, 16, v243
v_and_b32 v105, 0xffff0000, v243
v_fmac_f32 v102, v104, v60
v_fmac_f32 v103, v105, v60
s_waitcnt vmcnt(3)
v_lshlrev_b32 v104, 16, v244
v_and_b32 v105, 0xffff0000, v244
v_fmac_f32 v96, v104, v61
v_fmac_f32 v97, v105, v61
v_lshlrev_b32 v104, 16, v245
v_and_b32 v105, 0xffff0000, v245
v_fmac_f32 v98, v104, v61
v_fmac_f32 v99, v105, v61
v_lshlrev_b32 v104, 16, v246
v_and_b32 v105, 0xffff0000, v246
v_fmac_f32 v100, v104, v61
v_fmac_f32 v101, v105, v61
v_lshlrev_b32 v104, 16, v247
v_and_b32 v105, 0xffff0000, v247
v_fmac_f32 v102, v104, v61
v_fmac_f32 v103, v105, v61
s_waitcnt vmcnt(2)
v_lshlrev_b32 v104, 16, v248
v_and_b32 v105, 0xffff0000, v248
v_fmac_f32 v96, v104, v62
v_fmac_f32 v97, v105, v62
v_lshlrev_b32 v104, 16, v249
v_and_b32 v105, 0xffff0000, v249
v_fmac_f32 v98, v104, v62
v_fmac_f32 v99, v105, v62
v_lshlrev_b32 v104, 16, v250
v_and_b32 v105, 0xffff0000, v250
v_fmac_f32 v100, v104, v62
v_fmac_f32 v101, v105, v62
v_lshlrev_b32 v104, 16, v251
v_and_b32 v105, 0xffff0000, v251
v_fmac_f32 v102, v104, v62
v_fmac_f32 v103, v105, v62
s_waitcnt vmcnt(1)
v_lshlrev_b32 v104, 16, v252
v_and_b32 v105, 0xffff0000, v252
v_fmac_f32 v96, v104, v63
v_fmac_f32 v97, v105, v63
v_lshlrev_b32 v104, 16, v253
v_and_b32 v105, 0xffff0000, v253
v_fmac_f32 v98, v104, v63
v_fmac_f32 v99, v105, v63
v_lshlrev_b32 v104, 16, v254
v_and_b32 v105, 0xffff0000, v254
v_fmac_f32 v100, v104, v63
v_fmac_f32 v101, v105, v63
v_lshlrev_b32 v104, 16, v255
v_and_b32 v105, 0xffff0000, v255
v_fmac_f32 v102, v104, v63
v_fmac_f32 v103, v105, v63
s_barrier
s_lshl_b32 s62, s60, 8
s_add_u32 s62, s62, 3145728
s_nop 1
v_add_f32_dpp v96, v96, v96 row_ror:8 row_mask:0xf bank_mask:0xf
v_add_f32_dpp v97, v97, v97 row_ror:8 row_mask:0xf bank_mask:0xf
v_add_f32_dpp v98, v98, v98 row_ror:8 row_mask:0xf bank_mask:0xf
v_add_f32_dpp v99, v99, v99 row_ror:8 row_mask:0xf bank_mask:0xf
v_add_f32_dpp v100, v100, v100 row_ror:8 row_mask:0xf bank_mask:0xf
v_add_f32_dpp v101, v101, v101 row_ror:8 row_mask:0xf bank_mask:0xf
v_add_f32_dpp v102, v102, v102 row_ror:8 row_mask:0xf bank_mask:0xf
v_add_f32_dpp v103, v103, v103 row_ror:8 row_mask:0xf bank_mask:0xf
v_mov_b32 v16, v96
v_mov_b32 v17, v97
v_mov_b32 v18, v98
v_mov_b32 v19, v99
v_mov_b32 v20, v100
v_mov_b32 v21, v101
v_mov_b32 v22, v102
v_mov_b32 v23, v103
v_permlane16_swap_b32 v96, v16
v_permlane16_swap_b32 v97, v17
v_permlane16_swap_b32 v98, v18
v_permlane16_swap_b32 v99, v19
v_permlane16_swap_b32 v100, v20
v_permlane16_swap_b32 v101, v21
v_permlane16_swap_b32 v102, v22
v_permlane16_swap_b32 v103, v23
v_add_f32 v96, v96, v16
v_add_f32 v97, v97, v17
v_add_f32 v98, v98, v18
v_add_f32 v99, v99, v19
v_add_f32 v100, v100, v20
v_add_f32 v101, v101, v21
v_add_f32 v102, v102, v22
v_add_f32 v103, v103, v23
v_mov_b32 v16, v96
v_mov_b32 v17, v97
v_mov_b32 v18, v98
v_mov_b32 v19, v99
v_mov_b32 v20, v100
v_mov_b32 v21, v101
v_mov_b32 v22, v102
v_mov_b32 v23, v103
v_permlane32_swap_b32 v96, v16
v_permlane32_swap_b32 v97, v17
v_permlane32_swap_b32 v98, v18
v_permlane32_swap_b32 v99, v19
v_permlane32_swap_b32 v100, v20
v_permlane32_swap_b32 v101, v21
v_permlane32_swap_b32 v102, v22
v_permlane32_swap_b32 v103, v23
v_add_f32 v96, v96, v16
v_add_f32 v97, v97, v17
v_add_f32 v98, v98, v18
v_add_f32 v99, v99, v19
v_add_f32 v100, v100, v20
v_add_f32 v101, v101, v21
v_add_f32 v102, v102, v22
v_add_f32 v103, v103, v23
s_lshl_b32 s40, s32, 8
v_lshl_add_u32 v2, v3, 5, s40
ds_write_b128 v2, v[96:99] offset:1024
ds_write_b128 v2, v[100:103] offset:1040
s_waitcnt lgkmcnt(0)
s_barrier
v_and_b32 v2, 63, v0
v_lshlrev_b32 v2, 2, v2
ds_read_b32 v96, v2 offset:1024
ds_read_b32 v97, v2 offset:1280
ds_read_b32 v98, v2 offset:1536
ds_read_b32 v99, v2 offset:1792
s_min_u32 s40, s32, 1
s_lshl_b32 s40, s40, 30
s_add_u32 s40, s40, s62
s_waitcnt lgkmcnt(0)
v_add_f32 v96, v96, v97
v_add_f32 v98, v98, v99
v_add_f32 v96, v96, v98
v_cvt_pk_bf16_f32 v96, 0, v96
buffer_store_dword v96, v2, s[4:7], s40 offen sc1
v_mov_b32 v4, v10
v_mov_b32 v5, 1
s_mov_b32 s38, 8192
s_waitcnt vmcnt(0)
buffer_store_dword v5, v4, s[4:7], s38 offen sc1
Lst_577:
buffer_load_dword v48, off, s[12:15], 0 offset:16 sc1
buffer_load_dword v49, off, s[12:15], 0 offset:144 sc1
s_waitcnt vmcnt(0)
v_add_u32 v48, v48, v49
s_nop 0
v_readfirstlane_b32 s38, v48
s_nop 3
s_and_b32 s39, s38, 0x200ffff
s_cmp_eq_u32 s39, 0x2000100
s_cbranch_scc1 Lso_578
s_sub_u32 s37, s37, 1
s_cbranch_scc1 Lend_7
s_sleep 8
s_branch Lst_577
Lso_578:
s_bfe_u32 s35, s38, 0x80010
s_bfe_u32 s46, s38, 0x10018
s_lshl_b32 s46, s46, 13
s_barrier
s_mul_i32 s50, s32, 4096
v_lshlrev_b32 v1, 4, v9
v_add_u32 v0, s50, v1
v_lshrrev_b32 v80, 2, v9
v_min_u32 v80, 7, v80
v_lshlrev_b32 v80, 7, v80
v_and_b32 v2, 3, v9
v_lshl_add_u32 v2, v2, 2, v80
s_lshl_b32 s47, s33, 10
s_add_u32 s47, s47, 3432448
v_mov_b32 v6, v1
s_lshl_b32 s38, s26, 2
s_add_u32 s38, s38, s32
s_lshl_b32 s38, s38, 11
s_lshl_b32 s49, s33, 22
s_add_u32 s49, s49, s38
s_add_u32 s49, s49, 117374976
s_lshl_b32 s54, s33, 16
s_add_u32 s54, s54, 83886080
s_lshl_b32 s45, s26, 18
s_add_u32 s45, s45, s54
s_add_u32 m0, s50, 0
s_add_u32 s39, s45, 0
buffer_load_dwordx4 v0, s[4:7], s39 offen offset:0 sc1 lds
buffer_load_dwordx4 v0, s[4:7], s39 offen offset:1024 sc1 lds
buffer_load_dwordx4 v0, s[4:7], s39 offen offset:2048 sc1 lds
buffer_load_dwordx4 v0, s[4:7], s39 offen offset:3072 sc1 lds
s_add_u32 m0, s50, 16384
s_add_u32 s39, s45, 16384
buffer_load_dwordx4 v0, s[4:7], s39 offen offset:0 sc1 lds
buffer_load_dwordx4 v0, s[4:7], s39 offen offset:1024 sc1 lds
buffer_load_dwordx4 v0, s[4:7], s39 offen offset:2048 sc1 lds
buffer_load_dwordx4 v0, s[4:7], s39 offen offset:3072 sc1 lds
s_add_u32 m0, s50, 32768
s_add_u32 s39, s45, 32768
buffer_load_dwordx4 v0, s[4:7], s39 offen offset:0 sc1 lds
buffer_load_dwordx4 v0, s[4:7], s39 offen offset:1024 sc1 lds
buffer_load_dwordx4 v0, s[4:7], s39 offen offset:2048 sc1 lds
buffer_load_dwordx4 v0, s[4:7], s39 offen offset:3072 sc1 lds
s_add_u32 m0, s50, 49152
s_add_u32 s39, s45, 49152
buffer_load_dwordx4 v0, s[4:7], s39 offen offset:0 sc1 lds
buffer_load_dwordx4 v0, s[4:7], s39 offen offset:1024 sc1 lds
buffer_load_dwordx4 v0, s[4:7], s39 offen offset:2048 sc1 lds
buffer_load_dwordx4 v0, s[4:7], s39 offen offset:3072 sc1 lds
v_mov_b32 v8, 0
v_mov_b32 v80, -1
v_mov_b32 v81, -1
v_mov_b32 v82, -1
v_mov_b32 v83, -1
s_add_u32 s38, s49, 3997696
buffer_store_dwordx4 v[80:83], v6, s[4:7], s38 offen offset:0 sc1
buffer_store_dwordx4 v[80:83], v6, s[4:7], s38 offen offset:1024 sc1
s_add_u32 s38, s49, 4063232
buffer_store_dwordx4 v[80:83], v6, s[4:7], s38 offen offset:0 sc1
buffer_store_dwordx4 v[80:83], v6, s[4:7], s38 offen offset:1024 sc1
s_add_u32 s38, s49, 4128768
buffer_store_dwordx4 v[80:83], v6, s[4:7], s38 offen offset:0 sc1
buffer_store_dwordx4 v[80:83], v6, s[4:7], s38 offen offset:1024 sc1
s_add_u32 s38, s49, 4194304
buffer_store_dwordx4 v[80:83], v6, s[4:7], s38 offen offset:0 sc1
buffer_store_dwordx4 v[80:83], v6, s[4:7], s38 offen offset:1024 sc1
s_mov_b32 s36, 0
s_add_u32 s48, s36, 1
Lsw_579:
Lbw_584:
buffer_load_dword v3, v2, s[4:7], s47 offen sc1
s_waitcnt vmcnt(0)
v_cmp_gt_u32 vcc, s48, v3
s_cbranch_vccz Lbo_585
s_sub_u32 s37, s37, 1
s_cbranch_scc1 Lend_7
s_sleep 1
s_branch Lbw_584
Lbo_585:
s_add_u32 m0, s50, 0
s_add_u32 s39, s54, 0
buffer_load_dwordx4 v0, s[4:7], s39 offen offset:0 sc1 lds
buffer_load_dwordx4 v0, s[4:7], s39 offen offset:1024 sc1 lds
buffer_load_dwordx4 v0, s[4:7], s39 offen offset:2048 sc1 lds
buffer_load_dwordx4 v0, s[4:7], s39 offen offset:3072 sc1 lds
s_add_u32 m0, s50, 16384
s_add_u32 s39, s54, 16384
buffer_load_dwordx4 v0, s[4:7], s39 offen offset:0 sc1 lds
buffer_load_dwordx4 v0, s[4:7], s39 offen offset:1024 sc1 lds
buffer_load_dwordx4 v0, s[4:7], s39 offen offset:2048 sc1 lds
buffer_load_dwordx4 v0, s[4:7], s39 offen offset:3072 sc1 lds
s_add_u32 m0, s50, 32768
s_add_u32 s39, s54, 32768
buffer_load_dwordx4 v0, s[4:7], s39 offen offset:0 sc1 lds
buffer_load_dwordx4 v0, s[4:7], s39 offen offset:1024 sc1 lds
buffer_load_dwordx4 v0, s[4:7], s39 offen offset:2048 sc1 lds
buffer_load_dwordx4 v0, s[4:7], s39 offen offset:3072 sc1 lds
s_add_u32 m0, s50, 49152
s_add_u32 s39, s54, 49152
buffer_load_dwordx4 v0, s[4:7], s39 offen offset:0 sc1 lds
buffer_load_dwordx4 v0, s[4:7], s39 offen offset:1024 sc1 lds
buffer_load_dwordx4 v0, s[4:7], s39 offen offset:2048 sc1 lds
buffer_load_dwordx4 v0, s[4:7], s39 offen offset:3072 sc1 lds
buffer_load_dword v3, v2, s[4:7], s47 offen sc1
Lse_580:
s_waitcnt vmcnt(13)
s_barrier
ds_read_b128 v[16:19], v1 offset:0
ds_read_b128 v[20:23], v1 offset:1024
ds_read_b128 v[24:27], v1 offset:2048
ds_read_b128 v[28:31], v1 offset:3072
ds_read_b128 v[32:35], v1 offset:4096
ds_read_b128 v[36:39], v1 offset:5120
ds_read_b128 v[40:43], v1 offset:6144
s_add_u32 s54, s54, 262144
s_bitset0_b32 s54, 21
s_xor_b32 s50, s50, 0x10000
s_add_u32 s49, s49, 65536
s_add_u32 s36, s36, 1
s_add_u32 s48, s36, 1
s_waitcnt lgkmcnt(5)
v_mfma_f32_16x16x32_bf16 v[48:51], a[0:3], v[16:19], 0
ds_read_b128 v[44:47], v1 offset:7168
v_mfma_f32_16x16x32_bf16 v[52:55], a[128:131], v[16:19], 0
v_mfma_f32_16x16x32_bf16 v[56:59], a[0:3], v[20:23], 0
ds_read_b128 v[16:19], v1 offset:8192
v_mfma_f32_16x16x32_bf16 v[60:63], a[128:131], v[20:23], 0
s_waitcnt lgkmcnt(5)
v_mfma_f32_16x16x32_bf16 v[48:51], a[4:7], v[24:27], v[48:51]
ds_read_b128 v[20:23], v1 offset:9216
v_mfma_f32_16x16x32_bf16 v[52:55], a[132:135], v[24:27], v[52:55]
v_mfma_f32_16x16x32_bf16 v[56:59], a[4:7], v[28:31], v[56:59]
ds_read_b128 v[24:27], v1 offset:10240
v_mfma_f32_16x16x32_bf16 v[60:63], a[132:135], v[28:31], v[60:63]
s_waitcnt lgkmcnt(5)
v_mfma_f32_16x16x32_bf16 v[48:51], a[8:11], v[32:35], v[48:51]
ds_read_b128 v[28:31], v1 offset:11264
v_mfma_f32_16x16x32_bf16 v[52:55], a[136:139], v[32:35], v[52:55]
v_mfma_f32_16x16x32_bf16 v[56:59], a[8:11], v[36:39], v[56:59]
ds_read_b128 v[32:35], v1 offset:12288
v_mfma_f32_16x16x32_bf16 v[60:63], a[136:139], v[36:39], v[60:63]
s_waitcnt lgkmcnt(5)
v_mfma_f32_16x16x32_bf16 v[48:51], a[12:15], v[40:43], v[48:51]
ds_read_b128 v[36:39], v1 offset:13312
v_mfma_f32_16x16x32_bf16 v[52:55], a[140:143], v[40:43], v[52:55]
v_mfma_f32_16x16x32_bf16 v[56:59], a[12:15], v[44:47], v[56:59]
ds_read_b128 v[40:43], v1 offset:14336
v_mfma_f32_16x16x32_bf16 v[60:63], a[140:143], v[44:47], v[60:63]
s_waitcnt lgkmcnt(5)
v_mfma_f32_16x16x32_bf16 v[48:51], a[16:19], v[16:19], v[48:51]
ds_read_b128 v[44:47], v1 offset:15360
v_mfma_f32_16x16x32_bf16 v[52:55], a[144:147], v[16:19], v[52:55]
v_mfma_f32_16x16x32_bf16 v[56:59], a[16:19], v[20:23], v[56:59]
s_waitcnt vmcnt(9)
s_barrier
ds_read_b128 v[16:19], v1 offset:16384
v_mfma_f32_16x16x32_bf16 v[60:63], a[144:147], v[20:23], v[60:63]
s_waitcnt lgkmcnt(5)
v_mfma_f32_16x16x32_bf16 v[48:51], a[20:23], v[24:27], v[48:51]
ds_read_b128 v[20:23], v1 offset:17408
v_mfma_f32_16x16x32_bf16 v[52:55], a[148:151], v[24:27], v[52:55]
v_mfma_f32_16x16x32_bf16 v[56:59], a[20:23], v[28:31], v[56:59]
ds_read_b128 v[24:27], v1 offset:18432
v_mfma_f32_16x16x32_bf16 v[60:63], a[148:151], v[28:31], v[60:63]
s_waitcnt lgkmcnt(5)
v_mfma_f32_16x16x32_bf16 v[48:51], a[24:27], v[32:35], v[48:51]
ds_read_b128 v[28:31], v1 offset:19456
v_mfma_f32_16x16x32_bf16 v[52:55], a[152:155], v[32:35], v[52:55]
v_mfma_f32_16x16x32_bf16 v[56:59], a[24:27], v[36:39], v[56:59]
ds_read_b128 v[32:35], v1 offset:20480
v_mfma_f32_16x16x32_bf16 v[60:63], a[152:155], v[36:39], v[60:63]
s_waitcnt lgkmcnt(5)
v_mfma_f32_16x16x32_bf16 v[48:51], a[28:31], v[40:43], v[48:51]
ds_read_b128 v[36:39], v1 offset:21504
v_mfma_f32_16x16x32_bf16 v[52:55], a[156:159], v[40:43], v[52:55]
v_mfma_f32_16x16x32_bf16 v[56:59], a[28:31], v[44:47], v[56:59]
ds_read_b128 v[40:43], v1 offset:22528
v_mfma_f32_16x16x32_bf16 v[60:63], a[156:159], v[44:47], v[60:63]
s_waitcnt lgkmcnt(5)
v_mfma_f32_16x16x32_bf16 v[48:51], a[32:35], v[16:19], v[48:51]
ds_read_b128 v[44:47], v1 offset:23552
v_mfma_f32_16x16x32_bf16 v[52:55], a[160:163], v[16:19], v[52:55]
v_mfma_f32_16x16x32_bf16 v[56:59], a[32:35], v[20:23], v[56:59]
ds_read_b128 v[16:19], v1 offset:24576
v_mfma_f32_16x16x32_bf16 v[60:63], a[160:163], v[20:23], v[60:63]
s_waitcnt lgkmcnt(5)
v_mfma_f32_16x16x32_bf16 v[48:51], a[36:39], v[24:27], v[48:51]
ds_read_b128 v[20:23], v1 offset:25600
v_mfma_f32_16x16x32_bf16 v[52:55], a[164:167], v[24:27], v[52:55]
v_mfma_f32_16x16x32_bf16 v[56:59], a[36:39], v[28:31], v[56:59]
ds_read_b128 v[24:27], v1 offset:26624
v_mfma_f32_16x16x32_bf16 v[60:63], a[164:167], v[28:31], v[60:63]
s_waitcnt lgkmcnt(5)
v_mfma_f32_16x16x32_bf16 v[48:51], a[40:43], v[32:35], v[48:51]
ds_read_b128 v[28:31], v1 offset:27648
v_mfma_f32_16x16x32_bf16 v[52:55], a[168:171], v[32:35], v[52:55]
v_mfma_f32_16x16x32_bf16 v[56:59], a[40:43], v[36:39], v[56:59]
ds_read_b128 v[32:35], v1 offset:28672
v_mfma_f32_16x16x32_bf16 v[60:63], a[168:171], v[36:39], v[60:63]
s_waitcnt lgkmcnt(5)
v_mfma_f32_16x16x32_bf16 v[48:51], a[44:47], v[40:43], v[48:51]
ds_read_b128 v[36:39], v1 offset:29696
v_mfma_f32_16x16x32_bf16 v[52:55], a[172:175], v[40:43], v[52:55]
v_mfma_f32_16x16x32_bf16 v[56:59], a[44:47], v[44:47], v[56:59]
ds_read_b128 v[40:43], v1 offset:30720
v_mfma_f32_16x16x32_bf16 v[60:63], a[172:175], v[44:47], v[60:63]
s_waitcnt lgkmcnt(5)
v_mfma_f32_16x16x32_bf16 v[48:51], a[48:51], v[16:19], v[48:51]
ds_read_b128 v[44:47], v1 offset:31744
v_mfma_f32_16x16x32_bf16 v[52:55], a[176:179], v[16:19], v[52:55]
v_mfma_f32_16x16x32_bf16 v[56:59], a[48:51], v[20:23], v[56:59]
s_waitcnt vmcnt(5)
s_barrier
ds_read_b128 v[16:19], v1 offset:32768
v_mfma_f32_16x16x32_bf16 v[60:63], a[176:179], v[20:23], v[60:63]
s_waitcnt lgkmcnt(5)
v_mfma_f32_16x16x32_bf16 v[48:51], a[52:55], v[24:27], v[48:51]
ds_read_b128 v[20:23], v1 offset:33792
v_mfma_f32_16x16x32_bf16 v[52:55], a[180:183], v[24:27], v[52:55]
v_mfma_f32_16x16x32_bf16 v[56:59], a[52:55], v[28:31], v[56:59]
ds_read_b128 v[24:27], v1 offset:34816
v_mfma_f32_16x16x32_bf16 v[60:63], a[180:183], v[28:31], v[60:63]
s_waitcnt lgkmcnt(5)
v_mfma_f32_16x16x32_bf16 v[48:51], a[56:59], v[32:35], v[48:51]
ds_read_b128 v[28:31], v1 offset:35840
v_mfma_f32_16x16x32_bf16 v[52:55], a[184:187], v[32:35], v[52:55]
v_mfma_f32_16x16x32_bf16 v[56:59], a[56:59], v[36:39], v[56:59]
ds_read_b128 v[32:35], v1 offset:36864
v_mfma_f32_16x16x32_bf16 v[60:63], a[184:187], v[36:39], v[60:63]
s_waitcnt lgkmcnt(5)
v_mfma_f32_16x16x32_bf16 v[48:51], a[60:63], v[40:43], v[48:51]
ds_read_b128 v[36:39], v1 offset:37888
v_mfma_f32_16x16x32_bf16 v[52:55], a[188:191], v[40:43], v[52:55]
v_mfma_f32_16x16x32_bf16 v[56:59], a[60:63], v[44:47], v[56:59]
ds_read_b128 v[40:43], v1 offset:38912
v_mfma_f32_16x16x32_bf16 v[60:63], a[188:191], v[44:47], v[60:63]
s_waitcnt lgkmcnt(5)
v_mfma_f32_16x16x32_bf16 v[48:51], a[64:67], v[16:19], v[48:51]
ds_read_b128 v[44:47], v1 offset:39936
v_mfma_f32_16x16x32_bf16 v[52:55], a[192:195], v[16:19], v[52:55]
v_mfma_f32_16x16x32_bf16 v[56:59], a[64:67], v[20:23], v[56:59]
ds_read_b128 v[16:19], v1 offset:40960
v_mfma_f32_16x16x32_bf16 v[60:63], a[192:195], v[20:23], v[60:63]
s_waitcnt lgkmcnt(5)
v_mfma_f32_16x16x32_bf16 v[48:51], a[68:71], v[24:27], v[48:51]
ds_read_b128 v[20:23], v1 offset:41984
v_mfma_f32_16x16x32_bf16 v[52:55], a[196:199], v[24:27], v[52:55]
v_mfma_f32_16x16x32_bf16 v[56:59], a[68:71], v[28:31], v[56:59]
ds_read_b128 v[24:27], v1 offset:43008
v_mfma_f32_16x16x32_bf16 v[60:63], a[196:199], v[28:31], v[60:63]
s_waitcnt lgkmcnt(5)
v_mfma_f32_16x16x32_bf16 v[48:51], a[72:75], v[32:35], v[48:51]
ds_read_b128 v[28:31], v1 offset:44032
v_mfma_f32_16x16x32_bf16 v[52:55], a[200:203], v[32:35], v[52:55]
v_mfma_f32_16x16x32_bf16 v[56:59], a[72:75], v[36:39], v[56:59]
ds_read_b128 v[32:35], v1 offset:45056
v_mfma_f32_16x16x32_bf16 v[60:63], a[200:203], v[36:39], v[60:63]
s_waitcnt lgkmcnt(5)
v_mfma_f32_16x16x32_bf16 v[48:51], a[76:79], v[40:43], v[48:51]
ds_read_b128 v[36:39], v1 offset:46080
v_mfma_f32_16x16x32_bf16 v[52:55], a[204:207], v[40:43], v[52:55]
v_mfma_f32_16x16x32_bf16 v[56:59], a[76:79], v[44:47], v[56:59]
ds_read_b128 v[40:43], v1 offset:47104
v_mfma_f32_16x16x32_bf16 v[60:63], a[204:207], v[44:47], v[60:63]
s_waitcnt lgkmcnt(5)
v_mfma_f32_16x16x32_bf16 v[48:51], a[80:83], v[16:19], v[48:51]
ds_read_b128 v[44:47], v1 offset:48128
v_mfma_f32_16x16x32_bf16 v[52:55], a[208:211], v[16:19], v[52:55]
v_mfma_f32_16x16x32_bf16 v[56:59], a[80:83], v[20:23], v[56:59]
s_waitcnt vmcnt(1)
s_barrier
ds_read_b128 v[16:19], v1 offset:49152
v_mfma_f32_16x16x32_bf16 v[60:63], a[208:211], v[20:23], v[60:63]
s_waitcnt lgkmcnt(5)
buffer_load_dword v3, v2, s[4:7], s47 offen sc1
v_mfma_f32_16x16x32_bf16 v[48:51], a[84:87], v[24:27], v[48:51]
ds_read_b128 v[20:23], v1 offset:50176
v_mfma_f32_16x16x32_bf16 v[52:55], a[212:215], v[24:27], v[52:55]
v_mfma_f32_16x16x32_bf16 v[56:59], a[84:87], v[28:31], v[56:59]
ds_read_b128 v[24:27], v1 offset:51200
v_mfma_f32_16x16x32_bf16 v[60:63], a[212:215], v[28:31], v[60:63]
s_waitcnt lgkmcnt(5)
v_mfma_f32_16x16x32_bf16 v[48:51], a[88:91], v[32:35], v[48:51]
ds_read_b128 v[28:31], v1 offset:52224
v_mov_b32 v10, s36
v_mfma_f32_16x16x32_bf16 v[52:55], a[216:219], v[32:35], v[52:55]
s_and_b32 s38, s36, 1
s_lshl_b32 s38, s38, 12
s_cmp_gt_u32 s36, 60
v_mfma_f32_16x16x32_bf16 v[56:59], a[88:91], v[36:39], v[56:59]
s_cselect_b32 s38, s38, 0x70000000
ds_read_b128 v[32:35], v1 offset:53248
buffer_store_dword v10, v4, s[4:7], s38 offen sc1
v_mfma_f32_16x16x32_bf16 v[60:63], a[216:219], v[36:39], v[60:63]
s_waitcnt lgkmcnt(5)
v_mfma_f32_16x16x32_bf16 v[48:51], a[92:95], v[40:43], v[48:51]
ds_read_b128 v[36:39], v1 offset:54272
v_mfma_f32_16x16x32_bf16 v[52:55], a[220:223], v[40:43], v[52:55]
v_mfma_f32_16x16x32_bf16 v[56:59], a[92:95], v[44:47], v[56:59]
ds_read_b128 v[40:43], v1 offset:55296
v_mfma_f32_16x16x32_bf16 v[60:63], a[220:223], v[44:47], v[60:63]
s_waitcnt lgkmcnt(5)
v_mfma_f32_16x16x32_bf16 v[48:51], a[96:99], v[16:19], v[48:51]
ds_read_b128 v[44:47], v1 offset:56320
v_mfma_f32_16x16x32_bf16 v[52:55], a[224:227], v[16:19], v[52:55]
v_mfma_f32_16x16x32_bf16 v[56:59], a[96:99], v[20:23], v[56:59]
ds_read_b128 v[16:19], v1 offset:57344
v_mfma_f32_16x16x32_bf16 v[60:63], a[224:227], v[20:23], v[60:63]
s_waitcnt lgkmcnt(5)
v_mfma_f32_16x16x32_bf16 v[48:51], a[100:103], v[24:27], v[48:51]
ds_read_b128 v[20:23], v1 offset:58368
v_mfma_f32_16x16x32_bf16 v[52:55], a[228:231], v[24:27], v[52:55]
v_mfma_f32_16x16x32_bf16 v[56:59], a[100:103], v[28:31], v[56:59]
ds_read_b128 v[24:27], v1 offset:59392
v_mfma_f32_16x16x32_bf16 v[60:63], a[228:231], v[28:31], v[60:63]
s_waitcnt lgkmcnt(5)
v_mfma_f32_16x16x32_bf16 v[48:51], a[104:107], v[32:35], v[48:51]
ds_read_b128 v[28:31], v1 offset:60416
v_mfma_f32_16x16x32_bf16 v[52:55], a[232:235], v[32:35], v[52:55]
v_mfma_f32_16x16x32_bf16 v[56:59], a[104:107], v[36:39], v[56:59]
ds_read_b128 v[32:35], v1 offset:61440
v_mfma_f32_16x16x32_bf16 v[60:63], a[232:235], v[36:39], v[60:63]
s_waitcnt lgkmcnt(5)
v_mfma_f32_16x16x32_bf16 v[48:51], a[108:111], v[40:43], v[48:51]
ds_read_b128 v[36:39], v1 offset:62464
v_mfma_f32_16x16x32_bf16 v[52:55], a[236:239], v[40:43], v[52:55]
v_mfma_f32_16x16x32_bf16 v[56:59], a[108:111], v[44:47], v[56:59]
ds_read_b128 v[40:43], v1 offset:63488
v_mfma_f32_16x16x32_bf16 v[60:63], a[236:239], v[44:47], v[60:63]
s_waitcnt lgkmcnt(5)
v_mfma_f32_16x16x32_bf16 v[48:51], a[112:115], v[16:19], v[48:51]
ds_read_b128 v[44:47], v1 offset:64512
v_mfma_f32_16x16x32_bf16 v[52:55], a[240:243], v[16:19], v[52:55]
v_mfma_f32_16x16x32_bf16 v[56:59], a[112:115], v[20:23], v[56:59]
v_mfma_f32_16x16x32_bf16 v[60:63], a[240:243], v[20:23], v[60:63]
s_waitcnt lgkmcnt(4)
v_mfma_f32_16x16x32_bf16 v[48:51], a[116:119], v[24:27], v[48:51]
v_mfma_f32_16x16x32_bf16 v[52:55], a[244:247], v[24:27], v[52:55]
v_mfma_f32_16x16x32_bf16 v[56:59], a[116:119], v[28:31], v[56:59]
v_mfma_f32_16x16x32_bf16 v[60:63], a[244:247], v[28:31], v[60:63]
s_waitcnt lgkmcnt(2)
v_mfma_f32_16x16x32_bf16 v[48:51], a[120:123], v[32:35], v[48:51]
v_mfma_f32_16x16x32_bf16 v[52:55], a[248:251], v[32:35], v[52:55]
v_mfma_f32_16x16x32_bf16 v[56:59], a[120:123], v[36:39], v[56:59]
v_mfma_f32_16x16x32_bf16 v[60:63], a[248:251], v[36:39], v[60:63]
s_waitcnt lgkmcnt(0)
v_mfma_f32_16x16x32_bf16 v[48:51], a[124:127], v[40:43], v[48:51]
v_mfma_f32_16x16x32_bf16 v[52:55], a[252:255], v[40:43], v[52:55]
v_mfma_f32_16x16x32_bf16 v[56:59], a[124:127], v[44:47], v[56:59]
v_mfma_f32_16x16x32_bf16 v[60:63], a[252:255], v[44:47], v[60:63]
v_xor_b32 v1, 0x10000, v1
v_mov_b32 v5, s36
s_waitcnt vmcnt(1)
v_cmp_gt_u32 vcc, s48, v3
v_add_u32 v8, 1, v8
s_cmp_lg_u32 s35, 0
s_cbranch_scc1 Llf_586
buffer_store_dword v8, v7, s[4:7], 0 offen
s_branch Llo_587
Llf_586:
buffer_store_dword v8, v7, s[4:7], 0 offen sc1
Llo_587:
s_nop 3
v_cvt_pk_bf16_f32 v80, v48, v49
v_cvt_pk_bf16_f32 v81, v50, v51
v_cvt_pk_bf16_f32 v82, v52, v53
v_cvt_pk_bf16_f32 v83, v54, v55
buffer_store_dwordx4 v[80:83], v6, s[4:7], s49 offen offset:0 sc1
v_cvt_pk_bf16_f32 v84, v56, v57
v_cvt_pk_bf16_f32 v85, v58, v59
v_cvt_pk_bf16_f32 v86, v60, v61
v_cvt_pk_bf16_f32 v87, v62, v63
buffer_store_dwordx4 v[84:87], v6, s[4:7], s49 offen offset:1024 sc1
s_mov_b32 s46, 0
s_cbranch_vccnz Lsk_582
s_mov_b32 s46, 1
s_add_u32 m0, s50, 0
s_add_u32 s39, s54, 0
buffer_load_dwordx4 v0, s[4:7], s39 offen offset:0 sc1 lds
buffer_load_dwordx4 v0, s[4:7], s39 offen offset:1024 sc1 lds
buffer_load_dwordx4 v0, s[4:7], s39 offen offset:2048 sc1 lds
buffer_load_dwordx4 v0, s[4:7], s39 offen offset:3072 sc1 lds
s_add_u32 m0, s50, 16384
s_add_u32 s39, s54, 16384
buffer_load_dwordx4 v0, s[4:7], s39 offen offset:0 sc1 lds
buffer_load_dwordx4 v0, s[4:7], s39 offen offset:1024 sc1 lds
buffer_load_dwordx4 v0, s[4:7], s39 offen offset:2048 sc1 lds
buffer_load_dwordx4 v0, s[4:7], s39 offen offset:3072 sc1 lds
s_add_u32 m0, s50, 32768
s_add_u32 s39, s54, 32768
buffer_load_dwordx4 v0, s[4:7], s39 offen offset:0 sc1 lds
buffer_load_dwordx4 v0, s[4:7], s39 offen offset:1024 sc1 lds
buffer_load_dwordx4 v0, s[4:7], s39 offen offset:2048 sc1 lds
buffer_load_dwordx4 v0, s[4:7], s39 offen offset:3072 sc1 lds
s_add_u32 m0, s50, 49152
s_add_u32 s39, s54, 49152
buffer_load_dwordx4 v0, s[4:7], s39 offen offset:0 sc1 lds
buffer_load_dwordx4 v0, s[4:7], s39 offen offset:1024 sc1 lds
buffer_load_dwordx4 v0, s[4:7], s39 offen offset:2048 sc1 lds
buffer_load_dwordx4 v0, s[4:7], s39 offen offset:3072 sc1 lds
s_waitcnt vmcnt(16)
s_branch Lsj_583
Lsk_582:
s_waitcnt vmcnt(0)
Lsj_583:
s_barrier
s_and_b32 s38, s36, 1
s_lshl_b32 s38, s38, 12
buffer_store_dword v5, v4, s[4:7], s38 offen sc1
s_cmp_eq_u32 s36, 64
s_cbranch_scc1 Lso_581
s_cmp_lg_u32 s46, 0
s_cbranch_scc1 Lse_580
s_branch Lsw_579
Lso_581:
s_waitcnt vmcnt(0)
s_or_b32 s38, s26, s32
s_cbranch_scc1 Lend_7
buffer_wbl2 sc1
s_waitcnt vmcnt(0)
s_endpgm
Lhi_4:
s_cmp_ge_u32 s34, 16
s_cbranch_scc1 Lhelper_5
v_mov_b32 v9, v1
s_sub_u32 s44, s33, 4
s_lshl_b32 s44, s44, 4
s_and_b32 s38, s34, 7
s_lshl_b32 s38, s38, 1
s_add_u32 s44, s44, s38
s_lshr_b32 s38, s34, 3
s_xor_b32 s38, s38, 1
s_add_u32 s44, s44, s38
s_lshl_b32 s38, s44, 7
s_add_u32 s38, s38, 3407872
v_min_u32 v80, 1, v0
v_lshl_add_u32 v4, v80, 30, s38
v_mov_b32 v5, 0
buffer_store_dword v5, v4, s[4:7], 0 offen sc1
s_mov_b32 s38, 45056
buffer_store_dword v5, v4, s[4:7], s38 offen sc1
s_mov_b32 s52, 1
s_waitcnt vmcnt(0)
s_cmp_lg_u32 s32, 0
s_cbranch_scc1 Lar_588
s_mov_b64 exec, 1
v_mov_b32 v48, 144
v_mov_b32 v49, s52
buffer_atomic_add v49, v48, s[12:15], 0 offen sc1
s_mov_b64 exec, -1
Lar_588:
s_mov_b32 s8, s18
s_and_b32 s9, s19, 0xffff
s_mov_b32 s10, 0x800000
s_mov_b32 s11, 0x20000
s_mov_b32 s84, s20
s_and_b32 s85, s21, 0xffff
s_mov_b32 s86, 0x800000
s_mov_b32 s87, 0x20000
s_mov_b32 s88, s22
s_and_b32 s89, s23, 0xffff
s_mov_b32 s90, 0x800000
s_mov_b32 s91, 0x20000
s_lshl_b32 s60, s44, 7
s_xor_b32 s61, s60, 512
s_xor_b32 s62, s60, 256
s_and_b32 s52, s32, 1
s_lshl_b32 s52, s52, 6
v_bfe_u32 v84, v9, 2, 2
v_lshrrev_b32 v85, 4, v9
v_lshl_add_u32 v84, v85, 3, v84
v_lshl_add_u32 v84, v84, 7, s52
v_and_b32 v85, 3, v9
v_lshl_add_u32 v84, v85, 3, v84
v_add_u32 v84, 0, v84
v_bfe_u32 v85, v9, 3, 2
v_lshlrev_b32 v85, 5, v85
v_xor_b32 v80, v84, v85
v_bfe_u32 v84, v9, 2, 2
v_lshrrev_b32 v85, 4, v9
v_lshl_add_u32 v84, v85, 3, v84
v_lshl_add_u32 v84, v84, 7, s52
v_and_b32 v85, 3, v9
v_lshl_add_u32 v84, v85, 3, v84
v_add_u32 v84, 32, v84
v_bfe_u32 v85, v9, 3, 2
v_lshlrev_b32 v85, 5, v85
v_xor_b32 v81, v84, v85
s_lshl_b32 s52, s32, 5
v_bfe_u32 v84, v9, 2, 2
v_lshrrev_b32 v85, 4, v9
v_lshl_add_u32 v84, v85, 3, v84
v_lshl_add_u32 v84, v84, 7, s52
v_and_b32 v85, 3, v9
v_lshl_add_u32 v84, v85, 3, v84
v_add_u32 v84, 0, v84
v_bfe_u32 v85, v9, 3, 2
v_lshlrev_b32 v85, 5, v85
v_xor_b32 v82, v84, v85
s_mul_i32 s50, s32, 4096
v_lshlrev_b32 v1, 4, v9
v_add_u32 v0, s50, v1
s_xor_b32 s50, s50, 0x10000
s_mov_b32 s54, 8388608
v_lshrrev_b32 v84, 3, v9
s_mul_i32 s38, s32, 256
v_add_u32 v84, s38, v84
v_mul_u32_u24 v84, 8192, v84
v_and_b32 v85, 7, v9
v_lshl_add_u32 v84, v85, 4, v84
v_bfe_u32 v85, v9, 4, 1
v_lshlrev_b32 v85, 5, v85
v_xor_b32 v84, v84, v85
v_xor_b32 v85, 64, v84
s_lshl_b32 s38, s32, 13
s_barrier
s_add_u32 m0, s38, 0
s_add_u32 s39, s62, 0
buffer_load_dwordx4 v84, s[88:91], s39 offen lds
s_add_u32 m0, s38, 1024
s_add_u32 s39, s62, 65536
buffer_load_dwordx4 v85, s[88:91], s39 offen lds
s_add_u32 m0, s38, 2048
s_add_u32 s39, s62, 131072
buffer_load_dwordx4 v84, s[88:91], s39 offen lds
s_add_u32 m0, s38, 3072
s_add_u32 s39, s62, 196608
buffer_load_dwordx4 v85, s[88:91], s39 offen lds
s_add_u32 m0, s38, 4096
s_add_u32 s39, s62, 262144
buffer_load_dwordx4 v84, s[88:91], s39 offen lds
s_add_u32 m0, s38, 5120
s_add_u32 s39, s62, 327680
buffer_load_dwordx4 v85, s[88:91], s39 offen lds
s_add_u32 m0, s38, 6144
s_add_u32 s39, s62, 393216
buffer_load_dwordx4 v84, s[88:91], s39 offen lds
s_add_u32 m0, s38, 7168
s_add_u32 s39, s62, 458752
buffer_load_dwordx4 v85, s[88:91], s39 offen lds
s_add_u32 m0, s38, 32768
s_add_u32 s39, s62, 524288
buffer_load_dwordx4 v84, s[88:91], s39 offen lds
s_add_u32 m0, s38, 33792
s_add_u32 s39, s62, 589824
buffer_load_dwordx4 v85, s[88:91], s39 offen lds
s_add_u32 m0, s38, 34816
s_add_u32 s39, s62, 655360
buffer_load_dwordx4 v84, s[88:91], s39 offen lds
s_add_u32 m0, s38, 35840
s_add_u32 s39, s62, 720896
buffer_load_dwordx4 v85, s[88:91], s39 offen lds
s_add_u32 m0, s38, 36864
s_add_u32 s39, s62, 786432
buffer_load_dwordx4 v84, s[88:91], s39 offen lds
s_add_u32 m0, s38, 37888
s_add_u32 s39, s62, 851968
buffer_load_dwordx4 v85, s[88:91], s39 offen lds
s_add_u32 m0, s38, 38912
s_add_u32 s39, s62, 917504
buffer_load_dwordx4 v84, s[88:91], s39 offen lds
s_add_u32 m0, s38, 39936
s_add_u32 s39, s62, 983040
buffer_load_dwordx4 v85, s[88:91], s39 offen lds
s_waitcnt vmcnt(8)
s_barrier
ds_read_b64_tr_b16 v[128:129], v82 offset:0
ds_read_b64_tr_b16 v[130:131], v82 offset:512
ds_read_b64_tr_b16 v[132:133], v82 offset:4096
ds_read_b64_tr_b16 v[134:135], v82 offset:4608
ds_read_b64_tr_b16 v[160:161], v82 offset:8192
ds_read_b64_tr_b16 v[162:163], v82 offset:8704
ds_read_b64_tr_b16 v[164:165], v82 offset:12288
ds_read_b64_tr_b16 v[166:167], v82 offset:12800
ds_read_b64_tr_b16 v[192:193], v82 offset:16384
ds_read_b64_tr_b16 v[194:195], v82 offset:16896
ds_read_b64_tr_b16 v[196:197], v82 offset:20480
ds_read_b64_tr_b16 v[198:199], v82 offset:20992
ds_read_b64_tr_b16 v[224:225], v82 offset:24576
ds_read_b64_tr_b16 v[226:227], v82 offset:25088
ds_read_b64_tr_b16 v[228:229], v82 offset:28672
ds_read_b64_tr_b16 v[230:231], v82 offset:29184
Llw_589:
v_add_u32 v80, 32768, v80
v_add_u32 v81, 32768, v81
v_add_u32 v82, 32768, v82
s_add_u32 m0, s38, 65536
s_add_u32 s39, s62, 1048576
buffer_load_dwordx4 v84, s[88:91], s39 offen lds
s_add_u32 m0, s38, 66560
s_add_u32 s39, s62, 1114112
buffer_load_dwordx4 v85, s[88:91], s39 offen lds
s_add_u32 m0, s38, 67584
s_add_u32 s39, s62, 1179648
buffer_load_dwordx4 v84, s[88:91], s39 offen lds
s_add_u32 m0, s38, 68608
s_add_u32 s39, s62, 1245184
buffer_load_dwordx4 v85, s[88:91], s39 offen lds
s_add_u32 m0, s38, 69632
s_add_u32 s39, s62, 1310720
buffer_load_dwordx4 v84, s[88:91], s39 offen lds
s_add_u32 m0, s38, 70656
s_add_u32 s39, s62, 1376256
buffer_load_dwordx4 v85, s[88:91], s39 offen lds
s_add_u32 m0, s38, 71680
s_add_u32 s39, s62, 1441792
buffer_load_dwordx4 v84, s[88:91], s39 offen lds
s_add_u32 m0, s38, 72704
s_add_u32 s39, s62, 1507328
buffer_load_dwordx4 v85, s[88:91], s39 offen lds
s_waitcnt lgkmcnt(0)
s_waitcnt vmcnt(8)
s_barrier
ds_read_b64_tr_b16 v[136:137], v82 offset:0
ds_read_b64_tr_b16 v[138:139], v82 offset:512
ds_read_b64_tr_b16 v[140:141], v82 offset:4096
ds_read_b64_tr_b16 v[142:143], v82 offset:4608
ds_read_b64_tr_b16 v[168:169], v82 offset:8192
ds_read_b64_tr_b16 v[170:171], v82 offset:8704
ds_read_b64_tr_b16 v[172:173], v82 offset:12288
ds_read_b64_tr_b16 v[174:175], v82 offset:12800
ds_read_b64_tr_b16 v[200:201], v82 offset:16384
ds_read_b64_tr_b16 v[202:203], v82 offset:16896
ds_read_b64_tr_b16 v[204:205], v82 offset:20480
ds_read_b64_tr_b16 v[206:207], v82 offset:20992
ds_read_b64_tr_b16 v[232:233], v82 offset:24576
ds_read_b64_tr_b16 v[234:235], v82 offset:25088
ds_read_b64_tr_b16 v[236:237], v82 offset:28672
ds_read_b64_tr_b16 v[238:239], v82 offset:29184
Llw_590:
v_add_u32 v80, 32768, v80
v_add_u32 v81, 32768, v81
v_add_u32 v82, 32768, v82
s_add_u32 m0, s38, 98304
s_add_u32 s39, s62, 1572864
buffer_load_dwordx4 v84, s[88:91], s39 offen lds
s_add_u32 m0, s38, 99328
s_add_u32 s39, s62, 1638400
buffer_load_dwordx4 v85, s[88:91], s39 offen lds
s_add_u32 m0, s38, 100352
s_add_u32 s39, s62, 1703936
buffer_load_dwordx4 v84, s[88:91], s39 offen lds
s_add_u32 m0, s38, 101376
s_add_u32 s39, s62, 1769472
buffer_load_dwordx4 v85, s[88:91], s39 offen lds
s_add_u32 m0, s38, 102400
s_add_u32 s39, s62, 1835008
buffer_load_dwordx4 v84, s[88:91], s39 offen lds
s_add_u32 m0, s38, 103424
s_add_u32 s39, s62, 1900544
buffer_load_dwordx4 v85, s[88:91], s39 offen lds
s_add_u32 m0, s38, 104448
s_add_u32 s39, s62, 1966080
buffer_load_dwordx4 v84, s[88:91], s39 offen lds
s_add_u32 m0, s38, 105472
s_add_u32 s39, s62, 2031616
buffer_load_dwordx4 v85, s[88:91], s39 offen lds
s_waitcnt lgkmcnt(0)
s_waitcnt vmcnt(8)
s_barrier
ds_read_b64_tr_b16 v[144:145], v82 offset:0
ds_read_b64_tr_b16 v[146:147], v82 offset:512
ds_read_b64_tr_b16 v[148:149], v82 offset:4096
ds_read_b64_tr_b16 v[150:151], v82 offset:4608
ds_read_b64_tr_b16 v[176:177], v82 offset:8192
ds_read_b64_tr_b16 v[178:179], v82 offset:8704
ds_read_b64_tr_b16 v[180:181], v82 offset:12288
ds_read_b64_tr_b16 v[182:183], v82 offset:12800
ds_read_b64_tr_b16 v[208:209], v82 offset:16384
ds_read_b64_tr_b16 v[210:211], v82 offset:16896
ds_read_b64_tr_b16 v[212:213], v82 offset:20480
ds_read_b64_tr_b16 v[214:215], v82 offset:20992
ds_read_b64_tr_b16 v[240:241], v82 offset:24576
ds_read_b64_tr_b16 v[242:243], v82 offset:25088
ds_read_b64_tr_b16 v[244:245], v82 offset:28672
ds_read_b64_tr_b16 v[246:247], v82 offset:29184
Llw_591:
v_add_u32 v80, 32768, v80
v_add_u32 v81, 32768, v81
v_add_u32 v82, 32768, v82
s_add_u32 m0, s38, 131072
s_add_u32 s39, s61, 0
buffer_load_dwordx4 v84, s[84:87], s39 offen lds
s_add_u32 m0, s38, 132096
s_add_u32 s39, s61, 65536
buffer_load_dwordx4 v85, s[84:87], s39 offen lds
s_add_u32 m0, s38, 133120
s_add_u32 s39, s61, 131072
buffer_load_dwordx4 v84, s[84:87], s39 offen lds
s_add_u32 m0, s38, 134144
s_add_u32 s39, s61, 196608
buffer_load_dwordx4 v85, s[84:87], s39 offen lds
s_add_u32 m0, s38, 135168
s_add_u32 s39, s61, 262144
buffer_load_dwordx4 v84, s[84:87], s39 offen lds
s_add_u32 m0, s38, 136192
s_add_u32 s39, s61, 327680
buffer_load_dwordx4 v85, s[84:87], s39 offen lds
s_add_u32 m0, s38, 137216
s_add_u32 s39, s61, 393216
buffer_load_dwordx4 v84, s[84:87], s39 offen lds
s_add_u32 m0, s38, 138240
s_add_u32 s39, s61, 458752
buffer_load_dwordx4 v85, s[84:87], s39 offen lds
s_waitcnt lgkmcnt(0)
s_waitcnt vmcnt(8)
s_barrier
ds_read_b64_tr_b16 v[152:153], v82 offset:0
ds_read_b64_tr_b16 v[154:155], v82 offset:512
ds_read_b64_tr_b16 v[156:157], v82 offset:4096
ds_read_b64_tr_b16 v[158:159], v82 offset:4608
ds_read_b64_tr_b16 v[184:185], v82 offset:8192
ds_read_b64_tr_b16 v[186:187], v82 offset:8704
ds_read_b64_tr_b16 v[188:189], v82 offset:12288
ds_read_b64_tr_b16 v[190:191], v82 offset:12800
ds_read_b64_tr_b16 v[216:217], v82 offset:16384
ds_read_b64_tr_b16 v[218:219], v82 offset:16896
ds_read_b64_tr_b16 v[220:221], v82 offset:20480
ds_read_b64_tr_b16 v[222:223], v82 offset:20992
ds_read_b64_tr_b16 v[248:249], v82 offset:24576
ds_read_b64_tr_b16 v[250:251], v82 offset:25088
ds_read_b64_tr_b16 v[252:253], v82 offset:28672
ds_read_b64_tr_b16 v[254:255], v82 offset:29184
Llw_592:
v_add_u32 v80, 32768, v80
v_add_u32 v81, 32768, v81
v_add_u32 v82, 32768, v82
s_add_u32 m0, s38, 0
s_add_u32 s39, s61, 524288
buffer_load_dwordx4 v84, s[84:87], s39 offen lds
s_add_u32 m0, s38, 1024
s_add_u32 s39, s61, 589824
buffer_load_dwordx4 v85, s[84:87], s39 offen lds
s_add_u32 m0, s38, 2048
s_add_u32 s39, s61, 655360
buffer_load_dwordx4 v84, s[84:87], s39 offen lds
s_add_u32 m0, s38, 3072
s_add_u32 s39, s61, 720896
buffer_load_dwordx4 v85, s[84:87], s39 offen lds
s_add_u32 m0, s38, 4096
s_add_u32 s39, s61, 786432
buffer_load_dwordx4 v84, s[84:87], s39 offen lds
s_add_u32 m0, s38, 5120
s_add_u32 s39, s61, 851968
buffer_load_dwordx4 v85, s[84:87], s39 offen lds
s_add_u32 m0, s38, 6144
s_add_u32 s39, s61, 917504
buffer_load_dwordx4 v84, s[84:87], s39 offen lds
s_add_u32 m0, s38, 7168
s_add_u32 s39, s61, 983040
buffer_load_dwordx4 v85, s[84:87], s39 offen lds
s_waitcnt lgkmcnt(0)
s_waitcnt vmcnt(8)
s_barrier
s_bitcmp0_b32 s32, 1
s_cbranch_scc1 Llw_593
ds_read_b64_tr_b16 a[0:1], v80 offset:0
ds_read_b64_tr_b16 a[2:3], v80 offset:512
ds_read_b64_tr_b16 a[4:5], v80 offset:4096
ds_read_b64_tr_b16 a[6:7], v80 offset:4608
ds_read_b64_tr_b16 a[32:33], v80 offset:8192
ds_read_b64_tr_b16 a[34:35], v80 offset:8704
ds_read_b64_tr_b16 a[36:37], v80 offset:12288
ds_read_b64_tr_b16 a[38:39], v80 offset:12800
ds_read_b64_tr_b16 a[64:65], v80 offset:16384
ds_read_b64_tr_b16 a[66:67], v80 offset:16896
ds_read_b64_tr_b16 a[68:69], v80 offset:20480
ds_read_b64_tr_b16 a[70:71], v80 offset:20992
ds_read_b64_tr_b16 a[96:97], v80 offset:24576
ds_read_b64_tr_b16 a[98:99], v80 offset:25088
ds_read_b64_tr_b16 a[100:101], v80 offset:28672
ds_read_b64_tr_b16 a[102:103], v80 offset:29184
ds_read_b64_tr_b16 a[128:129], v81 offset:0
ds_read_b64_tr_b16 a[130:131], v81 offset:512
ds_read_b64_tr_b16 a[132:133], v81 offset:4096
ds_read_b64_tr_b16 a[134:135], v81 offset:4608
ds_read_b64_tr_b16 a[160:161], v81 offset:8192
ds_read_b64_tr_b16 a[162:163], v81 offset:8704
ds_read_b64_tr_b16 a[164:165], v81 offset:12288
ds_read_b64_tr_b16 a[166:167], v81 offset:12800
ds_read_b64_tr_b16 a[192:193], v81 offset:16384
ds_read_b64_tr_b16 a[194:195], v81 offset:16896
ds_read_b64_tr_b16 a[196:197], v81 offset:20480
ds_read_b64_tr_b16 a[198:199], v81 offset:20992
ds_read_b64_tr_b16 a[224:225], v81 offset:24576
ds_read_b64_tr_b16 a[226:227], v81 offset:25088
ds_read_b64_tr_b16 a[228:229], v81 offset:28672
ds_read_b64_tr_b16 a[230:231], v81 offset:29184
Llw_593:
v_add_u32 v80, -131072, v80
v_add_u32 v81, -131072, v81
v_add_u32 v82, -131072, v82
s_add_u32 m0, s38, 32768
s_add_u32 s39, s61, 1048576
buffer_load_dwordx4 v84, s[84:87], s39 offen lds
s_add_u32 m0, s38, 33792
s_add_u32 s39, s61, 1114112
buffer_load_dwordx4 v85, s[84:87], s39 offen lds
s_add_u32 m0, s38, 34816
s_add_u32 s39, s61, 1179648
buffer_load_dwordx4 v84, s[84:87], s39 offen lds
s_add_u32 m0, s38, 35840
s_add_u32 s39, s61, 1245184
buffer_load_dwordx4 v85, s[84:87], s39 offen lds
s_add_u32 m0, s38, 36864
s_add_u32 s39, s61, 1310720
buffer_load_dwordx4 v84, s[84:87], s39 offen lds
s_add_u32 m0, s38, 37888
s_add_u32 s39, s61, 1376256
buffer_load_dwordx4 v85, s[84:87], s39 offen lds
s_add_u32 m0, s38, 38912
s_add_u32 s39, s61, 1441792
buffer_load_dwordx4 v84, s[84:87], s39 offen lds
s_add_u32 m0, s38, 39936
s_add_u32 s39, s61, 1507328
buffer_load_dwordx4 v85, s[84:87], s39 offen lds
s_waitcnt lgkmcnt(0)
s_waitcnt vmcnt(8)
s_barrier
s_bitcmp0_b32 s32, 1
s_cbranch_scc1 Llw_594
ds_read_b64_tr_b16 a[8:9], v80 offset:0
ds_read_b64_tr_b16 a[10:11], v80 offset:512
ds_read_b64_tr_b16 a[12:13], v80 offset:4096
ds_read_b64_tr_b16 a[14:15], v80 offset:4608
ds_read_b64_tr_b16 a[40:41], v80 offset:8192
ds_read_b64_tr_b16 a[42:43], v80 offset:8704
ds_read_b64_tr_b16 a[44:45], v80 offset:12288
ds_read_b64_tr_b16 a[46:47], v80 offset:12800
ds_read_b64_tr_b16 a[72:73], v80 offset:16384
ds_read_b64_tr_b16 a[74:75], v80 offset:16896
ds_read_b64_tr_b16 a[76:77], v80 offset:20480
ds_read_b64_tr_b16 a[78:79], v80 offset:20992
ds_read_b64_tr_b16 a[104:105], v80 offset:24576
ds_read_b64_tr_b16 a[106:107], v80 offset:25088
ds_read_b64_tr_b16 a[108:109], v80 offset:28672
ds_read_b64_tr_b16 a[110:111], v80 offset:29184
ds_read_b64_tr_b16 a[136:137], v81 offset:0
ds_read_b64_tr_b16 a[138:139], v81 offset:512
ds_read_b64_tr_b16 a[140:141], v81 offset:4096
ds_read_b64_tr_b16 a[142:143], v81 offset:4608
ds_read_b64_tr_b16 a[168:169], v81 offset:8192
ds_read_b64_tr_b16 a[170:171], v81 offset:8704
ds_read_b64_tr_b16 a[172:173], v81 offset:12288
ds_read_b64_tr_b16 a[174:175], v81 offset:12800
ds_read_b64_tr_b16 a[200:201], v81 offset:16384
ds_read_b64_tr_b16 a[202:203], v81 offset:16896
ds_read_b64_tr_b16 a[204:205], v81 offset:20480
ds_read_b64_tr_b16 a[206:207], v81 offset:20992
ds_read_b64_tr_b16 a[232:233], v81 offset:24576
ds_read_b64_tr_b16 a[234:235], v81 offset:25088
ds_read_b64_tr_b16 a[236:237], v81 offset:28672
ds_read_b64_tr_b16 a[238:239], v81 offset:29184
Llw_594:
v_add_u32 v80, 32768, v80
v_add_u32 v81, 32768, v81
v_add_u32 v82, 32768, v82
buffer_load_dword v12, off, s[12:15], 0 offset:144 sc1
s_add_u32 m0, s38, 65536
s_add_u32 s39, s61, 1572864
buffer_load_dwordx4 v84, s[84:87], s39 offen lds
s_add_u32 m0, s38, 66560
s_add_u32 s39, s61, 1638400
buffer_load_dwordx4 v85, s[84:87], s39 offen lds
s_add_u32 m0, s38, 67584
s_add_u32 s39, s61, 1703936
buffer_load_dwordx4 v84, s[84:87], s39 offen lds
s_add_u32 m0, s38, 68608
s_add_u32 s39, s61, 1769472
buffer_load_dwordx4 v85, s[84:87], s39 offen lds
s_add_u32 m0, s38, 69632
s_add_u32 s39, s61, 1835008
buffer_load_dwordx4 v84, s[84:87], s39 offen lds
s_add_u32 m0, s38, 70656
s_add_u32 s39, s61, 1900544
buffer_load_dwordx4 v85, s[84:87], s39 offen lds
s_add_u32 m0, s38, 71680
s_add_u32 s39, s61, 1966080
buffer_load_dwordx4 v84, s[84:87], s39 offen lds
s_add_u32 m0, s38, 72704
s_add_u32 s39, s61, 2031616
buffer_load_dwordx4 v85, s[84:87], s39 offen lds
s_waitcnt lgkmcnt(0)
s_waitcnt vmcnt(8)
s_barrier
s_bitcmp0_b32 s32, 1
s_cbranch_scc1 Llw_595
ds_read_b64_tr_b16 a[16:17], v80 offset:0
ds_read_b64_tr_b16 a[18:19], v80 offset:512
ds_read_b64_tr_b16 a[20:21], v80 offset:4096
ds_read_b64_tr_b16 a[22:23], v80 offset:4608
ds_read_b64_tr_b16 a[48:49], v80 offset:8192
ds_read_b64_tr_b16 a[50:51], v80 offset:8704
ds_read_b64_tr_b16 a[52:53], v80 offset:12288
ds_read_b64_tr_b16 a[54:55], v80 offset:12800
ds_read_b64_tr_b16 a[80:81], v80 offset:16384
ds_read_b64_tr_b16 a[82:83], v80 offset:16896
ds_read_b64_tr_b16 a[84:85], v80 offset:20480
ds_read_b64_tr_b16 a[86:87], v80 offset:20992
ds_read_b64_tr_b16 a[112:113], v80 offset:24576
ds_read_b64_tr_b16 a[114:115], v80 offset:25088
ds_read_b64_tr_b16 a[116:117], v80 offset:28672
ds_read_b64_tr_b16 a[118:119], v80 offset:29184
ds_read_b64_tr_b16 a[144:145], v81 offset:0
ds_read_b64_tr_b16 a[146:147], v81 offset:512
ds_read_b64_tr_b16 a[148:149], v81 offset:4096
ds_read_b64_tr_b16 a[150:151], v81 offset:4608
ds_read_b64_tr_b16 a[176:177], v81 offset:8192
ds_read_b64_tr_b16 a[178:179], v81 offset:8704
ds_read_b64_tr_b16 a[180:181], v81 offset:12288
ds_read_b64_tr_b16 a[182:183], v81 offset:12800
ds_read_b64_tr_b16 a[208:209], v81 offset:16384
ds_read_b64_tr_b16 a[210:211], v81 offset:16896
ds_read_b64_tr_b16 a[212:213], v81 offset:20480
ds_read_b64_tr_b16 a[214:215], v81 offset:20992
ds_read_b64_tr_b16 a[240:241], v81 offset:24576
ds_read_b64_tr_b16 a[242:243], v81 offset:25088
ds_read_b64_tr_b16 a[244:245], v81 offset:28672
ds_read_b64_tr_b16 a[246:247], v81 offset:29184
Llw_595:
v_add_u32 v80, 32768, v80
v_add_u32 v81, 32768, v81
v_add_u32 v82, 32768, v82
s_add_u32 m0, s38, 98304
s_add_u32 s39, s60, 0
buffer_load_dwordx4 v84, s[8:11], s39 offen lds
s_add_u32 m0, s38, 99328
s_add_u32 s39, s60, 65536
buffer_load_dwordx4 v85, s[8:11], s39 offen lds
s_add_u32 m0, s38, 100352
s_add_u32 s39, s60, 131072
buffer_load_dwordx4 v84, s[8:11], s39 offen lds
s_add_u32 m0, s38, 101376
s_add_u32 s39, s60, 196608
buffer_load_dwordx4 v85, s[8:11], s39 offen lds
s_add_u32 m0, s38, 102400
s_add_u32 s39, s60, 262144
buffer_load_dwordx4 v84, s[8:11], s39 offen lds
s_add_u32 m0, s38, 103424
s_add_u32 s39, s60, 327680
buffer_load_dwordx4 v85, s[8:11], s39 offen lds
s_add_u32 m0, s38, 104448
s_add_u32 s39, s60, 393216
buffer_load_dwordx4 v84, s[8:11], s39 offen lds
s_add_u32 m0, s38, 105472
s_add_u32 s39, s60, 458752
buffer_load_dwordx4 v85, s[8:11], s39 offen lds
s_waitcnt lgkmcnt(0)
s_waitcnt vmcnt(8)
s_barrier
s_bitcmp0_b32 s32, 1
s_cbranch_scc1 Llw_596
ds_read_b64_tr_b16 a[24:25], v80 offset:0
ds_read_b64_tr_b16 a[26:27], v80 offset:512
ds_read_b64_tr_b16 a[28:29], v80 offset:4096
ds_read_b64_tr_b16 a[30:31], v80 offset:4608
ds_read_b64_tr_b16 a[56:57], v80 offset:8192
ds_read_b64_tr_b16 a[58:59], v80 offset:8704
ds_read_b64_tr_b16 a[60:61], v80 offset:12288
ds_read_b64_tr_b16 a[62:63], v80 offset:12800
ds_read_b64_tr_b16 a[88:89], v80 offset:16384
ds_read_b64_tr_b16 a[90:91], v80 offset:16896
ds_read_b64_tr_b16 a[92:93], v80 offset:20480
ds_read_b64_tr_b16 a[94:95], v80 offset:20992
ds_read_b64_tr_b16 a[120:121], v80 offset:24576
ds_read_b64_tr_b16 a[122:123], v80 offset:25088
ds_read_b64_tr_b16 a[124:125], v80 offset:28672
ds_read_b64_tr_b16 a[126:127], v80 offset:29184
ds_read_b64_tr_b16 a[152:153], v81 offset:0
ds_read_b64_tr_b16 a[154:155], v81 offset:512
ds_read_b64_tr_b16 a[156:157], v81 offset:4096
ds_read_b64_tr_b16 a[158:159], v81 offset:4608
ds_read_b64_tr_b16 a[184:185], v81 offset:8192
ds_read_b64_tr_b16 a[186:187], v81 offset:8704
ds_read_b64_tr_b16 a[188:189], v81 offset:12288
ds_read_b64_tr_b16 a[190:191], v81 offset:12800
ds_read_b64_tr_b16 a[216:217], v81 offset:16384
ds_read_b64_tr_b16 a[218:219], v81 offset:16896
ds_read_b64_tr_b16 a[220:221], v81 offset:20480
ds_read_b64_tr_b16 a[222:223], v81 offset:20992
ds_read_b64_tr_b16 a[248:249], v81 offset:24576
ds_read_b64_tr_b16 a[250:251], v81 offset:25088
ds_read_b64_tr_b16 a[252:253], v81 offset:28672
ds_read_b64_tr_b16 a[254:255], v81 offset:29184
Llw_596:
v_add_u32 v80, 32768, v80
v_add_u32 v81, 32768, v81
v_add_u32 v82, 32768, v82
s_add_u32 m0, s38, 131072
s_add_u32 s39, s60, 524288
buffer_load_dwordx4 v84, s[8:11], s39 offen lds
s_add_u32 m0, s38, 132096
s_add_u32 s39, s60, 589824
buffer_load_dwordx4 v85, s[8:11], s39 offen lds
s_add_u32 m0, s38, 133120
s_add_u32 s39, s60, 655360
buffer_load_dwordx4 v84, s[8:11], s39 offen lds
s_add_u32 m0, s38, 134144
s_add_u32 s39, s60, 720896
buffer_load_dwordx4 v85, s[8:11], s39 offen lds
s_add_u32 m0, s38, 135168
s_add_u32 s39, s60, 786432
buffer_load_dwordx4 v84, s[8:11], s39 offen lds
s_add_u32 m0, s38, 136192
s_add_u32 s39, s60, 851968
buffer_load_dwordx4 v85, s[8:11], s39 offen lds
s_add_u32 m0, s38, 137216
s_add_u32 s39, s60, 917504
buffer_load_dwordx4 v84, s[8:11], s39 offen lds
s_add_u32 m0, s38, 138240
s_add_u32 s39, s60, 983040
buffer_load_dwordx4 v85, s[8:11], s39 offen lds
s_waitcnt lgkmcnt(0)
s_waitcnt vmcnt(8)
s_barrier
s_bitcmp1_b32 s32, 1
s_cbranch_scc1 Llw_597
ds_read_b64_tr_b16 a[0:1], v80 offset:0
ds_read_b64_tr_b16 a[2:3], v80 offset:512
ds_read_b64_tr_b16 a[4:5], v80 offset:4096
ds_read_b64_tr_b16 a[6:7], v80 offset:4608
ds_read_b64_tr_b16 a[32:33], v80 offset:8192
ds_read_b64_tr_b16 a[34:35], v80 offset:8704
ds_read_b64_tr_b16 a[36:37], v80 offset:12288
ds_read_b64_tr_b16 a[38:39], v80 offset:12800
ds_read_b64_tr_b16 a[64:65], v80 offset:16384
ds_read_b64_tr_b16 a[66:67], v80 offset:16896
ds_read_b64_tr_b16 a[68:69], v80 offset:20480
ds_read_b64_tr_b16 a[70:71], v80 offset:20992
ds_read_b64_tr_b16 a[96:97], v80 offset:24576
ds_read_b64_tr_b16 a[98:99], v80 offset:25088
ds_read_b64_tr_b16 a[100:101], v80 offset:28672
ds_read_b64_tr_b16 a[102:103], v80 offset:29184
ds_read_b64_tr_b16 a[128:129], v81 offset:0
ds_read_b64_tr_b16 a[130:131], v81 offset:512
ds_read_b64_tr_b16 a[132:133], v81 offset:4096
ds_read_b64_tr_b16 a[134:135], v81 offset:4608
ds_read_b64_tr_b16 a[160:161], v81 offset:8192
ds_read_b64_tr_b16 a[162:163], v81 offset:8704
ds_read_b64_tr_b16 a[164:165], v81 offset:12288
ds_read_b64_tr_b16 a[166:167], v81 offset:12800
ds_read_b64_tr_b16 a[192:193], v81 offset:16384
ds_read_b64_tr_b16 a[194:195], v81 offset:16896
ds_read_b64_tr_b16 a[196:197], v81 offset:20480
ds_read_b64_tr_b16 a[198:199], v81 offset:20992
ds_read_b64_tr_b16 a[224:225], v81 offset:24576
ds_read_b64_tr_b16 a[226:227], v81 offset:25088
ds_read_b64_tr_b16 a[228:229], v81 offset:28672
ds_read_b64_tr_b16 a[230:231], v81 offset:29184
Llw_597:
v_add_u32 v80, 32768, v80
v_add_u32 v81, 32768, v81
v_add_u32 v82, 32768, v82
s_add_u32 m0, s38, 0
s_add_u32 s39, s60, 1048576
buffer_load_dwordx4 v84, s[8:11], s39 offen lds
s_add_u32 m0, s38, 1024
s_add_u32 s39, s60, 1114112
buffer_load_dwordx4 v85, s[8:11], s39 offen lds
s_add_u32 m0, s38, 2048
s_add_u32 s39, s60, 1179648
buffer_load_dwordx4 v84, s[8:11], s39 offen lds
s_add_u32 m0, s38, 3072
s_add_u32 s39, s60, 1245184
buffer_load_dwordx4 v85, s[8:11], s39 offen lds
s_add_u32 m0, s38, 4096
s_add_u32 s39, s60, 1310720
buffer_load_dwordx4 v84, s[8:11], s39 offen lds
s_add_u32 m0, s38, 5120
s_add_u32 s39, s60, 1376256
buffer_load_dwordx4 v85, s[8:11], s39 offen lds
s_add_u32 m0, s38, 6144
s_add_u32 s39, s60, 1441792
buffer_load_dwordx4 v84, s[8:11], s39 offen lds
s_add_u32 m0, s38, 7168
s_add_u32 s39, s60, 1507328
buffer_load_dwordx4 v85, s[8:11], s39 offen lds
s_waitcnt lgkmcnt(0)
s_waitcnt vmcnt(8)
s_barrier
s_bitcmp1_b32 s32, 1
s_cbranch_scc1 Llw_598
ds_read_b64_tr_b16 a[8:9], v80 offset:0
ds_read_b64_tr_b16 a[10:11], v80 offset:512
ds_read_b64_tr_b16 a[12:13], v80 offset:4096
ds_read_b64_tr_b16 a[14:15], v80 offset:4608
ds_read_b64_tr_b16 a[40:41], v80 offset:8192
ds_read_b64_tr_b16 a[42:43], v80 offset:8704
ds_read_b64_tr_b16 a[44:45], v80 offset:12288
ds_read_b64_tr_b16 a[46:47], v80 offset:12800
ds_read_b64_tr_b16 a[72:73], v80 offset:16384
ds_read_b64_tr_b16 a[74:75], v80 offset:16896
ds_read_b64_tr_b16 a[76:77], v80 offset:20480
ds_read_b64_tr_b16 a[78:79], v80 offset:20992
ds_read_b64_tr_b16 a[104:105], v80 offset:24576
ds_read_b64_tr_b16 a[106:107], v80 offset:25088
ds_read_b64_tr_b16 a[108:109], v80 offset:28672
ds_read_b64_tr_b16 a[110:111], v80 offset:29184
ds_read_b64_tr_b16 a[136:137], v81 offset:0
ds_read_b64_tr_b16 a[138:139], v81 offset:512
ds_read_b64_tr_b16 a[140:141], v81 offset:4096
ds_read_b64_tr_b16 a[142:143], v81 offset:4608
ds_read_b64_tr_b16 a[168:169], v81 offset:8192
ds_read_b64_tr_b16 a[170:171], v81 offset:8704
ds_read_b64_tr_b16 a[172:173], v81 offset:12288
ds_read_b64_tr_b16 a[174:175], v81 offset:12800
ds_read_b64_tr_b16 a[200:201], v81 offset:16384
ds_read_b64_tr_b16 a[202:203], v81 offset:16896
ds_read_b64_tr_b16 a[204:205], v81 offset:20480
ds_read_b64_tr_b16 a[206:207], v81 offset:20992
ds_read_b64_tr_b16 a[232:233], v81 offset:24576
ds_read_b64_tr_b16 a[234:235], v81 offset:25088
ds_read_b64_tr_b16 a[236:237], v81 offset:28672
ds_read_b64_tr_b16 a[238:239], v81 offset:29184
Llw_598:
v_add_u32 v80, -131072, v80
v_add_u32 v81, -131072, v81
v_add_u32 v82, -131072, v82
v_min_u32 v14, 7, v9
v_lshlrev_b32 v14, 7, v14
s_mov_b32 s39, 3424256
buffer_load_dword v13, v14, s[4:7], s39 offen sc1
s_add_u32 m0, s38, 32768
s_add_u32 s39, s60, 1572864
buffer_load_dwordx4 v84, s[8:11], s39 offen lds
s_add_u32 m0, s38, 33792
s_add_u32 s39, s60, 1638400
buffer_load_dwordx4 v85, s[8:11], s39 offen lds
s_add_u32 m0, s38, 34816
s_add_u32 s39, s60, 1703936
buffer_load_dwordx4 v84, s[8:11], s39 offen lds
s_add_u32 m0, s38, 35840
s_add_u32 s39, s60, 1769472
buffer_load_dwordx4 v85, s[8:11], s39 offen lds
s_add_u32 m0, s38, 36864
s_add_u32 s39, s60, 1835008
buffer_load_dwordx4 v84, s[8:11], s39 offen lds
s_add_u32 m0, s38, 37888
s_add_u32 s39, s60, 1900544
buffer_load_dwordx4 v85, s[8:11], s39 offen lds
s_add_u32 m0, s38, 38912
s_add_u32 s39, s60, 1966080
buffer_load_dwordx4 v84, s[8:11], s39 offen lds
s_add_u32 m0, s38, 39936
s_add_u32 s39, s60, 2031616
buffer_load_dwordx4 v85, s[8:11], s39 offen lds
s_waitcnt lgkmcnt(0)
s_waitcnt vmcnt(8)
s_barrier
s_bitcmp1_b32 s32, 1
s_cbranch_scc1 Llw_599
ds_read_b64_tr_b16 a[16:17], v80 offset:0
ds_read_b64_tr_b16 a[18:19], v80 offset:512
ds_read_b64_tr_b16 a[20:21], v80 offset:4096
ds_read_b64_tr_b16 a[22:23], v80 offset:4608
ds_read_b64_tr_b16 a[48:49], v80 offset:8192
ds_read_b64_tr_b16 a[50:51], v80 offset:8704
ds_read_b64_tr_b16 a[52:53], v80 offset:12288
ds_read_b64_tr_b16 a[54:55], v80 offset:12800
ds_read_b64_tr_b16 a[80:81], v80 offset:16384
ds_read_b64_tr_b16 a[82:83], v80 offset:16896
ds_read_b64_tr_b16 a[84:85], v80 offset:20480
ds_read_b64_tr_b16 a[86:87], v80 offset:20992
ds_read_b64_tr_b16 a[112:113], v80 offset:24576
ds_read_b64_tr_b16 a[114:115], v80 offset:25088
ds_read_b64_tr_b16 a[116:117], v80 offset:28672
ds_read_b64_tr_b16 a[118:119], v80 offset:29184
ds_read_b64_tr_b16 a[144:145], v81 offset:0
ds_read_b64_tr_b16 a[146:147], v81 offset:512
ds_read_b64_tr_b16 a[148:149], v81 offset:4096
ds_read_b64_tr_b16 a[150:151], v81 offset:4608
ds_read_b64_tr_b16 a[176:177], v81 offset:8192
ds_read_b64_tr_b16 a[178:179], v81 offset:8704
ds_read_b64_tr_b16 a[180:181], v81 offset:12288
ds_read_b64_tr_b16 a[182:183], v81 offset:12800
ds_read_b64_tr_b16 a[208:209], v81 offset:16384
ds_read_b64_tr_b16 a[210:211], v81 offset:16896
ds_read_b64_tr_b16 a[212:213], v81 offset:20480
ds_read_b64_tr_b16 a[214:215], v81 offset:20992
ds_read_b64_tr_b16 a[240:241], v81 offset:24576
ds_read_b64_tr_b16 a[242:243], v81 offset:25088
ds_read_b64_tr_b16 a[244:245], v81 offset:28672
ds_read_b64_tr_b16 a[246:247], v81 offset:29184
Llw_599:
v_add_u32 v80, 32768, v80
v_add_u32 v81, 32768, v81
v_add_u32 v82, 32768, v82
v_cmp_ne_u32 vcc, 0x80, v12
s_mov_b64 s[92:93], vcc
v_cmp_gt_u32 vcc, 2, v13
s_or_b64 vcc, vcc, s[92:93]
s_cselect_b32 s46, 0, 1
s_cbranch_scc1 Lqa_600
s_add_u32 m0, s50, 0
s_add_u32 s39, s54, 0
buffer_load_dwordx4 v0, s[4:7], s39 offen offset:0 sc1 lds
buffer_load_dwordx4 v0, s[4:7], s39 offen offset:2048 sc1 lds
s_add_u32 m0, s50, 16384
s_add_u32 s39, s54, 16384
buffer_load_dwordx4 v0, s[4:7], s39 offen offset:0 sc1 lds
buffer_load_dwordx4 v0, s[4:7], s39 offen offset:2048 sc1 lds
s_add_u32 m0, s50, 32768
s_add_u32 s39, s54, 32768
buffer_load_dwordx4 v0, s[4:7], s39 offen offset:0 sc1 lds
buffer_load_dwordx4 v0, s[4:7], s39 offen offset:2048 sc1 lds
s_add_u32 m0, s50, 49152
s_add_u32 s39, s54, 49152
buffer_load_dwordx4 v0, s[4:7], s39 offen offset:0 sc1 lds
buffer_load_dwordx4 v0, s[4:7], s39 offen offset:2048 sc1 lds
s_add_u32 m0, s50, 0
s_add_u32 s39, s54, 0
buffer_load_dwordx4 v0, s[4:7], s39 offen offset:1024 sc1 lds
buffer_load_dwordx4 v0, s[4:7], s39 offen offset:3072 sc1 lds
s_add_u32 m0, s50, 16384
s_add_u32 s39, s54, 16384
buffer_load_dwordx4 v0, s[4:7], s39 offen offset:1024 sc1 lds
buffer_load_dwordx4 v0, s[4:7], s39 offen offset:3072 sc1 lds
s_add_u32 m0, s50, 32768
s_add_u32 s39, s54, 32768
buffer_load_dwordx4 v0, s[4:7], s39 offen offset:1024 sc1 lds
buffer_load_dwordx4 v0, s[4:7], s39 offen offset:3072 sc1 lds
s_add_u32 m0, s50, 49152
s_add_u32 s39, s54, 49152
buffer_load_dwordx4 v0, s[4:7], s39 offen offset:1024 sc1 lds
buffer_load_dwordx4 v0, s[4:7], s39 offen offset:3072 sc1 lds
Lqa_600:
s_waitcnt lgkmcnt(0)
s_cmp_lg_u32 s46, 0
s_cbranch_scc1 Lqa_602
s_waitcnt vmcnt(0)
Lqa_602:
s_waitcnt vmcnt(16)
s_barrier
s_bitcmp1_b32 s32, 1
s_cbranch_scc1 Llw_604
ds_read_b64_tr_b16 a[24:25], v80 offset:0
ds_read_b64_tr_b16 a[26:27], v80 offset:512
ds_read_b64_tr_b16 a[28:29], v80 offset:4096
ds_read_b64_tr_b16 a[30:31], v80 offset:4608
ds_read_b64_tr_b16 a[56:57], v80 offset:8192
ds_read_b64_tr_b16 a[58:59], v80 offset:8704
ds_read_b64_tr_b16 a[60:61], v80 offset:12288
ds_read_b64_tr_b16 a[62:63], v80 offset:12800
ds_read_b64_tr_b16 a[88:89], v80 offset:16384
ds_read_b64_tr_b16 a[90:91], v80 offset:16896
ds_read_b64_tr_b16 a[92:93], v80 offset:20480
ds_read_b64_tr_b16 a[94:95], v80 offset:20992
ds_read_b64_tr_b16 a[120:121], v80 offset:24576
ds_read_b64_tr_b16 a[122:123], v80 offset:25088
ds_read_b64_tr_b16 a[124:125], v80 offset:28672
ds_read_b64_tr_b16 a[126:127], v80 offset:29184
ds_read_b64_tr_b16 a[152:153], v81 offset:0
ds_read_b64_tr_b16 a[154:155], v81 offset:512
ds_read_b64_tr_b16 a[156:157], v81 offset:4096
ds_read_b64_tr_b16 a[158:159], v81 offset:4608
ds_read_b64_tr_b16 a[184:185], v81 offset:8192
ds_read_b64_tr_b16 a[186:187], v81 offset:8704
ds_read_b64_tr_b16 a[188:189], v81 offset:12288
ds_read_b64_tr_b16 a[190:191], v81 offset:12800
ds_read_b64_tr_b16 a[216:217], v81 offset:16384
ds_read_b64_tr_b16 a[218:219], v81 offset:16896
ds_read_b64_tr_b16 a[220:221], v81 offset:20480
ds_read_b64_tr_b16 a[222:223], v81 offset:20992
ds_read_b64_tr_b16 a[248:249], v81 offset:24576
ds_read_b64_tr_b16 a[250:251], v81 offset:25088
ds_read_b64_tr_b16 a[252:253], v81 offset:28672
ds_read_b64_tr_b16 a[254:255], v81 offset:29184
Llw_604:
v_add_u32 v80, 32768, v80
v_add_u32 v81, 32768, v81
v_add_u32 v82, 32768, v82
s_waitcnt lgkmcnt(0)
s_barrier
s_and_b32 s52, s44, 1
s_lshr_b32 s38, s32, 1
s_lshl_b32 s38, s38, 3
s_and_b32 s39, s32, 1
s_add_u32 s38, s38, s39
s_lshl_b32 s39, s52, 1
s_add_u32 s38, s38, s39
s_lshl_b32 s38, s38, 10
s_lshr_b32 s53, s44, 1
s_and_b32 s39, s32, 2
s_xor_b32 s39, s39, s53
s_mul_i32 s39, s39, 24576
s_add_u32 s38, s38, s39
v_add_u32 v6, s38, v1
v_add_u32 v7, 4096, v6
s_lshl_b32 s38, s52, 2
s_add_u32 s38, s38, s32
s_add_u32 s38, s38, 16
s_lshl_b32 s38, s38, 10
s_xor_b32 s39, s53, 1
s_mul_i32 s39, s39, 24576
s_add_u32 s38, s38, s39
v_add_u32 v8, s38, v1
s_mov_b32 s49, 32768000
v_xor_b32 v1, 0x10000, v1
s_mov_b32 s36, 0
s_cmp_lg_u32 s46, 0
s_cbranch_scc1 Lqm_606
Lst_608:
buffer_load_dword v48, off, s[12:15], 0 offset:144 sc1
buffer_load_dword v49, off, s[12:15], 0 offset:144 sc1
s_waitcnt vmcnt(0)
v_add_u32 v48, v48, v49
s_nop 0
v_readfirstlane_b32 s38, v48
s_nop 3
s_and_b32 s39, s38, 0xffff
s_cmp_eq_u32 s39, 0x100
s_cbranch_scc1 Lso_609
s_sub_u32 s37, s37, 1
s_cbranch_scc1 Lend_7
s_sleep 8
s_branch Lst_608
Lso_609:
s_bfe_u32 s35, s38, 0x80010
s_bfe_u32 s46, s38, 0x10018
s_lshl_b32 s46, s46, 13
v_min_u32 v80, 7, v9
v_lshlrev_b32 v80, 7, v80
s_mov_b32 s38, 3424256
Lbw_610:
buffer_load_dword v81, v80, s[4:7], s38 offen sc1
s_waitcnt vmcnt(0)
v_cmp_gt_u32 vcc, 2, v81
s_cbranch_vccz Lbo_611
s_sub_u32 s37, s37, 1
s_cbranch_scc1 Lend_7
s_sleep 2
s_branch Lbw_610
Lbo_611:
s_add_u32 m0, s50, 0
s_add_u32 s39, s54, 0
buffer_load_dwordx4 v0, s[4:7], s39 offen offset:0 sc1 lds
buffer_load_dwordx4 v0, s[4:7], s39 offen offset:2048 sc1 lds
s_add_u32 m0, s50, 16384
s_add_u32 s39, s54, 16384
buffer_load_dwordx4 v0, s[4:7], s39 offen offset:0 sc1 lds
buffer_load_dwordx4 v0, s[4:7], s39 offen offset:2048 sc1 lds
s_add_u32 m0, s50, 32768
s_add_u32 s39, s54, 32768
buffer_load_dwordx4 v0, s[4:7], s39 offen offset:0 sc1 lds
buffer_load_dwordx4 v0, s[4:7], s39 offen offset:2048 sc1 lds
s_add_u32 m0, s50, 49152
s_add_u32 s39, s54, 49152
buffer_load_dwordx4 v0, s[4:7], s39 offen offset:0 sc1 lds
buffer_load_dwordx4 v0, s[4:7], s39 offen offset:2048 sc1 lds
s_add_u32 m0, s50, 0
s_add_u32 s39, s54, 0
buffer_load_dwordx4 v0, s[4:7], s39 offen offset:1024 sc1 lds
buffer_load_dwordx4 v0, s[4:7], s39 offen offset:3072 sc1 lds
s_add_u32 m0, s50, 16384
s_add_u32 s39, s54, 16384
buffer_load_dwordx4 v0, s[4:7], s39 offen offset:1024 sc1 lds
buffer_load_dwordx4 v0, s[4:7], s39 offen offset:3072 sc1 lds
s_add_u32 m0, s50, 32768
s_add_u32 s39, s54, 32768
buffer_load_dwordx4 v0, s[4:7], s39 offen offset:1024 sc1 lds
buffer_load_dwordx4 v0, s[4:7], s39 offen offset:3072 sc1 lds
s_add_u32 m0, s50, 49152
s_add_u32 s39, s54, 49152
buffer_load_dwordx4 v0, s[4:7], s39 offen offset:1024 sc1 lds
buffer_load_dwordx4 v0, s[4:7], s39 offen offset:3072 sc1 lds
Lqm_606:
s_waitcnt vmcnt(8)
s_barrier
ds_read_b128 v[16:19], v1 offset:0
ds_read_b128 v[20:23], v1 offset:2048
ds_read_b128 v[24:27], v1 offset:4096
ds_read_b128 v[28:31], v1 offset:6144
ds_read_b128 v[32:35], v1 offset:8192
ds_read_b128 v[36:39], v1 offset:10240
ds_read_b128 v[40:43], v1 offset:12288
s_mov_b32 s55, 0x70000000
s_mov_b32 s48, 3
Lql_605:
s_waitcnt lgkmcnt(5)
v_mfma_f32_16x16x32_bf16 v[48:51], a[0:3], v[16:19], 0
s_add_u32 s54, s54, 65536
ds_read_b128 v[44:47], v1 offset:14336
s_xor_b32 s50, s50, 0x10000
v_mfma_f32_16x16x32_bf16 v[52:55], a[128:131], v[16:19], 0
s_cmp_lt_u32 s36, 63
s_cselect_b32 s45, s54, 0x70000000
v_mfma_f32_16x16x32_bf16 v[64:67], v[16:19], v[128:131], 0
v_mfma_f32_16x16x32_bf16 v[48:51], a[4:7], v[20:23], v[48:51]
ds_read_b128 v[16:19], v1 offset:16384
v_mfma_f32_16x16x32_bf16 v[52:55], a[132:135], v[20:23], v[52:55]
v_mfma_f32_16x16x32_bf16 v[64:67], v[20:23], v[132:135], v[64:67]
s_waitcnt lgkmcnt(5)
v_mfma_f32_16x16x32_bf16 v[48:51], a[8:11], v[24:27], v[48:51]
ds_read_b128 v[20:23], v1 offset:18432
v_mfma_f32_16x16x32_bf16 v[52:55], a[136:139], v[24:27], v[52:55]
v_mfma_f32_16x16x32_bf16 v[64:67], v[24:27], v[136:139], v[64:67]
v_cvt_pk_bf16_f32 v84, v56, v57
v_cvt_pk_bf16_f32 v85, v58, v59
v_mfma_f32_16x16x32_bf16 v[48:51], a[12:15], v[28:31], v[48:51]
ds_read_b128 v[24:27], v1 offset:20480
v_cvt_pk_bf16_f32 v86, v60, v61
v_mfma_f32_16x16x32_bf16 v[52:55], a[140:143], v[28:31], v[52:55]
v_cvt_pk_bf16_f32 v87, v62, v63
v_cvt_pk_bf16_f32 v90, v68, v69
v_mfma_f32_16x16x32_bf16 v[64:67], v[28:31], v[140:143], v[64:67]
s_waitcnt lgkmcnt(5)
v_cvt_pk_bf16_f32 v91, v70, v71
v_mfma_f32_16x16x32_bf16 v[48:51], a[16:19], v[32:35], v[48:51]
ds_read_b128 v[28:31], v1 offset:22528
v_mfma_f32_16x16x32_bf16 v[52:55], a[144:147], v[32:35], v[52:55]
buffer_store_dwordx4 v[80:83], v6, s[4:7], s55 offen sc1
v_mfma_f32_16x16x32_bf16 v[64:67], v[32:35], v[144:147], v[64:67]
v_mfma_f32_16x16x32_bf16 v[48:51], a[20:23], v[36:39], v[48:51]
ds_read_b128 v[32:35], v1 offset:24576
v_mfma_f32_16x16x32_bf16 v[52:55], a[148:151], v[36:39], v[52:55]
v_mfma_f32_16x16x32_bf16 v[64:67], v[36:39], v[148:151], v[64:67]
s_waitcnt lgkmcnt(5)
buffer_store_dwordx4 v[84:87], v7, s[4:7], s55 offen sc1
v_mfma_f32_16x16x32_bf16 v[48:51], a[24:27], v[40:43], v[48:51]
ds_read_b128 v[36:39], v1 offset:26624
v_mfma_f32_16x16x32_bf16 v[52:55], a[152:155], v[40:43], v[52:55]
v_mfma_f32_16x16x32_bf16 v[64:67], v[40:43], v[152:155], v[64:67]
v_mfma_f32_16x16x32_bf16 v[48:51], a[28:31], v[44:47], v[48:51]
ds_read_b128 v[40:43], v1 offset:28672
v_mfma_f32_16x16x32_bf16 v[52:55], a[156:159], v[44:47], v[52:55]
buffer_store_dwordx4 v[88:91], v8, s[4:7], s55 offen sc1
v_mfma_f32_16x16x32_bf16 v[64:67], v[44:47], v[156:159], v[64:67]
s_waitcnt lgkmcnt(5)
v_mfma_f32_16x16x32_bf16 v[48:51], a[32:35], v[16:19], v[48:51]
ds_read_b128 v[44:47], v1 offset:30720
v_mfma_f32_16x16x32_bf16 v[52:55], a[160:163], v[16:19], v[52:55]
v_mfma_f32_16x16x32_bf16 v[64:67], v[16:19], v[160:163], v[64:67]
v_mov_b32 v5, s36
s_add_u32 m0, s50, 0
v_mfma_f32_16x16x32_bf16 v[48:51], a[36:39], v[20:23], v[48:51]
s_add_u32 s39, s45, 0
ds_read_b128 v[16:19], v1 offset:32768
buffer_load_dwordx4 v0, s[4:7], s39 offen offset:0 sc1 lds
v_mfma_f32_16x16x32_bf16 v[52:55], a[164:167], v[20:23], v[52:55]
v_mfma_f32_16x16x32_bf16 v[64:67], v[20:23], v[164:167], v[64:67]
s_waitcnt lgkmcnt(5)
v_mfma_f32_16x16x32_bf16 v[48:51], a[40:43], v[24:27], v[48:51]
ds_read_b128 v[20:23], v1 offset:34816
v_mfma_f32_16x16x32_bf16 v[52:55], a[168:171], v[24:27], v[52:55]
v_mfma_f32_16x16x32_bf16 v[64:67], v[24:27], v[168:171], v[64:67]
v_mfma_f32_16x16x32_bf16 v[48:51], a[44:47], v[28:31], v[48:51]
ds_read_b128 v[24:27], v1 offset:36864
v_mfma_f32_16x16x32_bf16 v[52:55], a[172:175], v[28:31], v[52:55]
v_mfma_f32_16x16x32_bf16 v[64:67], v[28:31], v[172:175], v[64:67]
s_waitcnt lgkmcnt(5)
v_mfma_f32_16x16x32_bf16 v[48:51], a[48:51], v[32:35], v[48:51]
ds_read_b128 v[28:31], v1 offset:38912
v_mfma_f32_16x16x32_bf16 v[52:55], a[176:179], v[32:35], v[52:55]
buffer_load_dwordx4 v0, s[4:7], s39 offen offset:2048 sc1 lds
s_add_u32 m0, s50, 16384
v_mfma_f32_16x16x32_bf16 v[64:67], v[32:35], v[176:179], v[64:67]
s_add_u32 s39, s45, 16384
v_mfma_f32_16x16x32_bf16 v[48:51], a[52:55], v[36:39], v[48:51]
ds_read_b128 v[32:35], v1 offset:40960
v_mfma_f32_16x16x32_bf16 v[52:55], a[180:183], v[36:39], v[52:55]
v_mfma_f32_16x16x32_bf16 v[64:67], v[36:39], v[180:183], v[64:67]
s_waitcnt lgkmcnt(5)
v_mfma_f32_16x16x32_bf16 v[48:51], a[56:59], v[40:43], v[48:51]
ds_read_b128 v[36:39], v1 offset:43008
v_mfma_f32_16x16x32_bf16 v[52:55], a[184:187], v[40:43], v[52:55]
v_mfma_f32_16x16x32_bf16 v[64:67], v[40:43], v[184:187], v[64:67]
v_mfma_f32_16x16x32_bf16 v[48:51], a[60:63], v[44:47], v[48:51]
ds_read_b128 v[40:43], v1 offset:45056
v_mfma_f32_16x16x32_bf16 v[52:55], a[188:191], v[44:47], v[52:55]
v_mfma_f32_16x16x32_bf16 v[64:67], v[44:47], v[188:191], v[64:67]
s_waitcnt lgkmcnt(5)
buffer_load_dwordx4 v0, s[4:7], s39 offen offset:0 sc1 lds
v_mfma_f32_16x16x32_bf16 v[48:51], a[64:67], v[16:19], v[48:51]
ds_read_b128 v[44:47], v1 offset:47104
v_mfma_f32_16x16x32_bf16 v[52:55], a[192:195], v[16:19], v[52:55]
v_mfma_f32_16x16x32_bf16 v[64:67], v[16:19], v[192:195], v[64:67]
v_mfma_f32_16x16x32_bf16 v[48:51], a[68:71], v[20:23], v[48:51]
ds_read_b128 v[16:19], v1 offset:49152
v_mfma_f32_16x16x32_bf16 v[52:55], a[196:199], v[20:23], v[52:55]
v_mfma_f32_16x16x32_bf16 v[64:67], v[20:23], v[196:199], v[64:67]
s_waitcnt lgkmcnt(5)
v_mfma_f32_16x16x32_bf16 v[48:51], a[72:75], v[24:27], v[48:51]
ds_read_b128 v[20:23], v1 offset:51200
v_mfma_f32_16x16x32_bf16 v[52:55], a[200:203], v[24:27], v[52:55]
v_mfma_f32_16x16x32_bf16 v[64:67], v[24:27], v[200:203], v[64:67]
v_mfma_f32_16x16x32_bf16 v[48:51], a[76:79], v[28:31], v[48:51]
ds_read_b128 v[24:27], v1 offset:53248
buffer_load_dwordx4 v0, s[4:7], s39 offen offset:2048 sc1 lds
v_mfma_f32_16x16x32_bf16 v[52:55], a[204:207], v[28:31], v[52:55]
s_add_u32 m0, s50, 32768
s_add_u32 s39, s45, 32768
v_mfma_f32_16x16x32_bf16 v[64:67], v[28:31], v[204:207], v[64:67]
s_waitcnt lgkmcnt(5)
v_mfma_f32_16x16x32_bf16 v[48:51], a[80:83], v[32:35], v[48:51]
ds_read_b128 v[28:31], v1 offset:55296
v_mfma_f32_16x16x32_bf16 v[52:55], a[208:211], v[32:35], v[52:55]
v_mfma_f32_16x16x32_bf16 v[64:67], v[32:35], v[208:211], v[64:67]
v_mfma_f32_16x16x32_bf16 v[48:51], a[84:87], v[36:39], v[48:51]
ds_read_b128 v[32:35], v1 offset:57344
v_mfma_f32_16x16x32_bf16 v[52:55], a[212:215], v[36:39], v[52:55]
v_mfma_f32_16x16x32_bf16 v[64:67], v[36:39], v[212:215], v[64:67]
s_waitcnt lgkmcnt(5)
v_mfma_f32_16x16x32_bf16 v[48:51], a[88:91], v[40:43], v[48:51]
ds_read_b128 v[36:39], v1 offset:59392
v_mfma_f32_16x16x32_bf16 v[52:55], a[216:219], v[40:43], v[52:55]
buffer_load_dwordx4 v0, s[4:7], s39 offen offset:0 sc1 lds
v_mfma_f32_16x16x32_bf16 v[64:67], v[40:43], v[216:219], v[64:67]
v_mfma_f32_16x16x32_bf16 v[48:51], a[92:95], v[44:47], v[48:51]
ds_read_b128 v[40:43], v1 offset:61440
v_mfma_f32_16x16x32_bf16 v[52:55], a[220:223], v[44:47], v[52:55]
v_mfma_f32_16x16x32_bf16 v[64:67], v[44:47], v[220:223], v[64:67]
s_waitcnt lgkmcnt(5)
v_mfma_f32_16x16x32_bf16 v[48:51], a[96:99], v[16:19], v[48:51]
ds_read_b128 v[44:47], v1 offset:63488
v_mfma_f32_16x16x32_bf16 v[52:55], a[224:227], v[16:19], v[52:55]
v_mfma_f32_16x16x32_bf16 v[64:67], v[16:19], v[224:227], v[64:67]
v_mfma_f32_16x16x32_bf16 v[48:51], a[100:103], v[20:23], v[48:51]
s_waitcnt vmcnt(5)
s_barrier
ds_read_b128 v[16:19], v1 offset:1024
v_mfma_f32_16x16x32_bf16 v[52:55], a[228:231], v[20:23], v[52:55]
buffer_store_dword v5, v4, s[4:7], 0 offen sc1
v_mfma_f32_16x16x32_bf16 v[64:67], v[20:23], v[228:231], v[64:67]
s_waitcnt lgkmcnt(5)
v_mfma_f32_16x16x32_bf16 v[48:51], a[104:107], v[24:27], v[48:51]
ds_read_b128 v[20:23], v1 offset:3072
v_mfma_f32_16x16x32_bf16 v[52:55], a[232:235], v[24:27], v[52:55]
v_mfma_f32_16x16x32_bf16 v[64:67], v[24:27], v[232:235], v[64:67]
v_mfma_f32_16x16x32_bf16 v[48:51], a[108:111], v[28:31], v[48:51]
ds_read_b128 v[24:27], v1 offset:5120
buffer_load_dwordx4 v0, s[4:7], s39 offen offset:2048 sc1 lds
v_mfma_f32_16x16x32_bf16 v[52:55], a[236:239], v[28:31], v[52:55]
s_add_u32 m0, s50, 49152
s_add_u32 s39, s45, 49152
v_mfma_f32_16x16x32_bf16 v[64:67], v[28:31], v[236:239], v[64:67]
s_waitcnt lgkmcnt(5)
v_mfma_f32_16x16x32_bf16 v[48:51], a[112:115], v[32:35], v[48:51]
ds_read_b128 v[28:31], v1 offset:7168
v_mfma_f32_16x16x32_bf16 v[52:55], a[240:243], v[32:35], v[52:55]
v_mfma_f32_16x16x32_bf16 v[64:67], v[32:35], v[240:243], v[64:67]
v_mfma_f32_16x16x32_bf16 v[48:51], a[116:119], v[36:39], v[48:51]
ds_read_b128 v[32:35], v1 offset:9216
v_mfma_f32_16x16x32_bf16 v[52:55], a[244:247], v[36:39], v[52:55]
v_mfma_f32_16x16x32_bf16 v[64:67], v[36:39], v[244:247], v[64:67]
s_waitcnt lgkmcnt(5)
v_mfma_f32_16x16x32_bf16 v[48:51], a[120:123], v[40:43], v[48:51]
ds_read_b128 v[36:39], v1 offset:11264
v_mfma_f32_16x16x32_bf16 v[52:55], a[248:251], v[40:43], v[52:55]
buffer_load_dwordx4 v0, s[4:7], s39 offen offset:0 sc1 lds
v_mfma_f32_16x16x32_bf16 v[64:67], v[40:43], v[248:251], v[64:67]
v_mfma_f32_16x16x32_bf16 v[48:51], a[124:127], v[44:47], v[48:51]
ds_read_b128 v[40:43], v1 offset:13312
v_mfma_f32_16x16x32_bf16 v[52:55], a[252:255], v[44:47], v[52:55]
v_mfma_f32_16x16x32_bf16 v[64:67], v[44:47], v[252:255], v[64:67]
s_waitcnt lgkmcnt(5)
v_mfma_f32_16x16x32_bf16 v[56:59], a[0:3], v[16:19], 0
ds_read_b128 v[44:47], v1 offset:15360
v_mfma_f32_16x16x32_bf16 v[60:63], a[128:131], v[16:19], 0
v_mfma_f32_16x16x32_bf16 v[68:71], v[16:19], v[128:131], 0
v_mfma_f32_16x16x32_bf16 v[56:59], a[4:7], v[20:23], v[56:59]
ds_read_b128 v[16:19], v1 offset:17408
v_mfma_f32_16x16x32_bf16 v[60:63], a[132:135], v[20:23], v[60:63]
v_mfma_f32_16x16x32_bf16 v[68:71], v[20:23], v[132:135], v[68:71]
s_waitcnt lgkmcnt(5)
buffer_load_dwordx4 v0, s[4:7], s39 offen offset:2048 sc1 lds
s_add_u32 m0, s50, 0
v_mfma_f32_16x16x32_bf16 v[56:59], a[8:11], v[24:27], v[56:59]
s_add_u32 s39, s45, 0
ds_read_b128 v[20:23], v1 offset:19456
v_mfma_f32_16x16x32_bf16 v[60:63], a[136:139], v[24:27], v[60:63]
v_mfma_f32_16x16x32_bf16 v[68:71], v[24:27], v[136:139], v[68:71]
v_mfma_f32_16x16x32_bf16 v[56:59], a[12:15], v[28:31], v[56:59]
ds_read_b128 v[24:27], v1 offset:21504
v_cvt_pk_bf16_f32 v80, v48, v49
v_mfma_f32_16x16x32_bf16 v[60:63], a[140:143], v[28:31], v[60:63]
v_cvt_pk_bf16_f32 v81, v50, v51
v_cvt_pk_bf16_f32 v82, v52, v53
v_mfma_f32_16x16x32_bf16 v[68:71], v[28:31], v[140:143], v[68:71]
s_waitcnt lgkmcnt(5)
v_cvt_pk_bf16_f32 v83, v54, v55
v_cvt_pk_bf16_f32 v88, v64, v65
v_mfma_f32_16x16x32_bf16 v[56:59], a[16:19], v[32:35], v[56:59]
ds_read_b128 v[28:31], v1 offset:23552
v_cvt_pk_bf16_f32 v89, v66, v67
v_mfma_f32_16x16x32_bf16 v[60:63], a[144:147], v[32:35], v[60:63]
s_add_u32 s49, s49, 786432
s_mov_b32 s55, s49
s_add_u32 s36, s36, 1
v_mfma_f32_16x16x32_bf16 v[68:71], v[32:35], v[144:147], v[68:71]
v_mfma_f32_16x16x32_bf16 v[56:59], a[20:23], v[36:39], v[56:59]
ds_read_b128 v[32:35], v1 offset:25600
buffer_load_dwordx4 v0, s[4:7], s39 offen offset:1024 sc1 lds
v_mfma_f32_16x16x32_bf16 v[60:63], a[148:151], v[36:39], v[60:63]
v_mfma_f32_16x16x32_bf16 v[68:71], v[36:39], v[148:151], v[68:71]
s_waitcnt lgkmcnt(5)
v_mfma_f32_16x16x32_bf16 v[56:59], a[24:27], v[40:43], v[56:59]
ds_read_b128 v[36:39], v1 offset:27648
v_mfma_f32_16x16x32_bf16 v[60:63], a[152:155], v[40:43], v[60:63]
v_mfma_f32_16x16x32_bf16 v[68:71], v[40:43], v[152:155], v[68:71]
v_mfma_f32_16x16x32_bf16 v[56:59], a[28:31], v[44:47], v[56:59]
ds_read_b128 v[40:43], v1 offset:29696
v_mfma_f32_16x16x32_bf16 v[60:63], a[156:159], v[44:47], v[60:63]
v_mfma_f32_16x16x32_bf16 v[68:71], v[44:47], v[156:159], v[68:71]
s_waitcnt lgkmcnt(5)
v_mfma_f32_16x16x32_bf16 v[56:59], a[32:35], v[16:19], v[56:59]
ds_read_b128 v[44:47], v1 offset:31744
v_mfma_f32_16x16x32_bf16 v[60:63], a[160:163], v[16:19], v[60:63]
buffer_load_dwordx4 v0, s[4:7], s39 offen offset:3072 sc1 lds
s_add_u32 m0, s50, 16384
v_mfma_f32_16x16x32_bf16 v[68:71], v[16:19], v[160:163], v[68:71]
s_add_u32 s39, s45, 16384
v_mfma_f32_16x16x32_bf16 v[56:59], a[36:39], v[20:23], v[56:59]
ds_read_b128 v[16:19], v1 offset:33792
v_mfma_f32_16x16x32_bf16 v[60:63], a[164:167], v[20:23], v[60:63]
v_mfma_f32_16x16x32_bf16 v[68:71], v[20:23], v[164:167], v[68:71]
s_waitcnt lgkmcnt(5)
v_mfma_f32_16x16x32_bf16 v[56:59], a[40:43], v[24:27], v[56:59]
ds_read_b128 v[20:23], v1 offset:35840
v_mfma_f32_16x16x32_bf16 v[60:63], a[168:171], v[24:27], v[60:63]
v_mfma_f32_16x16x32_bf16 v[68:71], v[24:27], v[168:171], v[68:71]
v_mfma_f32_16x16x32_bf16 v[56:59], a[44:47], v[28:31], v[56:59]
ds_read_b128 v[24:27], v1 offset:37888
v_mfma_f32_16x16x32_bf16 v[60:63], a[172:175], v[28:31], v[60:63]
v_mfma_f32_16x16x32_bf16 v[68:71], v[28:31], v[172:175], v[68:71]
s_waitcnt lgkmcnt(5)
buffer_load_dwordx4 v0, s[4:7], s39 offen offset:1024 sc1 lds
v_mfma_f32_16x16x32_bf16 v[56:59], a[48:51], v[32:35], v[56:59]
ds_read_b128 v[28:31], v1 offset:39936
v_mfma_f32_16x16x32_bf16 v[60:63], a[176:179], v[32:35], v[60:63]
v_mfma_f32_16x16x32_bf16 v[68:71], v[32:35], v[176:179], v[68:71]
v_mfma_f32_16x16x32_bf16 v[56:59], a[52:55], v[36:39], v[56:59]
ds_read_b128 v[32:35], v1 offset:41984
v_mfma_f32_16x16x32_bf16 v[60:63], a[180:183], v[36:39], v[60:63]
v_mfma_f32_16x16x32_bf16 v[68:71], v[36:39], v[180:183], v[68:71]
s_waitcnt lgkmcnt(5)
v_mfma_f32_16x16x32_bf16 v[56:59], a[56:59], v[40:43], v[56:59]
ds_read_b128 v[36:39], v1 offset:44032
v_mfma_f32_16x16x32_bf16 v[60:63], a[184:187], v[40:43], v[60:63]
v_mfma_f32_16x16x32_bf16 v[68:71], v[40:43], v[184:187], v[68:71]
v_mfma_f32_16x16x32_bf16 v[56:59], a[60:63], v[44:47], v[56:59]
ds_read_b128 v[40:43], v1 offset:46080
buffer_load_dwordx4 v0, s[4:7], s39 offen offset:3072 sc1 lds
v_mfma_f32_16x16x32_bf16 v[60:63], a[188:191], v[44:47], v[60:63]
s_add_u32 m0, s50, 32768
s_add_u32 s39, s45, 32768
v_mfma_f32_16x16x32_bf16 v[68:71], v[44:47], v[188:191], v[68:71]
s_waitcnt lgkmcnt(5)
v_mfma_f32_16x16x32_bf16 v[56:59], a[64:67], v[16:19], v[56:59]
ds_read_b128 v[44:47], v1 offset:48128
v_mfma_f32_16x16x32_bf16 v[60:63], a[192:195], v[16:19], v[60:63]
v_mfma_f32_16x16x32_bf16 v[68:71], v[16:19], v[192:195], v[68:71]
v_mfma_f32_16x16x32_bf16 v[56:59], a[68:71], v[20:23], v[56:59]
ds_read_b128 v[16:19], v1 offset:50176
v_mfma_f32_16x16x32_bf16 v[60:63], a[196:199], v[20:23], v[60:63]
v_mfma_f32_16x16x32_bf16 v[68:71], v[20:23], v[196:199], v[68:71]
s_waitcnt lgkmcnt(5)
v_mfma_f32_16x16x32_bf16 v[56:59], a[72:75], v[24:27], v[56:59]
ds_read_b128 v[20:23], v1 offset:52224
v_mfma_f32_16x16x32_bf16 v[60:63], a[200:203], v[24:27], v[60:63]
buffer_load_dwordx4 v0, s[4:7], s39 offen offset:1024 sc1 lds
v_mfma_f32_16x16x32_bf16 v[68:71], v[24:27], v[200:203], v[68:71]
v_mfma_f32_16x16x32_bf16 v[56:59], a[76:79], v[28:31], v[56:59]
ds_read_b128 v[24:27], v1 offset:54272
v_mfma_f32_16x16x32_bf16 v[60:63], a[204:207], v[28:31], v[60:63]
v_mfma_f32_16x16x32_bf16 v[68:71], v[28:31], v[204:207], v[68:71]
s_waitcnt lgkmcnt(5)
v_mfma_f32_16x16x32_bf16 v[56:59], a[80:83], v[32:35], v[56:59]
ds_read_b128 v[28:31], v1 offset:56320
v_mfma_f32_16x16x32_bf16 v[60:63], a[208:211], v[32:35], v[60:63]
v_mfma_f32_16x16x32_bf16 v[68:71], v[32:35], v[208:211], v[68:71]
v_mfma_f32_16x16x32_bf16 v[56:59], a[84:87], v[36:39], v[56:59]
ds_read_b128 v[32:35], v1 offset:58368
v_mfma_f32_16x16x32_bf16 v[60:63], a[212:215], v[36:39], v[60:63]
v_mfma_f32_16x16x32_bf16 v[68:71], v[36:39], v[212:215], v[68:71]
s_waitcnt lgkmcnt(5)
buffer_load_dwordx4 v0, s[4:7], s39 offen offset:3072 sc1 lds
s_add_u32 m0, s50, 49152
v_mfma_f32_16x16x32_bf16 v[56:59], a[88:91], v[40:43], v[56:59]
s_add_u32 s39, s45, 49152
ds_read_b128 v[36:39], v1 offset:60416
v_mfma_f32_16x16x32_bf16 v[60:63], a[216:219], v[40:43], v[60:63]
v_mfma_f32_16x16x32_bf16 v[68:71], v[40:43], v[216:219], v[68:71]
v_mfma_f32_16x16x32_bf16 v[56:59], a[92:95], v[44:47], v[56:59]
ds_read_b128 v[40:43], v1 offset:62464
v_mfma_f32_16x16x32_bf16 v[60:63], a[220:223], v[44:47], v[60:63]
v_mfma_f32_16x16x32_bf16 v[68:71], v[44:47], v[220:223], v[68:71]
s_waitcnt lgkmcnt(5)
v_mfma_f32_16x16x32_bf16 v[56:59], a[96:99], v[16:19], v[56:59]
ds_read_b128 v[44:47], v1 offset:64512
v_mfma_f32_16x16x32_bf16 v[60:63], a[224:227], v[16:19], v[60:63]
v_mfma_f32_16x16x32_bf16 v[68:71], v[16:19], v[224:227], v[68:71]
v_mfma_f32_16x16x32_bf16 v[56:59], a[100:103], v[20:23], v[56:59]
buffer_load_dwordx4 v0, s[4:7], s39 offen offset:1024 sc1 lds
v_mfma_f32_16x16x32_bf16 v[60:63], a[228:231], v[20:23], v[60:63]
v_mfma_f32_16x16x32_bf16 v[68:71], v[20:23], v[228:231], v[68:71]
s_waitcnt lgkmcnt(4)
v_mfma_f32_16x16x32_bf16 v[56:59], a[104:107], v[24:27], v[56:59]
v_mfma_f32_16x16x32_bf16 v[60:63], a[232:235], v[24:27], v[60:63]
v_mfma_f32_16x16x32_bf16 v[68:71], v[24:27], v[232:235], v[68:71]
v_xor_b32 v1, 0x10000, v1
s_waitcnt vmcnt(7) lgkmcnt(0)
s_barrier
v_mfma_f32_16x16x32_bf16 v[56:59], a[108:111], v[28:31], v[56:59]
ds_read_b128 v[16:19], v1 offset:0
ds_read_b128 v[20:23], v1 offset:2048
v_mfma_f32_16x16x32_bf16 v[60:63], a[236:239], v[28:31], v[60:63]
ds_read_b128 v[24:27], v1 offset:4096
v_mfma_f32_16x16x32_bf16 v[68:71], v[28:31], v[236:239], v[68:71]
v_mfma_f32_16x16x32_bf16 v[56:59], a[112:115], v[32:35], v[56:59]
ds_read_b128 v[28:31], v1 offset:6144
v_mfma_f32_16x16x32_bf16 v[60:63], a[240:243], v[32:35], v[60:63]
v_mfma_f32_16x16x32_bf16 v[68:71], v[32:35], v[240:243], v[68:71]
v_mfma_f32_16x16x32_bf16 v[56:59], a[116:119], v[36:39], v[56:59]
ds_read_b128 v[32:35], v1 offset:8192
v_mfma_f32_16x16x32_bf16 v[60:63], a[244:247], v[36:39], v[60:63]
buffer_load_dwordx4 v0, s[4:7], s39 offen offset:3072 sc1 lds
v_mfma_f32_16x16x32_bf16 v[68:71], v[36:39], v[244:247], v[68:71]
v_mfma_f32_16x16x32_bf16 v[56:59], a[120:123], v[40:43], v[56:59]
ds_read_b128 v[36:39], v1 offset:10240
v_mfma_f32_16x16x32_bf16 v[60:63], a[248:251], v[40:43], v[60:63]
v_mfma_f32_16x16x32_bf16 v[68:71], v[40:43], v[248:251], v[68:71]
s_cmp_lt_u32 s36, s48
v_mfma_f32_16x16x32_bf16 v[56:59], a[124:127], v[44:47], v[56:59]
ds_read_b128 v[40:43], v1 offset:12288
v_mfma_f32_16x16x32_bf16 v[60:63], a[252:255], v[44:47], v[60:63]
v_mfma_f32_16x16x32_bf16 v[68:71], v[44:47], v[252:255], v[68:71]
s_cbranch_scc1 Lql_605
s_cmp_eq_u32 s36, 64
s_cbranch_scc1 Lqe_607
v_min_u32 v14, 63, v9
v_lshlrev_b32 v14, 7, v14
s_mov_b32 s38, 3424256
Lbw_612:
buffer_load_dword v15, v14, s[4:7], s38 offen sc1
s_waitcnt vmcnt(0)
v_cmp_gt_u32 vcc, 3, v15
s_cbranch_vccz Lbo_613
s_sub_u32 s37, s37, 1
s_cbranch_scc1 Lend_7
s_sleep 2
s_branch Lbw_612
Lbo_613:
s_mov_b32 s48, 64
s_branch Lql_605
Lqe_607:
s_nop 7
v_cvt_pk_bf16_f32 v84, v56, v57
v_cvt_pk_bf16_f32 v85, v58, v59
v_cvt_pk_bf16_f32 v86, v60, v61
v_cvt_pk_bf16_f32 v87, v62, v63
v_cvt_pk_bf16_f32 v90, v68, v69
v_cvt_pk_bf16_f32 v91, v70, v71
buffer_store_dwordx4 v[80:83], v6, s[4:7], s55 offen sc1
buffer_store_dwordx4 v[84:87], v7, s[4:7], s55 offen sc1
buffer_store_dwordx4 v[88:91], v8, s[4:7], s55 offen sc1
v_mov_b32 v5, 64
s_waitcnt vmcnt(0) lgkmcnt(0)
s_barrier
buffer_store_dword v5, v4, s[4:7], 0 offen sc1
s_load_dwordx2 s[16:17], s[0:1], 104
s_and_b32 s52, s44, 3
s_lshr_b32 s53, s44, 2
v_lshrrev_b32 v80, 3, v9
v_and_b32 v81, 7, v9
s_lshr_b32 s38, s52, 1
s_lshl_b32 s38, s38, 10
s_and_b32 s39, s52, 1
s_lshl_b32 s39, s39, 7
s_add_u32 s38, s38, s39
s_lshl_b32 s39, s53, 12
s_add_u32 s38, s38, s39
v_lshl_add_u32 v6, v81, 4, s38
v_and_b32 v82, 3, v80
v_lshl_add_u32 v6, v82, 8, v6
v_lshrrev_b32 v82, 2, v80
v_lshl_add_u32 v6, v82, 11, v6
s_lshl_b32 s38, s52, 14
s_lshl_b32 s39, s53, 7
s_add_u32 s38, s38, s39
v_lshl_add_u32 v7, v81, 11, s38
v_lshl_add_u32 v7, v80, 4, v7
s_lshl_b32 s38, s53, 8
v_lshl_add_u32 v8, v80, 5, s38
v_min_u32 v2, 6, v9
v_lshlrev_b32 v2, 10, v2
s_lshr_b32 s47, s44, 3
s_lshl_b32 s47, s47, 7
s_add_u32 s47, s47, 3416068
s_mov_b32 s60, 0x00003f80
s_mov_b32 s61, 0x3f800000
s_waitcnt lgkmcnt(0)
s_mov_b32 s8, s16
s_and_b32 s9, s17, 0xffff
s_mov_b32 s10, 0x400000
s_mov_b32 s11, 0x20000
Lst_614:
buffer_load_dword v48, off, s[12:15], 0 offset:16 sc1
buffer_load_dword v49, off, s[12:15], 0 offset:144 sc1
s_waitcnt vmcnt(0)
v_add_u32 v48, v48, v49
s_nop 0
v_readfirstlane_b32 s38, v48
s_nop 3
s_and_b32 s39, s38, 0xffff
s_cmp_eq_u32 s39, 0x100
s_cbranch_scc1 Lso_615
s_sub_u32 s37, s37, 1
s_cbranch_scc1 Lend_7
s_sleep 8
s_branch Lst_614
Lso_615:
s_bfe_u32 s35, s38, 0x80010
s_bfe_u32 s46, s38, 0x10018
s_lshl_b32 s46, s46, 13
s_barrier
v_min_u32 v80, 31, v9
v_lshlrev_b32 v80, 7, v80
s_mov_b32 s38, 3448832
Lbw_616:
buffer_load_dword v81, v80, s[4:7], s38 offen sc1
s_waitcnt vmcnt(0)
v_cmp_gt_u32 vcc, 1, v81
s_cbranch_vccz Lbo_617
s_sub_u32 s37, s37, 1
s_cbranch_scc1 Lend_7
s_sleep 8
s_branch Lbw_616
Lbo_617:
s_mov_b32 s38, 3166208
buffer_load_dwordx4 v[16:19], v8, s[4:7], s38 offen offset:0 sc1
buffer_load_dwordx4 v[20:23], v8, s[4:7], s38 offen offset:16 sc1
s_mov_b32 s36, s32
Lfin_618:
s_add_u32 s48, s36, 5
Lbw_619:
buffer_load_dword v3, v2, s[4:7], s47 offen sc1
s_waitcnt vmcnt(0)
v_cmp_gt_u32 vcc, s48, v3
s_cbranch_vccz Lbo_620
s_sub_u32 s37, s37, 1
s_cbranch_scc1 Lend_7
s_sleep 32
s_branch Lbw_619
Lbo_620:
s_lshl_b32 s49, s36, 16
Lfa_621:
s_add_u32 s39, s49, 134217728
buffer_load_dwordx4 v[64:67], v6, s[4:7], s39 offen sc1
s_add_u32 s39, s49, 138412032
buffer_load_dwordx4 v[68:71], v6, s[4:7], s39 offen sc1
s_add_u32 s39, s49, 142606336
buffer_load_dwordx4 v[72:75], v6, s[4:7], s39 offen sc1
s_add_u32 s39, s49, 146800640
buffer_load_dwordx4 v[76:79], v6, s[4:7], s39 offen sc1
s_add_u32 s39, s49, 150994944
buffer_load_dwordx4 v[80:83], v6, s[4:7], s39 offen sc1
s_add_u32 s39, s49, 155189248
buffer_load_dwordx4 v[84:87], v6, s[4:7], s39 offen sc1
s_add_u32 s39, s49, 159383552
buffer_load_dwordx4 v[88:91], v6, s[4:7], s39 offen sc1
s_add_u32 s39, s49, 12582912
buffer_load_dwordx4 v[92:95], v6, s[4:7], s39 offen sc1
s_add_u32 s39, s49, 134479872
buffer_load_dwordx4 v[96:99], v6, s[4:7], s39 offen sc1
s_add_u32 s39, s49, 138674176
buffer_load_dwordx4 v[100:103], v6, s[4:7], s39 offen sc1
s_add_u32 s39, s49, 142868480
buffer_load_dwordx4 v[104:107], v6, s[4:7], s39 offen sc1
s_add_u32 s39, s49, 147062784
buffer_load_dwordx4 v[108:111], v6, s[4:7], s39 offen sc1
s_add_u32 s39, s49, 151257088
buffer_load_dwordx4 v[112:115], v6, s[4:7], s39 offen sc1
s_add_u32 s39, s49, 155451392
buffer_load_dwordx4 v[116:119], v6, s[4:7], s39 offen sc1
s_add_u32 s39, s49, 159645696
buffer_load_dwordx4 v[120:123], v6, s[4:7], s39 offen sc1
s_add_u32 s39, s49, 12845056
buffer_load_dwordx4 v[124:127], v6, s[4:7], s39 offen sc1
s_waitcnt vmcnt(8)
v_dot2_f32_bf16 v24, v64, s60, 0
v_dot2_f32_bf16 v25, v64, s61, 0
v_dot2_f32_bf16 v26, v65, s60, 0
v_dot2_f32_bf16 v27, v65, s61, 0
v_dot2_f32_bf16 v28, v66, s60, 0
v_dot2_f32_bf16 v29, v66, s61, 0
v_dot2_f32_bf16 v30, v67, s60, 0
v_dot2_f32_bf16 v31, v67, s61, 0
v_dot2_f32_bf16 v24, v68, s60, v24
v_dot2_f32_bf16 v25, v68, s61, v25
v_dot2_f32_bf16 v26, v69, s60, v26
v_dot2_f32_bf16 v27, v69, s61, v27
v_dot2_f32_bf16 v28, v70, s60, v28
v_dot2_f32_bf16 v29, v70, s61, v29
v_dot2_f32_bf16 v30, v71, s60, v30
v_dot2_f32_bf16 v31, v71, s61, v31
v_dot2_f32_bf16 v24, v72, s60, v24
v_dot2_f32_bf16 v25, v72, s61, v25
v_dot2_f32_bf16 v26, v73, s60, v26
v_dot2_f32_bf16 v27, v73, s61, v27
v_dot2_f32_bf16 v28, v74, s60, v28
v_dot2_f32_bf16 v29, v74, s61, v29
v_dot2_f32_bf16 v30, v75, s60, v30
v_dot2_f32_bf16 v31, v75, s61, v31
v_dot2_f32_bf16 v24, v76, s60, v24
v_dot2_f32_bf16 v25, v76, s61, v25
v_dot2_f32_bf16 v26, v77, s60, v26
v_dot2_f32_bf16 v27, v77, s61, v27
v_dot2_f32_bf16 v28, v78, s60, v28
v_dot2_f32_bf16 v29, v78, s61, v29
v_dot2_f32_bf16 v30, v79, s60, v30
v_dot2_f32_bf16 v31, v79, s61, v31
v_dot2_f32_bf16 v24, v80, s60, v24
v_dot2_f32_bf16 v25, v80, s61, v25
v_dot2_f32_bf16 v26, v81, s60, v26
v_dot2_f32_bf16 v27, v81, s61, v27
v_dot2_f32_bf16 v28, v82, s60, v28
v_dot2_f32_bf16 v29, v82, s61, v29
v_dot2_f32_bf16 v30, v83, s60, v30
v_dot2_f32_bf16 v31, v83, s61, v31
v_dot2_f32_bf16 v24, v84, s60, v24
v_dot2_f32_bf16 v25, v84, s61, v25
v_dot2_f32_bf16 v26, v85, s60, v26
v_dot2_f32_bf16 v27, v85, s61, v27
v_dot2_f32_bf16 v28, v86, s60, v28
v_dot2_f32_bf16 v29, v86, s61, v29
v_dot2_f32_bf16 v30, v87, s60, v30
v_dot2_f32_bf16 v31, v87, s61, v31
v_dot2_f32_bf16 v24, v88, s60, v24
v_dot2_f32_bf16 v25, v88, s61, v25
v_dot2_f32_bf16 v26, v89, s60, v26
v_dot2_f32_bf16 v27, v89, s61, v27
v_dot2_f32_bf16 v28, v90, s60, v28
v_dot2_f32_bf16 v29, v90, s61, v29
v_dot2_f32_bf16 v30, v91, s60, v30
v_dot2_f32_bf16 v31, v91, s61, v31
v_lshlrev_b32 v32, 16, v92
v_and_b32 v33, 0xffff0000, v92
v_lshlrev_b32 v34, 16, v93
v_and_b32 v35, 0xffff0000, v93
v_lshlrev_b32 v36, 16, v94
v_and_b32 v37, 0xffff0000, v94
v_lshlrev_b32 v38, 16, v95
v_and_b32 v39, 0xffff0000, v95
v_pk_fma_f32 v[32:33], v[24:25], v[16:17], v[32:33]
v_pk_fma_f32 v[34:35], v[26:27], v[18:19], v[34:35]
v_pk_fma_f32 v[36:37], v[28:29], v[20:21], v[36:37]
v_pk_fma_f32 v[38:39], v[30:31], v[22:23], v[38:39]
v_cvt_pk_bf16_f32 v40, v32, v33
v_cvt_pk_bf16_f32 v41, v34, v35
v_cvt_pk_bf16_f32 v42, v36, v37
v_cvt_pk_bf16_f32 v43, v38, v39
s_add_u32 s39, s49, 0
buffer_store_dwordx4 v[40:43], v7, s[8:11], s39 offen sc1
s_waitcnt vmcnt(1)
v_dot2_f32_bf16 v24, v96, s60, 0
v_dot2_f32_bf16 v25, v96, s61, 0
v_dot2_f32_bf16 v26, v97, s60, 0
v_dot2_f32_bf16 v27, v97, s61, 0
v_dot2_f32_bf16 v28, v98, s60, 0
v_dot2_f32_bf16 v29, v98, s61, 0
v_dot2_f32_bf16 v30, v99, s60, 0
v_dot2_f32_bf16 v31, v99, s61, 0
v_dot2_f32_bf16 v24, v100, s60, v24
v_dot2_f32_bf16 v25, v100, s61, v25
v_dot2_f32_bf16 v26, v101, s60, v26
v_dot2_f32_bf16 v27, v101, s61, v27
v_dot2_f32_bf16 v28, v102, s60, v28
v_dot2_f32_bf16 v29, v102, s61, v29
v_dot2_f32_bf16 v30, v103, s60, v30
v_dot2_f32_bf16 v31, v103, s61, v31
v_dot2_f32_bf16 v24, v104, s60, v24
v_dot2_f32_bf16 v25, v104, s61, v25
v_dot2_f32_bf16 v26, v105, s60, v26
v_dot2_f32_bf16 v27, v105, s61, v27
v_dot2_f32_bf16 v28, v106, s60, v28
v_dot2_f32_bf16 v29, v106, s61, v29
v_dot2_f32_bf16 v30, v107, s60, v30
v_dot2_f32_bf16 v31, v107, s61, v31
v_dot2_f32_bf16 v24, v108, s60, v24
v_dot2_f32_bf16 v25, v108, s61, v25
v_dot2_f32_bf16 v26, v109, s60, v26
v_dot2_f32_bf16 v27, v109, s61, v27
v_dot2_f32_bf16 v28, v110, s60, v28
v_dot2_f32_bf16 v29, v110, s61, v29
v_dot2_f32_bf16 v30, v111, s60, v30
v_dot2_f32_bf16 v31, v111, s61, v31
v_dot2_f32_bf16 v24, v112, s60, v24
v_dot2_f32_bf16 v25, v112, s61, v25
v_dot2_f32_bf16 v26, v113, s60, v26
v_dot2_f32_bf16 v27, v113, s61, v27
v_dot2_f32_bf16 v28, v114, s60, v28
v_dot2_f32_bf16 v29, v114, s61, v29
v_dot2_f32_bf16 v30, v115, s60, v30
v_dot2_f32_bf16 v31, v115, s61, v31
v_dot2_f32_bf16 v24, v116, s60, v24
v_dot2_f32_bf16 v25, v116, s61, v25
v_dot2_f32_bf16 v26, v117, s60, v26
v_dot2_f32_bf16 v27, v117, s61, v27
v_dot2_f32_bf16 v28, v118, s60, v28
v_dot2_f32_bf16 v29, v118, s61, v29
v_dot2_f32_bf16 v30, v119, s60, v30
v_dot2_f32_bf16 v31, v119, s61, v31
v_dot2_f32_bf16 v24, v120, s60, v24
v_dot2_f32_bf16 v25, v120, s61, v25
v_dot2_f32_bf16 v26, v121, s60, v26
v_dot2_f32_bf16 v27, v121, s61, v27
v_dot2_f32_bf16 v28, v122, s60, v28
v_dot2_f32_bf16 v29, v122, s61, v29
v_dot2_f32_bf16 v30, v123, s60, v30
v_dot2_f32_bf16 v31, v123, s61, v31
v_lshlrev_b32 v32, 16, v124
v_and_b32 v33, 0xffff0000, v124
v_lshlrev_b32 v34, 16, v125
v_and_b32 v35, 0xffff0000, v125
v_lshlrev_b32 v36, 16, v126
v_and_b32 v37, 0xffff0000, v126
v_lshlrev_b32 v38, 16, v127
v_and_b32 v39, 0xffff0000, v127
v_pk_fma_f32 v[32:33], v[24:25], v[16:17], v[32:33]
v_pk_fma_f32 v[34:35], v[26:27], v[18:19], v[34:35]
v_pk_fma_f32 v[36:37], v[28:29], v[20:21], v[36:37]
v_pk_fma_f32 v[38:39], v[30:31], v[22:23], v[38:39]
v_cvt_pk_bf16_f32 v44, v32, v33
v_cvt_pk_bf16_f32 v45, v34, v35
v_cvt_pk_bf16_f32 v46, v36, v37
v_cvt_pk_bf16_f32 v47, v38, v39
s_add_u32 s39, s49, 262144
buffer_store_dwordx4 v[44:47], v7, s[8:11], s39 offen sc1
s_add_u32 s36, s36, 8
s_cmp_lt_u32 s36, 48
s_cbranch_scc1 Lfin_618
Lfin_622:
s_add_u32 s48, s36, 1
Lbw_623:
buffer_load_dword v3, v2, s[4:7], s47 offen sc1
s_waitcnt vmcnt(0)
v_cmp_gt_u32 vcc, s48, v3
s_cbranch_vccz Lbo_624
s_sub_u32 s37, s37, 1
s_cbranch_scc1 Lend_7
s_sleep 4
s_branch Lbw_623
Lbo_624:
s_lshl_b32 s49, s36, 16
Lfa_625:
s_add_u32 s39, s49, 134217728
buffer_load_dwordx4 v[64:67], v6, s[4:7], s39 offen sc1
s_add_u32 s39, s49, 138412032
buffer_load_dwordx4 v[68:71], v6, s[4:7], s39 offen sc1
s_add_u32 s39, s49, 142606336
buffer_load_dwordx4 v[72:75], v6, s[4:7], s39 offen sc1
s_add_u32 s39, s49, 146800640
buffer_load_dwordx4 v[76:79], v6, s[4:7], s39 offen sc1
s_add_u32 s39, s49, 150994944
buffer_load_dwordx4 v[80:83], v6, s[4:7], s39 offen sc1
s_add_u32 s39, s49, 155189248
buffer_load_dwordx4 v[84:87], v6, s[4:7], s39 offen sc1
s_add_u32 s39, s49, 159383552
buffer_load_dwordx4 v[88:91], v6, s[4:7], s39 offen sc1
s_add_u32 s39, s49, 12582912
buffer_load_dwordx4 v[92:95], v6, s[4:7], s39 offen sc1
s_waitcnt vmcnt(0)
s_sub_u32 s37, s37, 1
s_cbranch_scc1 Lend_7
v_max3_u32 v24, v64, v65, v66
v_max3_u32 v24, v24, v67, v68
v_max3_u32 v24, v24, v69, v70
v_max3_u32 v24, v24, v71, v72
v_max3_u32 v24, v24, v73, v74
v_max3_u32 v24, v24, v75, v76
v_max3_u32 v24, v24, v77, v78
v_max3_u32 v24, v24, v79, v80
v_max3_u32 v24, v24, v81, v82
v_max3_u32 v24, v24, v83, v84
v_max3_u32 v24, v24, v85, v86
v_max3_u32 v24, v24, v87, v88
v_max3_u32 v24, v24, v89, v90
v_max_u32 v24, v24, v91
v_cmp_eq_u32 vcc, -1, v24
s_cbranch_vccnz Lfa_625
v_dot2_f32_bf16 v24, v64, s60, 0
v_dot2_f32_bf16 v25, v64, s61, 0
v_dot2_f32_bf16 v26, v65, s60, 0
v_dot2_f32_bf16 v27, v65, s61, 0
v_dot2_f32_bf16 v28, v66, s60, 0
v_dot2_f32_bf16 v29, v66, s61, 0
v_dot2_f32_bf16 v30, v67, s60, 0
v_dot2_f32_bf16 v31, v67, s61, 0
v_dot2_f32_bf16 v24, v68, s60, v24
v_dot2_f32_bf16 v25, v68, s61, v25
v_dot2_f32_bf16 v26, v69, s60, v26
v_dot2_f32_bf16 v27, v69, s61, v27
v_dot2_f32_bf16 v28, v70, s60, v28
v_dot2_f32_bf16 v29, v70, s61, v29
v_dot2_f32_bf16 v30, v71, s60, v30
v_dot2_f32_bf16 v31, v71, s61, v31
v_dot2_f32_bf16 v24, v72, s60, v24
v_dot2_f32_bf16 v25, v72, s61, v25
v_dot2_f32_bf16 v26, v73, s60, v26
v_dot2_f32_bf16 v27, v73, s61, v27
v_dot2_f32_bf16 v28, v74, s60, v28
v_dot2_f32_bf16 v29, v74, s61, v29
v_dot2_f32_bf16 v30, v75, s60, v30
v_dot2_f32_bf16 v31, v75, s61, v31
v_dot2_f32_bf16 v24, v76, s60, v24
v_dot2_f32_bf16 v25, v76, s61, v25
v_dot2_f32_bf16 v26, v77, s60, v26
v_dot2_f32_bf16 v27, v77, s61, v27
v_dot2_f32_bf16 v28, v78, s60, v28
v_dot2_f32_bf16 v29, v78, s61, v29
v_dot2_f32_bf16 v30, v79, s60, v30
v_dot2_f32_bf16 v31, v79, s61, v31
v_dot2_f32_bf16 v24, v80, s60, v24
v_dot2_f32_bf16 v25, v80, s61, v25
v_dot2_f32_bf16 v26, v81, s60, v26
v_dot2_f32_bf16 v27, v81, s61, v27
v_dot2_f32_bf16 v28, v82, s60, v28
v_dot2_f32_bf16 v29, v82, s61, v29
v_dot2_f32_bf16 v30, v83, s60, v30
v_dot2_f32_bf16 v31, v83, s61, v31
v_dot2_f32_bf16 v24, v84, s60, v24
v_dot2_f32_bf16 v25, v84, s61, v25
v_dot2_f32_bf16 v26, v85, s60, v26
v_dot2_f32_bf16 v27, v85, s61, v27
v_dot2_f32_bf16 v28, v86, s60, v28
v_dot2_f32_bf16 v29, v86, s61, v29
v_dot2_f32_bf16 v30, v87, s60, v30
v_dot2_f32_bf16 v31, v87, s61, v31
v_dot2_f32_bf16 v24, v88, s60, v24
v_dot2_f32_bf16 v25, v88, s61, v25
v_dot2_f32_bf16 v26, v89, s60, v26
v_dot2_f32_bf16 v27, v89, s61, v27
v_dot2_f32_bf16 v28, v90, s60, v28
v_dot2_f32_bf16 v29, v90, s61, v29
v_dot2_f32_bf16 v30, v91, s60, v30
v_dot2_f32_bf16 v31, v91, s61, v31
v_lshlrev_b32 v32, 16, v92
v_and_b32 v33, 0xffff0000, v92
v_lshlrev_b32 v34, 16, v93
v_and_b32 v35, 0xffff0000, v93
v_lshlrev_b32 v36, 16, v94
v_and_b32 v37, 0xffff0000, v94
v_lshlrev_b32 v38, 16, v95
v_and_b32 v39, 0xffff0000, v95
v_pk_fma_f32 v[32:33], v[24:25], v[16:17], v[32:33]
v_pk_fma_f32 v[34:35], v[26:27], v[18:19], v[34:35]
v_pk_fma_f32 v[36:37], v[28:29], v[20:21], v[36:37]
v_pk_fma_f32 v[38:39], v[30:31], v[22:23], v[38:39]
v_cvt_pk_bf16_f32 v40, v32, v33
v_cvt_pk_bf16_f32 v41, v34, v35
v_cvt_pk_bf16_f32 v42, v36, v37
v_cvt_pk_bf16_f32 v43, v38, v39
s_add_u32 s39, s49, 0
buffer_store_dwordx4 v[40:43], v7, s[8:11], s39 offen sc1
s_add_u32 s36, s36, 4
s_cmp_lt_u32 s36, 64
s_cbranch_scc1 Lfin_622
s_endpgm
Lend_7:
s_endpgm
Lhelper_5:
v_mov_b32 v9, v1
s_sub_u32 s52, s33, 4
s_lshl_b32 s26, s34, 2
s_add_u32 s26, s26, s52
s_sub_u32 s26, s26, 64
s_lshr_b32 s38, s52, 1
s_lshl_b32 s39, s38, 3
s_add_u32 s39, s39, 16
s_lshl_b32 s38, s38, 2
s_cmp_ge_u32 s34, 28
s_cselect_b32 s53, 28, 24
s_add_u32 s38, s38, s53
s_cmp_ge_u32 s34, 24
s_cselect_b32 s38, s38, s39
s_lshl_b32 s39, s52, 3
s_sub_u32 s39, s39, 16
s_bitcmp1_b32 s52, 0
s_cselect_b32 s38, s38, s39
s_add_u32 s44, s38, s34
s_load_dwordx2 s[16:17], s[0:1], 96
s_load_dwordx2 s[18:19], s[0:1], 88
s_load_dwordx2 s[20:21], s[0:1], 0
s_lshl_b32 s38, s26, 7
s_add_u32 s38, s38, 3424256
v_min_u32 v80, 1, v0
v_lshl_add_u32 v10, v80, 30, s38
s_lshl_b32 s38, s44, 7
s_add_u32 s38, s38, 3416064
v_min_u32 v80, 1, v0
v_lshl_add_u32 v8, v80, 30, s38
v_mov_b32 v14, 0
v_mov_b32 v15, 0
buffer_store_dword v14, v10, s[4:7], 0 offen sc1
buffer_store_dwordx2 v[14:15], v8, s[4:7], 0 offen sc1
s_waitcnt lgkmcnt(0)
s_mov_b32 s8, s16
s_and_b32 s9, s17, 0xffff
s_mov_b32 s10, 0xc00000
s_mov_b32 s11, 0x20000
s_mov_b32 s84, s18
s_and_b32 s85, s19, 0xffff
s_mov_b32 s86, 0x800
s_mov_b32 s87, 0x20000
s_mov_b32 s88, s20
s_and_b32 s89, s21, 0xffff
s_mov_b32 s90, 0x400000
s_mov_b32 s91, 0x20000
v_and_b32 v12, 15, v9
v_lshlrev_b32 v12, 5, v12
s_lshl_b32 s38, s32, 3
v_add_u32 v11, s38, v12
v_lshlrev_b32 v13, 4, v9
v_lshrrev_b32 v7, 4, v9
v_lshlrev_b32 v6, 6, v12
v_lshl_add_u32 v6, v7, 4, v6
v_lshlrev_b32 v7, 5, v7
s_and_b32 s60, s26, 2
s_lshl_b32 s60, s60, 3
s_lshr_b32 s61, s26, 2
s_add_u32 s60, s60, s61
s_and_b32 s61, s26, 1
s_lshl_b32 s62, s60, 8
s_lshl_b32 s38, s61, 13
s_add_u32 s62, s62, s38
s_add_u32 s62, s62, 3178496
s_min_u32 s38, s32, 1
s_lshl_b32 s38, s38, 30
s_add_u32 s38, s38, s62
v_lshlrev_b32 v2, 2, v9
v_mov_b32 v3, -1
buffer_store_dword v3, v2, s[4:7], s38 offen sc1
s_mov_b32 s52, 1
s_waitcnt vmcnt(0)
s_cmp_lg_u32 s32, 0
s_cbranch_scc1 Lar_626
s_mov_b64 exec, 1
v_mov_b32 v14, 144
v_mov_b32 v15, s52
buffer_atomic_add v15, v14, s[12:15], 0 offen sc1
s_mov_b64 exec, -1
Lar_626:
v_lshrrev_b32 v2, 3, v0
v_and_b32 v3, 7, v0
v_mul_u32_u24 v4, 12288, v2
v_lshl_add_u32 v4, v3, 4, v4
v_lshlrev_b32 v5, 1, v2
v_mov_b32 v96, 0
v_mov_b32 v97, 0
v_mov_b32 v98, 0
v_mov_b32 v99, 0
v_mov_b32 v100, 0
v_mov_b32 v101, 0
v_mov_b32 v102, 0
v_mov_b32 v103, 0
s_lshl_b32 s41, s61, 10
s_mul_i32 s40, s61, 6291456
s_lshl_b32 s42, s60, 7
s_add_u32 s40, s40, s42
buffer_load_ushort v80, v5, s[84:87], s41 offen offset:0
buffer_load_ushort v81, v5, s[84:87], s41 offen offset:64
buffer_load_ushort v82, v5, s[84:87], s41 offen offset:128
buffer_load_ushort v83, v5, s[84:87], s41 offen offset:192
buffer_load_ushort v84, v5, s[84:87], s41 offen offset:256
buffer_load_ushort v85, v5, s[84:87], s41 offen offset:320
buffer_load_ushort v86, v5, s[84:87], s41 offen offset:384
buffer_load_ushort v87, v5, s[84:87], s41 offen offset:448
buffer_load_ushort v88, v5, s[84:87], s41 offen offset:512
buffer_load_ushort v89, v5, s[84:87], s41 offen offset:576
buffer_load_ushort v90, v5, s[84:87], s41 offen offset:640
buffer_load_ushort v91, v5, s[84:87], s41 offen offset:704
buffer_load_ushort v92, v5, s[84:87], s41 offen offset:768
buffer_load_ushort v93, v5, s[84:87], s41 offen offset:832
buffer_load_ushort v94, v5, s[84:87], s41 offen offset:896
buffer_load_ushort v95, v5, s[84:87], s41 offen offset:960
buffer_load_dwordx4 v[16:19], v4, s[8:11], s40 offen
s_add_u32 s40, s40, 393216
buffer_load_dwordx4 v[20:23], v4, s[8:11], s40 offen
s_add_u32 s40, s40, 393216
buffer_load_dwordx4 v[24:27], v4, s[8:11], s40 offen
s_add_u32 s40, s40, 393216
buffer_load_dwordx4 v[28:31], v4, s[8:11], s40 offen
s_add_u32 s40, s40, 393216
buffer_load_dwordx4 v[32:35], v4, s[8:11], s40 offen
s_add_u32 s40, s40, 393216
buffer_load_dwordx4 v[36:39], v4, s[8:11], s40 offen
s_add_u32 s40, s40, 393216
buffer_load_dwordx4 v[40:43], v4, s[8:11], s40 offen
s_add_u32 s40, s40, 393216
buffer_load_dwordx4 v[44:47], v4, s[8:11], s40 offen
s_add_u32 s40, s40, 393216
buffer_load_dwordx4 v[48:51], v4, s[8:11], s40 offen
s_add_u32 s40, s40, 393216
buffer_load_dwordx4 v[52:55], v4, s[8:11], s40 offen
s_add_u32 s40, s40, 393216
buffer_load_dwordx4 v[56:59], v4, s[8:11], s40 offen
s_add_u32 s40, s40, 393216
buffer_load_dwordx4 v[60:63], v4, s[8:11], s40 offen
s_add_u32 s40, s40, 393216
buffer_load_dwordx4 v[64:67], v4, s[8:11], s40 offen
s_add_u32 s40, s40, 393216
buffer_load_dwordx4 v[68:71], v4, s[8:11], s40 offen
s_add_u32 s40, s40, 393216
buffer_load_dwordx4 v[72:75], v4, s[8:11], s40 offen
s_add_u32 s40, s40, 393216
buffer_load_dwordx4 v[76:79], v4, s[8:11], s40 offen
s_add_u32 s40, s40, 393216
s_add_u32 s52, s26, 0
s_lshl_b32 s41, s52, 15
s_lshl_b32 s42, s32, 9
s_add_u32 s41, s41, s42
buffer_load_dwordx4 a[0:3], v6, s[88:91], s41 offen offset:0
buffer_load_dwordx4 a[4:7], v6, s[88:91], s41 offen offset:64
buffer_load_dwordx4 a[8:11], v6, s[88:91], s41 offen offset:128
buffer_load_dwordx4 a[12:15], v6, s[88:91], s41 offen offset:192
buffer_load_dwordx4 a[16:19], v6, s[88:91], s41 offen offset:256
buffer_load_dwordx4 a[20:23], v6, s[88:91], s41 offen offset:320
buffer_load_dwordx4 a[24:27], v6, s[88:91], s41 offen offset:384
buffer_load_dwordx4 a[28:31], v6, s[88:91], s41 offen offset:448
s_waitcnt vmcnt(24)
v_lshlrev_b32 v80, 16, v80
v_mul_f32 v104, 0xbfb8aa3b, v80
v_exp_f32 v104, v104
s_nop 0
v_add_f32 v104, 1.0, v104
v_rcp_f32 v104, v104
s_nop 0
v_mul_f32 v104, v104, v80
v_cvt_pk_bf16_f32 v80, 0, v104
v_lshlrev_b32 v81, 16, v81
v_mul_f32 v104, 0xbfb8aa3b, v81
v_exp_f32 v104, v104
s_nop 0
v_add_f32 v104, 1.0, v104
v_rcp_f32 v104, v104
s_nop 0
v_mul_f32 v104, v104, v81
v_cvt_pk_bf16_f32 v81, 0, v104
v_lshlrev_b32 v82, 16, v82
v_mul_f32 v104, 0xbfb8aa3b, v82
v_exp_f32 v104, v104
s_nop 0
v_add_f32 v104, 1.0, v104
v_rcp_f32 v104, v104
s_nop 0
v_mul_f32 v104, v104, v82
v_cvt_pk_bf16_f32 v82, 0, v104
v_lshlrev_b32 v83, 16, v83
v_mul_f32 v104, 0xbfb8aa3b, v83
v_exp_f32 v104, v104
s_nop 0
v_add_f32 v104, 1.0, v104
v_rcp_f32 v104, v104
s_nop 0
v_mul_f32 v104, v104, v83
v_cvt_pk_bf16_f32 v83, 0, v104
v_lshlrev_b32 v84, 16, v84
v_mul_f32 v104, 0xbfb8aa3b, v84
v_exp_f32 v104, v104
s_nop 0
v_add_f32 v104, 1.0, v104
v_rcp_f32 v104, v104
s_nop 0
v_mul_f32 v104, v104, v84
v_cvt_pk_bf16_f32 v84, 0, v104
v_lshlrev_b32 v85, 16, v85
v_mul_f32 v104, 0xbfb8aa3b, v85
v_exp_f32 v104, v104
s_nop 0
v_add_f32 v104, 1.0, v104
v_rcp_f32 v104, v104
s_nop 0
v_mul_f32 v104, v104, v85
v_cvt_pk_bf16_f32 v85, 0, v104
v_lshlrev_b32 v86, 16, v86
v_mul_f32 v104, 0xbfb8aa3b, v86
v_exp_f32 v104, v104
s_nop 0
v_add_f32 v104, 1.0, v104
v_rcp_f32 v104, v104
s_nop 0
v_mul_f32 v104, v104, v86
v_cvt_pk_bf16_f32 v86, 0, v104
v_lshlrev_b32 v87, 16, v87
v_mul_f32 v104, 0xbfb8aa3b, v87
v_exp_f32 v104, v104
s_nop 0
v_add_f32 v104, 1.0, v104
v_rcp_f32 v104, v104
s_nop 0
v_mul_f32 v104, v104, v87
v_cvt_pk_bf16_f32 v87, 0, v104
v_lshlrev_b32 v88, 16, v88
v_mul_f32 v104, 0xbfb8aa3b, v88
v_exp_f32 v104, v104
s_nop 0
v_add_f32 v104, 1.0, v104
v_rcp_f32 v104, v104
s_nop 0
v_mul_f32 v104, v104, v88
v_cvt_pk_bf16_f32 v88, 0, v104
v_lshlrev_b32 v89, 16, v89
v_mul_f32 v104, 0xbfb8aa3b, v89
v_exp_f32 v104, v104
s_nop 0
v_add_f32 v104, 1.0, v104
v_rcp_f32 v104, v104
s_nop 0
v_mul_f32 v104, v104, v89
v_cvt_pk_bf16_f32 v89, 0, v104
v_lshlrev_b32 v90, 16, v90
v_mul_f32 v104, 0xbfb8aa3b, v90
v_exp_f32 v104, v104
s_nop 0
v_add_f32 v104, 1.0, v104
v_rcp_f32 v104, v104
s_nop 0
v_mul_f32 v104, v104, v90
v_cvt_pk_bf16_f32 v90, 0, v104
v_lshlrev_b32 v91, 16, v91
v_mul_f32 v104, 0xbfb8aa3b, v91
v_exp_f32 v104, v104
s_nop 0
v_add_f32 v104, 1.0, v104
v_rcp_f32 v104, v104
s_nop 0
v_mul_f32 v104, v104, v91
v_cvt_pk_bf16_f32 v91, 0, v104
v_lshlrev_b32 v92, 16, v92
v_mul_f32 v104, 0xbfb8aa3b, v92
v_exp_f32 v104, v104
s_nop 0
v_add_f32 v104, 1.0, v104
v_rcp_f32 v104, v104
s_nop 0
v_mul_f32 v104, v104, v92
v_cvt_pk_bf16_f32 v92, 0, v104
v_lshlrev_b32 v93, 16, v93
v_mul_f32 v104, 0xbfb8aa3b, v93
v_exp_f32 v104, v104
s_nop 0
v_add_f32 v104, 1.0, v104
v_rcp_f32 v104, v104
s_nop 0
v_mul_f32 v104, v104, v93
v_cvt_pk_bf16_f32 v93, 0, v104
v_lshlrev_b32 v94, 16, v94
v_mul_f32 v104, 0xbfb8aa3b, v94
v_exp_f32 v104, v104
s_nop 0
v_add_f32 v104, 1.0, v104
v_rcp_f32 v104, v104
s_nop 0
v_mul_f32 v104, v104, v94
v_cvt_pk_bf16_f32 v94, 0, v104
v_lshlrev_b32 v95, 16, v95
v_mul_f32 v104, 0xbfb8aa3b, v95
v_exp_f32 v104, v104
s_nop 0
v_add_f32 v104, 1.0, v104
v_rcp_f32 v104, v104
s_nop 0
v_mul_f32 v104, v104, v95
v_cvt_pk_bf16_f32 v95, 0, v104
s_waitcnt vmcnt(23)
v_lshlrev_b32 v104, 16, v16
v_and_b32 v105, 0xffff0000, v16
v_fmac_f32 v96, v104, v80
v_fmac_f32 v97, v105, v80
v_lshlrev_b32 v104, 16, v17
v_and_b32 v105, 0xffff0000, v17
v_fmac_f32 v98, v104, v80
v_fmac_f32 v99, v105, v80
v_lshlrev_b32 v104, 16, v18
v_and_b32 v105, 0xffff0000, v18
v_fmac_f32 v100, v104, v80
v_fmac_f32 v101, v105, v80
v_lshlrev_b32 v104, 16, v19
v_and_b32 v105, 0xffff0000, v19
v_fmac_f32 v102, v104, v80
v_fmac_f32 v103, v105, v80
s_waitcnt vmcnt(22)
v_lshlrev_b32 v104, 16, v20
v_and_b32 v105, 0xffff0000, v20
v_fmac_f32 v96, v104, v81
v_fmac_f32 v97, v105, v81
v_lshlrev_b32 v104, 16, v21
v_and_b32 v105, 0xffff0000, v21
v_fmac_f32 v98, v104, v81
v_fmac_f32 v99, v105, v81
v_lshlrev_b32 v104, 16, v22
v_and_b32 v105, 0xffff0000, v22
v_fmac_f32 v100, v104, v81
v_fmac_f32 v101, v105, v81
v_lshlrev_b32 v104, 16, v23
v_and_b32 v105, 0xffff0000, v23
v_fmac_f32 v102, v104, v81
v_fmac_f32 v103, v105, v81
s_waitcnt vmcnt(21)
v_lshlrev_b32 v104, 16, v24
v_and_b32 v105, 0xffff0000, v24
v_fmac_f32 v96, v104, v82
v_fmac_f32 v97, v105, v82
v_lshlrev_b32 v104, 16, v25
v_and_b32 v105, 0xffff0000, v25
v_fmac_f32 v98, v104, v82
v_fmac_f32 v99, v105, v82
v_lshlrev_b32 v104, 16, v26
v_and_b32 v105, 0xffff0000, v26
v_fmac_f32 v100, v104, v82
v_fmac_f32 v101, v105, v82
v_lshlrev_b32 v104, 16, v27
v_and_b32 v105, 0xffff0000, v27
v_fmac_f32 v102, v104, v82
v_fmac_f32 v103, v105, v82
s_waitcnt vmcnt(20)
v_lshlrev_b32 v104, 16, v28
v_and_b32 v105, 0xffff0000, v28
v_fmac_f32 v96, v104, v83
v_fmac_f32 v97, v105, v83
v_lshlrev_b32 v104, 16, v29
v_and_b32 v105, 0xffff0000, v29
v_fmac_f32 v98, v104, v83
v_fmac_f32 v99, v105, v83
v_lshlrev_b32 v104, 16, v30
v_and_b32 v105, 0xffff0000, v30
v_fmac_f32 v100, v104, v83
v_fmac_f32 v101, v105, v83
v_lshlrev_b32 v104, 16, v31
v_and_b32 v105, 0xffff0000, v31
v_fmac_f32 v102, v104, v83
v_fmac_f32 v103, v105, v83
s_waitcnt vmcnt(19)
v_lshlrev_b32 v104, 16, v32
v_and_b32 v105, 0xffff0000, v32
v_fmac_f32 v96, v104, v84
v_fmac_f32 v97, v105, v84
v_lshlrev_b32 v104, 16, v33
v_and_b32 v105, 0xffff0000, v33
v_fmac_f32 v98, v104, v84
v_fmac_f32 v99, v105, v84
v_lshlrev_b32 v104, 16, v34
v_and_b32 v105, 0xffff0000, v34
v_fmac_f32 v100, v104, v84
v_fmac_f32 v101, v105, v84
v_lshlrev_b32 v104, 16, v35
v_and_b32 v105, 0xffff0000, v35
v_fmac_f32 v102, v104, v84
v_fmac_f32 v103, v105, v84
s_waitcnt vmcnt(18)
v_lshlrev_b32 v104, 16, v36
v_and_b32 v105, 0xffff0000, v36
v_fmac_f32 v96, v104, v85
v_fmac_f32 v97, v105, v85
v_lshlrev_b32 v104, 16, v37
v_and_b32 v105, 0xffff0000, v37
v_fmac_f32 v98, v104, v85
v_fmac_f32 v99, v105, v85
v_lshlrev_b32 v104, 16, v38
v_and_b32 v105, 0xffff0000, v38
v_fmac_f32 v100, v104, v85
v_fmac_f32 v101, v105, v85
v_lshlrev_b32 v104, 16, v39
v_and_b32 v105, 0xffff0000, v39
v_fmac_f32 v102, v104, v85
v_fmac_f32 v103, v105, v85
s_waitcnt vmcnt(17)
v_lshlrev_b32 v104, 16, v40
v_and_b32 v105, 0xffff0000, v40
v_fmac_f32 v96, v104, v86
v_fmac_f32 v97, v105, v86
v_lshlrev_b32 v104, 16, v41
v_and_b32 v105, 0xffff0000, v41
v_fmac_f32 v98, v104, v86
v_fmac_f32 v99, v105, v86
v_lshlrev_b32 v104, 16, v42
v_and_b32 v105, 0xffff0000, v42
v_fmac_f32 v100, v104, v86
v_fmac_f32 v101, v105, v86
v_lshlrev_b32 v104, 16, v43
v_and_b32 v105, 0xffff0000, v43
v_fmac_f32 v102, v104, v86
v_fmac_f32 v103, v105, v86
s_waitcnt vmcnt(16)
v_lshlrev_b32 v104, 16, v44
v_and_b32 v105, 0xffff0000, v44
v_fmac_f32 v96, v104, v87
v_fmac_f32 v97, v105, v87
v_lshlrev_b32 v104, 16, v45
v_and_b32 v105, 0xffff0000, v45
v_fmac_f32 v98, v104, v87
v_fmac_f32 v99, v105, v87
v_lshlrev_b32 v104, 16, v46
v_and_b32 v105, 0xffff0000, v46
v_fmac_f32 v100, v104, v87
v_fmac_f32 v101, v105, v87
v_lshlrev_b32 v104, 16, v47
v_and_b32 v105, 0xffff0000, v47
v_fmac_f32 v102, v104, v87
v_fmac_f32 v103, v105, v87
s_waitcnt vmcnt(15)
v_lshlrev_b32 v104, 16, v48
v_and_b32 v105, 0xffff0000, v48
v_fmac_f32 v96, v104, v88
v_fmac_f32 v97, v105, v88
v_lshlrev_b32 v104, 16, v49
v_and_b32 v105, 0xffff0000, v49
v_fmac_f32 v98, v104, v88
v_fmac_f32 v99, v105, v88
v_lshlrev_b32 v104, 16, v50
v_and_b32 v105, 0xffff0000, v50
v_fmac_f32 v100, v104, v88
v_fmac_f32 v101, v105, v88
v_lshlrev_b32 v104, 16, v51
v_and_b32 v105, 0xffff0000, v51
v_fmac_f32 v102, v104, v88
v_fmac_f32 v103, v105, v88
s_waitcnt vmcnt(14)
v_lshlrev_b32 v104, 16, v52
v_and_b32 v105, 0xffff0000, v52
v_fmac_f32 v96, v104, v89
v_fmac_f32 v97, v105, v89
v_lshlrev_b32 v104, 16, v53
v_and_b32 v105, 0xffff0000, v53
v_fmac_f32 v98, v104, v89
v_fmac_f32 v99, v105, v89
v_lshlrev_b32 v104, 16, v54
v_and_b32 v105, 0xffff0000, v54
v_fmac_f32 v100, v104, v89
v_fmac_f32 v101, v105, v89
v_lshlrev_b32 v104, 16, v55
v_and_b32 v105, 0xffff0000, v55
v_fmac_f32 v102, v104, v89
v_fmac_f32 v103, v105, v89
s_waitcnt vmcnt(13)
v_lshlrev_b32 v104, 16, v56
v_and_b32 v105, 0xffff0000, v56
v_fmac_f32 v96, v104, v90
v_fmac_f32 v97, v105, v90
v_lshlrev_b32 v104, 16, v57
v_and_b32 v105, 0xffff0000, v57
v_fmac_f32 v98, v104, v90
v_fmac_f32 v99, v105, v90
v_lshlrev_b32 v104, 16, v58
v_and_b32 v105, 0xffff0000, v58
v_fmac_f32 v100, v104, v90
v_fmac_f32 v101, v105, v90
v_lshlrev_b32 v104, 16, v59
v_and_b32 v105, 0xffff0000, v59
v_fmac_f32 v102, v104, v90
v_fmac_f32 v103, v105, v90
s_waitcnt vmcnt(12)
v_lshlrev_b32 v104, 16, v60
v_and_b32 v105, 0xffff0000, v60
v_fmac_f32 v96, v104, v91
v_fmac_f32 v97, v105, v91
v_lshlrev_b32 v104, 16, v61
v_and_b32 v105, 0xffff0000, v61
v_fmac_f32 v98, v104, v91
v_fmac_f32 v99, v105, v91
v_lshlrev_b32 v104, 16, v62
v_and_b32 v105, 0xffff0000, v62
v_fmac_f32 v100, v104, v91
v_fmac_f32 v101, v105, v91
v_lshlrev_b32 v104, 16, v63
v_and_b32 v105, 0xffff0000, v63
v_fmac_f32 v102, v104, v91
v_fmac_f32 v103, v105, v91
s_waitcnt vmcnt(11)
v_lshlrev_b32 v104, 16, v64
v_and_b32 v105, 0xffff0000, v64
v_fmac_f32 v96, v104, v92
v_fmac_f32 v97, v105, v92
v_lshlrev_b32 v104, 16, v65
v_and_b32 v105, 0xffff0000, v65
v_fmac_f32 v98, v104, v92
v_fmac_f32 v99, v105, v92
v_lshlrev_b32 v104, 16, v66
v_and_b32 v105, 0xffff0000, v66
v_fmac_f32 v100, v104, v92
v_fmac_f32 v101, v105, v92
v_lshlrev_b32 v104, 16, v67
v_and_b32 v105, 0xffff0000, v67
v_fmac_f32 v102, v104, v92
v_fmac_f32 v103, v105, v92
s_waitcnt vmcnt(10)
v_lshlrev_b32 v104, 16, v68
v_and_b32 v105, 0xffff0000, v68
v_fmac_f32 v96, v104, v93
v_fmac_f32 v97, v105, v93
v_lshlrev_b32 v104, 16, v69
v_and_b32 v105, 0xffff0000, v69
v_fmac_f32 v98, v104, v93
v_fmac_f32 v99, v105, v93
v_lshlrev_b32 v104, 16, v70
v_and_b32 v105, 0xffff0000, v70
v_fmac_f32 v100, v104, v93
v_fmac_f32 v101, v105, v93
v_lshlrev_b32 v104, 16, v71
v_and_b32 v105, 0xffff0000, v71
v_fmac_f32 v102, v104, v93
v_fmac_f32 v103, v105, v93
s_waitcnt vmcnt(9)
v_lshlrev_b32 v104, 16, v72
v_and_b32 v105, 0xffff0000, v72
v_fmac_f32 v96, v104, v94
v_fmac_f32 v97, v105, v94
v_lshlrev_b32 v104, 16, v73
v_and_b32 v105, 0xffff0000, v73
v_fmac_f32 v98, v104, v94
v_fmac_f32 v99, v105, v94
v_lshlrev_b32 v104, 16, v74
v_and_b32 v105, 0xffff0000, v74
v_fmac_f32 v100, v104, v94
v_fmac_f32 v101, v105, v94
v_lshlrev_b32 v104, 16, v75
v_and_b32 v105, 0xffff0000, v75
v_fmac_f32 v102, v104, v94
v_fmac_f32 v103, v105, v94
s_waitcnt vmcnt(8)
v_lshlrev_b32 v104, 16, v76
v_and_b32 v105, 0xffff0000, v76
v_fmac_f32 v96, v104, v95
v_fmac_f32 v97, v105, v95
v_lshlrev_b32 v104, 16, v77
v_and_b32 v105, 0xffff0000, v77
v_fmac_f32 v98, v104, v95
v_fmac_f32 v99, v105, v95
v_lshlrev_b32 v104, 16, v78
v_and_b32 v105, 0xffff0000, v78
v_fmac_f32 v100, v104, v95
v_fmac_f32 v101, v105, v95
v_lshlrev_b32 v104, 16, v79
v_and_b32 v105, 0xffff0000, v79
v_fmac_f32 v102, v104, v95
v_fmac_f32 v103, v105, v95
s_nop 1
v_add_f32_dpp v96, v96, v96 row_ror:8 row_mask:0xf bank_mask:0xf
v_add_f32_dpp v97, v97, v97 row_ror:8 row_mask:0xf bank_mask:0xf
v_add_f32_dpp v98, v98, v98 row_ror:8 row_mask:0xf bank_mask:0xf
v_add_f32_dpp v99, v99, v99 row_ror:8 row_mask:0xf bank_mask:0xf
v_add_f32_dpp v100, v100, v100 row_ror:8 row_mask:0xf bank_mask:0xf
v_add_f32_dpp v101, v101, v101 row_ror:8 row_mask:0xf bank_mask:0xf
v_add_f32_dpp v102, v102, v102 row_ror:8 row_mask:0xf bank_mask:0xf
v_add_f32_dpp v103, v103, v103 row_ror:8 row_mask:0xf bank_mask:0xf
v_mov_b32 v16, v96
v_mov_b32 v17, v97
v_mov_b32 v18, v98
v_mov_b32 v19, v99
v_mov_b32 v20, v100
v_mov_b32 v21, v101
v_mov_b32 v22, v102
v_mov_b32 v23, v103
v_permlane16_swap_b32 v96, v16
v_permlane16_swap_b32 v97, v17
v_permlane16_swap_b32 v98, v18
v_permlane16_swap_b32 v99, v19
v_permlane16_swap_b32 v100, v20
v_permlane16_swap_b32 v101, v21
v_permlane16_swap_b32 v102, v22
v_permlane16_swap_b32 v103, v23
v_add_f32 v96, v96, v16
v_add_f32 v97, v97, v17
v_add_f32 v98, v98, v18
v_add_f32 v99, v99, v19
v_add_f32 v100, v100, v20
v_add_f32 v101, v101, v21
v_add_f32 v102, v102, v22
v_add_f32 v103, v103, v23
v_mov_b32 v16, v96
v_mov_b32 v17, v97
v_mov_b32 v18, v98
v_mov_b32 v19, v99
v_mov_b32 v20, v100
v_mov_b32 v21, v101
v_mov_b32 v22, v102
v_mov_b32 v23, v103
v_permlane32_swap_b32 v96, v16
v_permlane32_swap_b32 v97, v17
v_permlane32_swap_b32 v98, v18
v_permlane32_swap_b32 v99, v19
v_permlane32_swap_b32 v100, v20
v_permlane32_swap_b32 v101, v21
v_permlane32_swap_b32 v102, v22
v_permlane32_swap_b32 v103, v23
v_add_f32 v96, v96, v16
v_add_f32 v97, v97, v17
v_add_f32 v98, v98, v18
v_add_f32 v99, v99, v19
v_add_f32 v100, v100, v20
v_add_f32 v101, v101, v21
v_add_f32 v102, v102, v22
v_add_f32 v103, v103, v23
s_lshl_b32 s40, s32, 8
v_lshl_add_u32 v2, v3, 5, s40
ds_write_b128 v2, v[96:99] offset:1024
ds_write_b128 v2, v[100:103] offset:1040
s_waitcnt lgkmcnt(0)
s_barrier
v_and_b32 v2, 63, v0
v_lshlrev_b32 v2, 2, v2
ds_read_b32 v96, v2 offset:1024
ds_read_b32 v97, v2 offset:1280
ds_read_b32 v98, v2 offset:1536
ds_read_b32 v99, v2 offset:1792
s_min_u32 s40, s32, 1
s_lshl_b32 s40, s40, 30
s_add_u32 s40, s40, s62
s_waitcnt lgkmcnt(0)
v_add_f32 v96, v96, v97
v_add_f32 v98, v98, v99
v_add_f32 v96, v96, v98
v_min_u32 v96, -2, v96
buffer_store_dword v96, v2, s[4:7], s40 offen sc1
Lst_627:
buffer_load_dword v14, off, s[12:15], 0 offset:144 sc1
buffer_load_dword v15, off, s[12:15], 0 offset:144 sc1
s_waitcnt vmcnt(0)
v_add_u32 v14, v14, v15
s_nop 0
v_readfirstlane_b32 s38, v14
s_nop 3
s_and_b32 s39, s38, 0xffff
s_cmp_eq_u32 s39, 0x100
s_cbranch_scc1 Lso_628
s_sub_u32 s37, s37, 1
s_cbranch_scc1 Lend_7
s_sleep 8
s_branch Lst_627
Lso_628:
s_bfe_u32 s35, s38, 0x80010
s_bfe_u32 s46, s38, 0x10018
s_lshl_b32 s46, s46, 13
s_barrier
s_add_u32 s52, s26, 0
v_accvgpr_read_b32 v16, a0
v_accvgpr_read_b32 v17, a1
v_accvgpr_read_b32 v18, a2
v_accvgpr_read_b32 v19, a3
v_accvgpr_read_b32 v20, a4
v_accvgpr_read_b32 v21, a5
v_accvgpr_read_b32 v22, a6
v_accvgpr_read_b32 v23, a7
v_accvgpr_read_b32 v24, a8
v_accvgpr_read_b32 v25, a9
v_accvgpr_read_b32 v26, a10
v_accvgpr_read_b32 v27, a11
v_accvgpr_read_b32 v28, a12
v_accvgpr_read_b32 v29, a13
v_accvgpr_read_b32 v30, a14
v_accvgpr_read_b32 v31, a15
v_accvgpr_read_b32 v32, a16
v_accvgpr_read_b32 v33, a17
v_accvgpr_read_b32 v34, a18
v_accvgpr_read_b32 v35, a19
v_accvgpr_read_b32 v36, a20
v_accvgpr_read_b32 v37, a21
v_accvgpr_read_b32 v38, a22
v_accvgpr_read_b32 v39, a23
v_accvgpr_read_b32 v40, a24
v_accvgpr_read_b32 v41, a25
v_accvgpr_read_b32 v42, a26
v_accvgpr_read_b32 v43, a27
v_accvgpr_read_b32 v44, a28
v_accvgpr_read_b32 v45, a29
v_accvgpr_read_b32 v46, a30
v_accvgpr_read_b32 v47, a31
s_lshr_b32 s40, s52, 1
s_lshl_b32 s40, s40, 2
s_add_u32 s40, s40, s32
s_lshl_b32 s40, s40, 14
s_and_b32 s41, s52, 1
s_lshl_b32 s41, s41, 10
s_add_u32 s40, s40, s41
v_lshlrev_b32 v48, 16, v16
v_and_b32 v49, 0xffff0000, v16
v_lshlrev_b32 v50, 16, v17
v_and_b32 v51, 0xffff0000, v17
v_lshlrev_b32 v52, 16, v18
v_and_b32 v53, 0xffff0000, v18
v_lshlrev_b32 v54, 16, v19
v_and_b32 v55, 0xffff0000, v19
v_lshlrev_b32 v56, 16, v20
v_and_b32 v57, 0xffff0000, v20
v_lshlrev_b32 v58, 16, v21
v_and_b32 v59, 0xffff0000, v21
v_lshlrev_b32 v60, 16, v22
v_and_b32 v61, 0xffff0000, v22
v_lshlrev_b32 v62, 16, v23
v_and_b32 v63, 0xffff0000, v23
v_lshlrev_b32 v64, 16, v24
v_and_b32 v65, 0xffff0000, v24
v_lshlrev_b32 v66, 16, v25
v_and_b32 v67, 0xffff0000, v25
v_lshlrev_b32 v68, 16, v26
v_and_b32 v69, 0xffff0000, v26
v_lshlrev_b32 v70, 16, v27
v_and_b32 v71, 0xffff0000, v27
v_lshlrev_b32 v72, 16, v28
v_and_b32 v73, 0xffff0000, v28
v_lshlrev_b32 v74, 16, v29
v_and_b32 v75, 0xffff0000, v29
v_lshlrev_b32 v76, 16, v30
v_and_b32 v77, 0xffff0000, v30
v_lshlrev_b32 v78, 16, v31
v_and_b32 v79, 0xffff0000, v31
v_lshlrev_b32 v80, 16, v32
v_and_b32 v81, 0xffff0000, v32
v_lshlrev_b32 v82, 16, v33
v_and_b32 v83, 0xffff0000, v33
v_lshlrev_b32 v84, 16, v34
v_and_b32 v85, 0xffff0000, v34
v_lshlrev_b32 v86, 16, v35
v_and_b32 v87, 0xffff0000, v35
v_lshlrev_b32 v88, 16, v36
v_and_b32 v89, 0xffff0000, v36
v_lshlrev_b32 v90, 16, v37
v_and_b32 v91, 0xffff0000, v37
v_lshlrev_b32 v92, 16, v38
v_and_b32 v93, 0xffff0000, v38
v_lshlrev_b32 v94, 16, v39
v_and_b32 v95, 0xffff0000, v39
v_lshlrev_b32 v96, 16, v40
v_and_b32 v97, 0xffff0000, v40
v_lshlrev_b32 v98, 16, v41
v_and_b32 v99, 0xffff0000, v41
v_lshlrev_b32 v100, 16, v42
v_and_b32 v101, 0xffff0000, v42
v_lshlrev_b32 v102, 16, v43
v_and_b32 v103, 0xffff0000, v43
v_lshlrev_b32 v104, 16, v44
v_and_b32 v105, 0xffff0000, v44
v_lshlrev_b32 v106, 16, v45
v_and_b32 v107, 0xffff0000, v45
v_lshlrev_b32 v108, 16, v46
v_and_b32 v109, 0xffff0000, v46
v_lshlrev_b32 v110, 16, v47
v_and_b32 v111, 0xffff0000, v47
v_pk_mul_f32 v[240:241], v[48:49], 1.0 op_sel_hi:[1,0]
v_pk_mul_f32 v[242:243], v[48:49], v[48:49]
v_pk_add_f32 v[240:241], v[240:241], v[50:51]
v_pk_fma_f32 v[242:243], v[50:51], v[50:51], v[242:243]
v_pk_add_f32 v[240:241], v[240:241], v[52:53]
v_pk_fma_f32 v[242:243], v[52:53], v[52:53], v[242:243]
v_pk_add_f32 v[240:241], v[240:241], v[54:55]
v_pk_fma_f32 v[242:243], v[54:55], v[54:55], v[242:243]
v_pk_add_f32 v[240:241], v[240:241], v[56:57]
v_pk_fma_f32 v[242:243], v[56:57], v[56:57], v[242:243]
v_pk_add_f32 v[240:241], v[240:241], v[58:59]
v_pk_fma_f32 v[242:243], v[58:59], v[58:59], v[242:243]
v_pk_add_f32 v[240:241], v[240:241], v[60:61]
v_pk_fma_f32 v[242:243], v[60:61], v[60:61], v[242:243]
v_pk_add_f32 v[240:241], v[240:241], v[62:63]
v_pk_fma_f32 v[242:243], v[62:63], v[62:63], v[242:243]
v_pk_add_f32 v[240:241], v[240:241], v[64:65]
v_pk_fma_f32 v[242:243], v[64:65], v[64:65], v[242:243]
v_pk_add_f32 v[240:241], v[240:241], v[66:67]
v_pk_fma_f32 v[242:243], v[66:67], v[66:67], v[242:243]
v_pk_add_f32 v[240:241], v[240:241], v[68:69]
v_pk_fma_f32 v[242:243], v[68:69], v[68:69], v[242:243]
v_pk_add_f32 v[240:241], v[240:241], v[70:71]
v_pk_fma_f32 v[242:243], v[70:71], v[70:71], v[242:243]
v_pk_add_f32 v[240:241], v[240:241], v[72:73]
v_pk_fma_f32 v[242:243], v[72:73], v[72:73], v[242:243]
v_pk_add_f32 v[240:241], v[240:241], v[74:75]
v_pk_fma_f32 v[242:243], v[74:75], v[74:75], v[242:243]
v_pk_add_f32 v[240:241], v[240:241], v[76:77]
v_pk_fma_f32 v[242:243], v[76:77], v[76:77], v[242:243]
v_pk_add_f32 v[240:241], v[240:241], v[78:79]
v_pk_fma_f32 v[242:243], v[78:79], v[78:79], v[242:243]
v_pk_add_f32 v[240:241], v[240:241], v[80:81]
v_pk_fma_f32 v[242:243], v[80:81], v[80:81], v[242:243]
v_pk_add_f32 v[240:241], v[240:241], v[82:83]
v_pk_fma_f32 v[242:243], v[82:83], v[82:83], v[242:243]
v_pk_add_f32 v[240:241], v[240:241], v[84:85]
v_pk_fma_f32 v[242:243], v[84:85], v[84:85], v[242:243]
v_pk_add_f32 v[240:241], v[240:241], v[86:87]
v_pk_fma_f32 v[242:243], v[86:87], v[86:87], v[242:243]
v_pk_add_f32 v[240:241], v[240:241], v[88:89]
v_pk_fma_f32 v[242:243], v[88:89], v[88:89], v[242:243]
v_pk_add_f32 v[240:241], v[240:241], v[90:91]
v_pk_fma_f32 v[242:243], v[90:91], v[90:91], v[242:243]
v_pk_add_f32 v[240:241], v[240:241], v[92:93]
v_pk_fma_f32 v[242:243], v[92:93], v[92:93], v[242:243]
v_pk_add_f32 v[240:241], v[240:241], v[94:95]
v_pk_fma_f32 v[242:243], v[94:95], v[94:95], v[242:243]
v_pk_add_f32 v[240:241], v[240:241], v[96:97]
v_pk_fma_f32 v[242:243], v[96:97], v[96:97], v[242:243]
v_pk_add_f32 v[240:241], v[240:241], v[98:99]
v_pk_fma_f32 v[242:243], v[98:99], v[98:99], v[242:243]
v_pk_add_f32 v[240:241], v[240:241], v[100:101]
v_pk_fma_f32 v[242:243], v[100:101], v[100:101], v[242:243]
v_pk_add_f32 v[240:241], v[240:241], v[102:103]
v_pk_fma_f32 v[242:243], v[102:103], v[102:103], v[242:243]
v_pk_add_f32 v[240:241], v[240:241], v[104:105]
v_pk_fma_f32 v[242:243], v[104:105], v[104:105], v[242:243]
v_pk_add_f32 v[240:241], v[240:241], v[106:107]
v_pk_fma_f32 v[242:243], v[106:107], v[106:107], v[242:243]
v_pk_add_f32 v[240:241], v[240:241], v[108:109]
v_pk_fma_f32 v[242:243], v[108:109], v[108:109], v[242:243]
v_pk_add_f32 v[240:241], v[240:241], v[110:111]
v_pk_fma_f32 v[242:243], v[110:111], v[110:111], v[242:243]
v_add_f32 v240, v240, v241
v_add_f32 v241, v242, v243
v_mov_b32 v242, v240
v_mov_b32 v243, v241
s_nop 1
v_permlane16_swap_b32 v240, v242
v_permlane16_swap_b32 v241, v243
v_add_f32 v240, v240, v242
v_add_f32 v241, v241, v243
v_mov_b32 v242, v240
v_mov_b32 v243, v241
s_nop 1
v_permlane32_swap_b32 v240, v242
v_permlane32_swap_b32 v241, v243
v_add_f32 v240, v240, v242
v_add_f32 v241, v241, v243
ds_write_b64 v11, v[240:241] offset:2048
s_waitcnt lgkmcnt(0)
s_barrier
ds_read_b128 v[240:243], v12 offset:2048
ds_read_b128 v[244:247], v12 offset:2064
v_xor_b32 v11, 512, v11
v_xor_b32 v12, 512, v12
s_mov_b32 s38, 0x3a800000
s_waitcnt lgkmcnt(0)
v_pk_add_f32 v[240:241], v[240:241], v[242:243]
v_pk_add_f32 v[244:245], v[244:245], v[246:247]
v_pk_add_f32 v[240:241], v[240:241], v[244:245]
v_pk_mul_f32 v[240:241], v[240:241], s[38:39] op_sel_hi:[1,0]
v_fma_f32 v241, -v240, v240, v241
v_max_f32 v241, 0, v241
v_add_f32 v241, 0x3727c5ac, v241
v_rsq_f32 v241, v241
s_nop 0
v_mul_f32 v240, -v240, v241
v_pk_fma_f32 v[48:49], v[48:49], v[240:241], v[240:241] op_sel:[0,1,0] op_sel_hi:[1,1,0]
v_pk_fma_f32 v[50:51], v[50:51], v[240:241], v[240:241] op_sel:[0,1,0] op_sel_hi:[1,1,0]
v_pk_fma_f32 v[52:53], v[52:53], v[240:241], v[240:241] op_sel:[0,1,0] op_sel_hi:[1,1,0]
v_pk_fma_f32 v[54:55], v[54:55], v[240:241], v[240:241] op_sel:[0,1,0] op_sel_hi:[1,1,0]
v_pk_fma_f32 v[56:57], v[56:57], v[240:241], v[240:241] op_sel:[0,1,0] op_sel_hi:[1,1,0]
v_pk_fma_f32 v[58:59], v[58:59], v[240:241], v[240:241] op_sel:[0,1,0] op_sel_hi:[1,1,0]
v_pk_fma_f32 v[60:61], v[60:61], v[240:241], v[240:241] op_sel:[0,1,0] op_sel_hi:[1,1,0]
v_pk_fma_f32 v[62:63], v[62:63], v[240:241], v[240:241] op_sel:[0,1,0] op_sel_hi:[1,1,0]
v_pk_fma_f32 v[64:65], v[64:65], v[240:241], v[240:241] op_sel:[0,1,0] op_sel_hi:[1,1,0]
v_pk_fma_f32 v[66:67], v[66:67], v[240:241], v[240:241] op_sel:[0,1,0] op_sel_hi:[1,1,0]
v_pk_fma_f32 v[68:69], v[68:69], v[240:241], v[240:241] op_sel:[0,1,0] op_sel_hi:[1,1,0]
v_pk_fma_f32 v[70:71], v[70:71], v[240:241], v[240:241] op_sel:[0,1,0] op_sel_hi:[1,1,0]
v_pk_fma_f32 v[72:73], v[72:73], v[240:241], v[240:241] op_sel:[0,1,0] op_sel_hi:[1,1,0]
v_pk_fma_f32 v[74:75], v[74:75], v[240:241], v[240:241] op_sel:[0,1,0] op_sel_hi:[1,1,0]
v_pk_fma_f32 v[76:77], v[76:77], v[240:241], v[240:241] op_sel:[0,1,0] op_sel_hi:[1,1,0]
v_pk_fma_f32 v[78:79], v[78:79], v[240:241], v[240:241] op_sel:[0,1,0] op_sel_hi:[1,1,0]
v_pk_fma_f32 v[80:81], v[80:81], v[240:241], v[240:241] op_sel:[0,1,0] op_sel_hi:[1,1,0]
v_pk_fma_f32 v[82:83], v[82:83], v[240:241], v[240:241] op_sel:[0,1,0] op_sel_hi:[1,1,0]
v_pk_fma_f32 v[84:85], v[84:85], v[240:241], v[240:241] op_sel:[0,1,0] op_sel_hi:[1,1,0]
v_pk_fma_f32 v[86:87], v[86:87], v[240:241], v[240:241] op_sel:[0,1,0] op_sel_hi:[1,1,0]
v_pk_fma_f32 v[88:89], v[88:89], v[240:241], v[240:241] op_sel:[0,1,0] op_sel_hi:[1,1,0]
v_pk_fma_f32 v[90:91], v[90:91], v[240:241], v[240:241] op_sel:[0,1,0] op_sel_hi:[1,1,0]
v_pk_fma_f32 v[92:93], v[92:93], v[240:241], v[240:241] op_sel:[0,1,0] op_sel_hi:[1,1,0]
v_pk_fma_f32 v[94:95], v[94:95], v[240:241], v[240:241] op_sel:[0,1,0] op_sel_hi:[1,1,0]
v_pk_fma_f32 v[96:97], v[96:97], v[240:241], v[240:241] op_sel:[0,1,0] op_sel_hi:[1,1,0]
v_pk_fma_f32 v[98:99], v[98:99], v[240:241], v[240:241] op_sel:[0,1,0] op_sel_hi:[1,1,0]
v_pk_fma_f32 v[100:101], v[100:101], v[240:241], v[240:241] op_sel:[0,1,0] op_sel_hi:[1,1,0]
v_pk_fma_f32 v[102:103], v[102:103], v[240:241], v[240:241] op_sel:[0,1,0] op_sel_hi:[1,1,0]
v_pk_fma_f32 v[104:105], v[104:105], v[240:241], v[240:241] op_sel:[0,1,0] op_sel_hi:[1,1,0]
v_pk_fma_f32 v[106:107], v[106:107], v[240:241], v[240:241] op_sel:[0,1,0] op_sel_hi:[1,1,0]
v_pk_fma_f32 v[108:109], v[108:109], v[240:241], v[240:241] op_sel:[0,1,0] op_sel_hi:[1,1,0]
v_pk_fma_f32 v[110:111], v[110:111], v[240:241], v[240:241] op_sel:[0,1,0] op_sel_hi:[1,1,0]
v_lshlrev_b32 v14, 5, v0
Lbw_629:
s_mov_b32 s42, 3178496
buffer_load_dwordx4 v[16:19], v14, s[4:7], s42 offen offset:0 sc1
buffer_load_dwordx4 v[20:23], v14, s[4:7], s42 offen offset:16 sc1
s_mov_b32 s42, 3186688
buffer_load_dwordx4 v[24:27], v14, s[4:7], s42 offen offset:0 sc1
buffer_load_dwordx4 v[28:31], v14, s[4:7], s42 offen offset:16 sc1
s_waitcnt vmcnt(0)
v_max3_u32 v15, v16, v17, v18
v_max3_u32 v15, v15, v19, v20
v_max3_u32 v15, v15, v21, v22
v_max3_u32 v15, v15, v23, v24
v_max3_u32 v15, v15, v25, v26
v_max3_u32 v15, v15, v27, v28
v_max3_u32 v15, v15, v29, v30
v_max_u32 v15, v15, v31
v_cmp_eq_u32 vcc, -1, v15
s_cbranch_vccz Lbo_630
s_sub_u32 s37, s37, 1
s_cbranch_scc1 Lend_7
s_sleep 4
s_branch Lbw_629
Lbo_630:
s_add_u32 s52, s26, 64
s_lshl_b32 s41, s52, 15
s_lshl_b32 s42, s32, 9
s_add_u32 s41, s41, s42
buffer_load_dwordx4 a[32:35], v6, s[88:91], s41 offen offset:0
buffer_load_dwordx4 a[36:39], v6, s[88:91], s41 offen offset:64
buffer_load_dwordx4 a[40:43], v6, s[88:91], s41 offen offset:128
buffer_load_dwordx4 a[44:47], v6, s[88:91], s41 offen offset:192
buffer_load_dwordx4 a[48:51], v6, s[88:91], s41 offen offset:256
buffer_load_dwordx4 a[52:55], v6, s[88:91], s41 offen offset:320
buffer_load_dwordx4 a[56:59], v6, s[88:91], s41 offen offset:384
buffer_load_dwordx4 a[60:63], v6, s[88:91], s41 offen offset:448
s_cmp_ge_u32 s32, 2
s_cselect_b32 s42, 1.0, 0
s_lshl_b32 s43, s32, 10
v_add_u32 v7, s43, v7
v_add_f32 v16, v16, v24
v_add_f32 v17, v17, v25
v_add_f32 v18, v18, v26
v_add_f32 v19, v19, v27
v_add_f32 v20, v20, v28
v_add_f32 v21, v21, v29
v_add_f32 v22, v22, v30
v_add_f32 v23, v23, v31
v_cvt_pk_bf16_f32 v16, 0, v16
v_cvt_pk_bf16_f32 v17, 0, v17
v_cvt_pk_bf16_f32 v18, 0, v18
v_cvt_pk_bf16_f32 v19, 0, v19
v_cvt_pk_bf16_f32 v20, 0, v20
v_cvt_pk_bf16_f32 v21, 0, v21
v_cvt_pk_bf16_f32 v22, 0, v22
v_cvt_pk_bf16_f32 v23, 0, v23
v_add_f32 v16, s42, v16
v_add_f32 v17, s42, v17
v_add_f32 v18, s42, v18
v_add_f32 v19, s42, v19
v_add_f32 v20, s42, v20
v_add_f32 v21, s42, v21
v_add_f32 v22, s42, v22
v_add_f32 v23, s42, v23
ds_write_b128 v14, v[16:19] offset:4096
ds_write_b128 v14, v[20:23] offset:4112
s_waitcnt lgkmcnt(0)
s_barrier
ds_read_b128 v[112:115], v7 offset:4096
ds_read_b128 v[176:179], v7 offset:8192
ds_read_b128 v[116:119], v7 offset:4112
ds_read_b128 v[180:183], v7 offset:8208
ds_read_b128 v[120:123], v7 offset:4224
ds_read_b128 v[184:187], v7 offset:8320
ds_read_b128 v[124:127], v7 offset:4240
ds_read_b128 v[188:191], v7 offset:8336
ds_read_b128 v[128:131], v7 offset:4352
ds_read_b128 v[192:195], v7 offset:8448
ds_read_b128 v[132:135], v7 offset:4368
ds_read_b128 v[196:199], v7 offset:8464
ds_read_b128 v[136:139], v7 offset:4480
ds_read_b128 v[200:203], v7 offset:8576
ds_read_b128 v[140:143], v7 offset:4496
ds_read_b128 v[204:207], v7 offset:8592
ds_read_b128 v[144:147], v7 offset:4608
ds_read_b128 v[208:211], v7 offset:8704
ds_read_b128 v[148:151], v7 offset:4624
ds_read_b128 v[212:215], v7 offset:8720
ds_read_b128 v[152:155], v7 offset:4736
ds_read_b128 v[216:219], v7 offset:8832
ds_read_b128 v[156:159], v7 offset:4752
ds_read_b128 v[220:223], v7 offset:8848
ds_read_b128 v[160:163], v7 offset:4864
ds_read_b128 v[224:227], v7 offset:8960
ds_read_b128 v[164:167], v7 offset:4880
ds_read_b128 v[228:231], v7 offset:8976
ds_read_b128 v[168:171], v7 offset:4992
ds_read_b128 v[232:235], v7 offset:9088
ds_read_b128 v[172:175], v7 offset:5008
ds_read_b128 v[236:239], v7 offset:9104
s_waitcnt lgkmcnt(0)
v_pk_fma_f32 v[48:49], v[48:49], v[176:177], v[112:113]
v_pk_fma_f32 v[50:51], v[50:51], v[178:179], v[114:115]
v_pk_fma_f32 v[52:53], v[52:53], v[180:181], v[116:117]
v_pk_fma_f32 v[54:55], v[54:55], v[182:183], v[118:119]
v_cvt_pk_bf16_f32 v16, v48, v49
v_cvt_pk_bf16_f32 v17, v50, v51
v_cvt_pk_bf16_f32 v18, v52, v53
v_cvt_pk_bf16_f32 v19, v54, v55
s_add_u32 s41, s40, 8388608
buffer_store_dwordx4 v[16:19], v13, s[4:7], s41 offen sc1
v_pk_fma_f32 v[56:57], v[56:57], v[184:185], v[120:121]
v_pk_fma_f32 v[58:59], v[58:59], v[186:187], v[122:123]
v_pk_fma_f32 v[60:61], v[60:61], v[188:189], v[124:125]
v_pk_fma_f32 v[62:63], v[62:63], v[190:191], v[126:127]
v_cvt_pk_bf16_f32 v20, v56, v57
v_cvt_pk_bf16_f32 v21, v58, v59
v_cvt_pk_bf16_f32 v22, v60, v61
v_cvt_pk_bf16_f32 v23, v62, v63
s_add_u32 s41, s40, 8390656
buffer_store_dwordx4 v[20:23], v13, s[4:7], s41 offen sc1
v_pk_fma_f32 v[64:65], v[64:65], v[192:193], v[128:129]
v_pk_fma_f32 v[66:67], v[66:67], v[194:195], v[130:131]
v_pk_fma_f32 v[68:69], v[68:69], v[196:197], v[132:133]
v_pk_fma_f32 v[70:71], v[70:71], v[198:199], v[134:135]
v_cvt_pk_bf16_f32 v24, v64, v65
v_cvt_pk_bf16_f32 v25, v66, v67
v_cvt_pk_bf16_f32 v26, v68, v69
v_cvt_pk_bf16_f32 v27, v70, v71
s_add_u32 s41, s40, 8392704
buffer_store_dwordx4 v[24:27], v13, s[4:7], s41 offen sc1
v_pk_fma_f32 v[72:73], v[72:73], v[200:201], v[136:137]
v_pk_fma_f32 v[74:75], v[74:75], v[202:203], v[138:139]
v_pk_fma_f32 v[76:77], v[76:77], v[204:205], v[140:141]
v_pk_fma_f32 v[78:79], v[78:79], v[206:207], v[142:143]
v_cvt_pk_bf16_f32 v28, v72, v73
v_cvt_pk_bf16_f32 v29, v74, v75
v_cvt_pk_bf16_f32 v30, v76, v77
v_cvt_pk_bf16_f32 v31, v78, v79
s_add_u32 s41, s40, 8394752
buffer_store_dwordx4 v[28:31], v13, s[4:7], s41 offen sc1
v_pk_fma_f32 v[80:81], v[80:81], v[208:209], v[144:145]
v_pk_fma_f32 v[82:83], v[82:83], v[210:211], v[146:147]
v_pk_fma_f32 v[84:85], v[84:85], v[212:213], v[148:149]
v_pk_fma_f32 v[86:87], v[86:87], v[214:215], v[150:151]
v_cvt_pk_bf16_f32 v32, v80, v81
v_cvt_pk_bf16_f32 v33, v82, v83
v_cvt_pk_bf16_f32 v34, v84, v85
v_cvt_pk_bf16_f32 v35, v86, v87
s_add_u32 s41, s40, 8396800
buffer_store_dwordx4 v[32:35], v13, s[4:7], s41 offen sc1
v_pk_fma_f32 v[88:89], v[88:89], v[216:217], v[152:153]
v_pk_fma_f32 v[90:91], v[90:91], v[218:219], v[154:155]
v_pk_fma_f32 v[92:93], v[92:93], v[220:221], v[156:157]
v_pk_fma_f32 v[94:95], v[94:95], v[222:223], v[158:159]
v_cvt_pk_bf16_f32 v36, v88, v89
v_cvt_pk_bf16_f32 v37, v90, v91
v_cvt_pk_bf16_f32 v38, v92, v93
v_cvt_pk_bf16_f32 v39, v94, v95
s_add_u32 s41, s40, 8398848
buffer_store_dwordx4 v[36:39], v13, s[4:7], s41 offen sc1
v_pk_fma_f32 v[96:97], v[96:97], v[224:225], v[160:161]
v_pk_fma_f32 v[98:99], v[98:99], v[226:227], v[162:163]
v_pk_fma_f32 v[100:101], v[100:101], v[228:229], v[164:165]
v_pk_fma_f32 v[102:103], v[102:103], v[230:231], v[166:167]
v_cvt_pk_bf16_f32 v40, v96, v97
v_cvt_pk_bf16_f32 v41, v98, v99
v_cvt_pk_bf16_f32 v42, v100, v101
v_cvt_pk_bf16_f32 v43, v102, v103
s_add_u32 s41, s40, 8400896
buffer_store_dwordx4 v[40:43], v13, s[4:7], s41 offen sc1
v_pk_fma_f32 v[104:105], v[104:105], v[232:233], v[168:169]
v_pk_fma_f32 v[106:107], v[106:107], v[234:235], v[170:171]
v_pk_fma_f32 v[108:109], v[108:109], v[236:237], v[172:173]
v_pk_fma_f32 v[110:111], v[110:111], v[238:239], v[174:175]
v_cvt_pk_bf16_f32 v44, v104, v105
v_cvt_pk_bf16_f32 v45, v106, v107
v_cvt_pk_bf16_f32 v46, v108, v109
v_cvt_pk_bf16_f32 v47, v110, v111
s_add_u32 s41, s40, 8402944
buffer_store_dwordx4 v[44:47], v13, s[4:7], s41 offen sc1
v_mov_b32 v14, 2
s_waitcnt vmcnt(0)
s_barrier
buffer_store_dword v14, v10, s[4:7], 0 offen sc1
s_add_u32 s52, s26, 64
v_accvgpr_read_b32 v16, a32
v_accvgpr_read_b32 v17, a33
v_accvgpr_read_b32 v18, a34
v_accvgpr_read_b32 v19, a35
v_accvgpr_read_b32 v20, a36
v_accvgpr_read_b32 v21, a37
v_accvgpr_read_b32 v22, a38
v_accvgpr_read_b32 v23, a39
v_accvgpr_read_b32 v24, a40
v_accvgpr_read_b32 v25, a41
v_accvgpr_read_b32 v26, a42
v_accvgpr_read_b32 v27, a43
v_accvgpr_read_b32 v28, a44
v_accvgpr_read_b32 v29, a45
v_accvgpr_read_b32 v30, a46
v_accvgpr_read_b32 v31, a47
v_accvgpr_read_b32 v32, a48
v_accvgpr_read_b32 v33, a49
v_accvgpr_read_b32 v34, a50
v_accvgpr_read_b32 v35, a51
v_accvgpr_read_b32 v36, a52
v_accvgpr_read_b32 v37, a53
v_accvgpr_read_b32 v38, a54
v_accvgpr_read_b32 v39, a55
v_accvgpr_read_b32 v40, a56
v_accvgpr_read_b32 v41, a57
v_accvgpr_read_b32 v42, a58
v_accvgpr_read_b32 v43, a59
v_accvgpr_read_b32 v44, a60
v_accvgpr_read_b32 v45, a61
v_accvgpr_read_b32 v46, a62
v_accvgpr_read_b32 v47, a63
s_lshr_b32 s40, s52, 1
s_lshl_b32 s40, s40, 2
s_add_u32 s40, s40, s32
s_lshl_b32 s40, s40, 14
s_and_b32 s41, s52, 1
s_lshl_b32 s41, s41, 10
s_add_u32 s40, s40, s41
v_lshlrev_b32 v48, 16, v16
v_and_b32 v49, 0xffff0000, v16
v_lshlrev_b32 v50, 16, v17
v_and_b32 v51, 0xffff0000, v17
v_lshlrev_b32 v52, 16, v18
v_and_b32 v53, 0xffff0000, v18
v_lshlrev_b32 v54, 16, v19
v_and_b32 v55, 0xffff0000, v19
v_lshlrev_b32 v56, 16, v20
v_and_b32 v57, 0xffff0000, v20
v_lshlrev_b32 v58, 16, v21
v_and_b32 v59, 0xffff0000, v21
v_lshlrev_b32 v60, 16, v22
v_and_b32 v61, 0xffff0000, v22
v_lshlrev_b32 v62, 16, v23
v_and_b32 v63, 0xffff0000, v23
v_lshlrev_b32 v64, 16, v24
v_and_b32 v65, 0xffff0000, v24
v_lshlrev_b32 v66, 16, v25
v_and_b32 v67, 0xffff0000, v25
v_lshlrev_b32 v68, 16, v26
v_and_b32 v69, 0xffff0000, v26
v_lshlrev_b32 v70, 16, v27
v_and_b32 v71, 0xffff0000, v27
v_lshlrev_b32 v72, 16, v28
v_and_b32 v73, 0xffff0000, v28
v_lshlrev_b32 v74, 16, v29
v_and_b32 v75, 0xffff0000, v29
v_lshlrev_b32 v76, 16, v30
v_and_b32 v77, 0xffff0000, v30
v_lshlrev_b32 v78, 16, v31
v_and_b32 v79, 0xffff0000, v31
v_lshlrev_b32 v80, 16, v32
v_and_b32 v81, 0xffff0000, v32
v_lshlrev_b32 v82, 16, v33
v_and_b32 v83, 0xffff0000, v33
v_lshlrev_b32 v84, 16, v34
v_and_b32 v85, 0xffff0000, v34
v_lshlrev_b32 v86, 16, v35
v_and_b32 v87, 0xffff0000, v35
v_lshlrev_b32 v88, 16, v36
v_and_b32 v89, 0xffff0000, v36
v_lshlrev_b32 v90, 16, v37
v_and_b32 v91, 0xffff0000, v37
v_lshlrev_b32 v92, 16, v38
v_and_b32 v93, 0xffff0000, v38
v_lshlrev_b32 v94, 16, v39
v_and_b32 v95, 0xffff0000, v39
v_lshlrev_b32 v96, 16, v40
v_and_b32 v97, 0xffff0000, v40
v_lshlrev_b32 v98, 16, v41
v_and_b32 v99, 0xffff0000, v41
v_lshlrev_b32 v100, 16, v42
v_and_b32 v101, 0xffff0000, v42
v_lshlrev_b32 v102, 16, v43
v_and_b32 v103, 0xffff0000, v43
v_lshlrev_b32 v104, 16, v44
v_and_b32 v105, 0xffff0000, v44
v_lshlrev_b32 v106, 16, v45
v_and_b32 v107, 0xffff0000, v45
v_lshlrev_b32 v108, 16, v46
v_and_b32 v109, 0xffff0000, v46
v_lshlrev_b32 v110, 16, v47
v_and_b32 v111, 0xffff0000, v47
v_pk_mul_f32 v[240:241], v[48:49], 1.0 op_sel_hi:[1,0]
v_pk_mul_f32 v[242:243], v[48:49], v[48:49]
v_pk_add_f32 v[240:241], v[240:241], v[50:51]
v_pk_fma_f32 v[242:243], v[50:51], v[50:51], v[242:243]
v_pk_add_f32 v[240:241], v[240:241], v[52:53]
v_pk_fma_f32 v[242:243], v[52:53], v[52:53], v[242:243]
v_pk_add_f32 v[240:241], v[240:241], v[54:55]
v_pk_fma_f32 v[242:243], v[54:55], v[54:55], v[242:243]
v_pk_add_f32 v[240:241], v[240:241], v[56:57]
v_pk_fma_f32 v[242:243], v[56:57], v[56:57], v[242:243]
v_pk_add_f32 v[240:241], v[240:241], v[58:59]
v_pk_fma_f32 v[242:243], v[58:59], v[58:59], v[242:243]
v_pk_add_f32 v[240:241], v[240:241], v[60:61]
v_pk_fma_f32 v[242:243], v[60:61], v[60:61], v[242:243]
v_pk_add_f32 v[240:241], v[240:241], v[62:63]
v_pk_fma_f32 v[242:243], v[62:63], v[62:63], v[242:243]
v_pk_add_f32 v[240:241], v[240:241], v[64:65]
v_pk_fma_f32 v[242:243], v[64:65], v[64:65], v[242:243]
v_pk_add_f32 v[240:241], v[240:241], v[66:67]
v_pk_fma_f32 v[242:243], v[66:67], v[66:67], v[242:243]
v_pk_add_f32 v[240:241], v[240:241], v[68:69]
v_pk_fma_f32 v[242:243], v[68:69], v[68:69], v[242:243]
v_pk_add_f32 v[240:241], v[240:241], v[70:71]
v_pk_fma_f32 v[242:243], v[70:71], v[70:71], v[242:243]
v_pk_add_f32 v[240:241], v[240:241], v[72:73]
v_pk_fma_f32 v[242:243], v[72:73], v[72:73], v[242:243]
v_pk_add_f32 v[240:241], v[240:241], v[74:75]
v_pk_fma_f32 v[242:243], v[74:75], v[74:75], v[242:243]
v_pk_add_f32 v[240:241], v[240:241], v[76:77]
v_pk_fma_f32 v[242:243], v[76:77], v[76:77], v[242:243]
v_pk_add_f32 v[240:241], v[240:241], v[78:79]
v_pk_fma_f32 v[242:243], v[78:79], v[78:79], v[242:243]
v_pk_add_f32 v[240:241], v[240:241], v[80:81]
v_pk_fma_f32 v[242:243], v[80:81], v[80:81], v[242:243]
v_pk_add_f32 v[240:241], v[240:241], v[82:83]
v_pk_fma_f32 v[242:243], v[82:83], v[82:83], v[242:243]
v_pk_add_f32 v[240:241], v[240:241], v[84:85]
v_pk_fma_f32 v[242:243], v[84:85], v[84:85], v[242:243]
v_pk_add_f32 v[240:241], v[240:241], v[86:87]
v_pk_fma_f32 v[242:243], v[86:87], v[86:87], v[242:243]
v_pk_add_f32 v[240:241], v[240:241], v[88:89]
v_pk_fma_f32 v[242:243], v[88:89], v[88:89], v[242:243]
v_pk_add_f32 v[240:241], v[240:241], v[90:91]
v_pk_fma_f32 v[242:243], v[90:91], v[90:91], v[242:243]
v_pk_add_f32 v[240:241], v[240:241], v[92:93]
v_pk_fma_f32 v[242:243], v[92:93], v[92:93], v[242:243]
v_pk_add_f32 v[240:241], v[240:241], v[94:95]
v_pk_fma_f32 v[242:243], v[94:95], v[94:95], v[242:243]
v_pk_add_f32 v[240:241], v[240:241], v[96:97]
v_pk_fma_f32 v[242:243], v[96:97], v[96:97], v[242:243]
v_pk_add_f32 v[240:241], v[240:241], v[98:99]
v_pk_fma_f32 v[242:243], v[98:99], v[98:99], v[242:243]
v_pk_add_f32 v[240:241], v[240:241], v[100:101]
v_pk_fma_f32 v[242:243], v[100:101], v[100:101], v[242:243]
v_pk_add_f32 v[240:241], v[240:241], v[102:103]
v_pk_fma_f32 v[242:243], v[102:103], v[102:103], v[242:243]
v_pk_add_f32 v[240:241], v[240:241], v[104:105]
v_pk_fma_f32 v[242:243], v[104:105], v[104:105], v[242:243]
v_pk_add_f32 v[240:241], v[240:241], v[106:107]
v_pk_fma_f32 v[242:243], v[106:107], v[106:107], v[242:243]
v_pk_add_f32 v[240:241], v[240:241], v[108:109]
v_pk_fma_f32 v[242:243], v[108:109], v[108:109], v[242:243]
v_pk_add_f32 v[240:241], v[240:241], v[110:111]
v_pk_fma_f32 v[242:243], v[110:111], v[110:111], v[242:243]
v_add_f32 v240, v240, v241
v_add_f32 v241, v242, v243
v_mov_b32 v242, v240
v_mov_b32 v243, v241
s_nop 1
v_permlane16_swap_b32 v240, v242
v_permlane16_swap_b32 v241, v243
v_add_f32 v240, v240, v242
v_add_f32 v241, v241, v243
v_mov_b32 v242, v240
v_mov_b32 v243, v241
s_nop 1
v_permlane32_swap_b32 v240, v242
v_permlane32_swap_b32 v241, v243
v_add_f32 v240, v240, v242
v_add_f32 v241, v241, v243
ds_write_b64 v11, v[240:241] offset:2048
s_waitcnt lgkmcnt(0)
s_barrier
ds_read_b128 v[240:243], v12 offset:2048
ds_read_b128 v[244:247], v12 offset:2064
v_xor_b32 v11, 512, v11
v_xor_b32 v12, 512, v12
s_mov_b32 s38, 0x3a800000
s_waitcnt lgkmcnt(0)
v_pk_add_f32 v[240:241], v[240:241], v[242:243]
v_pk_add_f32 v[244:245], v[244:245], v[246:247]
v_pk_add_f32 v[240:241], v[240:241], v[244:245]
v_pk_mul_f32 v[240:241], v[240:241], s[38:39] op_sel_hi:[1,0]
v_fma_f32 v241, -v240, v240, v241
v_max_f32 v241, 0, v241
v_add_f32 v241, 0x3727c5ac, v241
v_rsq_f32 v241, v241
s_nop 0
v_mul_f32 v240, -v240, v241
v_pk_fma_f32 v[48:49], v[48:49], v[240:241], v[240:241] op_sel:[0,1,0] op_sel_hi:[1,1,0]
v_pk_fma_f32 v[50:51], v[50:51], v[240:241], v[240:241] op_sel:[0,1,0] op_sel_hi:[1,1,0]
v_pk_fma_f32 v[52:53], v[52:53], v[240:241], v[240:241] op_sel:[0,1,0] op_sel_hi:[1,1,0]
v_pk_fma_f32 v[54:55], v[54:55], v[240:241], v[240:241] op_sel:[0,1,0] op_sel_hi:[1,1,0]
v_pk_fma_f32 v[56:57], v[56:57], v[240:241], v[240:241] op_sel:[0,1,0] op_sel_hi:[1,1,0]
v_pk_fma_f32 v[58:59], v[58:59], v[240:241], v[240:241] op_sel:[0,1,0] op_sel_hi:[1,1,0]
v_pk_fma_f32 v[60:61], v[60:61], v[240:241], v[240:241] op_sel:[0,1,0] op_sel_hi:[1,1,0]
v_pk_fma_f32 v[62:63], v[62:63], v[240:241], v[240:241] op_sel:[0,1,0] op_sel_hi:[1,1,0]
v_pk_fma_f32 v[64:65], v[64:65], v[240:241], v[240:241] op_sel:[0,1,0] op_sel_hi:[1,1,0]
v_pk_fma_f32 v[66:67], v[66:67], v[240:241], v[240:241] op_sel:[0,1,0] op_sel_hi:[1,1,0]
v_pk_fma_f32 v[68:69], v[68:69], v[240:241], v[240:241] op_sel:[0,1,0] op_sel_hi:[1,1,0]
v_pk_fma_f32 v[70:71], v[70:71], v[240:241], v[240:241] op_sel:[0,1,0] op_sel_hi:[1,1,0]
v_pk_fma_f32 v[72:73], v[72:73], v[240:241], v[240:241] op_sel:[0,1,0] op_sel_hi:[1,1,0]
v_pk_fma_f32 v[74:75], v[74:75], v[240:241], v[240:241] op_sel:[0,1,0] op_sel_hi:[1,1,0]
v_pk_fma_f32 v[76:77], v[76:77], v[240:241], v[240:241] op_sel:[0,1,0] op_sel_hi:[1,1,0]
v_pk_fma_f32 v[78:79], v[78:79], v[240:241], v[240:241] op_sel:[0,1,0] op_sel_hi:[1,1,0]
v_pk_fma_f32 v[80:81], v[80:81], v[240:241], v[240:241] op_sel:[0,1,0] op_sel_hi:[1,1,0]
v_pk_fma_f32 v[82:83], v[82:83], v[240:241], v[240:241] op_sel:[0,1,0] op_sel_hi:[1,1,0]
v_pk_fma_f32 v[84:85], v[84:85], v[240:241], v[240:241] op_sel:[0,1,0] op_sel_hi:[1,1,0]
v_pk_fma_f32 v[86:87], v[86:87], v[240:241], v[240:241] op_sel:[0,1,0] op_sel_hi:[1,1,0]
v_pk_fma_f32 v[88:89], v[88:89], v[240:241], v[240:241] op_sel:[0,1,0] op_sel_hi:[1,1,0]
v_pk_fma_f32 v[90:91], v[90:91], v[240:241], v[240:241] op_sel:[0,1,0] op_sel_hi:[1,1,0]
v_pk_fma_f32 v[92:93], v[92:93], v[240:241], v[240:241] op_sel:[0,1,0] op_sel_hi:[1,1,0]
v_pk_fma_f32 v[94:95], v[94:95], v[240:241], v[240:241] op_sel:[0,1,0] op_sel_hi:[1,1,0]
v_pk_fma_f32 v[96:97], v[96:97], v[240:241], v[240:241] op_sel:[0,1,0] op_sel_hi:[1,1,0]
v_pk_fma_f32 v[98:99], v[98:99], v[240:241], v[240:241] op_sel:[0,1,0] op_sel_hi:[1,1,0]
v_pk_fma_f32 v[100:101], v[100:101], v[240:241], v[240:241] op_sel:[0,1,0] op_sel_hi:[1,1,0]
v_pk_fma_f32 v[102:103], v[102:103], v[240:241], v[240:241] op_sel:[0,1,0] op_sel_hi:[1,1,0]
v_pk_fma_f32 v[104:105], v[104:105], v[240:241], v[240:241] op_sel:[0,1,0] op_sel_hi:[1,1,0]
v_pk_fma_f32 v[106:107], v[106:107], v[240:241], v[240:241] op_sel:[0,1,0] op_sel_hi:[1,1,0]
v_pk_fma_f32 v[108:109], v[108:109], v[240:241], v[240:241] op_sel:[0,1,0] op_sel_hi:[1,1,0]
v_pk_fma_f32 v[110:111], v[110:111], v[240:241], v[240:241] op_sel:[0,1,0] op_sel_hi:[1,1,0]
v_pk_fma_f32 v[48:49], v[48:49], v[176:177], v[112:113]
v_pk_fma_f32 v[50:51], v[50:51], v[178:179], v[114:115]
v_pk_fma_f32 v[52:53], v[52:53], v[180:181], v[116:117]
v_pk_fma_f32 v[54:55], v[54:55], v[182:183], v[118:119]
v_cvt_pk_bf16_f32 v16, v48, v49
v_cvt_pk_bf16_f32 v17, v50, v51
v_cvt_pk_bf16_f32 v18, v52, v53
v_cvt_pk_bf16_f32 v19, v54, v55
s_add_u32 s41, s40, 8388608
buffer_store_dwordx4 v[16:19], v13, s[4:7], s41 offen sc1
v_pk_fma_f32 v[56:57], v[56:57], v[184:185], v[120:121]
v_pk_fma_f32 v[58:59], v[58:59], v[186:187], v[122:123]
v_pk_fma_f32 v[60:61], v[60:61], v[188:189], v[124:125]
v_pk_fma_f32 v[62:63], v[62:63], v[190:191], v[126:127]
v_cvt_pk_bf16_f32 v20, v56, v57
v_cvt_pk_bf16_f32 v21, v58, v59
v_cvt_pk_bf16_f32 v22, v60, v61
v_cvt_pk_bf16_f32 v23, v62, v63
s_add_u32 s41, s40, 8390656
buffer_store_dwordx4 v[20:23], v13, s[4:7], s41 offen sc1
v_pk_fma_f32 v[64:65], v[64:65], v[192:193], v[128:129]
v_pk_fma_f32 v[66:67], v[66:67], v[194:195], v[130:131]
v_pk_fma_f32 v[68:69], v[68:69], v[196:197], v[132:133]
v_pk_fma_f32 v[70:71], v[70:71], v[198:199], v[134:135]
v_cvt_pk_bf16_f32 v24, v64, v65
v_cvt_pk_bf16_f32 v25, v66, v67
v_cvt_pk_bf16_f32 v26, v68, v69
v_cvt_pk_bf16_f32 v27, v70, v71
s_add_u32 s41, s40, 8392704
buffer_store_dwordx4 v[24:27], v13, s[4:7], s41 offen sc1
v_pk_fma_f32 v[72:73], v[72:73], v[200:201], v[136:137]
v_pk_fma_f32 v[74:75], v[74:75], v[202:203], v[138:139]
v_pk_fma_f32 v[76:77], v[76:77], v[204:205], v[140:141]
v_pk_fma_f32 v[78:79], v[78:79], v[206:207], v[142:143]
v_cvt_pk_bf16_f32 v28, v72, v73
v_cvt_pk_bf16_f32 v29, v74, v75
v_cvt_pk_bf16_f32 v30, v76, v77
v_cvt_pk_bf16_f32 v31, v78, v79
s_add_u32 s41, s40, 8394752
buffer_store_dwordx4 v[28:31], v13, s[4:7], s41 offen sc1
v_pk_fma_f32 v[80:81], v[80:81], v[208:209], v[144:145]
v_pk_fma_f32 v[82:83], v[82:83], v[210:211], v[146:147]
v_pk_fma_f32 v[84:85], v[84:85], v[212:213], v[148:149]
v_pk_fma_f32 v[86:87], v[86:87], v[214:215], v[150:151]
v_cvt_pk_bf16_f32 v32, v80, v81
v_cvt_pk_bf16_f32 v33, v82, v83
v_cvt_pk_bf16_f32 v34, v84, v85
v_cvt_pk_bf16_f32 v35, v86, v87
s_add_u32 s41, s40, 8396800
buffer_store_dwordx4 v[32:35], v13, s[4:7], s41 offen sc1
v_pk_fma_f32 v[88:89], v[88:89], v[216:217], v[152:153]
v_pk_fma_f32 v[90:91], v[90:91], v[218:219], v[154:155]
v_pk_fma_f32 v[92:93], v[92:93], v[220:221], v[156:157]
v_pk_fma_f32 v[94:95], v[94:95], v[222:223], v[158:159]
v_cvt_pk_bf16_f32 v36, v88, v89
v_cvt_pk_bf16_f32 v37, v90, v91
v_cvt_pk_bf16_f32 v38, v92, v93
v_cvt_pk_bf16_f32 v39, v94, v95
s_add_u32 s41, s40, 8398848
buffer_store_dwordx4 v[36:39], v13, s[4:7], s41 offen sc1
v_pk_fma_f32 v[96:97], v[96:97], v[224:225], v[160:161]
v_pk_fma_f32 v[98:99], v[98:99], v[226:227], v[162:163]
v_pk_fma_f32 v[100:101], v[100:101], v[228:229], v[164:165]
v_pk_fma_f32 v[102:103], v[102:103], v[230:231], v[166:167]
v_cvt_pk_bf16_f32 v40, v96, v97
v_cvt_pk_bf16_f32 v41, v98, v99
v_cvt_pk_bf16_f32 v42, v100, v101
v_cvt_pk_bf16_f32 v43, v102, v103
s_add_u32 s41, s40, 8400896
buffer_store_dwordx4 v[40:43], v13, s[4:7], s41 offen sc1
v_pk_fma_f32 v[104:105], v[104:105], v[232:233], v[168:169]
v_pk_fma_f32 v[106:107], v[106:107], v[234:235], v[170:171]
v_pk_fma_f32 v[108:109], v[108:109], v[236:237], v[172:173]
v_pk_fma_f32 v[110:111], v[110:111], v[238:239], v[174:175]
v_cvt_pk_bf16_f32 v44, v104, v105
v_cvt_pk_bf16_f32 v45, v106, v107
v_cvt_pk_bf16_f32 v46, v108, v109
v_cvt_pk_bf16_f32 v47, v110, v111
s_add_u32 s41, s40, 8402944
buffer_store_dwordx4 v[44:47], v13, s[4:7], s41 offen sc1
v_mov_b32 v14, 3
s_waitcnt vmcnt(0)
s_barrier
buffer_store_dword v14, v10, s[4:7], 0 offen sc1
v_mov_b32 v4, v8
v_mov_b32 v5, 0
s_cmp_ge_u32 s44, 56
s_cbranch_scc1 Lln_6
s_load_dwordx2 s[16:17], s[0:1], 64
s_load_dwordx2 s[18:19], s[0:1], 72
s_load_dwordx2 s[20:21], s[0:1], 80
s_waitcnt lgkmcnt(0)
s_mov_b32 s8, s16
s_and_b32 s9, s17, 0xffff
s_mov_b32 s10, 0x700000
s_mov_b32 s11, 0x20000
s_mov_b32 s84, s18
s_and_b32 s85, s19, 0xffff
s_mov_b32 s86, 0x700000
s_mov_b32 s87, 0x20000
s_mov_b32 s88, s20
s_and_b32 s89, s21, 0xffff
s_mov_b32 s90, 0x700000
s_mov_b32 s91, 0x20000
s_lshl_b32 s60, s44, 7
s_lshl_b32 s52, s32, 5
v_bfe_u32 v84, v9, 2, 2
v_lshrrev_b32 v85, 4, v9
v_lshl_add_u32 v84, v85, 3, v84
v_lshl_add_u32 v84, v84, 7, s52
v_and_b32 v85, 3, v9
v_lshl_add_u32 v84, v85, 3, v84
v_add_u32 v84, 0, v84
v_bfe_u32 v85, v9, 3, 2
v_lshlrev_b32 v85, 5, v85
v_xor_b32 v80, v84, v85
v_bfe_u32 v84, v9, 2, 2
v_lshrrev_b32 v85, 4, v9
v_lshl_add_u32 v84, v85, 3, v84
v_lshl_add_u32 v84, v84, 7, s52
v_and_b32 v85, 3, v9
v_lshl_add_u32 v84, v85, 3, v84
v_add_u32 v84, 16384, v84
v_bfe_u32 v85, v9, 3, 2
v_lshlrev_b32 v85, 5, v85
v_xor_b32 v81, v84, v85
v_lshrrev_b32 v84, 3, v9
s_mul_i32 s38, s32, 256
v_add_u32 v84, s38, v84
v_mul_u32_u24 v84, 7168, v84
v_and_b32 v85, 7, v9
v_lshl_add_u32 v84, v85, 4, v84
v_bfe_u32 v85, v9, 4, 1
v_lshlrev_b32 v85, 5, v85
v_xor_b32 v84, v84, v85
v_xor_b32 v85, 64, v84
s_lshl_b32 s38, s32, 12
s_barrier
s_add_u32 m0, s38, 0
s_add_u32 s39, s60, 0
buffer_load_dwordx4 v84, s[8:11], s39 offen lds
s_add_u32 m0, s38, 1024
s_add_u32 s39, s60, 57344
buffer_load_dwordx4 v85, s[8:11], s39 offen lds
s_add_u32 m0, s38, 2048
s_add_u32 s39, s60, 114688
buffer_load_dwordx4 v84, s[8:11], s39 offen lds
s_add_u32 m0, s38, 3072
s_add_u32 s39, s60, 172032
buffer_load_dwordx4 v85, s[8:11], s39 offen lds
s_add_u32 m0, s38, 16384
s_add_u32 s39, s60, 0
buffer_load_dwordx4 v84, s[84:87], s39 offen lds
s_add_u32 m0, s38, 17408
s_add_u32 s39, s60, 57344
buffer_load_dwordx4 v85, s[84:87], s39 offen lds
s_add_u32 m0, s38, 18432
s_add_u32 s39, s60, 114688
buffer_load_dwordx4 v84, s[84:87], s39 offen lds
s_add_u32 m0, s38, 19456
s_add_u32 s39, s60, 172032
buffer_load_dwordx4 v85, s[84:87], s39 offen lds
s_add_u32 m0, s38, 32768
s_add_u32 s39, s60, 229376
buffer_load_dwordx4 v84, s[8:11], s39 offen lds
s_add_u32 m0, s38, 33792
s_add_u32 s39, s60, 286720
buffer_load_dwordx4 v85, s[8:11], s39 offen lds
s_add_u32 m0, s38, 34816
s_add_u32 s39, s60, 344064
buffer_load_dwordx4 v84, s[8:11], s39 offen lds
s_add_u32 m0, s38, 35840
s_add_u32 s39, s60, 401408
buffer_load_dwordx4 v85, s[8:11], s39 offen lds
s_add_u32 m0, s38, 49152
s_add_u32 s39, s60, 229376
buffer_load_dwordx4 v84, s[84:87], s39 offen lds
s_add_u32 m0, s38, 50176
s_add_u32 s39, s60, 286720
buffer_load_dwordx4 v85, s[84:87], s39 offen lds
s_add_u32 m0, s38, 51200
s_add_u32 s39, s60, 344064
buffer_load_dwordx4 v84, s[84:87], s39 offen lds
s_add_u32 m0, s38, 52224
s_add_u32 s39, s60, 401408
buffer_load_dwordx4 v85, s[84:87], s39 offen lds
s_waitcnt vmcnt(8)
s_barrier
ds_read_b64_tr_b16 a[0:1], v80 offset:0
ds_read_b64_tr_b16 a[2:3], v80 offset:512
ds_read_b64_tr_b16 a[32:33], v80 offset:4096
ds_read_b64_tr_b16 a[34:35], v80 offset:4608
ds_read_b64_tr_b16 a[64:65], v80 offset:8192
ds_read_b64_tr_b16 a[66:67], v80 offset:8704
ds_read_b64_tr_b16 a[96:97], v80 offset:12288
ds_read_b64_tr_b16 a[98:99], v80 offset:12800
ds_read_b64_tr_b16 a[128:129], v81 offset:0
ds_read_b64_tr_b16 a[130:131], v81 offset:512
ds_read_b64_tr_b16 a[160:161], v81 offset:4096
ds_read_b64_tr_b16 a[162:163], v81 offset:4608
ds_read_b64_tr_b16 a[192:193], v81 offset:8192
ds_read_b64_tr_b16 a[194:195], v81 offset:8704
ds_read_b64_tr_b16 a[224:225], v81 offset:12288
ds_read_b64_tr_b16 a[226:227], v81 offset:12800
v_add_u32 v80, 32768, v80
v_add_u32 v81, 32768, v81
s_add_u32 m0, s38, 65536
s_add_u32 s39, s60, 458752
buffer_load_dwordx4 v84, s[8:11], s39 offen lds
s_add_u32 m0, s38, 66560
s_add_u32 s39, s60, 516096
buffer_load_dwordx4 v85, s[8:11], s39 offen lds
s_add_u32 m0, s38, 67584
s_add_u32 s39, s60, 573440
buffer_load_dwordx4 v84, s[8:11], s39 offen lds
s_add_u32 m0, s38, 68608
s_add_u32 s39, s60, 630784
buffer_load_dwordx4 v85, s[8:11], s39 offen lds
s_add_u32 m0, s38, 81920
s_add_u32 s39, s60, 458752
buffer_load_dwordx4 v84, s[84:87], s39 offen lds
s_add_u32 m0, s38, 82944
s_add_u32 s39, s60, 516096
buffer_load_dwordx4 v85, s[84:87], s39 offen lds
s_add_u32 m0, s38, 83968
s_add_u32 s39, s60, 573440
buffer_load_dwordx4 v84, s[84:87], s39 offen lds
s_add_u32 m0, s38, 84992
s_add_u32 s39, s60, 630784
buffer_load_dwordx4 v85, s[84:87], s39 offen lds
s_waitcnt lgkmcnt(0)
s_waitcnt vmcnt(8)
s_barrier
ds_read_b64_tr_b16 a[4:5], v80 offset:0
ds_read_b64_tr_b16 a[6:7], v80 offset:512
ds_read_b64_tr_b16 a[36:37], v80 offset:4096
ds_read_b64_tr_b16 a[38:39], v80 offset:4608
ds_read_b64_tr_b16 a[68:69], v80 offset:8192
ds_read_b64_tr_b16 a[70:71], v80 offset:8704
ds_read_b64_tr_b16 a[100:101], v80 offset:12288
ds_read_b64_tr_b16 a[102:103], v80 offset:12800
ds_read_b64_tr_b16 a[132:133], v81 offset:0
ds_read_b64_tr_b16 a[134:135], v81 offset:512
ds_read_b64_tr_b16 a[164:165], v81 offset:4096
ds_read_b64_tr_b16 a[166:167], v81 offset:4608
ds_read_b64_tr_b16 a[196:197], v81 offset:8192
ds_read_b64_tr_b16 a[198:199], v81 offset:8704
ds_read_b64_tr_b16 a[228:229], v81 offset:12288
ds_read_b64_tr_b16 a[230:231], v81 offset:12800
v_add_u32 v80, 32768, v80
v_add_u32 v81, 32768, v81
s_add_u32 m0, s38, 98304
s_add_u32 s39, s60, 688128
buffer_load_dwordx4 v84, s[8:11], s39 offen lds
s_add_u32 m0, s38, 99328
s_add_u32 s39, s60, 745472
buffer_load_dwordx4 v85, s[8:11], s39 offen lds
s_add_u32 m0, s38, 100352
s_add_u32 s39, s60, 802816
buffer_load_dwordx4 v84, s[8:11], s39 offen lds
s_add_u32 m0, s38, 101376
s_add_u32 s39, s60, 860160
buffer_load_dwordx4 v85, s[8:11], s39 offen lds
s_add_u32 m0, s38, 114688
s_add_u32 s39, s60, 688128
buffer_load_dwordx4 v84, s[84:87], s39 offen lds
s_add_u32 m0, s38, 115712
s_add_u32 s39, s60, 745472
buffer_load_dwordx4 v85, s[84:87], s39 offen lds
s_add_u32 m0, s38, 116736
s_add_u32 s39, s60, 802816
buffer_load_dwordx4 v84, s[84:87], s39 offen lds
s_add_u32 m0, s38, 117760
s_add_u32 s39, s60, 860160
buffer_load_dwordx4 v85, s[84:87], s39 offen lds
s_waitcnt lgkmcnt(0)
s_waitcnt vmcnt(8)
s_barrier
ds_read_b64_tr_b16 a[8:9], v80 offset:0
ds_read_b64_tr_b16 a[10:11], v80 offset:512
ds_read_b64_tr_b16 a[40:41], v80 offset:4096
ds_read_b64_tr_b16 a[42:43], v80 offset:4608
ds_read_b64_tr_b16 a[72:73], v80 offset:8192
ds_read_b64_tr_b16 a[74:75], v80 offset:8704
ds_read_b64_tr_b16 a[104:105], v80 offset:12288
ds_read_b64_tr_b16 a[106:107], v80 offset:12800
ds_read_b64_tr_b16 a[136:137], v81 offset:0
ds_read_b64_tr_b16 a[138:139], v81 offset:512
ds_read_b64_tr_b16 a[168:169], v81 offset:4096
ds_read_b64_tr_b16 a[170:171], v81 offset:4608
ds_read_b64_tr_b16 a[200:201], v81 offset:8192
ds_read_b64_tr_b16 a[202:203], v81 offset:8704
ds_read_b64_tr_b16 a[232:233], v81 offset:12288
ds_read_b64_tr_b16 a[234:235], v81 offset:12800
v_add_u32 v80, 32768, v80
v_add_u32 v81, 32768, v81
s_add_u32 m0, s38, 131072
s_add_u32 s39, s60, 917504
buffer_load_dwordx4 v84, s[8:11], s39 offen lds
s_add_u32 m0, s38, 132096
s_add_u32 s39, s60, 974848
buffer_load_dwordx4 v85, s[8:11], s39 offen lds
s_add_u32 m0, s38, 133120
s_add_u32 s39, s60, 1032192
buffer_load_dwordx4 v84, s[8:11], s39 offen lds
s_add_u32 m0, s38, 134144
s_add_u32 s39, s60, 1089536
buffer_load_dwordx4 v85, s[8:11], s39 offen lds
s_add_u32 m0, s38, 147456
s_add_u32 s39, s60, 917504
buffer_load_dwordx4 v84, s[84:87], s39 offen lds
s_add_u32 m0, s38, 148480
s_add_u32 s39, s60, 974848
buffer_load_dwordx4 v85, s[84:87], s39 offen lds
s_add_u32 m0, s38, 149504
s_add_u32 s39, s60, 1032192
buffer_load_dwordx4 v84, s[84:87], s39 offen lds
s_add_u32 m0, s38, 150528
s_add_u32 s39, s60, 1089536
buffer_load_dwordx4 v85, s[84:87], s39 offen lds
s_waitcnt lgkmcnt(0)
s_waitcnt vmcnt(8)
s_barrier
ds_read_b64_tr_b16 a[12:13], v80 offset:0
ds_read_b64_tr_b16 a[14:15], v80 offset:512
ds_read_b64_tr_b16 a[44:45], v80 offset:4096
ds_read_b64_tr_b16 a[46:47], v80 offset:4608
ds_read_b64_tr_b16 a[76:77], v80 offset:8192
ds_read_b64_tr_b16 a[78:79], v80 offset:8704
ds_read_b64_tr_b16 a[108:109], v80 offset:12288
ds_read_b64_tr_b16 a[110:111], v80 offset:12800
ds_read_b64_tr_b16 a[140:141], v81 offset:0
ds_read_b64_tr_b16 a[142:143], v81 offset:512
ds_read_b64_tr_b16 a[172:173], v81 offset:4096
ds_read_b64_tr_b16 a[174:175], v81 offset:4608
ds_read_b64_tr_b16 a[204:205], v81 offset:8192
ds_read_b64_tr_b16 a[206:207], v81 offset:8704
ds_read_b64_tr_b16 a[236:237], v81 offset:12288
ds_read_b64_tr_b16 a[238:239], v81 offset:12800
v_add_u32 v80, 32768, v80
v_add_u32 v81, 32768, v81
s_add_u32 m0, s38, 0
s_add_u32 s39, s60, 1146880
buffer_load_dwordx4 v84, s[8:11], s39 offen lds
s_add_u32 m0, s38, 1024
s_add_u32 s39, s60, 1204224
buffer_load_dwordx4 v85, s[8:11], s39 offen lds
s_add_u32 m0, s38, 2048
s_add_u32 s39, s60, 1261568
buffer_load_dwordx4 v84, s[8:11], s39 offen lds
s_add_u32 m0, s38, 3072
s_add_u32 s39, s60, 1318912
buffer_load_dwordx4 v85, s[8:11], s39 offen lds
s_add_u32 m0, s38, 16384
s_add_u32 s39, s60, 1146880
buffer_load_dwordx4 v84, s[84:87], s39 offen lds
s_add_u32 m0, s38, 17408
s_add_u32 s39, s60, 1204224
buffer_load_dwordx4 v85, s[84:87], s39 offen lds
s_add_u32 m0, s38, 18432
s_add_u32 s39, s60, 1261568
buffer_load_dwordx4 v84, s[84:87], s39 offen lds
s_add_u32 m0, s38, 19456
s_add_u32 s39, s60, 1318912
buffer_load_dwordx4 v85, s[84:87], s39 offen lds
s_waitcnt lgkmcnt(0)
s_waitcnt vmcnt(8)
s_barrier
ds_read_b64_tr_b16 a[16:17], v80 offset:0
ds_read_b64_tr_b16 a[18:19], v80 offset:512
ds_read_b64_tr_b16 a[48:49], v80 offset:4096
ds_read_b64_tr_b16 a[50:51], v80 offset:4608
ds_read_b64_tr_b16 a[80:81], v80 offset:8192
ds_read_b64_tr_b16 a[82:83], v80 offset:8704
ds_read_b64_tr_b16 a[112:113], v80 offset:12288
ds_read_b64_tr_b16 a[114:115], v80 offset:12800
ds_read_b64_tr_b16 a[144:145], v81 offset:0
ds_read_b64_tr_b16 a[146:147], v81 offset:512
ds_read_b64_tr_b16 a[176:177], v81 offset:4096
ds_read_b64_tr_b16 a[178:179], v81 offset:4608
ds_read_b64_tr_b16 a[208:209], v81 offset:8192
ds_read_b64_tr_b16 a[210:211], v81 offset:8704
ds_read_b64_tr_b16 a[240:241], v81 offset:12288
ds_read_b64_tr_b16 a[242:243], v81 offset:12800
v_add_u32 v80, -131072, v80
v_add_u32 v81, -131072, v81
s_add_u32 m0, s38, 32768
s_add_u32 s39, s60, 1376256
buffer_load_dwordx4 v84, s[8:11], s39 offen lds
s_add_u32 m0, s38, 33792
s_add_u32 s39, s60, 1433600
buffer_load_dwordx4 v85, s[8:11], s39 offen lds
s_add_u32 m0, s38, 34816
s_add_u32 s39, s60, 1490944
buffer_load_dwordx4 v84, s[8:11], s39 offen lds
s_add_u32 m0, s38, 35840
s_add_u32 s39, s60, 1548288
buffer_load_dwordx4 v85, s[8:11], s39 offen lds
s_add_u32 m0, s38, 49152
s_add_u32 s39, s60, 1376256
buffer_load_dwordx4 v84, s[84:87], s39 offen lds
s_add_u32 m0, s38, 50176
s_add_u32 s39, s60, 1433600
buffer_load_dwordx4 v85, s[84:87], s39 offen lds
s_add_u32 m0, s38, 51200
s_add_u32 s39, s60, 1490944
buffer_load_dwordx4 v84, s[84:87], s39 offen lds
s_add_u32 m0, s38, 52224
s_add_u32 s39, s60, 1548288
buffer_load_dwordx4 v85, s[84:87], s39 offen lds
s_waitcnt lgkmcnt(0)
s_waitcnt vmcnt(8)
s_barrier
ds_read_b64_tr_b16 a[20:21], v80 offset:0
ds_read_b64_tr_b16 a[22:23], v80 offset:512
ds_read_b64_tr_b16 a[52:53], v80 offset:4096
ds_read_b64_tr_b16 a[54:55], v80 offset:4608
ds_read_b64_tr_b16 a[84:85], v80 offset:8192
ds_read_b64_tr_b16 a[86:87], v80 offset:8704
ds_read_b64_tr_b16 a[116:117], v80 offset:12288
ds_read_b64_tr_b16 a[118:119], v80 offset:12800
ds_read_b64_tr_b16 a[148:149], v81 offset:0
ds_read_b64_tr_b16 a[150:151], v81 offset:512
ds_read_b64_tr_b16 a[180:181], v81 offset:4096
ds_read_b64_tr_b16 a[182:183], v81 offset:4608
ds_read_b64_tr_b16 a[212:213], v81 offset:8192
ds_read_b64_tr_b16 a[214:215], v81 offset:8704
ds_read_b64_tr_b16 a[244:245], v81 offset:12288
ds_read_b64_tr_b16 a[246:247], v81 offset:12800
v_add_u32 v80, 32768, v80
v_add_u32 v81, 32768, v81
s_add_u32 m0, s38, 65536
s_add_u32 s39, s60, 1605632
buffer_load_dwordx4 v84, s[8:11], s39 offen lds
s_add_u32 m0, s38, 66560
s_add_u32 s39, s60, 1662976
buffer_load_dwordx4 v85, s[8:11], s39 offen lds
s_add_u32 m0, s38, 67584
s_add_u32 s39, s60, 1720320
buffer_load_dwordx4 v84, s[8:11], s39 offen lds
s_add_u32 m0, s38, 68608
s_add_u32 s39, s60, 1777664
buffer_load_dwordx4 v85, s[8:11], s39 offen lds
s_add_u32 m0, s38, 81920
s_add_u32 s39, s60, 1605632
buffer_load_dwordx4 v84, s[84:87], s39 offen lds
s_add_u32 m0, s38, 82944
s_add_u32 s39, s60, 1662976
buffer_load_dwordx4 v85, s[84:87], s39 offen lds
s_add_u32 m0, s38, 83968
s_add_u32 s39, s60, 1720320
buffer_load_dwordx4 v84, s[84:87], s39 offen lds
s_add_u32 m0, s38, 84992
s_add_u32 s39, s60, 1777664
buffer_load_dwordx4 v85, s[84:87], s39 offen lds
s_waitcnt lgkmcnt(0)
s_waitcnt vmcnt(8)
s_barrier
ds_read_b64_tr_b16 a[24:25], v80 offset:0
ds_read_b64_tr_b16 a[26:27], v80 offset:512
ds_read_b64_tr_b16 a[56:57], v80 offset:4096
ds_read_b64_tr_b16 a[58:59], v80 offset:4608
ds_read_b64_tr_b16 a[88:89], v80 offset:8192
ds_read_b64_tr_b16 a[90:91], v80 offset:8704
ds_read_b64_tr_b16 a[120:121], v80 offset:12288
ds_read_b64_tr_b16 a[122:123], v80 offset:12800
ds_read_b64_tr_b16 a[152:153], v81 offset:0
ds_read_b64_tr_b16 a[154:155], v81 offset:512
ds_read_b64_tr_b16 a[184:185], v81 offset:4096
ds_read_b64_tr_b16 a[186:187], v81 offset:4608
ds_read_b64_tr_b16 a[216:217], v81 offset:8192
ds_read_b64_tr_b16 a[218:219], v81 offset:8704
ds_read_b64_tr_b16 a[248:249], v81 offset:12288
ds_read_b64_tr_b16 a[250:251], v81 offset:12800
v_add_u32 v80, 32768, v80
v_add_u32 v81, 32768, v81
s_waitcnt lgkmcnt(0)
s_waitcnt vmcnt(0)
s_barrier
ds_read_b64_tr_b16 a[28:29], v80 offset:0
ds_read_b64_tr_b16 a[30:31], v80 offset:512
ds_read_b64_tr_b16 a[60:61], v80 offset:4096
ds_read_b64_tr_b16 a[62:63], v80 offset:4608
ds_read_b64_tr_b16 a[92:93], v80 offset:8192
ds_read_b64_tr_b16 a[94:95], v80 offset:8704
ds_read_b64_tr_b16 a[124:125], v80 offset:12288
ds_read_b64_tr_b16 a[126:127], v80 offset:12800
ds_read_b64_tr_b16 a[156:157], v81 offset:0
ds_read_b64_tr_b16 a[158:159], v81 offset:512
ds_read_b64_tr_b16 a[188:189], v81 offset:4096
ds_read_b64_tr_b16 a[190:191], v81 offset:4608
ds_read_b64_tr_b16 a[220:221], v81 offset:8192
ds_read_b64_tr_b16 a[222:223], v81 offset:8704
ds_read_b64_tr_b16 a[252:253], v81 offset:12288
ds_read_b64_tr_b16 a[254:255], v81 offset:12800
v_add_u32 v80, 32768, v80
v_add_u32 v81, 32768, v81
s_waitcnt lgkmcnt(0)
s_barrier
s_lshr_b32 s26, s44, 3
s_and_b32 s62, s44, 7
s_lshl_b32 s60, s26, 20
s_lshl_b32 s38, s62, 8
s_add_u32 s60, s60, s38
s_add_u32 s61, s60, 128
s_lshr_b32 s52, s32, 1
s_lshl_b32 s52, s52, 14
s_and_b32 s53, s32, 1
s_lshl_b32 s53, s53, 6
s_add_u32 s52, s52, s53
v_bfe_u32 v84, v9, 2, 2
v_lshrrev_b32 v85, 4, v9
v_lshl_add_u32 v84, v85, 3, v84
v_lshl_add_u32 v84, v84, 7, s52
v_and_b32 v85, 3, v9
v_lshl_add_u32 v84, v85, 4, v84
v_add_u32 v84, 0, v84
v_bfe_u32 v85, v9, 3, 2
v_lshlrev_b32 v85, 5, v85
v_xor_b32 v80, v84, v85
v_bfe_u32 v84, v9, 2, 2
v_lshrrev_b32 v85, 4, v9
v_lshl_add_u32 v84, v85, 3, v84
v_lshl_add_u32 v84, v84, 7, s52
v_and_b32 v85, 3, v9
v_lshl_add_u32 v84, v85, 4, v84
v_add_u32 v84, 8, v84
v_bfe_u32 v85, v9, 3, 2
v_lshlrev_b32 v85, 5, v85
v_xor_b32 v81, v84, v85
v_lshrrev_b32 v84, 3, v9
s_mul_i32 s38, s32, 128
v_add_u32 v84, s38, v84
v_mul_u32_u24 v84, 2048, v84
v_and_b32 v85, 7, v9
v_lshl_add_u32 v84, v85, 4, v84
v_bfe_u32 v85, v9, 4, 1
v_lshlrev_b32 v85, 5, v85
v_xor_b32 v84, v84, v85
v_xor_b32 v85, 64, v84
s_lshl_b32 s38, s32, 12
s_barrier
s_add_u32 m0, s38, 0
s_add_u32 s39, s60, 0
buffer_load_dwordx4 v84, s[88:91], s39 offen lds
s_add_u32 m0, s38, 1024
s_add_u32 s39, s60, 16384
buffer_load_dwordx4 v85, s[88:91], s39 offen lds
s_add_u32 m0, s38, 2048
s_add_u32 s39, s60, 32768
buffer_load_dwordx4 v84, s[88:91], s39 offen lds
s_add_u32 m0, s38, 3072
s_add_u32 s39, s60, 49152
buffer_load_dwordx4 v85, s[88:91], s39 offen lds
s_add_u32 m0, s38, 16384
s_add_u32 s39, s61, 0
buffer_load_dwordx4 v84, s[88:91], s39 offen lds
s_add_u32 m0, s38, 17408
s_add_u32 s39, s61, 16384
buffer_load_dwordx4 v85, s[88:91], s39 offen lds
s_add_u32 m0, s38, 18432
s_add_u32 s39, s61, 32768
buffer_load_dwordx4 v84, s[88:91], s39 offen lds
s_add_u32 m0, s38, 19456
s_add_u32 s39, s61, 49152
buffer_load_dwordx4 v85, s[88:91], s39 offen lds
s_add_u32 m0, s38, 32768
s_add_u32 s39, s60, 65536
buffer_load_dwordx4 v84, s[88:91], s39 offen lds
s_add_u32 m0, s38, 33792
s_add_u32 s39, s60, 81920
buffer_load_dwordx4 v85, s[88:91], s39 offen lds
s_add_u32 m0, s38, 34816
s_add_u32 s39, s60, 98304
buffer_load_dwordx4 v84, s[88:91], s39 offen lds
s_add_u32 m0, s38, 35840
s_add_u32 s39, s60, 114688
buffer_load_dwordx4 v85, s[88:91], s39 offen lds
s_add_u32 m0, s38, 49152
s_add_u32 s39, s61, 65536
buffer_load_dwordx4 v84, s[88:91], s39 offen lds
s_add_u32 m0, s38, 50176
s_add_u32 s39, s61, 81920
buffer_load_dwordx4 v85, s[88:91], s39 offen lds
s_add_u32 m0, s38, 51200
s_add_u32 s39, s61, 98304
buffer_load_dwordx4 v84, s[88:91], s39 offen lds
s_add_u32 m0, s38, 52224
s_add_u32 s39, s61, 114688
buffer_load_dwordx4 v85, s[88:91], s39 offen lds
s_waitcnt vmcnt(8)
s_barrier
ds_read_b64_tr_b16 v[128:129], v80 offset:0
ds_read_b64_tr_b16 v[130:131], v80 offset:512
ds_read_b64_tr_b16 v[144:145], v80 offset:4096
ds_read_b64_tr_b16 v[146:147], v80 offset:4608
ds_read_b64_tr_b16 v[160:161], v80 offset:8192
ds_read_b64_tr_b16 v[162:163], v80 offset:8704
ds_read_b64_tr_b16 v[176:177], v80 offset:12288
ds_read_b64_tr_b16 v[178:179], v80 offset:12800
ds_read_b64_tr_b16 v[192:193], v81 offset:0
ds_read_b64_tr_b16 v[194:195], v81 offset:512
ds_read_b64_tr_b16 v[208:209], v81 offset:4096
ds_read_b64_tr_b16 v[210:211], v81 offset:4608
ds_read_b64_tr_b16 v[224:225], v81 offset:8192
ds_read_b64_tr_b16 v[226:227], v81 offset:8704
ds_read_b64_tr_b16 v[240:241], v81 offset:12288
ds_read_b64_tr_b16 v[242:243], v81 offset:12800
v_add_u32 v80, 32768, v80
v_add_u32 v81, 32768, v81
s_add_u32 m0, s38, 65536
s_add_u32 s39, s60, 131072
buffer_load_dwordx4 v84, s[88:91], s39 offen lds
s_add_u32 m0, s38, 66560
s_add_u32 s39, s60, 147456
buffer_load_dwordx4 v85, s[88:91], s39 offen lds
s_add_u32 m0, s38, 67584
s_add_u32 s39, s60, 163840
buffer_load_dwordx4 v84, s[88:91], s39 offen lds
s_add_u32 m0, s38, 68608
s_add_u32 s39, s60, 180224
buffer_load_dwordx4 v85, s[88:91], s39 offen lds
s_add_u32 m0, s38, 81920
s_add_u32 s39, s61, 131072
buffer_load_dwordx4 v84, s[88:91], s39 offen lds
s_add_u32 m0, s38, 82944
s_add_u32 s39, s61, 147456
buffer_load_dwordx4 v85, s[88:91], s39 offen lds
s_add_u32 m0, s38, 83968
s_add_u32 s39, s61, 163840
buffer_load_dwordx4 v84, s[88:91], s39 offen lds
s_add_u32 m0, s38, 84992
s_add_u32 s39, s61, 180224
buffer_load_dwordx4 v85, s[88:91], s39 offen lds
s_waitcnt lgkmcnt(0)
s_waitcnt vmcnt(8)
s_barrier
ds_read_b64_tr_b16 v[132:133], v80 offset:0
ds_read_b64_tr_b16 v[134:135], v80 offset:512
ds_read_b64_tr_b16 v[148:149], v80 offset:4096
ds_read_b64_tr_b16 v[150:151], v80 offset:4608
ds_read_b64_tr_b16 v[164:165], v80 offset:8192
ds_read_b64_tr_b16 v[166:167], v80 offset:8704
ds_read_b64_tr_b16 v[180:181], v80 offset:12288
ds_read_b64_tr_b16 v[182:183], v80 offset:12800
ds_read_b64_tr_b16 v[196:197], v81 offset:0
ds_read_b64_tr_b16 v[198:199], v81 offset:512
ds_read_b64_tr_b16 v[212:213], v81 offset:4096
ds_read_b64_tr_b16 v[214:215], v81 offset:4608
ds_read_b64_tr_b16 v[228:229], v81 offset:8192
ds_read_b64_tr_b16 v[230:231], v81 offset:8704
ds_read_b64_tr_b16 v[244:245], v81 offset:12288
ds_read_b64_tr_b16 v[246:247], v81 offset:12800
v_add_u32 v80, 32768, v80
v_add_u32 v81, 32768, v81
s_add_u32 m0, s38, 98304
s_add_u32 s39, s60, 196608
buffer_load_dwordx4 v84, s[88:91], s39 offen lds
s_add_u32 m0, s38, 99328
s_add_u32 s39, s60, 212992
buffer_load_dwordx4 v85, s[88:91], s39 offen lds
s_add_u32 m0, s38, 100352
s_add_u32 s39, s60, 229376
buffer_load_dwordx4 v84, s[88:91], s39 offen lds
s_add_u32 m0, s38, 101376
s_add_u32 s39, s60, 245760
buffer_load_dwordx4 v85, s[88:91], s39 offen lds
s_add_u32 m0, s38, 114688
s_add_u32 s39, s61, 196608
buffer_load_dwordx4 v84, s[88:91], s39 offen lds
s_add_u32 m0, s38, 115712
s_add_u32 s39, s61, 212992
buffer_load_dwordx4 v85, s[88:91], s39 offen lds
s_add_u32 m0, s38, 116736
s_add_u32 s39, s61, 229376
buffer_load_dwordx4 v84, s[88:91], s39 offen lds
s_add_u32 m0, s38, 117760
s_add_u32 s39, s61, 245760
buffer_load_dwordx4 v85, s[88:91], s39 offen lds
s_waitcnt lgkmcnt(0)
s_waitcnt vmcnt(8)
s_barrier
ds_read_b64_tr_b16 v[136:137], v80 offset:0
ds_read_b64_tr_b16 v[138:139], v80 offset:512
ds_read_b64_tr_b16 v[152:153], v80 offset:4096
ds_read_b64_tr_b16 v[154:155], v80 offset:4608
ds_read_b64_tr_b16 v[168:169], v80 offset:8192
ds_read_b64_tr_b16 v[170:171], v80 offset:8704
ds_read_b64_tr_b16 v[184:185], v80 offset:12288
ds_read_b64_tr_b16 v[186:187], v80 offset:12800
ds_read_b64_tr_b16 v[200:201], v81 offset:0
ds_read_b64_tr_b16 v[202:203], v81 offset:512
ds_read_b64_tr_b16 v[216:217], v81 offset:4096
ds_read_b64_tr_b16 v[218:219], v81 offset:4608
ds_read_b64_tr_b16 v[232:233], v81 offset:8192
ds_read_b64_tr_b16 v[234:235], v81 offset:8704
ds_read_b64_tr_b16 v[248:249], v81 offset:12288
ds_read_b64_tr_b16 v[250:251], v81 offset:12800
v_add_u32 v80, 32768, v80
v_add_u32 v81, 32768, v81
s_waitcnt lgkmcnt(0)
s_waitcnt vmcnt(0)
s_barrier
ds_read_b64_tr_b16 v[140:141], v80 offset:0
ds_read_b64_tr_b16 v[142:143], v80 offset:512
ds_read_b64_tr_b16 v[156:157], v80 offset:4096
ds_read_b64_tr_b16 v[158:159], v80 offset:4608
ds_read_b64_tr_b16 v[172:173], v80 offset:8192
ds_read_b64_tr_b16 v[174:175], v80 offset:8704
ds_read_b64_tr_b16 v[188:189], v80 offset:12288
ds_read_b64_tr_b16 v[190:191], v80 offset:12800
ds_read_b64_tr_b16 v[204:205], v81 offset:0
ds_read_b64_tr_b16 v[206:207], v81 offset:512
ds_read_b64_tr_b16 v[220:221], v81 offset:4096
ds_read_b64_tr_b16 v[222:223], v81 offset:4608
ds_read_b64_tr_b16 v[236:237], v81 offset:8192
ds_read_b64_tr_b16 v[238:239], v81 offset:8704
ds_read_b64_tr_b16 v[252:253], v81 offset:12288
ds_read_b64_tr_b16 v[254:255], v81 offset:12800
v_add_u32 v80, 32768, v80
v_add_u32 v81, 32768, v81
s_waitcnt lgkmcnt(0)
s_barrier
s_mul_i32 s50, s32, 4096
v_lshlrev_b32 v1, 4, v9
v_add_u32 v0, s50, v1
s_mov_b32 s60, s50
v_add_u32 v11, 0x20000, v1
v_mov_b32 v7, v1
v_min_u32 v2, 3, v9
v_lshlrev_b32 v2, 7, v2
v_min_u32 v12, 7, v9
v_lshlrev_b32 v12, 7, v12
s_lshl_b32 s61, s26, 10
s_add_u32 s61, s61, 3416064
s_lshl_b32 s38, s44, 1
s_lshr_b32 s39, s32, 1
s_add_u32 s38, s38, s39
s_lshl_b32 s38, s38, 11
s_and_b32 s39, s32, 1
s_lshl_b32 s39, s39, 9
s_add_u32 s38, s38, s39
v_and_b32 v80, 15, v9
v_lshl_add_u32 v6, v80, 4, s38
v_bfe_u32 v80, v9, 4, 1
v_lshl_add_u32 v6, v80, 10, v6
v_lshrrev_b32 v80, 5, v9
v_lshl_add_u32 v6, v80, 8, v6
s_mov_b32 s49, 100663296
s_mov_b32 s54, 16777216
s_lshl_b32 s59, s26, 15
s_add_u32 s59, s59, 99975168
s_lshl_b32 s38, s62, 2
s_add_u32 s38, s38, s32
s_lshl_b32 s38, s38, 11
s_lshl_b32 s62, s26, 22
s_add_u32 s62, s62, s38
s_add_u32 s62, s62, 134021120
s_mov_b32 s64, 0xbfb8aa3b
v_mov_b32 v100, 0
v_mov_b32 v101, 0
v_mov_b32 v80, -1
v_mov_b32 v81, -1
v_mov_b32 v82, -1
v_mov_b32 v83, -1
s_add_u32 s38, s62, 4128768
buffer_store_dwordx4 v[80:83], v7, s[4:7], s38 offen offset:0 sc1
buffer_store_dwordx4 v[80:83], v7, s[4:7], s38 offen offset:1024 sc1
s_add_u32 s38, s62, 4194304
buffer_store_dwordx4 v[80:83], v7, s[4:7], s38 offen offset:0 sc1
buffer_store_dwordx4 v[80:83], v7, s[4:7], s38 offen offset:1024 sc1
s_add_u32 s38, s62, 4259840
buffer_store_dwordx4 v[80:83], v7, s[4:7], s38 offen offset:0 sc1
buffer_store_dwordx4 v[80:83], v7, s[4:7], s38 offen offset:1024 sc1
s_add_u32 s38, s62, 4325376
buffer_store_dwordx4 v[80:83], v7, s[4:7], s38 offen offset:0 sc1
buffer_store_dwordx4 v[80:83], v7, s[4:7], s38 offen offset:1024 sc1
s_mov_b32 s36, 0
s_add_u32 s48, s36, 0
s_and_b32 s47, s48, 1
s_lshl_b32 s47, s47, 9
s_add_u32 s47, s47, 3423232
s_add_u32 s48, s48, 1
Lfw_632:
Lbw_639:
buffer_load_dword v13, v12, s[4:7], s61 offen sc1
buffer_load_dword v3, v2, s[4:7], s47 offen sc1
s_waitcnt vmcnt(0)
v_cmp_gt_u32 vcc, s48, v3
s_cbranch_vccz Lbo_640
s_sub_u32 s37, s37, 1
s_cbranch_scc1 Lend_7
s_sleep 4
s_branch Lbw_639
Lbo_640:
s_add_u32 m0, s50, 0
s_add_u32 s39, s54, 0
buffer_load_dwordx4 v0, s[4:7], s39 offen offset:0 sc1 lds
buffer_load_dwordx4 v0, s[4:7], s39 offen offset:2048 sc1 lds
s_add_u32 m0, s50, 16384
s_add_u32 s39, s54, 16384
buffer_load_dwordx4 v0, s[4:7], s39 offen offset:0 sc1 lds
buffer_load_dwordx4 v0, s[4:7], s39 offen offset:2048 sc1 lds
s_add_u32 m0, s50, 32768
s_add_u32 s39, s54, 32768
buffer_load_dwordx4 v0, s[4:7], s39 offen offset:0 sc1 lds
buffer_load_dwordx4 v0, s[4:7], s39 offen offset:2048 sc1 lds
s_add_u32 m0, s50, 49152
s_add_u32 s39, s54, 49152
buffer_load_dwordx4 v0, s[4:7], s39 offen offset:0 sc1 lds
buffer_load_dwordx4 v0, s[4:7], s39 offen offset:2048 sc1 lds
s_add_u32 m0, s50, 0
s_add_u32 s39, s54, 0
buffer_load_dwordx4 v0, s[4:7], s39 offen offset:1024 sc1 lds
buffer_load_dwordx4 v0, s[4:7], s39 offen offset:3072 sc1 lds
s_add_u32 m0, s50, 16384
s_add_u32 s39, s54, 16384
buffer_load_dwordx4 v0, s[4:7], s39 offen offset:1024 sc1 lds
buffer_load_dwordx4 v0, s[4:7], s39 offen offset:3072 sc1 lds
s_add_u32 m0, s50, 32768
s_add_u32 s39, s54, 32768
buffer_load_dwordx4 v0, s[4:7], s39 offen offset:1024 sc1 lds
buffer_load_dwordx4 v0, s[4:7], s39 offen offset:3072 sc1 lds
s_add_u32 m0, s50, 49152
s_add_u32 s39, s54, 49152
buffer_load_dwordx4 v0, s[4:7], s39 offen offset:1024 sc1 lds
buffer_load_dwordx4 v0, s[4:7], s39 offen offset:3072 sc1 lds
s_waitcnt vmcnt(8)
Lfe_637:
s_mov_b32 s58, 0x70000000
s_barrier
ds_read_b128 v[16:19], v1 offset:0
ds_read_b128 v[20:23], v1 offset:2048
ds_read_b128 v[24:27], v1 offset:4096
ds_read_b128 v[28:31], v1 offset:6144
ds_read_b128 v[32:35], v1 offset:8192
ds_read_b128 v[36:39], v1 offset:10240
ds_read_b128 v[40:43], v1 offset:12288
Lfb_631:
s_waitcnt lgkmcnt(5)
v_mfma_f32_16x16x32_bf16 v[48:51], a[0:3], v[16:19], 0
s_sub_u32 s57, s36, 2
ds_read_b128 v[44:47], v1 offset:14336
s_max_i32 s57, s57, 0
v_mfma_f32_16x16x32_bf16 v[56:59], a[128:131], v[16:19], 0
v_cmp_gt_u32 vcc, s57, v13
v_mfma_f32_16x16x32_bf16 v[48:51], a[4:7], v[20:23], v[48:51]
ds_read_b128 v[16:19], v1 offset:16384
v_mfma_f32_16x16x32_bf16 v[56:59], a[132:135], v[20:23], v[56:59]
s_waitcnt lgkmcnt(5)
s_cmp_eq_u64 vcc, 0
s_cselect_b32 s56, 1, 0
v_mfma_f32_16x16x32_bf16 v[48:51], a[8:11], v[24:27], v[48:51]
s_cselect_b32 s55, s59, 0x70000000
ds_read_b128 v[20:23], v1 offset:18432
s_add_u32 s48, s36, 1
v_mfma_f32_16x16x32_bf16 v[56:59], a[136:139], v[24:27], v[56:59]
s_and_b32 s47, s48, 1
s_lshl_b32 s47, s47, 9
s_add_u32 s47, s47, 3423232
v_mfma_f32_16x16x32_bf16 v[48:51], a[12:15], v[28:31], v[48:51]
s_add_u32 s48, s48, 1
ds_read_b128 v[24:27], v1 offset:20480
buffer_load_dword v3, v2, s[4:7], s47 offen sc1
v_mfma_f32_16x16x32_bf16 v[56:59], a[140:143], v[28:31], v[56:59]
s_waitcnt lgkmcnt(5)
s_add_u32 s54, s54, 65536
s_xor_b32 s50, s50, 0x10000
v_mfma_f32_16x16x32_bf16 v[48:51], a[16:19], v[32:35], v[48:51]
s_add_u32 m0, s60, 131072
ds_read_b128 v[28:31], v1 offset:22528
s_add_u32 s39, s55, 0
v_mfma_f32_16x16x32_bf16 v[56:59], a[144:147], v[32:35], v[56:59]
buffer_load_dwordx4 v0, s[4:7], s39 offen offset:0 sc1 lds
v_mfma_f32_16x16x32_bf16 v[48:51], a[20:23], v[36:39], v[48:51]
ds_read_b128 v[32:35], v1 offset:24576
v_cvt_pk_bf16_f32 v80, v64, v65
v_mfma_f32_16x16x32_bf16 v[56:59], a[148:151], v[36:39], v[56:59]
s_waitcnt lgkmcnt(5)
v_cvt_pk_bf16_f32 v81, v66, v67
v_cvt_pk_bf16_f32 v82, v68, v69
v_mfma_f32_16x16x32_bf16 v[48:51], a[24:27], v[40:43], v[48:51]
ds_read_b128 v[36:39], v1 offset:26624
v_cvt_pk_bf16_f32 v83, v70, v71
v_mfma_f32_16x16x32_bf16 v[56:59], a[152:155], v[40:43], v[56:59]
v_cvt_pk_bf16_f32 v84, v72, v73
v_cvt_pk_bf16_f32 v85, v74, v75
v_mfma_f32_16x16x32_bf16 v[48:51], a[28:31], v[44:47], v[48:51]
ds_read_b128 v[40:43], v1 offset:28672
v_cvt_pk_bf16_f32 v86, v76, v77
v_mfma_f32_16x16x32_bf16 v[56:59], a[156:159], v[44:47], v[56:59]
s_waitcnt lgkmcnt(5)
v_cvt_pk_bf16_f32 v87, v78, v79
v_mfma_f32_16x16x32_bf16 v[48:51], a[32:35], v[16:19], v[48:51]
ds_read_b128 v[44:47], v1 offset:30720
v_mfma_f32_16x16x32_bf16 v[56:59], a[160:163], v[16:19], v[56:59]
buffer_load_dwordx4 v0, s[4:7], s39 offen offset:1024 sc1 lds
v_mfma_f32_16x16x32_bf16 v[48:51], a[36:39], v[20:23], v[48:51]
ds_read_b128 v[16:19], v1 offset:32768
v_mfma_f32_16x16x32_bf16 v[56:59], a[164:167], v[20:23], v[56:59]
s_waitcnt lgkmcnt(5)
v_mfma_f32_16x16x32_bf16 v[48:51], a[40:43], v[24:27], v[48:51]
ds_read_b128 v[20:23], v1 offset:34816
v_mfma_f32_16x16x32_bf16 v[56:59], a[168:171], v[24:27], v[56:59]
v_mfma_f32_16x16x32_bf16 v[48:51], a[44:47], v[28:31], v[48:51]
ds_read_b128 v[24:27], v1 offset:36864
v_mfma_f32_16x16x32_bf16 v[56:59], a[172:175], v[28:31], v[56:59]
s_waitcnt lgkmcnt(5)
v_mfma_f32_16x16x32_bf16 v[48:51], a[48:51], v[32:35], v[48:51]
ds_read_b128 v[28:31], v1 offset:38912
v_mfma_f32_16x16x32_bf16 v[56:59], a[176:179], v[32:35], v[56:59]
buffer_load_dwordx4 v0, s[4:7], s39 offen offset:2048 sc1 lds
v_mfma_f32_16x16x32_bf16 v[48:51], a[52:55], v[36:39], v[48:51]
ds_read_b128 v[32:35], v1 offset:40960
v_mfma_f32_16x16x32_bf16 v[56:59], a[180:183], v[36:39], v[56:59]
s_waitcnt lgkmcnt(5)
v_mfma_f32_16x16x32_bf16 v[48:51], a[56:59], v[40:43], v[48:51]
ds_read_b128 v[36:39], v1 offset:43008
v_mfma_f32_16x16x32_bf16 v[56:59], a[184:187], v[40:43], v[56:59]
v_mfma_f32_16x16x32_bf16 v[48:51], a[60:63], v[44:47], v[48:51]
ds_read_b128 v[40:43], v1 offset:45056
v_mfma_f32_16x16x32_bf16 v[56:59], a[188:191], v[44:47], v[56:59]
s_waitcnt lgkmcnt(5)
v_mfma_f32_16x16x32_bf16 v[48:51], a[64:67], v[16:19], v[48:51]
ds_read_b128 v[44:47], v1 offset:47104
v_mfma_f32_16x16x32_bf16 v[56:59], a[192:195], v[16:19], v[56:59]
buffer_load_dwordx4 v0, s[4:7], s39 offen offset:3072 sc1 lds
s_add_u32 m0, s60, 147456
v_mfma_f32_16x16x32_bf16 v[48:51], a[68:71], v[20:23], v[48:51]
s_add_u32 s39, s55, 16384
ds_read_b128 v[16:19], v1 offset:49152
v_mfma_f32_16x16x32_bf16 v[56:59], a[196:199], v[20:23], v[56:59]
s_waitcnt lgkmcnt(5)
v_mfma_f32_16x16x32_bf16 v[48:51], a[72:75], v[24:27], v[48:51]
ds_read_b128 v[20:23], v1 offset:51200
v_mfma_f32_16x16x32_bf16 v[56:59], a[200:203], v[24:27], v[56:59]
v_mfma_f32_16x16x32_bf16 v[48:51], a[76:79], v[28:31], v[48:51]
ds_read_b128 v[24:27], v1 offset:53248
v_mfma_f32_16x16x32_bf16 v[56:59], a[204:207], v[28:31], v[56:59]
s_waitcnt lgkmcnt(5)
v_mfma_f32_16x16x32_bf16 v[48:51], a[80:83], v[32:35], v[48:51]
ds_read_b128 v[28:31], v1 offset:55296
v_mfma_f32_16x16x32_bf16 v[56:59], a[208:211], v[32:35], v[56:59]
buffer_load_dwordx4 v0, s[4:7], s39 offen offset:0 sc1 lds
v_mfma_f32_16x16x32_bf16 v[48:51], a[84:87], v[36:39], v[48:51]
ds_read_b128 v[32:35], v1 offset:57344
v_mfma_f32_16x16x32_bf16 v[56:59], a[212:215], v[36:39], v[56:59]
s_waitcnt lgkmcnt(5)
v_mfma_f32_16x16x32_bf16 v[48:51], a[88:91], v[40:43], v[48:51]
ds_read_b128 v[36:39], v1 offset:59392
v_mfma_f32_16x16x32_bf16 v[56:59], a[216:219], v[40:43], v[56:59]
v_mfma_f32_16x16x32_bf16 v[48:51], a[92:95], v[44:47], v[48:51]
ds_read_b128 v[40:43], v1 offset:61440
v_mfma_f32_16x16x32_bf16 v[56:59], a[220:223], v[44:47], v[56:59]
s_waitcnt lgkmcnt(5)
v_mfma_f32_16x16x32_bf16 v[48:51], a[96:99], v[16:19], v[48:51]
ds_read_b128 v[44:47], v1 offset:63488
v_mfma_f32_16x16x32_bf16 v[56:59], a[224:227], v[16:19], v[56:59]
v_mfma_f32_16x16x32_bf16 v[48:51], a[100:103], v[20:23], v[48:51]
s_waitcnt vmcnt(6)
s_barrier
ds_read_b128 v[16:19], v1 offset:1024
v_mfma_f32_16x16x32_bf16 v[56:59], a[228:231], v[20:23], v[56:59]
s_waitcnt lgkmcnt(5)
v_min_u32 v100, s36, 64
s_sub_u32 s38, s36, 4
v_mfma_f32_16x16x32_bf16 v[48:51], a[104:107], v[24:27], v[48:51]
ds_read_b128 v[20:23], v1 offset:3072
v_max_i32 v101, s38, 0
v_mfma_f32_16x16x32_bf16 v[56:59], a[232:235], v[24:27], v[56:59]
buffer_store_dwordx2 v[100:101], v4, s[4:7], 0 offen sc1
v_mfma_f32_16x16x32_bf16 v[48:51], a[108:111], v[28:31], v[48:51]
ds_read_b128 v[24:27], v1 offset:5120
v_mfma_f32_16x16x32_bf16 v[56:59], a[236:239], v[28:31], v[56:59]
s_waitcnt lgkmcnt(5)
v_mfma_f32_16x16x32_bf16 v[48:51], a[112:115], v[32:35], v[48:51]
ds_read_b128 v[28:31], v1 offset:7168
buffer_load_dwordx4 v0, s[4:7], s39 offen offset:1024 sc1 lds
v_mfma_f32_16x16x32_bf16 v[56:59], a[240:243], v[32:35], v[56:59]
v_mfma_f32_16x16x32_bf16 v[48:51], a[116:119], v[36:39], v[48:51]
ds_read_b128 v[32:35], v1 offset:9216
v_mfma_f32_16x16x32_bf16 v[56:59], a[244:247], v[36:39], v[56:59]
s_waitcnt lgkmcnt(5)
v_mfma_f32_16x16x32_bf16 v[48:51], a[120:123], v[40:43], v[48:51]
s_waitcnt vmcnt(7)
ds_read_b128 v[36:39], v1 offset:11264
v_cmp_gt_u32 vcc, s48, v3
v_mfma_f32_16x16x32_bf16 v[56:59], a[248:251], v[40:43], v[56:59]
v_mfma_f32_16x16x32_bf16 v[48:51], a[124:127], v[44:47], v[48:51]
ds_read_b128 v[40:43], v1 offset:13312
buffer_load_dwordx4 v0, s[4:7], s39 offen offset:2048 sc1 lds
v_mfma_f32_16x16x32_bf16 v[56:59], a[252:255], v[44:47], v[56:59]
s_waitcnt lgkmcnt(5)
s_cmp_eq_u64 vcc, 0
s_cselect_b32 s46, 1, 0
v_mfma_f32_16x16x32_bf16 v[52:55], a[0:3], v[16:19], 0
s_cselect_b32 s45, s54, 0x70000000
ds_read_b128 v[44:47], v1 offset:15360
v_cmp_gt_u32 vcc, 62, v13
v_mfma_f32_16x16x32_bf16 v[60:63], a[128:131], v[16:19], 0
s_add_u32 s52, s59, 229376
v_mfma_f32_16x16x32_bf16 v[52:55], a[4:7], v[20:23], v[52:55]
ds_read_b128 v[16:19], v1 offset:17408
v_mfma_f32_16x16x32_bf16 v[60:63], a[132:135], v[20:23], v[60:63]
s_waitcnt lgkmcnt(5)
s_cmp_eq_u64 vcc, 0
s_cselect_b32 s52, s52, 0x70000000
v_mfma_f32_16x16x32_bf16 v[52:55], a[8:11], v[24:27], v[52:55]
ds_read_b128 v[20:23], v1 offset:19456
buffer_load_dwordx4 v0, s[4:7], s39 offen offset:3072 sc1 lds
v_mfma_f32_16x16x32_bf16 v[60:63], a[136:139], v[24:27], v[60:63]
s_cmp_eq_u32 s36, 63
s_cselect_b32 s45, s52, s45
v_mfma_f32_16x16x32_bf16 v[52:55], a[12:15], v[28:31], v[52:55]
s_add_u32 m0, s50, 0
ds_read_b128 v[24:27], v1 offset:21504
s_add_u32 s39, s45, 0
v_mfma_f32_16x16x32_bf16 v[60:63], a[140:143], v[28:31], v[60:63]
s_waitcnt lgkmcnt(5)
buffer_load_dwordx4 v0, s[4:7], s39 offen offset:0 sc1 lds
v_mfma_f32_16x16x32_bf16 v[52:55], a[16:19], v[32:35], v[52:55]
ds_read_b128 v[28:31], v1 offset:23552
v_mul_f32 v88, s64, v48
v_mfma_f32_16x16x32_bf16 v[60:63], a[144:147], v[32:35], v[60:63]
v_mul_f32 v89, s64, v49
v_mul_f32 v90, s64, v50
v_mfma_f32_16x16x32_bf16 v[52:55], a[20:23], v[36:39], v[52:55]
ds_read_b128 v[32:35], v1 offset:25600
v_mul_f32 v91, s64, v51
v_mfma_f32_16x16x32_bf16 v[60:63], a[148:151], v[36:39], v[60:63]
s_waitcnt lgkmcnt(5)
v_exp_f32 v88, v88
v_mfma_f32_16x16x32_bf16 v[52:55], a[24:27], v[40:43], v[52:55]
ds_read_b128 v[36:39], v1 offset:27648
v_mfma_f32_16x16x32_bf16 v[60:63], a[152:155], v[40:43], v[60:63]
v_exp_f32 v89, v89
v_mfma_f32_16x16x32_bf16 v[52:55], a[28:31], v[44:47], v[52:55]
ds_read_b128 v[40:43], v1 offset:29696
v_mfma_f32_16x16x32_bf16 v[60:63], a[156:159], v[44:47], v[60:63]
s_waitcnt lgkmcnt(5)
buffer_load_dwordx4 v0, s[4:7], s39 offen offset:2048 sc1 lds
s_add_u32 m0, s50, 16384
v_mfma_f32_16x16x32_bf16 v[52:55], a[32:35], v[16:19], v[52:55]
s_add_u32 s39, s45, 16384
ds_read_b128 v[44:47], v1 offset:31744
v_mfma_f32_16x16x32_bf16 v[60:63], a[160:163], v[16:19], v[60:63]
v_exp_f32 v90, v90
v_mfma_f32_16x16x32_bf16 v[52:55], a[36:39], v[20:23], v[52:55]
ds_read_b128 v[16:19], v1 offset:33792
v_mfma_f32_16x16x32_bf16 v[60:63], a[164:167], v[20:23], v[60:63]
s_waitcnt lgkmcnt(5)
v_exp_f32 v91, v91
v_mfma_f32_16x16x32_bf16 v[52:55], a[40:43], v[24:27], v[52:55]
ds_read_b128 v[20:23], v1 offset:35840
v_mul_f32 v104, v48, v56
v_mfma_f32_16x16x32_bf16 v[60:63], a[168:171], v[24:27], v[60:63]
v_mul_f32 v105, v49, v57
v_mul_f32 v106, v50, v58
v_mfma_f32_16x16x32_bf16 v[52:55], a[44:47], v[28:31], v[52:55]
ds_read_b128 v[24:27], v1 offset:37888
v_mul_f32 v107, v51, v59
v_mfma_f32_16x16x32_bf16 v[60:63], a[172:175], v[28:31], v[60:63]
s_waitcnt lgkmcnt(5)
buffer_load_dwordx4 v0, s[4:7], s39 offen offset:0 sc1 lds
v_add_f32 v88, 1.0, v88
v_mfma_f32_16x16x32_bf16 v[52:55], a[48:51], v[32:35], v[52:55]
ds_read_b128 v[28:31], v1 offset:39936
v_add_f32 v89, 1.0, v89
v_mfma_f32_16x16x32_bf16 v[60:63], a[176:179], v[32:35], v[60:63]
v_add_f32 v90, 1.0, v90
v_add_f32 v91, 1.0, v91
v_mfma_f32_16x16x32_bf16 v[52:55], a[52:55], v[36:39], v[52:55]
ds_read_b128 v[32:35], v1 offset:41984
v_mfma_f32_16x16x32_bf16 v[60:63], a[180:183], v[36:39], v[60:63]
s_waitcnt lgkmcnt(5)
v_rcp_f32 v88, v88
v_mfma_f32_16x16x32_bf16 v[52:55], a[56:59], v[40:43], v[52:55]
ds_read_b128 v[36:39], v1 offset:44032
v_mfma_f32_16x16x32_bf16 v[60:63], a[184:187], v[40:43], v[60:63]
v_rcp_f32 v89, v89
v_mfma_f32_16x16x32_bf16 v[52:55], a[60:63], v[44:47], v[52:55]
ds_read_b128 v[40:43], v1 offset:46080
v_mfma_f32_16x16x32_bf16 v[60:63], a[188:191], v[44:47], v[60:63]
s_waitcnt lgkmcnt(5)
buffer_load_dwordx4 v0, s[4:7], s39 offen offset:2048 sc1 lds
s_add_u32 m0, s50, 32768
v_mfma_f32_16x16x32_bf16 v[52:55], a[64:67], v[16:19], v[52:55]
s_add_u32 s39, s45, 32768
ds_read_b128 v[44:47], v1 offset:48128
v_mfma_f32_16x16x32_bf16 v[60:63], a[192:195], v[16:19], v[60:63]
v_rcp_f32 v90, v90
v_mfma_f32_16x16x32_bf16 v[52:55], a[68:71], v[20:23], v[52:55]
ds_read_b128 v[16:19], v1 offset:50176
v_mfma_f32_16x16x32_bf16 v[60:63], a[196:199], v[20:23], v[60:63]
s_waitcnt lgkmcnt(5)
v_rcp_f32 v91, v91
v_mfma_f32_16x16x32_bf16 v[52:55], a[72:75], v[24:27], v[52:55]
ds_read_b128 v[20:23], v1 offset:52224
v_mul_f32 v104, v104, v88
v_mfma_f32_16x16x32_bf16 v[60:63], a[200:203], v[24:27], v[60:63]
v_mul_f32 v105, v105, v89
v_mul_f32 v106, v106, v90
v_mfma_f32_16x16x32_bf16 v[52:55], a[76:79], v[28:31], v[52:55]
ds_read_b128 v[24:27], v1 offset:54272
v_mul_f32 v107, v107, v91
v_mfma_f32_16x16x32_bf16 v[60:63], a[204:207], v[28:31], v[60:63]
s_waitcnt lgkmcnt(5)
buffer_load_dwordx4 v0, s[4:7], s39 offen offset:0 sc1 lds
v_mfma_f32_16x16x32_bf16 v[52:55], a[80:83], v[32:35], v[52:55]
ds_read_b128 v[28:31], v1 offset:56320
v_mfma_f32_16x16x32_bf16 v[60:63], a[208:211], v[32:35], v[60:63]
v_mfma_f32_16x16x32_bf16 v[52:55], a[84:87], v[36:39], v[52:55]
ds_read_b128 v[32:35], v1 offset:58368
v_mfma_f32_16x16x32_bf16 v[60:63], a[212:215], v[36:39], v[60:63]
s_waitcnt lgkmcnt(5)
v_mfma_f32_16x16x32_bf16 v[52:55], a[88:91], v[40:43], v[52:55]
ds_read_b128 v[36:39], v1 offset:60416
v_mfma_f32_16x16x32_bf16 v[60:63], a[216:219], v[40:43], v[60:63]
v_mfma_f32_16x16x32_bf16 v[52:55], a[92:95], v[44:47], v[52:55]
ds_read_b128 v[40:43], v1 offset:62464
v_mfma_f32_16x16x32_bf16 v[60:63], a[220:223], v[44:47], v[60:63]
s_waitcnt lgkmcnt(5)
buffer_load_dwordx4 v0, s[4:7], s39 offen offset:2048 sc1 lds
v_mfma_f32_16x16x32_bf16 v[52:55], a[96:99], v[16:19], v[52:55]
ds_read_b128 v[44:47], v1 offset:64512
v_mfma_f32_16x16x32_bf16 v[60:63], a[224:227], v[16:19], v[60:63]
v_mfma_f32_16x16x32_bf16 v[52:55], a[100:103], v[20:23], v[52:55]
v_mfma_f32_16x16x32_bf16 v[60:63], a[228:231], v[20:23], v[60:63]
s_waitcnt lgkmcnt(4)
v_mfma_f32_16x16x32_bf16 v[52:55], a[104:107], v[24:27], v[52:55]
v_mfma_f32_16x16x32_bf16 v[60:63], a[232:235], v[24:27], v[60:63]
s_cmp_eq_u32 s56, 0
s_cbranch_scc1 Lfl_633
s_waitcnt vmcnt(6) lgkmcnt(0)
Lfg_634:
s_barrier
v_mfma_f32_16x16x32_bf16 v[52:55], a[108:111], v[28:31], v[52:55]
ds_read_b128 v[16:19], v11 offset:0
ds_read_b128 v[20:23], v11 offset:1024
v_mfma_f32_16x16x32_bf16 v[60:63], a[236:239], v[28:31], v[60:63]
s_add_u32 m0, s50, 49152
ds_read_b128 v[24:27], v11 offset:2048
s_add_u32 s39, s45, 49152
v_mfma_f32_16x16x32_bf16 v[52:55], a[112:115], v[32:35], v[52:55]
ds_read_b128 v[28:31], v11 offset:3072
buffer_load_dwordx4 v0, s[4:7], s39 offen offset:0 sc1 lds
v_mfma_f32_16x16x32_bf16 v[60:63], a[240:243], v[32:35], v[60:63]
v_mfma_f32_16x16x32_bf16 v[52:55], a[116:119], v[36:39], v[52:55]
ds_read_b128 v[32:35], v11 offset:4096
buffer_load_dword v3, v2, s[4:7], s47 offen sc1
v_mfma_f32_16x16x32_bf16 v[60:63], a[244:247], v[36:39], v[60:63]
buffer_load_dword v13, v12, s[4:7], s61 offen sc1
v_mfma_f32_16x16x32_bf16 v[52:55], a[120:123], v[40:43], v[52:55]
ds_read_b128 v[36:39], v11 offset:5120
v_xor_b32 v1, 0x10000, v1
v_mfma_f32_16x16x32_bf16 v[60:63], a[248:251], v[40:43], v[60:63]
v_mfma_f32_16x16x32_bf16 v[52:55], a[124:127], v[44:47], v[52:55]
ds_read_b128 v[40:43], v11 offset:6144
buffer_load_dwordx4 v0, s[4:7], s39 offen offset:2048 sc1 lds
v_mfma_f32_16x16x32_bf16 v[60:63], a[252:255], v[44:47], v[60:63]
s_waitcnt lgkmcnt(5)
v_mfma_f32_16x16x32_bf16 v[64:67], v[128:131], v[16:19], 0
s_add_u32 m0, s50, 0
ds_read_b128 v[44:47], v11 offset:7168
s_add_u32 s39, s45, 0
v_mfma_f32_16x16x32_bf16 v[68:71], v[192:195], v[16:19], 0
buffer_load_dwordx4 v0, s[4:7], s39 offen offset:1024 sc1 lds
v_mfma_f32_16x16x32_bf16 v[72:75], v[128:131], v[20:23], 0
ds_read_b128 v[16:19], v11 offset:8192
v_mfma_f32_16x16x32_bf16 v[76:79], v[192:195], v[20:23], 0
s_waitcnt lgkmcnt(5)
buffer_store_dwordx4 v[80:83], v7, s[4:7], s58 offen offset:0 sc1
v_mfma_f32_16x16x32_bf16 v[64:67], v[132:135], v[24:27], v[64:67]
ds_read_b128 v[20:23], v11 offset:9216
v_mfma_f32_16x16x32_bf16 v[68:71], v[196:199], v[24:27], v[68:71]
v_mfma_f32_16x16x32_bf16 v[72:75], v[132:135], v[28:31], v[72:75]
ds_read_b128 v[24:27], v11 offset:10240
v_mfma_f32_16x16x32_bf16 v[76:79], v[196:199], v[28:31], v[76:79]
s_waitcnt lgkmcnt(5)
buffer_store_dwordx4 v[84:87], v7, s[4:7], s58 offen offset:1024 sc1
v_mfma_f32_16x16x32_bf16 v[64:67], v[136:139], v[32:35], v[64:67]
ds_read_b128 v[28:31], v11 offset:11264
v_mul_f32 v88, s64, v52
v_mfma_f32_16x16x32_bf16 v[68:71], v[200:203], v[32:35], v[68:71]
buffer_load_dwordx4 v0, s[4:7], s39 offen offset:3072 sc1 lds
s_add_u32 m0, s50, 16384
v_mfma_f32_16x16x32_bf16 v[72:75], v[136:139], v[36:39], v[72:75]
s_add_u32 s39, s45, 16384
ds_read_b128 v[32:35], v11 offset:12288
v_mul_f32 v89, s64, v53
v_mfma_f32_16x16x32_bf16 v[76:79], v[200:203], v[36:39], v[76:79]
s_waitcnt lgkmcnt(5)
v_mul_f32 v90, s64, v54
v_mul_f32 v91, s64, v55
v_mfma_f32_16x16x32_bf16 v[64:67], v[140:143], v[40:43], v[64:67]
ds_read_b128 v[36:39], v11 offset:13312
v_mfma_f32_16x16x32_bf16 v[68:71], v[204:207], v[40:43], v[68:71]
v_exp_f32 v88, v88
v_mfma_f32_16x16x32_bf16 v[72:75], v[140:143], v[44:47], v[72:75]
ds_read_b128 v[40:43], v11 offset:14336
v_mfma_f32_16x16x32_bf16 v[76:79], v[204:207], v[44:47], v[76:79]
s_waitcnt lgkmcnt(5)
v_exp_f32 v89, v89
v_mfma_f32_16x16x32_bf16 v[64:67], v[144:147], v[16:19], v[64:67]
ds_read_b128 v[44:47], v11 offset:15360
v_mfma_f32_16x16x32_bf16 v[68:71], v[208:211], v[16:19], v[68:71]
buffer_load_dwordx4 v0, s[4:7], s39 offen offset:1024 sc1 lds
v_mfma_f32_16x16x32_bf16 v[72:75], v[144:147], v[20:23], v[72:75]
ds_read_b128 v[16:19], v11 offset:16384
v_mfma_f32_16x16x32_bf16 v[76:79], v[208:211], v[20:23], v[76:79]
s_waitcnt lgkmcnt(5)
v_exp_f32 v90, v90
v_mfma_f32_16x16x32_bf16 v[64:67], v[148:151], v[24:27], v[64:67]
ds_read_b128 v[20:23], v11 offset:17408
v_mfma_f32_16x16x32_bf16 v[68:71], v[212:215], v[24:27], v[68:71]
v_exp_f32 v91, v91
v_mfma_f32_16x16x32_bf16 v[72:75], v[148:151], v[28:31], v[72:75]
ds_read_b128 v[24:27], v11 offset:18432
v_mul_f32 v108, v52, v60
v_mfma_f32_16x16x32_bf16 v[76:79], v[212:215], v[28:31], v[76:79]
s_waitcnt lgkmcnt(5)
v_mul_f32 v109, v53, v61
v_mul_f32 v110, v54, v62
v_mfma_f32_16x16x32_bf16 v[64:67], v[152:155], v[32:35], v[64:67]
ds_read_b128 v[28:31], v11 offset:19456
v_mul_f32 v111, v55, v63
v_mfma_f32_16x16x32_bf16 v[68:71], v[216:219], v[32:35], v[68:71]
buffer_load_dwordx4 v0, s[4:7], s39 offen offset:3072 sc1 lds
s_add_u32 m0, s50, 32768
v_mfma_f32_16x16x32_bf16 v[72:75], v[152:155], v[36:39], v[72:75]
s_add_u32 s39, s45, 32768
ds_read_b128 v[32:35], v11 offset:20480
v_add_f32 v88, 1.0, v88
v_mfma_f32_16x16x32_bf16 v[76:79], v[216:219], v[36:39], v[76:79]
s_waitcnt lgkmcnt(5)
v_add_f32 v89, 1.0, v89
v_add_f32 v90, 1.0, v90
v_mfma_f32_16x16x32_bf16 v[64:67], v[156:159], v[40:43], v[64:67]
ds_read_b128 v[36:39], v11 offset:21504
v_add_f32 v91, 1.0, v91
v_mfma_f32_16x16x32_bf16 v[68:71], v[220:223], v[40:43], v[68:71]
v_rcp_f32 v88, v88
v_mfma_f32_16x16x32_bf16 v[72:75], v[156:159], v[44:47], v[72:75]
ds_read_b128 v[40:43], v11 offset:22528
v_mfma_f32_16x16x32_bf16 v[76:79], v[220:223], v[44:47], v[76:79]
s_waitcnt lgkmcnt(5)
v_rcp_f32 v89, v89
v_mfma_f32_16x16x32_bf16 v[64:67], v[160:163], v[16:19], v[64:67]
ds_read_b128 v[44:47], v11 offset:23552
v_mfma_f32_16x16x32_bf16 v[68:71], v[224:227], v[16:19], v[68:71]
buffer_load_dwordx4 v0, s[4:7], s39 offen offset:1024 sc1 lds
v_mfma_f32_16x16x32_bf16 v[72:75], v[160:163], v[20:23], v[72:75]
ds_read_b128 v[16:19], v11 offset:24576
v_mfma_f32_16x16x32_bf16 v[76:79], v[224:227], v[20:23], v[76:79]
s_waitcnt lgkmcnt(5)
v_rcp_f32 v90, v90
v_mfma_f32_16x16x32_bf16 v[64:67], v[164:167], v[24:27], v[64:67]
ds_read_b128 v[20:23], v11 offset:25600
v_mfma_f32_16x16x32_bf16 v[68:71], v[228:231], v[24:27], v[68:71]
v_rcp_f32 v91, v91
v_mfma_f32_16x16x32_bf16 v[72:75], v[164:167], v[28:31], v[72:75]
ds_read_b128 v[24:27], v11 offset:26624
v_mul_f32 v108, v108, v88
v_mfma_f32_16x16x32_bf16 v[76:79], v[228:231], v[28:31], v[76:79]
s_waitcnt lgkmcnt(5)
v_mul_f32 v109, v109, v89
v_mul_f32 v110, v110, v90
v_mfma_f32_16x16x32_bf16 v[64:67], v[168:171], v[32:35], v[64:67]
ds_read_b128 v[28:31], v11 offset:27648
v_mul_f32 v111, v111, v91
v_mfma_f32_16x16x32_bf16 v[68:71], v[232:235], v[32:35], v[68:71]
buffer_load_dwordx4 v0, s[4:7], s39 offen offset:3072 sc1 lds
s_add_u32 m0, s50, 49152
v_mfma_f32_16x16x32_bf16 v[72:75], v[168:171], v[36:39], v[72:75]
s_add_u32 s39, s45, 49152
ds_read_b128 v[32:35], v11 offset:28672
v_cvt_pk_bf16_f32 v96, v104, v105
v_mfma_f32_16x16x32_bf16 v[76:79], v[232:235], v[36:39], v[76:79]
s_waitcnt lgkmcnt(5)
v_cvt_pk_bf16_f32 v97, v106, v107
v_cvt_pk_bf16_f32 v98, v108, v109
v_mfma_f32_16x16x32_bf16 v[64:67], v[172:175], v[40:43], v[64:67]
ds_read_b128 v[36:39], v11 offset:29696
v_cvt_pk_bf16_f32 v99, v110, v111
v_mfma_f32_16x16x32_bf16 v[68:71], v[236:239], v[40:43], v[68:71]
v_mfma_f32_16x16x32_bf16 v[72:75], v[172:175], v[44:47], v[72:75]
ds_read_b128 v[40:43], v11 offset:30720
v_permlane16_swap_b32 v96, v98
v_mfma_f32_16x16x32_bf16 v[76:79], v[236:239], v[44:47], v[76:79]
s_waitcnt lgkmcnt(5)
v_permlane16_swap_b32 v97, v99
v_mfma_f32_16x16x32_bf16 v[64:67], v[176:179], v[16:19], v[64:67]
ds_read_b128 v[44:47], v11 offset:31744
v_mfma_f32_16x16x32_bf16 v[68:71], v[240:243], v[16:19], v[68:71]
buffer_load_dwordx4 v0, s[4:7], s39 offen offset:1024 sc1 lds
v_mfma_f32_16x16x32_bf16 v[72:75], v[176:179], v[20:23], v[72:75]
buffer_store_dwordx4 v[96:99], v6, s[4:7], s49 offen sc1
v_mfma_f32_16x16x32_bf16 v[76:79], v[240:243], v[20:23], v[76:79]
s_waitcnt lgkmcnt(4)
s_cmp_ge_u32 s36, 3
s_cselect_b32 s58, s62, 0x70000000
v_mfma_f32_16x16x32_bf16 v[64:67], v[180:183], v[24:27], v[64:67]
s_add_u32 s49, s49, 229376
s_add_u32 s62, s62, 65536
s_add_u32 s59, s59, 229376
v_mfma_f32_16x16x32_bf16 v[68:71], v[244:247], v[24:27], v[68:71]
s_add_u32 s36, s36, 1
s_cmp_eq_u32 s46, 0
s_waitcnt vmcnt(10) lgkmcnt(0)
s_cbranch_scc1 Lfs_635
s_barrier
v_mfma_f32_16x16x32_bf16 v[72:75], v[180:183], v[28:31], v[72:75]
ds_read_b128 v[16:19], v1 offset:0
ds_read_b128 v[20:23], v1 offset:2048
v_mfma_f32_16x16x32_bf16 v[76:79], v[244:247], v[28:31], v[76:79]
ds_read_b128 v[24:27], v1 offset:4096
v_mfma_f32_16x16x32_bf16 v[64:67], v[184:187], v[32:35], v[64:67]
ds_read_b128 v[28:31], v1 offset:6144
v_mfma_f32_16x16x32_bf16 v[68:71], v[248:251], v[32:35], v[68:71]
v_mfma_f32_16x16x32_bf16 v[72:75], v[184:187], v[36:39], v[72:75]
ds_read_b128 v[32:35], v1 offset:8192
v_mfma_f32_16x16x32_bf16 v[76:79], v[248:251], v[36:39], v[76:79]
buffer_load_dwordx4 v0, s[4:7], s39 offen offset:3072 sc1 lds
v_mfma_f32_16x16x32_bf16 v[64:67], v[188:191], v[40:43], v[64:67]
ds_read_b128 v[36:39], v1 offset:10240
v_mfma_f32_16x16x32_bf16 v[68:71], v[252:255], v[40:43], v[68:71]
v_mfma_f32_16x16x32_bf16 v[72:75], v[188:191], v[44:47], v[72:75]
ds_read_b128 v[40:43], v1 offset:12288
v_mfma_f32_16x16x32_bf16 v[76:79], v[252:255], v[44:47], v[76:79]
s_branch Lfb_631
Lfs_635:
v_cmp_gt_u32 vcc, s48, v3
s_cbranch_vccnz Lfd_638
s_add_u32 m0, s50, 0
s_add_u32 s39, s54, 0
buffer_load_dwordx4 v0, s[4:7], s39 offen offset:0 sc1 lds
buffer_load_dwordx4 v0, s[4:7], s39 offen offset:2048 sc1 lds
s_add_u32 m0, s50, 16384
s_add_u32 s39, s54, 16384
buffer_load_dwordx4 v0, s[4:7], s39 offen offset:0 sc1 lds
buffer_load_dwordx4 v0, s[4:7], s39 offen offset:2048 sc1 lds
s_add_u32 m0, s50, 32768
s_add_u32 s39, s54, 32768
buffer_load_dwordx4 v0, s[4:7], s39 offen offset:0 sc1 lds
buffer_load_dwordx4 v0, s[4:7], s39 offen offset:2048 sc1 lds
s_add_u32 m0, s50, 49152
s_add_u32 s39, s54, 49152
buffer_load_dwordx4 v0, s[4:7], s39 offen offset:0 sc1 lds
buffer_load_dwordx4 v0, s[4:7], s39 offen offset:2048 sc1 lds
s_add_u32 m0, s50, 0
s_add_u32 s39, s54, 0
buffer_load_dwordx4 v0, s[4:7], s39 offen offset:1024 sc1 lds
buffer_load_dwordx4 v0, s[4:7], s39 offen offset:3072 sc1 lds
s_add_u32 m0, s50, 16384
s_add_u32 s39, s54, 16384
buffer_load_dwordx4 v0, s[4:7], s39 offen offset:1024 sc1 lds
buffer_load_dwordx4 v0, s[4:7], s39 offen offset:3072 sc1 lds
s_add_u32 m0, s50, 32768
s_add_u32 s39, s54, 32768
buffer_load_dwordx4 v0, s[4:7], s39 offen offset:1024 sc1 lds
buffer_load_dwordx4 v0, s[4:7], s39 offen offset:3072 sc1 lds
s_add_u32 m0, s50, 49152
s_add_u32 s39, s54, 49152
buffer_load_dwordx4 v0, s[4:7], s39 offen offset:1024 sc1 lds
buffer_load_dwordx4 v0, s[4:7], s39 offen offset:3072 sc1 lds
v_mfma_f32_16x16x32_bf16 v[72:75], v[180:183], v[28:31], v[72:75]
v_mfma_f32_16x16x32_bf16 v[76:79], v[244:247], v[28:31], v[76:79]
s_waitcnt lgkmcnt(2)
v_mfma_f32_16x16x32_bf16 v[64:67], v[184:187], v[32:35], v[64:67]
v_mfma_f32_16x16x32_bf16 v[68:71], v[248:251], v[32:35], v[68:71]
v_mfma_f32_16x16x32_bf16 v[72:75], v[184:187], v[36:39], v[72:75]
v_mfma_f32_16x16x32_bf16 v[76:79], v[248:251], v[36:39], v[76:79]
s_waitcnt lgkmcnt(0)
v_mfma_f32_16x16x32_bf16 v[64:67], v[188:191], v[40:43], v[64:67]
v_mfma_f32_16x16x32_bf16 v[68:71], v[252:255], v[40:43], v[68:71]
v_mfma_f32_16x16x32_bf16 v[72:75], v[188:191], v[44:47], v[72:75]
v_mfma_f32_16x16x32_bf16 v[76:79], v[252:255], v[44:47], v[76:79]
s_nop 7
v_cvt_pk_bf16_f32 v80, v64, v65
v_cvt_pk_bf16_f32 v81, v66, v67
v_cvt_pk_bf16_f32 v82, v68, v69
v_cvt_pk_bf16_f32 v83, v70, v71
v_cvt_pk_bf16_f32 v84, v72, v73
v_cvt_pk_bf16_f32 v85, v74, v75
v_cvt_pk_bf16_f32 v86, v76, v77
v_cvt_pk_bf16_f32 v87, v78, v79
buffer_store_dwordx4 v[80:83], v7, s[4:7], s58 offen offset:0 sc1
buffer_store_dwordx4 v[84:87], v7, s[4:7], s58 offen offset:1024 sc1
s_waitcnt vmcnt(10)
s_branch Lfe_637
Lfd_638:
v_mfma_f32_16x16x32_bf16 v[72:75], v[180:183], v[28:31], v[72:75]
v_mfma_f32_16x16x32_bf16 v[76:79], v[244:247], v[28:31], v[76:79]
s_waitcnt lgkmcnt(2)
v_mfma_f32_16x16x32_bf16 v[64:67], v[184:187], v[32:35], v[64:67]
v_mfma_f32_16x16x32_bf16 v[68:71], v[248:251], v[32:35], v[68:71]
v_mfma_f32_16x16x32_bf16 v[72:75], v[184:187], v[36:39], v[72:75]
v_mfma_f32_16x16x32_bf16 v[76:79], v[248:251], v[36:39], v[76:79]
s_waitcnt lgkmcnt(0)
v_mfma_f32_16x16x32_bf16 v[64:67], v[188:191], v[40:43], v[64:67]
v_mfma_f32_16x16x32_bf16 v[68:71], v[252:255], v[40:43], v[68:71]
v_mfma_f32_16x16x32_bf16 v[72:75], v[188:191], v[44:47], v[72:75]
v_mfma_f32_16x16x32_bf16 v[76:79], v[252:255], v[44:47], v[76:79]
s_nop 7
v_cvt_pk_bf16_f32 v80, v64, v65
v_cvt_pk_bf16_f32 v81, v66, v67
v_cvt_pk_bf16_f32 v82, v68, v69
v_cvt_pk_bf16_f32 v83, v70, v71
v_cvt_pk_bf16_f32 v84, v72, v73
v_cvt_pk_bf16_f32 v85, v74, v75
v_cvt_pk_bf16_f32 v86, v76, v77
v_cvt_pk_bf16_f32 v87, v78, v79
s_cmp_eq_u32 s36, 64
s_cbranch_scc1 Lfz_636
buffer_store_dwordx4 v[80:83], v7, s[4:7], s58 offen offset:0 sc1
buffer_store_dwordx4 v[84:87], v7, s[4:7], s58 offen offset:1024 sc1
s_branch Lfw_632
Lfl_633:
Lbw_641:
buffer_load_dword v13, v12, s[4:7], s61 offen sc1
s_waitcnt vmcnt(0)
v_cmp_gt_u32 vcc, s57, v13
s_cbranch_vccz Lbo_642
s_sub_u32 s37, s37, 1
s_cbranch_scc1 Lend_7
s_sleep 2
s_branch Lbw_641
Lbo_642:
s_add_u32 m0, s60, 131072
s_add_u32 s39, s59, 0
buffer_load_dwordx4 v0, s[4:7], s39 offen offset:0 sc1 lds
buffer_load_dwordx4 v0, s[4:7], s39 offen offset:1024 sc1 lds
buffer_load_dwordx4 v0, s[4:7], s39 offen offset:2048 sc1 lds
buffer_load_dwordx4 v0, s[4:7], s39 offen offset:3072 sc1 lds
s_add_u32 m0, s60, 147456
s_add_u32 s39, s59, 16384
buffer_load_dwordx4 v0, s[4:7], s39 offen offset:0 sc1 lds
buffer_load_dwordx4 v0, s[4:7], s39 offen offset:1024 sc1 lds
buffer_load_dwordx4 v0, s[4:7], s39 offen offset:2048 sc1 lds
buffer_load_dwordx4 v0, s[4:7], s39 offen offset:3072 sc1 lds
s_waitcnt vmcnt(0) lgkmcnt(0)
s_branch Lfg_634
Lfz_636:
s_waitcnt vmcnt(0)
s_barrier
v_min_u32 v100, s36, 64
s_sub_u32 s38, s36, 4
v_max_i32 v101, s38, 0
buffer_store_dwordx2 v[100:101], v4, s[4:7], 0 offen sc1
v_add_u32 v11, -0x20000, v11
s_mov_b32 s53, s59
s_cmp_lg_u32 s45, 0x70000000
s_cselect_b32 s56, 1, 0
s_mov_b32 s57, 62
s_cmp_lg_u32 s56, 0
s_cbranch_scc1 Lfq_643
Lbw_644:
buffer_load_dword v13, v12, s[4:7], s61 offen sc1
s_waitcnt vmcnt(0)
v_cmp_gt_u32 vcc, s57, v13
s_cbranch_vccz Lbo_645
s_sub_u32 s37, s37, 1
s_cbranch_scc1 Lend_7
s_sleep 1
s_branch Lbw_644
Lbo_645:
s_add_u32 s55, s53, 0
s_add_u32 m0, s60, 0
s_add_u32 s39, s55, 0
buffer_load_dwordx4 v0, s[4:7], s39 offen offset:0 sc1 lds
buffer_load_dwordx4 v0, s[4:7], s39 offen offset:1024 sc1 lds
buffer_load_dwordx4 v0, s[4:7], s39 offen offset:2048 sc1 lds
buffer_load_dwordx4 v0, s[4:7], s39 offen offset:3072 sc1 lds
s_add_u32 m0, s60, 16384
s_add_u32 s39, s55, 16384
buffer_load_dwordx4 v0, s[4:7], s39 offen offset:0 sc1 lds
buffer_load_dwordx4 v0, s[4:7], s39 offen offset:1024 sc1 lds
buffer_load_dwordx4 v0, s[4:7], s39 offen offset:2048 sc1 lds
buffer_load_dwordx4 v0, s[4:7], s39 offen offset:3072 sc1 lds
s_waitcnt vmcnt(0)
Lfq_643:
s_mov_b32 s57, 63
v_cmp_gt_u32 vcc, s57, v13
s_mov_b32 s56, 0
s_cbranch_vccnz Lfq_646
s_mov_b32 s56, 1
s_add_u32 s55, s53, 229376
s_add_u32 m0, s60, 65536
s_add_u32 s39, s55, 0
buffer_load_dwordx4 v0, s[4:7], s39 offen offset:0 sc1 lds
buffer_load_dwordx4 v0, s[4:7], s39 offen offset:1024 sc1 lds
buffer_load_dwordx4 v0, s[4:7], s39 offen offset:2048 sc1 lds
buffer_load_dwordx4 v0, s[4:7], s39 offen offset:3072 sc1 lds
s_add_u32 m0, s60, 81920
s_add_u32 s39, s55, 16384
buffer_load_dwordx4 v0, s[4:7], s39 offen offset:0 sc1 lds
buffer_load_dwordx4 v0, s[4:7], s39 offen offset:1024 sc1 lds
buffer_load_dwordx4 v0, s[4:7], s39 offen offset:2048 sc1 lds
buffer_load_dwordx4 v0, s[4:7], s39 offen offset:3072 sc1 lds
Lfq_646:
s_barrier
ds_read_b128 v[16:19], v11 offset:0
ds_read_b128 v[20:23], v11 offset:1024
ds_read_b128 v[24:27], v11 offset:2048
ds_read_b128 v[28:31], v11 offset:3072
ds_read_b128 v[32:35], v11 offset:4096
ds_read_b128 v[36:39], v11 offset:5120
ds_read_b128 v[40:43], v11 offset:6144
s_waitcnt lgkmcnt(5)
v_mfma_f32_16x16x32_bf16 v[64:67], v[128:131], v[16:19], 0
ds_read_b128 v[44:47], v11 offset:7168
v_mfma_f32_16x16x32_bf16 v[68:71], v[192:195], v[16:19], 0
v_mfma_f32_16x16x32_bf16 v[72:75], v[128:131], v[20:23], 0
ds_read_b128 v[16:19], v11 offset:8192
v_mfma_f32_16x16x32_bf16 v[76:79], v[192:195], v[20:23], 0
s_waitcnt lgkmcnt(5)
buffer_store_dwordx4 v[80:83], v7, s[4:7], s58 offen offset:0 sc1
v_mfma_f32_16x16x32_bf16 v[64:67], v[132:135], v[24:27], v[64:67]
ds_read_b128 v[20:23], v11 offset:9216
v_mfma_f32_16x16x32_bf16 v[68:71], v[196:199], v[24:27], v[68:71]
v_mfma_f32_16x16x32_bf16 v[72:75], v[132:135], v[28:31], v[72:75]
ds_read_b128 v[24:27], v11 offset:10240
v_mfma_f32_16x16x32_bf16 v[76:79], v[196:199], v[28:31], v[76:79]
s_waitcnt lgkmcnt(5)
v_mfma_f32_16x16x32_bf16 v[64:67], v[136:139], v[32:35], v[64:67]
ds_read_b128 v[28:31], v11 offset:11264
v_mfma_f32_16x16x32_bf16 v[68:71], v[200:203], v[32:35], v[68:71]
buffer_store_dwordx4 v[84:87], v7, s[4:7], s58 offen offset:1024 sc1
v_mfma_f32_16x16x32_bf16 v[72:75], v[136:139], v[36:39], v[72:75]
ds_read_b128 v[32:35], v11 offset:12288
v_mfma_f32_16x16x32_bf16 v[76:79], v[200:203], v[36:39], v[76:79]
s_waitcnt lgkmcnt(5)
v_mfma_f32_16x16x32_bf16 v[64:67], v[140:143], v[40:43], v[64:67]
ds_read_b128 v[36:39], v11 offset:13312
v_mfma_f32_16x16x32_bf16 v[68:71], v[204:207], v[40:43], v[68:71]
v_mfma_f32_16x16x32_bf16 v[72:75], v[140:143], v[44:47], v[72:75]
ds_read_b128 v[40:43], v11 offset:14336
v_mfma_f32_16x16x32_bf16 v[76:79], v[204:207], v[44:47], v[76:79]
s_waitcnt lgkmcnt(5)
v_mfma_f32_16x16x32_bf16 v[64:67], v[144:147], v[16:19], v[64:67]
ds_read_b128 v[44:47], v11 offset:15360
v_mfma_f32_16x16x32_bf16 v[68:71], v[208:211], v[16:19], v[68:71]
v_mfma_f32_16x16x32_bf16 v[72:75], v[144:147], v[20:23], v[72:75]
ds_read_b128 v[16:19], v11 offset:16384
v_mfma_f32_16x16x32_bf16 v[76:79], v[208:211], v[20:23], v[76:79]
s_waitcnt lgkmcnt(5)
v_mfma_f32_16x16x32_bf16 v[64:67], v[148:151], v[24:27], v[64:67]
ds_read_b128 v[20:23], v11 offset:17408
v_mfma_f32_16x16x32_bf16 v[68:71], v[212:215], v[24:27], v[68:71]
v_mfma_f32_16x16x32_bf16 v[72:75], v[148:151], v[28:31], v[72:75]
ds_read_b128 v[24:27], v11 offset:18432
v_mfma_f32_16x16x32_bf16 v[76:79], v[212:215], v[28:31], v[76:79]
s_waitcnt lgkmcnt(5)
v_mfma_f32_16x16x32_bf16 v[64:67], v[152:155], v[32:35], v[64:67]
ds_read_b128 v[28:31], v11 offset:19456
v_mfma_f32_16x16x32_bf16 v[68:71], v[216:219], v[32:35], v[68:71]
v_mfma_f32_16x16x32_bf16 v[72:75], v[152:155], v[36:39], v[72:75]
ds_read_b128 v[32:35], v11 offset:20480
v_mfma_f32_16x16x32_bf16 v[76:79], v[216:219], v[36:39], v[76:79]
s_waitcnt lgkmcnt(5)
v_mfma_f32_16x16x32_bf16 v[64:67], v[156:159], v[40:43], v[64:67]
ds_read_b128 v[36:39], v11 offset:21504
v_mfma_f32_16x16x32_bf16 v[68:71], v[220:223], v[40:43], v[68:71]
v_mfma_f32_16x16x32_bf16 v[72:75], v[156:159], v[44:47], v[72:75]
ds_read_b128 v[40:43], v11 offset:22528
v_mfma_f32_16x16x32_bf16 v[76:79], v[220:223], v[44:47], v[76:79]
s_waitcnt lgkmcnt(5)
v_mfma_f32_16x16x32_bf16 v[64:67], v[160:163], v[16:19], v[64:67]
ds_read_b128 v[44:47], v11 offset:23552
v_mfma_f32_16x16x32_bf16 v[68:71], v[224:227], v[16:19], v[68:71]
v_mfma_f32_16x16x32_bf16 v[72:75], v[160:163], v[20:23], v[72:75]
ds_read_b128 v[16:19], v11 offset:24576
v_mfma_f32_16x16x32_bf16 v[76:79], v[224:227], v[20:23], v[76:79]
s_waitcnt lgkmcnt(5)
v_mfma_f32_16x16x32_bf16 v[64:67], v[164:167], v[24:27], v[64:67]
ds_read_b128 v[20:23], v11 offset:25600
v_mfma_f32_16x16x32_bf16 v[68:71], v[228:231], v[24:27], v[68:71]
v_mfma_f32_16x16x32_bf16 v[72:75], v[164:167], v[28:31], v[72:75]
ds_read_b128 v[24:27], v11 offset:26624
v_mfma_f32_16x16x32_bf16 v[76:79], v[228:231], v[28:31], v[76:79]
s_waitcnt lgkmcnt(5)
v_mfma_f32_16x16x32_bf16 v[64:67], v[168:171], v[32:35], v[64:67]
ds_read_b128 v[28:31], v11 offset:27648
v_mfma_f32_16x16x32_bf16 v[68:71], v[232:235], v[32:35], v[68:71]
v_mfma_f32_16x16x32_bf16 v[72:75], v[168:171], v[36:39], v[72:75]
ds_read_b128 v[32:35], v11 offset:28672
v_mfma_f32_16x16x32_bf16 v[76:79], v[232:235], v[36:39], v[76:79]
s_waitcnt lgkmcnt(5)
v_mfma_f32_16x16x32_bf16 v[64:67], v[172:175], v[40:43], v[64:67]
ds_read_b128 v[36:39], v11 offset:29696
v_mfma_f32_16x16x32_bf16 v[68:71], v[236:239], v[40:43], v[68:71]
buffer_load_dword v13, v12, s[4:7], s61 offen sc1
v_mfma_f32_16x16x32_bf16 v[72:75], v[172:175], v[44:47], v[72:75]
ds_read_b128 v[40:43], v11 offset:30720
v_mfma_f32_16x16x32_bf16 v[76:79], v[236:239], v[44:47], v[76:79]
s_waitcnt lgkmcnt(5)
v_mfma_f32_16x16x32_bf16 v[64:67], v[176:179], v[16:19], v[64:67]
ds_read_b128 v[44:47], v11 offset:31744
v_mfma_f32_16x16x32_bf16 v[68:71], v[240:243], v[16:19], v[68:71]
v_mfma_f32_16x16x32_bf16 v[72:75], v[176:179], v[20:23], v[72:75]
v_mfma_f32_16x16x32_bf16 v[76:79], v[240:243], v[20:23], v[76:79]
s_waitcnt lgkmcnt(4)
v_mfma_f32_16x16x32_bf16 v[64:67], v[180:183], v[24:27], v[64:67]
v_mfma_f32_16x16x32_bf16 v[68:71], v[244:247], v[24:27], v[68:71]
v_mfma_f32_16x16x32_bf16 v[72:75], v[180:183], v[28:31], v[72:75]
v_mfma_f32_16x16x32_bf16 v[76:79], v[244:247], v[28:31], v[76:79]
s_waitcnt lgkmcnt(2)
v_mfma_f32_16x16x32_bf16 v[64:67], v[184:187], v[32:35], v[64:67]
v_mfma_f32_16x16x32_bf16 v[68:71], v[248:251], v[32:35], v[68:71]
v_mfma_f32_16x16x32_bf16 v[72:75], v[184:187], v[36:39], v[72:75]
v_mfma_f32_16x16x32_bf16 v[76:79], v[248:251], v[36:39], v[76:79]
s_waitcnt lgkmcnt(0)
v_mfma_f32_16x16x32_bf16 v[64:67], v[188:191], v[40:43], v[64:67]
v_mfma_f32_16x16x32_bf16 v[68:71], v[252:255], v[40:43], v[68:71]
v_mfma_f32_16x16x32_bf16 v[72:75], v[188:191], v[44:47], v[72:75]
v_mfma_f32_16x16x32_bf16 v[76:79], v[252:255], v[44:47], v[76:79]
s_cmp_ge_u32 s36, 3
s_cselect_b32 s58, s62, 0x70000000
s_add_u32 s49, s49, 229376
s_add_u32 s62, s62, 65536
s_add_u32 s59, s59, 229376
s_add_u32 s36, s36, 1
v_add_u32 v11, 0x10000, v11
s_nop 0
v_cvt_pk_bf16_f32 v80, v64, v65
v_cvt_pk_bf16_f32 v81, v66, v67
v_cvt_pk_bf16_f32 v82, v68, v69
v_cvt_pk_bf16_f32 v83, v70, v71
v_cvt_pk_bf16_f32 v84, v72, v73
v_cvt_pk_bf16_f32 v85, v74, v75
v_cvt_pk_bf16_f32 v86, v76, v77
v_cvt_pk_bf16_f32 v87, v78, v79
s_waitcnt vmcnt(0)
s_mov_b32 s57, 63
s_cmp_lg_u32 s56, 0
s_cbranch_scc1 Lfq_647
Lbw_648:
buffer_load_dword v13, v12, s[4:7], s61 offen sc1
s_waitcnt vmcnt(0)
v_cmp_gt_u32 vcc, s57, v13
s_cbranch_vccz Lbo_649
s_sub_u32 s37, s37, 1
s_cbranch_scc1 Lend_7
s_sleep 1
s_branch Lbw_648
Lbo_649:
s_add_u32 s55, s53, 229376
s_add_u32 m0, s60, 65536
s_add_u32 s39, s55, 0
buffer_load_dwordx4 v0, s[4:7], s39 offen offset:0 sc1 lds
buffer_load_dwordx4 v0, s[4:7], s39 offen offset:1024 sc1 lds
buffer_load_dwordx4 v0, s[4:7], s39 offen offset:2048 sc1 lds
buffer_load_dwordx4 v0, s[4:7], s39 offen offset:3072 sc1 lds
s_add_u32 m0, s60, 81920
s_add_u32 s39, s55, 16384
buffer_load_dwordx4 v0, s[4:7], s39 offen offset:0 sc1 lds
buffer_load_dwordx4 v0, s[4:7], s39 offen offset:1024 sc1 lds
buffer_load_dwordx4 v0, s[4:7], s39 offen offset:2048 sc1 lds
buffer_load_dwordx4 v0, s[4:7], s39 offen offset:3072 sc1 lds
s_waitcnt vmcnt(0)
Lfq_647:
s_mov_b32 s57, 64
v_cmp_gt_u32 vcc, s57, v13
s_mov_b32 s56, 0
s_cbranch_vccnz Lfq_650
s_mov_b32 s56, 1
s_add_u32 s55, s53, 458752
s_add_u32 m0, s60, 131072
s_add_u32 s39, s55, 0
buffer_load_dwordx4 v0, s[4:7], s39 offen offset:0 sc1 lds
buffer_load_dwordx4 v0, s[4:7], s39 offen offset:1024 sc1 lds
buffer_load_dwordx4 v0, s[4:7], s39 offen offset:2048 sc1 lds
buffer_load_dwordx4 v0, s[4:7], s39 offen offset:3072 sc1 lds
s_add_u32 m0, s60, 147456
s_add_u32 s39, s55, 16384
buffer_load_dwordx4 v0, s[4:7], s39 offen offset:0 sc1 lds
buffer_load_dwordx4 v0, s[4:7], s39 offen offset:1024 sc1 lds
buffer_load_dwordx4 v0, s[4:7], s39 offen offset:2048 sc1 lds
buffer_load_dwordx4 v0, s[4:7], s39 offen offset:3072 sc1 lds
Lfq_650:
s_barrier
ds_read_b128 v[16:19], v11 offset:0
ds_read_b128 v[20:23], v11 offset:1024
ds_read_b128 v[24:27], v11 offset:2048
ds_read_b128 v[28:31], v11 offset:3072
ds_read_b128 v[32:35], v11 offset:4096
ds_read_b128 v[36:39], v11 offset:5120
ds_read_b128 v[40:43], v11 offset:6144
s_waitcnt lgkmcnt(5)
v_mfma_f32_16x16x32_bf16 v[64:67], v[128:131], v[16:19], 0
ds_read_b128 v[44:47], v11 offset:7168
v_mfma_f32_16x16x32_bf16 v[68:71], v[192:195], v[16:19], 0
v_mfma_f32_16x16x32_bf16 v[72:75], v[128:131], v[20:23], 0
ds_read_b128 v[16:19], v11 offset:8192
v_mfma_f32_16x16x32_bf16 v[76:79], v[192:195], v[20:23], 0
s_waitcnt lgkmcnt(5)
buffer_store_dwordx4 v[80:83], v7, s[4:7], s58 offen offset:0 sc1
v_mfma_f32_16x16x32_bf16 v[64:67], v[132:135], v[24:27], v[64:67]
ds_read_b128 v[20:23], v11 offset:9216
v_mfma_f32_16x16x32_bf16 v[68:71], v[196:199], v[24:27], v[68:71]
v_mfma_f32_16x16x32_bf16 v[72:75], v[132:135], v[28:31], v[72:75]
ds_read_b128 v[24:27], v11 offset:10240
v_mfma_f32_16x16x32_bf16 v[76:79], v[196:199], v[28:31], v[76:79]
s_waitcnt lgkmcnt(5)
v_mfma_f32_16x16x32_bf16 v[64:67], v[136:139], v[32:35], v[64:67]
ds_read_b128 v[28:31], v11 offset:11264
v_mfma_f32_16x16x32_bf16 v[68:71], v[200:203], v[32:35], v[68:71]
buffer_store_dwordx4 v[84:87], v7, s[4:7], s58 offen offset:1024 sc1
v_mfma_f32_16x16x32_bf16 v[72:75], v[136:139], v[36:39], v[72:75]
ds_read_b128 v[32:35], v11 offset:12288
v_mfma_f32_16x16x32_bf16 v[76:79], v[200:203], v[36:39], v[76:79]
s_waitcnt lgkmcnt(5)
v_mfma_f32_16x16x32_bf16 v[64:67], v[140:143], v[40:43], v[64:67]
ds_read_b128 v[36:39], v11 offset:13312
v_mfma_f32_16x16x32_bf16 v[68:71], v[204:207], v[40:43], v[68:71]
v_mfma_f32_16x16x32_bf16 v[72:75], v[140:143], v[44:47], v[72:75]
ds_read_b128 v[40:43], v11 offset:14336
v_mfma_f32_16x16x32_bf16 v[76:79], v[204:207], v[44:47], v[76:79]
s_waitcnt lgkmcnt(5)
v_mfma_f32_16x16x32_bf16 v[64:67], v[144:147], v[16:19], v[64:67]
ds_read_b128 v[44:47], v11 offset:15360
v_mfma_f32_16x16x32_bf16 v[68:71], v[208:211], v[16:19], v[68:71]
v_mfma_f32_16x16x32_bf16 v[72:75], v[144:147], v[20:23], v[72:75]
ds_read_b128 v[16:19], v11 offset:16384
v_mfma_f32_16x16x32_bf16 v[76:79], v[208:211], v[20:23], v[76:79]
s_waitcnt lgkmcnt(5)
v_mfma_f32_16x16x32_bf16 v[64:67], v[148:151], v[24:27], v[64:67]
ds_read_b128 v[20:23], v11 offset:17408
v_mfma_f32_16x16x32_bf16 v[68:71], v[212:215], v[24:27], v[68:71]
v_mfma_f32_16x16x32_bf16 v[72:75], v[148:151], v[28:31], v[72:75]
ds_read_b128 v[24:27], v11 offset:18432
v_mfma_f32_16x16x32_bf16 v[76:79], v[212:215], v[28:31], v[76:79]
s_waitcnt lgkmcnt(5)
v_mfma_f32_16x16x32_bf16 v[64:67], v[152:155], v[32:35], v[64:67]
ds_read_b128 v[28:31], v11 offset:19456
v_mfma_f32_16x16x32_bf16 v[68:71], v[216:219], v[32:35], v[68:71]
v_mfma_f32_16x16x32_bf16 v[72:75], v[152:155], v[36:39], v[72:75]
ds_read_b128 v[32:35], v11 offset:20480
v_mfma_f32_16x16x32_bf16 v[76:79], v[216:219], v[36:39], v[76:79]
s_waitcnt lgkmcnt(5)
v_mfma_f32_16x16x32_bf16 v[64:67], v[156:159], v[40:43], v[64:67]
ds_read_b128 v[36:39], v11 offset:21504
v_mfma_f32_16x16x32_bf16 v[68:71], v[220:223], v[40:43], v[68:71]
v_mfma_f32_16x16x32_bf16 v[72:75], v[156:159], v[44:47], v[72:75]
ds_read_b128 v[40:43], v11 offset:22528
v_mfma_f32_16x16x32_bf16 v[76:79], v[220:223], v[44:47], v[76:79]
s_waitcnt lgkmcnt(5)
v_mfma_f32_16x16x32_bf16 v[64:67], v[160:163], v[16:19], v[64:67]
ds_read_b128 v[44:47], v11 offset:23552
v_mfma_f32_16x16x32_bf16 v[68:71], v[224:227], v[16:19], v[68:71]
v_mfma_f32_16x16x32_bf16 v[72:75], v[160:163], v[20:23], v[72:75]
ds_read_b128 v[16:19], v11 offset:24576
v_mfma_f32_16x16x32_bf16 v[76:79], v[224:227], v[20:23], v[76:79]
s_waitcnt lgkmcnt(5)
v_mfma_f32_16x16x32_bf16 v[64:67], v[164:167], v[24:27], v[64:67]
ds_read_b128 v[20:23], v11 offset:25600
v_mfma_f32_16x16x32_bf16 v[68:71], v[228:231], v[24:27], v[68:71]
v_mfma_f32_16x16x32_bf16 v[72:75], v[164:167], v[28:31], v[72:75]
ds_read_b128 v[24:27], v11 offset:26624
v_mfma_f32_16x16x32_bf16 v[76:79], v[228:231], v[28:31], v[76:79]
s_waitcnt lgkmcnt(5)
v_mfma_f32_16x16x32_bf16 v[64:67], v[168:171], v[32:35], v[64:67]
ds_read_b128 v[28:31], v11 offset:27648
v_mfma_f32_16x16x32_bf16 v[68:71], v[232:235], v[32:35], v[68:71]
v_mfma_f32_16x16x32_bf16 v[72:75], v[168:171], v[36:39], v[72:75]
ds_read_b128 v[32:35], v11 offset:28672
v_mfma_f32_16x16x32_bf16 v[76:79], v[232:235], v[36:39], v[76:79]
s_waitcnt lgkmcnt(5)
v_mfma_f32_16x16x32_bf16 v[64:67], v[172:175], v[40:43], v[64:67]
ds_read_b128 v[36:39], v11 offset:29696
v_mfma_f32_16x16x32_bf16 v[68:71], v[236:239], v[40:43], v[68:71]
v_mfma_f32_16x16x32_bf16 v[72:75], v[172:175], v[44:47], v[72:75]
ds_read_b128 v[40:43], v11 offset:30720
v_mfma_f32_16x16x32_bf16 v[76:79], v[236:239], v[44:47], v[76:79]
s_waitcnt lgkmcnt(5)
v_mfma_f32_16x16x32_bf16 v[64:67], v[176:179], v[16:19], v[64:67]
ds_read_b128 v[44:47], v11 offset:31744
v_mfma_f32_16x16x32_bf16 v[68:71], v[240:243], v[16:19], v[68:71]
v_mfma_f32_16x16x32_bf16 v[72:75], v[176:179], v[20:23], v[72:75]
v_mfma_f32_16x16x32_bf16 v[76:79], v[240:243], v[20:23], v[76:79]
s_waitcnt lgkmcnt(4)
v_mfma_f32_16x16x32_bf16 v[64:67], v[180:183], v[24:27], v[64:67]
v_mfma_f32_16x16x32_bf16 v[68:71], v[244:247], v[24:27], v[68:71]
v_mfma_f32_16x16x32_bf16 v[72:75], v[180:183], v[28:31], v[72:75]
v_mfma_f32_16x16x32_bf16 v[76:79], v[244:247], v[28:31], v[76:79]
s_waitcnt lgkmcnt(2)
v_mfma_f32_16x16x32_bf16 v[64:67], v[184:187], v[32:35], v[64:67]
v_mfma_f32_16x16x32_bf16 v[68:71], v[248:251], v[32:35], v[68:71]
v_mfma_f32_16x16x32_bf16 v[72:75], v[184:187], v[36:39], v[72:75]
v_mfma_f32_16x16x32_bf16 v[76:79], v[248:251], v[36:39], v[76:79]
s_waitcnt lgkmcnt(0)
v_mfma_f32_16x16x32_bf16 v[64:67], v[188:191], v[40:43], v[64:67]
v_mfma_f32_16x16x32_bf16 v[68:71], v[252:255], v[40:43], v[68:71]
v_mfma_f32_16x16x32_bf16 v[72:75], v[188:191], v[44:47], v[72:75]
v_mfma_f32_16x16x32_bf16 v[76:79], v[252:255], v[44:47], v[76:79]
s_cmp_ge_u32 s36, 3
s_cselect_b32 s58, s62, 0x70000000
s_add_u32 s49, s49, 229376
s_add_u32 s62, s62, 65536
s_add_u32 s59, s59, 229376
s_add_u32 s36, s36, 1
v_add_u32 v11, 0x10000, v11
s_nop 0
v_cvt_pk_bf16_f32 v80, v64, v65
v_cvt_pk_bf16_f32 v81, v66, v67
v_cvt_pk_bf16_f32 v82, v68, v69
v_cvt_pk_bf16_f32 v83, v70, v71
v_cvt_pk_bf16_f32 v84, v72, v73
v_cvt_pk_bf16_f32 v85, v74, v75
v_cvt_pk_bf16_f32 v86, v76, v77
v_cvt_pk_bf16_f32 v87, v78, v79
s_waitcnt vmcnt(2)
s_mov_b32 s57, 64
s_cmp_lg_u32 s56, 0
s_cbranch_scc1 Lfq_651
Lbw_652:
buffer_load_dword v13, v12, s[4:7], s61 offen sc1
s_waitcnt vmcnt(0)
v_cmp_gt_u32 vcc, s57, v13
s_cbranch_vccz Lbo_653
s_sub_u32 s37, s37, 1
s_cbranch_scc1 Lend_7
s_sleep 1
s_branch Lbw_652
Lbo_653:
s_add_u32 s55, s53, 458752
s_add_u32 m0, s60, 131072
s_add_u32 s39, s55, 0
buffer_load_dwordx4 v0, s[4:7], s39 offen offset:0 sc1 lds
buffer_load_dwordx4 v0, s[4:7], s39 offen offset:1024 sc1 lds
buffer_load_dwordx4 v0, s[4:7], s39 offen offset:2048 sc1 lds
buffer_load_dwordx4 v0, s[4:7], s39 offen offset:3072 sc1 lds
s_add_u32 m0, s60, 147456
s_add_u32 s39, s55, 16384
buffer_load_dwordx4 v0, s[4:7], s39 offen offset:0 sc1 lds
buffer_load_dwordx4 v0, s[4:7], s39 offen offset:1024 sc1 lds
buffer_load_dwordx4 v0, s[4:7], s39 offen offset:2048 sc1 lds
buffer_load_dwordx4 v0, s[4:7], s39 offen offset:3072 sc1 lds
s_waitcnt vmcnt(0)
Lfq_651:
s_barrier
ds_read_b128 v[16:19], v11 offset:0
ds_read_b128 v[20:23], v11 offset:1024
ds_read_b128 v[24:27], v11 offset:2048
ds_read_b128 v[28:31], v11 offset:3072
ds_read_b128 v[32:35], v11 offset:4096
ds_read_b128 v[36:39], v11 offset:5120
ds_read_b128 v[40:43], v11 offset:6144
s_waitcnt lgkmcnt(5)
v_mfma_f32_16x16x32_bf16 v[64:67], v[128:131], v[16:19], 0
ds_read_b128 v[44:47], v11 offset:7168
v_mfma_f32_16x16x32_bf16 v[68:71], v[192:195], v[16:19], 0
v_mfma_f32_16x16x32_bf16 v[72:75], v[128:131], v[20:23], 0
ds_read_b128 v[16:19], v11 offset:8192
v_mfma_f32_16x16x32_bf16 v[76:79], v[192:195], v[20:23], 0
s_waitcnt lgkmcnt(5)
buffer_store_dwordx4 v[80:83], v7, s[4:7], s58 offen offset:0 sc1
v_mfma_f32_16x16x32_bf16 v[64:67], v[132:135], v[24:27], v[64:67]
ds_read_b128 v[20:23], v11 offset:9216
v_mfma_f32_16x16x32_bf16 v[68:71], v[196:199], v[24:27], v[68:71]
v_mfma_f32_16x16x32_bf16 v[72:75], v[132:135], v[28:31], v[72:75]
ds_read_b128 v[24:27], v11 offset:10240
v_mfma_f32_16x16x32_bf16 v[76:79], v[196:199], v[28:31], v[76:79]
s_waitcnt lgkmcnt(5)
buffer_store_dwordx4 v[84:87], v7, s[4:7], s58 offen offset:1024 sc1
v_mfma_f32_16x16x32_bf16 v[64:67], v[136:139], v[32:35], v[64:67]
ds_read_b128 v[28:31], v11 offset:11264
v_mfma_f32_16x16x32_bf16 v[68:71], v[200:203], v[32:35], v[68:71]
v_mfma_f32_16x16x32_bf16 v[72:75], v[136:139], v[36:39], v[72:75]
ds_read_b128 v[32:35], v11 offset:12288
v_mfma_f32_16x16x32_bf16 v[76:79], v[200:203], v[36:39], v[76:79]
s_waitcnt lgkmcnt(5)
v_mfma_f32_16x16x32_bf16 v[64:67], v[140:143], v[40:43], v[64:67]
ds_read_b128 v[36:39], v11 offset:13312
v_mfma_f32_16x16x32_bf16 v[68:71], v[204:207], v[40:43], v[68:71]
v_mfma_f32_16x16x32_bf16 v[72:75], v[140:143], v[44:47], v[72:75]
ds_read_b128 v[40:43], v11 offset:14336
v_mfma_f32_16x16x32_bf16 v[76:79], v[204:207], v[44:47], v[76:79]
s_waitcnt lgkmcnt(5)
v_mfma_f32_16x16x32_bf16 v[64:67], v[144:147], v[16:19], v[64:67]
ds_read_b128 v[44:47], v11 offset:15360
v_mfma_f32_16x16x32_bf16 v[68:71], v[208:211], v[16:19], v[68:71]
v_mfma_f32_16x16x32_bf16 v[72:75], v[144:147], v[20:23], v[72:75]
ds_read_b128 v[16:19], v11 offset:16384
v_mfma_f32_16x16x32_bf16 v[76:79], v[208:211], v[20:23], v[76:79]
s_waitcnt lgkmcnt(5)
v_mfma_f32_16x16x32_bf16 v[64:67], v[148:151], v[24:27], v[64:67]
ds_read_b128 v[20:23], v11 offset:17408
v_mfma_f32_16x16x32_bf16 v[68:71], v[212:215], v[24:27], v[68:71]
v_mfma_f32_16x16x32_bf16 v[72:75], v[148:151], v[28:31], v[72:75]
ds_read_b128 v[24:27], v11 offset:18432
v_mfma_f32_16x16x32_bf16 v[76:79], v[212:215], v[28:31], v[76:79]
s_waitcnt lgkmcnt(5)
v_mfma_f32_16x16x32_bf16 v[64:67], v[152:155], v[32:35], v[64:67]
ds_read_b128 v[28:31], v11 offset:19456
v_mfma_f32_16x16x32_bf16 v[68:71], v[216:219], v[32:35], v[68:71]
v_mfma_f32_16x16x32_bf16 v[72:75], v[152:155], v[36:39], v[72:75]
ds_read_b128 v[32:35], v11 offset:20480
v_mfma_f32_16x16x32_bf16 v[76:79], v[216:219], v[36:39], v[76:79]
s_waitcnt lgkmcnt(5)
v_mfma_f32_16x16x32_bf16 v[64:67], v[156:159], v[40:43], v[64:67]
ds_read_b128 v[36:39], v11 offset:21504
v_mfma_f32_16x16x32_bf16 v[68:71], v[220:223], v[40:43], v[68:71]
v_mfma_f32_16x16x32_bf16 v[72:75], v[156:159], v[44:47], v[72:75]
ds_read_b128 v[40:43], v11 offset:22528
v_min_u32 v100, s36, 64
v_mfma_f32_16x16x32_bf16 v[76:79], v[220:223], v[44:47], v[76:79]
s_waitcnt lgkmcnt(5)
s_sub_u32 s38, s36, 2
v_max_i32 v101, s38, 0
v_mfma_f32_16x16x32_bf16 v[64:67], v[160:163], v[16:19], v[64:67]
ds_read_b128 v[44:47], v11 offset:23552
buffer_store_dwordx2 v[100:101], v4, s[4:7], 0 offen sc1
v_mfma_f32_16x16x32_bf16 v[68:71], v[224:227], v[16:19], v[68:71]
v_mfma_f32_16x16x32_bf16 v[72:75], v[160:163], v[20:23], v[72:75]
ds_read_b128 v[16:19], v11 offset:24576
v_mfma_f32_16x16x32_bf16 v[76:79], v[224:227], v[20:23], v[76:79]
s_waitcnt lgkmcnt(5)
v_mfma_f32_16x16x32_bf16 v[64:67], v[164:167], v[24:27], v[64:67]
ds_read_b128 v[20:23], v11 offset:25600
v_mfma_f32_16x16x32_bf16 v[68:71], v[228:231], v[24:27], v[68:71]
v_mfma_f32_16x16x32_bf16 v[72:75], v[164:167], v[28:31], v[72:75]
ds_read_b128 v[24:27], v11 offset:26624
v_mfma_f32_16x16x32_bf16 v[76:79], v[228:231], v[28:31], v[76:79]
s_waitcnt lgkmcnt(5)
v_mfma_f32_16x16x32_bf16 v[64:67], v[168:171], v[32:35], v[64:67]
ds_read_b128 v[28:31], v11 offset:27648
v_mfma_f32_16x16x32_bf16 v[68:71], v[232:235], v[32:35], v[68:71]
v_mfma_f32_16x16x32_bf16 v[72:75], v[168:171], v[36:39], v[72:75]
ds_read_b128 v[32:35], v11 offset:28672
v_mfma_f32_16x16x32_bf16 v[76:79], v[232:235], v[36:39], v[76:79]
s_waitcnt lgkmcnt(5)
v_mfma_f32_16x16x32_bf16 v[64:67], v[172:175], v[40:43], v[64:67]
ds_read_b128 v[36:39], v11 offset:29696
v_mfma_f32_16x16x32_bf16 v[68:71], v[236:239], v[40:43], v[68:71]
v_mfma_f32_16x16x32_bf16 v[72:75], v[172:175], v[44:47], v[72:75]
ds_read_b128 v[40:43], v11 offset:30720
v_mfma_f32_16x16x32_bf16 v[76:79], v[236:239], v[44:47], v[76:79]
s_waitcnt lgkmcnt(5)
v_mfma_f32_16x16x32_bf16 v[64:67], v[176:179], v[16:19], v[64:67]
ds_read_b128 v[44:47], v11 offset:31744
v_mfma_f32_16x16x32_bf16 v[68:71], v[240:243], v[16:19], v[68:71]
v_mfma_f32_16x16x32_bf16 v[72:75], v[176:179], v[20:23], v[72:75]
v_mfma_f32_16x16x32_bf16 v[76:79], v[240:243], v[20:23], v[76:79]
s_waitcnt lgkmcnt(4)
v_mfma_f32_16x16x32_bf16 v[64:67], v[180:183], v[24:27], v[64:67]
v_mfma_f32_16x16x32_bf16 v[68:71], v[244:247], v[24:27], v[68:71]
v_mfma_f32_16x16x32_bf16 v[72:75], v[180:183], v[28:31], v[72:75]
v_mfma_f32_16x16x32_bf16 v[76:79], v[244:247], v[28:31], v[76:79]
s_waitcnt lgkmcnt(2)
v_mfma_f32_16x16x32_bf16 v[64:67], v[184:187], v[32:35], v[64:67]
v_mfma_f32_16x16x32_bf16 v[68:71], v[248:251], v[32:35], v[68:71]
v_mfma_f32_16x16x32_bf16 v[72:75], v[184:187], v[36:39], v[72:75]
v_mfma_f32_16x16x32_bf16 v[76:79], v[248:251], v[36:39], v[76:79]
s_waitcnt lgkmcnt(0)
v_mfma_f32_16x16x32_bf16 v[64:67], v[188:191], v[40:43], v[64:67]
v_mfma_f32_16x16x32_bf16 v[68:71], v[252:255], v[40:43], v[68:71]
v_mfma_f32_16x16x32_bf16 v[72:75], v[188:191], v[44:47], v[72:75]
v_mfma_f32_16x16x32_bf16 v[76:79], v[252:255], v[44:47], v[76:79]
s_cmp_ge_u32 s36, 3
s_cselect_b32 s58, s62, 0x70000000
s_add_u32 s49, s49, 229376
s_add_u32 s62, s62, 65536
s_add_u32 s59, s59, 229376
s_add_u32 s36, s36, 1
v_add_u32 v11, 0x10000, v11
s_nop 0
v_cvt_pk_bf16_f32 v80, v64, v65
v_cvt_pk_bf16_f32 v81, v66, v67
v_cvt_pk_bf16_f32 v82, v68, v69
v_cvt_pk_bf16_f32 v83, v70, v71
v_cvt_pk_bf16_f32 v84, v72, v73
v_cvt_pk_bf16_f32 v85, v74, v75
v_cvt_pk_bf16_f32 v86, v76, v77
v_cvt_pk_bf16_f32 v87, v78, v79
buffer_store_dwordx4 v[80:83], v7, s[4:7], s58 offen offset:0 sc1
buffer_store_dwordx4 v[84:87], v7, s[4:7], s58 offen offset:1024 sc1
s_endpgm
Lln_6:
s_sub_u32 s26, s44, 56
s_and_b32 s52, s26, 3
s_lshl_b32 s53, s32, 2
v_lshrrev_b32 v80, 3, v9
v_and_b32 v81, 7, v9
s_lshr_b32 s38, s52, 1
s_lshl_b32 s38, s38, 10
s_and_b32 s39, s52, 1
s_lshl_b32 s39, s39, 7
s_add_u32 s38, s38, s39
s_lshl_b32 s39, s53, 12
s_add_u32 s38, s38, s39
v_lshl_add_u32 v6, v81, 4, s38
v_and_b32 v82, 3, v80
v_lshl_add_u32 v6, v82, 8, v6
v_lshrrev_b32 v82, 2, v80
v_lshl_add_u32 v6, v82, 11, v6
s_lshl_b32 s38, s52, 14
s_lshl_b32 s39, s53, 7
s_add_u32 s38, s38, s39
v_lshl_add_u32 v7, v81, 11, s38
v_lshl_add_u32 v7, v80, 4, v7
s_lshl_b32 s38, s53, 8
v_lshl_add_u32 v8, v80, 5, s38
v_and_b32 v12, 7, v9
v_lshlrev_b32 v12, 5, v12
s_lshl_b32 s38, s32, 3
v_add_u32 v11, s38, v12
s_mov_b32 s60, 0x00003f80
s_mov_b32 s61, 0x3f800000
v_min_u32 v2, 31, v9
v_lshlrev_b32 v2, 7, v2
s_lshr_b32 s47, s26, 2
s_xor_b32 s47, s47, 1
s_lshl_b32 s47, s47, 12
s_add_u32 s47, s47, 3440640
Lst_654:
buffer_load_dword v48, off, s[12:15], 0 offset:16 sc1
buffer_load_dword v49, off, s[12:15], 0 offset:144 sc1
s_waitcnt vmcnt(0)
v_add_u32 v48, v48, v49
s_nop 0
v_readfirstlane_b32 s38, v48
s_nop 3
s_and_b32 s39, s38, 0xffff
s_cmp_eq_u32 s39, 0x100
s_cbranch_scc1 Lso_655
s_sub_u32 s37, s37, 1
s_cbranch_scc1 Lend_7
s_sleep 8
s_branch Lst_654
Lso_655:
s_bfe_u32 s35, s38, 0x80010
s_bfe_u32 s46, s38, 0x10018
s_lshl_b32 s46, s46, 13
s_barrier
v_min_u32 v80, 31, v9
v_lshlrev_b32 v80, 7, v80
s_mov_b32 s38, 3448832
Lbw_656:
buffer_load_dword v81, v80, s[4:7], s38 offen sc1
s_waitcnt vmcnt(0)
v_cmp_gt_u32 vcc, 1, v81
s_cbranch_vccz Lbo_657
s_sub_u32 s37, s37, 1
s_cbranch_scc1 Lend_7
s_sleep 8
s_branch Lbw_656
Lbo_657:
s_mov_b32 s38, 3153920
buffer_load_dwordx4 v[128:131], v8, s[4:7], s38 offen offset:0 sc1
buffer_load_dwordx4 v[132:135], v8, s[4:7], s38 offen offset:16 sc1
buffer_load_dwordx4 v[136:139], v8, s[4:7], s38 offen offset:256 sc1
buffer_load_dwordx4 v[140:143], v8, s[4:7], s38 offen offset:272 sc1
buffer_load_dwordx4 v[144:147], v8, s[4:7], s38 offen offset:512 sc1
buffer_load_dwordx4 v[148:151], v8, s[4:7], s38 offen offset:528 sc1
buffer_load_dwordx4 v[152:155], v8, s[4:7], s38 offen offset:768 sc1
buffer_load_dwordx4 v[156:159], v8, s[4:7], s38 offen offset:784 sc1
s_mov_b32 s38, 3158016
buffer_load_dwordx4 v[192:195], v8, s[4:7], s38 offen offset:0 sc1
buffer_load_dwordx4 v[196:199], v8, s[4:7], s38 offen offset:16 sc1
buffer_load_dwordx4 v[200:203], v8, s[4:7], s38 offen offset:256 sc1
buffer_load_dwordx4 v[204:207], v8, s[4:7], s38 offen offset:272 sc1
buffer_load_dwordx4 v[208:211], v8, s[4:7], s38 offen offset:512 sc1
buffer_load_dwordx4 v[212:215], v8, s[4:7], s38 offen offset:528 sc1
buffer_load_dwordx4 v[216:219], v8, s[4:7], s38 offen offset:768 sc1
buffer_load_dwordx4 v[220:223], v8, s[4:7], s38 offen offset:784 sc1
s_mov_b32 s38, 3162112
buffer_load_dwordx4 v[160:163], v8, s[4:7], s38 offen offset:0 sc1
buffer_load_dwordx4 v[164:167], v8, s[4:7], s38 offen offset:16 sc1
buffer_load_dwordx4 v[168:171], v8, s[4:7], s38 offen offset:256 sc1
buffer_load_dwordx4 v[172:175], v8, s[4:7], s38 offen offset:272 sc1
buffer_load_dwordx4 v[176:179], v8, s[4:7], s38 offen offset:512 sc1
buffer_load_dwordx4 v[180:183], v8, s[4:7], s38 offen offset:528 sc1
buffer_load_dwordx4 v[184:187], v8, s[4:7], s38 offen offset:768 sc1
buffer_load_dwordx4 v[188:191], v8, s[4:7], s38 offen offset:784 sc1
s_waitcnt vmcnt(0)
v_pk_add_f32 v[160:161], v[160:161], 1.0 op_sel_hi:[1,0]
v_pk_add_f32 v[162:163], v[162:163], 1.0 op_sel_hi:[1,0]
v_pk_add_f32 v[164:165], v[164:165], 1.0 op_sel_hi:[1,0]
v_pk_add_f32 v[166:167], v[166:167], 1.0 op_sel_hi:[1,0]
v_pk_add_f32 v[168:169], v[168:169], 1.0 op_sel_hi:[1,0]
v_pk_add_f32 v[170:171], v[170:171], 1.0 op_sel_hi:[1,0]
v_pk_add_f32 v[172:173], v[172:173], 1.0 op_sel_hi:[1,0]
v_pk_add_f32 v[174:175], v[174:175], 1.0 op_sel_hi:[1,0]
v_pk_add_f32 v[176:177], v[176:177], 1.0 op_sel_hi:[1,0]
v_pk_add_f32 v[178:179], v[178:179], 1.0 op_sel_hi:[1,0]
v_pk_add_f32 v[180:181], v[180:181], 1.0 op_sel_hi:[1,0]
v_pk_add_f32 v[182:183], v[182:183], 1.0 op_sel_hi:[1,0]
v_pk_add_f32 v[184:185], v[184:185], 1.0 op_sel_hi:[1,0]
v_pk_add_f32 v[186:187], v[186:187], 1.0 op_sel_hi:[1,0]
v_pk_add_f32 v[188:189], v[188:189], 1.0 op_sel_hi:[1,0]
v_pk_add_f32 v[190:191], v[190:191], 1.0 op_sel_hi:[1,0]
s_lshr_b32 s36, s26, 2
Lln_658:
s_lshl_b32 s49, s36, 16
buffer_load_dwordx4 v[80:83], v7, s[88:91], s49 offen offset:0
buffer_load_dwordx4 v[84:87], v7, s[88:91], s49 offen offset:128
buffer_load_dwordx4 v[88:91], v7, s[88:91], s49 offen offset:256
buffer_load_dwordx4 v[92:95], v7, s[88:91], s49 offen offset:384
s_add_u32 s48, s36, 1
s_cmp_lg_u32 s32, 0
s_cbranch_scc1 Llo_659
Lbw_660:
buffer_load_dword v3, v2, s[4:7], s47 offen sc1
s_waitcnt vmcnt(0)
v_cmp_gt_u32 vcc, s48, v3
s_cbranch_vccz Lbo_661
s_sub_u32 s37, s37, 1
s_cbranch_scc1 Lend_7
s_sleep 2
s_branch Lbw_660
Lbo_661:
Llo_659:
s_waitcnt vmcnt(0)
s_barrier
Lla_662:
s_add_u32 s39, s49, 117440512
buffer_load_dwordx4 v[16:19], v6, s[4:7], s39 offen sc1
s_add_u32 s39, s49, 121634816
buffer_load_dwordx4 v[20:23], v6, s[4:7], s39 offen sc1
s_add_u32 s39, s49, 125829120
buffer_load_dwordx4 v[24:27], v6, s[4:7], s39 offen sc1
s_add_u32 s39, s49, 130023424
buffer_load_dwordx4 v[28:31], v6, s[4:7], s39 offen sc1
s_add_u32 s39, s49, 117444608
buffer_load_dwordx4 v[32:35], v6, s[4:7], s39 offen sc1
s_add_u32 s39, s49, 121638912
buffer_load_dwordx4 v[36:39], v6, s[4:7], s39 offen sc1
s_add_u32 s39, s49, 125833216
buffer_load_dwordx4 v[40:43], v6, s[4:7], s39 offen sc1
s_add_u32 s39, s49, 130027520
buffer_load_dwordx4 v[44:47], v6, s[4:7], s39 offen sc1
s_add_u32 s39, s49, 117448704
buffer_load_dwordx4 v[48:51], v6, s[4:7], s39 offen sc1
s_add_u32 s39, s49, 121643008
buffer_load_dwordx4 v[52:55], v6, s[4:7], s39 offen sc1
s_add_u32 s39, s49, 125837312
buffer_load_dwordx4 v[56:59], v6, s[4:7], s39 offen sc1
s_add_u32 s39, s49, 130031616
buffer_load_dwordx4 v[60:63], v6, s[4:7], s39 offen sc1
s_add_u32 s39, s49, 117452800
buffer_load_dwordx4 v[64:67], v6, s[4:7], s39 offen sc1
s_add_u32 s39, s49, 121647104
buffer_load_dwordx4 v[68:71], v6, s[4:7], s39 offen sc1
s_add_u32 s39, s49, 125841408
buffer_load_dwordx4 v[72:75], v6, s[4:7], s39 offen sc1
s_add_u32 s39, s49, 130035712
buffer_load_dwordx4 v[76:79], v6, s[4:7], s39 offen sc1
s_cmp_lt_u32 s36, 60
s_cbranch_scc1 Lls_663
s_sub_u32 s37, s37, 1
s_cbranch_scc1 Lend_7
v_mov_b32 v224, 0
s_waitcnt vmcnt(12)
v_max3_u32 v224, v224, v16, v17
v_max3_u32 v224, v224, v18, v19
v_max3_u32 v224, v224, v20, v21
v_max3_u32 v224, v224, v22, v23
v_max3_u32 v224, v224, v24, v25
v_max3_u32 v224, v224, v26, v27
v_max3_u32 v224, v224, v28, v29
v_max3_u32 v224, v224, v30, v31
s_waitcnt vmcnt(8)
v_max3_u32 v224, v224, v32, v33
v_max3_u32 v224, v224, v34, v35
v_max3_u32 v224, v224, v36, v37
v_max3_u32 v224, v224, v38, v39
v_max3_u32 v224, v224, v40, v41
v_max3_u32 v224, v224, v42, v43
v_max3_u32 v224, v224, v44, v45
v_max3_u32 v224, v224, v46, v47
s_waitcnt vmcnt(4)
v_max3_u32 v224, v224, v48, v49
v_max3_u32 v224, v224, v50, v51
v_max3_u32 v224, v224, v52, v53
v_max3_u32 v224, v224, v54, v55
v_max3_u32 v224, v224, v56, v57
v_max3_u32 v224, v224, v58, v59
v_max3_u32 v224, v224, v60, v61
v_max3_u32 v224, v224, v62, v63
s_waitcnt vmcnt(0)
v_max3_u32 v224, v224, v64, v65
v_max3_u32 v224, v224, v66, v67
v_max3_u32 v224, v224, v68, v69
v_max3_u32 v224, v224, v70, v71
v_max3_u32 v224, v224, v72, v73
v_max3_u32 v224, v224, v74, v75
v_max3_u32 v224, v224, v76, v77
v_max3_u32 v224, v224, v78, v79
v_cmp_eq_u32 vcc, -1, v224
s_cbranch_vccnz Lla_662
Lls_663:
v_lshlrev_b32 v96, 16, v80
v_and_b32 v97, 0xffff0000, v80
v_lshlrev_b32 v98, 16, v81
v_and_b32 v99, 0xffff0000, v81
v_lshlrev_b32 v100, 16, v82
v_and_b32 v101, 0xffff0000, v82
v_lshlrev_b32 v102, 16, v83
v_and_b32 v103, 0xffff0000, v83
v_lshlrev_b32 v104, 16, v84
v_and_b32 v105, 0xffff0000, v84
v_lshlrev_b32 v106, 16, v85
v_and_b32 v107, 0xffff0000, v85
v_lshlrev_b32 v108, 16, v86
v_and_b32 v109, 0xffff0000, v86
v_lshlrev_b32 v110, 16, v87
v_and_b32 v111, 0xffff0000, v87
v_lshlrev_b32 v112, 16, v88
v_and_b32 v113, 0xffff0000, v88
v_lshlrev_b32 v114, 16, v89
v_and_b32 v115, 0xffff0000, v89
v_lshlrev_b32 v116, 16, v90
v_and_b32 v117, 0xffff0000, v90
v_lshlrev_b32 v118, 16, v91
v_and_b32 v119, 0xffff0000, v91
v_lshlrev_b32 v120, 16, v92
v_and_b32 v121, 0xffff0000, v92
v_lshlrev_b32 v122, 16, v93
v_and_b32 v123, 0xffff0000, v93
v_lshlrev_b32 v124, 16, v94
v_and_b32 v125, 0xffff0000, v94
v_lshlrev_b32 v126, 16, v95
v_and_b32 v127, 0xffff0000, v95
s_waitcnt vmcnt(12)
v_dot2_f32_bf16 v224, v16, s60, 0
v_dot2_f32_bf16 v225, v16, s61, 0
v_dot2_f32_bf16 v226, v17, s60, 0
v_dot2_f32_bf16 v227, v17, s61, 0
v_dot2_f32_bf16 v228, v18, s60, 0
v_dot2_f32_bf16 v229, v18, s61, 0
v_dot2_f32_bf16 v230, v19, s60, 0
v_dot2_f32_bf16 v231, v19, s61, 0
v_dot2_f32_bf16 v224, v20, s60, v224
v_dot2_f32_bf16 v225, v20, s61, v225
v_dot2_f32_bf16 v226, v21, s60, v226
v_dot2_f32_bf16 v227, v21, s61, v227
v_dot2_f32_bf16 v228, v22, s60, v228
v_dot2_f32_bf16 v229, v22, s61, v229
v_dot2_f32_bf16 v230, v23, s60, v230
v_dot2_f32_bf16 v231, v23, s61, v231
v_dot2_f32_bf16 v224, v24, s60, v224
v_dot2_f32_bf16 v225, v24, s61, v225
v_dot2_f32_bf16 v226, v25, s60, v226
v_dot2_f32_bf16 v227, v25, s61, v227
v_dot2_f32_bf16 v228, v26, s60, v228
v_dot2_f32_bf16 v229, v26, s61, v229
v_dot2_f32_bf16 v230, v27, s60, v230
v_dot2_f32_bf16 v231, v27, s61, v231
v_dot2_f32_bf16 v224, v28, s60, v224
v_dot2_f32_bf16 v225, v28, s61, v225
v_dot2_f32_bf16 v226, v29, s60, v226
v_dot2_f32_bf16 v227, v29, s61, v227
v_dot2_f32_bf16 v228, v30, s60, v228
v_dot2_f32_bf16 v229, v30, s61, v229
v_dot2_f32_bf16 v230, v31, s60, v230
v_dot2_f32_bf16 v231, v31, s61, v231
s_nop 1
v_pk_fma_f32 v[96:97], v[224:225], v[128:129], v[96:97]
v_pk_fma_f32 v[98:99], v[226:227], v[130:131], v[98:99]
v_pk_fma_f32 v[100:101], v[228:229], v[132:133], v[100:101]
v_pk_fma_f32 v[102:103], v[230:231], v[134:135], v[102:103]
v_cvt_pk_bf16_f32 v80, v96, v97
v_cvt_pk_bf16_f32 v81, v98, v99
v_cvt_pk_bf16_f32 v82, v100, v101
v_cvt_pk_bf16_f32 v83, v102, v103
s_add_u32 s39, s49, 12582912
buffer_store_dwordx4 v[80:83], v6, s[4:7], s39 offen sc1
v_lshlrev_b32 v96, 16, v80
v_and_b32 v97, 0xffff0000, v80
v_lshlrev_b32 v98, 16, v81
v_and_b32 v99, 0xffff0000, v81
v_lshlrev_b32 v100, 16, v82
v_and_b32 v101, 0xffff0000, v82
v_lshlrev_b32 v102, 16, v83
v_and_b32 v103, 0xffff0000, v83
v_pk_mul_f32 v[232:233], v[96:97], 1.0 op_sel_hi:[1,0]
v_pk_mul_f32 v[234:235], v[96:97], v[96:97]
v_pk_add_f32 v[232:233], v[232:233], v[98:99]
v_pk_fma_f32 v[234:235], v[98:99], v[98:99], v[234:235]
v_pk_add_f32 v[232:233], v[232:233], v[100:101]
v_pk_fma_f32 v[234:235], v[100:101], v[100:101], v[234:235]
v_pk_add_f32 v[232:233], v[232:233], v[102:103]
v_pk_fma_f32 v[234:235], v[102:103], v[102:103], v[234:235]
s_waitcnt vmcnt(9)
v_dot2_f32_bf16 v224, v32, s60, 0
v_dot2_f32_bf16 v225, v32, s61, 0
v_dot2_f32_bf16 v226, v33, s60, 0
v_dot2_f32_bf16 v227, v33, s61, 0
v_dot2_f32_bf16 v228, v34, s60, 0
v_dot2_f32_bf16 v229, v34, s61, 0
v_dot2_f32_bf16 v230, v35, s60, 0
v_dot2_f32_bf16 v231, v35, s61, 0
v_dot2_f32_bf16 v224, v36, s60, v224
v_dot2_f32_bf16 v225, v36, s61, v225
v_dot2_f32_bf16 v226, v37, s60, v226
v_dot2_f32_bf16 v227, v37, s61, v227
v_dot2_f32_bf16 v228, v38, s60, v228
v_dot2_f32_bf16 v229, v38, s61, v229
v_dot2_f32_bf16 v230, v39, s60, v230
v_dot2_f32_bf16 v231, v39, s61, v231
v_dot2_f32_bf16 v224, v40, s60, v224
v_dot2_f32_bf16 v225, v40, s61, v225
v_dot2_f32_bf16 v226, v41, s60, v226
v_dot2_f32_bf16 v227, v41, s61, v227
v_dot2_f32_bf16 v228, v42, s60, v228
v_dot2_f32_bf16 v229, v42, s61, v229
v_dot2_f32_bf16 v230, v43, s60, v230
v_dot2_f32_bf16 v231, v43, s61, v231
v_dot2_f32_bf16 v224, v44, s60, v224
v_dot2_f32_bf16 v225, v44, s61, v225
v_dot2_f32_bf16 v226, v45, s60, v226
v_dot2_f32_bf16 v227, v45, s61, v227
v_dot2_f32_bf16 v228, v46, s60, v228
v_dot2_f32_bf16 v229, v46, s61, v229
v_dot2_f32_bf16 v230, v47, s60, v230
v_dot2_f32_bf16 v231, v47, s61, v231
s_nop 1
v_pk_fma_f32 v[104:105], v[224:225], v[136:137], v[104:105]
v_pk_fma_f32 v[106:107], v[226:227], v[138:139], v[106:107]
v_pk_fma_f32 v[108:109], v[228:229], v[140:141], v[108:109]
v_pk_fma_f32 v[110:111], v[230:231], v[142:143], v[110:111]
v_cvt_pk_bf16_f32 v84, v104, v105
v_cvt_pk_bf16_f32 v85, v106, v107
v_cvt_pk_bf16_f32 v86, v108, v109
v_cvt_pk_bf16_f32 v87, v110, v111
s_add_u32 s39, s49, 12587008
buffer_store_dwordx4 v[84:87], v6, s[4:7], s39 offen sc1
v_lshlrev_b32 v104, 16, v84
v_and_b32 v105, 0xffff0000, v84
v_lshlrev_b32 v106, 16, v85
v_and_b32 v107, 0xffff0000, v85
v_lshlrev_b32 v108, 16, v86
v_and_b32 v109, 0xffff0000, v86
v_lshlrev_b32 v110, 16, v87
v_and_b32 v111, 0xffff0000, v87
v_pk_add_f32 v[232:233], v[232:233], v[104:105]
v_pk_fma_f32 v[234:235], v[104:105], v[104:105], v[234:235]
v_pk_add_f32 v[232:233], v[232:233], v[106:107]
v_pk_fma_f32 v[234:235], v[106:107], v[106:107], v[234:235]
v_pk_add_f32 v[232:233], v[232:233], v[108:109]
v_pk_fma_f32 v[234:235], v[108:109], v[108:109], v[234:235]
v_pk_add_f32 v[232:233], v[232:233], v[110:111]
v_pk_fma_f32 v[234:235], v[110:111], v[110:111], v[234:235]
s_waitcnt vmcnt(6)
v_dot2_f32_bf16 v224, v48, s60, 0
v_dot2_f32_bf16 v225, v48, s61, 0
v_dot2_f32_bf16 v226, v49, s60, 0
v_dot2_f32_bf16 v227, v49, s61, 0
v_dot2_f32_bf16 v228, v50, s60, 0
v_dot2_f32_bf16 v229, v50, s61, 0
v_dot2_f32_bf16 v230, v51, s60, 0
v_dot2_f32_bf16 v231, v51, s61, 0
v_dot2_f32_bf16 v224, v52, s60, v224
v_dot2_f32_bf16 v225, v52, s61, v225
v_dot2_f32_bf16 v226, v53, s60, v226
v_dot2_f32_bf16 v227, v53, s61, v227
v_dot2_f32_bf16 v228, v54, s60, v228
v_dot2_f32_bf16 v229, v54, s61, v229
v_dot2_f32_bf16 v230, v55, s60, v230
v_dot2_f32_bf16 v231, v55, s61, v231
v_dot2_f32_bf16 v224, v56, s60, v224
v_dot2_f32_bf16 v225, v56, s61, v225
v_dot2_f32_bf16 v226, v57, s60, v226
v_dot2_f32_bf16 v227, v57, s61, v227
v_dot2_f32_bf16 v228, v58, s60, v228
v_dot2_f32_bf16 v229, v58, s61, v229
v_dot2_f32_bf16 v230, v59, s60, v230
v_dot2_f32_bf16 v231, v59, s61, v231
v_dot2_f32_bf16 v224, v60, s60, v224
v_dot2_f32_bf16 v225, v60, s61, v225
v_dot2_f32_bf16 v226, v61, s60, v226
v_dot2_f32_bf16 v227, v61, s61, v227
v_dot2_f32_bf16 v228, v62, s60, v228
v_dot2_f32_bf16 v229, v62, s61, v229
v_dot2_f32_bf16 v230, v63, s60, v230
v_dot2_f32_bf16 v231, v63, s61, v231
s_nop 1
v_pk_fma_f32 v[112:113], v[224:225], v[144:145], v[112:113]
v_pk_fma_f32 v[114:115], v[226:227], v[146:147], v[114:115]
v_pk_fma_f32 v[116:117], v[228:229], v[148:149], v[116:117]
v_pk_fma_f32 v[118:119], v[230:231], v[150:151], v[118:119]
v_cvt_pk_bf16_f32 v88, v112, v113
v_cvt_pk_bf16_f32 v89, v114, v115
v_cvt_pk_bf16_f32 v90, v116, v117
v_cvt_pk_bf16_f32 v91, v118, v119
s_add_u32 s39, s49, 12591104
buffer_store_dwordx4 v[88:91], v6, s[4:7], s39 offen sc1
v_lshlrev_b32 v112, 16, v88
v_and_b32 v113, 0xffff0000, v88
v_lshlrev_b32 v114, 16, v89
v_and_b32 v115, 0xffff0000, v89
v_lshlrev_b32 v116, 16, v90
v_and_b32 v117, 0xffff0000, v90
v_lshlrev_b32 v118, 16, v91
v_and_b32 v119, 0xffff0000, v91
v_pk_add_f32 v[232:233], v[232:233], v[112:113]
v_pk_fma_f32 v[234:235], v[112:113], v[112:113], v[234:235]
v_pk_add_f32 v[232:233], v[232:233], v[114:115]
v_pk_fma_f32 v[234:235], v[114:115], v[114:115], v[234:235]
v_pk_add_f32 v[232:233], v[232:233], v[116:117]
v_pk_fma_f32 v[234:235], v[116:117], v[116:117], v[234:235]
v_pk_add_f32 v[232:233], v[232:233], v[118:119]
v_pk_fma_f32 v[234:235], v[118:119], v[118:119], v[234:235]
s_waitcnt vmcnt(3)
v_dot2_f32_bf16 v224, v64, s60, 0
v_dot2_f32_bf16 v225, v64, s61, 0
v_dot2_f32_bf16 v226, v65, s60, 0
v_dot2_f32_bf16 v227, v65, s61, 0
v_dot2_f32_bf16 v228, v66, s60, 0
v_dot2_f32_bf16 v229, v66, s61, 0
v_dot2_f32_bf16 v230, v67, s60, 0
v_dot2_f32_bf16 v231, v67, s61, 0
v_dot2_f32_bf16 v224, v68, s60, v224
v_dot2_f32_bf16 v225, v68, s61, v225
v_dot2_f32_bf16 v226, v69, s60, v226
v_dot2_f32_bf16 v227, v69, s61, v227
v_dot2_f32_bf16 v228, v70, s60, v228
v_dot2_f32_bf16 v229, v70, s61, v229
v_dot2_f32_bf16 v230, v71, s60, v230
v_dot2_f32_bf16 v231, v71, s61, v231
v_dot2_f32_bf16 v224, v72, s60, v224
v_dot2_f32_bf16 v225, v72, s61, v225
v_dot2_f32_bf16 v226, v73, s60, v226
v_dot2_f32_bf16 v227, v73, s61, v227
v_dot2_f32_bf16 v228, v74, s60, v228
v_dot2_f32_bf16 v229, v74, s61, v229
v_dot2_f32_bf16 v230, v75, s60, v230
v_dot2_f32_bf16 v231, v75, s61, v231
v_dot2_f32_bf16 v224, v76, s60, v224
v_dot2_f32_bf16 v225, v76, s61, v225
v_dot2_f32_bf16 v226, v77, s60, v226
v_dot2_f32_bf16 v227, v77, s61, v227
v_dot2_f32_bf16 v228, v78, s60, v228
v_dot2_f32_bf16 v229, v78, s61, v229
v_dot2_f32_bf16 v230, v79, s60, v230
v_dot2_f32_bf16 v231, v79, s61, v231
s_nop 1
v_pk_fma_f32 v[120:121], v[224:225], v[152:153], v[120:121]
v_pk_fma_f32 v[122:123], v[226:227], v[154:155], v[122:123]
v_pk_fma_f32 v[124:125], v[228:229], v[156:157], v[124:125]
v_pk_fma_f32 v[126:127], v[230:231], v[158:159], v[126:127]
v_cvt_pk_bf16_f32 v92, v120, v121
v_cvt_pk_bf16_f32 v93, v122, v123
v_cvt_pk_bf16_f32 v94, v124, v125
v_cvt_pk_bf16_f32 v95, v126, v127
s_add_u32 s39, s49, 12595200
buffer_store_dwordx4 v[92:95], v6, s[4:7], s39 offen sc1
v_lshlrev_b32 v120, 16, v92
v_and_b32 v121, 0xffff0000, v92
v_lshlrev_b32 v122, 16, v93
v_and_b32 v123, 0xffff0000, v93
v_lshlrev_b32 v124, 16, v94
v_and_b32 v125, 0xffff0000, v94
v_lshlrev_b32 v126, 16, v95
v_and_b32 v127, 0xffff0000, v95
v_pk_add_f32 v[232:233], v[232:233], v[120:121]
v_pk_fma_f32 v[234:235], v[120:121], v[120:121], v[234:235]
v_pk_add_f32 v[232:233], v[232:233], v[122:123]
v_pk_fma_f32 v[234:235], v[122:123], v[122:123], v[234:235]
v_pk_add_f32 v[232:233], v[232:233], v[124:125]
v_pk_fma_f32 v[234:235], v[124:125], v[124:125], v[234:235]
v_pk_add_f32 v[232:233], v[232:233], v[126:127]
v_pk_fma_f32 v[234:235], v[126:127], v[126:127], v[234:235]
v_add_f32 v232, v232, v233
v_add_f32 v233, v234, v235
s_nop 1
v_add_f32_dpp v232, v232, v232 row_ror:8 row_mask:0xf bank_mask:0xf
v_add_f32_dpp v233, v233, v233 row_ror:8 row_mask:0xf bank_mask:0xf
v_mov_b32 v234, v232
v_mov_b32 v235, v233
s_nop 1
v_permlane16_swap_b32 v232, v234
v_permlane16_swap_b32 v233, v235
v_add_f32 v232, v232, v234
v_add_f32 v233, v233, v235
v_mov_b32 v234, v232
v_mov_b32 v235, v233
s_nop 1
v_permlane32_swap_b32 v232, v234
v_permlane32_swap_b32 v233, v235
v_add_f32 v232, v232, v234
v_add_f32 v233, v233, v235
ds_write_b64 v11, v[232:233] offset:2048
s_waitcnt lgkmcnt(0)
s_barrier
ds_read_b128 v[232:235], v12 offset:2048
ds_read_b128 v[236:239], v12 offset:2064
v_xor_b32 v11, 512, v11
v_xor_b32 v12, 512, v12
s_mov_b32 s38, 0x3a800000
s_waitcnt lgkmcnt(0)
v_pk_add_f32 v[232:233], v[232:233], v[234:235]
v_pk_add_f32 v[236:237], v[236:237], v[238:239]
v_pk_add_f32 v[232:233], v[232:233], v[236:237]
v_pk_mul_f32 v[232:233], v[232:233], s[38:39] op_sel_hi:[1,0]
v_fma_f32 v233, -v232, v232, v233
v_max_f32 v233, 0, v233
v_add_f32 v233, 0x3727c5ac, v233
v_rsq_f32 v233, v233
s_nop 0
v_mul_f32 v232, -v232, v233
v_pk_fma_f32 v[96:97], v[96:97], v[232:233], v[232:233] op_sel:[0,1,0] op_sel_hi:[1,1,0]
v_pk_fma_f32 v[98:99], v[98:99], v[232:233], v[232:233] op_sel:[0,1,0] op_sel_hi:[1,1,0]
v_pk_fma_f32 v[100:101], v[100:101], v[232:233], v[232:233] op_sel:[0,1,0] op_sel_hi:[1,1,0]
v_pk_fma_f32 v[102:103], v[102:103], v[232:233], v[232:233] op_sel:[0,1,0] op_sel_hi:[1,1,0]
v_pk_fma_f32 v[104:105], v[104:105], v[232:233], v[232:233] op_sel:[0,1,0] op_sel_hi:[1,1,0]
v_pk_fma_f32 v[106:107], v[106:107], v[232:233], v[232:233] op_sel:[0,1,0] op_sel_hi:[1,1,0]
v_pk_fma_f32 v[108:109], v[108:109], v[232:233], v[232:233] op_sel:[0,1,0] op_sel_hi:[1,1,0]
v_pk_fma_f32 v[110:111], v[110:111], v[232:233], v[232:233] op_sel:[0,1,0] op_sel_hi:[1,1,0]
v_pk_fma_f32 v[112:113], v[112:113], v[232:233], v[232:233] op_sel:[0,1,0] op_sel_hi:[1,1,0]
v_pk_fma_f32 v[114:115], v[114:115], v[232:233], v[232:233] op_sel:[0,1,0] op_sel_hi:[1,1,0]
v_pk_fma_f32 v[116:117], v[116:117], v[232:233], v[232:233] op_sel:[0,1,0] op_sel_hi:[1,1,0]
v_pk_fma_f32 v[118:119], v[118:119], v[232:233], v[232:233] op_sel:[0,1,0] op_sel_hi:[1,1,0]
v_pk_fma_f32 v[120:121], v[120:121], v[232:233], v[232:233] op_sel:[0,1,0] op_sel_hi:[1,1,0]
v_pk_fma_f32 v[122:123], v[122:123], v[232:233], v[232:233] op_sel:[0,1,0] op_sel_hi:[1,1,0]
v_pk_fma_f32 v[124:125], v[124:125], v[232:233], v[232:233] op_sel:[0,1,0] op_sel_hi:[1,1,0]
v_pk_fma_f32 v[126:127], v[126:127], v[232:233], v[232:233] op_sel:[0,1,0] op_sel_hi:[1,1,0]
v_pk_fma_f32 v[96:97], v[96:97], v[160:161], v[192:193]
v_pk_fma_f32 v[98:99], v[98:99], v[162:163], v[194:195]
v_pk_fma_f32 v[100:101], v[100:101], v[164:165], v[196:197]
v_pk_fma_f32 v[102:103], v[102:103], v[166:167], v[198:199]
v_cvt_pk_bf16_f32 v16, v96, v97
v_cvt_pk_bf16_f32 v17, v98, v99
v_cvt_pk_bf16_f32 v18, v100, v101
v_cvt_pk_bf16_f32 v19, v102, v103
s_add_u32 s39, s49, 16777216
buffer_store_dwordx4 v[16:19], v6, s[4:7], s39 offen sc1
v_pk_fma_f32 v[104:105], v[104:105], v[168:169], v[200:201]
v_pk_fma_f32 v[106:107], v[106:107], v[170:171], v[202:203]
v_pk_fma_f32 v[108:109], v[108:109], v[172:173], v[204:205]
v_pk_fma_f32 v[110:111], v[110:111], v[174:175], v[206:207]
v_cvt_pk_bf16_f32 v20, v104, v105
v_cvt_pk_bf16_f32 v21, v106, v107
v_cvt_pk_bf16_f32 v22, v108, v109
v_cvt_pk_bf16_f32 v23, v110, v111
s_add_u32 s39, s49, 16781312
buffer_store_dwordx4 v[20:23], v6, s[4:7], s39 offen sc1
v_pk_fma_f32 v[112:113], v[112:113], v[176:177], v[208:209]
v_pk_fma_f32 v[114:115], v[114:115], v[178:179], v[210:211]
v_pk_fma_f32 v[116:117], v[116:117], v[180:181], v[212:213]
v_pk_fma_f32 v[118:119], v[118:119], v[182:183], v[214:215]
v_cvt_pk_bf16_f32 v24, v112, v113
v_cvt_pk_bf16_f32 v25, v114, v115
v_cvt_pk_bf16_f32 v26, v116, v117
v_cvt_pk_bf16_f32 v27, v118, v119
s_add_u32 s39, s49, 16785408
buffer_store_dwordx4 v[24:27], v6, s[4:7], s39 offen sc1
v_pk_fma_f32 v[120:121], v[120:121], v[184:185], v[216:217]
v_pk_fma_f32 v[122:123], v[122:123], v[186:187], v[218:219]
v_pk_fma_f32 v[124:125], v[124:125], v[188:189], v[220:221]
v_pk_fma_f32 v[126:127], v[126:127], v[190:191], v[222:223]
v_cvt_pk_bf16_f32 v28, v120, v121
v_cvt_pk_bf16_f32 v29, v122, v123
v_cvt_pk_bf16_f32 v30, v124, v125
v_cvt_pk_bf16_f32 v31, v126, v127
s_add_u32 s39, s49, 16789504
buffer_store_dwordx4 v[28:31], v6, s[4:7], s39 offen sc1
v_mov_b32 v5, s48
s_waitcnt vmcnt(0)
s_barrier
buffer_store_dword v5, v4, s[4:7], 0 offen sc1
s_add_u32 s36, s36, 2
s_cmp_lt_u32 s36, 64
s_cbranch_scc1 Lln_658
s_endpgm
Lcode_end:

.section .rodata,"a"
.p2align 6
.amdhsa_kernel adaLN_cond__memory_aug_recurrent_mem_tr__glu_gated_swiglu__prompt_kernel
  .amdhsa_next_free_vgpr 512
  .amdhsa_next_free_sgpr 102
  .amdhsa_accum_offset 256
  .amdhsa_group_segment_fixed_size 0
  .amdhsa_kernarg_size 128
  .amdhsa_user_sgpr_count 2
  .amdhsa_user_sgpr_kernarg_segment_ptr 1
  .amdhsa_system_sgpr_workgroup_id_x 1
  .amdhsa_float_denorm_mode_32 3
.end_amdhsa_kernel
```
